```python
import torch

def _softmax(x, axis=-1):
    return torch.softmax(x, dim=axis)

def _gelu(x):
    return torch.nn.functional.gelu(x, approximate='tanh')

def _silu(x):
    return torch.nn.functional.silu(x)

def _sigmoid(x):
    return torch.sigmoid(x)

def _layernorm(x, axis=-1, eps=1e-05):
    m = x.mean(dim=axis, keepdim=True)
    v = x.var(dim=axis, keepdim=True, unbiased=False)
    return (x - m) / torch.sqrt(v + eps)

def _scatter_add(tgt, idx, src, axis=0):
    return tgt.clone().index_add_(axis, idx, src)

def _segment_sum(src, seg, n):
    out = torch.zeros((n,) + src.shape[1:], dtype=src.dtype)
    return out.index_add_(0, seg, src)

def _pad(x, pw):
    flat = tuple((v for pair in reversed(pw) for v in pair))
    return torch.nn.functional.pad(x, flat)
kernel_name = 'recurrent_scan__sliding_block__mixer_gmlp__prompt'

def setup_inputs():

    _w = lambda a: (lambda t: t.to(torch.bfloat16) if t.is_floating_point() else t)(torch.as_tensor(a))

    def _A_setup():
        B, S, D = (1, 2048, 576)
        return {'x': _w((lambda *s: torch.randn(*s, dtype=torch.bfloat16) * 0.05)(B, S, D)), 'wqkv': _w((lambda *s: torch.randn(*s, dtype=torch.bfloat16) * 0.05)(D, 3 * D)), 'wo': _w((lambda *s: torch.randn(*s, dtype=torch.bfloat16) * 0.05)(D, D))}
    _A_in = _A_setup()

    def _B_setup():
        B, S, D, F = (1, 2048, 576, 4608)
        Fh = F // 2
        return {'x': _w((lambda *s: torch.randn(*s, dtype=torch.bfloat16) * 0.05)(B, S, D)), 'w_in': _w((lambda *s: torch.randn(*s, dtype=torch.bfloat16) * 0.4)(D, 2 * Fh)), 'w_sp': _w(0.01 * (lambda *s: torch.randn(*s, dtype=torch.bfloat16) * 0.4)(S, S)), 'b_sp': _w(1.0 + 0.01 * (lambda *s: torch.randn(*s, dtype=torch.bfloat16) * 0.05)(S)), 'w_out': _w((lambda *s: torch.randn(*s, dtype=torch.bfloat16) * 0.05)(Fh, D))}
    _B_in = _B_setup()
    return {'A_x': _A_in['x'], 'A_wqkv': _A_in['wqkv'], 'A_wo': _A_in['wo'], 'B_x': _B_in['x'], 'B_w_in': _B_in['w_in'], 'B_w_sp': _B_in['w_sp'], 'B_b_sp': _B_in['b_sp'], 'B_w_out': _B_in['w_out']}

def reference(A_x, A_wqkv, A_wo, B_x, B_w_in, B_w_sp, B_b_sp, B_w_out):

    def _A_ref(x, wqkv, wo):
        B, S, D = x.shape
        H = 32
        Dh = D // H
        W = 256
        qkv = (lambda x, *d: x.permute(*d))((x @ wqkv).reshape(B, S, 3, H, Dh), 2, 0, 3, 1, 4)
        q, k, v = (qkv[0], qkv[1], qkv[2])
        scores = torch.einsum('bhqd,bhkd->bhqk', q, k) * Dh ** (-0.5)
        idx = torch.arange(S)
        mask = (idx[:, None] - idx[None, :] >= 0) & (idx[:, None] - idx[None, :] < W)
        scores = torch.where(mask[None, None], scores, -1000000000.0)
        p = _softmax(scores, axis=-1)
        o = torch.einsum('bhqk,bhkd->bhqd', p, v)
        return (lambda x, *d: x.permute(*d))(o, 0, 2, 1, 3).reshape(B, S, D) @ wo

    def _B_ref(x, w_in, w_sp, b_sp, w_out):
        B, S, D = x.shape
        F = w_in.shape[-1]
        Fh = F // 2
        z = _gelu(torch.einsum('bsd,df->bsf', x, w_in))
        z1 = z[..., :Fh].clone()
        z2 = _layernorm(z[..., Fh:], axis=-1)
        g = torch.einsum('ts,bsf->btf', w_sp, z2) + b_sp[None, :, None]
        return torch.einsum('bsf,fd->bsd', z1 * g, w_out)
    x = A_x
    xn = _layernorm(x, axis=-1)
    s = _A_ref(xn, A_wqkv, A_wo)
    g = _silu(_B_ref(xn, B_w_in, B_w_sp, B_b_sp, B_w_out))
    return x + s * g
```

```asm
; @launch kernel=k1_kernel grid=(256,1,1) block=(256,1,1) lds=163840
.amdgcn_target "amdgcn-amd-amdhsa--gfx950"
.text
.globl k1_kernel
.p2align 8
.type k1_kernel,@function
k1_kernel:
    s_load_dwordx4 s[72:75], s[0:1], 72
    s_load_dwordx2 s[68:69], s[0:1], 32
    s_load_dwordx2 s[66:67], s[0:1], 8
    s_load_dwordx2 s[84:85], s[0:1], 40
    s_load_dwordx2 s[86:87], s[0:1], 56
    s_load_dwordx2 s[88:89], s[0:1], 16
    s_load_dwordx2 s[70:71], s[0:1], 0
    s_cmp_ge_u32 s2, 256
    s_cbranch_scc1 k1_end
    v_lshrrev_b32 v16, 6, v0
    v_and_b32 v17, 63, v0
    v_readfirstlane_b32 s40, v16
    s_and_b32 s76, s2, 7
    s_lshr_b32 s77, s2, 3
    s_and_b32 s78, s76, 1
    s_lshl_b32 s78, s78, 2
    s_and_b32 s79, s77, 3
    s_add_u32 s78, s78, s79
    s_lshr_b32 s79, s76, 1
    s_and_b32 s80, s77, 28
    s_add_u32 s41, s79, s80
    s_lshl_b32 s42, s78, 3
    s_lshl_b32 s79, s40, 1
    s_add_u32 s42, s42, s79
    s_mul_i32 s43, s42, 36864
    s_add_u32 s44, s43, 36864
    s_mul_i32 s45, s40, 3072
    v_lshlrev_b32 v10, 4, v17
    v_lshrrev_b32 v18, 3, v17
    s_mul_i32 s79, s40, 24
    v_add_u32 v18, s79, v18
    v_bfe_u32 v19, v17, 4, 1
    v_lshlrev_b32 v19, 2, v19
    v_and_b32 v20, 7, v17
    v_xor_b32 v19, v19, v20
    v_lshlrev_b32 v19, 4, v19
    v_mul_u32_u24 v7, 9216, v18
    v_add_u32 v7, v7, v19
    v_add_u32 v8, 72704, v7
    v_add_u32 v9, 145408, v7
    s_lshl_b32 s48, s41, 7
    s_add_u32 s46, s48, 4608
    s_mov_b32 s49, s48
    s_mov_b32 s6, 2359296
    s_mov_b32 s7, 0x20000
    s_mov_b32 s10, 5308416
    s_mov_b32 s11, 0x20000
    v_lshrrev_b32 v20, 2, v17
    s_mul_i32 s79, s40, 48
    v_add_u32 v20, s79, v20
    v_mul_u32_u24 v245, 9216, v20
    v_and_b32 v26, 3, v17
    v_lshl_add_u32 v245, v26, 4, v245
    v_add_u32 v247, 146432, v245
    v_add_u32 v249, 292864, v245
    s_and_b32 s79, s41, 7
    s_add_u32 s81, s79, 64
    s_bfe_u32 s80, s41, 0x10003
    s_lshl_b32 s47, s81, 6
    s_cmp_eq_u32 s80, 0
    s_cselect_b32 s82, 4608, 0
    s_cselect_b32 s53, 1.0, 0
    s_cselect_b32 s34, 0, 9437184
    s_cselect_b32 s38, 9437184, 0
    s_add_u32 s47, s47, s82
    v_and_b32 v80, 7, v17
    v_lshrrev_b32 v81, 3, v17
    s_lshl_b32 s79, s78, 5
    s_add_u32 s79, s79, s41
    s_lshl_b32 s79, s79, 3
    s_mul_i32 s83, s40, 18
    v_add_u32 v82, s83, v81
    v_mul_u32_u24 v83, 1152, v80
    v_lshl_add_u32 v83, v82, 4, v83
    v_mov_b32 v85, 2147483632
    v_cmp_gt_u32 vcc, 2, v81
    v_add_u32 v84, 256, v83
    s_nop 0
    v_cndmask_b32 v84, v85, v84, vcc
    s_mul_i32 s82, s79, 1152
    s_mov_b32 s26, 2359296
    s_mov_b32 s27, 0x20000
    s_waitcnt lgkmcnt(0)
    s_mov_b32 s24, s70
    s_mov_b32 s25, s71
    s_add_u32 s28, s74, 34603008
    s_addc_u32 s29, s75, 0
    s_mov_b32 s30, 81920
    s_mov_b32 s31, 0x20000
    s_lshl_b32 s83, s77, 2
    s_add_u32 s83, s83, s40
    s_cmp_eq_u32 s83, 3
    s_cbranch_scc1 k1_ld
    buffer_load_dwordx4 v[96:99], v83, s[24:27], s82 offen
    buffer_load_dwordx4 v[100:103], v83, s[24:27], s82 offen offset:128
    buffer_load_dwordx4 v[104:107], v84, s[24:27], s82 offen
    s_cmp_lg_u32 s41, 31
    s_cbranch_scc1 k1_nl
    v_mov_b32 v88, 0
    v_mov_b32 v89, 0
    v_mov_b32 v90, 0
    v_mov_b32 v91, 0
    v_mov_b32 v92, 0x3f803f80
    v_mov_b32 v93, 0x3f803f80
    v_mov_b32 v94, 0x3f803f80
    v_mov_b32 v95, 0x3f803f80
    v_lshlrev_b32 v86, 4, v0
    v_cmp_gt_u32 vcc, 128, v0
    s_nop 1
    v_cndmask_b32 v87, v85, v86, vcc
    s_lshl_b32 s83, s78, 11
    buffer_store_dwordx4 v[88:91], v87, s[28:31], s83 offen sc1
    s_add_u32 s16, s74, 31457280
    s_addc_u32 s17, s75, 0
    s_mov_b32 s18, 2392064
    s_mov_b32 s19, 0x20000
    v_mul_u32_u24 v87, 9344, v0
    v_add_u32 v87, 9216, v87
    v_cmp_gt_u32 vcc, 32, v0
    s_nop 1
    v_cndmask_b32 v87, v85, v87, vcc
    s_mul_i32 s83, s78, 299008
    buffer_store_dwordx4 v[92:95], v87, s[16:19], s83 offen sc1
    s_branch k1_nl
k1_ld:
    v_mov_b32 v88, 0
    v_mov_b32 v89, 0
    v_mov_b32 v90, 0
    v_mov_b32 v91, 0
    s_sub_u32 s83, 9, s2
    s_lshl_b32 s83, s83, 13
    buffer_store_dwordx4 v[88:91], v10, s[28:31], s83 offen offset:0 sc1
    buffer_store_dwordx4 v[88:91], v10, s[28:31], s83 offen offset:1024 sc1
    buffer_store_dwordx4 v[88:91], v10, s[28:31], s83 offen offset:2048 sc1
    buffer_store_dwordx4 v[88:91], v10, s[28:31], s83 offen offset:3072 sc1
    buffer_load_dwordx4 v[96:99], v83, s[24:27], s82 offen
    buffer_load_dwordx4 v[100:103], v83, s[24:27], s82 offen offset:128
    buffer_load_dwordx4 v[104:107], v84, s[24:27], s82 offen
    s_lshl_b32 s83, s2, 2
    s_add_u32 s83, s83, 128
    s_cmp_eq_u32 s2, 0
    s_cselect_b32 s83, 0, s83
    v_mov_b32 v87, 1
    v_mov_b32 v86, s83
    s_waitcnt vmcnt(3)
    s_mov_b64 exec, 1
    global_store_dword v86, v87, s[72:73] sc1
    s_mov_b64 exec, -1
k1_nl:
    s_mov_b32 s4, s74
    s_mov_b32 s5, s75
    s_mov_b32 s8, s68
    s_mov_b32 s9, s69
    s_mov_b32 s20, s66
    s_mov_b32 s21, s67
    s_mov_b32 s22, 1990656
    s_mov_b32 s23, 0x20000
    s_lshl_b32 s83, s2, 15
    v_lshlrev_b32 v94, 7, v0
    v_add_u32 v94, s83, v94
    buffer_load_dword v95, v94, s[8:11], 0 offen
    v_subrev_u32 v94, 5308416, v94
    buffer_load_dword v95, v94, s[20:23], 0 offen
    s_add_u32 m0, s45, 90112
    s_add_u32 s50, s46, 0
    buffer_load_dwordx4 v7, s[8:11], s50 offen offset:0 lds
    buffer_load_dwordx4 v8, s[8:11], s50 offen offset:1024 lds
    buffer_load_dwordx4 v9, s[8:11], s50 offen offset:2048 lds
    s_add_u32 m0, s45, 53248
    s_add_u32 s50, s47, 0
    buffer_load_dwordx4 v245, s[8:11], s50 offen offset:0 lds
    buffer_load_dwordx4 v247, s[8:11], s50 offen offset:1024 lds
    buffer_load_dwordx4 v249, s[8:11], s50 offen offset:2048 lds
    s_getpc_b64 s[16:17]
k1_pc:
    s_mov_b32 s18, code_end-k1_pc
    s_mov_b32 s19, 0x20000
    s_lshl_b32 s83, s77, 12
    v_lshlrev_b32 v86, 4, v0
    buffer_load_dword v87, v86, s[16:19], s83 offen
    v_add_u32 v86, s79, v80
    v_lshrrev_b32 v108, 5, v86
    v_mul_u32_u24 v108, 36, v108
    v_lshrrev_b32 v109, 1, v82
    v_add_u32 v108, v108, v109
    v_lshlrev_b32 v108, 10, v108
    v_and_b32 v109, 1, v82
    v_lshl_add_u32 v108, v109, 9, v108
    v_and_b32 v109, 31, v86
    v_lshl_add_u32 v108, v109, 4, v108
    v_add_u32 v109, 4096, v108
    v_add_u32 v110, 8192, v108
    v_cmp_gt_u32 vcc, 2, v81
    s_nop 1
    v_cndmask_b32 v110, v85, v110, vcc
    s_lshl_b32 s79, s2, 13
    v_lshlrev_b32 v255, 5, v0
    v_add_u32 v255, s79, v255
    v_lshlrev_b32 v13, 2, v17
    v_mul_u32_u24 v14, 3456, v18
    v_add_u32 v14, v14, v19
    v_add_u32 v15, 26624, v14
    v_add_u32 v223, 53248, v14
    s_mov_b32 s12, s66
    s_mov_b32 s13, s67
    s_mov_b32 s14, 1990656
    s_mov_b32 s15, 0x20000
    s_cmp_lt_u32 s41, 27
    s_cselect_b32 s14, s14, 0
    v_bfe_u32 v18, v17, 4, 1
    v_and_b32 v19, 3, v17
    v_lshl_add_u32 v18, v18, 2, v19
    v_and_b32 v19, 1, v18
    v_lshlrev_b32 v19, 2, v19
    v_lshrrev_b32 v20, 1, v18
    v_add_u32 v19, v19, v20
    v_lshrrev_b32 v20, 5, v17
    v_lshlrev_b32 v20, 3, v20
    v_bfe_u32 v21, v17, 2, 2
    v_add_u32 v20, v20, v21
    v_lshlrev_b32 v1, 7, v20
    v_lshl_add_u32 v1, v19, 3, v1
    v_bfe_u32 v21, v17, 3, 1
    v_lshlrev_b32 v21, 6, v21
    v_xor_b32 v1, v1, v21
    v_xor_b32 v2, 64, v1
    v_lshrrev_b32 v21, 1, v19
    v_and_b32 v21, s80, v21
    v_xor_b32 v21, v21, v19
    v_lshlrev_b32 v3, 6, v20
    v_lshl_add_u32 v3, v21, 3, v3
    v_add_u32 v4, 126976, v1
    v_add_u32 v1, 65536, v1
    v_add_u32 v5, 126976, v2
    v_add_u32 v2, 65536, v2
    v_add_u32 v3, 53248, v3
    v_bfe_u32 v20, v17, 4, 1
    v_mul_u32_u24 v11, 73728, v20
    v_lshrrev_b32 v21, 5, v17
    v_lshl_add_u32 v11, v21, 9, v11
    v_and_b32 v20, 15, v17
    v_lshl_add_u32 v11, v20, 4, v11
    s_mul_i32 s83, s42, 147456
    s_lshl_b32 s79, s41, 11
    s_add_u32 s54, s83, s79
    s_add_u32 s55, s54, 147456
    s_lshl_b32 s79, s81, 10
    s_add_u32 s56, s83, s79
    s_cmp_lt_u32 s41, 16
    s_cselect_b32 s79, 147456, 0
    s_add_u32 s56, s56, s79
    s_lshl_b32 s59, s42, 8
    s_add_u32 s16, s74, 4194304
    s_addc_u32 s17, s75, 0
    s_mov_b32 s18, 9437184
    s_mov_b32 s19, 0x20000
    s_add_u32 s20, s74, 14680064
    s_addc_u32 s21, s75, 0
    s_mov_b32 s22, 9437184
    s_mov_b32 s23, 0x20000
    s_add_u32 s28, s74, 34603008
    s_addc_u32 s29, s75, 0
    s_mov_b32 s30, 81920
    s_mov_b32 s31, 0x20000
    s_mov_b32 s32, s16
    s_mov_b32 s33, s17
    s_mov_b32 s35, 0x20000
    s_mov_b32 s36, s20
    s_mov_b32 s37, s21
    s_mov_b32 s39, 0x20000
    s_lshl_b32 s63, s42, 6
    s_add_u32 s63, s63, 16384
    s_mov_b32 s52, 0x409d30fc
    s_mov_b32 s62, 0xffff0000
    s_cmp_lt_u32 s41, 9
    s_cselect_b32 s60, 0x3f39be31, s60
    s_cselect_b32 s60, s60, 0x40088e99
    v_mov_b32 v216, 0
    v_mov_b32 v217, 0
    v_mov_b32 v218, 0
    v_mov_b32 v219, 0
    v_mov_b32 v220, 0
    v_mov_b32 v221, 0
    v_mov_b32 v18, 0x7ffffff0
    v_cmp_eq_u32 vcc, 0, v17
    s_nop 1
    v_cndmask_b32 v252, v18, v17, vcc
    s_mul_i32 s79, s41, 43
    s_lshr_b32 s79, s79, 7
    s_lshl_b32 s79, s79, 7
    s_add_u32 s79, s79, 49152
    s_cmp_lt_u32 s81, 66
    s_cselect_b32 s82, 10, 11
    s_cmp_eq_u32 s80, 0
    s_cselect_b32 s82, s82, 12
    s_lshl_b32 s82, s82, 7
    s_add_u32 s82, s82, 49152
    v_mov_b32 v19, s79
    v_cmp_eq_u32 vcc, 0, v0
    s_nop 1
    v_cndmask_b32 v6, v18, v19, vcc
    v_mov_b32 v19, s82
    v_cmp_eq_u32 vcc, 1, v0
    s_nop 1
    v_cndmask_b32 v6, v6, v19, vcc
    s_lshl_b32 s79, s78, 7
    s_add_u32 s79, s79, 65536
    v_mov_b32 v19, s79
    v_cmp_eq_u32 vcc, 0, v0
    s_nop 1
    v_cndmask_b32 v251, v18, v19, vcc
    s_lshl_b32 s79, s40, 6
    s_add_u32 s79, s79, 0
    v_lshlrev_b32 v111, 3, v80
    v_add_u32 v88, 0, v111
    v_add_u32 v111, s79, v111
    s_waitcnt vmcnt(9)
    v_lshlrev_b32 v112, 16, v96
    v_and_b32 v113, s62, v96
    v_lshlrev_b32 v114, 16, v97
    v_and_b32 v115, s62, v97
    v_lshlrev_b32 v116, 16, v98
    v_and_b32 v117, s62, v98
    v_lshlrev_b32 v118, 16, v99
    v_and_b32 v119, s62, v99
    v_lshlrev_b32 v120, 16, v100
    v_and_b32 v121, s62, v100
    v_lshlrev_b32 v122, 16, v101
    v_and_b32 v123, s62, v101
    v_lshlrev_b32 v124, 16, v102
    v_and_b32 v125, s62, v102
    v_lshlrev_b32 v126, 16, v103
    v_and_b32 v127, s62, v103
    v_lshlrev_b32 v128, 16, v104
    v_and_b32 v129, s62, v104
    v_lshlrev_b32 v130, 16, v105
    v_and_b32 v131, s62, v105
    v_lshlrev_b32 v132, 16, v106
    v_and_b32 v133, s62, v106
    v_lshlrev_b32 v134, 16, v107
    v_and_b32 v135, s62, v107
    v_pk_add_f32 v[136:137], v[112:113], v[114:115]
    v_pk_mul_f32 v[138:139], v[112:113], v[112:113]
    v_pk_fma_f32 v[138:139], v[114:115], v[114:115], v[138:139]
    v_pk_add_f32 v[136:137], v[136:137], v[116:117]
    v_pk_fma_f32 v[138:139], v[116:117], v[116:117], v[138:139]
    v_pk_add_f32 v[136:137], v[136:137], v[118:119]
    v_pk_fma_f32 v[138:139], v[118:119], v[118:119], v[138:139]
    v_pk_add_f32 v[136:137], v[136:137], v[120:121]
    v_pk_fma_f32 v[138:139], v[120:121], v[120:121], v[138:139]
    v_pk_add_f32 v[136:137], v[136:137], v[122:123]
    v_pk_fma_f32 v[138:139], v[122:123], v[122:123], v[138:139]
    v_pk_add_f32 v[136:137], v[136:137], v[124:125]
    v_pk_fma_f32 v[138:139], v[124:125], v[124:125], v[138:139]
    v_pk_add_f32 v[136:137], v[136:137], v[126:127]
    v_pk_fma_f32 v[138:139], v[126:127], v[126:127], v[138:139]
    v_pk_add_f32 v[136:137], v[136:137], v[128:129]
    v_pk_fma_f32 v[138:139], v[128:129], v[128:129], v[138:139]
    v_pk_add_f32 v[136:137], v[136:137], v[130:131]
    v_pk_fma_f32 v[138:139], v[130:131], v[130:131], v[138:139]
    v_pk_add_f32 v[136:137], v[136:137], v[132:133]
    v_pk_fma_f32 v[138:139], v[132:133], v[132:133], v[138:139]
    v_pk_add_f32 v[136:137], v[136:137], v[134:135]
    v_pk_fma_f32 v[138:139], v[134:135], v[134:135], v[138:139]
    v_add_f32 v136, v136, v137
    v_add_f32 v137, v138, v139
    s_nop 0
    v_add_f32_dpp v136, v136, v136 row_ror:8 row_mask:0xf bank_mask:0xf
    v_add_f32_dpp v137, v137, v137 row_ror:8 row_mask:0xf bank_mask:0xf
    v_mov_b32 v138, v136
    v_mov_b32 v139, v137
    s_nop 0
    v_permlane16_swap_b32 v136, v138
    v_permlane16_swap_b32 v137, v139
    v_add_f32 v136, v136, v138
    v_add_f32 v137, v137, v139
    v_mov_b32 v138, v136
    v_mov_b32 v139, v137
    s_nop 0
    v_permlane32_swap_b32 v136, v138
    v_permlane32_swap_b32 v137, v139
    v_add_f32 v136, v136, v138
    v_add_f32 v137, v137, v139
    ds_write_b64 v111, v[136:137]
    v_mov_b32 v89, 0
    s_waitcnt lgkmcnt(0)
    s_barrier
    ds_read_b64 v[136:137], v88 offset:0
    ds_read_b64 v[138:139], v88 offset:64
    ds_read_b64 v[140:141], v88 offset:128
    ds_read_b64 v[142:143], v88 offset:192
    s_waitcnt lgkmcnt(0)
    v_pk_add_f32 v[136:137], v[136:137], v[138:139]
    v_pk_add_f32 v[140:141], v[140:141], v[142:143]
    v_pk_add_f32 v[136:137], v[136:137], v[140:141]
    v_mul_f32 v136, 0x3ae38e39, v136
    v_mov_b32 v138, 0x3727c5ac
    v_fmac_f32 v138, 0x3ae38e39, v137
    v_fma_f32 v138, -v136, v136, v138
    v_max_f32 v138, 0x3727c5ac, v138
    v_rsq_f32 v138, v138
    s_nop 0
    v_mul_f32 v138, 0x3eeff558, v138
    v_mul_f32 v140, -v136, v138
    v_pk_fma_f32 v[112:113], v[112:113], v[138:139], v[140:141] op_sel_hi:[1,0,0]
    v_pk_fma_f32 v[114:115], v[114:115], v[138:139], v[140:141] op_sel_hi:[1,0,0]
    v_pk_fma_f32 v[116:117], v[116:117], v[138:139], v[140:141] op_sel_hi:[1,0,0]
    v_pk_fma_f32 v[118:119], v[118:119], v[138:139], v[140:141] op_sel_hi:[1,0,0]
    v_pk_fma_f32 v[120:121], v[120:121], v[138:139], v[140:141] op_sel_hi:[1,0,0]
    v_pk_fma_f32 v[122:123], v[122:123], v[138:139], v[140:141] op_sel_hi:[1,0,0]
    v_pk_fma_f32 v[124:125], v[124:125], v[138:139], v[140:141] op_sel_hi:[1,0,0]
    v_pk_fma_f32 v[126:127], v[126:127], v[138:139], v[140:141] op_sel_hi:[1,0,0]
    v_pk_fma_f32 v[128:129], v[128:129], v[138:139], v[140:141] op_sel_hi:[1,0,0]
    v_pk_fma_f32 v[130:131], v[130:131], v[138:139], v[140:141] op_sel_hi:[1,0,0]
    v_pk_fma_f32 v[132:133], v[132:133], v[138:139], v[140:141] op_sel_hi:[1,0,0]
    v_pk_fma_f32 v[134:135], v[134:135], v[138:139], v[140:141] op_sel_hi:[1,0,0]
    v_cvt_pk_bf16_f32 v96, v112, v113
    v_cvt_pk_bf16_f32 v97, v114, v115
    v_cvt_pk_bf16_f32 v98, v116, v117
    v_cvt_pk_bf16_f32 v99, v118, v119
    buffer_store_dwordx4 v[96:99], v108, s[4:7], 0 offen sc1
    v_cvt_pk_bf16_f32 v100, v120, v121
    v_cvt_pk_bf16_f32 v101, v122, v123
    v_cvt_pk_bf16_f32 v102, v124, v125
    v_cvt_pk_bf16_f32 v103, v126, v127
    buffer_store_dwordx4 v[100:103], v109, s[4:7], 0 offen sc1
    v_cvt_pk_bf16_f32 v104, v128, v129
    v_cvt_pk_bf16_f32 v105, v130, v131
    v_cvt_pk_bf16_f32 v106, v132, v133
    v_cvt_pk_bf16_f32 v107, v134, v135
    buffer_store_dwordx4 v[104:107], v110, s[4:7], 0 offen sc1
    global_load_dword v90, v89, s[72:73] sc1
    v_lshlrev_b32 v91, 7, v0
    v_cmp_gt_u32 vcc, 4, v0
    s_nop 1
    v_cndmask_b32 v91, v85, v91, vcc
    s_lshl_b32 s79, s78, 9
    s_add_u32 s79, s79, 73728
    s_and_b32 s82, s41, 3
    s_lshl_b32 s82, s82, 7
    s_add_u32 s82, s82, s79
    v_mov_b32 v92, 1
    s_mov_b32 s51, 0
    s_waitcnt vmcnt(0)
k1_i1:
    v_cmp_eq_u32 vcc, 0, v90
    s_add_u32 s51, s51, 1
    s_cmp_eq_u64 vcc, 0
    s_cbranch_scc1 k1_i2
    s_cmp_ge_u32 s51, 200000
    s_cbranch_scc1 k1_i2
    s_sleep 4
    global_load_dword v90, v89, s[72:73] sc1
    s_waitcnt vmcnt(0)
    s_branch k1_i1
k1_i2:
    s_barrier
    buffer_atomic_add v92, v91, s[28:31], s79 offen
    s_cmp_eq_u32 s40, 0
    s_cbranch_scc1 k1_x0
    s_add_u32 m0, s45, 102400
    s_add_u32 s50, s46, 884736
    buffer_load_dwordx4 v7, s[8:11], s50 offen offset:0 lds
    buffer_load_dwordx4 v8, s[8:11], s50 offen offset:1024 lds
    buffer_load_dwordx4 v9, s[8:11], s50 offen offset:2048 lds
    s_add_u32 m0, s45, 114688
    s_add_u32 s50, s46, 1769472
    buffer_load_dwordx4 v7, s[8:11], s50 offen offset:0 lds
    buffer_load_dwordx4 v8, s[8:11], s50 offen offset:1024 lds
    buffer_load_dwordx4 v9, s[8:11], s50 offen offset:2048 lds
    s_add_u32 m0, s45, 65536
    s_add_u32 s50, s47, 1769472
    buffer_load_dwordx4 v245, s[8:11], s50 offen offset:0 lds
    buffer_load_dwordx4 v247, s[8:11], s50 offen offset:1024 lds
    buffer_load_dwordx4 v249, s[8:11], s50 offen offset:2048 lds
    s_branch k1_x2
k1_x0:
    s_mov_b32 s51, 0
    v_min_u32 v89, 6, v17
    v_lshlrev_b32 v89, 2, v89
k1_x1:
    v_mov_b32 v93, 0
    buffer_atomic_add v93, v252, s[28:31], s82 offen sc0
    global_load_dword v90, v89, s[72:73] offset:132 sc1
    s_add_u32 s51, s51, 1
    s_waitcnt vmcnt(0)
    v_readfirstlane_b32 s64, v93
    v_cmp_eq_u32 vcc, 0, v90
    s_nop 0
    s_cmp_eq_u64 vcc, 0
    s_cselect_b32 s64, s64, 0
    s_cmp_ge_u32 s64, 32
    s_cbranch_scc1 k1_x3
    s_cmp_lt_u32 s51, 200000
    s_sleep 1
    s_cbranch_scc1 k1_x1
k1_x3:
    s_barrier
    s_add_u32 m0, s45, 102400
    s_add_u32 s50, s46, 884736
    buffer_load_dwordx4 v7, s[8:11], s50 offen offset:0 lds
    buffer_load_dwordx4 v8, s[8:11], s50 offen offset:1024 lds
    buffer_load_dwordx4 v9, s[8:11], s50 offen offset:2048 lds
    s_add_u32 m0, s45, 114688
    s_add_u32 s50, s46, 1769472
    buffer_load_dwordx4 v7, s[8:11], s50 offen offset:0 lds
    buffer_load_dwordx4 v8, s[8:11], s50 offen offset:1024 lds
    buffer_load_dwordx4 v9, s[8:11], s50 offen offset:2048 lds
    s_add_u32 m0, s45, 65536
    s_add_u32 s50, s47, 1769472
    buffer_load_dwordx4 v245, s[8:11], s50 offen offset:0 lds
    buffer_load_dwordx4 v247, s[8:11], s50 offen offset:1024 lds
    buffer_load_dwordx4 v249, s[8:11], s50 offen offset:2048 lds
    s_branch k1_x4
k1_x2:
    s_barrier
k1_x4:
    buffer_load_dwordx4 a[0:3], v10, s[4:7], s43 offen offset:0 sc1
    buffer_load_dwordx4 a[4:7], v10, s[4:7], s44 offen offset:0 sc1
    buffer_load_dwordx4 a[8:11], v10, s[4:7], s43 offen offset:1024 sc1
    buffer_load_dwordx4 a[12:15], v10, s[4:7], s44 offen offset:1024 sc1
    buffer_load_dwordx4 a[16:19], v10, s[4:7], s43 offen offset:2048 sc1
    buffer_load_dwordx4 a[20:23], v10, s[4:7], s44 offen offset:2048 sc1
    s_cmp_lt_u32 s41, 18
    s_cbranch_scc1 k1_qk
    s_cmp_ge_u32 s41, 27
    s_cbranch_scc1 k1_w
    s_add_u32 s24, s74, 31457280
    s_addc_u32 s25, s75, 0
    s_mov_b32 s26, 2392064
    s_mov_b32 s27, 0x20000
    v_and_b32 v18, 31, v17
    v_lshrrev_b32 v19, 2, v18
    v_and_b32 v20, 1, v19
    v_lshlrev_b32 v20, 2, v20
    v_lshrrev_b32 v19, 1, v19
    v_add_u32 v19, v19, v20
    v_and_b32 v18, 3, v18
    v_lshl_add_u32 v18, v19, 2, v18
    v_lshlrev_b32 v18, 4, v18
    v_lshrrev_b32 v19, 5, v17
    v_mul_u32_u24 v19, 9344, v19
    v_add_u32 v12, v18, v19
    s_mul_i32 s57, s42, 37376
    s_sub_u32 s79, s41, 18
    s_lshl_b32 s79, s79, 10
    s_add_u32 s57, s57, s79
    s_add_u32 s58, s57, 37376
    buffer_load_dwordx4 a[24:27], v10, s[4:7], s43 offen offset:3072 sc1
    buffer_load_dwordx4 a[28:31], v10, s[4:7], s44 offen offset:3072 sc1
    s_add_u32 s43, s43, 4096
    buffer_load_dwordx4 a[32:35], v10, s[4:7], s43 offen offset:0 sc1
    s_add_u32 s44, s44, 4096
    buffer_load_dwordx4 a[36:39], v10, s[4:7], s44 offen offset:0 sc1
    buffer_load_dwordx4 a[40:43], v10, s[4:7], s43 offen offset:1024 sc1
    buffer_load_dwordx4 a[44:47], v10, s[4:7], s44 offen offset:1024 sc1
    s_waitcnt vmcnt(21)
    s_barrier
    ds_read_b64_tr_b16 v[192:193], v1 offset:24576
    ds_read_b64_tr_b16 v[194:195], v1 offset:25088
    ds_read_b64_tr_b16 v[196:197], v2 offset:24576
    ds_read_b64_tr_b16 v[198:199], v2 offset:25088
    ds_read_b64_tr_b16 v[200:201], v3 offset:0
    ds_read_b64_tr_b16 v[202:203], v3 offset:256
    ds_read_b64_tr_b16 v[204:205], v1 offset:26624
    ds_read_b64_tr_b16 v[206:207], v1 offset:27136
    s_waitcnt vmcnt(10) lgkmcnt(4)
    v_mfma_f32_32x32x16_bf16 v[16:31], v[192:195], a[0:3], 0
    ds_read_b64_tr_b16 v[208:209], v2 offset:26624
    v_mfma_f32_32x32x16_bf16 v[32:47], v[192:195], a[4:7], 0
    ds_read_b64_tr_b16 v[210:211], v2 offset:27136
    v_mfma_f32_32x32x16_bf16 v[48:63], v[196:199], a[0:3], 0
    ds_read_b64_tr_b16 v[212:213], v3 offset:1024
    buffer_load_dwordx4 a[48:51], v10, s[4:7], s43 offen offset:2048 sc1
    v_mfma_f32_32x32x16_bf16 v[64:79], v[196:199], a[4:7], 0
    ds_read_b64_tr_b16 v[214:215], v3 offset:1280
    s_waitcnt lgkmcnt(6)
    v_mfma_f32_32x32x16_bf16 v[144:159], v[200:203], a[0:3], 0
    ds_read_b64_tr_b16 v[192:193], v1 offset:28672
    ds_read_b64_tr_b16 v[194:195], v1 offset:29184
    buffer_load_dwordx4 a[52:55], v10, s[4:7], s44 offen offset:2048 sc1
    s_waitcnt vmcnt(10) lgkmcnt(4)
    v_mfma_f32_32x32x16_bf16 v[16:31], v[204:207], a[8:11], v[16:31]
    ds_read_b64_tr_b16 v[196:197], v2 offset:28672
    v_mfma_f32_32x32x16_bf16 v[32:47], v[204:207], a[12:15], v[32:47]
    ds_read_b64_tr_b16 v[198:199], v2 offset:29184
    buffer_load_dwordx4 a[56:59], v10, s[4:7], s43 offen offset:3072 sc1
    v_mfma_f32_32x32x16_bf16 v[48:63], v[208:211], a[8:11], v[48:63]
    ds_read_b64_tr_b16 v[200:201], v3 offset:2048
    v_mfma_f32_32x32x16_bf16 v[64:79], v[208:211], a[12:15], v[64:79]
    ds_read_b64_tr_b16 v[202:203], v3 offset:2304
    buffer_load_dwordx4 a[60:63], v10, s[4:7], s44 offen offset:3072 sc1
    s_waitcnt lgkmcnt(6)
    v_mfma_f32_32x32x16_bf16 v[144:159], v[212:215], a[8:11], v[144:159]
    ds_read_b64_tr_b16 v[204:205], v1 offset:30720
    ds_read_b64_tr_b16 v[206:207], v1 offset:31232
    s_waitcnt vmcnt(10) lgkmcnt(4)
    v_mfma_f32_32x32x16_bf16 v[16:31], v[192:195], a[16:19], v[16:31]
    ds_read_b64_tr_b16 v[208:209], v2 offset:30720
    s_add_u32 s43, s43, 4096
    buffer_load_dwordx4 a[64:67], v10, s[4:7], s43 offen offset:0 sc1
    v_mfma_f32_32x32x16_bf16 v[32:47], v[192:195], a[20:23], v[32:47]
    ds_read_b64_tr_b16 v[210:211], v2 offset:31232
    v_mfma_f32_32x32x16_bf16 v[48:63], v[196:199], a[16:19], v[48:63]
    ds_read_b64_tr_b16 v[212:213], v3 offset:3072
    s_add_u32 s44, s44, 4096
    buffer_load_dwordx4 a[68:71], v10, s[4:7], s44 offen offset:0 sc1
    v_mfma_f32_32x32x16_bf16 v[64:79], v[196:199], a[20:23], v[64:79]
    ds_read_b64_tr_b16 v[214:215], v3 offset:3328
    s_waitcnt lgkmcnt(6)
    v_mfma_f32_32x32x16_bf16 v[144:159], v[200:203], a[16:19], v[144:159]
    ds_read_b64_tr_b16 v[192:193], v1 offset:32768
    ds_read_b64_tr_b16 v[194:195], v1 offset:33280
    buffer_load_dwordx4 a[72:75], v10, s[4:7], s43 offen offset:1024 sc1
    s_waitcnt vmcnt(11) lgkmcnt(4)
    v_mfma_f32_32x32x16_bf16 v[16:31], v[204:207], a[24:27], v[16:31]
    ds_read_b64_tr_b16 v[196:197], v2 offset:32768
    v_mfma_f32_32x32x16_bf16 v[32:47], v[204:207], a[28:31], v[32:47]
    ds_read_b64_tr_b16 v[198:199], v2 offset:33280
    buffer_load_dwordx4 a[76:79], v10, s[4:7], s44 offen offset:1024 sc1
    v_mfma_f32_32x32x16_bf16 v[48:63], v[208:211], a[24:27], v[48:63]
    ds_read_b64_tr_b16 v[200:201], v3 offset:4096
    v_mfma_f32_32x32x16_bf16 v[64:79], v[208:211], a[28:31], v[64:79]
    ds_read_b64_tr_b16 v[202:203], v3 offset:4352
    buffer_load_dwordx4 a[80:83], v10, s[4:7], s43 offen offset:2048 sc1
    s_waitcnt lgkmcnt(6)
    v_mfma_f32_32x32x16_bf16 v[144:159], v[212:215], a[24:27], v[144:159]
    ds_read_b64_tr_b16 v[204:205], v1 offset:34816
    ds_read_b64_tr_b16 v[206:207], v1 offset:35328
    s_waitcnt vmcnt(11) lgkmcnt(4)
    v_mfma_f32_32x32x16_bf16 v[16:31], v[192:195], a[32:35], v[16:31]
    ds_read_b64_tr_b16 v[208:209], v2 offset:34816
    buffer_load_dwordx4 a[84:87], v10, s[4:7], s44 offen offset:2048 sc1
    v_mfma_f32_32x32x16_bf16 v[32:47], v[192:195], a[36:39], v[32:47]
    ds_read_b64_tr_b16 v[210:211], v2 offset:35328
    v_mfma_f32_32x32x16_bf16 v[48:63], v[196:199], a[32:35], v[48:63]
    ds_read_b64_tr_b16 v[212:213], v3 offset:5120
    buffer_load_dwordx4 a[88:91], v10, s[4:7], s43 offen offset:3072 sc1
    v_mfma_f32_32x32x16_bf16 v[64:79], v[196:199], a[36:39], v[64:79]
    ds_read_b64_tr_b16 v[214:215], v3 offset:5376
    s_waitcnt lgkmcnt(6)
    v_mfma_f32_32x32x16_bf16 v[144:159], v[200:203], a[32:35], v[144:159]
    s_barrier
    ds_read_b64_tr_b16 v[192:193], v1 offset:36864
    ds_read_b64_tr_b16 v[194:195], v1 offset:37376
    s_waitcnt vmcnt(11) lgkmcnt(4)
    v_mfma_f32_32x32x16_bf16 v[16:31], v[204:207], a[40:43], v[16:31]
    ds_read_b64_tr_b16 v[196:197], v2 offset:36864
    buffer_load_dwordx4 a[92:95], v10, s[4:7], s44 offen offset:3072 sc1
    v_mfma_f32_32x32x16_bf16 v[32:47], v[204:207], a[44:47], v[32:47]
    ds_read_b64_tr_b16 v[198:199], v2 offset:37376
    v_mfma_f32_32x32x16_bf16 v[48:63], v[208:211], a[40:43], v[48:63]
    ds_read_b64_tr_b16 v[200:201], v3 offset:6144
    s_add_u32 s43, s43, 4096
    buffer_load_dwordx4 a[96:99], v10, s[4:7], s43 offen offset:0 sc1
    v_mfma_f32_32x32x16_bf16 v[64:79], v[208:211], a[44:47], v[64:79]
    ds_read_b64_tr_b16 v[202:203], v3 offset:6400
    s_waitcnt lgkmcnt(6)
    v_mfma_f32_32x32x16_bf16 v[144:159], v[212:215], a[40:43], v[144:159]
    ds_read_b64_tr_b16 v[204:205], v1 offset:38912
    ds_read_b64_tr_b16 v[206:207], v1 offset:39424
    s_add_u32 s44, s44, 4096
    buffer_load_dwordx4 a[100:103], v10, s[4:7], s44 offen offset:0 sc1
    s_waitcnt vmcnt(12) lgkmcnt(4)
    v_mfma_f32_32x32x16_bf16 v[16:31], v[192:195], a[48:51], v[16:31]
    ds_read_b64_tr_b16 v[208:209], v2 offset:38912
    v_mfma_f32_32x32x16_bf16 v[32:47], v[192:195], a[52:55], v[32:47]
    ds_read_b64_tr_b16 v[210:211], v2 offset:39424
    buffer_load_dwordx4 a[104:107], v10, s[4:7], s43 offen offset:1024 sc1
    v_mfma_f32_32x32x16_bf16 v[48:63], v[196:199], a[48:51], v[48:63]
    ds_read_b64_tr_b16 v[212:213], v3 offset:7168
    v_mfma_f32_32x32x16_bf16 v[64:79], v[196:199], a[52:55], v[64:79]
    ds_read_b64_tr_b16 v[214:215], v3 offset:7424
    buffer_load_dwordx4 a[108:111], v10, s[4:7], s44 offen offset:1024 sc1
    s_waitcnt lgkmcnt(6)
    v_mfma_f32_32x32x16_bf16 v[144:159], v[200:203], a[48:51], v[144:159]
    ds_read_b64_tr_b16 v[192:193], v1 offset:40960
    ds_read_b64_tr_b16 v[194:195], v1 offset:41472
    s_waitcnt vmcnt(12) lgkmcnt(4)
    v_mfma_f32_32x32x16_bf16 v[16:31], v[204:207], a[56:59], v[16:31]
    ds_read_b64_tr_b16 v[196:197], v2 offset:40960
    s_add_u32 m0, s45, 126976
    s_add_u32 s50, s46, 2654208
    buffer_load_dwordx4 v7, s[8:11], s50 offen offset:0 lds
    v_mfma_f32_32x32x16_bf16 v[32:47], v[204:207], a[60:63], v[32:47]
    ds_read_b64_tr_b16 v[198:199], v2 offset:41472
    v_mfma_f32_32x32x16_bf16 v[48:63], v[208:211], a[56:59], v[48:63]
    ds_read_b64_tr_b16 v[200:201], v3 offset:8192
    buffer_load_dwordx4 v8, s[8:11], s50 offen offset:1024 lds
    v_mfma_f32_32x32x16_bf16 v[64:79], v[208:211], a[60:63], v[64:79]
    ds_read_b64_tr_b16 v[202:203], v3 offset:8448
    s_waitcnt lgkmcnt(6)
    v_mfma_f32_32x32x16_bf16 v[144:159], v[212:215], a[56:59], v[144:159]
    ds_read_b64_tr_b16 v[204:205], v1 offset:43008
    ds_read_b64_tr_b16 v[206:207], v1 offset:43520
    buffer_load_dwordx4 v9, s[8:11], s50 offen offset:2048 lds
    s_waitcnt vmcnt(13) lgkmcnt(4)
    v_mfma_f32_32x32x16_bf16 v[16:31], v[192:195], a[64:67], v[16:31]
    ds_read_b64_tr_b16 v[208:209], v2 offset:43008
    v_mfma_f32_32x32x16_bf16 v[32:47], v[192:195], a[68:71], v[32:47]
    ds_read_b64_tr_b16 v[210:211], v2 offset:43520
    buffer_load_dwordx4 a[112:115], v10, s[4:7], s43 offen offset:2048 sc1
    v_mfma_f32_32x32x16_bf16 v[48:63], v[196:199], a[64:67], v[48:63]
    ds_read_b64_tr_b16 v[212:213], v3 offset:9216
    v_mfma_f32_32x32x16_bf16 v[64:79], v[196:199], a[68:71], v[64:79]
    ds_read_b64_tr_b16 v[214:215], v3 offset:9472
    buffer_load_dwordx4 a[116:119], v10, s[4:7], s44 offen offset:2048 sc1
    s_waitcnt lgkmcnt(6)
    v_mfma_f32_32x32x16_bf16 v[144:159], v[200:203], a[64:67], v[144:159]
    ds_read_b64_tr_b16 v[192:193], v1 offset:45056
    ds_read_b64_tr_b16 v[194:195], v1 offset:45568
    s_waitcnt vmcnt(13) lgkmcnt(4)
    v_mfma_f32_32x32x16_bf16 v[16:31], v[204:207], a[72:75], v[16:31]
    ds_read_b64_tr_b16 v[196:197], v2 offset:45056
    buffer_load_dwordx4 a[120:123], v10, s[4:7], s43 offen offset:3072 sc1
    v_mfma_f32_32x32x16_bf16 v[32:47], v[204:207], a[76:79], v[32:47]
    ds_read_b64_tr_b16 v[198:199], v2 offset:45568
    v_mfma_f32_32x32x16_bf16 v[48:63], v[208:211], a[72:75], v[48:63]
    ds_read_b64_tr_b16 v[200:201], v3 offset:10240
    buffer_load_dwordx4 a[124:127], v10, s[4:7], s44 offen offset:3072 sc1
    v_mfma_f32_32x32x16_bf16 v[64:79], v[208:211], a[76:79], v[64:79]
    ds_read_b64_tr_b16 v[202:203], v3 offset:10496
    s_waitcnt lgkmcnt(6)
    v_mfma_f32_32x32x16_bf16 v[144:159], v[212:215], a[72:75], v[144:159]
    ds_read_b64_tr_b16 v[204:205], v1 offset:47104
    ds_read_b64_tr_b16 v[206:207], v1 offset:47616
    s_waitcnt vmcnt(13) lgkmcnt(4)
    v_mfma_f32_32x32x16_bf16 v[16:31], v[192:195], a[80:83], v[16:31]
    ds_read_b64_tr_b16 v[208:209], v2 offset:47104
    s_add_u32 s43, s43, 4096
    buffer_load_dwordx4 a[128:131], v10, s[4:7], s43 offen offset:0 sc1
    v_mfma_f32_32x32x16_bf16 v[32:47], v[192:195], a[84:87], v[32:47]
    ds_read_b64_tr_b16 v[210:211], v2 offset:47616
    v_mfma_f32_32x32x16_bf16 v[48:63], v[196:199], a[80:83], v[48:63]
    ds_read_b64_tr_b16 v[212:213], v3 offset:11264
    s_add_u32 s44, s44, 4096
    buffer_load_dwordx4 a[132:135], v10, s[4:7], s44 offen offset:0 sc1
    v_mfma_f32_32x32x16_bf16 v[64:79], v[196:199], a[84:87], v[64:79]
    ds_read_b64_tr_b16 v[214:215], v3 offset:11520
    s_waitcnt lgkmcnt(6)
    v_mfma_f32_32x32x16_bf16 v[144:159], v[200:203], a[80:83], v[144:159]
    s_barrier
    ds_read_b64_tr_b16 v[192:193], v1 offset:49152
    ds_read_b64_tr_b16 v[194:195], v1 offset:49664
    buffer_load_dwordx4 a[136:139], v10, s[4:7], s43 offen offset:1024 sc1
    s_waitcnt vmcnt(14) lgkmcnt(4)
    v_mfma_f32_32x32x16_bf16 v[16:31], v[204:207], a[88:91], v[16:31]
    ds_read_b64_tr_b16 v[196:197], v2 offset:49152
    v_mfma_f32_32x32x16_bf16 v[32:47], v[204:207], a[92:95], v[32:47]
    ds_read_b64_tr_b16 v[198:199], v2 offset:49664
    buffer_load_dwordx4 a[140:143], v10, s[4:7], s44 offen offset:1024 sc1
    v_mfma_f32_32x32x16_bf16 v[48:63], v[208:211], a[88:91], v[48:63]
    ds_read_b64_tr_b16 v[200:201], v3 offset:12288
    v_mfma_f32_32x32x16_bf16 v[64:79], v[208:211], a[92:95], v[64:79]
    ds_read_b64_tr_b16 v[202:203], v3 offset:12544
    buffer_load_dwordx4 a[144:147], v10, s[4:7], s43 offen offset:2048 sc1
    s_waitcnt lgkmcnt(6)
    v_mfma_f32_32x32x16_bf16 v[144:159], v[212:215], a[88:91], v[144:159]
    ds_read_b64_tr_b16 v[204:205], v1 offset:51200
    ds_read_b64_tr_b16 v[206:207], v1 offset:51712
    s_waitcnt vmcnt(14) lgkmcnt(4)
    v_mfma_f32_32x32x16_bf16 v[16:31], v[192:195], a[96:99], v[16:31]
    ds_read_b64_tr_b16 v[208:209], v2 offset:51200
    buffer_load_dwordx4 a[148:151], v10, s[4:7], s44 offen offset:2048 sc1
    v_mfma_f32_32x32x16_bf16 v[32:47], v[192:195], a[100:103], v[32:47]
    ds_read_b64_tr_b16 v[210:211], v2 offset:51712
    v_mfma_f32_32x32x16_bf16 v[48:63], v[196:199], a[96:99], v[48:63]
    ds_read_b64_tr_b16 v[212:213], v3 offset:13312
    buffer_load_dwordx4 a[152:155], v10, s[4:7], s43 offen offset:3072 sc1
    v_mfma_f32_32x32x16_bf16 v[64:79], v[196:199], a[100:103], v[64:79]
    ds_read_b64_tr_b16 v[214:215], v3 offset:13568
    s_waitcnt lgkmcnt(6)
    v_mfma_f32_32x32x16_bf16 v[144:159], v[200:203], a[96:99], v[144:159]
    ds_read_b64_tr_b16 v[192:193], v1 offset:53248
    ds_read_b64_tr_b16 v[194:195], v1 offset:53760
    buffer_load_dwordx4 a[156:159], v10, s[4:7], s44 offen offset:3072 sc1
    s_waitcnt vmcnt(15) lgkmcnt(4)
    v_mfma_f32_32x32x16_bf16 v[16:31], v[204:207], a[104:107], v[16:31]
    ds_read_b64_tr_b16 v[196:197], v2 offset:53248
    v_mfma_f32_32x32x16_bf16 v[32:47], v[204:207], a[108:111], v[32:47]
    ds_read_b64_tr_b16 v[198:199], v2 offset:53760
    s_add_u32 m0, s45, 139264
    s_add_u32 s50, s46, 3538944
    buffer_load_dwordx4 v7, s[8:11], s50 offen offset:0 lds
    v_mfma_f32_32x32x16_bf16 v[48:63], v[208:211], a[104:107], v[48:63]
    ds_read_b64_tr_b16 v[200:201], v3 offset:14336
    v_mfma_f32_32x32x16_bf16 v[64:79], v[208:211], a[108:111], v[64:79]
    ds_read_b64_tr_b16 v[202:203], v3 offset:14592
    buffer_load_dwordx4 v8, s[8:11], s50 offen offset:1024 lds
    s_waitcnt lgkmcnt(6)
    v_mfma_f32_32x32x16_bf16 v[144:159], v[212:215], a[104:107], v[144:159]
    ds_read_b64_tr_b16 v[204:205], v1 offset:55296
    ds_read_b64_tr_b16 v[206:207], v1 offset:55808
    s_waitcnt vmcnt(12) lgkmcnt(4)
    v_mfma_f32_32x32x16_bf16 v[16:31], v[192:195], a[112:115], v[16:31]
    ds_read_b64_tr_b16 v[208:209], v2 offset:55296
    buffer_load_dwordx4 v9, s[8:11], s50 offen offset:2048 lds
    v_mfma_f32_32x32x16_bf16 v[32:47], v[192:195], a[116:119], v[32:47]
    ds_read_b64_tr_b16 v[210:211], v2 offset:55808
    v_mfma_f32_32x32x16_bf16 v[48:63], v[196:199], a[112:115], v[48:63]
    ds_read_b64_tr_b16 v[212:213], v3 offset:15360
    s_add_u32 m0, s45, 77824
    s_add_u32 s50, s47, 3538944
    buffer_load_dwordx4 v245, s[8:11], s50 offen offset:0 lds
    v_mfma_f32_32x32x16_bf16 v[64:79], v[196:199], a[116:119], v[64:79]
    ds_read_b64_tr_b16 v[214:215], v3 offset:15616
    s_waitcnt lgkmcnt(6)
    v_mfma_f32_32x32x16_bf16 v[144:159], v[200:203], a[112:115], v[144:159]
    ds_read_b64_tr_b16 v[192:193], v1 offset:57344
    ds_read_b64_tr_b16 v[194:195], v1 offset:57856
    s_waitcnt vmcnt(12) lgkmcnt(4)
    v_mfma_f32_32x32x16_bf16 v[16:31], v[204:207], a[120:123], v[16:31]
    ds_read_b64_tr_b16 v[196:197], v2 offset:57344
    buffer_load_dwordx4 v247, s[8:11], s50 offen offset:1024 lds
    v_mfma_f32_32x32x16_bf16 v[32:47], v[204:207], a[124:127], v[32:47]
    ds_read_b64_tr_b16 v[198:199], v2 offset:57856
    v_mfma_f32_32x32x16_bf16 v[48:63], v[208:211], a[120:123], v[48:63]
    ds_read_b64_tr_b16 v[200:201], v3 offset:16384
    buffer_load_dwordx4 v249, s[8:11], s50 offen offset:2048 lds
    v_mfma_f32_32x32x16_bf16 v[64:79], v[208:211], a[124:127], v[64:79]
    ds_read_b64_tr_b16 v[202:203], v3 offset:16640
    s_waitcnt lgkmcnt(6)
    v_mfma_f32_32x32x16_bf16 v[144:159], v[212:215], a[120:123], v[144:159]
    ds_read_b64_tr_b16 v[204:205], v1 offset:59392
    ds_read_b64_tr_b16 v[206:207], v1 offset:59904
    s_add_u32 s43, s43, 4096
    buffer_load_dwordx4 a[160:163], v10, s[4:7], s43 offen offset:0 sc1
    s_waitcnt vmcnt(13) lgkmcnt(4)
    v_mfma_f32_32x32x16_bf16 v[16:31], v[192:195], a[128:131], v[16:31]
    ds_read_b64_tr_b16 v[208:209], v2 offset:59392
    v_mfma_f32_32x32x16_bf16 v[32:47], v[192:195], a[132:135], v[32:47]
    ds_read_b64_tr_b16 v[210:211], v2 offset:59904
    s_add_u32 s44, s44, 4096
    buffer_load_dwordx4 a[164:167], v10, s[4:7], s44 offen offset:0 sc1
    v_mfma_f32_32x32x16_bf16 v[48:63], v[196:199], a[128:131], v[48:63]
    ds_read_b64_tr_b16 v[212:213], v3 offset:17408
    v_mfma_f32_32x32x16_bf16 v[64:79], v[196:199], a[132:135], v[64:79]
    ds_read_b64_tr_b16 v[214:215], v3 offset:17664
    buffer_load_dwordx4 a[168:171], v10, s[4:7], s43 offen offset:1024 sc1
    s_waitcnt lgkmcnt(6)
    v_mfma_f32_32x32x16_bf16 v[144:159], v[200:203], a[128:131], v[144:159]
    s_barrier
    ds_read_b64_tr_b16 v[192:193], v4 offset:0
    ds_read_b64_tr_b16 v[194:195], v4 offset:512
    s_waitcnt vmcnt(13) lgkmcnt(4)
    v_mfma_f32_32x32x16_bf16 v[16:31], v[204:207], a[136:139], v[16:31]
    ds_read_b64_tr_b16 v[196:197], v5 offset:0
    buffer_load_dwordx4 a[172:175], v10, s[4:7], s44 offen offset:1024 sc1
    v_mfma_f32_32x32x16_bf16 v[32:47], v[204:207], a[140:143], v[32:47]
    ds_read_b64_tr_b16 v[198:199], v5 offset:512
    v_mfma_f32_32x32x16_bf16 v[48:63], v[208:211], a[136:139], v[48:63]
    ds_read_b64_tr_b16 v[200:201], v3 offset:18432
    buffer_load_dwordx4 a[176:179], v10, s[4:7], s43 offen offset:2048 sc1
    v_mfma_f32_32x32x16_bf16 v[64:79], v[208:211], a[140:143], v[64:79]
    ds_read_b64_tr_b16 v[202:203], v3 offset:18688
    s_waitcnt lgkmcnt(6)
    v_mfma_f32_32x32x16_bf16 v[144:159], v[212:215], a[136:139], v[144:159]
    ds_read_b64_tr_b16 v[204:205], v4 offset:2048
    ds_read_b64_tr_b16 v[206:207], v4 offset:2560
    buffer_load_dwordx4 a[180:183], v10, s[4:7], s44 offen offset:2048 sc1
    s_waitcnt vmcnt(14) lgkmcnt(4)
    v_mfma_f32_32x32x16_bf16 v[16:31], v[192:195], a[144:147], v[16:31]
    ds_read_b64_tr_b16 v[208:209], v5 offset:2048
    v_mfma_f32_32x32x16_bf16 v[32:47], v[192:195], a[148:151], v[32:47]
    ds_read_b64_tr_b16 v[210:211], v5 offset:2560
    buffer_load_dwordx4 a[184:187], v10, s[4:7], s43 offen offset:3072 sc1
    v_mfma_f32_32x32x16_bf16 v[48:63], v[196:199], a[144:147], v[48:63]
    ds_read_b64_tr_b16 v[212:213], v3 offset:19456
    v_mfma_f32_32x32x16_bf16 v[64:79], v[196:199], a[148:151], v[64:79]
    ds_read_b64_tr_b16 v[214:215], v3 offset:19712
    buffer_load_dwordx4 a[188:191], v10, s[4:7], s44 offen offset:3072 sc1
    s_waitcnt lgkmcnt(6)
    v_mfma_f32_32x32x16_bf16 v[144:159], v[200:203], a[144:147], v[144:159]
    ds_read_b64_tr_b16 v[192:193], v4 offset:4096
    ds_read_b64_tr_b16 v[194:195], v4 offset:4608
    s_waitcnt vmcnt(14) lgkmcnt(4)
    v_mfma_f32_32x32x16_bf16 v[16:31], v[204:207], a[152:155], v[16:31]
    ds_read_b64_tr_b16 v[196:197], v5 offset:4096
    s_add_u32 s43, s43, 4096
    buffer_load_dwordx4 a[192:195], v10, s[4:7], s43 offen offset:0 sc1
    v_mfma_f32_32x32x16_bf16 v[32:47], v[204:207], a[156:159], v[32:47]
    ds_read_b64_tr_b16 v[198:199], v5 offset:4608
    v_mfma_f32_32x32x16_bf16 v[48:63], v[208:211], a[152:155], v[48:63]
    ds_read_b64_tr_b16 v[200:201], v3 offset:20480
    s_add_u32 s44, s44, 4096
    buffer_load_dwordx4 a[196:199], v10, s[4:7], s44 offen offset:0 sc1
    v_mfma_f32_32x32x16_bf16 v[64:79], v[208:211], a[156:159], v[64:79]
    ds_read_b64_tr_b16 v[202:203], v3 offset:20736
    s_waitcnt lgkmcnt(6)
    v_mfma_f32_32x32x16_bf16 v[144:159], v[212:215], a[152:155], v[144:159]
    ds_read_b64_tr_b16 v[204:205], v4 offset:6144
    ds_read_b64_tr_b16 v[206:207], v4 offset:6656
    s_waitcnt vmcnt(8) lgkmcnt(4)
    v_mfma_f32_32x32x16_bf16 v[16:31], v[192:195], a[160:163], v[16:31]
    ds_read_b64_tr_b16 v[208:209], v5 offset:6144
    buffer_load_dwordx4 a[200:203], v10, s[4:7], s43 offen offset:1024 sc1
    v_mfma_f32_32x32x16_bf16 v[32:47], v[192:195], a[164:167], v[32:47]
    ds_read_b64_tr_b16 v[210:211], v5 offset:6656
    v_mfma_f32_32x32x16_bf16 v[48:63], v[196:199], a[160:163], v[48:63]
    ds_read_b64_tr_b16 v[212:213], v3 offset:21504
    buffer_load_dwordx4 a[204:207], v10, s[4:7], s44 offen offset:1024 sc1
    v_mfma_f32_32x32x16_bf16 v[64:79], v[196:199], a[164:167], v[64:79]
    ds_read_b64_tr_b16 v[214:215], v3 offset:21760
    s_waitcnt lgkmcnt(6)
    v_mfma_f32_32x32x16_bf16 v[144:159], v[200:203], a[160:163], v[144:159]
    ds_read_b64_tr_b16 v[192:193], v4 offset:8192
    ds_read_b64_tr_b16 v[194:195], v4 offset:8704
    s_add_u32 m0, s45, 151552
    s_add_u32 s50, s46, 4423680
    buffer_load_dwordx4 v7, s[8:11], s50 offen offset:0 lds
    s_waitcnt vmcnt(9) lgkmcnt(4)
    v_mfma_f32_32x32x16_bf16 v[16:31], v[204:207], a[168:171], v[16:31]
    ds_read_b64_tr_b16 v[196:197], v5 offset:8192
    v_mfma_f32_32x32x16_bf16 v[32:47], v[204:207], a[172:175], v[32:47]
    ds_read_b64_tr_b16 v[198:199], v5 offset:8704
    buffer_load_dwordx4 v8, s[8:11], s50 offen offset:1024 lds
    v_mfma_f32_32x32x16_bf16 v[48:63], v[208:211], a[168:171], v[48:63]
    ds_read_b64_tr_b16 v[200:201], v3 offset:22528
    v_mfma_f32_32x32x16_bf16 v[64:79], v[208:211], a[172:175], v[64:79]
    ds_read_b64_tr_b16 v[202:203], v3 offset:22784
    buffer_load_dwordx4 v9, s[8:11], s50 offen offset:2048 lds
    s_waitcnt lgkmcnt(6)
    v_mfma_f32_32x32x16_bf16 v[144:159], v[212:215], a[168:171], v[144:159]
    ds_read_b64_tr_b16 v[204:205], v4 offset:10240
    ds_read_b64_tr_b16 v[206:207], v4 offset:10752
    s_waitcnt vmcnt(9) lgkmcnt(4)
    v_mfma_f32_32x32x16_bf16 v[16:31], v[192:195], a[176:179], v[16:31]
    ds_read_b64_tr_b16 v[208:209], v5 offset:10240
    buffer_load_dwordx4 a[208:211], v10, s[4:7], s43 offen offset:2048 sc1
    v_mfma_f32_32x32x16_bf16 v[32:47], v[192:195], a[180:183], v[32:47]
    ds_read_b64_tr_b16 v[210:211], v5 offset:10752
    v_mfma_f32_32x32x16_bf16 v[48:63], v[196:199], a[176:179], v[48:63]
    ds_read_b64_tr_b16 v[212:213], v3 offset:23552
    buffer_load_dwordx4 a[212:215], v10, s[4:7], s44 offen offset:2048 sc1
    v_mfma_f32_32x32x16_bf16 v[64:79], v[196:199], a[180:183], v[64:79]
    ds_read_b64_tr_b16 v[214:215], v3 offset:23808
    s_waitcnt lgkmcnt(6)
    v_mfma_f32_32x32x16_bf16 v[144:159], v[200:203], a[176:179], v[144:159]
    s_barrier
    ds_read_b64_tr_b16 v[192:193], v4 offset:12288
    ds_read_b64_tr_b16 v[194:195], v4 offset:12800
    buffer_load_dwordx4 a[216:219], v10, s[4:7], s43 offen offset:3072 sc1
    s_waitcnt vmcnt(10) lgkmcnt(4)
    v_mfma_f32_32x32x16_bf16 v[16:31], v[204:207], a[184:187], v[16:31]
    ds_read_b64_tr_b16 v[196:197], v5 offset:12288
    v_mfma_f32_32x32x16_bf16 v[32:47], v[204:207], a[188:191], v[32:47]
    ds_read_b64_tr_b16 v[198:199], v5 offset:12800
    buffer_load_dwordx4 a[220:223], v10, s[4:7], s44 offen offset:3072 sc1
    v_mfma_f32_32x32x16_bf16 v[48:63], v[208:211], a[184:187], v[48:63]
    ds_read_b64_tr_b16 v[200:201], v3 offset:24576
    v_mfma_f32_32x32x16_bf16 v[64:79], v[208:211], a[188:191], v[64:79]
    ds_read_b64_tr_b16 v[202:203], v3 offset:24832
    s_add_u32 s43, s43, 4096
    buffer_load_dwordx4 a[224:227], v10, s[4:7], s43 offen offset:0 sc1
    s_waitcnt lgkmcnt(6)
    v_mfma_f32_32x32x16_bf16 v[144:159], v[212:215], a[184:187], v[144:159]
    ds_read_b64_tr_b16 v[204:205], v4 offset:14336
    ds_read_b64_tr_b16 v[206:207], v4 offset:14848
    s_waitcnt vmcnt(10) lgkmcnt(4)
    v_mfma_f32_32x32x16_bf16 v[16:31], v[192:195], a[192:195], v[16:31]
    ds_read_b64_tr_b16 v[208:209], v5 offset:14336
    s_add_u32 s44, s44, 4096
    buffer_load_dwordx4 a[228:231], v10, s[4:7], s44 offen offset:0 sc1
    v_mfma_f32_32x32x16_bf16 v[32:47], v[192:195], a[196:199], v[32:47]
    ds_read_b64_tr_b16 v[210:211], v5 offset:14848
    v_mfma_f32_32x32x16_bf16 v[48:63], v[196:199], a[192:195], v[48:63]
    ds_read_b64_tr_b16 v[212:213], v3 offset:25600
    buffer_load_dwordx4 a[232:235], v10, s[4:7], s43 offen offset:1024 sc1
    v_mfma_f32_32x32x16_bf16 v[64:79], v[196:199], a[196:199], v[64:79]
    ds_read_b64_tr_b16 v[214:215], v3 offset:25856
    s_waitcnt lgkmcnt(6)
    v_mfma_f32_32x32x16_bf16 v[144:159], v[200:203], a[192:195], v[144:159]
    ds_read_b64_tr_b16 v[192:193], v4 offset:16384
    ds_read_b64_tr_b16 v[194:195], v4 offset:16896
    s_waitcnt vmcnt(10) lgkmcnt(4)
    v_mfma_f32_32x32x16_bf16 v[16:31], v[204:207], a[200:203], v[16:31]
    ds_read_b64_tr_b16 v[196:197], v5 offset:16384
    buffer_load_dwordx4 a[236:239], v10, s[4:7], s44 offen offset:1024 sc1
    v_mfma_f32_32x32x16_bf16 v[32:47], v[204:207], a[204:207], v[32:47]
    ds_read_b64_tr_b16 v[198:199], v5 offset:16896
    v_mfma_f32_32x32x16_bf16 v[48:63], v[208:211], a[200:203], v[48:63]
    ds_read_b64_tr_b16 v[200:201], v3 offset:26624
    buffer_load_dwordx4 a[240:243], v10, s[4:7], s43 offen offset:2048 sc1
    v_mfma_f32_32x32x16_bf16 v[64:79], v[208:211], a[204:207], v[64:79]
    ds_read_b64_tr_b16 v[202:203], v3 offset:26880
    s_waitcnt lgkmcnt(6)
    v_mfma_f32_32x32x16_bf16 v[144:159], v[212:215], a[200:203], v[144:159]
    ds_read_b64_tr_b16 v[204:205], v4 offset:18432
    ds_read_b64_tr_b16 v[206:207], v4 offset:18944
    buffer_load_dwordx4 a[244:247], v10, s[4:7], s44 offen offset:2048 sc1
    s_waitcnt vmcnt(8) lgkmcnt(4)
    v_mfma_f32_32x32x16_bf16 v[16:31], v[192:195], a[208:211], v[16:31]
    ds_read_b64_tr_b16 v[208:209], v5 offset:18432
    v_mfma_f32_32x32x16_bf16 v[32:47], v[192:195], a[212:215], v[32:47]
    ds_read_b64_tr_b16 v[210:211], v5 offset:18944
    buffer_load_dwordx4 a[248:251], v10, s[4:7], s43 offen offset:3072 sc1
    v_mfma_f32_32x32x16_bf16 v[48:63], v[196:199], a[208:211], v[48:63]
    ds_read_b64_tr_b16 v[212:213], v3 offset:27648
    v_mfma_f32_32x32x16_bf16 v[64:79], v[196:199], a[212:215], v[64:79]
    ds_read_b64_tr_b16 v[214:215], v3 offset:27904
    buffer_load_dwordx4 a[252:255], v10, s[4:7], s44 offen offset:3072 sc1
    s_waitcnt lgkmcnt(6)
    v_mfma_f32_32x32x16_bf16 v[144:159], v[200:203], a[208:211], v[144:159]
    ds_read_b64_tr_b16 v[192:193], v4 offset:20480
    ds_read_b64_tr_b16 v[194:195], v4 offset:20992
    s_waitcnt vmcnt(8) lgkmcnt(4)
    v_mfma_f32_32x32x16_bf16 v[16:31], v[204:207], a[216:219], v[16:31]
    ds_read_b64_tr_b16 v[196:197], v5 offset:20480
    s_add_u32 s43, s43, 4096
    buffer_load_dwordx4 v[160:163], v10, s[4:7], s43 offen offset:0 sc1
    v_mfma_f32_32x32x16_bf16 v[32:47], v[204:207], a[220:223], v[32:47]
    ds_read_b64_tr_b16 v[198:199], v5 offset:20992
    v_mfma_f32_32x32x16_bf16 v[48:63], v[208:211], a[216:219], v[48:63]
    ds_read_b64_tr_b16 v[200:201], v3 offset:28672
    s_add_u32 s44, s44, 4096
    buffer_load_dwordx4 v[164:167], v10, s[4:7], s44 offen offset:0 sc1
    v_mfma_f32_32x32x16_bf16 v[64:79], v[208:211], a[220:223], v[64:79]
    ds_read_b64_tr_b16 v[202:203], v3 offset:28928
    s_waitcnt lgkmcnt(6)
    v_mfma_f32_32x32x16_bf16 v[144:159], v[212:215], a[216:219], v[144:159]
    ds_read_b64_tr_b16 v[204:205], v4 offset:22528
    ds_read_b64_tr_b16 v[206:207], v4 offset:23040
    buffer_load_dwordx4 v[168:171], v10, s[4:7], s43 offen offset:1024 sc1
    s_waitcnt vmcnt(9) lgkmcnt(4)
    v_mfma_f32_32x32x16_bf16 v[16:31], v[192:195], a[224:227], v[16:31]
    ds_read_b64_tr_b16 v[208:209], v5 offset:22528
    v_mfma_f32_32x32x16_bf16 v[32:47], v[192:195], a[228:231], v[32:47]
    ds_read_b64_tr_b16 v[210:211], v5 offset:23040
    buffer_load_dwordx4 v[172:175], v10, s[4:7], s44 offen offset:1024 sc1
    v_mfma_f32_32x32x16_bf16 v[48:63], v[196:199], a[224:227], v[48:63]
    ds_read_b64_tr_b16 v[212:213], v3 offset:29696
    v_mfma_f32_32x32x16_bf16 v[64:79], v[196:199], a[228:231], v[64:79]
    ds_read_b64_tr_b16 v[214:215], v3 offset:29952
    buffer_load_dwordx4 v[176:179], v10, s[4:7], s43 offen offset:2048 sc1
    s_waitcnt lgkmcnt(6)
    v_mfma_f32_32x32x16_bf16 v[144:159], v[200:203], a[224:227], v[144:159]
    s_barrier
    ds_read_b64_tr_b16 v[192:193], v4 offset:24576
    ds_read_b64_tr_b16 v[194:195], v4 offset:25088
    s_waitcnt vmcnt(9) lgkmcnt(4)
    v_mfma_f32_32x32x16_bf16 v[16:31], v[204:207], a[232:235], v[16:31]
    ds_read_b64_tr_b16 v[196:197], v5 offset:24576
    buffer_load_dwordx4 v[180:183], v10, s[4:7], s44 offen offset:2048 sc1
    v_mfma_f32_32x32x16_bf16 v[32:47], v[204:207], a[236:239], v[32:47]
    ds_read_b64_tr_b16 v[198:199], v5 offset:25088
    v_mfma_f32_32x32x16_bf16 v[48:63], v[208:211], a[232:235], v[48:63]
    ds_read_b64_tr_b16 v[200:201], v3 offset:30720
    buffer_load_dwordx4 v[184:187], v10, s[4:7], s43 offen offset:3072 sc1
    v_mfma_f32_32x32x16_bf16 v[64:79], v[208:211], a[236:239], v[64:79]
    ds_read_b64_tr_b16 v[202:203], v3 offset:30976
    s_waitcnt lgkmcnt(6)
    v_mfma_f32_32x32x16_bf16 v[144:159], v[212:215], a[232:235], v[144:159]
    ds_read_b64_tr_b16 v[204:205], v4 offset:26624
    ds_read_b64_tr_b16 v[206:207], v4 offset:27136
    s_waitcnt vmcnt(9) lgkmcnt(4)
    v_mfma_f32_32x32x16_bf16 v[16:31], v[192:195], a[240:243], v[16:31]
    ds_read_b64_tr_b16 v[208:209], v5 offset:26624
    buffer_load_dwordx4 v[188:191], v10, s[4:7], s44 offen offset:3072 sc1
    v_mfma_f32_32x32x16_bf16 v[32:47], v[192:195], a[244:247], v[32:47]
    ds_read_b64_tr_b16 v[210:211], v5 offset:27136
    v_mfma_f32_32x32x16_bf16 v[48:63], v[196:199], a[240:243], v[48:63]
    ds_read_b64_tr_b16 v[212:213], v3 offset:31744
    s_add_u32 m0, s45, 4096
    s_add_u32 s50, s49, 0
    buffer_load_dwordx4 v14, s[12:15], s50 offen offset:0 lds
    v_mfma_f32_32x32x16_bf16 v[64:79], v[196:199], a[244:247], v[64:79]
    ds_read_b64_tr_b16 v[214:215], v3 offset:32000
    s_waitcnt lgkmcnt(6)
    v_mfma_f32_32x32x16_bf16 v[144:159], v[200:203], a[240:243], v[144:159]
    ds_read_b64_tr_b16 v[192:193], v4 offset:28672
    ds_read_b64_tr_b16 v[194:195], v4 offset:29184
    buffer_load_dwordx4 v15, s[12:15], s50 offen offset:1024 lds
    s_waitcnt vmcnt(10) lgkmcnt(4)
    v_mfma_f32_32x32x16_bf16 v[16:31], v[204:207], a[248:251], v[16:31]
    ds_read_b64_tr_b16 v[196:197], v5 offset:28672
    v_mfma_f32_32x32x16_bf16 v[32:47], v[204:207], a[252:255], v[32:47]
    ds_read_b64_tr_b16 v[198:199], v5 offset:29184
    buffer_load_dwordx4 v223, s[12:15], s50 offen offset:2048 lds
    v_mfma_f32_32x32x16_bf16 v[48:63], v[208:211], a[248:251], v[48:63]
    ds_read_b64_tr_b16 v[200:201], v3 offset:32768
    v_mfma_f32_32x32x16_bf16 v[64:79], v[208:211], a[252:255], v[64:79]
    ds_read_b64_tr_b16 v[202:203], v3 offset:33024
    s_add_u32 m0, s45, 16384
    s_add_u32 s50, s49, 331776
    buffer_load_dwordx4 v14, s[12:15], s50 offen offset:0 lds
    s_waitcnt lgkmcnt(6)
    v_mfma_f32_32x32x16_bf16 v[144:159], v[212:215], a[248:251], v[144:159]
    ds_read_b64_tr_b16 v[204:205], v4 offset:30720
    ds_read_b64_tr_b16 v[206:207], v4 offset:31232
    s_waitcnt vmcnt(10) lgkmcnt(4)
    v_mfma_f32_32x32x16_bf16 v[16:31], v[192:195], v[160:163], v[16:31]
    ds_read_b64_tr_b16 v[208:209], v5 offset:30720
    buffer_load_dwordx4 v15, s[12:15], s50 offen offset:1024 lds
    v_mfma_f32_32x32x16_bf16 v[32:47], v[192:195], v[164:167], v[32:47]
    ds_read_b64_tr_b16 v[210:211], v5 offset:31232
    v_mfma_f32_32x32x16_bf16 v[48:63], v[196:199], v[160:163], v[48:63]
    ds_read_b64_tr_b16 v[212:213], v3 offset:33792
    buffer_load_dwordx4 v223, s[12:15], s50 offen offset:2048 lds
    v_mfma_f32_32x32x16_bf16 v[64:79], v[196:199], v[164:167], v[64:79]
    ds_read_b64_tr_b16 v[214:215], v3 offset:34048
    s_waitcnt lgkmcnt(6)
    v_mfma_f32_32x32x16_bf16 v[144:159], v[200:203], v[160:163], v[144:159]
    ds_read_b64_tr_b16 v[192:193], v4 offset:32768
    ds_read_b64_tr_b16 v[194:195], v4 offset:33280
    s_add_u32 m0, s45, 28672
    s_add_u32 s50, s49, 663552
    buffer_load_dwordx4 v14, s[12:15], s50 offen offset:0 lds
    s_waitcnt vmcnt(11) lgkmcnt(4)
    v_mfma_f32_32x32x16_bf16 v[16:31], v[204:207], v[168:171], v[16:31]
    ds_read_b64_tr_b16 v[196:197], v5 offset:32768
    v_mfma_f32_32x32x16_bf16 v[32:47], v[204:207], v[172:175], v[32:47]
    ds_read_b64_tr_b16 v[198:199], v5 offset:33280
    buffer_load_dwordx4 v15, s[12:15], s50 offen offset:1024 lds
    v_mfma_f32_32x32x16_bf16 v[48:63], v[208:211], v[168:171], v[48:63]
    ds_read_b64_tr_b16 v[200:201], v3 offset:34816
    v_mfma_f32_32x32x16_bf16 v[64:79], v[208:211], v[172:175], v[64:79]
    ds_read_b64_tr_b16 v[202:203], v3 offset:35072
    buffer_load_dwordx4 v223, s[12:15], s50 offen offset:2048 lds
    s_waitcnt lgkmcnt(6)
    v_mfma_f32_32x32x16_bf16 v[144:159], v[212:215], v[168:171], v[144:159]
    ds_read_b64_tr_b16 v[204:205], v4 offset:34816
    ds_read_b64_tr_b16 v[206:207], v4 offset:35328
    v_subrev_u32 v245, 61440, v1
    v_subrev_u32 v247, 61440, v2
    s_waitcnt vmcnt(11) lgkmcnt(4)
    v_mfma_f32_32x32x16_bf16 v[16:31], v[192:195], v[176:179], v[16:31]
    ds_read_b64_tr_b16 v[208:209], v5 offset:34816
    s_add_u32 m0, s45, 40960
    s_add_u32 s50, s49, 995328
    buffer_load_dwordx4 v14, s[12:15], s50 offen offset:0 lds
    v_mfma_f32_32x32x16_bf16 v[32:47], v[192:195], v[180:183], v[32:47]
    ds_read_b64_tr_b16 v[210:211], v5 offset:35328
    v_mfma_f32_32x32x16_bf16 v[48:63], v[196:199], v[176:179], v[48:63]
    ds_read_b64_tr_b16 v[212:213], v3 offset:35840
    buffer_load_dwordx4 v15, s[12:15], s50 offen offset:1024 lds
    v_mfma_f32_32x32x16_bf16 v[64:79], v[196:199], v[180:183], v[64:79]
    ds_read_b64_tr_b16 v[214:215], v3 offset:36096
    s_waitcnt lgkmcnt(6)
    v_mfma_f32_32x32x16_bf16 v[144:159], v[200:203], v[176:179], v[144:159]
    s_waitcnt vmcnt(8)
    s_barrier
    ds_read_b64_tr_b16 v[192:193], v245 offset:0
    ds_read_b64_tr_b16 v[194:195], v245 offset:512
    s_waitcnt lgkmcnt(4)
    v_mfma_f32_32x32x16_bf16 v[16:31], v[204:207], v[184:187], v[16:31]
    ds_read_b64_tr_b16 v[196:197], v245 offset:2048
    buffer_load_dwordx4 v223, s[12:15], s50 offen offset:2048 lds
    v_mfma_f32_32x32x16_bf16 v[32:47], v[204:207], v[188:191], v[32:47]
    ds_read_b64_tr_b16 v[198:199], v245 offset:2560
    v_mfma_f32_32x32x16_bf16 v[48:63], v[208:211], v[184:187], v[48:63]
    ds_read_b64_tr_b16 v[200:201], v245 offset:4096
    s_add_u32 m0, s45, 53248
    s_add_u32 s50, s49, 1327104
    buffer_load_dwordx4 v14, s[12:15], s50 offen offset:0 lds
    v_mfma_f32_32x32x16_bf16 v[64:79], v[208:211], v[188:191], v[64:79]
    ds_read_b64_tr_b16 v[202:203], v245 offset:4608
    s_waitcnt lgkmcnt(6)
    v_mfma_f32_32x32x16_bf16 v[144:159], v[212:215], v[184:187], v[144:159]
    ds_read_b64_tr_b16 v[204:205], v245 offset:6144
    ds_read_b64_tr_b16 v[206:207], v245 offset:6656
    buffer_load_dwordx4 v15, s[12:15], s50 offen offset:1024 lds
    s_waitcnt lgkmcnt(4)
    v_mfma_f32_32x32x16_bf16 v[80:95], a[0:3], v[192:195], 0
    ds_read_b64_tr_b16 v[208:209], v245 offset:8192
    v_mfma_f32_32x32x16_bf16 v[96:111], a[4:7], v[192:195], 0
    ds_read_b64_tr_b16 v[210:211], v245 offset:8704
    buffer_load_dwordx4 v223, s[12:15], s50 offen offset:2048 lds
    v_mfma_f32_32x32x16_bf16 v[80:95], a[8:11], v[196:199], v[80:95]
    ds_read_b64_tr_b16 v[212:213], v245 offset:10240
    v_add_u32 v222, 0, v255
    global_load_dword v254, v222, s[84:85]
    v_fma_f32 v224, -v16, v16, -s52
    v_fma_f32 v225, -v17, v17, -s52
    v_fma_f32 v226, -v18, v18, -s52
    v_fma_f32 v227, -v19, v19, -s52
    v_mul_f32 v224, v224, v16
    v_mul_f32 v225, v225, v17
    v_mfma_f32_32x32x16_bf16 v[96:111], a[12:15], v[196:199], v[96:111]
    ds_read_b64_tr_b16 v[214:215], v245 offset:10752
    s_add_u32 m0, s45, 65536
    s_add_u32 s50, s49, 1658880
    buffer_load_dwordx4 v14, s[12:15], s50 offen offset:0 lds
    v_mul_f32 v226, v226, v18
    v_mul_f32 v227, v227, v19
    v_exp_f32 v224, v224
    s_waitcnt lgkmcnt(4)
    v_mfma_f32_32x32x16_bf16 v[80:95], a[16:19], v[200:203], v[80:95]
    s_waitcnt vmcnt(11)
    s_barrier
    ds_read_b64_tr_b16 v[192:193], v245 offset:12288
    v_exp_f32 v225, v225
    v_exp_f32 v226, v226
    v_exp_f32 v227, v227
    v_mfma_f32_32x32x16_bf16 v[96:111], a[20:23], v[200:203], v[96:111]
    ds_read_b64_tr_b16 v[194:195], v245 offset:12800
    buffer_load_dwordx4 v15, s[12:15], s50 offen offset:1024 lds
    v_add_f32 v224, 1.0, v224
    v_add_f32 v225, 1.0, v225
    v_add_f32 v226, 1.0, v226
    v_add_f32 v227, 1.0, v227
    v_rcp_f32 v224, v224
    v_mfma_f32_32x32x16_bf16 v[80:95], a[24:27], v[204:207], v[80:95]
    ds_read_b64_tr_b16 v[196:197], v245 offset:14336
    v_rcp_f32 v225, v225
    v_rcp_f32 v226, v226
    v_rcp_f32 v227, v227
    v_mul_f32 v224, v224, v16
    v_mul_f32 v225, v225, v17
    v_mul_f32 v226, v226, v18
    v_mfma_f32_32x32x16_bf16 v[96:111], a[28:31], v[204:207], v[96:111]
    ds_read_b64_tr_b16 v[198:199], v245 offset:14848
    buffer_load_dwordx4 v223, s[12:15], s50 offen offset:2048 lds
    v_mul_f32 v227, v227, v19
    v_add_f32 v216, v216, v224
    v_fmac_f32 v217, v224, v224
    v_add_f32 v216, v216, v225
    v_fmac_f32 v217, v225, v225
    v_add_f32 v216, v216, v226
    s_waitcnt lgkmcnt(4)
    v_mfma_f32_32x32x16_bf16 v[80:95], a[32:35], v[208:211], v[80:95]
    ds_read_b64_tr_b16 v[200:201], v245 offset:16384
    v_fmac_f32 v217, v226, v226
    v_add_f32 v216, v216, v227
    v_fmac_f32 v217, v227, v227
    v_cvt_pk_bf16_f32 v16, v224, v225
    v_cvt_pk_bf16_f32 v17, v226, v227
    v_fma_f32 v228, -v20, v20, -s52
    v_fma_f32 v229, -v21, v21, -s52
    v_fma_f32 v230, -v22, v22, -s52
    v_mfma_f32_32x32x16_bf16 v[96:111], a[36:39], v[208:211], v[96:111]
    ds_read_b64_tr_b16 v[202:203], v245 offset:16896
    v_fma_f32 v231, -v23, v23, -s52
    v_mul_f32 v228, v228, v20
    v_mul_f32 v229, v229, v21
    v_mul_f32 v230, v230, v22
    v_mul_f32 v231, v231, v23
    v_exp_f32 v228, v228
    v_mfma_f32_32x32x16_bf16 v[80:95], a[40:43], v[212:215], v[80:95]
    ds_read_b64_tr_b16 v[204:205], v245 offset:18432
    v_exp_f32 v229, v229
    v_exp_f32 v230, v230
    v_exp_f32 v231, v231
    v_add_f32 v228, 1.0, v228
    v_add_f32 v229, 1.0, v229
    v_add_f32 v230, 1.0, v230
    v_mfma_f32_32x32x16_bf16 v[96:111], a[44:47], v[212:215], v[96:111]
    ds_read_b64_tr_b16 v[206:207], v245 offset:18944
    v_add_f32 v231, 1.0, v231
    v_rcp_f32 v228, v228
    v_rcp_f32 v229, v229
    v_rcp_f32 v230, v230
    s_waitcnt lgkmcnt(4)
    v_mfma_f32_32x32x16_bf16 v[80:95], a[48:51], v[192:195], v[80:95]
    ds_read_b64_tr_b16 v[208:209], v245 offset:20480
    v_rcp_f32 v231, v231
    v_mul_f32 v228, v228, v20
    v_mul_f32 v229, v229, v21
    v_mul_f32 v230, v230, v22
    v_mul_f32 v231, v231, v23
    v_add_f32 v216, v216, v228
    v_fmac_f32 v217, v228, v228
    v_mfma_f32_32x32x16_bf16 v[96:111], a[52:55], v[192:195], v[96:111]
    ds_read_b64_tr_b16 v[210:211], v245 offset:20992
    s_add_u32 m0, s45, 90112
    s_add_u32 s50, s48, 0
    buffer_load_dwordx4 v7, s[8:11], s50 offen offset:0 lds
    v_add_f32 v216, v216, v229
    v_fmac_f32 v217, v229, v229
    v_add_f32 v216, v216, v230
    v_fmac_f32 v217, v230, v230
    v_add_f32 v216, v216, v231
    v_mfma_f32_32x32x16_bf16 v[80:95], a[56:59], v[196:199], v[80:95]
    ds_read_b64_tr_b16 v[212:213], v245 offset:22528
    v_fmac_f32 v217, v231, v231
    v_cvt_pk_bf16_f32 v18, v228, v229
    v_cvt_pk_bf16_f32 v19, v230, v231
    v_add_u32 v222, 2097152, v255
    global_load_dword v254, v222, s[84:85]
    v_fma_f32 v224, -v24, v24, -s52
    v_fma_f32 v225, -v25, v25, -s52
    v_fma_f32 v226, -v26, v26, -s52
    v_mfma_f32_32x32x16_bf16 v[96:111], a[60:63], v[196:199], v[96:111]
    ds_read_b64_tr_b16 v[214:215], v245 offset:23040
    v_fma_f32 v227, -v27, v27, -s52
    v_mul_f32 v224, v224, v24
    v_mul_f32 v225, v225, v25
    v_mul_f32 v226, v226, v26
    v_mul_f32 v227, v227, v27
    v_exp_f32 v224, v224
    s_waitcnt lgkmcnt(4)
    v_mfma_f32_32x32x16_bf16 v[80:95], a[64:67], v[200:203], v[80:95]
    s_waitcnt vmcnt(9)
    s_barrier
    ds_read_b64_tr_b16 v[192:193], v245 offset:24576
    v_exp_f32 v225, v225
    v_exp_f32 v226, v226
    v_exp_f32 v227, v227
    v_mfma_f32_32x32x16_bf16 v[96:111], a[68:71], v[200:203], v[96:111]
    ds_read_b64_tr_b16 v[194:195], v245 offset:25088
    v_add_f32 v224, 1.0, v224
    v_add_f32 v225, 1.0, v225
    v_add_f32 v226, 1.0, v226
    v_add_f32 v227, 1.0, v227
    v_rcp_f32 v224, v224
    v_rcp_f32 v225, v225
    v_mfma_f32_32x32x16_bf16 v[80:95], a[72:75], v[204:207], v[80:95]
    ds_read_b64_tr_b16 v[196:197], v245 offset:26624
    v_rcp_f32 v226, v226
    v_rcp_f32 v227, v227
    v_mul_f32 v224, v224, v24
    v_mul_f32 v225, v225, v25
    v_mul_f32 v226, v226, v26
    v_mul_f32 v227, v227, v27
    v_mfma_f32_32x32x16_bf16 v[96:111], a[76:79], v[204:207], v[96:111]
    ds_read_b64_tr_b16 v[198:199], v245 offset:27136
    buffer_load_dwordx4 v8, s[8:11], s50 offen offset:1024 lds
    v_add_f32 v216, v216, v224
    v_fmac_f32 v217, v224, v224
    v_add_f32 v216, v216, v225
    v_fmac_f32 v217, v225, v225
    v_add_f32 v216, v216, v226
    v_fmac_f32 v217, v226, v226
    s_waitcnt lgkmcnt(4)
    v_mfma_f32_32x32x16_bf16 v[80:95], a[80:83], v[208:211], v[80:95]
    ds_read_b64_tr_b16 v[200:201], v245 offset:28672
    v_add_f32 v216, v216, v227
    v_fmac_f32 v217, v227, v227
    v_cvt_pk_bf16_f32 v20, v224, v225
    v_cvt_pk_bf16_f32 v21, v226, v227
    v_fma_f32 v228, -v28, v28, -s52
    v_fma_f32 v229, -v29, v29, -s52
    v_fma_f32 v230, -v30, v30, -s52
    v_fma_f32 v231, -v31, v31, -s52
    v_mfma_f32_32x32x16_bf16 v[96:111], a[84:87], v[208:211], v[96:111]
    ds_read_b64_tr_b16 v[202:203], v245 offset:29184
    v_mul_f32 v228, v228, v28
    v_mul_f32 v229, v229, v29
    v_mul_f32 v230, v230, v30
    v_mul_f32 v231, v231, v31
    v_exp_f32 v228, v228
    v_exp_f32 v229, v229
    v_mfma_f32_32x32x16_bf16 v[80:95], a[88:91], v[212:215], v[80:95]
    ds_read_b64_tr_b16 v[204:205], v245 offset:30720
    v_exp_f32 v230, v230
    v_exp_f32 v231, v231
    v_add_f32 v228, 1.0, v228
    v_add_f32 v229, 1.0, v229
    v_add_f32 v230, 1.0, v230
    v_add_f32 v231, 1.0, v231
    v_mfma_f32_32x32x16_bf16 v[96:111], a[92:95], v[212:215], v[96:111]
    ds_read_b64_tr_b16 v[206:207], v245 offset:31232
    v_rcp_f32 v228, v228
    v_rcp_f32 v229, v229
    v_rcp_f32 v230, v230
    s_waitcnt lgkmcnt(4)
    v_mfma_f32_32x32x16_bf16 v[80:95], a[96:99], v[192:195], v[80:95]
    ds_read_b64_tr_b16 v[208:209], v245 offset:32768
    v_rcp_f32 v231, v231
    v_mul_f32 v228, v228, v28
    v_mul_f32 v229, v229, v29
    v_mul_f32 v230, v230, v30
    v_mul_f32 v231, v231, v31
    v_add_f32 v216, v216, v228
    v_fmac_f32 v217, v228, v228
    v_add_f32 v216, v216, v229
    v_mfma_f32_32x32x16_bf16 v[96:111], a[100:103], v[192:195], v[96:111]
    ds_read_b64_tr_b16 v[210:211], v245 offset:33280
    buffer_load_dwordx4 v9, s[8:11], s50 offen offset:2048 lds
    v_fmac_f32 v217, v229, v229
    v_add_f32 v216, v216, v230
    v_fmac_f32 v217, v230, v230
    v_add_f32 v216, v216, v231
    v_fmac_f32 v217, v231, v231
    v_cvt_pk_bf16_f32 v22, v228, v229
    v_cvt_pk_bf16_f32 v23, v230, v231
    v_mfma_f32_32x32x16_bf16 v[80:95], a[104:107], v[196:199], v[80:95]
    ds_read_b64_tr_b16 v[212:213], v245 offset:34816
    v_add_u32 v222, 4194304, v255
    global_load_dword v254, v222, s[84:85]
    v_fma_f32 v224, -v32, v32, -s52
    v_fma_f32 v225, -v33, v33, -s52
    v_fma_f32 v226, -v34, v34, -s52
    v_fma_f32 v227, -v35, v35, -s52
    v_mul_f32 v224, v224, v32
    v_mul_f32 v225, v225, v33
    v_mfma_f32_32x32x16_bf16 v[96:111], a[108:111], v[196:199], v[96:111]
    ds_read_b64_tr_b16 v[214:215], v245 offset:35328
    v_mul_f32 v226, v226, v34
    v_mul_f32 v227, v227, v35
    v_exp_f32 v224, v224
    v_exp_f32 v225, v225
    s_waitcnt lgkmcnt(4)
    v_mfma_f32_32x32x16_bf16 v[80:95], a[112:115], v[200:203], v[80:95]
    ds_read_b64_tr_b16 v[192:193], v245 offset:36864
    v_exp_f32 v226, v226
    v_exp_f32 v227, v227
    v_add_f32 v224, 1.0, v224
    v_add_f32 v225, 1.0, v225
    v_add_f32 v226, 1.0, v226
    v_add_f32 v227, 1.0, v227
    v_mfma_f32_32x32x16_bf16 v[96:111], a[116:119], v[200:203], v[96:111]
    ds_read_b64_tr_b16 v[194:195], v245 offset:37376
    v_rcp_f32 v224, v224
    v_rcp_f32 v225, v225
    v_rcp_f32 v226, v226
    v_rcp_f32 v227, v227
    v_mul_f32 v224, v224, v32
    v_mfma_f32_32x32x16_bf16 v[80:95], a[120:123], v[204:207], v[80:95]
    ds_read_b64_tr_b16 v[196:197], v245 offset:38912
    v_mul_f32 v225, v225, v33
    v_mul_f32 v226, v226, v34
    v_mul_f32 v227, v227, v35
    v_add_f32 v218, v218, v224
    v_fmac_f32 v219, v224, v224
    v_add_f32 v218, v218, v225
    v_fmac_f32 v219, v225, v225
    v_add_f32 v218, v218, v226
    v_mfma_f32_32x32x16_bf16 v[96:111], a[124:127], v[204:207], v[96:111]
    ds_read_b64_tr_b16 v[198:199], v245 offset:39424
    s_add_u32 m0, s45, 102400
    s_add_u32 s50, s48, 884736
    buffer_load_dwordx4 v7, s[8:11], s50 offen offset:0 lds
    v_fmac_f32 v219, v226, v226
    v_add_f32 v218, v218, v227
    v_fmac_f32 v219, v227, v227
    v_cvt_pk_bf16_f32 v24, v224, v225
    s_waitcnt lgkmcnt(4)
    v_mfma_f32_32x32x16_bf16 v[80:95], a[128:131], v[208:211], v[80:95]
    ds_read_b64_tr_b16 v[200:201], v245 offset:40960
    v_cvt_pk_bf16_f32 v25, v226, v227
    v_fma_f32 v228, -v36, v36, -s52
    v_fma_f32 v229, -v37, v37, -s52
    v_fma_f32 v230, -v38, v38, -s52
    v_fma_f32 v231, -v39, v39, -s52
    v_mul_f32 v228, v228, v36
    v_mul_f32 v229, v229, v37
    v_mul_f32 v230, v230, v38
    v_mfma_f32_32x32x16_bf16 v[96:111], a[132:135], v[208:211], v[96:111]
    ds_read_b64_tr_b16 v[202:203], v245 offset:41472
    v_mul_f32 v231, v231, v39
    v_exp_f32 v228, v228
    v_exp_f32 v229, v229
    v_exp_f32 v230, v230
    v_mfma_f32_32x32x16_bf16 v[80:95], a[136:139], v[212:215], v[80:95]
    ds_read_b64_tr_b16 v[204:205], v245 offset:43008
    v_exp_f32 v231, v231
    v_add_f32 v228, 1.0, v228
    v_add_f32 v229, 1.0, v229
    v_add_f32 v230, 1.0, v230
    v_add_f32 v231, 1.0, v231
    v_rcp_f32 v228, v228
    v_mfma_f32_32x32x16_bf16 v[96:111], a[140:143], v[212:215], v[96:111]
    ds_read_b64_tr_b16 v[206:207], v245 offset:43520
    v_rcp_f32 v229, v229
    v_rcp_f32 v230, v230
    v_rcp_f32 v231, v231
    v_mul_f32 v228, v228, v36
    v_mul_f32 v229, v229, v37
    s_waitcnt lgkmcnt(4)
    v_mfma_f32_32x32x16_bf16 v[80:95], a[144:147], v[192:195], v[80:95]
    ds_read_b64_tr_b16 v[208:209], v245 offset:45056
    v_mul_f32 v230, v230, v38
    v_mul_f32 v231, v231, v39
    v_add_f32 v218, v218, v228
    v_fmac_f32 v219, v228, v228
    v_add_f32 v218, v218, v229
    v_fmac_f32 v219, v229, v229
    v_add_f32 v218, v218, v230
    v_fmac_f32 v219, v230, v230
    v_mfma_f32_32x32x16_bf16 v[96:111], a[148:151], v[192:195], v[96:111]
    ds_read_b64_tr_b16 v[210:211], v245 offset:45568
    buffer_load_dwordx4 v8, s[8:11], s50 offen offset:1024 lds
    v_add_f32 v218, v218, v231
    v_fmac_f32 v219, v231, v231
    v_cvt_pk_bf16_f32 v26, v228, v229
    v_cvt_pk_bf16_f32 v27, v230, v231
    v_add_u32 v222, 6291456, v255
    global_load_dword v254, v222, s[84:85]
    v_fma_f32 v224, -v40, v40, -s52
    v_mfma_f32_32x32x16_bf16 v[80:95], a[152:155], v[196:199], v[80:95]
    ds_read_b64_tr_b16 v[212:213], v245 offset:47104
    v_fma_f32 v225, -v41, v41, -s52
    v_fma_f32 v226, -v42, v42, -s52
    v_fma_f32 v227, -v43, v43, -s52
    v_mul_f32 v224, v224, v40
    v_mul_f32 v225, v225, v41
    v_mul_f32 v226, v226, v42
    v_mul_f32 v227, v227, v43
    v_mfma_f32_32x32x16_bf16 v[96:111], a[156:159], v[196:199], v[96:111]
    ds_read_b64_tr_b16 v[214:215], v245 offset:47616
    v_exp_f32 v224, v224
    v_exp_f32 v225, v225
    v_exp_f32 v226, v226
    v_exp_f32 v227, v227
    s_waitcnt lgkmcnt(4)
    v_mfma_f32_32x32x16_bf16 v[80:95], a[160:163], v[200:203], v[80:95]
    s_waitcnt vmcnt(8)
    s_barrier
    ds_read_b64_tr_b16 v[192:193], v245 offset:49152
    v_add_f32 v224, 1.0, v224
    v_add_f32 v225, 1.0, v225
    v_add_f32 v226, 1.0, v226
    v_add_f32 v227, 1.0, v227
    v_rcp_f32 v224, v224
    v_mfma_f32_32x32x16_bf16 v[96:111], a[164:167], v[200:203], v[96:111]
    ds_read_b64_tr_b16 v[194:195], v245 offset:49664
    v_rcp_f32 v225, v225
    v_rcp_f32 v226, v226
    v_rcp_f32 v227, v227
    v_mul_f32 v224, v224, v40
    v_mul_f32 v225, v225, v41
    v_mfma_f32_32x32x16_bf16 v[80:95], a[168:171], v[204:207], v[80:95]
    ds_read_b64_tr_b16 v[196:197], v245 offset:51200
    v_mul_f32 v226, v226, v42
    v_mul_f32 v227, v227, v43
    v_add_f32 v218, v218, v224
    v_fmac_f32 v219, v224, v224
    v_add_f32 v218, v218, v225
    v_fmac_f32 v219, v225, v225
    v_add_f32 v218, v218, v226
    v_fmac_f32 v219, v226, v226
    v_mfma_f32_32x32x16_bf16 v[96:111], a[172:175], v[204:207], v[96:111]
    ds_read_b64_tr_b16 v[198:199], v245 offset:51712
    buffer_load_dwordx4 v9, s[8:11], s50 offen offset:2048 lds
    v_add_f32 v218, v218, v227
    v_fmac_f32 v219, v227, v227
    v_cvt_pk_bf16_f32 v28, v224, v225
    v_cvt_pk_bf16_f32 v29, v226, v227
    v_fma_f32 v228, -v44, v44, -s52
    v_fma_f32 v229, -v45, v45, -s52
    s_waitcnt lgkmcnt(4)
    v_mfma_f32_32x32x16_bf16 v[80:95], a[176:179], v[208:211], v[80:95]
    ds_read_b64_tr_b16 v[200:201], v245 offset:53248
    v_fma_f32 v230, -v46, v46, -s52
    v_fma_f32 v231, -v47, v47, -s52
    v_mul_f32 v228, v228, v44
    v_mul_f32 v229, v229, v45
    v_mul_f32 v230, v230, v46
    v_mul_f32 v231, v231, v47
    v_exp_f32 v228, v228
    v_mfma_f32_32x32x16_bf16 v[96:111], a[180:183], v[208:211], v[96:111]
    ds_read_b64_tr_b16 v[202:203], v245 offset:53760
    v_exp_f32 v229, v229
    v_exp_f32 v230, v230
    v_exp_f32 v231, v231
    v_add_f32 v228, 1.0, v228
    v_add_f32 v229, 1.0, v229
    v_mfma_f32_32x32x16_bf16 v[80:95], a[184:187], v[212:215], v[80:95]
    ds_read_b64_tr_b16 v[204:205], v245 offset:55296
    v_add_f32 v230, 1.0, v230
    v_add_f32 v231, 1.0, v231
    v_rcp_f32 v228, v228
    v_rcp_f32 v229, v229
    v_rcp_f32 v230, v230
    v_mfma_f32_32x32x16_bf16 v[96:111], a[188:191], v[212:215], v[96:111]
    ds_read_b64_tr_b16 v[206:207], v245 offset:55808
    v_rcp_f32 v231, v231
    v_mul_f32 v228, v228, v44
    v_mul_f32 v229, v229, v45
    v_mul_f32 v230, v230, v46
    v_mul_f32 v231, v231, v47
    v_add_f32 v218, v218, v228
    s_waitcnt lgkmcnt(4)
    v_mfma_f32_32x32x16_bf16 v[80:95], a[192:195], v[192:195], v[80:95]
    ds_read_b64_tr_b16 v[208:209], v245 offset:57344
    v_fmac_f32 v219, v228, v228
    v_add_f32 v218, v218, v229
    v_fmac_f32 v219, v229, v229
    v_add_f32 v218, v218, v230
    v_fmac_f32 v219, v230, v230
    v_add_f32 v218, v218, v231
    v_fmac_f32 v219, v231, v231
    v_cvt_pk_bf16_f32 v30, v228, v229
    v_mfma_f32_32x32x16_bf16 v[96:111], a[196:199], v[192:195], v[96:111]
    ds_read_b64_tr_b16 v[210:211], v245 offset:57856
    s_add_u32 m0, s45, 114688
    s_add_u32 s50, s48, 1769472
    buffer_load_dwordx4 v7, s[8:11], s50 offen offset:0 lds
    v_cvt_pk_bf16_f32 v31, v230, v231
    global_load_dword v254, v255, s[86:87]
    v_fma_f32 v224, -v48, v48, -s52
    v_fma_f32 v225, -v49, v49, -s52
    v_fma_f32 v226, -v50, v50, -s52
    v_mfma_f32_32x32x16_bf16 v[80:95], a[200:203], v[196:199], v[80:95]
    ds_read_b64_tr_b16 v[212:213], v245 offset:59392
    v_fma_f32 v227, -v51, v51, -s52
    v_mul_f32 v224, v224, v48
    v_mul_f32 v225, v225, v49
    v_mul_f32 v226, v226, v50
    v_mul_f32 v227, v227, v51
    v_exp_f32 v224, v224
    v_mfma_f32_32x32x16_bf16 v[96:111], a[204:207], v[196:199], v[96:111]
    ds_read_b64_tr_b16 v[214:215], v245 offset:59904
    v_exp_f32 v225, v225
    v_exp_f32 v226, v226
    v_exp_f32 v227, v227
    v_add_f32 v224, 1.0, v224
    v_add_f32 v225, 1.0, v225
    s_waitcnt lgkmcnt(4)
    v_mfma_f32_32x32x16_bf16 v[80:95], a[208:211], v[200:203], v[80:95]
    ds_read_b64_tr_b16 v[192:193], v1 offset:0
    v_add_f32 v226, 1.0, v226
    v_add_f32 v227, 1.0, v227
    v_rcp_f32 v224, v224
    v_rcp_f32 v225, v225
    v_rcp_f32 v226, v226
    v_mfma_f32_32x32x16_bf16 v[96:111], a[212:215], v[200:203], v[96:111]
    ds_read_b64_tr_b16 v[194:195], v1 offset:512
    v_rcp_f32 v227, v227
    v_mul_f32 v224, v224, v48
    v_mul_f32 v225, v225, v49
    v_mul_f32 v226, v226, v50
    v_mul_f32 v227, v227, v51
    v_add_f32 v216, v216, v224
    v_fmac_f32 v217, v224, v224
    v_mfma_f32_32x32x16_bf16 v[80:95], a[216:219], v[204:207], v[80:95]
    ds_read_b64_tr_b16 v[196:197], v1 offset:2048
    v_add_f32 v216, v216, v225
    v_fmac_f32 v217, v225, v225
    v_add_f32 v216, v216, v226
    v_fmac_f32 v217, v226, v226
    v_add_f32 v216, v216, v227
    v_fmac_f32 v217, v227, v227
    v_cvt_pk_bf16_f32 v32, v224, v225
    v_cvt_pk_bf16_f32 v33, v226, v227
    v_mfma_f32_32x32x16_bf16 v[96:111], a[220:223], v[204:207], v[96:111]
    ds_read_b64_tr_b16 v[198:199], v1 offset:2560
    buffer_load_dwordx4 v8, s[8:11], s50 offen offset:1024 lds
    v_fma_f32 v228, -v52, v52, -s52
    v_fma_f32 v229, -v53, v53, -s52
    v_fma_f32 v230, -v54, v54, -s52
    v_fma_f32 v231, -v55, v55, -s52
    v_mul_f32 v228, v228, v52
    v_mul_f32 v229, v229, v53
    s_waitcnt lgkmcnt(4)
    v_mfma_f32_32x32x16_bf16 v[80:95], a[224:227], v[208:211], v[80:95]
    ds_read_b64_tr_b16 v[200:201], v1 offset:4096
    v_mul_f32 v230, v230, v54
    v_mul_f32 v231, v231, v55
    v_exp_f32 v228, v228
    v_exp_f32 v229, v229
    v_exp_f32 v230, v230
    v_mfma_f32_32x32x16_bf16 v[96:111], a[228:231], v[208:211], v[96:111]
    ds_read_b64_tr_b16 v[202:203], v1 offset:4608
    v_exp_f32 v231, v231
    v_add_f32 v228, 1.0, v228
    v_add_f32 v229, 1.0, v229
    v_add_f32 v230, 1.0, v230
    v_add_f32 v231, 1.0, v231
    v_rcp_f32 v228, v228
    v_mfma_f32_32x32x16_bf16 v[80:95], a[232:235], v[212:215], v[80:95]
    ds_read_b64_tr_b16 v[204:205], v1 offset:6144
    v_rcp_f32 v229, v229
    v_rcp_f32 v230, v230
    v_rcp_f32 v231, v231
    v_mul_f32 v228, v228, v52
    v_mul_f32 v229, v229, v53
    v_mfma_f32_32x32x16_bf16 v[96:111], a[236:239], v[212:215], v[96:111]
    ds_read_b64_tr_b16 v[206:207], v1 offset:6656
    v_mul_f32 v230, v230, v54
    v_mul_f32 v231, v231, v55
    v_add_f32 v216, v216, v228
    v_fmac_f32 v217, v228, v228
    v_add_f32 v216, v216, v229
    v_fmac_f32 v217, v229, v229
    v_add_f32 v216, v216, v230
    s_waitcnt lgkmcnt(4)
    v_mfma_f32_32x32x16_bf16 v[80:95], a[240:243], v[192:195], v[80:95]
    ds_read_b64_tr_b16 v[208:209], v1 offset:8192
    v_fmac_f32 v217, v230, v230
    v_add_f32 v216, v216, v231
    v_fmac_f32 v217, v231, v231
    v_cvt_pk_bf16_f32 v34, v228, v229
    v_cvt_pk_bf16_f32 v35, v230, v231
    v_lshrrev_b32 v255, 1, v255
    v_add_u32 v222, 2097152, v255
    v_min_u32 v222, 2654204, v222
    v_mfma_f32_32x32x16_bf16 v[96:111], a[244:247], v[192:195], v[96:111]
    ds_read_b64_tr_b16 v[210:211], v1 offset:8704
    buffer_load_dwordx4 v9, s[8:11], s50 offen offset:2048 lds
    global_load_dword v254, v222, s[86:87]
    v_fma_f32 v224, -v56, v56, -s52
    v_fma_f32 v225, -v57, v57, -s52
    v_fma_f32 v226, -v58, v58, -s52
    v_fma_f32 v227, -v59, v59, -s52
    v_mul_f32 v224, v224, v56
    v_mul_f32 v225, v225, v57
    v_mfma_f32_32x32x16_bf16 v[80:95], a[248:251], v[196:199], v[80:95]
    ds_read_b64_tr_b16 v[212:213], v1 offset:10240
    v_mul_f32 v226, v226, v58
    v_mul_f32 v227, v227, v59
    v_exp_f32 v224, v224
    v_exp_f32 v225, v225
    v_exp_f32 v226, v226
    v_mfma_f32_32x32x16_bf16 v[96:111], a[252:255], v[196:199], v[96:111]
    ds_read_b64_tr_b16 v[214:215], v1 offset:10752
    v_exp_f32 v227, v227
    v_add_f32 v224, 1.0, v224
    v_add_f32 v225, 1.0, v225
    v_add_f32 v226, 1.0, v226
    v_add_f32 v227, 1.0, v227
    s_waitcnt lgkmcnt(4)
    v_mfma_f32_32x32x16_bf16 v[80:95], v[160:163], v[200:203], v[80:95]
    ds_read_b64_tr_b16 v[192:193], v247 offset:0
    v_rcp_f32 v224, v224
    v_rcp_f32 v225, v225
    v_rcp_f32 v226, v226
    v_rcp_f32 v227, v227
    v_mul_f32 v224, v224, v56
    v_mfma_f32_32x32x16_bf16 v[96:111], v[164:167], v[200:203], v[96:111]
    ds_read_b64_tr_b16 v[194:195], v247 offset:512
    v_mul_f32 v225, v225, v57
    v_mul_f32 v226, v226, v58
    v_mul_f32 v227, v227, v59
    v_add_f32 v216, v216, v224
    v_fmac_f32 v217, v224, v224
    v_add_f32 v216, v216, v225
    v_fmac_f32 v217, v225, v225
    v_add_f32 v216, v216, v226
    v_mfma_f32_32x32x16_bf16 v[80:95], v[168:171], v[204:207], v[80:95]
    ds_read_b64_tr_b16 v[196:197], v247 offset:2048
    v_fmac_f32 v217, v226, v226
    v_add_f32 v216, v216, v227
    v_fmac_f32 v217, v227, v227
    v_cvt_pk_bf16_f32 v36, v224, v225
    v_cvt_pk_bf16_f32 v37, v226, v227
    v_fma_f32 v228, -v60, v60, -s52
    v_fma_f32 v229, -v61, v61, -s52
    v_fma_f32 v230, -v62, v62, -s52
    v_mfma_f32_32x32x16_bf16 v[96:111], v[172:175], v[204:207], v[96:111]
    ds_read_b64_tr_b16 v[198:199], v247 offset:2560
    s_add_u32 m0, s45, 126976
    s_add_u32 s50, s48, 2654208
    buffer_load_dwordx4 v7, s[8:11], s50 offen offset:0 lds
    v_fma_f32 v231, -v63, v63, -s52
    v_mul_f32 v228, v228, v60
    v_mul_f32 v229, v229, v61
    v_mul_f32 v230, v230, v62
    s_waitcnt lgkmcnt(4)
    v_mfma_f32_32x32x16_bf16 v[80:95], v[176:179], v[208:211], v[80:95]
    ds_read_b64_tr_b16 v[200:201], v247 offset:4096
    v_mul_f32 v231, v231, v63
    v_exp_f32 v228, v228
    v_exp_f32 v229, v229
    v_exp_f32 v230, v230
    v_mfma_f32_32x32x16_bf16 v[96:111], v[180:183], v[208:211], v[96:111]
    ds_read_b64_tr_b16 v[202:203], v247 offset:4608
    v_exp_f32 v231, v231
    v_add_f32 v228, 1.0, v228
    v_add_f32 v229, 1.0, v229
    v_add_f32 v230, 1.0, v230
    v_add_f32 v231, 1.0, v231
    v_rcp_f32 v228, v228
    v_mfma_f32_32x32x16_bf16 v[80:95], v[184:187], v[212:215], v[80:95]
    ds_read_b64_tr_b16 v[204:205], v247 offset:6144
    v_rcp_f32 v229, v229
    v_rcp_f32 v230, v230
    v_rcp_f32 v231, v231
    v_mul_f32 v228, v228, v60
    v_mul_f32 v229, v229, v61
    v_mul_f32 v230, v230, v62
    v_mfma_f32_32x32x16_bf16 v[96:111], v[188:191], v[212:215], v[96:111]
    ds_read_b64_tr_b16 v[206:207], v247 offset:6656
    v_mul_f32 v231, v231, v63
    v_add_f32 v216, v216, v228
    v_fmac_f32 v217, v228, v228
    v_add_f32 v216, v216, v229
    v_fmac_f32 v217, v229, v229
    v_add_f32 v216, v216, v230
    v_fmac_f32 v217, v230, v230
    s_waitcnt lgkmcnt(4)
    v_mfma_f32_32x32x16_bf16 v[112:127], a[0:3], v[192:195], 0
    ds_read_b64_tr_b16 v[208:209], v247 offset:8192
    v_add_f32 v216, v216, v231
    v_fmac_f32 v217, v231, v231
    v_cvt_pk_bf16_f32 v38, v228, v229
    v_cvt_pk_bf16_f32 v39, v230, v231
    v_min_u32 v222, 663548, v255
    global_load_dword v254, v222, s[88:89]
    v_fma_f32 v224, -v64, v64, -s52
    v_fma_f32 v225, -v65, v65, -s52
    v_mfma_f32_32x32x16_bf16 v[128:143], a[4:7], v[192:195], 0
    ds_read_b64_tr_b16 v[210:211], v247 offset:8704
    buffer_load_dwordx4 v8, s[8:11], s50 offen offset:1024 lds
    v_fma_f32 v226, -v66, v66, -s52
    v_fma_f32 v227, -v67, v67, -s52
    v_mul_f32 v224, v224, v64
    v_mul_f32 v225, v225, v65
    v_mul_f32 v226, v226, v66
    v_mul_f32 v227, v227, v67
    v_mfma_f32_32x32x16_bf16 v[112:127], a[8:11], v[196:199], v[112:127]
    ds_read_b64_tr_b16 v[212:213], v247 offset:10240
    v_exp_f32 v224, v224
    v_exp_f32 v225, v225
    v_exp_f32 v226, v226
    v_exp_f32 v227, v227
    v_add_f32 v224, 1.0, v224
    v_mfma_f32_32x32x16_bf16 v[128:143], a[12:15], v[196:199], v[128:143]
    ds_read_b64_tr_b16 v[214:215], v247 offset:10752
    v_add_f32 v225, 1.0, v225
    v_add_f32 v226, 1.0, v226
    v_add_f32 v227, 1.0, v227
    v_rcp_f32 v224, v224
    v_rcp_f32 v225, v225
    s_waitcnt lgkmcnt(4)
    v_mfma_f32_32x32x16_bf16 v[112:127], a[16:19], v[200:203], v[112:127]
    ds_read_b64_tr_b16 v[192:193], v247 offset:12288
    v_rcp_f32 v226, v226
    v_rcp_f32 v227, v227
    v_mul_f32 v224, v224, v64
    v_mul_f32 v225, v225, v65
    v_mul_f32 v226, v226, v66
    v_mul_f32 v227, v227, v67
    v_mfma_f32_32x32x16_bf16 v[128:143], a[20:23], v[200:203], v[128:143]
    ds_read_b64_tr_b16 v[194:195], v247 offset:12800
    v_add_f32 v218, v218, v224
    v_fmac_f32 v219, v224, v224
    v_add_f32 v218, v218, v225
    v_fmac_f32 v219, v225, v225
    v_add_f32 v218, v218, v226
    v_fmac_f32 v219, v226, v226
    v_add_f32 v218, v218, v227
    v_fmac_f32 v219, v227, v227
    v_mfma_f32_32x32x16_bf16 v[112:127], a[24:27], v[204:207], v[112:127]
    ds_read_b64_tr_b16 v[196:197], v247 offset:14336
    v_cvt_pk_bf16_f32 v40, v224, v225
    v_cvt_pk_bf16_f32 v41, v226, v227
    v_fma_f32 v228, -v68, v68, -s52
    v_fma_f32 v229, -v69, v69, -s52
    v_fma_f32 v230, -v70, v70, -s52
    v_fma_f32 v231, -v71, v71, -s52
    v_mul_f32 v228, v228, v68
    v_mul_f32 v229, v229, v69
    v_mfma_f32_32x32x16_bf16 v[128:143], a[28:31], v[204:207], v[128:143]
    ds_read_b64_tr_b16 v[198:199], v247 offset:14848
    buffer_load_dwordx4 v9, s[8:11], s50 offen offset:2048 lds
    v_mul_f32 v230, v230, v70
    v_mul_f32 v231, v231, v71
    v_exp_f32 v228, v228
    v_exp_f32 v229, v229
    s_waitcnt lgkmcnt(4)
    v_mfma_f32_32x32x16_bf16 v[112:127], a[32:35], v[208:211], v[112:127]
    ds_read_b64_tr_b16 v[200:201], v247 offset:16384
    v_exp_f32 v230, v230
    v_exp_f32 v231, v231
    v_add_f32 v228, 1.0, v228
    v_add_f32 v229, 1.0, v229
    v_add_f32 v230, 1.0, v230
    v_add_f32 v231, 1.0, v231
    v_mfma_f32_32x32x16_bf16 v[128:143], a[36:39], v[208:211], v[128:143]
    ds_read_b64_tr_b16 v[202:203], v247 offset:16896
    v_rcp_f32 v228, v228
    v_rcp_f32 v229, v229
    v_rcp_f32 v230, v230
    v_rcp_f32 v231, v231
    v_mfma_f32_32x32x16_bf16 v[112:127], a[40:43], v[212:215], v[112:127]
    ds_read_b64_tr_b16 v[204:205], v247 offset:18432
    v_mul_f32 v228, v228, v68
    v_mul_f32 v229, v229, v69
    v_mul_f32 v230, v230, v70
    v_mul_f32 v231, v231, v71
    v_add_f32 v218, v218, v228
    v_fmac_f32 v219, v228, v228
    v_add_f32 v218, v218, v229
    v_fmac_f32 v219, v229, v229
    v_mfma_f32_32x32x16_bf16 v[128:143], a[44:47], v[212:215], v[128:143]
    ds_read_b64_tr_b16 v[206:207], v247 offset:18944
    v_add_f32 v218, v218, v230
    v_fmac_f32 v219, v230, v230
    v_add_f32 v218, v218, v231
    v_fmac_f32 v219, v231, v231
    v_cvt_pk_bf16_f32 v42, v228, v229
    v_cvt_pk_bf16_f32 v43, v230, v231
    v_fma_f32 v224, -v72, v72, -s52
    s_waitcnt lgkmcnt(4)
    v_mfma_f32_32x32x16_bf16 v[112:127], a[48:51], v[192:195], v[112:127]
    ds_read_b64_tr_b16 v[208:209], v247 offset:20480
    v_fma_f32 v225, -v73, v73, -s52
    v_fma_f32 v226, -v74, v74, -s52
    v_fma_f32 v227, -v75, v75, -s52
    v_mul_f32 v224, v224, v72
    v_mul_f32 v225, v225, v73
    v_mul_f32 v226, v226, v74
    v_mul_f32 v227, v227, v75
    v_mfma_f32_32x32x16_bf16 v[128:143], a[52:55], v[192:195], v[128:143]
    ds_read_b64_tr_b16 v[210:211], v247 offset:20992
    s_add_u32 m0, s45, 139264
    s_add_u32 s50, s48, 3538944
    buffer_load_dwordx4 v7, s[8:11], s50 offen offset:0 lds
    v_exp_f32 v224, v224
    v_exp_f32 v225, v225
    v_exp_f32 v226, v226
    v_mfma_f32_32x32x16_bf16 v[112:127], a[56:59], v[196:199], v[112:127]
    ds_read_b64_tr_b16 v[212:213], v247 offset:22528
    v_exp_f32 v227, v227
    v_add_f32 v224, 1.0, v224
    v_add_f32 v225, 1.0, v225
    v_add_f32 v226, 1.0, v226
    v_add_f32 v227, 1.0, v227
    v_rcp_f32 v224, v224
    v_mfma_f32_32x32x16_bf16 v[128:143], a[60:63], v[196:199], v[128:143]
    ds_read_b64_tr_b16 v[214:215], v247 offset:23040
    v_rcp_f32 v225, v225
    v_rcp_f32 v226, v226
    v_rcp_f32 v227, v227
    v_mul_f32 v224, v224, v72
    s_waitcnt lgkmcnt(4)
    v_mfma_f32_32x32x16_bf16 v[112:127], a[64:67], v[200:203], v[112:127]
    ds_read_b64_tr_b16 v[192:193], v247 offset:24576
    v_mul_f32 v225, v225, v73
    v_mul_f32 v226, v226, v74
    v_mul_f32 v227, v227, v75
    v_add_f32 v218, v218, v224
    v_fmac_f32 v219, v224, v224
    v_add_f32 v218, v218, v225
    v_fmac_f32 v219, v225, v225
    v_add_f32 v218, v218, v226
    v_mfma_f32_32x32x16_bf16 v[128:143], a[68:71], v[200:203], v[128:143]
    ds_read_b64_tr_b16 v[194:195], v247 offset:25088
    v_fmac_f32 v219, v226, v226
    v_add_f32 v218, v218, v227
    v_fmac_f32 v219, v227, v227
    v_cvt_pk_bf16_f32 v44, v224, v225
    v_cvt_pk_bf16_f32 v45, v226, v227
    v_fma_f32 v228, -v76, v76, -s52
    v_fma_f32 v229, -v77, v77, -s52
    v_fma_f32 v230, -v78, v78, -s52
    v_mfma_f32_32x32x16_bf16 v[112:127], a[72:75], v[204:207], v[112:127]
    ds_read_b64_tr_b16 v[196:197], v247 offset:26624
    v_fma_f32 v231, -v79, v79, -s52
    v_mul_f32 v228, v228, v76
    v_mul_f32 v229, v229, v77
    v_mul_f32 v230, v230, v78
    v_mul_f32 v231, v231, v79
    v_exp_f32 v228, v228
    v_mfma_f32_32x32x16_bf16 v[128:143], a[76:79], v[204:207], v[128:143]
    ds_read_b64_tr_b16 v[198:199], v247 offset:27136
    buffer_load_dwordx4 v8, s[8:11], s50 offen offset:1024 lds
    v_exp_f32 v229, v229
    v_exp_f32 v230, v230
    v_exp_f32 v231, v231
    v_add_f32 v228, 1.0, v228
    s_waitcnt lgkmcnt(4)
    v_mfma_f32_32x32x16_bf16 v[112:127], a[80:83], v[208:211], v[112:127]
    ds_read_b64_tr_b16 v[200:201], v247 offset:28672
    v_add_f32 v229, 1.0, v229
    v_add_f32 v230, 1.0, v230
    v_add_f32 v231, 1.0, v231
    v_rcp_f32 v228, v228
    v_rcp_f32 v229, v229
    v_mfma_f32_32x32x16_bf16 v[128:143], a[84:87], v[208:211], v[128:143]
    ds_read_b64_tr_b16 v[202:203], v247 offset:29184
    v_rcp_f32 v230, v230
    v_rcp_f32 v231, v231
    v_mul_f32 v228, v228, v76
    v_mul_f32 v229, v229, v77
    v_mul_f32 v230, v230, v78
    v_mul_f32 v231, v231, v79
    v_add_f32 v218, v218, v228
    v_mfma_f32_32x32x16_bf16 v[112:127], a[88:91], v[212:215], v[112:127]
    ds_read_b64_tr_b16 v[204:205], v247 offset:30720
    v_fmac_f32 v219, v228, v228
    v_add_f32 v218, v218, v229
    v_fmac_f32 v219, v229, v229
    v_add_f32 v218, v218, v230
    v_fmac_f32 v219, v230, v230
    v_add_f32 v218, v218, v231
    v_fmac_f32 v219, v231, v231
    v_cvt_pk_bf16_f32 v46, v228, v229
    v_mfma_f32_32x32x16_bf16 v[128:143], a[92:95], v[212:215], v[128:143]
    ds_read_b64_tr_b16 v[206:207], v247 offset:31232
    v_cvt_pk_bf16_f32 v47, v230, v231
    v_fma_f32 v224, -v144, v144, -s52
    v_fma_f32 v225, -v145, v145, -s52
    v_fma_f32 v226, -v146, v146, -s52
    v_fma_f32 v227, -v147, v147, -s52
    v_mul_f32 v224, v224, v144
    v_mul_f32 v225, v225, v145
    s_waitcnt lgkmcnt(4)
    v_mfma_f32_32x32x16_bf16 v[112:127], a[96:99], v[192:195], v[112:127]
    ds_read_b64_tr_b16 v[208:209], v247 offset:32768
    v_mul_f32 v226, v226, v146
    v_mul_f32 v227, v227, v147
    v_exp_f32 v224, v224
    v_exp_f32 v225, v225
    v_exp_f32 v226, v226
    v_mfma_f32_32x32x16_bf16 v[128:143], a[100:103], v[192:195], v[128:143]
    ds_read_b64_tr_b16 v[210:211], v247 offset:33280
    buffer_load_dwordx4 v9, s[8:11], s50 offen offset:2048 lds
    v_exp_f32 v227, v227
    v_add_f32 v224, 1.0, v224
    v_add_f32 v225, 1.0, v225
    v_add_f32 v226, 1.0, v226
    v_add_f32 v227, 1.0, v227
    v_mfma_f32_32x32x16_bf16 v[112:127], a[104:107], v[196:199], v[112:127]
    ds_read_b64_tr_b16 v[212:213], v247 offset:34816
    v_rcp_f32 v224, v224
    v_rcp_f32 v225, v225
    v_rcp_f32 v226, v226
    v_rcp_f32 v227, v227
    v_mul_f32 v224, v224, v144
    v_mfma_f32_32x32x16_bf16 v[128:143], a[108:111], v[196:199], v[128:143]
    ds_read_b64_tr_b16 v[214:215], v247 offset:35328
    v_mul_f32 v225, v225, v145
    v_mul_f32 v226, v226, v146
    v_mul_f32 v227, v227, v147
    v_add_f32 v220, v220, v224
    v_fmac_f32 v221, v224, v224
    v_add_f32 v220, v220, v225
    v_fmac_f32 v221, v225, v225
    s_waitcnt lgkmcnt(4)
    v_mfma_f32_32x32x16_bf16 v[112:127], a[112:115], v[200:203], v[112:127]
    ds_read_b64_tr_b16 v[192:193], v247 offset:36864
    v_add_f32 v220, v220, v226
    v_fmac_f32 v221, v226, v226
    v_add_f32 v220, v220, v227
    v_fmac_f32 v221, v227, v227
    v_cvt_pk_bf16_f32 v144, v224, v225
    v_cvt_pk_bf16_f32 v145, v226, v227
    v_fma_f32 v228, -v148, v148, -s52
    v_fma_f32 v229, -v149, v149, -s52
    v_mfma_f32_32x32x16_bf16 v[128:143], a[116:119], v[200:203], v[128:143]
    ds_read_b64_tr_b16 v[194:195], v247 offset:37376
    v_fma_f32 v230, -v150, v150, -s52
    v_fma_f32 v231, -v151, v151, -s52
    v_mul_f32 v228, v228, v148
    v_mul_f32 v229, v229, v149
    v_mul_f32 v230, v230, v150
    v_mul_f32 v231, v231, v151
    v_exp_f32 v228, v228
    v_mfma_f32_32x32x16_bf16 v[112:127], a[120:123], v[204:207], v[112:127]
    ds_read_b64_tr_b16 v[196:197], v247 offset:38912
    v_exp_f32 v229, v229
    v_exp_f32 v230, v230
    v_exp_f32 v231, v231
    v_add_f32 v228, 1.0, v228
    v_add_f32 v229, 1.0, v229
    v_mfma_f32_32x32x16_bf16 v[128:143], a[124:127], v[204:207], v[128:143]
    ds_read_b64_tr_b16 v[198:199], v247 offset:39424
    s_add_u32 m0, s45, 151552
    s_add_u32 s50, s48, 4423680
    buffer_load_dwordx4 v7, s[8:11], s50 offen offset:0 lds
    v_add_f32 v230, 1.0, v230
    v_add_f32 v231, 1.0, v231
    v_rcp_f32 v228, v228
    s_waitcnt lgkmcnt(4)
    v_mfma_f32_32x32x16_bf16 v[112:127], a[128:131], v[208:211], v[112:127]
    ds_read_b64_tr_b16 v[200:201], v247 offset:40960
    v_rcp_f32 v229, v229
    v_rcp_f32 v230, v230
    v_rcp_f32 v231, v231
    v_mul_f32 v228, v228, v148
    v_mul_f32 v229, v229, v149
    v_mfma_f32_32x32x16_bf16 v[128:143], a[132:135], v[208:211], v[128:143]
    ds_read_b64_tr_b16 v[202:203], v247 offset:41472
    v_mul_f32 v230, v230, v150
    v_mul_f32 v231, v231, v151
    v_add_f32 v220, v220, v228
    v_fmac_f32 v221, v228, v228
    v_add_f32 v220, v220, v229
    v_fmac_f32 v221, v229, v229
    v_add_f32 v220, v220, v230
    v_fmac_f32 v221, v230, v230
    v_mfma_f32_32x32x16_bf16 v[112:127], a[136:139], v[212:215], v[112:127]
    ds_read_b64_tr_b16 v[204:205], v247 offset:43008
    v_add_f32 v220, v220, v231
    v_fmac_f32 v221, v231, v231
    v_cvt_pk_bf16_f32 v146, v228, v229
    v_cvt_pk_bf16_f32 v147, v230, v231
    buffer_store_dwordx4 v[144:147], v11, s[32:35], s56 offen offset:0 sc1
    v_fma_f32 v224, -v152, v152, -s52
    v_fma_f32 v225, -v153, v153, -s52
    v_fma_f32 v226, -v154, v154, -s52
    v_mfma_f32_32x32x16_bf16 v[128:143], a[140:143], v[212:215], v[128:143]
    ds_read_b64_tr_b16 v[206:207], v247 offset:43520
    v_fma_f32 v227, -v155, v155, -s52
    v_mul_f32 v224, v224, v152
    v_mul_f32 v225, v225, v153
    v_mul_f32 v226, v226, v154
    v_mul_f32 v227, v227, v155
    v_exp_f32 v224, v224
    s_waitcnt lgkmcnt(4)
    v_mfma_f32_32x32x16_bf16 v[112:127], a[144:147], v[192:195], v[112:127]
    ds_read_b64_tr_b16 v[208:209], v247 offset:45056
    v_exp_f32 v225, v225
    v_exp_f32 v226, v226
    v_exp_f32 v227, v227
    v_add_f32 v224, 1.0, v224
    v_add_f32 v225, 1.0, v225
    v_mfma_f32_32x32x16_bf16 v[128:143], a[148:151], v[192:195], v[128:143]
    ds_read_b64_tr_b16 v[210:211], v247 offset:45568
    buffer_load_dwordx4 v8, s[8:11], s50 offen offset:1024 lds
    v_add_f32 v226, 1.0, v226
    v_add_f32 v227, 1.0, v227
    v_rcp_f32 v224, v224
    v_rcp_f32 v225, v225
    v_mfma_f32_32x32x16_bf16 v[112:127], a[152:155], v[196:199], v[112:127]
    ds_read_b64_tr_b16 v[212:213], v247 offset:47104
    v_rcp_f32 v226, v226
    v_rcp_f32 v227, v227
    v_mul_f32 v224, v224, v152
    v_mul_f32 v225, v225, v153
    v_mul_f32 v226, v226, v154
    v_mul_f32 v227, v227, v155
    v_add_f32 v220, v220, v224
    v_mfma_f32_32x32x16_bf16 v[128:143], a[156:159], v[196:199], v[128:143]
    ds_read_b64_tr_b16 v[214:215], v247 offset:47616
    v_fmac_f32 v221, v224, v224
    v_add_f32 v220, v220, v225
    v_fmac_f32 v221, v225, v225
    v_add_f32 v220, v220, v226
    v_fmac_f32 v221, v226, v226
    v_add_f32 v220, v220, v227
    v_fmac_f32 v221, v227, v227
    s_waitcnt lgkmcnt(4)
    v_mfma_f32_32x32x16_bf16 v[112:127], a[160:163], v[200:203], v[112:127]
    ds_read_b64_tr_b16 v[192:193], v247 offset:49152
    v_cvt_pk_bf16_f32 v148, v224, v225
    v_cvt_pk_bf16_f32 v149, v226, v227
    v_fma_f32 v228, -v156, v156, -s52
    v_fma_f32 v229, -v157, v157, -s52
    v_fma_f32 v230, -v158, v158, -s52
    v_fma_f32 v231, -v159, v159, -s52
    v_mul_f32 v228, v228, v156
    v_mul_f32 v229, v229, v157
    v_mfma_f32_32x32x16_bf16 v[128:143], a[164:167], v[200:203], v[128:143]
    ds_read_b64_tr_b16 v[194:195], v247 offset:49664
    v_mul_f32 v230, v230, v158
    v_mul_f32 v231, v231, v159
    v_exp_f32 v228, v228
    v_exp_f32 v229, v229
    v_exp_f32 v230, v230
    v_mfma_f32_32x32x16_bf16 v[112:127], a[168:171], v[204:207], v[112:127]
    ds_read_b64_tr_b16 v[196:197], v247 offset:51200
    v_exp_f32 v231, v231
    v_add_f32 v228, 1.0, v228
    v_add_f32 v229, 1.0, v229
    v_add_f32 v230, 1.0, v230
    v_add_f32 v231, 1.0, v231
    v_rcp_f32 v228, v228
    v_mfma_f32_32x32x16_bf16 v[128:143], a[172:175], v[204:207], v[128:143]
    ds_read_b64_tr_b16 v[198:199], v247 offset:51712
    buffer_load_dwordx4 v9, s[8:11], s50 offen offset:2048 lds
    v_rcp_f32 v229, v229
    v_rcp_f32 v230, v230
    v_rcp_f32 v231, v231
    s_waitcnt lgkmcnt(4)
    v_mfma_f32_32x32x16_bf16 v[112:127], a[176:179], v[208:211], v[112:127]
    ds_read_b64_tr_b16 v[200:201], v247 offset:53248
    v_mul_f32 v228, v228, v156
    v_mul_f32 v229, v229, v157
    v_mul_f32 v230, v230, v158
    v_mul_f32 v231, v231, v159
    v_add_f32 v220, v220, v228
    v_fmac_f32 v221, v228, v228
    v_add_f32 v220, v220, v229
    v_fmac_f32 v221, v229, v229
    v_mfma_f32_32x32x16_bf16 v[128:143], a[180:183], v[208:211], v[128:143]
    ds_read_b64_tr_b16 v[202:203], v247 offset:53760
    v_add_f32 v220, v220, v230
    v_fmac_f32 v221, v230, v230
    v_add_f32 v220, v220, v231
    v_fmac_f32 v221, v231, v231
    v_cvt_pk_bf16_f32 v150, v228, v229
    v_cvt_pk_bf16_f32 v151, v230, v231
    buffer_store_dwordx4 v[148:151], v11, s[32:35], s56 offen offset:256 sc1
    v_fma_f32 v216, v220, s53, v216
    v_mfma_f32_32x32x16_bf16 v[112:127], a[184:187], v[212:215], v[112:127]
    ds_read_b64_tr_b16 v[204:205], v247 offset:55296
    v_fma_f32 v217, v221, s53, v217
    v_permlane32_swap_b32 v218, v219
    s_nop 0
    v_permlane32_swap_b32 v216, v217
    v_add_f32 v216, v216, v217
    v_add_f32 v218, v218, v219
    buffer_atomic_add_f32 v216, v13, s[28:31], s59 offen offset:0
    buffer_atomic_add_f32 v218, v13, s[28:31], s59 offen offset:256
    v_mfma_f32_32x32x16_bf16 v[128:143], a[188:191], v[212:215], v[128:143]
    ds_read_b64_tr_b16 v[206:207], v247 offset:55808
    v_cvt_pk_bf16_f32 v232, v80, v81
    v_cvt_pk_bf16_f32 v233, v82, v83
    v_cvt_pk_bf16_f32 v234, v84, v85
    v_cvt_pk_bf16_f32 v235, v86, v87
    s_waitcnt lgkmcnt(4)
    v_mfma_f32_32x32x16_bf16 v[112:127], a[192:195], v[192:195], v[112:127]
    ds_read_b64_tr_b16 v[208:209], v247 offset:57344
    s_add_u32 s51, s57, 0
    buffer_store_dwordx4 v[232:235], v12, s[24:27], s51 offen offset:0 sc1
    v_cvt_pk_bf16_f32 v236, v88, v89
    v_cvt_pk_bf16_f32 v237, v90, v91
    v_cvt_pk_bf16_f32 v238, v92, v93
    v_mfma_f32_32x32x16_bf16 v[128:143], a[196:199], v[192:195], v[128:143]
    ds_read_b64_tr_b16 v[210:211], v247 offset:57856
    v_cvt_pk_bf16_f32 v239, v94, v95
    s_add_u32 s51, s57, 18688
    buffer_store_dwordx4 v[236:239], v12, s[24:27], s51 offen offset:0 sc1
    v_cvt_pk_bf16_f32 v240, v96, v97
    v_cvt_pk_bf16_f32 v241, v98, v99
    v_mfma_f32_32x32x16_bf16 v[112:127], a[200:203], v[196:199], v[112:127]
    ds_read_b64_tr_b16 v[212:213], v247 offset:59392
    v_cvt_pk_bf16_f32 v242, v100, v101
    v_cvt_pk_bf16_f32 v243, v102, v103
    s_add_u32 s51, s58, 0
    buffer_store_dwordx4 v[240:243], v12, s[24:27], s51 offen offset:0 sc1
    v_cvt_pk_bf16_f32 v232, v104, v105
    v_mfma_f32_32x32x16_bf16 v[128:143], a[204:207], v[196:199], v[128:143]
    ds_read_b64_tr_b16 v[214:215], v247 offset:59904
    v_cvt_pk_bf16_f32 v233, v106, v107
    v_cvt_pk_bf16_f32 v234, v108, v109
    v_cvt_pk_bf16_f32 v235, v110, v111
    s_add_u32 s51, s58, 18688
    s_waitcnt lgkmcnt(4)
    v_mfma_f32_32x32x16_bf16 v[112:127], a[208:211], v[200:203], v[112:127]
    ds_read_b64_tr_b16 v[192:193], v2 offset:0
    buffer_store_dwordx4 v[232:235], v12, s[24:27], s51 offen offset:0 sc1
    v_mfma_f32_32x32x16_bf16 v[128:143], a[212:215], v[200:203], v[128:143]
    ds_read_b64_tr_b16 v[194:195], v2 offset:512
    v_mfma_f32_32x32x16_bf16 v[112:127], a[216:219], v[204:207], v[112:127]
    ds_read_b64_tr_b16 v[196:197], v2 offset:2048
    v_mfma_f32_32x32x16_bf16 v[128:143], a[220:223], v[204:207], v[128:143]
    ds_read_b64_tr_b16 v[198:199], v2 offset:2560
    s_waitcnt lgkmcnt(4)
    v_mfma_f32_32x32x16_bf16 v[112:127], a[224:227], v[208:211], v[112:127]
    ds_read_b64_tr_b16 v[200:201], v2 offset:4096
    v_mfma_f32_32x32x16_bf16 v[128:143], a[228:231], v[208:211], v[128:143]
    ds_read_b64_tr_b16 v[202:203], v2 offset:4608
    v_mfma_f32_32x32x16_bf16 v[112:127], a[232:235], v[212:215], v[112:127]
    ds_read_b64_tr_b16 v[204:205], v2 offset:6144
    v_mfma_f32_32x32x16_bf16 v[128:143], a[236:239], v[212:215], v[128:143]
    ds_read_b64_tr_b16 v[206:207], v2 offset:6656
    s_waitcnt lgkmcnt(4)
    v_mfma_f32_32x32x16_bf16 v[112:127], a[240:243], v[192:195], v[112:127]
    ds_read_b64_tr_b16 v[208:209], v2 offset:8192
    v_mfma_f32_32x32x16_bf16 v[128:143], a[244:247], v[192:195], v[128:143]
    ds_read_b64_tr_b16 v[210:211], v2 offset:8704
    v_mfma_f32_32x32x16_bf16 v[112:127], a[248:251], v[196:199], v[112:127]
    ds_read_b64_tr_b16 v[212:213], v2 offset:10240
    v_mfma_f32_32x32x16_bf16 v[128:143], a[252:255], v[196:199], v[128:143]
    ds_read_b64_tr_b16 v[214:215], v2 offset:10752
    s_waitcnt lgkmcnt(4)
    v_mfma_f32_32x32x16_bf16 v[112:127], v[160:163], v[200:203], v[112:127]
    s_waitcnt vmcnt(7)
    s_barrier
    ds_read_b64_tr_b16 v[192:193], v1 offset:24576
    v_mfma_f32_32x32x16_bf16 v[128:143], v[164:167], v[200:203], v[128:143]
    ds_read_b64_tr_b16 v[194:195], v1 offset:25088
    v_mfma_f32_32x32x16_bf16 v[112:127], v[168:171], v[204:207], v[112:127]
    ds_read_b64_tr_b16 v[196:197], v1 offset:26624
    v_mfma_f32_32x32x16_bf16 v[128:143], v[172:175], v[204:207], v[128:143]
    ds_read_b64_tr_b16 v[198:199], v1 offset:27136
    s_waitcnt vmcnt(4)
    v_mov_b32 v222, 1
    buffer_atomic_add v222, v252, s[28:31], s63 offen
    s_waitcnt lgkmcnt(4)
    v_mfma_f32_32x32x16_bf16 v[112:127], v[176:179], v[208:211], v[112:127]
    ds_read_b64_tr_b16 v[200:201], v1 offset:28672
    v_mfma_f32_32x32x16_bf16 v[128:143], v[180:183], v[208:211], v[128:143]
    ds_read_b64_tr_b16 v[202:203], v1 offset:29184
    v_mfma_f32_32x32x16_bf16 v[112:127], v[184:187], v[212:215], v[112:127]
    ds_read_b64_tr_b16 v[204:205], v1 offset:30720
    v_mfma_f32_32x32x16_bf16 v[128:143], v[188:191], v[212:215], v[128:143]
    ds_read_b64_tr_b16 v[206:207], v1 offset:31232
    s_waitcnt lgkmcnt(4)
    v_mfma_f32_32x32x16_bf16 v[48:63], v[192:195], a[0:3], 0
    ds_read_b64_tr_b16 v[208:209], v1 offset:32768
    v_mfma_f32_32x32x16_bf16 v[64:79], v[192:195], a[4:7], 0
    ds_read_b64_tr_b16 v[210:211], v1 offset:33280
    v_mfma_f32_32x32x16_bf16 v[48:63], v[196:199], a[8:11], v[48:63]
    ds_read_b64_tr_b16 v[212:213], v1 offset:34816
    s_nop 1
    v_cvt_pk_bf16_f32 v236, v112, v113
    v_cvt_pk_bf16_f32 v237, v114, v115
    v_cvt_pk_bf16_f32 v238, v116, v117
    v_cvt_pk_bf16_f32 v239, v118, v119
    s_add_u32 s51, s57, 0
    v_mfma_f32_32x32x16_bf16 v[64:79], v[196:199], a[12:15], v[64:79]
    ds_read_b64_tr_b16 v[214:215], v1 offset:35328
    buffer_store_dwordx4 v[236:239], v12, s[24:27], s51 offen offset:512 sc1
    v_cvt_pk_bf16_f32 v240, v120, v121
    v_cvt_pk_bf16_f32 v241, v122, v123
    v_cvt_pk_bf16_f32 v242, v124, v125
    s_waitcnt lgkmcnt(4)
    v_mfma_f32_32x32x16_bf16 v[48:63], v[200:203], a[16:19], v[48:63]
    ds_read_b64_tr_b16 v[192:193], v1 offset:36864
    v_cvt_pk_bf16_f32 v243, v126, v127
    s_add_u32 s51, s57, 18688
    buffer_store_dwordx4 v[240:243], v12, s[24:27], s51 offen offset:512 sc1
    v_cvt_pk_bf16_f32 v232, v128, v129
    v_cvt_pk_bf16_f32 v233, v130, v131
    v_mfma_f32_32x32x16_bf16 v[64:79], v[200:203], a[20:23], v[64:79]
    ds_read_b64_tr_b16 v[194:195], v1 offset:37376
    v_cvt_pk_bf16_f32 v234, v132, v133
    v_cvt_pk_bf16_f32 v235, v134, v135
    s_add_u32 s51, s58, 0
    buffer_store_dwordx4 v[232:235], v12, s[24:27], s51 offen offset:512 sc1
    v_cvt_pk_bf16_f32 v236, v136, v137
    v_mfma_f32_32x32x16_bf16 v[48:63], v[204:207], a[24:27], v[48:63]
    ds_read_b64_tr_b16 v[196:197], v1 offset:38912
    v_cvt_pk_bf16_f32 v237, v138, v139
    v_cvt_pk_bf16_f32 v238, v140, v141
    v_cvt_pk_bf16_f32 v239, v142, v143
    s_add_u32 s51, s58, 18688
    buffer_store_dwordx4 v[236:239], v12, s[24:27], s51 offen offset:512 sc1
    v_mfma_f32_32x32x16_bf16 v[64:79], v[204:207], a[28:31], v[64:79]
    ds_read_b64_tr_b16 v[198:199], v1 offset:39424
    s_waitcnt lgkmcnt(4)
    v_mfma_f32_32x32x16_bf16 v[48:63], v[208:211], a[32:35], v[48:63]
    ds_read_b64_tr_b16 v[200:201], v1 offset:40960
    v_mfma_f32_32x32x16_bf16 v[64:79], v[208:211], a[36:39], v[64:79]
    ds_read_b64_tr_b16 v[202:203], v1 offset:41472
    v_mfma_f32_32x32x16_bf16 v[48:63], v[212:215], a[40:43], v[48:63]
    ds_read_b64_tr_b16 v[204:205], v1 offset:43008
    v_mfma_f32_32x32x16_bf16 v[64:79], v[212:215], a[44:47], v[64:79]
    ds_read_b64_tr_b16 v[206:207], v1 offset:43520
    s_waitcnt lgkmcnt(4)
    v_mfma_f32_32x32x16_bf16 v[48:63], v[192:195], a[48:51], v[48:63]
    ds_read_b64_tr_b16 v[208:209], v1 offset:45056
    v_mfma_f32_32x32x16_bf16 v[64:79], v[192:195], a[52:55], v[64:79]
    ds_read_b64_tr_b16 v[210:211], v1 offset:45568
    v_mfma_f32_32x32x16_bf16 v[48:63], v[196:199], a[56:59], v[48:63]
    ds_read_b64_tr_b16 v[212:213], v1 offset:47104
    v_mfma_f32_32x32x16_bf16 v[64:79], v[196:199], a[60:63], v[64:79]
    ds_read_b64_tr_b16 v[214:215], v1 offset:47616
    s_waitcnt lgkmcnt(4)
    v_mfma_f32_32x32x16_bf16 v[48:63], v[200:203], a[64:67], v[48:63]
    ds_read_b64_tr_b16 v[192:193], v1 offset:49152
    v_mfma_f32_32x32x16_bf16 v[64:79], v[200:203], a[68:71], v[64:79]
    ds_read_b64_tr_b16 v[194:195], v1 offset:49664
    v_mfma_f32_32x32x16_bf16 v[48:63], v[204:207], a[72:75], v[48:63]
    ds_read_b64_tr_b16 v[196:197], v1 offset:51200
    v_mfma_f32_32x32x16_bf16 v[64:79], v[204:207], a[76:79], v[64:79]
    ds_read_b64_tr_b16 v[198:199], v1 offset:51712
    s_waitcnt lgkmcnt(4)
    v_mfma_f32_32x32x16_bf16 v[48:63], v[208:211], a[80:83], v[48:63]
    ds_read_b64_tr_b16 v[200:201], v1 offset:53248
    v_mfma_f32_32x32x16_bf16 v[64:79], v[208:211], a[84:87], v[64:79]
    ds_read_b64_tr_b16 v[202:203], v1 offset:53760
    v_mfma_f32_32x32x16_bf16 v[48:63], v[212:215], a[88:91], v[48:63]
    ds_read_b64_tr_b16 v[204:205], v1 offset:55296
    v_mfma_f32_32x32x16_bf16 v[64:79], v[212:215], a[92:95], v[64:79]
    ds_read_b64_tr_b16 v[206:207], v1 offset:55808
    s_waitcnt lgkmcnt(4)
    v_mfma_f32_32x32x16_bf16 v[48:63], v[192:195], a[96:99], v[48:63]
    ds_read_b64_tr_b16 v[208:209], v1 offset:57344
    v_mfma_f32_32x32x16_bf16 v[64:79], v[192:195], a[100:103], v[64:79]
    ds_read_b64_tr_b16 v[210:211], v1 offset:57856
    v_mfma_f32_32x32x16_bf16 v[48:63], v[196:199], a[104:107], v[48:63]
    ds_read_b64_tr_b16 v[212:213], v1 offset:59392
    v_mfma_f32_32x32x16_bf16 v[64:79], v[196:199], a[108:111], v[64:79]
    ds_read_b64_tr_b16 v[214:215], v1 offset:59904
    v_mov_b32 v253, 0
    buffer_atomic_add v253, v252, s[28:31], s63 offen sc0
    s_waitcnt lgkmcnt(4)
    v_mfma_f32_32x32x16_bf16 v[48:63], v[200:203], a[112:115], v[48:63]
    ds_read_b64_tr_b16 v[192:193], v4 offset:0
    v_mfma_f32_32x32x16_bf16 v[64:79], v[200:203], a[116:119], v[64:79]
    ds_read_b64_tr_b16 v[194:195], v4 offset:512
    v_mfma_f32_32x32x16_bf16 v[48:63], v[204:207], a[120:123], v[48:63]
    ds_read_b64_tr_b16 v[196:197], v4 offset:2048
    v_mfma_f32_32x32x16_bf16 v[64:79], v[204:207], a[124:127], v[64:79]
    ds_read_b64_tr_b16 v[198:199], v4 offset:2560
    s_waitcnt lgkmcnt(4)
    v_mfma_f32_32x32x16_bf16 v[48:63], v[208:211], a[128:131], v[48:63]
    ds_read_b64_tr_b16 v[200:201], v4 offset:4096
    v_mfma_f32_32x32x16_bf16 v[64:79], v[208:211], a[132:135], v[64:79]
    ds_read_b64_tr_b16 v[202:203], v4 offset:4608
    v_mfma_f32_32x32x16_bf16 v[48:63], v[212:215], a[136:139], v[48:63]
    ds_read_b64_tr_b16 v[204:205], v4 offset:6144
    v_mfma_f32_32x32x16_bf16 v[64:79], v[212:215], a[140:143], v[64:79]
    ds_read_b64_tr_b16 v[206:207], v4 offset:6656
    s_waitcnt lgkmcnt(4)
    v_mfma_f32_32x32x16_bf16 v[48:63], v[192:195], a[144:147], v[48:63]
    ds_read_b64_tr_b16 v[208:209], v4 offset:8192
    v_mfma_f32_32x32x16_bf16 v[64:79], v[192:195], a[148:151], v[64:79]
    ds_read_b64_tr_b16 v[210:211], v4 offset:8704
    v_mfma_f32_32x32x16_bf16 v[48:63], v[196:199], a[152:155], v[48:63]
    ds_read_b64_tr_b16 v[212:213], v4 offset:10240
    v_mfma_f32_32x32x16_bf16 v[64:79], v[196:199], a[156:159], v[64:79]
    ds_read_b64_tr_b16 v[214:215], v4 offset:10752
    s_waitcnt lgkmcnt(4)
    v_mfma_f32_32x32x16_bf16 v[48:63], v[200:203], a[160:163], v[48:63]
    ds_read_b64_tr_b16 v[192:193], v4 offset:12288
    v_mfma_f32_32x32x16_bf16 v[64:79], v[200:203], a[164:167], v[64:79]
    ds_read_b64_tr_b16 v[194:195], v4 offset:12800
    v_mfma_f32_32x32x16_bf16 v[48:63], v[204:207], a[168:171], v[48:63]
    ds_read_b64_tr_b16 v[196:197], v4 offset:14336
    v_mfma_f32_32x32x16_bf16 v[64:79], v[204:207], a[172:175], v[64:79]
    ds_read_b64_tr_b16 v[198:199], v4 offset:14848
    s_waitcnt lgkmcnt(4)
    v_mfma_f32_32x32x16_bf16 v[48:63], v[208:211], a[176:179], v[48:63]
    ds_read_b64_tr_b16 v[200:201], v4 offset:16384
    s_waitcnt vmcnt(0)
    s_mov_b32 s51, 0
k1_kernel_pl1:
    v_readfirstlane_b32 s64, v253
    s_nop 0
    s_and_b32 s64, s64, 255
    s_cmp_ge_u32 s64, 32
    s_cbranch_scc1 k1_kernel_pd2
    s_add_u32 s51, s51, 1
    s_cmp_ge_u32 s51, 100000
    s_cbranch_scc1 k1_kernel_pd2
    s_sleep 4
    v_mov_b32 v253, 0
    buffer_atomic_add v253, v252, s[28:31], s63 offen sc0
    s_waitcnt vmcnt(0)
    s_branch k1_kernel_pl1
k1_kernel_pd2:
    v_mfma_f32_32x32x16_bf16 v[64:79], v[208:211], a[180:183], v[64:79]
    ds_read_b64_tr_b16 v[202:203], v4 offset:16896
    buffer_load_dword v216, v13, s[28:31], s59 offen offset:0 sc1
    buffer_load_dword v218, v13, s[28:31], s59 offen offset:256 sc1
    v_mfma_f32_32x32x16_bf16 v[48:63], v[212:215], a[184:187], v[48:63]
    ds_read_b64_tr_b16 v[204:205], v4 offset:18432
    s_barrier
    v_mov_b32 v222, 1
    buffer_atomic_add v222, v251, s[28:31], 0 offen
    v_mfma_f32_32x32x16_bf16 v[64:79], v[212:215], a[188:191], v[64:79]
    ds_read_b64_tr_b16 v[206:207], v4 offset:18944
    s_waitcnt lgkmcnt(4)
    v_mfma_f32_32x32x16_bf16 v[48:63], v[192:195], a[192:195], v[48:63]
    ds_read_b64_tr_b16 v[208:209], v4 offset:20480
    v_mfma_f32_32x32x16_bf16 v[64:79], v[192:195], a[196:199], v[64:79]
    ds_read_b64_tr_b16 v[210:211], v4 offset:20992
    v_mfma_f32_32x32x16_bf16 v[48:63], v[196:199], a[200:203], v[48:63]
    ds_read_b64_tr_b16 v[212:213], v4 offset:22528
    v_mfma_f32_32x32x16_bf16 v[64:79], v[196:199], a[204:207], v[64:79]
    ds_read_b64_tr_b16 v[214:215], v4 offset:23040
    s_waitcnt lgkmcnt(4)
    v_mfma_f32_32x32x16_bf16 v[48:63], v[200:203], a[208:211], v[48:63]
    ds_read_b64_tr_b16 v[192:193], v4 offset:24576
    v_mfma_f32_32x32x16_bf16 v[64:79], v[200:203], a[212:215], v[64:79]
    ds_read_b64_tr_b16 v[194:195], v4 offset:25088
    v_mfma_f32_32x32x16_bf16 v[48:63], v[204:207], a[216:219], v[48:63]
    ds_read_b64_tr_b16 v[196:197], v4 offset:26624
    v_mfma_f32_32x32x16_bf16 v[64:79], v[204:207], a[220:223], v[64:79]
    ds_read_b64_tr_b16 v[198:199], v4 offset:27136
    s_waitcnt lgkmcnt(4)
    v_mfma_f32_32x32x16_bf16 v[48:63], v[208:211], a[224:227], v[48:63]
    ds_read_b64_tr_b16 v[200:201], v4 offset:28672
    v_mfma_f32_32x32x16_bf16 v[64:79], v[208:211], a[228:231], v[64:79]
    ds_read_b64_tr_b16 v[202:203], v4 offset:29184
    v_mfma_f32_32x32x16_bf16 v[48:63], v[212:215], a[232:235], v[48:63]
    ds_read_b64_tr_b16 v[204:205], v4 offset:30720
    v_mfma_f32_32x32x16_bf16 v[64:79], v[212:215], a[236:239], v[64:79]
    ds_read_b64_tr_b16 v[206:207], v4 offset:31232
    s_waitcnt lgkmcnt(4)
    v_mfma_f32_32x32x16_bf16 v[48:63], v[192:195], a[240:243], v[48:63]
    ds_read_b64_tr_b16 v[208:209], v4 offset:32768
    s_waitcnt vmcnt(2)
    v_mov_b32 v217, v216
    s_waitcnt vmcnt(1)
    v_mov_b32 v219, v218
    v_mfma_f32_32x32x16_bf16 v[64:79], v[192:195], a[244:247], v[64:79]
    ds_read_b64_tr_b16 v[210:211], v4 offset:33280
    v_mov_b32 v244, 0x361367a4
    v_mov_b32 v248, 0x361367a4
    v_permlane32_swap_b32 v216, v217
    v_permlane32_swap_b32 v218, v219
    v_mul_f32 v216, 0x39e38e39, v216
    v_mfma_f32_32x32x16_bf16 v[48:63], v[196:199], a[248:251], v[48:63]
    ds_read_b64_tr_b16 v[212:213], v4 offset:34816
    v_mul_f32 v218, 0x39e38e39, v218
    v_fmac_f32 v244, 0x39e38e39, v217
    v_fmac_f32 v248, 0x39e38e39, v219
    v_fma_f32 v244, -v216, v216, v244
    v_fma_f32 v248, -v218, v218, v248
    v_mfma_f32_32x32x16_bf16 v[64:79], v[196:199], a[252:255], v[64:79]
    ds_read_b64_tr_b16 v[214:215], v4 offset:35328
    v_max_f32 v244, 0x361367a4, v244
    v_max_f32 v248, 0x361367a4, v248
    v_rsq_f32 v244, v244
    s_waitcnt lgkmcnt(4)
    v_mfma_f32_32x32x16_bf16 v[48:63], v[200:203], v[160:163], v[48:63]
    ds_read_b64_tr_b16 v[192:193], v2 offset:24576
    v_rsq_f32 v248, v248
    v_mul_f32 v244, 0x40088e99, v244
    v_mul_f32 v248, 0x40088e99, v248
    v_mul_f32 v246, -v216, v244
    v_mfma_f32_32x32x16_bf16 v[64:79], v[200:203], v[164:167], v[64:79]
    ds_read_b64_tr_b16 v[194:195], v2 offset:25088
    v_mul_f32 v250, -v218, v248
    v_lshlrev_b32 v152, 16, v16
    v_and_b32 v153, s62, v16
    v_lshlrev_b32 v154, 16, v17
    v_and_b32 v155, s62, v17
    v_lshlrev_b32 v156, 16, v18
    v_mfma_f32_32x32x16_bf16 v[48:63], v[204:207], v[168:171], v[48:63]
    ds_read_b64_tr_b16 v[196:197], v2 offset:26624
    v_and_b32 v157, s62, v18
    v_lshlrev_b32 v158, 16, v19
    v_and_b32 v159, s62, v19
    v_fma_f32 v152, v152, v244, v246
    v_fma_f32 v153, v153, v244, v246
    v_fma_f32 v154, v154, v244, v246
    v_mfma_f32_32x32x16_bf16 v[64:79], v[204:207], v[172:175], v[64:79]
    ds_read_b64_tr_b16 v[198:199], v2 offset:27136
    v_fma_f32 v155, v155, v244, v246
    v_fma_f32 v156, v156, v244, v246
    v_fma_f32 v157, v157, v244, v246
    v_fma_f32 v158, v158, v244, v246
    v_fma_f32 v159, v159, v244, v246
    s_waitcnt lgkmcnt(4)
    v_mfma_f32_32x32x16_bf16 v[48:63], v[208:211], v[176:179], v[48:63]
    ds_read_b64_tr_b16 v[200:201], v2 offset:28672
    v_cvt_pk_bf16_f32 v16, v152, v153
    v_cvt_pk_bf16_f32 v17, v154, v155
    v_cvt_pk_bf16_f32 v18, v156, v157
    v_cvt_pk_bf16_f32 v19, v158, v159
    buffer_store_dwordx4 v[16:19], v11, s[20:23], s54 offen offset:0 sc1
    v_lshlrev_b32 v152, 16, v20
    v_mfma_f32_32x32x16_bf16 v[64:79], v[208:211], v[180:183], v[64:79]
    ds_read_b64_tr_b16 v[202:203], v2 offset:29184
    v_and_b32 v153, s62, v20
    v_lshlrev_b32 v154, 16, v21
    v_and_b32 v155, s62, v21
    v_lshlrev_b32 v156, 16, v22
    v_and_b32 v157, s62, v22
    v_lshlrev_b32 v158, 16, v23
    v_mfma_f32_32x32x16_bf16 v[48:63], v[212:215], v[184:187], v[48:63]
    ds_read_b64_tr_b16 v[204:205], v2 offset:30720
    v_and_b32 v159, s62, v23
    v_fma_f32 v152, v152, v244, v246
    v_fma_f32 v153, v153, v244, v246
    v_fma_f32 v154, v154, v244, v246
    v_fma_f32 v155, v155, v244, v246
    v_fma_f32 v156, v156, v244, v246
    v_mfma_f32_32x32x16_bf16 v[64:79], v[212:215], v[188:191], v[64:79]
    ds_read_b64_tr_b16 v[206:207], v2 offset:31232
    v_fma_f32 v157, v157, v244, v246
    v_fma_f32 v158, v158, v244, v246
    v_fma_f32 v159, v159, v244, v246
    v_cvt_pk_bf16_f32 v20, v152, v153
    v_cvt_pk_bf16_f32 v21, v154, v155
    s_waitcnt lgkmcnt(4)
    v_mfma_f32_32x32x16_bf16 v[80:95], v[192:195], a[0:3], 0
    ds_read_b64_tr_b16 v[208:209], v2 offset:32768
    v_cvt_pk_bf16_f32 v22, v156, v157
    v_cvt_pk_bf16_f32 v23, v158, v159
    buffer_store_dwordx4 v[20:23], v11, s[20:23], s54 offen offset:256 sc1
    v_lshlrev_b32 v152, 16, v24
    v_and_b32 v153, s62, v24
    v_lshlrev_b32 v154, 16, v25
    v_mfma_f32_32x32x16_bf16 v[96:111], v[192:195], a[4:7], 0
    ds_read_b64_tr_b16 v[210:211], v2 offset:33280
    v_and_b32 v155, s62, v25
    v_lshlrev_b32 v156, 16, v26
    v_and_b32 v157, s62, v26
    v_lshlrev_b32 v158, 16, v27
    v_and_b32 v159, s62, v27
    v_fma_f32 v152, v152, v248, v250
    v_mfma_f32_32x32x16_bf16 v[80:95], v[196:199], a[8:11], v[80:95]
    ds_read_b64_tr_b16 v[212:213], v2 offset:34816
    v_fma_f32 v153, v153, v248, v250
    v_fma_f32 v154, v154, v248, v250
    v_fma_f32 v155, v155, v248, v250
    v_fma_f32 v156, v156, v248, v250
    v_fma_f32 v157, v157, v248, v250
    v_fma_f32 v158, v158, v248, v250
    v_mfma_f32_32x32x16_bf16 v[96:111], v[196:199], a[12:15], v[96:111]
    ds_read_b64_tr_b16 v[214:215], v2 offset:35328
    v_fma_f32 v159, v159, v248, v250
    v_cvt_pk_bf16_f32 v24, v152, v153
    v_cvt_pk_bf16_f32 v25, v154, v155
    v_cvt_pk_bf16_f32 v26, v156, v157
    v_cvt_pk_bf16_f32 v27, v158, v159
    s_waitcnt lgkmcnt(4)
    v_mfma_f32_32x32x16_bf16 v[80:95], v[200:203], a[16:19], v[80:95]
    ds_read_b64_tr_b16 v[192:193], v2 offset:36864
    buffer_store_dwordx4 v[24:27], v11, s[20:23], s55 offen offset:0 sc1
    v_lshlrev_b32 v152, 16, v28
    v_and_b32 v153, s62, v28
    v_lshlrev_b32 v154, 16, v29
    v_and_b32 v155, s62, v29
    v_lshlrev_b32 v156, 16, v30
    v_mfma_f32_32x32x16_bf16 v[96:111], v[200:203], a[20:23], v[96:111]
    ds_read_b64_tr_b16 v[194:195], v2 offset:37376
    v_and_b32 v157, s62, v30
    v_lshlrev_b32 v158, 16, v31
    v_and_b32 v159, s62, v31
    v_fma_f32 v152, v152, v248, v250
    v_fma_f32 v153, v153, v248, v250
    v_fma_f32 v154, v154, v248, v250
    v_mfma_f32_32x32x16_bf16 v[80:95], v[204:207], a[24:27], v[80:95]
    ds_read_b64_tr_b16 v[196:197], v2 offset:38912
    v_fma_f32 v155, v155, v248, v250
    v_fma_f32 v156, v156, v248, v250
    v_fma_f32 v157, v157, v248, v250
    v_fma_f32 v158, v158, v248, v250
    v_fma_f32 v159, v159, v248, v250
    v_cvt_pk_bf16_f32 v28, v152, v153
    v_mfma_f32_32x32x16_bf16 v[96:111], v[204:207], a[28:31], v[96:111]
    ds_read_b64_tr_b16 v[198:199], v2 offset:39424
    v_cvt_pk_bf16_f32 v29, v154, v155
    v_cvt_pk_bf16_f32 v30, v156, v157
    v_cvt_pk_bf16_f32 v31, v158, v159
    buffer_store_dwordx4 v[28:31], v11, s[20:23], s55 offen offset:256 sc1
    v_lshlrev_b32 v152, 16, v32
    s_waitcnt lgkmcnt(4)
    v_mfma_f32_32x32x16_bf16 v[80:95], v[208:211], a[32:35], v[80:95]
    ds_read_b64_tr_b16 v[200:201], v2 offset:40960
    v_and_b32 v153, s62, v32
    v_lshlrev_b32 v154, 16, v33
    v_and_b32 v155, s62, v33
    v_lshlrev_b32 v156, 16, v34
    v_and_b32 v157, s62, v34
    v_lshlrev_b32 v158, 16, v35
    v_mfma_f32_32x32x16_bf16 v[96:111], v[208:211], a[36:39], v[96:111]
    ds_read_b64_tr_b16 v[202:203], v2 offset:41472
    v_and_b32 v159, s62, v35
    v_fma_f32 v152, v152, v244, v246
    v_fma_f32 v153, v153, v244, v246
    v_fma_f32 v154, v154, v244, v246
    v_fma_f32 v155, v155, v244, v246
    v_fma_f32 v156, v156, v244, v246
    v_mfma_f32_32x32x16_bf16 v[80:95], v[212:215], a[40:43], v[80:95]
    ds_read_b64_tr_b16 v[204:205], v2 offset:43008
    v_fma_f32 v157, v157, v244, v246
    v_fma_f32 v158, v158, v244, v246
    v_fma_f32 v159, v159, v244, v246
    v_cvt_pk_bf16_f32 v32, v152, v153
    v_cvt_pk_bf16_f32 v33, v154, v155
    v_cvt_pk_bf16_f32 v34, v156, v157
    v_mfma_f32_32x32x16_bf16 v[96:111], v[212:215], a[44:47], v[96:111]
    ds_read_b64_tr_b16 v[206:207], v2 offset:43520
    v_cvt_pk_bf16_f32 v35, v158, v159
    buffer_store_dwordx4 v[32:35], v11, s[20:23], s54 offen offset:1024 sc1
    v_lshlrev_b32 v152, 16, v36
    v_and_b32 v153, s62, v36
    v_lshlrev_b32 v154, 16, v37
    s_waitcnt lgkmcnt(4)
    v_mfma_f32_32x32x16_bf16 v[80:95], v[192:195], a[48:51], v[80:95]
    ds_read_b64_tr_b16 v[208:209], v2 offset:45056
    v_and_b32 v155, s62, v37
    v_lshlrev_b32 v156, 16, v38
    v_and_b32 v157, s62, v38
    v_lshlrev_b32 v158, 16, v39
    v_and_b32 v159, s62, v39
    v_fma_f32 v152, v152, v244, v246
    v_mfma_f32_32x32x16_bf16 v[96:111], v[192:195], a[52:55], v[96:111]
    ds_read_b64_tr_b16 v[210:211], v2 offset:45568
    v_fma_f32 v153, v153, v244, v246
    v_fma_f32 v154, v154, v244, v246
    v_fma_f32 v155, v155, v244, v246
    v_fma_f32 v156, v156, v244, v246
    v_fma_f32 v157, v157, v244, v246
    v_fma_f32 v158, v158, v244, v246
    v_mfma_f32_32x32x16_bf16 v[80:95], v[196:199], a[56:59], v[80:95]
    ds_read_b64_tr_b16 v[212:213], v2 offset:47104
    v_fma_f32 v159, v159, v244, v246
    v_cvt_pk_bf16_f32 v36, v152, v153
    v_cvt_pk_bf16_f32 v37, v154, v155
    v_cvt_pk_bf16_f32 v38, v156, v157
    v_cvt_pk_bf16_f32 v39, v158, v159
    buffer_store_dwordx4 v[36:39], v11, s[20:23], s54 offen offset:1280 sc1
    v_mfma_f32_32x32x16_bf16 v[96:111], v[196:199], a[60:63], v[96:111]
    ds_read_b64_tr_b16 v[214:215], v2 offset:47616
    v_lshlrev_b32 v152, 16, v40
    v_and_b32 v153, s62, v40
    v_lshlrev_b32 v154, 16, v41
    v_and_b32 v155, s62, v41
    v_lshlrev_b32 v156, 16, v42
    s_waitcnt lgkmcnt(4)
    v_mfma_f32_32x32x16_bf16 v[80:95], v[200:203], a[64:67], v[80:95]
    ds_read_b64_tr_b16 v[192:193], v2 offset:49152
    v_and_b32 v157, s62, v42
    v_lshlrev_b32 v158, 16, v43
    v_and_b32 v159, s62, v43
    v_fma_f32 v152, v152, v248, v250
    v_fma_f32 v153, v153, v248, v250
    v_fma_f32 v154, v154, v248, v250
    v_mfma_f32_32x32x16_bf16 v[96:111], v[200:203], a[68:71], v[96:111]
    ds_read_b64_tr_b16 v[194:195], v2 offset:49664
    v_fma_f32 v155, v155, v248, v250
    v_fma_f32 v156, v156, v248, v250
    v_fma_f32 v157, v157, v248, v250
    v_fma_f32 v158, v158, v248, v250
    v_fma_f32 v159, v159, v248, v250
    v_cvt_pk_bf16_f32 v40, v152, v153
    v_mfma_f32_32x32x16_bf16 v[80:95], v[204:207], a[72:75], v[80:95]
    ds_read_b64_tr_b16 v[196:197], v2 offset:51200
    v_cvt_pk_bf16_f32 v41, v154, v155
    v_cvt_pk_bf16_f32 v42, v156, v157
    v_cvt_pk_bf16_f32 v43, v158, v159
    buffer_store_dwordx4 v[40:43], v11, s[20:23], s55 offen offset:1024 sc1
    v_lshlrev_b32 v152, 16, v44
    v_and_b32 v153, s62, v44
    v_mfma_f32_32x32x16_bf16 v[96:111], v[204:207], a[76:79], v[96:111]
    ds_read_b64_tr_b16 v[198:199], v2 offset:51712
    v_lshlrev_b32 v154, 16, v45
    v_and_b32 v155, s62, v45
    v_lshlrev_b32 v156, 16, v46
    v_and_b32 v157, s62, v46
    v_lshlrev_b32 v158, 16, v47
    s_waitcnt lgkmcnt(4)
    v_mfma_f32_32x32x16_bf16 v[80:95], v[208:211], a[80:83], v[80:95]
    ds_read_b64_tr_b16 v[200:201], v2 offset:53248
    v_and_b32 v159, s62, v47
    v_fma_f32 v152, v152, v248, v250
    v_fma_f32 v153, v153, v248, v250
    v_fma_f32 v154, v154, v248, v250
    v_fma_f32 v155, v155, v248, v250
    v_fma_f32 v156, v156, v248, v250
    v_mfma_f32_32x32x16_bf16 v[96:111], v[208:211], a[84:87], v[96:111]
    ds_read_b64_tr_b16 v[202:203], v2 offset:53760
    v_fma_f32 v157, v157, v248, v250
    v_fma_f32 v158, v158, v248, v250
    v_fma_f32 v159, v159, v248, v250
    v_cvt_pk_bf16_f32 v44, v152, v153
    v_cvt_pk_bf16_f32 v45, v154, v155
    v_cvt_pk_bf16_f32 v46, v156, v157
    v_mfma_f32_32x32x16_bf16 v[80:95], v[212:215], a[88:91], v[80:95]
    ds_read_b64_tr_b16 v[204:205], v2 offset:55296
    v_cvt_pk_bf16_f32 v47, v158, v159
    buffer_store_dwordx4 v[44:47], v11, s[20:23], s55 offen offset:1280 sc1
    v_lshlrev_b32 v152, 16, v144
    v_and_b32 v153, s62, v144
    v_lshlrev_b32 v154, 16, v145
    v_and_b32 v155, s62, v145
    v_mfma_f32_32x32x16_bf16 v[96:111], v[212:215], a[92:95], v[96:111]
    ds_read_b64_tr_b16 v[206:207], v2 offset:55808
    v_lshlrev_b32 v156, 16, v146
    v_and_b32 v157, s62, v146
    v_lshlrev_b32 v158, 16, v147
    v_and_b32 v159, s62, v147
    v_fma_f32 v152, v152, v244, v246
    s_waitcnt lgkmcnt(4)
    v_mfma_f32_32x32x16_bf16 v[80:95], v[192:195], a[96:99], v[80:95]
    ds_read_b64_tr_b16 v[208:209], v2 offset:57344
    v_fma_f32 v153, v153, v244, v246
    v_fma_f32 v154, v154, v244, v246
    v_fma_f32 v155, v155, v244, v246
    v_fma_f32 v156, v156, v244, v246
    v_fma_f32 v157, v157, v244, v246
    v_fma_f32 v158, v158, v244, v246
    v_mfma_f32_32x32x16_bf16 v[96:111], v[192:195], a[100:103], v[96:111]
    ds_read_b64_tr_b16 v[210:211], v2 offset:57856
    v_fma_f32 v159, v159, v244, v246
    v_cvt_pk_bf16_f32 v144, v152, v153
    v_cvt_pk_bf16_f32 v145, v154, v155
    v_cvt_pk_bf16_f32 v146, v156, v157
    v_cvt_pk_bf16_f32 v147, v158, v159
    buffer_store_dwordx4 v[144:147], v11, s[36:39], s56 offen offset:0 sc1
    v_mfma_f32_32x32x16_bf16 v[80:95], v[196:199], a[104:107], v[80:95]
    ds_read_b64_tr_b16 v[212:213], v2 offset:59392
    v_lshlrev_b32 v152, 16, v148
    v_and_b32 v153, s62, v148
    v_lshlrev_b32 v154, 16, v149
    v_and_b32 v155, s62, v149
    v_lshlrev_b32 v156, 16, v150
    v_and_b32 v157, s62, v150
    v_mfma_f32_32x32x16_bf16 v[96:111], v[196:199], a[108:111], v[96:111]
    ds_read_b64_tr_b16 v[214:215], v2 offset:59904
    v_lshlrev_b32 v158, 16, v151
    v_and_b32 v159, s62, v151
    v_fma_f32 v152, v152, v244, v246
    v_fma_f32 v153, v153, v244, v246
    v_fma_f32 v154, v154, v244, v246
    s_waitcnt lgkmcnt(4)
    v_mfma_f32_32x32x16_bf16 v[80:95], v[200:203], a[112:115], v[80:95]
    ds_read_b64_tr_b16 v[192:193], v5 offset:0
    v_fma_f32 v155, v155, v244, v246
    v_fma_f32 v156, v156, v244, v246
    v_fma_f32 v157, v157, v244, v246
    v_fma_f32 v158, v158, v244, v246
    v_fma_f32 v159, v159, v244, v246
    v_cvt_pk_bf16_f32 v148, v152, v153
    v_mfma_f32_32x32x16_bf16 v[96:111], v[200:203], a[116:119], v[96:111]
    ds_read_b64_tr_b16 v[194:195], v5 offset:512
    v_cvt_pk_bf16_f32 v149, v154, v155
    v_cvt_pk_bf16_f32 v150, v156, v157
    v_cvt_pk_bf16_f32 v151, v158, v159
    buffer_store_dwordx4 v[148:151], v11, s[36:39], s56 offen offset:256 sc1
    v_fma_f32 v224, -v48, v48, -s52
    v_fma_f32 v225, -v49, v49, -s52
    v_mfma_f32_32x32x16_bf16 v[80:95], v[204:207], a[120:123], v[80:95]
    ds_read_b64_tr_b16 v[196:197], v5 offset:2048
    v_fma_f32 v226, -v50, v50, -s52
    v_fma_f32 v227, -v51, v51, -s52
    v_mul_f32 v224, v224, v48
    v_mul_f32 v225, v225, v49
    v_mul_f32 v226, v226, v50
    v_mul_f32 v227, v227, v51
    v_mfma_f32_32x32x16_bf16 v[96:111], v[204:207], a[124:127], v[96:111]
    ds_read_b64_tr_b16 v[198:199], v5 offset:2560
    v_exp_f32 v224, v224
    v_exp_f32 v225, v225
    s_waitcnt lgkmcnt(4)
    v_mfma_f32_32x32x16_bf16 v[80:95], v[208:211], a[128:131], v[80:95]
    ds_read_b64_tr_b16 v[200:201], v5 offset:4096
    v_exp_f32 v226, v226
    v_exp_f32 v227, v227
    v_add_f32 v224, 1.0, v224
    v_add_f32 v225, 1.0, v225
    v_add_f32 v226, 1.0, v226
    v_mfma_f32_32x32x16_bf16 v[96:111], v[208:211], a[132:135], v[96:111]
    ds_read_b64_tr_b16 v[202:203], v5 offset:4608
    v_add_f32 v227, 1.0, v227
    v_rcp_f32 v224, v224
    v_rcp_f32 v225, v225
    v_mfma_f32_32x32x16_bf16 v[80:95], v[212:215], a[136:139], v[80:95]
    ds_read_b64_tr_b16 v[204:205], v5 offset:6144
    v_rcp_f32 v226, v226
    v_rcp_f32 v227, v227
    v_mul_f32 v224, v224, v48
    v_mul_f32 v225, v225, v49
    v_mul_f32 v226, v226, v50
    v_mfma_f32_32x32x16_bf16 v[96:111], v[212:215], a[140:143], v[96:111]
    ds_read_b64_tr_b16 v[206:207], v5 offset:6656
    v_mul_f32 v227, v227, v51
    v_cvt_pk_bf16_f32 v240, v224, v225
    v_cvt_pk_bf16_f32 v241, v226, v227
    v_fma_f32 v228, -v52, v52, -s52
    v_fma_f32 v229, -v53, v53, -s52
    s_waitcnt lgkmcnt(4)
    v_mfma_f32_32x32x16_bf16 v[80:95], v[192:195], a[144:147], v[80:95]
    ds_read_b64_tr_b16 v[208:209], v5 offset:8192
    v_fma_f32 v230, -v54, v54, -s52
    v_fma_f32 v231, -v55, v55, -s52
    v_mul_f32 v228, v228, v52
    v_mul_f32 v229, v229, v53
    v_mul_f32 v230, v230, v54
    v_mul_f32 v231, v231, v55
    v_mfma_f32_32x32x16_bf16 v[96:111], v[192:195], a[148:151], v[96:111]
    ds_read_b64_tr_b16 v[210:211], v5 offset:8704
    v_exp_f32 v228, v228
    v_exp_f32 v229, v229
    v_exp_f32 v230, v230
    v_mfma_f32_32x32x16_bf16 v[80:95], v[196:199], a[152:155], v[80:95]
    ds_read_b64_tr_b16 v[212:213], v5 offset:10240
    v_exp_f32 v231, v231
    v_add_f32 v228, 1.0, v228
    v_add_f32 v229, 1.0, v229
    v_add_f32 v230, 1.0, v230
    v_add_f32 v231, 1.0, v231
    v_mfma_f32_32x32x16_bf16 v[96:111], v[196:199], a[156:159], v[96:111]
    ds_read_b64_tr_b16 v[214:215], v5 offset:10752
    v_rcp_f32 v228, v228
    v_rcp_f32 v229, v229
    s_waitcnt lgkmcnt(4)
    v_mfma_f32_32x32x16_bf16 v[80:95], v[200:203], a[160:163], v[80:95]
    ds_read_b64_tr_b16 v[192:193], v5 offset:12288
    v_rcp_f32 v230, v230
    v_rcp_f32 v231, v231
    v_mul_f32 v228, v228, v52
    v_mul_f32 v229, v229, v53
    v_mul_f32 v230, v230, v54
    v_mfma_f32_32x32x16_bf16 v[96:111], v[200:203], a[164:167], v[96:111]
    ds_read_b64_tr_b16 v[194:195], v5 offset:12800
    v_mul_f32 v231, v231, v55
    v_cvt_pk_bf16_f32 v242, v228, v229
    v_cvt_pk_bf16_f32 v243, v230, v231
    buffer_store_dwordx4 v[240:243], v11, s[16:19], s54 offen offset:0 sc1
    v_fma_f32 v224, -v56, v56, -s52
    v_fma_f32 v225, -v57, v57, -s52
    v_mfma_f32_32x32x16_bf16 v[80:95], v[204:207], a[168:171], v[80:95]
    ds_read_b64_tr_b16 v[196:197], v5 offset:14336
    v_fma_f32 v226, -v58, v58, -s52
    v_fma_f32 v227, -v59, v59, -s52
    v_mul_f32 v224, v224, v56
    v_mul_f32 v225, v225, v57
    v_mul_f32 v226, v226, v58
    v_mul_f32 v227, v227, v59
    v_mfma_f32_32x32x16_bf16 v[96:111], v[204:207], a[172:175], v[96:111]
    ds_read_b64_tr_b16 v[198:199], v5 offset:14848
    v_exp_f32 v224, v224
    v_exp_f32 v225, v225
    s_waitcnt lgkmcnt(4)
    v_mfma_f32_32x32x16_bf16 v[80:95], v[208:211], a[176:179], v[80:95]
    ds_read_b64_tr_b16 v[200:201], v5 offset:16384
    v_exp_f32 v226, v226
    v_exp_f32 v227, v227
    v_add_f32 v224, 1.0, v224
    v_add_f32 v225, 1.0, v225
    v_add_f32 v226, 1.0, v226
    v_mfma_f32_32x32x16_bf16 v[96:111], v[208:211], a[180:183], v[96:111]
    ds_read_b64_tr_b16 v[202:203], v5 offset:16896
    v_add_f32 v227, 1.0, v227
    v_rcp_f32 v224, v224
    v_rcp_f32 v225, v225
    v_mfma_f32_32x32x16_bf16 v[80:95], v[212:215], a[184:187], v[80:95]
    ds_read_b64_tr_b16 v[204:205], v5 offset:18432
    v_rcp_f32 v226, v226
    v_rcp_f32 v227, v227
    v_mul_f32 v224, v224, v56
    v_mul_f32 v225, v225, v57
    v_mul_f32 v226, v226, v58
    v_mfma_f32_32x32x16_bf16 v[96:111], v[212:215], a[188:191], v[96:111]
    ds_read_b64_tr_b16 v[206:207], v5 offset:18944
    v_mul_f32 v227, v227, v59
    v_cvt_pk_bf16_f32 v234, v224, v225
    v_cvt_pk_bf16_f32 v235, v226, v227
    v_fma_f32 v228, -v60, v60, -s52
    v_fma_f32 v229, -v61, v61, -s52
    s_waitcnt lgkmcnt(4)
    v_mfma_f32_32x32x16_bf16 v[80:95], v[192:195], a[192:195], v[80:95]
    ds_read_b64_tr_b16 v[208:209], v5 offset:20480
    v_fma_f32 v230, -v62, v62, -s52
    v_fma_f32 v231, -v63, v63, -s52
    v_mul_f32 v228, v228, v60
    v_mul_f32 v229, v229, v61
    v_mul_f32 v230, v230, v62
    v_mul_f32 v231, v231, v63
    v_mfma_f32_32x32x16_bf16 v[96:111], v[192:195], a[196:199], v[96:111]
    ds_read_b64_tr_b16 v[210:211], v5 offset:20992
    v_exp_f32 v228, v228
    v_exp_f32 v229, v229
    v_exp_f32 v230, v230
    v_mfma_f32_32x32x16_bf16 v[80:95], v[196:199], a[200:203], v[80:95]
    ds_read_b64_tr_b16 v[212:213], v5 offset:22528
    v_exp_f32 v231, v231
    v_add_f32 v228, 1.0, v228
    v_add_f32 v229, 1.0, v229
    v_add_f32 v230, 1.0, v230
    v_add_f32 v231, 1.0, v231
    v_mfma_f32_32x32x16_bf16 v[96:111], v[196:199], a[204:207], v[96:111]
    ds_read_b64_tr_b16 v[214:215], v5 offset:23040
    v_rcp_f32 v228, v228
    v_rcp_f32 v229, v229
    s_waitcnt lgkmcnt(4)
    v_mfma_f32_32x32x16_bf16 v[80:95], v[200:203], a[208:211], v[80:95]
    ds_read_b64_tr_b16 v[192:193], v5 offset:24576
    v_rcp_f32 v230, v230
    v_rcp_f32 v231, v231
    v_mul_f32 v228, v228, v60
    v_mul_f32 v229, v229, v61
    v_mul_f32 v230, v230, v62
    v_mfma_f32_32x32x16_bf16 v[96:111], v[200:203], a[212:215], v[96:111]
    ds_read_b64_tr_b16 v[194:195], v5 offset:25088
    v_mul_f32 v231, v231, v63
    v_cvt_pk_bf16_f32 v232, v228, v229
    v_cvt_pk_bf16_f32 v233, v230, v231
    buffer_store_dwordx4 v[232:235], v11, s[16:19], s54 offen offset:256 sc1
    v_mfma_f32_32x32x16_bf16 v[80:95], v[204:207], a[216:219], v[80:95]
    ds_read_b64_tr_b16 v[196:197], v5 offset:26624
    s_waitcnt vmcnt(2)
    s_barrier
    v_mov_b32 v222, 1
    buffer_atomic_add v222, v6, s[28:31], 0 offen
    v_fma_f32 v224, -v64, v64, -s52
    v_fma_f32 v225, -v65, v65, -s52
    v_fma_f32 v226, -v66, v66, -s52
    v_mfma_f32_32x32x16_bf16 v[96:111], v[204:207], a[220:223], v[96:111]
    ds_read_b64_tr_b16 v[198:199], v5 offset:27136
    v_fma_f32 v227, -v67, v67, -s52
    v_mul_f32 v224, v224, v64
    v_mul_f32 v225, v225, v65
    v_mul_f32 v226, v226, v66
    v_mul_f32 v227, v227, v67
    s_waitcnt lgkmcnt(4)
    v_mfma_f32_32x32x16_bf16 v[80:95], v[208:211], a[224:227], v[80:95]
    ds_read_b64_tr_b16 v[200:201], v5 offset:28672
    v_exp_f32 v224, v224
    v_exp_f32 v225, v225
    v_exp_f32 v226, v226
    v_mfma_f32_32x32x16_bf16 v[96:111], v[208:211], a[228:231], v[96:111]
    ds_read_b64_tr_b16 v[202:203], v5 offset:29184
    v_exp_f32 v227, v227
    v_add_f32 v224, 1.0, v224
    v_add_f32 v225, 1.0, v225
    v_add_f32 v226, 1.0, v226
    v_add_f32 v227, 1.0, v227
    v_mfma_f32_32x32x16_bf16 v[80:95], v[212:215], a[232:235], v[80:95]
    ds_read_b64_tr_b16 v[204:205], v5 offset:30720
    v_rcp_f32 v224, v224
    v_rcp_f32 v225, v225
    v_rcp_f32 v226, v226
    v_mfma_f32_32x32x16_bf16 v[96:111], v[212:215], a[236:239], v[96:111]
    ds_read_b64_tr_b16 v[206:207], v5 offset:31232
    v_rcp_f32 v227, v227
    v_mul_f32 v224, v224, v64
    v_mul_f32 v225, v225, v65
    v_mul_f32 v226, v226, v66
    s_waitcnt lgkmcnt(4)
    v_mfma_f32_32x32x16_bf16 v[80:95], v[192:195], a[240:243], v[80:95]
    ds_read_b64_tr_b16 v[208:209], v5 offset:32768
    v_mul_f32 v227, v227, v67
    v_cvt_pk_bf16_f32 v236, v224, v225
    v_cvt_pk_bf16_f32 v237, v226, v227
    v_fma_f32 v228, -v68, v68, -s52
    v_fma_f32 v229, -v69, v69, -s52
    v_fma_f32 v230, -v70, v70, -s52
    v_mfma_f32_32x32x16_bf16 v[96:111], v[192:195], a[244:247], v[96:111]
    ds_read_b64_tr_b16 v[210:211], v5 offset:33280
    v_fma_f32 v231, -v71, v71, -s52
    v_mul_f32 v228, v228, v68
    v_mul_f32 v229, v229, v69
    v_mul_f32 v230, v230, v70
    v_mul_f32 v231, v231, v71
    v_mfma_f32_32x32x16_bf16 v[80:95], v[196:199], a[248:251], v[80:95]
    ds_read_b64_tr_b16 v[212:213], v5 offset:34816
    v_exp_f32 v228, v228
    v_exp_f32 v229, v229
    v_exp_f32 v230, v230
    v_mfma_f32_32x32x16_bf16 v[96:111], v[196:199], a[252:255], v[96:111]
    ds_read_b64_tr_b16 v[214:215], v5 offset:35328
    v_exp_f32 v231, v231
    v_add_f32 v228, 1.0, v228
    v_add_f32 v229, 1.0, v229
    v_add_f32 v230, 1.0, v230
    v_add_f32 v231, 1.0, v231
    s_waitcnt lgkmcnt(4)
    v_mfma_f32_32x32x16_bf16 v[80:95], v[200:203], v[160:163], v[80:95]
    v_rcp_f32 v228, v228
    v_rcp_f32 v229, v229
    v_rcp_f32 v230, v230
    v_mfma_f32_32x32x16_bf16 v[96:111], v[200:203], v[164:167], v[96:111]
    v_rcp_f32 v231, v231
    v_mul_f32 v228, v228, v68
    v_mul_f32 v229, v229, v69
    v_mul_f32 v230, v230, v70
    v_mul_f32 v231, v231, v71
    v_cvt_pk_bf16_f32 v238, v228, v229
    v_cvt_pk_bf16_f32 v239, v230, v231
    v_mfma_f32_32x32x16_bf16 v[80:95], v[204:207], v[168:171], v[80:95]
    buffer_store_dwordx4 v[236:239], v11, s[16:19], s55 offen offset:0 sc1
    v_fma_f32 v224, -v72, v72, -s52
    v_fma_f32 v225, -v73, v73, -s52
    v_fma_f32 v226, -v74, v74, -s52
    v_fma_f32 v227, -v75, v75, -s52
    v_mul_f32 v224, v224, v72
    v_mul_f32 v225, v225, v73
    v_mfma_f32_32x32x16_bf16 v[96:111], v[204:207], v[172:175], v[96:111]
    v_mul_f32 v226, v226, v74
    v_mul_f32 v227, v227, v75
    v_exp_f32 v224, v224
    v_exp_f32 v225, v225
    s_waitcnt lgkmcnt(0)
    v_mfma_f32_32x32x16_bf16 v[80:95], v[208:211], v[176:179], v[80:95]
    v_exp_f32 v226, v226
    v_exp_f32 v227, v227
    v_add_f32 v224, 1.0, v224
    v_add_f32 v225, 1.0, v225
    v_add_f32 v226, 1.0, v226
    v_mfma_f32_32x32x16_bf16 v[96:111], v[208:211], v[180:183], v[96:111]
    v_add_f32 v227, 1.0, v227
    v_rcp_f32 v224, v224
    v_rcp_f32 v225, v225
    v_rcp_f32 v226, v226
    v_mfma_f32_32x32x16_bf16 v[80:95], v[212:215], v[184:187], v[80:95]
    v_rcp_f32 v227, v227
    v_mul_f32 v224, v224, v72
    v_mul_f32 v225, v225, v73
    v_mul_f32 v226, v226, v74
    v_mul_f32 v227, v227, v75
    v_cvt_pk_bf16_f32 v242, v224, v225
    v_mfma_f32_32x32x16_bf16 v[96:111], v[212:215], v[188:191], v[96:111]
    v_cvt_pk_bf16_f32 v243, v226, v227
    v_fma_f32 v228, -v76, v76, -s52
    v_fma_f32 v229, -v77, v77, -s52
    v_fma_f32 v230, -v78, v78, -s52
    v_fma_f32 v231, -v79, v79, -s52
    v_mul_f32 v228, v228, v76
    v_mul_f32 v229, v229, v77
    v_mul_f32 v230, v230, v78
    v_mul_f32 v231, v231, v79
    v_exp_f32 v228, v228
    v_exp_f32 v229, v229
    v_exp_f32 v230, v230
    v_exp_f32 v231, v231
    v_add_f32 v228, 1.0, v228
    v_add_f32 v229, 1.0, v229
    v_add_f32 v230, 1.0, v230
    v_add_f32 v231, 1.0, v231
    v_rcp_f32 v228, v228
    v_rcp_f32 v229, v229
    v_rcp_f32 v230, v230
    v_rcp_f32 v231, v231
    v_mul_f32 v228, v228, v76
    v_mul_f32 v229, v229, v77
    v_mul_f32 v230, v230, v78
    v_mul_f32 v231, v231, v79
    v_cvt_pk_bf16_f32 v240, v228, v229
    v_cvt_pk_bf16_f32 v241, v230, v231
    buffer_store_dwordx4 v[240:243], v11, s[16:19], s55 offen offset:256 sc1
    s_branch k1_fin
k1_w:
    s_add_u32 s24, s74, 50331648
    s_addc_u32 s25, s75, 0
    s_mov_b32 s26, 3317760
    s_mov_b32 s27, 0x20000
    s_sub_u32 s79, s41, 27
    s_lshl_b32 s79, s79, 5
    s_lshr_b32 s57, s42, 1
    s_add_u32 s57, s57, s79
    v_mov_b32 v15, v17
    v_mov_b32 v18, 2147483632
    v_mov_b32 v19, 32768
    v_cmp_eq_u32 vcc, 0, v0
    s_nop 1
    v_cndmask_b32 v12, v18, v19, vcc
    buffer_load_dwordx4 a[24:27], v10, s[4:7], s43 offen offset:3072 sc1
    buffer_load_dwordx4 a[28:31], v10, s[4:7], s44 offen offset:3072 sc1
    s_add_u32 s43, s43, 4096
    buffer_load_dwordx4 a[32:35], v10, s[4:7], s43 offen offset:0 sc1
    s_add_u32 s44, s44, 4096
    buffer_load_dwordx4 a[36:39], v10, s[4:7], s44 offen offset:0 sc1
    buffer_load_dwordx4 a[40:43], v10, s[4:7], s43 offen offset:1024 sc1
    buffer_load_dwordx4 a[44:47], v10, s[4:7], s44 offen offset:1024 sc1
    s_waitcnt vmcnt(21)
    s_barrier
    ds_read_b64_tr_b16 v[192:193], v1 offset:24576
    ds_read_b64_tr_b16 v[194:195], v1 offset:25088
    ds_read_b64_tr_b16 v[196:197], v2 offset:24576
    ds_read_b64_tr_b16 v[198:199], v2 offset:25088
    ds_read_b64_tr_b16 v[200:201], v3 offset:0
    ds_read_b64_tr_b16 v[202:203], v3 offset:256
    ds_read_b64_tr_b16 v[204:205], v1 offset:26624
    ds_read_b64_tr_b16 v[206:207], v1 offset:27136
    s_waitcnt vmcnt(10) lgkmcnt(4)
    v_mfma_f32_32x32x16_bf16 v[16:31], v[192:195], a[0:3], 0
    ds_read_b64_tr_b16 v[208:209], v2 offset:26624
    v_mfma_f32_32x32x16_bf16 v[32:47], v[192:195], a[4:7], 0
    ds_read_b64_tr_b16 v[210:211], v2 offset:27136
    v_mfma_f32_32x32x16_bf16 v[48:63], v[196:199], a[0:3], 0
    ds_read_b64_tr_b16 v[212:213], v3 offset:1024
    buffer_load_dwordx4 a[48:51], v10, s[4:7], s43 offen offset:2048 sc1
    v_mfma_f32_32x32x16_bf16 v[64:79], v[196:199], a[4:7], 0
    ds_read_b64_tr_b16 v[214:215], v3 offset:1280
    s_waitcnt lgkmcnt(6)
    v_mfma_f32_32x32x16_bf16 v[144:159], v[200:203], a[0:3], 0
    ds_read_b64_tr_b16 v[192:193], v1 offset:28672
    ds_read_b64_tr_b16 v[194:195], v1 offset:29184
    buffer_load_dwordx4 a[52:55], v10, s[4:7], s44 offen offset:2048 sc1
    s_waitcnt vmcnt(10) lgkmcnt(4)
    v_mfma_f32_32x32x16_bf16 v[16:31], v[204:207], a[8:11], v[16:31]
    ds_read_b64_tr_b16 v[196:197], v2 offset:28672
    v_mfma_f32_32x32x16_bf16 v[32:47], v[204:207], a[12:15], v[32:47]
    ds_read_b64_tr_b16 v[198:199], v2 offset:29184
    buffer_load_dwordx4 a[56:59], v10, s[4:7], s43 offen offset:3072 sc1
    v_mfma_f32_32x32x16_bf16 v[48:63], v[208:211], a[8:11], v[48:63]
    ds_read_b64_tr_b16 v[200:201], v3 offset:2048
    v_mfma_f32_32x32x16_bf16 v[64:79], v[208:211], a[12:15], v[64:79]
    ds_read_b64_tr_b16 v[202:203], v3 offset:2304
    buffer_load_dwordx4 a[60:63], v10, s[4:7], s44 offen offset:3072 sc1
    s_waitcnt lgkmcnt(6)
    v_mfma_f32_32x32x16_bf16 v[144:159], v[212:215], a[8:11], v[144:159]
    ds_read_b64_tr_b16 v[204:205], v1 offset:30720
    ds_read_b64_tr_b16 v[206:207], v1 offset:31232
    s_waitcnt vmcnt(10) lgkmcnt(4)
    v_mfma_f32_32x32x16_bf16 v[16:31], v[192:195], a[16:19], v[16:31]
    ds_read_b64_tr_b16 v[208:209], v2 offset:30720
    s_add_u32 s43, s43, 4096
    buffer_load_dwordx4 a[64:67], v10, s[4:7], s43 offen offset:0 sc1
    v_mfma_f32_32x32x16_bf16 v[32:47], v[192:195], a[20:23], v[32:47]
    ds_read_b64_tr_b16 v[210:211], v2 offset:31232
    v_mfma_f32_32x32x16_bf16 v[48:63], v[196:199], a[16:19], v[48:63]
    ds_read_b64_tr_b16 v[212:213], v3 offset:3072
    s_add_u32 s44, s44, 4096
    buffer_load_dwordx4 a[68:71], v10, s[4:7], s44 offen offset:0 sc1
    v_mfma_f32_32x32x16_bf16 v[64:79], v[196:199], a[20:23], v[64:79]
    ds_read_b64_tr_b16 v[214:215], v3 offset:3328
    s_waitcnt lgkmcnt(6)
    v_mfma_f32_32x32x16_bf16 v[144:159], v[200:203], a[16:19], v[144:159]
    ds_read_b64_tr_b16 v[192:193], v1 offset:32768
    ds_read_b64_tr_b16 v[194:195], v1 offset:33280
    buffer_load_dwordx4 a[72:75], v10, s[4:7], s43 offen offset:1024 sc1
    s_waitcnt vmcnt(11) lgkmcnt(4)
    v_mfma_f32_32x32x16_bf16 v[16:31], v[204:207], a[24:27], v[16:31]
    ds_read_b64_tr_b16 v[196:197], v2 offset:32768
    v_mfma_f32_32x32x16_bf16 v[32:47], v[204:207], a[28:31], v[32:47]
    ds_read_b64_tr_b16 v[198:199], v2 offset:33280
    buffer_load_dwordx4 a[76:79], v10, s[4:7], s44 offen offset:1024 sc1
    v_mfma_f32_32x32x16_bf16 v[48:63], v[208:211], a[24:27], v[48:63]
    ds_read_b64_tr_b16 v[200:201], v3 offset:4096
    v_mfma_f32_32x32x16_bf16 v[64:79], v[208:211], a[28:31], v[64:79]
    ds_read_b64_tr_b16 v[202:203], v3 offset:4352
    buffer_load_dwordx4 a[80:83], v10, s[4:7], s43 offen offset:2048 sc1
    s_waitcnt lgkmcnt(6)
    v_mfma_f32_32x32x16_bf16 v[144:159], v[212:215], a[24:27], v[144:159]
    ds_read_b64_tr_b16 v[204:205], v1 offset:34816
    ds_read_b64_tr_b16 v[206:207], v1 offset:35328
    s_waitcnt vmcnt(11) lgkmcnt(4)
    v_mfma_f32_32x32x16_bf16 v[16:31], v[192:195], a[32:35], v[16:31]
    ds_read_b64_tr_b16 v[208:209], v2 offset:34816
    buffer_load_dwordx4 a[84:87], v10, s[4:7], s44 offen offset:2048 sc1
    v_mfma_f32_32x32x16_bf16 v[32:47], v[192:195], a[36:39], v[32:47]
    ds_read_b64_tr_b16 v[210:211], v2 offset:35328
    v_mfma_f32_32x32x16_bf16 v[48:63], v[196:199], a[32:35], v[48:63]
    ds_read_b64_tr_b16 v[212:213], v3 offset:5120
    buffer_load_dwordx4 a[88:91], v10, s[4:7], s43 offen offset:3072 sc1
    v_mfma_f32_32x32x16_bf16 v[64:79], v[196:199], a[36:39], v[64:79]
    ds_read_b64_tr_b16 v[214:215], v3 offset:5376
    s_waitcnt lgkmcnt(6)
    v_mfma_f32_32x32x16_bf16 v[144:159], v[200:203], a[32:35], v[144:159]
    s_barrier
    ds_read_b64_tr_b16 v[192:193], v1 offset:36864
    ds_read_b64_tr_b16 v[194:195], v1 offset:37376
    s_waitcnt vmcnt(11) lgkmcnt(4)
    v_mfma_f32_32x32x16_bf16 v[16:31], v[204:207], a[40:43], v[16:31]
    ds_read_b64_tr_b16 v[196:197], v2 offset:36864
    buffer_load_dwordx4 a[92:95], v10, s[4:7], s44 offen offset:3072 sc1
    v_mfma_f32_32x32x16_bf16 v[32:47], v[204:207], a[44:47], v[32:47]
    ds_read_b64_tr_b16 v[198:199], v2 offset:37376
    v_mfma_f32_32x32x16_bf16 v[48:63], v[208:211], a[40:43], v[48:63]
    ds_read_b64_tr_b16 v[200:201], v3 offset:6144
    s_add_u32 s43, s43, 4096
    buffer_load_dwordx4 a[96:99], v10, s[4:7], s43 offen offset:0 sc1
    v_mfma_f32_32x32x16_bf16 v[64:79], v[208:211], a[44:47], v[64:79]
    ds_read_b64_tr_b16 v[202:203], v3 offset:6400
    s_waitcnt lgkmcnt(6)
    v_mfma_f32_32x32x16_bf16 v[144:159], v[212:215], a[40:43], v[144:159]
    ds_read_b64_tr_b16 v[204:205], v1 offset:38912
    ds_read_b64_tr_b16 v[206:207], v1 offset:39424
    s_add_u32 s44, s44, 4096
    buffer_load_dwordx4 a[100:103], v10, s[4:7], s44 offen offset:0 sc1
    s_waitcnt vmcnt(12) lgkmcnt(4)
    v_mfma_f32_32x32x16_bf16 v[16:31], v[192:195], a[48:51], v[16:31]
    ds_read_b64_tr_b16 v[208:209], v2 offset:38912
    v_mfma_f32_32x32x16_bf16 v[32:47], v[192:195], a[52:55], v[32:47]
    ds_read_b64_tr_b16 v[210:211], v2 offset:39424
    buffer_load_dwordx4 a[104:107], v10, s[4:7], s43 offen offset:1024 sc1
    v_mfma_f32_32x32x16_bf16 v[48:63], v[196:199], a[48:51], v[48:63]
    ds_read_b64_tr_b16 v[212:213], v3 offset:7168
    v_mfma_f32_32x32x16_bf16 v[64:79], v[196:199], a[52:55], v[64:79]
    ds_read_b64_tr_b16 v[214:215], v3 offset:7424
    buffer_load_dwordx4 a[108:111], v10, s[4:7], s44 offen offset:1024 sc1
    s_waitcnt lgkmcnt(6)
    v_mfma_f32_32x32x16_bf16 v[144:159], v[200:203], a[48:51], v[144:159]
    ds_read_b64_tr_b16 v[192:193], v1 offset:40960
    ds_read_b64_tr_b16 v[194:195], v1 offset:41472
    s_waitcnt vmcnt(12) lgkmcnt(4)
    v_mfma_f32_32x32x16_bf16 v[16:31], v[204:207], a[56:59], v[16:31]
    ds_read_b64_tr_b16 v[196:197], v2 offset:40960
    s_add_u32 m0, s45, 126976
    s_add_u32 s50, s46, 2654208
    buffer_load_dwordx4 v7, s[8:11], s50 offen offset:0 lds
    v_mfma_f32_32x32x16_bf16 v[32:47], v[204:207], a[60:63], v[32:47]
    ds_read_b64_tr_b16 v[198:199], v2 offset:41472
    v_mfma_f32_32x32x16_bf16 v[48:63], v[208:211], a[56:59], v[48:63]
    ds_read_b64_tr_b16 v[200:201], v3 offset:8192
    buffer_load_dwordx4 v8, s[8:11], s50 offen offset:1024 lds
    v_mfma_f32_32x32x16_bf16 v[64:79], v[208:211], a[60:63], v[64:79]
    ds_read_b64_tr_b16 v[202:203], v3 offset:8448
    s_waitcnt lgkmcnt(6)
    v_mfma_f32_32x32x16_bf16 v[144:159], v[212:215], a[56:59], v[144:159]
    ds_read_b64_tr_b16 v[204:205], v1 offset:43008
    ds_read_b64_tr_b16 v[206:207], v1 offset:43520
    buffer_load_dwordx4 v9, s[8:11], s50 offen offset:2048 lds
    s_waitcnt vmcnt(13) lgkmcnt(4)
    v_mfma_f32_32x32x16_bf16 v[16:31], v[192:195], a[64:67], v[16:31]
    ds_read_b64_tr_b16 v[208:209], v2 offset:43008
    v_mfma_f32_32x32x16_bf16 v[32:47], v[192:195], a[68:71], v[32:47]
    ds_read_b64_tr_b16 v[210:211], v2 offset:43520
    buffer_load_dwordx4 a[112:115], v10, s[4:7], s43 offen offset:2048 sc1
    v_mfma_f32_32x32x16_bf16 v[48:63], v[196:199], a[64:67], v[48:63]
    ds_read_b64_tr_b16 v[212:213], v3 offset:9216
    v_mfma_f32_32x32x16_bf16 v[64:79], v[196:199], a[68:71], v[64:79]
    ds_read_b64_tr_b16 v[214:215], v3 offset:9472
    buffer_load_dwordx4 a[116:119], v10, s[4:7], s44 offen offset:2048 sc1
    s_waitcnt lgkmcnt(6)
    v_mfma_f32_32x32x16_bf16 v[144:159], v[200:203], a[64:67], v[144:159]
    ds_read_b64_tr_b16 v[192:193], v1 offset:45056
    ds_read_b64_tr_b16 v[194:195], v1 offset:45568
    s_waitcnt vmcnt(13) lgkmcnt(4)
    v_mfma_f32_32x32x16_bf16 v[16:31], v[204:207], a[72:75], v[16:31]
    ds_read_b64_tr_b16 v[196:197], v2 offset:45056
    buffer_load_dwordx4 a[120:123], v10, s[4:7], s43 offen offset:3072 sc1
    v_mfma_f32_32x32x16_bf16 v[32:47], v[204:207], a[76:79], v[32:47]
    ds_read_b64_tr_b16 v[198:199], v2 offset:45568
    v_mfma_f32_32x32x16_bf16 v[48:63], v[208:211], a[72:75], v[48:63]
    ds_read_b64_tr_b16 v[200:201], v3 offset:10240
    buffer_load_dwordx4 a[124:127], v10, s[4:7], s44 offen offset:3072 sc1
    v_mfma_f32_32x32x16_bf16 v[64:79], v[208:211], a[76:79], v[64:79]
    ds_read_b64_tr_b16 v[202:203], v3 offset:10496
    s_waitcnt lgkmcnt(6)
    v_mfma_f32_32x32x16_bf16 v[144:159], v[212:215], a[72:75], v[144:159]
    ds_read_b64_tr_b16 v[204:205], v1 offset:47104
    ds_read_b64_tr_b16 v[206:207], v1 offset:47616
    s_waitcnt vmcnt(13) lgkmcnt(4)
    v_mfma_f32_32x32x16_bf16 v[16:31], v[192:195], a[80:83], v[16:31]
    ds_read_b64_tr_b16 v[208:209], v2 offset:47104
    s_add_u32 s43, s43, 4096
    buffer_load_dwordx4 a[128:131], v10, s[4:7], s43 offen offset:0 sc1
    v_mfma_f32_32x32x16_bf16 v[32:47], v[192:195], a[84:87], v[32:47]
    ds_read_b64_tr_b16 v[210:211], v2 offset:47616
    v_mfma_f32_32x32x16_bf16 v[48:63], v[196:199], a[80:83], v[48:63]
    ds_read_b64_tr_b16 v[212:213], v3 offset:11264
    s_add_u32 s44, s44, 4096
    buffer_load_dwordx4 a[132:135], v10, s[4:7], s44 offen offset:0 sc1
    v_mfma_f32_32x32x16_bf16 v[64:79], v[196:199], a[84:87], v[64:79]
    ds_read_b64_tr_b16 v[214:215], v3 offset:11520
    s_waitcnt lgkmcnt(6)
    v_mfma_f32_32x32x16_bf16 v[144:159], v[200:203], a[80:83], v[144:159]
    s_barrier
    ds_read_b64_tr_b16 v[192:193], v1 offset:49152
    ds_read_b64_tr_b16 v[194:195], v1 offset:49664
    buffer_load_dwordx4 a[136:139], v10, s[4:7], s43 offen offset:1024 sc1
    s_waitcnt vmcnt(14) lgkmcnt(4)
    v_mfma_f32_32x32x16_bf16 v[16:31], v[204:207], a[88:91], v[16:31]
    ds_read_b64_tr_b16 v[196:197], v2 offset:49152
    v_mfma_f32_32x32x16_bf16 v[32:47], v[204:207], a[92:95], v[32:47]
    ds_read_b64_tr_b16 v[198:199], v2 offset:49664
    buffer_load_dwordx4 a[140:143], v10, s[4:7], s44 offen offset:1024 sc1
    v_mfma_f32_32x32x16_bf16 v[48:63], v[208:211], a[88:91], v[48:63]
    ds_read_b64_tr_b16 v[200:201], v3 offset:12288
    v_mfma_f32_32x32x16_bf16 v[64:79], v[208:211], a[92:95], v[64:79]
    ds_read_b64_tr_b16 v[202:203], v3 offset:12544
    buffer_load_dwordx4 a[144:147], v10, s[4:7], s43 offen offset:2048 sc1
    s_waitcnt lgkmcnt(6)
    v_mfma_f32_32x32x16_bf16 v[144:159], v[212:215], a[88:91], v[144:159]
    ds_read_b64_tr_b16 v[204:205], v1 offset:51200
    ds_read_b64_tr_b16 v[206:207], v1 offset:51712
    s_waitcnt vmcnt(14) lgkmcnt(4)
    v_mfma_f32_32x32x16_bf16 v[16:31], v[192:195], a[96:99], v[16:31]
    ds_read_b64_tr_b16 v[208:209], v2 offset:51200
    buffer_load_dwordx4 a[148:151], v10, s[4:7], s44 offen offset:2048 sc1
    v_mfma_f32_32x32x16_bf16 v[32:47], v[192:195], a[100:103], v[32:47]
    ds_read_b64_tr_b16 v[210:211], v2 offset:51712
    v_mfma_f32_32x32x16_bf16 v[48:63], v[196:199], a[96:99], v[48:63]
    ds_read_b64_tr_b16 v[212:213], v3 offset:13312
    buffer_load_dwordx4 a[152:155], v10, s[4:7], s43 offen offset:3072 sc1
    v_mfma_f32_32x32x16_bf16 v[64:79], v[196:199], a[100:103], v[64:79]
    ds_read_b64_tr_b16 v[214:215], v3 offset:13568
    s_waitcnt lgkmcnt(6)
    v_mfma_f32_32x32x16_bf16 v[144:159], v[200:203], a[96:99], v[144:159]
    ds_read_b64_tr_b16 v[192:193], v1 offset:53248
    ds_read_b64_tr_b16 v[194:195], v1 offset:53760
    buffer_load_dwordx4 a[156:159], v10, s[4:7], s44 offen offset:3072 sc1
    s_waitcnt vmcnt(15) lgkmcnt(4)
    v_mfma_f32_32x32x16_bf16 v[16:31], v[204:207], a[104:107], v[16:31]
    ds_read_b64_tr_b16 v[196:197], v2 offset:53248
    v_mfma_f32_32x32x16_bf16 v[32:47], v[204:207], a[108:111], v[32:47]
    ds_read_b64_tr_b16 v[198:199], v2 offset:53760
    s_add_u32 m0, s45, 139264
    s_add_u32 s50, s46, 3538944
    buffer_load_dwordx4 v7, s[8:11], s50 offen offset:0 lds
    v_mfma_f32_32x32x16_bf16 v[48:63], v[208:211], a[104:107], v[48:63]
    ds_read_b64_tr_b16 v[200:201], v3 offset:14336
    v_mfma_f32_32x32x16_bf16 v[64:79], v[208:211], a[108:111], v[64:79]
    ds_read_b64_tr_b16 v[202:203], v3 offset:14592
    buffer_load_dwordx4 v8, s[8:11], s50 offen offset:1024 lds
    s_waitcnt lgkmcnt(6)
    v_mfma_f32_32x32x16_bf16 v[144:159], v[212:215], a[104:107], v[144:159]
    ds_read_b64_tr_b16 v[204:205], v1 offset:55296
    ds_read_b64_tr_b16 v[206:207], v1 offset:55808
    s_waitcnt vmcnt(12) lgkmcnt(4)
    v_mfma_f32_32x32x16_bf16 v[16:31], v[192:195], a[112:115], v[16:31]
    ds_read_b64_tr_b16 v[208:209], v2 offset:55296
    buffer_load_dwordx4 v9, s[8:11], s50 offen offset:2048 lds
    v_mfma_f32_32x32x16_bf16 v[32:47], v[192:195], a[116:119], v[32:47]
    ds_read_b64_tr_b16 v[210:211], v2 offset:55808
    v_mfma_f32_32x32x16_bf16 v[48:63], v[196:199], a[112:115], v[48:63]
    ds_read_b64_tr_b16 v[212:213], v3 offset:15360
    s_add_u32 m0, s45, 77824
    s_add_u32 s50, s47, 3538944
    buffer_load_dwordx4 v245, s[8:11], s50 offen offset:0 lds
    v_mfma_f32_32x32x16_bf16 v[64:79], v[196:199], a[116:119], v[64:79]
    ds_read_b64_tr_b16 v[214:215], v3 offset:15616
    s_waitcnt lgkmcnt(6)
    v_mfma_f32_32x32x16_bf16 v[144:159], v[200:203], a[112:115], v[144:159]
    ds_read_b64_tr_b16 v[192:193], v1 offset:57344
    ds_read_b64_tr_b16 v[194:195], v1 offset:57856
    s_waitcnt vmcnt(12) lgkmcnt(4)
    v_mfma_f32_32x32x16_bf16 v[16:31], v[204:207], a[120:123], v[16:31]
    ds_read_b64_tr_b16 v[196:197], v2 offset:57344
    buffer_load_dwordx4 v247, s[8:11], s50 offen offset:1024 lds
    v_mfma_f32_32x32x16_bf16 v[32:47], v[204:207], a[124:127], v[32:47]
    ds_read_b64_tr_b16 v[198:199], v2 offset:57856
    v_mfma_f32_32x32x16_bf16 v[48:63], v[208:211], a[120:123], v[48:63]
    ds_read_b64_tr_b16 v[200:201], v3 offset:16384
    buffer_load_dwordx4 v249, s[8:11], s50 offen offset:2048 lds
    v_mfma_f32_32x32x16_bf16 v[64:79], v[208:211], a[124:127], v[64:79]
    ds_read_b64_tr_b16 v[202:203], v3 offset:16640
    s_waitcnt lgkmcnt(6)
    v_mfma_f32_32x32x16_bf16 v[144:159], v[212:215], a[120:123], v[144:159]
    ds_read_b64_tr_b16 v[204:205], v1 offset:59392
    ds_read_b64_tr_b16 v[206:207], v1 offset:59904
    s_add_u32 s43, s43, 4096
    buffer_load_dwordx4 a[160:163], v10, s[4:7], s43 offen offset:0 sc1
    s_waitcnt vmcnt(13) lgkmcnt(4)
    v_mfma_f32_32x32x16_bf16 v[16:31], v[192:195], a[128:131], v[16:31]
    ds_read_b64_tr_b16 v[208:209], v2 offset:59392
    v_mfma_f32_32x32x16_bf16 v[32:47], v[192:195], a[132:135], v[32:47]
    ds_read_b64_tr_b16 v[210:211], v2 offset:59904
    s_add_u32 s44, s44, 4096
    buffer_load_dwordx4 a[164:167], v10, s[4:7], s44 offen offset:0 sc1
    v_mfma_f32_32x32x16_bf16 v[48:63], v[196:199], a[128:131], v[48:63]
    ds_read_b64_tr_b16 v[212:213], v3 offset:17408
    v_mfma_f32_32x32x16_bf16 v[64:79], v[196:199], a[132:135], v[64:79]
    ds_read_b64_tr_b16 v[214:215], v3 offset:17664
    buffer_load_dwordx4 a[168:171], v10, s[4:7], s43 offen offset:1024 sc1
    s_waitcnt lgkmcnt(6)
    v_mfma_f32_32x32x16_bf16 v[144:159], v[200:203], a[128:131], v[144:159]
    s_barrier
    ds_read_b64_tr_b16 v[192:193], v4 offset:0
    ds_read_b64_tr_b16 v[194:195], v4 offset:512
    s_waitcnt vmcnt(13) lgkmcnt(4)
    v_mfma_f32_32x32x16_bf16 v[16:31], v[204:207], a[136:139], v[16:31]
    ds_read_b64_tr_b16 v[196:197], v5 offset:0
    buffer_load_dwordx4 a[172:175], v10, s[4:7], s44 offen offset:1024 sc1
    v_mfma_f32_32x32x16_bf16 v[32:47], v[204:207], a[140:143], v[32:47]
    ds_read_b64_tr_b16 v[198:199], v5 offset:512
    v_mfma_f32_32x32x16_bf16 v[48:63], v[208:211], a[136:139], v[48:63]
    ds_read_b64_tr_b16 v[200:201], v3 offset:18432
    buffer_load_dwordx4 a[176:179], v10, s[4:7], s43 offen offset:2048 sc1
    v_mfma_f32_32x32x16_bf16 v[64:79], v[208:211], a[140:143], v[64:79]
    ds_read_b64_tr_b16 v[202:203], v3 offset:18688
    s_waitcnt lgkmcnt(6)
    v_mfma_f32_32x32x16_bf16 v[144:159], v[212:215], a[136:139], v[144:159]
    ds_read_b64_tr_b16 v[204:205], v4 offset:2048
    ds_read_b64_tr_b16 v[206:207], v4 offset:2560
    buffer_load_dwordx4 a[180:183], v10, s[4:7], s44 offen offset:2048 sc1
    s_waitcnt vmcnt(14) lgkmcnt(4)
    v_mfma_f32_32x32x16_bf16 v[16:31], v[192:195], a[144:147], v[16:31]
    ds_read_b64_tr_b16 v[208:209], v5 offset:2048
    v_mfma_f32_32x32x16_bf16 v[32:47], v[192:195], a[148:151], v[32:47]
    ds_read_b64_tr_b16 v[210:211], v5 offset:2560
    buffer_load_dwordx4 a[184:187], v10, s[4:7], s43 offen offset:3072 sc1
    v_mfma_f32_32x32x16_bf16 v[48:63], v[196:199], a[144:147], v[48:63]
    ds_read_b64_tr_b16 v[212:213], v3 offset:19456
    v_mfma_f32_32x32x16_bf16 v[64:79], v[196:199], a[148:151], v[64:79]
    ds_read_b64_tr_b16 v[214:215], v3 offset:19712
    buffer_load_dwordx4 a[188:191], v10, s[4:7], s44 offen offset:3072 sc1
    s_waitcnt lgkmcnt(6)
    v_mfma_f32_32x32x16_bf16 v[144:159], v[200:203], a[144:147], v[144:159]
    ds_read_b64_tr_b16 v[192:193], v4 offset:4096
    ds_read_b64_tr_b16 v[194:195], v4 offset:4608
    s_waitcnt vmcnt(14) lgkmcnt(4)
    v_mfma_f32_32x32x16_bf16 v[16:31], v[204:207], a[152:155], v[16:31]
    ds_read_b64_tr_b16 v[196:197], v5 offset:4096
    s_add_u32 s43, s43, 4096
    buffer_load_dwordx4 a[192:195], v10, s[4:7], s43 offen offset:0 sc1
    v_mfma_f32_32x32x16_bf16 v[32:47], v[204:207], a[156:159], v[32:47]
    ds_read_b64_tr_b16 v[198:199], v5 offset:4608
    v_mfma_f32_32x32x16_bf16 v[48:63], v[208:211], a[152:155], v[48:63]
    ds_read_b64_tr_b16 v[200:201], v3 offset:20480
    s_add_u32 s44, s44, 4096
    buffer_load_dwordx4 a[196:199], v10, s[4:7], s44 offen offset:0 sc1
    v_mfma_f32_32x32x16_bf16 v[64:79], v[208:211], a[156:159], v[64:79]
    ds_read_b64_tr_b16 v[202:203], v3 offset:20736
    s_waitcnt lgkmcnt(6)
    v_mfma_f32_32x32x16_bf16 v[144:159], v[212:215], a[152:155], v[144:159]
    ds_read_b64_tr_b16 v[204:205], v4 offset:6144
    ds_read_b64_tr_b16 v[206:207], v4 offset:6656
    s_waitcnt vmcnt(8) lgkmcnt(4)
    v_mfma_f32_32x32x16_bf16 v[16:31], v[192:195], a[160:163], v[16:31]
    ds_read_b64_tr_b16 v[208:209], v5 offset:6144
    buffer_load_dwordx4 a[200:203], v10, s[4:7], s43 offen offset:1024 sc1
    v_mfma_f32_32x32x16_bf16 v[32:47], v[192:195], a[164:167], v[32:47]
    ds_read_b64_tr_b16 v[210:211], v5 offset:6656
    v_mfma_f32_32x32x16_bf16 v[48:63], v[196:199], a[160:163], v[48:63]
    ds_read_b64_tr_b16 v[212:213], v3 offset:21504
    buffer_load_dwordx4 a[204:207], v10, s[4:7], s44 offen offset:1024 sc1
    v_mfma_f32_32x32x16_bf16 v[64:79], v[196:199], a[164:167], v[64:79]
    ds_read_b64_tr_b16 v[214:215], v3 offset:21760
    s_waitcnt lgkmcnt(6)
    v_mfma_f32_32x32x16_bf16 v[144:159], v[200:203], a[160:163], v[144:159]
    ds_read_b64_tr_b16 v[192:193], v4 offset:8192
    ds_read_b64_tr_b16 v[194:195], v4 offset:8704
    s_add_u32 m0, s45, 151552
    s_add_u32 s50, s46, 4423680
    buffer_load_dwordx4 v7, s[8:11], s50 offen offset:0 lds
    s_waitcnt vmcnt(9) lgkmcnt(4)
    v_mfma_f32_32x32x16_bf16 v[16:31], v[204:207], a[168:171], v[16:31]
    ds_read_b64_tr_b16 v[196:197], v5 offset:8192
    v_mfma_f32_32x32x16_bf16 v[32:47], v[204:207], a[172:175], v[32:47]
    ds_read_b64_tr_b16 v[198:199], v5 offset:8704
    buffer_load_dwordx4 v8, s[8:11], s50 offen offset:1024 lds
    v_mfma_f32_32x32x16_bf16 v[48:63], v[208:211], a[168:171], v[48:63]
    ds_read_b64_tr_b16 v[200:201], v3 offset:22528
    v_mfma_f32_32x32x16_bf16 v[64:79], v[208:211], a[172:175], v[64:79]
    ds_read_b64_tr_b16 v[202:203], v3 offset:22784
    buffer_load_dwordx4 v9, s[8:11], s50 offen offset:2048 lds
    s_waitcnt lgkmcnt(6)
    v_mfma_f32_32x32x16_bf16 v[144:159], v[212:215], a[168:171], v[144:159]
    ds_read_b64_tr_b16 v[204:205], v4 offset:10240
    ds_read_b64_tr_b16 v[206:207], v4 offset:10752
    s_waitcnt vmcnt(9) lgkmcnt(4)
    v_mfma_f32_32x32x16_bf16 v[16:31], v[192:195], a[176:179], v[16:31]
    ds_read_b64_tr_b16 v[208:209], v5 offset:10240
    buffer_load_dwordx4 a[208:211], v10, s[4:7], s43 offen offset:2048 sc1
    v_mfma_f32_32x32x16_bf16 v[32:47], v[192:195], a[180:183], v[32:47]
    ds_read_b64_tr_b16 v[210:211], v5 offset:10752
    v_mfma_f32_32x32x16_bf16 v[48:63], v[196:199], a[176:179], v[48:63]
    ds_read_b64_tr_b16 v[212:213], v3 offset:23552
    buffer_load_dwordx4 a[212:215], v10, s[4:7], s44 offen offset:2048 sc1
    v_mfma_f32_32x32x16_bf16 v[64:79], v[196:199], a[180:183], v[64:79]
    ds_read_b64_tr_b16 v[214:215], v3 offset:23808
    s_waitcnt lgkmcnt(6)
    v_mfma_f32_32x32x16_bf16 v[144:159], v[200:203], a[176:179], v[144:159]
    s_barrier
    ds_read_b64_tr_b16 v[192:193], v4 offset:12288
    ds_read_b64_tr_b16 v[194:195], v4 offset:12800
    buffer_load_dwordx4 a[216:219], v10, s[4:7], s43 offen offset:3072 sc1
    s_waitcnt vmcnt(10) lgkmcnt(4)
    v_mfma_f32_32x32x16_bf16 v[16:31], v[204:207], a[184:187], v[16:31]
    ds_read_b64_tr_b16 v[196:197], v5 offset:12288
    v_mfma_f32_32x32x16_bf16 v[32:47], v[204:207], a[188:191], v[32:47]
    ds_read_b64_tr_b16 v[198:199], v5 offset:12800
    buffer_load_dwordx4 a[220:223], v10, s[4:7], s44 offen offset:3072 sc1
    v_mfma_f32_32x32x16_bf16 v[48:63], v[208:211], a[184:187], v[48:63]
    ds_read_b64_tr_b16 v[200:201], v3 offset:24576
    v_mfma_f32_32x32x16_bf16 v[64:79], v[208:211], a[188:191], v[64:79]
    ds_read_b64_tr_b16 v[202:203], v3 offset:24832
    s_add_u32 s43, s43, 4096
    buffer_load_dwordx4 a[224:227], v10, s[4:7], s43 offen offset:0 sc1
    s_waitcnt lgkmcnt(6)
    v_mfma_f32_32x32x16_bf16 v[144:159], v[212:215], a[184:187], v[144:159]
    ds_read_b64_tr_b16 v[204:205], v4 offset:14336
    ds_read_b64_tr_b16 v[206:207], v4 offset:14848
    s_waitcnt vmcnt(10) lgkmcnt(4)
    v_mfma_f32_32x32x16_bf16 v[16:31], v[192:195], a[192:195], v[16:31]
    ds_read_b64_tr_b16 v[208:209], v5 offset:14336
    s_add_u32 s44, s44, 4096
    buffer_load_dwordx4 a[228:231], v10, s[4:7], s44 offen offset:0 sc1
    v_mfma_f32_32x32x16_bf16 v[32:47], v[192:195], a[196:199], v[32:47]
    ds_read_b64_tr_b16 v[210:211], v5 offset:14848
    v_mfma_f32_32x32x16_bf16 v[48:63], v[196:199], a[192:195], v[48:63]
    ds_read_b64_tr_b16 v[212:213], v3 offset:25600
    buffer_load_dwordx4 a[232:235], v10, s[4:7], s43 offen offset:1024 sc1
    v_mfma_f32_32x32x16_bf16 v[64:79], v[196:199], a[196:199], v[64:79]
    ds_read_b64_tr_b16 v[214:215], v3 offset:25856
    s_waitcnt lgkmcnt(6)
    v_mfma_f32_32x32x16_bf16 v[144:159], v[200:203], a[192:195], v[144:159]
    ds_read_b64_tr_b16 v[192:193], v4 offset:16384
    ds_read_b64_tr_b16 v[194:195], v4 offset:16896
    s_waitcnt vmcnt(10) lgkmcnt(4)
    v_mfma_f32_32x32x16_bf16 v[16:31], v[204:207], a[200:203], v[16:31]
    ds_read_b64_tr_b16 v[196:197], v5 offset:16384
    buffer_load_dwordx4 a[236:239], v10, s[4:7], s44 offen offset:1024 sc1
    v_mfma_f32_32x32x16_bf16 v[32:47], v[204:207], a[204:207], v[32:47]
    ds_read_b64_tr_b16 v[198:199], v5 offset:16896
    v_mfma_f32_32x32x16_bf16 v[48:63], v[208:211], a[200:203], v[48:63]
    ds_read_b64_tr_b16 v[200:201], v3 offset:26624
    buffer_load_dwordx4 a[240:243], v10, s[4:7], s43 offen offset:2048 sc1
    v_mfma_f32_32x32x16_bf16 v[64:79], v[208:211], a[204:207], v[64:79]
    ds_read_b64_tr_b16 v[202:203], v3 offset:26880
    s_waitcnt lgkmcnt(6)
    v_mfma_f32_32x32x16_bf16 v[144:159], v[212:215], a[200:203], v[144:159]
    ds_read_b64_tr_b16 v[204:205], v4 offset:18432
    ds_read_b64_tr_b16 v[206:207], v4 offset:18944
    buffer_load_dwordx4 a[244:247], v10, s[4:7], s44 offen offset:2048 sc1
    s_waitcnt vmcnt(8) lgkmcnt(4)
    v_mfma_f32_32x32x16_bf16 v[16:31], v[192:195], a[208:211], v[16:31]
    ds_read_b64_tr_b16 v[208:209], v5 offset:18432
    v_mfma_f32_32x32x16_bf16 v[32:47], v[192:195], a[212:215], v[32:47]
    ds_read_b64_tr_b16 v[210:211], v5 offset:18944
    buffer_load_dwordx4 a[248:251], v10, s[4:7], s43 offen offset:3072 sc1
    v_mfma_f32_32x32x16_bf16 v[48:63], v[196:199], a[208:211], v[48:63]
    ds_read_b64_tr_b16 v[212:213], v3 offset:27648
    v_mfma_f32_32x32x16_bf16 v[64:79], v[196:199], a[212:215], v[64:79]
    ds_read_b64_tr_b16 v[214:215], v3 offset:27904
    buffer_load_dwordx4 a[252:255], v10, s[4:7], s44 offen offset:3072 sc1
    s_waitcnt lgkmcnt(6)
    v_mfma_f32_32x32x16_bf16 v[144:159], v[200:203], a[208:211], v[144:159]
    ds_read_b64_tr_b16 v[192:193], v4 offset:20480
    ds_read_b64_tr_b16 v[194:195], v4 offset:20992
    s_waitcnt vmcnt(8) lgkmcnt(4)
    v_mfma_f32_32x32x16_bf16 v[16:31], v[204:207], a[216:219], v[16:31]
    ds_read_b64_tr_b16 v[196:197], v5 offset:20480
    s_add_u32 s43, s43, 4096
    buffer_load_dwordx4 v[160:163], v10, s[4:7], s43 offen offset:0 sc1
    v_mfma_f32_32x32x16_bf16 v[32:47], v[204:207], a[220:223], v[32:47]
    ds_read_b64_tr_b16 v[198:199], v5 offset:20992
    v_mfma_f32_32x32x16_bf16 v[48:63], v[208:211], a[216:219], v[48:63]
    ds_read_b64_tr_b16 v[200:201], v3 offset:28672
    s_add_u32 s44, s44, 4096
    buffer_load_dwordx4 v[164:167], v10, s[4:7], s44 offen offset:0 sc1
    v_mfma_f32_32x32x16_bf16 v[64:79], v[208:211], a[220:223], v[64:79]
    ds_read_b64_tr_b16 v[202:203], v3 offset:28928
    s_waitcnt lgkmcnt(6)
    v_mfma_f32_32x32x16_bf16 v[144:159], v[212:215], a[216:219], v[144:159]
    ds_read_b64_tr_b16 v[204:205], v4 offset:22528
    ds_read_b64_tr_b16 v[206:207], v4 offset:23040
    buffer_load_dwordx4 v[168:171], v10, s[4:7], s43 offen offset:1024 sc1
    s_waitcnt vmcnt(9) lgkmcnt(4)
    v_mfma_f32_32x32x16_bf16 v[16:31], v[192:195], a[224:227], v[16:31]
    ds_read_b64_tr_b16 v[208:209], v5 offset:22528
    v_mfma_f32_32x32x16_bf16 v[32:47], v[192:195], a[228:231], v[32:47]
    ds_read_b64_tr_b16 v[210:211], v5 offset:23040
    buffer_load_dwordx4 v[172:175], v10, s[4:7], s44 offen offset:1024 sc1
    v_mfma_f32_32x32x16_bf16 v[48:63], v[196:199], a[224:227], v[48:63]
    ds_read_b64_tr_b16 v[212:213], v3 offset:29696
    v_mfma_f32_32x32x16_bf16 v[64:79], v[196:199], a[228:231], v[64:79]
    ds_read_b64_tr_b16 v[214:215], v3 offset:29952
    buffer_load_dwordx4 v[176:179], v10, s[4:7], s43 offen offset:2048 sc1
    s_waitcnt lgkmcnt(6)
    v_mfma_f32_32x32x16_bf16 v[144:159], v[200:203], a[224:227], v[144:159]
    s_barrier
    ds_read_b64_tr_b16 v[192:193], v4 offset:24576
    ds_read_b64_tr_b16 v[194:195], v4 offset:25088
    s_waitcnt vmcnt(9) lgkmcnt(4)
    v_mfma_f32_32x32x16_bf16 v[16:31], v[204:207], a[232:235], v[16:31]
    ds_read_b64_tr_b16 v[196:197], v5 offset:24576
    buffer_load_dwordx4 v[180:183], v10, s[4:7], s44 offen offset:2048 sc1
    v_mfma_f32_32x32x16_bf16 v[32:47], v[204:207], a[236:239], v[32:47]
    ds_read_b64_tr_b16 v[198:199], v5 offset:25088
    v_mfma_f32_32x32x16_bf16 v[48:63], v[208:211], a[232:235], v[48:63]
    ds_read_b64_tr_b16 v[200:201], v3 offset:30720
    buffer_load_dwordx4 v[184:187], v10, s[4:7], s43 offen offset:3072 sc1
    v_mfma_f32_32x32x16_bf16 v[64:79], v[208:211], a[236:239], v[64:79]
    ds_read_b64_tr_b16 v[202:203], v3 offset:30976
    s_waitcnt lgkmcnt(6)
    v_mfma_f32_32x32x16_bf16 v[144:159], v[212:215], a[232:235], v[144:159]
    ds_read_b64_tr_b16 v[204:205], v4 offset:26624
    ds_read_b64_tr_b16 v[206:207], v4 offset:27136
    s_waitcnt vmcnt(9) lgkmcnt(4)
    v_mfma_f32_32x32x16_bf16 v[16:31], v[192:195], a[240:243], v[16:31]
    ds_read_b64_tr_b16 v[208:209], v5 offset:26624
    buffer_load_dwordx4 v[188:191], v10, s[4:7], s44 offen offset:3072 sc1
    v_mfma_f32_32x32x16_bf16 v[32:47], v[192:195], a[244:247], v[32:47]
    ds_read_b64_tr_b16 v[210:211], v5 offset:27136
    v_mfma_f32_32x32x16_bf16 v[48:63], v[196:199], a[240:243], v[48:63]
    ds_read_b64_tr_b16 v[212:213], v3 offset:31744
    s_add_u32 m0, s45, 90112
    s_add_u32 s50, s48, 0
    buffer_load_dwordx4 v7, s[8:11], s50 offen offset:0 lds
    v_mfma_f32_32x32x16_bf16 v[64:79], v[196:199], a[244:247], v[64:79]
    ds_read_b64_tr_b16 v[214:215], v3 offset:32000
    s_waitcnt lgkmcnt(6)
    v_mfma_f32_32x32x16_bf16 v[144:159], v[200:203], a[240:243], v[144:159]
    ds_read_b64_tr_b16 v[192:193], v4 offset:28672
    ds_read_b64_tr_b16 v[194:195], v4 offset:29184
    buffer_load_dwordx4 v8, s[8:11], s50 offen offset:1024 lds
    s_waitcnt vmcnt(10) lgkmcnt(4)
    v_mfma_f32_32x32x16_bf16 v[16:31], v[204:207], a[248:251], v[16:31]
    ds_read_b64_tr_b16 v[196:197], v5 offset:28672
    v_mfma_f32_32x32x16_bf16 v[32:47], v[204:207], a[252:255], v[32:47]
    ds_read_b64_tr_b16 v[198:199], v5 offset:29184
    buffer_load_dwordx4 v9, s[8:11], s50 offen offset:2048 lds
    v_mfma_f32_32x32x16_bf16 v[48:63], v[208:211], a[248:251], v[48:63]
    ds_read_b64_tr_b16 v[200:201], v3 offset:32768
    v_mfma_f32_32x32x16_bf16 v[64:79], v[208:211], a[252:255], v[64:79]
    ds_read_b64_tr_b16 v[202:203], v3 offset:33024
    s_add_u32 m0, s45, 102400
    s_add_u32 s50, s48, 884736
    buffer_load_dwordx4 v7, s[8:11], s50 offen offset:0 lds
    s_waitcnt lgkmcnt(6)
    v_mfma_f32_32x32x16_bf16 v[144:159], v[212:215], a[248:251], v[144:159]
    ds_read_b64_tr_b16 v[204:205], v4 offset:30720
    ds_read_b64_tr_b16 v[206:207], v4 offset:31232
    s_waitcnt vmcnt(10) lgkmcnt(4)
    v_mfma_f32_32x32x16_bf16 v[16:31], v[192:195], v[160:163], v[16:31]
    ds_read_b64_tr_b16 v[208:209], v5 offset:30720
    buffer_load_dwordx4 v8, s[8:11], s50 offen offset:1024 lds
    v_mfma_f32_32x32x16_bf16 v[32:47], v[192:195], v[164:167], v[32:47]
    ds_read_b64_tr_b16 v[210:211], v5 offset:31232
    v_mfma_f32_32x32x16_bf16 v[48:63], v[196:199], v[160:163], v[48:63]
    ds_read_b64_tr_b16 v[212:213], v3 offset:33792
    buffer_load_dwordx4 v9, s[8:11], s50 offen offset:2048 lds
    v_mfma_f32_32x32x16_bf16 v[64:79], v[196:199], v[164:167], v[64:79]
    ds_read_b64_tr_b16 v[214:215], v3 offset:34048
    s_waitcnt lgkmcnt(6)
    v_mfma_f32_32x32x16_bf16 v[144:159], v[200:203], v[160:163], v[144:159]
    ds_read_b64_tr_b16 v[192:193], v4 offset:32768
    ds_read_b64_tr_b16 v[194:195], v4 offset:33280
    s_add_u32 m0, s45, 114688
    s_add_u32 s50, s48, 1769472
    buffer_load_dwordx4 v7, s[8:11], s50 offen offset:0 lds
    s_waitcnt vmcnt(11) lgkmcnt(4)
    v_mfma_f32_32x32x16_bf16 v[16:31], v[204:207], v[168:171], v[16:31]
    ds_read_b64_tr_b16 v[196:197], v5 offset:32768
    v_mfma_f32_32x32x16_bf16 v[32:47], v[204:207], v[172:175], v[32:47]
    ds_read_b64_tr_b16 v[198:199], v5 offset:33280
    buffer_load_dwordx4 v8, s[8:11], s50 offen offset:1024 lds
    v_mfma_f32_32x32x16_bf16 v[48:63], v[208:211], v[168:171], v[48:63]
    ds_read_b64_tr_b16 v[200:201], v3 offset:34816
    v_mfma_f32_32x32x16_bf16 v[64:79], v[208:211], v[172:175], v[64:79]
    ds_read_b64_tr_b16 v[202:203], v3 offset:35072
    buffer_load_dwordx4 v9, s[8:11], s50 offen offset:2048 lds
    s_waitcnt lgkmcnt(6)
    v_mfma_f32_32x32x16_bf16 v[144:159], v[212:215], v[168:171], v[144:159]
    ds_read_b64_tr_b16 v[204:205], v4 offset:34816
    ds_read_b64_tr_b16 v[206:207], v4 offset:35328
    v_subrev_u32 v245, 61440, v1
    v_subrev_u32 v247, 61440, v2
    s_waitcnt vmcnt(11) lgkmcnt(4)
    v_mfma_f32_32x32x16_bf16 v[16:31], v[192:195], v[176:179], v[16:31]
    ds_read_b64_tr_b16 v[208:209], v5 offset:34816
    s_add_u32 m0, s45, 126976
    s_add_u32 s50, s48, 2654208
    buffer_load_dwordx4 v7, s[8:11], s50 offen offset:0 lds
    v_mfma_f32_32x32x16_bf16 v[32:47], v[192:195], v[180:183], v[32:47]
    ds_read_b64_tr_b16 v[210:211], v5 offset:35328
    v_mfma_f32_32x32x16_bf16 v[48:63], v[196:199], v[176:179], v[48:63]
    ds_read_b64_tr_b16 v[212:213], v3 offset:35840
    buffer_load_dwordx4 v8, s[8:11], s50 offen offset:1024 lds
    v_mfma_f32_32x32x16_bf16 v[64:79], v[196:199], v[180:183], v[64:79]
    ds_read_b64_tr_b16 v[214:215], v3 offset:36096
    s_waitcnt lgkmcnt(6)
    v_mfma_f32_32x32x16_bf16 v[144:159], v[200:203], v[176:179], v[144:159]
    s_waitcnt vmcnt(11) lgkmcnt(2)
    v_mfma_f32_32x32x16_bf16 v[16:31], v[204:207], v[184:187], v[16:31]
    buffer_load_dwordx4 v9, s[8:11], s50 offen offset:2048 lds
    v_mfma_f32_32x32x16_bf16 v[32:47], v[204:207], v[188:191], v[32:47]
    v_mfma_f32_32x32x16_bf16 v[48:63], v[208:211], v[184:187], v[48:63]
    v_mfma_f32_32x32x16_bf16 v[64:79], v[208:211], v[188:191], v[64:79]
    s_waitcnt lgkmcnt(0)
    v_mfma_f32_32x32x16_bf16 v[144:159], v[212:215], v[184:187], v[144:159]
    s_barrier
    v_add_u32 v222, 0, v255
    global_load_dword v254, v222, s[84:85]
    s_nop 2
    v_pk_fma_f32 v[224:225], v[16:17], v[16:17], s[52:53] op_sel_hi:[1,1,0] neg_lo:[1,0,1] neg_hi:[1,0,1]
    v_pk_fma_f32 v[226:227], v[18:19], v[18:19], s[52:53] op_sel_hi:[1,1,0] neg_lo:[1,0,1] neg_hi:[1,0,1]
    v_pk_mul_f32 v[224:225], v[224:225], v[16:17]
    v_pk_mul_f32 v[226:227], v[226:227], v[18:19]
    v_exp_f32 v224, v224
    v_exp_f32 v225, v225
    v_exp_f32 v226, v226
    v_exp_f32 v227, v227
    v_pk_add_f32 v[224:225], v[224:225], 1.0 op_sel_hi:[1,0]
    v_pk_add_f32 v[226:227], v[226:227], 1.0 op_sel_hi:[1,0]
    v_rcp_f32 v224, v224
    v_rcp_f32 v225, v225
    v_rcp_f32 v226, v226
    v_rcp_f32 v227, v227
    v_pk_mul_f32 v[224:225], v[224:225], v[16:17]
    v_pk_mul_f32 v[226:227], v[226:227], v[18:19]
    v_add_f32 v216, v216, v224
    v_fmac_f32 v217, v224, v224
    v_add_f32 v216, v216, v225
    v_fmac_f32 v217, v225, v225
    v_add_f32 v216, v216, v226
    v_fmac_f32 v217, v226, v226
    v_add_f32 v216, v216, v227
    v_fmac_f32 v217, v227, v227
    v_cvt_pk_bf16_f32 v16, v224, v225
    v_cvt_pk_bf16_f32 v17, v226, v227
    s_add_u32 m0, s45, 139264
    s_add_u32 s50, s48, 3538944
    buffer_load_dwordx4 v7, s[8:11], s50 offen offset:0 lds
    buffer_load_dwordx4 v8, s[8:11], s50 offen offset:1024 lds
    buffer_load_dwordx4 v9, s[8:11], s50 offen offset:2048 lds
    v_pk_fma_f32 v[228:229], v[20:21], v[20:21], s[52:53] op_sel_hi:[1,1,0] neg_lo:[1,0,1] neg_hi:[1,0,1]
    v_pk_fma_f32 v[230:231], v[22:23], v[22:23], s[52:53] op_sel_hi:[1,1,0] neg_lo:[1,0,1] neg_hi:[1,0,1]
    v_pk_mul_f32 v[228:229], v[228:229], v[20:21]
    v_pk_mul_f32 v[230:231], v[230:231], v[22:23]
    v_exp_f32 v228, v228
    v_exp_f32 v229, v229
    v_exp_f32 v230, v230
    v_exp_f32 v231, v231
    v_pk_add_f32 v[228:229], v[228:229], 1.0 op_sel_hi:[1,0]
    v_pk_add_f32 v[230:231], v[230:231], 1.0 op_sel_hi:[1,0]
    v_rcp_f32 v228, v228
    v_rcp_f32 v229, v229
    v_rcp_f32 v230, v230
    v_rcp_f32 v231, v231
    v_pk_mul_f32 v[228:229], v[228:229], v[20:21]
    v_pk_mul_f32 v[230:231], v[230:231], v[22:23]
    v_add_f32 v216, v216, v228
    v_fmac_f32 v217, v228, v228
    v_add_f32 v216, v216, v229
    v_fmac_f32 v217, v229, v229
    v_add_f32 v216, v216, v230
    v_fmac_f32 v217, v230, v230
    v_add_f32 v216, v216, v231
    v_fmac_f32 v217, v231, v231
    v_cvt_pk_bf16_f32 v18, v228, v229
    v_cvt_pk_bf16_f32 v19, v230, v231
    v_add_u32 v222, 2097152, v255
    global_load_dword v254, v222, s[84:85]
    v_pk_fma_f32 v[224:225], v[24:25], v[24:25], s[52:53] op_sel_hi:[1,1,0] neg_lo:[1,0,1] neg_hi:[1,0,1]
    v_pk_fma_f32 v[226:227], v[26:27], v[26:27], s[52:53] op_sel_hi:[1,1,0] neg_lo:[1,0,1] neg_hi:[1,0,1]
    v_pk_mul_f32 v[224:225], v[224:225], v[24:25]
    v_pk_mul_f32 v[226:227], v[226:227], v[26:27]
    v_exp_f32 v224, v224
    v_exp_f32 v225, v225
    v_exp_f32 v226, v226
    v_exp_f32 v227, v227
    v_pk_add_f32 v[224:225], v[224:225], 1.0 op_sel_hi:[1,0]
    v_pk_add_f32 v[226:227], v[226:227], 1.0 op_sel_hi:[1,0]
    v_rcp_f32 v224, v224
    v_rcp_f32 v225, v225
    v_rcp_f32 v226, v226
    v_rcp_f32 v227, v227
    v_pk_mul_f32 v[224:225], v[224:225], v[24:25]
    v_pk_mul_f32 v[226:227], v[226:227], v[26:27]
    v_add_f32 v216, v216, v224
    v_fmac_f32 v217, v224, v224
    v_add_f32 v216, v216, v225
    v_fmac_f32 v217, v225, v225
    v_add_f32 v216, v216, v226
    v_fmac_f32 v217, v226, v226
    v_add_f32 v216, v216, v227
    v_fmac_f32 v217, v227, v227
    v_cvt_pk_bf16_f32 v20, v224, v225
    v_cvt_pk_bf16_f32 v21, v226, v227
    s_add_u32 m0, s45, 151552
    s_add_u32 s50, s48, 4423680
    buffer_load_dwordx4 v7, s[8:11], s50 offen offset:0 lds
    buffer_load_dwordx4 v8, s[8:11], s50 offen offset:1024 lds
    buffer_load_dwordx4 v9, s[8:11], s50 offen offset:2048 lds
    v_pk_fma_f32 v[228:229], v[28:29], v[28:29], s[52:53] op_sel_hi:[1,1,0] neg_lo:[1,0,1] neg_hi:[1,0,1]
    v_pk_fma_f32 v[230:231], v[30:31], v[30:31], s[52:53] op_sel_hi:[1,1,0] neg_lo:[1,0,1] neg_hi:[1,0,1]
    v_pk_mul_f32 v[228:229], v[228:229], v[28:29]
    v_pk_mul_f32 v[230:231], v[230:231], v[30:31]
    v_exp_f32 v228, v228
    v_exp_f32 v229, v229
    v_exp_f32 v230, v230
    v_exp_f32 v231, v231
    v_pk_add_f32 v[228:229], v[228:229], 1.0 op_sel_hi:[1,0]
    v_pk_add_f32 v[230:231], v[230:231], 1.0 op_sel_hi:[1,0]
    v_rcp_f32 v228, v228
    v_rcp_f32 v229, v229
    v_rcp_f32 v230, v230
    v_rcp_f32 v231, v231
    v_pk_mul_f32 v[228:229], v[228:229], v[28:29]
    v_pk_mul_f32 v[230:231], v[230:231], v[30:31]
    v_add_f32 v216, v216, v228
    v_fmac_f32 v217, v228, v228
    v_add_f32 v216, v216, v229
    v_fmac_f32 v217, v229, v229
    v_add_f32 v216, v216, v230
    v_fmac_f32 v217, v230, v230
    v_add_f32 v216, v216, v231
    v_fmac_f32 v217, v231, v231
    v_cvt_pk_bf16_f32 v22, v228, v229
    v_cvt_pk_bf16_f32 v23, v230, v231
    v_add_u32 v222, 4194304, v255
    global_load_dword v254, v222, s[84:85]
    v_pk_fma_f32 v[224:225], v[32:33], v[32:33], s[52:53] op_sel_hi:[1,1,0] neg_lo:[1,0,1] neg_hi:[1,0,1]
    v_pk_fma_f32 v[226:227], v[34:35], v[34:35], s[52:53] op_sel_hi:[1,1,0] neg_lo:[1,0,1] neg_hi:[1,0,1]
    v_pk_mul_f32 v[224:225], v[224:225], v[32:33]
    v_pk_mul_f32 v[226:227], v[226:227], v[34:35]
    v_exp_f32 v224, v224
    v_exp_f32 v225, v225
    v_exp_f32 v226, v226
    v_exp_f32 v227, v227
    v_pk_add_f32 v[224:225], v[224:225], 1.0 op_sel_hi:[1,0]
    v_pk_add_f32 v[226:227], v[226:227], 1.0 op_sel_hi:[1,0]
    v_rcp_f32 v224, v224
    v_rcp_f32 v225, v225
    v_rcp_f32 v226, v226
    v_rcp_f32 v227, v227
    v_pk_mul_f32 v[224:225], v[224:225], v[32:33]
    v_pk_mul_f32 v[226:227], v[226:227], v[34:35]
    v_add_f32 v218, v218, v224
    v_fmac_f32 v219, v224, v224
    v_add_f32 v218, v218, v225
    v_fmac_f32 v219, v225, v225
    v_add_f32 v218, v218, v226
    v_fmac_f32 v219, v226, v226
    v_add_f32 v218, v218, v227
    v_fmac_f32 v219, v227, v227
    v_cvt_pk_bf16_f32 v24, v224, v225
    v_cvt_pk_bf16_f32 v25, v226, v227
    v_pk_fma_f32 v[228:229], v[36:37], v[36:37], s[52:53] op_sel_hi:[1,1,0] neg_lo:[1,0,1] neg_hi:[1,0,1]
    v_pk_fma_f32 v[230:231], v[38:39], v[38:39], s[52:53] op_sel_hi:[1,1,0] neg_lo:[1,0,1] neg_hi:[1,0,1]
    v_pk_mul_f32 v[228:229], v[228:229], v[36:37]
    v_pk_mul_f32 v[230:231], v[230:231], v[38:39]
    v_exp_f32 v228, v228
    v_exp_f32 v229, v229
    v_exp_f32 v230, v230
    v_exp_f32 v231, v231
    v_pk_add_f32 v[228:229], v[228:229], 1.0 op_sel_hi:[1,0]
    v_pk_add_f32 v[230:231], v[230:231], 1.0 op_sel_hi:[1,0]
    v_rcp_f32 v228, v228
    v_rcp_f32 v229, v229
    v_rcp_f32 v230, v230
    v_rcp_f32 v231, v231
    v_pk_mul_f32 v[228:229], v[228:229], v[36:37]
    v_pk_mul_f32 v[230:231], v[230:231], v[38:39]
    v_add_f32 v218, v218, v228
    v_fmac_f32 v219, v228, v228
    v_add_f32 v218, v218, v229
    v_fmac_f32 v219, v229, v229
    v_add_f32 v218, v218, v230
    v_fmac_f32 v219, v230, v230
    v_add_f32 v218, v218, v231
    v_fmac_f32 v219, v231, v231
    v_cvt_pk_bf16_f32 v26, v228, v229
    v_cvt_pk_bf16_f32 v27, v230, v231
    v_add_u32 v222, 6291456, v255
    global_load_dword v254, v222, s[84:85]
    v_pk_fma_f32 v[224:225], v[40:41], v[40:41], s[52:53] op_sel_hi:[1,1,0] neg_lo:[1,0,1] neg_hi:[1,0,1]
    v_pk_fma_f32 v[226:227], v[42:43], v[42:43], s[52:53] op_sel_hi:[1,1,0] neg_lo:[1,0,1] neg_hi:[1,0,1]
    v_pk_mul_f32 v[224:225], v[224:225], v[40:41]
    v_pk_mul_f32 v[226:227], v[226:227], v[42:43]
    v_exp_f32 v224, v224
    v_exp_f32 v225, v225
    v_exp_f32 v226, v226
    v_exp_f32 v227, v227
    v_pk_add_f32 v[224:225], v[224:225], 1.0 op_sel_hi:[1,0]
    v_pk_add_f32 v[226:227], v[226:227], 1.0 op_sel_hi:[1,0]
    v_rcp_f32 v224, v224
    v_rcp_f32 v225, v225
    v_rcp_f32 v226, v226
    v_rcp_f32 v227, v227
    v_pk_mul_f32 v[224:225], v[224:225], v[40:41]
    v_pk_mul_f32 v[226:227], v[226:227], v[42:43]
    v_add_f32 v218, v218, v224
    v_fmac_f32 v219, v224, v224
    v_add_f32 v218, v218, v225
    v_fmac_f32 v219, v225, v225
    v_add_f32 v218, v218, v226
    v_fmac_f32 v219, v226, v226
    v_add_f32 v218, v218, v227
    v_fmac_f32 v219, v227, v227
    v_cvt_pk_bf16_f32 v28, v224, v225
    v_cvt_pk_bf16_f32 v29, v226, v227
    v_pk_fma_f32 v[228:229], v[44:45], v[44:45], s[52:53] op_sel_hi:[1,1,0] neg_lo:[1,0,1] neg_hi:[1,0,1]
    v_pk_fma_f32 v[230:231], v[46:47], v[46:47], s[52:53] op_sel_hi:[1,1,0] neg_lo:[1,0,1] neg_hi:[1,0,1]
    v_pk_mul_f32 v[228:229], v[228:229], v[44:45]
    v_pk_mul_f32 v[230:231], v[230:231], v[46:47]
    v_exp_f32 v228, v228
    v_exp_f32 v229, v229
    v_exp_f32 v230, v230
    v_exp_f32 v231, v231
    v_pk_add_f32 v[228:229], v[228:229], 1.0 op_sel_hi:[1,0]
    v_pk_add_f32 v[230:231], v[230:231], 1.0 op_sel_hi:[1,0]
    v_rcp_f32 v228, v228
    v_rcp_f32 v229, v229
    v_rcp_f32 v230, v230
    v_rcp_f32 v231, v231
    v_pk_mul_f32 v[228:229], v[228:229], v[44:45]
    v_pk_mul_f32 v[230:231], v[230:231], v[46:47]
    v_add_f32 v218, v218, v228
    v_fmac_f32 v219, v228, v228
    v_add_f32 v218, v218, v229
    v_fmac_f32 v219, v229, v229
    v_add_f32 v218, v218, v230
    v_fmac_f32 v219, v230, v230
    v_add_f32 v218, v218, v231
    v_fmac_f32 v219, v231, v231
    v_cvt_pk_bf16_f32 v30, v228, v229
    v_cvt_pk_bf16_f32 v31, v230, v231
    global_load_dword v254, v255, s[86:87]
    v_pk_fma_f32 v[224:225], v[48:49], v[48:49], s[52:53] op_sel_hi:[1,1,0] neg_lo:[1,0,1] neg_hi:[1,0,1]
    v_pk_fma_f32 v[226:227], v[50:51], v[50:51], s[52:53] op_sel_hi:[1,1,0] neg_lo:[1,0,1] neg_hi:[1,0,1]
    v_pk_mul_f32 v[224:225], v[224:225], v[48:49]
    v_pk_mul_f32 v[226:227], v[226:227], v[50:51]
    v_exp_f32 v224, v224
    v_exp_f32 v225, v225
    v_exp_f32 v226, v226
    v_exp_f32 v227, v227
    v_pk_add_f32 v[224:225], v[224:225], 1.0 op_sel_hi:[1,0]
    v_pk_add_f32 v[226:227], v[226:227], 1.0 op_sel_hi:[1,0]
    v_rcp_f32 v224, v224
    v_rcp_f32 v225, v225
    v_rcp_f32 v226, v226
    v_rcp_f32 v227, v227
    v_pk_mul_f32 v[224:225], v[224:225], v[48:49]
    v_pk_mul_f32 v[226:227], v[226:227], v[50:51]
    v_add_f32 v216, v216, v224
    v_fmac_f32 v217, v224, v224
    v_add_f32 v216, v216, v225
    v_fmac_f32 v217, v225, v225
    v_add_f32 v216, v216, v226
    v_fmac_f32 v217, v226, v226
    v_add_f32 v216, v216, v227
    v_fmac_f32 v217, v227, v227
    v_cvt_pk_bf16_f32 v32, v224, v225
    v_cvt_pk_bf16_f32 v33, v226, v227
    v_pk_fma_f32 v[228:229], v[52:53], v[52:53], s[52:53] op_sel_hi:[1,1,0] neg_lo:[1,0,1] neg_hi:[1,0,1]
    v_pk_fma_f32 v[230:231], v[54:55], v[54:55], s[52:53] op_sel_hi:[1,1,0] neg_lo:[1,0,1] neg_hi:[1,0,1]
    v_pk_mul_f32 v[228:229], v[228:229], v[52:53]
    v_pk_mul_f32 v[230:231], v[230:231], v[54:55]
    v_exp_f32 v228, v228
    v_exp_f32 v229, v229
    v_exp_f32 v230, v230
    v_exp_f32 v231, v231
    v_pk_add_f32 v[228:229], v[228:229], 1.0 op_sel_hi:[1,0]
    v_pk_add_f32 v[230:231], v[230:231], 1.0 op_sel_hi:[1,0]
    v_rcp_f32 v228, v228
    v_rcp_f32 v229, v229
    v_rcp_f32 v230, v230
    v_rcp_f32 v231, v231
    v_pk_mul_f32 v[228:229], v[228:229], v[52:53]
    v_pk_mul_f32 v[230:231], v[230:231], v[54:55]
    v_add_f32 v216, v216, v228
    v_fmac_f32 v217, v228, v228
    v_add_f32 v216, v216, v229
    v_fmac_f32 v217, v229, v229
    v_add_f32 v216, v216, v230
    v_fmac_f32 v217, v230, v230
    v_add_f32 v216, v216, v231
    v_fmac_f32 v217, v231, v231
    v_cvt_pk_bf16_f32 v34, v228, v229
    v_cvt_pk_bf16_f32 v35, v230, v231
    v_lshrrev_b32 v255, 1, v255
    v_add_u32 v222, 2097152, v255
    v_min_u32 v222, 2654204, v222
    global_load_dword v254, v222, s[86:87]
    v_pk_fma_f32 v[224:225], v[56:57], v[56:57], s[52:53] op_sel_hi:[1,1,0] neg_lo:[1,0,1] neg_hi:[1,0,1]
    v_pk_fma_f32 v[226:227], v[58:59], v[58:59], s[52:53] op_sel_hi:[1,1,0] neg_lo:[1,0,1] neg_hi:[1,0,1]
    v_pk_mul_f32 v[224:225], v[224:225], v[56:57]
    v_pk_mul_f32 v[226:227], v[226:227], v[58:59]
    v_exp_f32 v224, v224
    v_exp_f32 v225, v225
    v_exp_f32 v226, v226
    v_exp_f32 v227, v227
    v_pk_add_f32 v[224:225], v[224:225], 1.0 op_sel_hi:[1,0]
    v_pk_add_f32 v[226:227], v[226:227], 1.0 op_sel_hi:[1,0]
    v_rcp_f32 v224, v224
    v_rcp_f32 v225, v225
    v_rcp_f32 v226, v226
    v_rcp_f32 v227, v227
    v_pk_mul_f32 v[224:225], v[224:225], v[56:57]
    v_pk_mul_f32 v[226:227], v[226:227], v[58:59]
    v_add_f32 v216, v216, v224
    v_fmac_f32 v217, v224, v224
    v_add_f32 v216, v216, v225
    v_fmac_f32 v217, v225, v225
    v_add_f32 v216, v216, v226
    v_fmac_f32 v217, v226, v226
    v_add_f32 v216, v216, v227
    v_fmac_f32 v217, v227, v227
    v_cvt_pk_bf16_f32 v36, v224, v225
    v_cvt_pk_bf16_f32 v37, v226, v227
    v_pk_fma_f32 v[228:229], v[60:61], v[60:61], s[52:53] op_sel_hi:[1,1,0] neg_lo:[1,0,1] neg_hi:[1,0,1]
    v_pk_fma_f32 v[230:231], v[62:63], v[62:63], s[52:53] op_sel_hi:[1,1,0] neg_lo:[1,0,1] neg_hi:[1,0,1]
    v_pk_mul_f32 v[228:229], v[228:229], v[60:61]
    v_pk_mul_f32 v[230:231], v[230:231], v[62:63]
    v_exp_f32 v228, v228
    v_exp_f32 v229, v229
    v_exp_f32 v230, v230
    v_exp_f32 v231, v231
    v_pk_add_f32 v[228:229], v[228:229], 1.0 op_sel_hi:[1,0]
    v_pk_add_f32 v[230:231], v[230:231], 1.0 op_sel_hi:[1,0]
    v_rcp_f32 v228, v228
    v_rcp_f32 v229, v229
    v_rcp_f32 v230, v230
    v_rcp_f32 v231, v231
    v_pk_mul_f32 v[228:229], v[228:229], v[60:61]
    v_pk_mul_f32 v[230:231], v[230:231], v[62:63]
    v_add_f32 v216, v216, v228
    v_fmac_f32 v217, v228, v228
    v_add_f32 v216, v216, v229
    v_fmac_f32 v217, v229, v229
    v_add_f32 v216, v216, v230
    v_fmac_f32 v217, v230, v230
    v_add_f32 v216, v216, v231
    v_fmac_f32 v217, v231, v231
    v_cvt_pk_bf16_f32 v38, v228, v229
    v_cvt_pk_bf16_f32 v39, v230, v231
    v_min_u32 v222, 663548, v255
    global_load_dword v254, v222, s[88:89]
    v_pk_fma_f32 v[224:225], v[64:65], v[64:65], s[52:53] op_sel_hi:[1,1,0] neg_lo:[1,0,1] neg_hi:[1,0,1]
    v_pk_fma_f32 v[226:227], v[66:67], v[66:67], s[52:53] op_sel_hi:[1,1,0] neg_lo:[1,0,1] neg_hi:[1,0,1]
    v_pk_mul_f32 v[224:225], v[224:225], v[64:65]
    v_pk_mul_f32 v[226:227], v[226:227], v[66:67]
    v_exp_f32 v224, v224
    v_exp_f32 v225, v225
    v_exp_f32 v226, v226
    v_exp_f32 v227, v227
    v_pk_add_f32 v[224:225], v[224:225], 1.0 op_sel_hi:[1,0]
    v_pk_add_f32 v[226:227], v[226:227], 1.0 op_sel_hi:[1,0]
    v_rcp_f32 v224, v224
    v_rcp_f32 v225, v225
    v_rcp_f32 v226, v226
    v_rcp_f32 v227, v227
    v_pk_mul_f32 v[224:225], v[224:225], v[64:65]
    v_pk_mul_f32 v[226:227], v[226:227], v[66:67]
    v_add_f32 v218, v218, v224
    v_fmac_f32 v219, v224, v224
    v_add_f32 v218, v218, v225
    v_fmac_f32 v219, v225, v225
    v_add_f32 v218, v218, v226
    v_fmac_f32 v219, v226, v226
    v_add_f32 v218, v218, v227
    v_fmac_f32 v219, v227, v227
    v_cvt_pk_bf16_f32 v40, v224, v225
    v_cvt_pk_bf16_f32 v41, v226, v227
    v_pk_fma_f32 v[228:229], v[68:69], v[68:69], s[52:53] op_sel_hi:[1,1,0] neg_lo:[1,0,1] neg_hi:[1,0,1]
    v_pk_fma_f32 v[230:231], v[70:71], v[70:71], s[52:53] op_sel_hi:[1,1,0] neg_lo:[1,0,1] neg_hi:[1,0,1]
    v_pk_mul_f32 v[228:229], v[228:229], v[68:69]
    v_pk_mul_f32 v[230:231], v[230:231], v[70:71]
    v_exp_f32 v228, v228
    v_exp_f32 v229, v229
    v_exp_f32 v230, v230
    v_exp_f32 v231, v231
    v_pk_add_f32 v[228:229], v[228:229], 1.0 op_sel_hi:[1,0]
    v_pk_add_f32 v[230:231], v[230:231], 1.0 op_sel_hi:[1,0]
    v_rcp_f32 v228, v228
    v_rcp_f32 v229, v229
    v_rcp_f32 v230, v230
    v_rcp_f32 v231, v231
    v_pk_mul_f32 v[228:229], v[228:229], v[68:69]
    v_pk_mul_f32 v[230:231], v[230:231], v[70:71]
    v_add_f32 v218, v218, v228
    v_fmac_f32 v219, v228, v228
    v_add_f32 v218, v218, v229
    v_fmac_f32 v219, v229, v229
    v_add_f32 v218, v218, v230
    v_fmac_f32 v219, v230, v230
    v_add_f32 v218, v218, v231
    v_fmac_f32 v219, v231, v231
    v_cvt_pk_bf16_f32 v42, v228, v229
    v_cvt_pk_bf16_f32 v43, v230, v231
    v_pk_fma_f32 v[224:225], v[72:73], v[72:73], s[52:53] op_sel_hi:[1,1,0] neg_lo:[1,0,1] neg_hi:[1,0,1]
    v_pk_fma_f32 v[226:227], v[74:75], v[74:75], s[52:53] op_sel_hi:[1,1,0] neg_lo:[1,0,1] neg_hi:[1,0,1]
    v_pk_mul_f32 v[224:225], v[224:225], v[72:73]
    v_pk_mul_f32 v[226:227], v[226:227], v[74:75]
    v_exp_f32 v224, v224
    v_exp_f32 v225, v225
    v_exp_f32 v226, v226
    v_exp_f32 v227, v227
    v_pk_add_f32 v[224:225], v[224:225], 1.0 op_sel_hi:[1,0]
    v_pk_add_f32 v[226:227], v[226:227], 1.0 op_sel_hi:[1,0]
    v_rcp_f32 v224, v224
    v_rcp_f32 v225, v225
    v_rcp_f32 v226, v226
    v_rcp_f32 v227, v227
    v_pk_mul_f32 v[224:225], v[224:225], v[72:73]
    v_pk_mul_f32 v[226:227], v[226:227], v[74:75]
    v_add_f32 v218, v218, v224
    v_fmac_f32 v219, v224, v224
    v_add_f32 v218, v218, v225
    v_fmac_f32 v219, v225, v225
    v_add_f32 v218, v218, v226
    v_fmac_f32 v219, v226, v226
    v_add_f32 v218, v218, v227
    v_fmac_f32 v219, v227, v227
    v_cvt_pk_bf16_f32 v44, v224, v225
    v_cvt_pk_bf16_f32 v45, v226, v227
    v_pk_fma_f32 v[228:229], v[76:77], v[76:77], s[52:53] op_sel_hi:[1,1,0] neg_lo:[1,0,1] neg_hi:[1,0,1]
    v_pk_fma_f32 v[230:231], v[78:79], v[78:79], s[52:53] op_sel_hi:[1,1,0] neg_lo:[1,0,1] neg_hi:[1,0,1]
    v_pk_mul_f32 v[228:229], v[228:229], v[76:77]
    v_pk_mul_f32 v[230:231], v[230:231], v[78:79]
    v_exp_f32 v228, v228
    v_exp_f32 v229, v229
    v_exp_f32 v230, v230
    v_exp_f32 v231, v231
    v_pk_add_f32 v[228:229], v[228:229], 1.0 op_sel_hi:[1,0]
    v_pk_add_f32 v[230:231], v[230:231], 1.0 op_sel_hi:[1,0]
    v_rcp_f32 v228, v228
    v_rcp_f32 v229, v229
    v_rcp_f32 v230, v230
    v_rcp_f32 v231, v231
    v_pk_mul_f32 v[228:229], v[228:229], v[76:77]
    v_pk_mul_f32 v[230:231], v[230:231], v[78:79]
    v_add_f32 v218, v218, v228
    v_fmac_f32 v219, v228, v228
    v_add_f32 v218, v218, v229
    v_fmac_f32 v219, v229, v229
    v_add_f32 v218, v218, v230
    v_fmac_f32 v219, v230, v230
    v_add_f32 v218, v218, v231
    v_fmac_f32 v219, v231, v231
    v_cvt_pk_bf16_f32 v46, v228, v229
    v_cvt_pk_bf16_f32 v47, v230, v231
    v_pk_fma_f32 v[224:225], v[144:145], v[144:145], s[52:53] op_sel_hi:[1,1,0] neg_lo:[1,0,1] neg_hi:[1,0,1]
    v_pk_fma_f32 v[226:227], v[146:147], v[146:147], s[52:53] op_sel_hi:[1,1,0] neg_lo:[1,0,1] neg_hi:[1,0,1]
    v_pk_mul_f32 v[224:225], v[224:225], v[144:145]
    v_pk_mul_f32 v[226:227], v[226:227], v[146:147]
    v_exp_f32 v224, v224
    v_exp_f32 v225, v225
    v_exp_f32 v226, v226
    v_exp_f32 v227, v227
    v_pk_add_f32 v[224:225], v[224:225], 1.0 op_sel_hi:[1,0]
    v_pk_add_f32 v[226:227], v[226:227], 1.0 op_sel_hi:[1,0]
    v_rcp_f32 v224, v224
    v_rcp_f32 v225, v225
    v_rcp_f32 v226, v226
    v_rcp_f32 v227, v227
    v_pk_mul_f32 v[224:225], v[224:225], v[144:145]
    v_pk_mul_f32 v[226:227], v[226:227], v[146:147]
    v_add_f32 v220, v220, v224
    v_fmac_f32 v221, v224, v224
    v_add_f32 v220, v220, v225
    v_fmac_f32 v221, v225, v225
    v_add_f32 v220, v220, v226
    v_fmac_f32 v221, v226, v226
    v_add_f32 v220, v220, v227
    v_fmac_f32 v221, v227, v227
    v_cvt_pk_bf16_f32 v144, v224, v225
    v_cvt_pk_bf16_f32 v145, v226, v227
    v_pk_fma_f32 v[228:229], v[148:149], v[148:149], s[52:53] op_sel_hi:[1,1,0] neg_lo:[1,0,1] neg_hi:[1,0,1]
    v_pk_fma_f32 v[230:231], v[150:151], v[150:151], s[52:53] op_sel_hi:[1,1,0] neg_lo:[1,0,1] neg_hi:[1,0,1]
    v_pk_mul_f32 v[228:229], v[228:229], v[148:149]
    v_pk_mul_f32 v[230:231], v[230:231], v[150:151]
    v_exp_f32 v228, v228
    v_exp_f32 v229, v229
    v_exp_f32 v230, v230
    v_exp_f32 v231, v231
    v_pk_add_f32 v[228:229], v[228:229], 1.0 op_sel_hi:[1,0]
    v_pk_add_f32 v[230:231], v[230:231], 1.0 op_sel_hi:[1,0]
    v_rcp_f32 v228, v228
    v_rcp_f32 v229, v229
    v_rcp_f32 v230, v230
    v_rcp_f32 v231, v231
    v_pk_mul_f32 v[228:229], v[228:229], v[148:149]
    v_pk_mul_f32 v[230:231], v[230:231], v[150:151]
    v_add_f32 v220, v220, v228
    v_fmac_f32 v221, v228, v228
    v_add_f32 v220, v220, v229
    v_fmac_f32 v221, v229, v229
    v_add_f32 v220, v220, v230
    v_fmac_f32 v221, v230, v230
    v_add_f32 v220, v220, v231
    v_fmac_f32 v221, v231, v231
    v_cvt_pk_bf16_f32 v146, v228, v229
    v_cvt_pk_bf16_f32 v147, v230, v231
    buffer_store_dwordx4 v[144:147], v11, s[32:35], s56 offen offset:0 sc1
    v_pk_fma_f32 v[224:225], v[152:153], v[152:153], s[52:53] op_sel_hi:[1,1,0] neg_lo:[1,0,1] neg_hi:[1,0,1]
    v_pk_fma_f32 v[226:227], v[154:155], v[154:155], s[52:53] op_sel_hi:[1,1,0] neg_lo:[1,0,1] neg_hi:[1,0,1]
    v_pk_mul_f32 v[224:225], v[224:225], v[152:153]
    v_pk_mul_f32 v[226:227], v[226:227], v[154:155]
    v_exp_f32 v224, v224
    v_exp_f32 v225, v225
    v_exp_f32 v226, v226
    v_exp_f32 v227, v227
    v_pk_add_f32 v[224:225], v[224:225], 1.0 op_sel_hi:[1,0]
    v_pk_add_f32 v[226:227], v[226:227], 1.0 op_sel_hi:[1,0]
    v_rcp_f32 v224, v224
    v_rcp_f32 v225, v225
    v_rcp_f32 v226, v226
    v_rcp_f32 v227, v227
    v_pk_mul_f32 v[224:225], v[224:225], v[152:153]
    v_pk_mul_f32 v[226:227], v[226:227], v[154:155]
    v_add_f32 v220, v220, v224
    v_fmac_f32 v221, v224, v224
    v_add_f32 v220, v220, v225
    v_fmac_f32 v221, v225, v225
    v_add_f32 v220, v220, v226
    v_fmac_f32 v221, v226, v226
    v_add_f32 v220, v220, v227
    v_fmac_f32 v221, v227, v227
    v_cvt_pk_bf16_f32 v148, v224, v225
    v_cvt_pk_bf16_f32 v149, v226, v227
    v_pk_fma_f32 v[228:229], v[156:157], v[156:157], s[52:53] op_sel_hi:[1,1,0] neg_lo:[1,0,1] neg_hi:[1,0,1]
    v_pk_fma_f32 v[230:231], v[158:159], v[158:159], s[52:53] op_sel_hi:[1,1,0] neg_lo:[1,0,1] neg_hi:[1,0,1]
    v_pk_mul_f32 v[228:229], v[228:229], v[156:157]
    v_pk_mul_f32 v[230:231], v[230:231], v[158:159]
    v_exp_f32 v228, v228
    v_exp_f32 v229, v229
    v_exp_f32 v230, v230
    v_exp_f32 v231, v231
    v_pk_add_f32 v[228:229], v[228:229], 1.0 op_sel_hi:[1,0]
    v_pk_add_f32 v[230:231], v[230:231], 1.0 op_sel_hi:[1,0]
    v_rcp_f32 v228, v228
    v_rcp_f32 v229, v229
    v_rcp_f32 v230, v230
    v_rcp_f32 v231, v231
    v_pk_mul_f32 v[228:229], v[228:229], v[156:157]
    v_pk_mul_f32 v[230:231], v[230:231], v[158:159]
    v_add_f32 v220, v220, v228
    v_fmac_f32 v221, v228, v228
    v_add_f32 v220, v220, v229
    v_fmac_f32 v221, v229, v229
    v_add_f32 v220, v220, v230
    v_fmac_f32 v221, v230, v230
    v_add_f32 v220, v220, v231
    v_fmac_f32 v221, v231, v231
    v_cvt_pk_bf16_f32 v150, v228, v229
    v_cvt_pk_bf16_f32 v151, v230, v231
    buffer_store_dwordx4 v[148:151], v11, s[32:35], s56 offen offset:256 sc1
    v_fma_f32 v216, v220, s53, v216
    v_fma_f32 v217, v221, s53, v217
    v_permlane32_swap_b32 v218, v219
    s_nop 0
    v_permlane32_swap_b32 v216, v217
    v_add_f32 v216, v216, v217
    v_add_f32 v218, v218, v219
    buffer_atomic_add_f32 v216, v13, s[28:31], s59 offen offset:0
    buffer_atomic_add_f32 v218, v13, s[28:31], s59 offen offset:256
    s_waitcnt vmcnt(9)
    s_barrier
    ds_read_b64_tr_b16 v[192:193], v1 offset:24576
    ds_read_b64_tr_b16 v[194:195], v1 offset:25088
    ds_read_b64_tr_b16 v[196:197], v1 offset:26624
    ds_read_b64_tr_b16 v[198:199], v1 offset:27136
    ds_read_b64_tr_b16 v[200:201], v1 offset:28672
    ds_read_b64_tr_b16 v[202:203], v1 offset:29184
    ds_read_b64_tr_b16 v[204:205], v1 offset:30720
    ds_read_b64_tr_b16 v[206:207], v1 offset:31232
    s_waitcnt lgkmcnt(4)
    v_mfma_f32_32x32x16_bf16 v[48:63], v[192:195], a[0:3], 0
    ds_read_b64_tr_b16 v[208:209], v1 offset:32768
    v_mfma_f32_32x32x16_bf16 v[64:79], v[192:195], a[4:7], 0
    ds_read_b64_tr_b16 v[210:211], v1 offset:33280
    v_mfma_f32_32x32x16_bf16 v[48:63], v[196:199], a[8:11], v[48:63]
    ds_read_b64_tr_b16 v[212:213], v1 offset:34816
    v_mfma_f32_32x32x16_bf16 v[64:79], v[196:199], a[12:15], v[64:79]
    ds_read_b64_tr_b16 v[214:215], v1 offset:35328
    s_waitcnt lgkmcnt(4)
    v_mfma_f32_32x32x16_bf16 v[48:63], v[200:203], a[16:19], v[48:63]
    ds_read_b64_tr_b16 v[192:193], v1 offset:36864
    v_mfma_f32_32x32x16_bf16 v[64:79], v[200:203], a[20:23], v[64:79]
    ds_read_b64_tr_b16 v[194:195], v1 offset:37376
    v_mfma_f32_32x32x16_bf16 v[48:63], v[204:207], a[24:27], v[48:63]
    ds_read_b64_tr_b16 v[196:197], v1 offset:38912
    v_mfma_f32_32x32x16_bf16 v[64:79], v[204:207], a[28:31], v[64:79]
    ds_read_b64_tr_b16 v[198:199], v1 offset:39424
    s_waitcnt lgkmcnt(4)
    v_mfma_f32_32x32x16_bf16 v[48:63], v[208:211], a[32:35], v[48:63]
    ds_read_b64_tr_b16 v[200:201], v1 offset:40960
    v_mfma_f32_32x32x16_bf16 v[64:79], v[208:211], a[36:39], v[64:79]
    ds_read_b64_tr_b16 v[202:203], v1 offset:41472
    v_mfma_f32_32x32x16_bf16 v[48:63], v[212:215], a[40:43], v[48:63]
    ds_read_b64_tr_b16 v[204:205], v1 offset:43008
    v_mfma_f32_32x32x16_bf16 v[64:79], v[212:215], a[44:47], v[64:79]
    ds_read_b64_tr_b16 v[206:207], v1 offset:43520
    s_waitcnt lgkmcnt(4)
    v_mfma_f32_32x32x16_bf16 v[48:63], v[192:195], a[48:51], v[48:63]
    ds_read_b64_tr_b16 v[208:209], v1 offset:45056
    v_mfma_f32_32x32x16_bf16 v[64:79], v[192:195], a[52:55], v[64:79]
    ds_read_b64_tr_b16 v[210:211], v1 offset:45568
    v_mfma_f32_32x32x16_bf16 v[48:63], v[196:199], a[56:59], v[48:63]
    ds_read_b64_tr_b16 v[212:213], v1 offset:47104
    v_mfma_f32_32x32x16_bf16 v[64:79], v[196:199], a[60:63], v[64:79]
    ds_read_b64_tr_b16 v[214:215], v1 offset:47616
    s_waitcnt lgkmcnt(4)
    v_mfma_f32_32x32x16_bf16 v[48:63], v[200:203], a[64:67], v[48:63]
    ds_read_b64_tr_b16 v[192:193], v1 offset:49152
    v_mfma_f32_32x32x16_bf16 v[64:79], v[200:203], a[68:71], v[64:79]
    ds_read_b64_tr_b16 v[194:195], v1 offset:49664
    v_mfma_f32_32x32x16_bf16 v[48:63], v[204:207], a[72:75], v[48:63]
    ds_read_b64_tr_b16 v[196:197], v1 offset:51200
    v_mfma_f32_32x32x16_bf16 v[64:79], v[204:207], a[76:79], v[64:79]
    ds_read_b64_tr_b16 v[198:199], v1 offset:51712
    s_waitcnt lgkmcnt(4)
    v_mfma_f32_32x32x16_bf16 v[48:63], v[208:211], a[80:83], v[48:63]
    ds_read_b64_tr_b16 v[200:201], v1 offset:53248
    v_mfma_f32_32x32x16_bf16 v[64:79], v[208:211], a[84:87], v[64:79]
    ds_read_b64_tr_b16 v[202:203], v1 offset:53760
    s_waitcnt vmcnt(0)
    v_mov_b32 v222, 1
    buffer_atomic_add v222, v252, s[28:31], s63 offen
    v_mfma_f32_32x32x16_bf16 v[48:63], v[212:215], a[88:91], v[48:63]
    ds_read_b64_tr_b16 v[204:205], v1 offset:55296
    s_barrier
    v_mov_b32 v222, 1
    buffer_atomic_add v222, v251, s[28:31], 0 offen
    v_mfma_f32_32x32x16_bf16 v[64:79], v[212:215], a[92:95], v[64:79]
    ds_read_b64_tr_b16 v[206:207], v1 offset:55808
    s_waitcnt lgkmcnt(4)
    v_mfma_f32_32x32x16_bf16 v[48:63], v[192:195], a[96:99], v[48:63]
    ds_read_b64_tr_b16 v[208:209], v1 offset:57344
    v_mfma_f32_32x32x16_bf16 v[64:79], v[192:195], a[100:103], v[64:79]
    ds_read_b64_tr_b16 v[210:211], v1 offset:57856
    v_mfma_f32_32x32x16_bf16 v[48:63], v[196:199], a[104:107], v[48:63]
    ds_read_b64_tr_b16 v[212:213], v1 offset:59392
    v_mfma_f32_32x32x16_bf16 v[64:79], v[196:199], a[108:111], v[64:79]
    ds_read_b64_tr_b16 v[214:215], v1 offset:59904
    s_waitcnt lgkmcnt(4)
    v_mfma_f32_32x32x16_bf16 v[48:63], v[200:203], a[112:115], v[48:63]
    ds_read_b64_tr_b16 v[192:193], v4 offset:0
    v_mfma_f32_32x32x16_bf16 v[64:79], v[200:203], a[116:119], v[64:79]
    ds_read_b64_tr_b16 v[194:195], v4 offset:512
    v_mfma_f32_32x32x16_bf16 v[48:63], v[204:207], a[120:123], v[48:63]
    ds_read_b64_tr_b16 v[196:197], v4 offset:2048
    v_mfma_f32_32x32x16_bf16 v[64:79], v[204:207], a[124:127], v[64:79]
    ds_read_b64_tr_b16 v[198:199], v4 offset:2560
    s_waitcnt lgkmcnt(4)
    v_mfma_f32_32x32x16_bf16 v[48:63], v[208:211], a[128:131], v[48:63]
    ds_read_b64_tr_b16 v[200:201], v4 offset:4096
    v_mfma_f32_32x32x16_bf16 v[64:79], v[208:211], a[132:135], v[64:79]
    ds_read_b64_tr_b16 v[202:203], v4 offset:4608
    v_mfma_f32_32x32x16_bf16 v[48:63], v[212:215], a[136:139], v[48:63]
    ds_read_b64_tr_b16 v[204:205], v4 offset:6144
    v_mfma_f32_32x32x16_bf16 v[64:79], v[212:215], a[140:143], v[64:79]
    ds_read_b64_tr_b16 v[206:207], v4 offset:6656
    s_waitcnt lgkmcnt(4)
    v_mfma_f32_32x32x16_bf16 v[48:63], v[192:195], a[144:147], v[48:63]
    ds_read_b64_tr_b16 v[208:209], v4 offset:8192
    v_mfma_f32_32x32x16_bf16 v[64:79], v[192:195], a[148:151], v[64:79]
    ds_read_b64_tr_b16 v[210:211], v4 offset:8704
    v_mfma_f32_32x32x16_bf16 v[48:63], v[196:199], a[152:155], v[48:63]
    ds_read_b64_tr_b16 v[212:213], v4 offset:10240
    v_mfma_f32_32x32x16_bf16 v[64:79], v[196:199], a[156:159], v[64:79]
    ds_read_b64_tr_b16 v[214:215], v4 offset:10752
    s_waitcnt lgkmcnt(4)
    v_mfma_f32_32x32x16_bf16 v[48:63], v[200:203], a[160:163], v[48:63]
    ds_read_b64_tr_b16 v[192:193], v4 offset:12288
    v_mfma_f32_32x32x16_bf16 v[64:79], v[200:203], a[164:167], v[64:79]
    ds_read_b64_tr_b16 v[194:195], v4 offset:12800
    v_mfma_f32_32x32x16_bf16 v[48:63], v[204:207], a[168:171], v[48:63]
    ds_read_b64_tr_b16 v[196:197], v4 offset:14336
    v_mfma_f32_32x32x16_bf16 v[64:79], v[204:207], a[172:175], v[64:79]
    ds_read_b64_tr_b16 v[198:199], v4 offset:14848
    s_waitcnt lgkmcnt(4)
    v_mfma_f32_32x32x16_bf16 v[48:63], v[208:211], a[176:179], v[48:63]
    ds_read_b64_tr_b16 v[200:201], v4 offset:16384
    v_mfma_f32_32x32x16_bf16 v[64:79], v[208:211], a[180:183], v[64:79]
    ds_read_b64_tr_b16 v[202:203], v4 offset:16896
    v_mfma_f32_32x32x16_bf16 v[48:63], v[212:215], a[184:187], v[48:63]
    ds_read_b64_tr_b16 v[204:205], v4 offset:18432
    v_mfma_f32_32x32x16_bf16 v[64:79], v[212:215], a[188:191], v[64:79]
    ds_read_b64_tr_b16 v[206:207], v4 offset:18944
    s_waitcnt lgkmcnt(4)
    v_mfma_f32_32x32x16_bf16 v[48:63], v[192:195], a[192:195], v[48:63]
    ds_read_b64_tr_b16 v[208:209], v4 offset:20480
    v_mfma_f32_32x32x16_bf16 v[64:79], v[192:195], a[196:199], v[64:79]
    ds_read_b64_tr_b16 v[210:211], v4 offset:20992
    v_mfma_f32_32x32x16_bf16 v[48:63], v[196:199], a[200:203], v[48:63]
    ds_read_b64_tr_b16 v[212:213], v4 offset:22528
    v_mfma_f32_32x32x16_bf16 v[64:79], v[196:199], a[204:207], v[64:79]
    ds_read_b64_tr_b16 v[214:215], v4 offset:23040
    s_waitcnt lgkmcnt(4)
    v_mfma_f32_32x32x16_bf16 v[48:63], v[200:203], a[208:211], v[48:63]
    ds_read_b64_tr_b16 v[192:193], v4 offset:24576
    v_mfma_f32_32x32x16_bf16 v[64:79], v[200:203], a[212:215], v[64:79]
    ds_read_b64_tr_b16 v[194:195], v4 offset:25088
    v_mfma_f32_32x32x16_bf16 v[48:63], v[204:207], a[216:219], v[48:63]
    ds_read_b64_tr_b16 v[196:197], v4 offset:26624
    v_mfma_f32_32x32x16_bf16 v[64:79], v[204:207], a[220:223], v[64:79]
    ds_read_b64_tr_b16 v[198:199], v4 offset:27136
    s_waitcnt lgkmcnt(4)
    v_mfma_f32_32x32x16_bf16 v[48:63], v[208:211], a[224:227], v[48:63]
    ds_read_b64_tr_b16 v[200:201], v4 offset:28672
    v_mfma_f32_32x32x16_bf16 v[64:79], v[208:211], a[228:231], v[64:79]
    ds_read_b64_tr_b16 v[202:203], v4 offset:29184
    v_mfma_f32_32x32x16_bf16 v[48:63], v[212:215], a[232:235], v[48:63]
    ds_read_b64_tr_b16 v[204:205], v4 offset:30720
    v_mfma_f32_32x32x16_bf16 v[64:79], v[212:215], a[236:239], v[64:79]
    ds_read_b64_tr_b16 v[206:207], v4 offset:31232
    s_waitcnt lgkmcnt(4)
    v_mfma_f32_32x32x16_bf16 v[48:63], v[192:195], a[240:243], v[48:63]
    ds_read_b64_tr_b16 v[208:209], v4 offset:32768
    v_mfma_f32_32x32x16_bf16 v[64:79], v[192:195], a[244:247], v[64:79]
    ds_read_b64_tr_b16 v[210:211], v4 offset:33280
    v_mfma_f32_32x32x16_bf16 v[48:63], v[196:199], a[248:251], v[48:63]
    ds_read_b64_tr_b16 v[212:213], v4 offset:34816
    v_mfma_f32_32x32x16_bf16 v[64:79], v[196:199], a[252:255], v[64:79]
    ds_read_b64_tr_b16 v[214:215], v4 offset:35328
    s_waitcnt lgkmcnt(4)
    v_mfma_f32_32x32x16_bf16 v[48:63], v[200:203], v[160:163], v[48:63]
    ds_read_b64_tr_b16 v[192:193], v2 offset:24576
    v_mfma_f32_32x32x16_bf16 v[64:79], v[200:203], v[164:167], v[64:79]
    ds_read_b64_tr_b16 v[194:195], v2 offset:25088
    v_mfma_f32_32x32x16_bf16 v[48:63], v[204:207], v[168:171], v[48:63]
    ds_read_b64_tr_b16 v[196:197], v2 offset:26624
    v_mfma_f32_32x32x16_bf16 v[64:79], v[204:207], v[172:175], v[64:79]
    ds_read_b64_tr_b16 v[198:199], v2 offset:27136
    s_waitcnt lgkmcnt(4)
    v_mfma_f32_32x32x16_bf16 v[48:63], v[208:211], v[176:179], v[48:63]
    ds_read_b64_tr_b16 v[200:201], v2 offset:28672
    v_mfma_f32_32x32x16_bf16 v[64:79], v[208:211], v[180:183], v[64:79]
    ds_read_b64_tr_b16 v[202:203], v2 offset:29184
    v_mfma_f32_32x32x16_bf16 v[48:63], v[212:215], v[184:187], v[48:63]
    ds_read_b64_tr_b16 v[204:205], v2 offset:30720
    v_mfma_f32_32x32x16_bf16 v[64:79], v[212:215], v[188:191], v[64:79]
    ds_read_b64_tr_b16 v[206:207], v2 offset:31232
    s_waitcnt lgkmcnt(4)
    v_mfma_f32_32x32x16_bf16 v[80:95], v[192:195], a[0:3], 0
    ds_read_b64_tr_b16 v[208:209], v2 offset:32768
    v_mfma_f32_32x32x16_bf16 v[96:111], v[192:195], a[4:7], 0
    ds_read_b64_tr_b16 v[210:211], v2 offset:33280
    v_mfma_f32_32x32x16_bf16 v[80:95], v[196:199], a[8:11], v[80:95]
    ds_read_b64_tr_b16 v[212:213], v2 offset:34816
    s_nop 1
    v_fma_f32 v224, -v48, v48, -s52
    v_fma_f32 v225, -v49, v49, -s52
    v_fma_f32 v226, -v50, v50, -s52
    v_fma_f32 v227, -v51, v51, -s52
    v_mul_f32 v224, v224, v48
    v_mfma_f32_32x32x16_bf16 v[96:111], v[196:199], a[12:15], v[96:111]
    ds_read_b64_tr_b16 v[214:215], v2 offset:35328
    v_mul_f32 v225, v225, v49
    v_mul_f32 v226, v226, v50
    v_mul_f32 v227, v227, v51
    s_waitcnt lgkmcnt(4)
    v_mfma_f32_32x32x16_bf16 v[80:95], v[200:203], a[16:19], v[80:95]
    ds_read_b64_tr_b16 v[192:193], v2 offset:36864
    v_exp_f32 v224, v224
    v_exp_f32 v225, v225
    v_mfma_f32_32x32x16_bf16 v[96:111], v[200:203], a[20:23], v[96:111]
    ds_read_b64_tr_b16 v[194:195], v2 offset:37376
    v_exp_f32 v226, v226
    v_exp_f32 v227, v227
    v_add_f32 v224, 1.0, v224
    v_mfma_f32_32x32x16_bf16 v[80:95], v[204:207], a[24:27], v[80:95]
    ds_read_b64_tr_b16 v[196:197], v2 offset:38912
    v_add_f32 v225, 1.0, v225
    v_add_f32 v226, 1.0, v226
    v_add_f32 v227, 1.0, v227
    v_rcp_f32 v224, v224
    v_mfma_f32_32x32x16_bf16 v[96:111], v[204:207], a[28:31], v[96:111]
    ds_read_b64_tr_b16 v[198:199], v2 offset:39424
    v_rcp_f32 v225, v225
    v_rcp_f32 v226, v226
    s_waitcnt lgkmcnt(4)
    v_mfma_f32_32x32x16_bf16 v[80:95], v[208:211], a[32:35], v[80:95]
    ds_read_b64_tr_b16 v[200:201], v2 offset:40960
    v_rcp_f32 v227, v227
    v_mul_f32 v224, v224, v48
    v_mul_f32 v225, v225, v49
    v_mul_f32 v226, v226, v50
    v_mfma_f32_32x32x16_bf16 v[96:111], v[208:211], a[36:39], v[96:111]
    ds_read_b64_tr_b16 v[202:203], v2 offset:41472
    v_mul_f32 v227, v227, v51
    v_cvt_pk_bf16_f32 v232, v224, v225
    v_cvt_pk_bf16_f32 v233, v226, v227
    v_fma_f32 v228, -v52, v52, -s52
    v_fma_f32 v229, -v53, v53, -s52
    v_mfma_f32_32x32x16_bf16 v[80:95], v[212:215], a[40:43], v[80:95]
    ds_read_b64_tr_b16 v[204:205], v2 offset:43008
    v_fma_f32 v230, -v54, v54, -s52
    v_fma_f32 v231, -v55, v55, -s52
    v_mul_f32 v228, v228, v52
    v_mul_f32 v229, v229, v53
    v_mul_f32 v230, v230, v54
    v_mfma_f32_32x32x16_bf16 v[96:111], v[212:215], a[44:47], v[96:111]
    ds_read_b64_tr_b16 v[206:207], v2 offset:43520
    v_mul_f32 v231, v231, v55
    v_exp_f32 v228, v228
    s_waitcnt lgkmcnt(4)
    v_mfma_f32_32x32x16_bf16 v[80:95], v[192:195], a[48:51], v[80:95]
    ds_read_b64_tr_b16 v[208:209], v2 offset:45056
    v_exp_f32 v229, v229
    v_exp_f32 v230, v230
    v_mfma_f32_32x32x16_bf16 v[96:111], v[192:195], a[52:55], v[96:111]
    ds_read_b64_tr_b16 v[210:211], v2 offset:45568
    v_exp_f32 v231, v231
    v_add_f32 v228, 1.0, v228
    v_add_f32 v229, 1.0, v229
    v_add_f32 v230, 1.0, v230
    v_mfma_f32_32x32x16_bf16 v[80:95], v[196:199], a[56:59], v[80:95]
    ds_read_b64_tr_b16 v[212:213], v2 offset:47104
    v_add_f32 v231, 1.0, v231
    v_rcp_f32 v228, v228
    v_rcp_f32 v229, v229
    v_mfma_f32_32x32x16_bf16 v[96:111], v[196:199], a[60:63], v[96:111]
    ds_read_b64_tr_b16 v[214:215], v2 offset:47616
    v_rcp_f32 v230, v230
    v_rcp_f32 v231, v231
    s_waitcnt lgkmcnt(4)
    v_mfma_f32_32x32x16_bf16 v[80:95], v[200:203], a[64:67], v[80:95]
    ds_read_b64_tr_b16 v[192:193], v2 offset:49152
    v_mul_f32 v228, v228, v52
    v_mul_f32 v229, v229, v53
    v_mul_f32 v230, v230, v54
    v_mul_f32 v231, v231, v55
    v_cvt_pk_bf16_f32 v234, v228, v229
    v_mfma_f32_32x32x16_bf16 v[96:111], v[200:203], a[68:71], v[96:111]
    ds_read_b64_tr_b16 v[194:195], v2 offset:49664
    v_cvt_pk_bf16_f32 v235, v230, v231
    buffer_store_dwordx4 v[232:235], v11, s[16:19], s54 offen offset:0 sc1
    v_fma_f32 v224, -v56, v56, -s52
    v_fma_f32 v225, -v57, v57, -s52
    v_fma_f32 v226, -v58, v58, -s52
    v_mfma_f32_32x32x16_bf16 v[80:95], v[204:207], a[72:75], v[80:95]
    ds_read_b64_tr_b16 v[196:197], v2 offset:51200
    v_fma_f32 v227, -v59, v59, -s52
    v_mul_f32 v224, v224, v56
    v_mul_f32 v225, v225, v57
    v_mul_f32 v226, v226, v58
    v_mul_f32 v227, v227, v59
    v_mfma_f32_32x32x16_bf16 v[96:111], v[204:207], a[76:79], v[96:111]
    ds_read_b64_tr_b16 v[198:199], v2 offset:51712
    v_exp_f32 v224, v224
    v_exp_f32 v225, v225
    s_waitcnt lgkmcnt(4)
    v_mfma_f32_32x32x16_bf16 v[80:95], v[208:211], a[80:83], v[80:95]
    ds_read_b64_tr_b16 v[200:201], v2 offset:53248
    v_exp_f32 v226, v226
    v_exp_f32 v227, v227
    v_add_f32 v224, 1.0, v224
    v_mfma_f32_32x32x16_bf16 v[96:111], v[208:211], a[84:87], v[96:111]
    ds_read_b64_tr_b16 v[202:203], v2 offset:53760
    v_add_f32 v225, 1.0, v225
    v_add_f32 v226, 1.0, v226
    v_add_f32 v227, 1.0, v227
    v_rcp_f32 v224, v224
    v_mfma_f32_32x32x16_bf16 v[80:95], v[212:215], a[88:91], v[80:95]
    ds_read_b64_tr_b16 v[204:205], v2 offset:55296
    v_rcp_f32 v225, v225
    v_rcp_f32 v226, v226
    v_mfma_f32_32x32x16_bf16 v[96:111], v[212:215], a[92:95], v[96:111]
    ds_read_b64_tr_b16 v[206:207], v2 offset:55808
    v_rcp_f32 v227, v227
    v_mul_f32 v224, v224, v56
    v_mul_f32 v225, v225, v57
    s_waitcnt lgkmcnt(4)
    v_mfma_f32_32x32x16_bf16 v[80:95], v[192:195], a[96:99], v[80:95]
    ds_read_b64_tr_b16 v[208:209], v2 offset:57344
    v_mul_f32 v226, v226, v58
    v_mul_f32 v227, v227, v59
    v_cvt_pk_bf16_f32 v238, v224, v225
    v_cvt_pk_bf16_f32 v239, v226, v227
    v_fma_f32 v228, -v60, v60, -s52
    v_mfma_f32_32x32x16_bf16 v[96:111], v[192:195], a[100:103], v[96:111]
    ds_read_b64_tr_b16 v[210:211], v2 offset:57856
    v_fma_f32 v229, -v61, v61, -s52
    v_fma_f32 v230, -v62, v62, -s52
    v_fma_f32 v231, -v63, v63, -s52
    v_mul_f32 v228, v228, v60
    v_mul_f32 v229, v229, v61
    v_mfma_f32_32x32x16_bf16 v[80:95], v[196:199], a[104:107], v[80:95]
    ds_read_b64_tr_b16 v[212:213], v2 offset:59392
    v_mul_f32 v230, v230, v62
    v_mul_f32 v231, v231, v63
    v_exp_f32 v228, v228
    v_mfma_f32_32x32x16_bf16 v[96:111], v[196:199], a[108:111], v[96:111]
    ds_read_b64_tr_b16 v[214:215], v2 offset:59904
    v_exp_f32 v229, v229
    v_exp_f32 v230, v230
    s_waitcnt lgkmcnt(4)
    v_mfma_f32_32x32x16_bf16 v[80:95], v[200:203], a[112:115], v[80:95]
    ds_read_b64_tr_b16 v[192:193], v5 offset:0
    v_exp_f32 v231, v231
    v_add_f32 v228, 1.0, v228
    v_add_f32 v229, 1.0, v229
    v_add_f32 v230, 1.0, v230
    v_mfma_f32_32x32x16_bf16 v[96:111], v[200:203], a[116:119], v[96:111]
    ds_read_b64_tr_b16 v[194:195], v5 offset:512
    v_add_f32 v231, 1.0, v231
    v_rcp_f32 v228, v228
    v_rcp_f32 v229, v229
    v_mfma_f32_32x32x16_bf16 v[80:95], v[204:207], a[120:123], v[80:95]
    ds_read_b64_tr_b16 v[196:197], v5 offset:2048
    v_rcp_f32 v230, v230
    v_rcp_f32 v231, v231
    v_mul_f32 v228, v228, v60
    v_mfma_f32_32x32x16_bf16 v[96:111], v[204:207], a[124:127], v[96:111]
    ds_read_b64_tr_b16 v[198:199], v5 offset:2560
    v_mul_f32 v229, v229, v61
    v_mul_f32 v230, v230, v62
    v_mul_f32 v231, v231, v63
    v_cvt_pk_bf16_f32 v236, v228, v229
    s_waitcnt lgkmcnt(4)
    v_mfma_f32_32x32x16_bf16 v[80:95], v[208:211], a[128:131], v[80:95]
    ds_read_b64_tr_b16 v[200:201], v5 offset:4096
    v_cvt_pk_bf16_f32 v237, v230, v231
    buffer_store_dwordx4 v[236:239], v11, s[16:19], s54 offen offset:256 sc1
    v_fma_f32 v224, -v64, v64, -s52
    v_fma_f32 v225, -v65, v65, -s52
    v_fma_f32 v226, -v66, v66, -s52
    v_mfma_f32_32x32x16_bf16 v[96:111], v[208:211], a[132:135], v[96:111]
    ds_read_b64_tr_b16 v[202:203], v5 offset:4608
    v_fma_f32 v227, -v67, v67, -s52
    v_mul_f32 v224, v224, v64
    v_mul_f32 v225, v225, v65
    v_mul_f32 v226, v226, v66
    v_mul_f32 v227, v227, v67
    v_mfma_f32_32x32x16_bf16 v[80:95], v[212:215], a[136:139], v[80:95]
    ds_read_b64_tr_b16 v[204:205], v5 offset:6144
    v_exp_f32 v224, v224
    v_exp_f32 v225, v225
    v_mfma_f32_32x32x16_bf16 v[96:111], v[212:215], a[140:143], v[96:111]
    ds_read_b64_tr_b16 v[206:207], v5 offset:6656
    v_exp_f32 v226, v226
    v_exp_f32 v227, v227
    s_waitcnt lgkmcnt(4)
    v_mfma_f32_32x32x16_bf16 v[80:95], v[192:195], a[144:147], v[80:95]
    ds_read_b64_tr_b16 v[208:209], v5 offset:8192
    v_add_f32 v224, 1.0, v224
    v_add_f32 v225, 1.0, v225
    v_add_f32 v226, 1.0, v226
    v_add_f32 v227, 1.0, v227
    v_mfma_f32_32x32x16_bf16 v[96:111], v[192:195], a[148:151], v[96:111]
    ds_read_b64_tr_b16 v[210:211], v5 offset:8704
    v_rcp_f32 v224, v224
    v_rcp_f32 v225, v225
    v_mfma_f32_32x32x16_bf16 v[80:95], v[196:199], a[152:155], v[80:95]
    ds_read_b64_tr_b16 v[212:213], v5 offset:10240
    v_rcp_f32 v226, v226
    v_rcp_f32 v227, v227
    v_mul_f32 v224, v224, v64
    v_mfma_f32_32x32x16_bf16 v[96:111], v[196:199], a[156:159], v[96:111]
    ds_read_b64_tr_b16 v[214:215], v5 offset:10752
    v_mul_f32 v225, v225, v65
    v_mul_f32 v226, v226, v66
    v_mul_f32 v227, v227, v67
    v_cvt_pk_bf16_f32 v240, v224, v225
    s_waitcnt lgkmcnt(4)
    v_mfma_f32_32x32x16_bf16 v[80:95], v[200:203], a[160:163], v[80:95]
    ds_read_b64_tr_b16 v[192:193], v5 offset:12288
    v_cvt_pk_bf16_f32 v241, v226, v227
    v_fma_f32 v228, -v68, v68, -s52
    v_fma_f32 v229, -v69, v69, -s52
    v_fma_f32 v230, -v70, v70, -s52
    v_fma_f32 v231, -v71, v71, -s52
    v_mfma_f32_32x32x16_bf16 v[96:111], v[200:203], a[164:167], v[96:111]
    ds_read_b64_tr_b16 v[194:195], v5 offset:12800
    v_mul_f32 v228, v228, v68
    v_mul_f32 v229, v229, v69
    v_mul_f32 v230, v230, v70
    v_mul_f32 v231, v231, v71
    v_mfma_f32_32x32x16_bf16 v[80:95], v[204:207], a[168:171], v[80:95]
    ds_read_b64_tr_b16 v[196:197], v5 offset:14336
    v_exp_f32 v228, v228
    v_exp_f32 v229, v229
    v_mfma_f32_32x32x16_bf16 v[96:111], v[204:207], a[172:175], v[96:111]
    ds_read_b64_tr_b16 v[198:199], v5 offset:14848
    v_exp_f32 v230, v230
    v_exp_f32 v231, v231
    s_waitcnt lgkmcnt(4)
    v_mfma_f32_32x32x16_bf16 v[80:95], v[208:211], a[176:179], v[80:95]
    ds_read_b64_tr_b16 v[200:201], v5 offset:16384
    v_add_f32 v228, 1.0, v228
    v_add_f32 v229, 1.0, v229
    v_add_f32 v230, 1.0, v230
    v_add_f32 v231, 1.0, v231
    v_mfma_f32_32x32x16_bf16 v[96:111], v[208:211], a[180:183], v[96:111]
    ds_read_b64_tr_b16 v[202:203], v5 offset:16896
    v_rcp_f32 v228, v228
    v_rcp_f32 v229, v229
    v_mfma_f32_32x32x16_bf16 v[80:95], v[212:215], a[184:187], v[80:95]
    ds_read_b64_tr_b16 v[204:205], v5 offset:18432
    v_rcp_f32 v230, v230
    v_rcp_f32 v231, v231
    v_mul_f32 v228, v228, v68
    v_mfma_f32_32x32x16_bf16 v[96:111], v[212:215], a[188:191], v[96:111]
    ds_read_b64_tr_b16 v[206:207], v5 offset:18944
    v_mul_f32 v229, v229, v69
    v_mul_f32 v230, v230, v70
    v_mul_f32 v231, v231, v71
    v_cvt_pk_bf16_f32 v242, v228, v229
    s_waitcnt lgkmcnt(4)
    v_mfma_f32_32x32x16_bf16 v[80:95], v[192:195], a[192:195], v[80:95]
    ds_read_b64_tr_b16 v[208:209], v5 offset:20480
    v_cvt_pk_bf16_f32 v243, v230, v231
    buffer_store_dwordx4 v[240:243], v11, s[16:19], s55 offen offset:0 sc1
    v_fma_f32 v224, -v72, v72, -s52
    v_fma_f32 v225, -v73, v73, -s52
    v_fma_f32 v226, -v74, v74, -s52
    v_mfma_f32_32x32x16_bf16 v[96:111], v[192:195], a[196:199], v[96:111]
    ds_read_b64_tr_b16 v[210:211], v5 offset:20992
    v_fma_f32 v227, -v75, v75, -s52
    v_mul_f32 v224, v224, v72
    v_mul_f32 v225, v225, v73
    v_mul_f32 v226, v226, v74
    v_mul_f32 v227, v227, v75
    v_mfma_f32_32x32x16_bf16 v[80:95], v[196:199], a[200:203], v[80:95]
    ds_read_b64_tr_b16 v[212:213], v5 offset:22528
    v_exp_f32 v224, v224
    v_exp_f32 v225, v225
    v_mfma_f32_32x32x16_bf16 v[96:111], v[196:199], a[204:207], v[96:111]
    ds_read_b64_tr_b16 v[214:215], v5 offset:23040
    v_exp_f32 v226, v226
    v_exp_f32 v227, v227
    s_waitcnt lgkmcnt(4)
    v_mfma_f32_32x32x16_bf16 v[80:95], v[200:203], a[208:211], v[80:95]
    ds_read_b64_tr_b16 v[192:193], v5 offset:24576
    v_add_f32 v224, 1.0, v224
    v_add_f32 v225, 1.0, v225
    v_add_f32 v226, 1.0, v226
    v_add_f32 v227, 1.0, v227
    v_mfma_f32_32x32x16_bf16 v[96:111], v[200:203], a[212:215], v[96:111]
    ds_read_b64_tr_b16 v[194:195], v5 offset:25088
    v_rcp_f32 v224, v224
    v_rcp_f32 v225, v225
    v_mfma_f32_32x32x16_bf16 v[80:95], v[204:207], a[216:219], v[80:95]
    ds_read_b64_tr_b16 v[196:197], v5 offset:26624
    v_rcp_f32 v226, v226
    v_rcp_f32 v227, v227
    v_mul_f32 v224, v224, v72
    v_mfma_f32_32x32x16_bf16 v[96:111], v[204:207], a[220:223], v[96:111]
    ds_read_b64_tr_b16 v[198:199], v5 offset:27136
    v_mul_f32 v225, v225, v73
    v_mul_f32 v226, v226, v74
    v_mul_f32 v227, v227, v75
    v_cvt_pk_bf16_f32 v234, v224, v225
    s_waitcnt lgkmcnt(4)
    v_mfma_f32_32x32x16_bf16 v[80:95], v[208:211], a[224:227], v[80:95]
    ds_read_b64_tr_b16 v[200:201], v5 offset:28672
    v_cvt_pk_bf16_f32 v235, v226, v227
    v_fma_f32 v228, -v76, v76, -s52
    v_fma_f32 v229, -v77, v77, -s52
    v_fma_f32 v230, -v78, v78, -s52
    v_fma_f32 v231, -v79, v79, -s52
    v_mfma_f32_32x32x16_bf16 v[96:111], v[208:211], a[228:231], v[96:111]
    ds_read_b64_tr_b16 v[202:203], v5 offset:29184
    v_mul_f32 v228, v228, v76
    v_mul_f32 v229, v229, v77
    v_mul_f32 v230, v230, v78
    v_mul_f32 v231, v231, v79
    v_mfma_f32_32x32x16_bf16 v[80:95], v[212:215], a[232:235], v[80:95]
    ds_read_b64_tr_b16 v[204:205], v5 offset:30720
    v_exp_f32 v228, v228
    v_exp_f32 v229, v229
    v_mfma_f32_32x32x16_bf16 v[96:111], v[212:215], a[236:239], v[96:111]
    ds_read_b64_tr_b16 v[206:207], v5 offset:31232
    v_exp_f32 v230, v230
    v_exp_f32 v231, v231
    s_waitcnt lgkmcnt(4)
    v_mfma_f32_32x32x16_bf16 v[80:95], v[192:195], a[240:243], v[80:95]
    ds_read_b64_tr_b16 v[208:209], v5 offset:32768
    v_add_f32 v228, 1.0, v228
    v_add_f32 v229, 1.0, v229
    v_add_f32 v230, 1.0, v230
    v_add_f32 v231, 1.0, v231
    v_mfma_f32_32x32x16_bf16 v[96:111], v[192:195], a[244:247], v[96:111]
    ds_read_b64_tr_b16 v[210:211], v5 offset:33280
    v_rcp_f32 v228, v228
    v_rcp_f32 v229, v229
    v_mfma_f32_32x32x16_bf16 v[80:95], v[196:199], a[248:251], v[80:95]
    ds_read_b64_tr_b16 v[212:213], v5 offset:34816
    v_rcp_f32 v230, v230
    v_rcp_f32 v231, v231
    v_mul_f32 v228, v228, v76
    v_mfma_f32_32x32x16_bf16 v[96:111], v[196:199], a[252:255], v[96:111]
    ds_read_b64_tr_b16 v[214:215], v5 offset:35328
    v_mul_f32 v229, v229, v77
    v_mul_f32 v230, v230, v78
    v_mul_f32 v231, v231, v79
    v_cvt_pk_bf16_f32 v232, v228, v229
    s_waitcnt lgkmcnt(4)
    v_mfma_f32_32x32x16_bf16 v[80:95], v[200:203], v[160:163], v[80:95]
    v_cvt_pk_bf16_f32 v233, v230, v231
    buffer_store_dwordx4 v[232:235], v11, s[16:19], s55 offen offset:256 sc1
    v_mfma_f32_32x32x16_bf16 v[96:111], v[200:203], v[164:167], v[96:111]
    v_mfma_f32_32x32x16_bf16 v[80:95], v[204:207], v[168:171], v[80:95]
    v_mfma_f32_32x32x16_bf16 v[96:111], v[204:207], v[172:175], v[96:111]
    s_waitcnt lgkmcnt(0)
    v_mfma_f32_32x32x16_bf16 v[80:95], v[208:211], v[176:179], v[80:95]
    v_mfma_f32_32x32x16_bf16 v[96:111], v[208:211], v[180:183], v[96:111]
    v_mfma_f32_32x32x16_bf16 v[80:95], v[212:215], v[184:187], v[80:95]
    v_mfma_f32_32x32x16_bf16 v[96:111], v[212:215], v[188:191], v[96:111]
    v_mov_b32 v253, 0
    buffer_atomic_add v253, v252, s[28:31], s63 offen sc0
    s_waitcnt vmcnt(0)
    s_mov_b32 s51, 0
k1_kernel_pl3:
    v_readfirstlane_b32 s64, v253
    s_nop 0
    s_and_b32 s64, s64, 255
    s_cmp_ge_u32 s64, 32
    s_cbranch_scc1 k1_kernel_pd4
    s_add_u32 s51, s51, 1
    s_cmp_ge_u32 s51, 100000
    s_cbranch_scc1 k1_kernel_pd4
    s_sleep 4
    v_mov_b32 v253, 0
    buffer_atomic_add v253, v252, s[28:31], s63 offen sc0
    s_waitcnt vmcnt(0)
    s_branch k1_kernel_pl3
k1_kernel_pd4:
    buffer_load_dword v216, v13, s[28:31], s59 offen offset:0 sc1
    buffer_load_dword v218, v13, s[28:31], s59 offen offset:256 sc1
    s_waitcnt vmcnt(1)
    v_mov_b32 v217, v216
    s_waitcnt vmcnt(0)
    v_mov_b32 v219, v218
    v_mov_b32 v244, 0x361367a4
    v_mov_b32 v248, 0x361367a4
    v_permlane32_swap_b32 v216, v217
    v_permlane32_swap_b32 v218, v219
    v_mul_f32 v216, 0x39e38e39, v216
    v_mul_f32 v218, 0x39e38e39, v218
    v_fmac_f32 v244, 0x39e38e39, v217
    v_fmac_f32 v248, 0x39e38e39, v219
    v_fma_f32 v244, -v216, v216, v244
    v_fma_f32 v248, -v218, v218, v248
    v_max_f32 v244, 0x361367a4, v244
    v_max_f32 v248, 0x361367a4, v248
    v_rsq_f32 v244, v244
    v_rsq_f32 v248, v248
    v_mul_f32 v244, 0x40088e99, v244
    v_mul_f32 v248, 0x40088e99, v248
    v_mul_f32 v246, -v216, v244
    v_mul_f32 v250, -v218, v248
    v_lshlrev_b32 v152, 16, v16
    v_and_b32 v153, s62, v16
    v_lshlrev_b32 v154, 16, v17
    v_and_b32 v155, s62, v17
    v_lshlrev_b32 v156, 16, v18
    v_and_b32 v157, s62, v18
    v_lshlrev_b32 v158, 16, v19
    v_and_b32 v159, s62, v19
    v_pk_fma_f32 v[152:153], v[152:153], v[244:245], v[246:247] op_sel_hi:[1,0,0]
    v_pk_fma_f32 v[154:155], v[154:155], v[244:245], v[246:247] op_sel_hi:[1,0,0]
    v_pk_fma_f32 v[156:157], v[156:157], v[244:245], v[246:247] op_sel_hi:[1,0,0]
    v_pk_fma_f32 v[158:159], v[158:159], v[244:245], v[246:247] op_sel_hi:[1,0,0]
    v_cvt_pk_bf16_f32 v16, v152, v153
    v_cvt_pk_bf16_f32 v17, v154, v155
    v_cvt_pk_bf16_f32 v18, v156, v157
    v_cvt_pk_bf16_f32 v19, v158, v159
    buffer_store_dwordx4 v[16:19], v11, s[20:23], s54 offen offset:0 sc1
    v_lshlrev_b32 v152, 16, v20
    v_and_b32 v153, s62, v20
    v_lshlrev_b32 v154, 16, v21
    v_and_b32 v155, s62, v21
    v_lshlrev_b32 v156, 16, v22
    v_and_b32 v157, s62, v22
    v_lshlrev_b32 v158, 16, v23
    v_and_b32 v159, s62, v23
    v_pk_fma_f32 v[152:153], v[152:153], v[244:245], v[246:247] op_sel_hi:[1,0,0]
    v_pk_fma_f32 v[154:155], v[154:155], v[244:245], v[246:247] op_sel_hi:[1,0,0]
    v_pk_fma_f32 v[156:157], v[156:157], v[244:245], v[246:247] op_sel_hi:[1,0,0]
    v_pk_fma_f32 v[158:159], v[158:159], v[244:245], v[246:247] op_sel_hi:[1,0,0]
    v_cvt_pk_bf16_f32 v20, v152, v153
    v_cvt_pk_bf16_f32 v21, v154, v155
    v_cvt_pk_bf16_f32 v22, v156, v157
    v_cvt_pk_bf16_f32 v23, v158, v159
    buffer_store_dwordx4 v[20:23], v11, s[20:23], s54 offen offset:256 sc1
    v_lshlrev_b32 v152, 16, v24
    v_and_b32 v153, s62, v24
    v_lshlrev_b32 v154, 16, v25
    v_and_b32 v155, s62, v25
    v_lshlrev_b32 v156, 16, v26
    v_and_b32 v157, s62, v26
    v_lshlrev_b32 v158, 16, v27
    v_and_b32 v159, s62, v27
    v_pk_fma_f32 v[152:153], v[152:153], v[248:249], v[250:251] op_sel_hi:[1,0,0]
    v_pk_fma_f32 v[154:155], v[154:155], v[248:249], v[250:251] op_sel_hi:[1,0,0]
    v_pk_fma_f32 v[156:157], v[156:157], v[248:249], v[250:251] op_sel_hi:[1,0,0]
    v_pk_fma_f32 v[158:159], v[158:159], v[248:249], v[250:251] op_sel_hi:[1,0,0]
    v_cvt_pk_bf16_f32 v24, v152, v153
    v_cvt_pk_bf16_f32 v25, v154, v155
    v_cvt_pk_bf16_f32 v26, v156, v157
    v_cvt_pk_bf16_f32 v27, v158, v159
    buffer_store_dwordx4 v[24:27], v11, s[20:23], s55 offen offset:0 sc1
    v_lshlrev_b32 v152, 16, v28
    v_and_b32 v153, s62, v28
    v_lshlrev_b32 v154, 16, v29
    v_and_b32 v155, s62, v29
    v_lshlrev_b32 v156, 16, v30
    v_and_b32 v157, s62, v30
    v_lshlrev_b32 v158, 16, v31
    v_and_b32 v159, s62, v31
    v_pk_fma_f32 v[152:153], v[152:153], v[248:249], v[250:251] op_sel_hi:[1,0,0]
    v_pk_fma_f32 v[154:155], v[154:155], v[248:249], v[250:251] op_sel_hi:[1,0,0]
    v_pk_fma_f32 v[156:157], v[156:157], v[248:249], v[250:251] op_sel_hi:[1,0,0]
    v_pk_fma_f32 v[158:159], v[158:159], v[248:249], v[250:251] op_sel_hi:[1,0,0]
    v_cvt_pk_bf16_f32 v28, v152, v153
    v_cvt_pk_bf16_f32 v29, v154, v155
    v_cvt_pk_bf16_f32 v30, v156, v157
    v_cvt_pk_bf16_f32 v31, v158, v159
    buffer_store_dwordx4 v[28:31], v11, s[20:23], s55 offen offset:256 sc1
    v_lshlrev_b32 v152, 16, v32
    v_and_b32 v153, s62, v32
    v_lshlrev_b32 v154, 16, v33
    v_and_b32 v155, s62, v33
    v_lshlrev_b32 v156, 16, v34
    v_and_b32 v157, s62, v34
    v_lshlrev_b32 v158, 16, v35
    v_and_b32 v159, s62, v35
    v_pk_fma_f32 v[152:153], v[152:153], v[244:245], v[246:247] op_sel_hi:[1,0,0]
    v_pk_fma_f32 v[154:155], v[154:155], v[244:245], v[246:247] op_sel_hi:[1,0,0]
    v_pk_fma_f32 v[156:157], v[156:157], v[244:245], v[246:247] op_sel_hi:[1,0,0]
    v_pk_fma_f32 v[158:159], v[158:159], v[244:245], v[246:247] op_sel_hi:[1,0,0]
    v_cvt_pk_bf16_f32 v32, v152, v153
    v_cvt_pk_bf16_f32 v33, v154, v155
    v_cvt_pk_bf16_f32 v34, v156, v157
    v_cvt_pk_bf16_f32 v35, v158, v159
    buffer_store_dwordx4 v[32:35], v11, s[20:23], s54 offen offset:1024 sc1
    v_lshlrev_b32 v152, 16, v36
    v_and_b32 v153, s62, v36
    v_lshlrev_b32 v154, 16, v37
    v_and_b32 v155, s62, v37
    v_lshlrev_b32 v156, 16, v38
    v_and_b32 v157, s62, v38
    v_lshlrev_b32 v158, 16, v39
    v_and_b32 v159, s62, v39
    v_pk_fma_f32 v[152:153], v[152:153], v[244:245], v[246:247] op_sel_hi:[1,0,0]
    v_pk_fma_f32 v[154:155], v[154:155], v[244:245], v[246:247] op_sel_hi:[1,0,0]
    v_pk_fma_f32 v[156:157], v[156:157], v[244:245], v[246:247] op_sel_hi:[1,0,0]
    v_pk_fma_f32 v[158:159], v[158:159], v[244:245], v[246:247] op_sel_hi:[1,0,0]
    v_cvt_pk_bf16_f32 v36, v152, v153
    v_cvt_pk_bf16_f32 v37, v154, v155
    v_cvt_pk_bf16_f32 v38, v156, v157
    v_cvt_pk_bf16_f32 v39, v158, v159
    buffer_store_dwordx4 v[36:39], v11, s[20:23], s54 offen offset:1280 sc1
    v_lshlrev_b32 v152, 16, v40
    v_and_b32 v153, s62, v40
    v_lshlrev_b32 v154, 16, v41
    v_and_b32 v155, s62, v41
    v_lshlrev_b32 v156, 16, v42
    v_and_b32 v157, s62, v42
    v_lshlrev_b32 v158, 16, v43
    v_and_b32 v159, s62, v43
    v_pk_fma_f32 v[152:153], v[152:153], v[248:249], v[250:251] op_sel_hi:[1,0,0]
    v_pk_fma_f32 v[154:155], v[154:155], v[248:249], v[250:251] op_sel_hi:[1,0,0]
    v_pk_fma_f32 v[156:157], v[156:157], v[248:249], v[250:251] op_sel_hi:[1,0,0]
    v_pk_fma_f32 v[158:159], v[158:159], v[248:249], v[250:251] op_sel_hi:[1,0,0]
    v_cvt_pk_bf16_f32 v40, v152, v153
    v_cvt_pk_bf16_f32 v41, v154, v155
    v_cvt_pk_bf16_f32 v42, v156, v157
    v_cvt_pk_bf16_f32 v43, v158, v159
    buffer_store_dwordx4 v[40:43], v11, s[20:23], s55 offen offset:1024 sc1
    v_lshlrev_b32 v152, 16, v44
    v_and_b32 v153, s62, v44
    v_lshlrev_b32 v154, 16, v45
    v_and_b32 v155, s62, v45
    v_lshlrev_b32 v156, 16, v46
    v_and_b32 v157, s62, v46
    v_lshlrev_b32 v158, 16, v47
    v_and_b32 v159, s62, v47
    v_pk_fma_f32 v[152:153], v[152:153], v[248:249], v[250:251] op_sel_hi:[1,0,0]
    v_pk_fma_f32 v[154:155], v[154:155], v[248:249], v[250:251] op_sel_hi:[1,0,0]
    v_pk_fma_f32 v[156:157], v[156:157], v[248:249], v[250:251] op_sel_hi:[1,0,0]
    v_pk_fma_f32 v[158:159], v[158:159], v[248:249], v[250:251] op_sel_hi:[1,0,0]
    v_cvt_pk_bf16_f32 v44, v152, v153
    v_cvt_pk_bf16_f32 v45, v154, v155
    v_cvt_pk_bf16_f32 v46, v156, v157
    v_cvt_pk_bf16_f32 v47, v158, v159
    buffer_store_dwordx4 v[44:47], v11, s[20:23], s55 offen offset:1280 sc1
    v_lshlrev_b32 v152, 16, v144
    v_and_b32 v153, s62, v144
    v_lshlrev_b32 v154, 16, v145
    v_and_b32 v155, s62, v145
    v_lshlrev_b32 v156, 16, v146
    v_and_b32 v157, s62, v146
    v_lshlrev_b32 v158, 16, v147
    v_and_b32 v159, s62, v147
    v_pk_fma_f32 v[152:153], v[152:153], v[244:245], v[246:247] op_sel_hi:[1,0,0]
    v_pk_fma_f32 v[154:155], v[154:155], v[244:245], v[246:247] op_sel_hi:[1,0,0]
    v_pk_fma_f32 v[156:157], v[156:157], v[244:245], v[246:247] op_sel_hi:[1,0,0]
    v_pk_fma_f32 v[158:159], v[158:159], v[244:245], v[246:247] op_sel_hi:[1,0,0]
    v_cvt_pk_bf16_f32 v144, v152, v153
    v_cvt_pk_bf16_f32 v145, v154, v155
    v_cvt_pk_bf16_f32 v146, v156, v157
    v_cvt_pk_bf16_f32 v147, v158, v159
    buffer_store_dwordx4 v[144:147], v11, s[36:39], s56 offen offset:0 sc1
    v_lshlrev_b32 v152, 16, v148
    v_and_b32 v153, s62, v148
    v_lshlrev_b32 v154, 16, v149
    v_and_b32 v155, s62, v149
    v_lshlrev_b32 v156, 16, v150
    v_and_b32 v157, s62, v150
    v_lshlrev_b32 v158, 16, v151
    v_and_b32 v159, s62, v151
    v_pk_fma_f32 v[152:153], v[152:153], v[244:245], v[246:247] op_sel_hi:[1,0,0]
    v_pk_fma_f32 v[154:155], v[154:155], v[244:245], v[246:247] op_sel_hi:[1,0,0]
    v_pk_fma_f32 v[156:157], v[156:157], v[244:245], v[246:247] op_sel_hi:[1,0,0]
    v_pk_fma_f32 v[158:159], v[158:159], v[244:245], v[246:247] op_sel_hi:[1,0,0]
    v_cvt_pk_bf16_f32 v148, v152, v153
    v_cvt_pk_bf16_f32 v149, v154, v155
    v_cvt_pk_bf16_f32 v150, v156, v157
    v_cvt_pk_bf16_f32 v151, v158, v159
    buffer_store_dwordx4 v[148:151], v11, s[36:39], s56 offen offset:256 sc1
    s_waitcnt vmcnt(0)
    s_barrier
    v_mov_b32 v222, 1
    buffer_atomic_add v222, v6, s[28:31], 0 offen
    s_branch k1_fin
k1_qk:
    s_add_u32 s24, s74, 25165824
    s_addc_u32 s25, s75, 0
    s_mov_b32 s26, 4718592
    s_mov_b32 s27, 0x20000
    s_cmp_lt_u32 s41, 27
    s_cselect_b32 s26, s26, 0
    v_lshrrev_b32 v19, 5, v17
    v_lshlrev_b32 v19, 10, v19
    v_and_b32 v18, 31, v17
    v_lshl_add_u32 v12, v18, 3, v19
    s_mul_i32 s57, s42, 73728
    s_lshl_b32 s79, s41, 12
    s_add_u32 s57, s57, s79
    s_add_u32 s58, s57, 73728
    s_cmp_lt_u32 s41, 16
    s_cbranch_scc1 k1_qk1
    buffer_load_dwordx4 a[24:27], v10, s[4:7], s43 offen offset:3072 sc1
    buffer_load_dwordx4 a[28:31], v10, s[4:7], s44 offen offset:3072 sc1
    s_add_u32 s43, s43, 4096
    buffer_load_dwordx4 a[32:35], v10, s[4:7], s43 offen offset:0 sc1
    s_add_u32 s44, s44, 4096
    buffer_load_dwordx4 a[36:39], v10, s[4:7], s44 offen offset:0 sc1
    buffer_load_dwordx4 a[40:43], v10, s[4:7], s43 offen offset:1024 sc1
    buffer_load_dwordx4 a[44:47], v10, s[4:7], s44 offen offset:1024 sc1
    s_waitcnt vmcnt(21)
    s_barrier
    ds_read_b64_tr_b16 v[192:193], v1 offset:24576
    ds_read_b64_tr_b16 v[194:195], v1 offset:25088
    ds_read_b64_tr_b16 v[196:197], v2 offset:24576
    ds_read_b64_tr_b16 v[198:199], v2 offset:25088
    ds_read_b64_tr_b16 v[200:201], v3 offset:0
    ds_read_b64_tr_b16 v[202:203], v3 offset:256
    ds_read_b64_tr_b16 v[204:205], v1 offset:26624
    ds_read_b64_tr_b16 v[206:207], v1 offset:27136
    s_waitcnt vmcnt(10) lgkmcnt(4)
    v_mfma_f32_32x32x16_bf16 v[16:31], v[192:195], a[0:3], 0
    ds_read_b64_tr_b16 v[208:209], v2 offset:26624
    v_mfma_f32_32x32x16_bf16 v[32:47], v[192:195], a[4:7], 0
    ds_read_b64_tr_b16 v[210:211], v2 offset:27136
    v_mfma_f32_32x32x16_bf16 v[48:63], v[196:199], a[0:3], 0
    ds_read_b64_tr_b16 v[212:213], v3 offset:1024
    buffer_load_dwordx4 a[48:51], v10, s[4:7], s43 offen offset:2048 sc1
    v_mfma_f32_32x32x16_bf16 v[64:79], v[196:199], a[4:7], 0
    ds_read_b64_tr_b16 v[214:215], v3 offset:1280
    s_waitcnt lgkmcnt(6)
    v_mfma_f32_32x32x16_bf16 v[144:159], v[200:203], a[0:3], 0
    ds_read_b64_tr_b16 v[192:193], v1 offset:28672
    ds_read_b64_tr_b16 v[194:195], v1 offset:29184
    buffer_load_dwordx4 a[52:55], v10, s[4:7], s44 offen offset:2048 sc1
    s_waitcnt vmcnt(10) lgkmcnt(4)
    v_mfma_f32_32x32x16_bf16 v[16:31], v[204:207], a[8:11], v[16:31]
    ds_read_b64_tr_b16 v[196:197], v2 offset:28672
    v_mfma_f32_32x32x16_bf16 v[32:47], v[204:207], a[12:15], v[32:47]
    ds_read_b64_tr_b16 v[198:199], v2 offset:29184
    buffer_load_dwordx4 a[56:59], v10, s[4:7], s43 offen offset:3072 sc1
    v_mfma_f32_32x32x16_bf16 v[48:63], v[208:211], a[8:11], v[48:63]
    ds_read_b64_tr_b16 v[200:201], v3 offset:2048
    v_mfma_f32_32x32x16_bf16 v[64:79], v[208:211], a[12:15], v[64:79]
    ds_read_b64_tr_b16 v[202:203], v3 offset:2304
    buffer_load_dwordx4 a[60:63], v10, s[4:7], s44 offen offset:3072 sc1
    s_waitcnt lgkmcnt(6)
    v_mfma_f32_32x32x16_bf16 v[144:159], v[212:215], a[8:11], v[144:159]
    ds_read_b64_tr_b16 v[204:205], v1 offset:30720
    ds_read_b64_tr_b16 v[206:207], v1 offset:31232
    s_waitcnt vmcnt(10) lgkmcnt(4)
    v_mfma_f32_32x32x16_bf16 v[16:31], v[192:195], a[16:19], v[16:31]
    ds_read_b64_tr_b16 v[208:209], v2 offset:30720
    s_add_u32 s43, s43, 4096
    buffer_load_dwordx4 a[64:67], v10, s[4:7], s43 offen offset:0 sc1
    v_mfma_f32_32x32x16_bf16 v[32:47], v[192:195], a[20:23], v[32:47]
    ds_read_b64_tr_b16 v[210:211], v2 offset:31232
    v_mfma_f32_32x32x16_bf16 v[48:63], v[196:199], a[16:19], v[48:63]
    ds_read_b64_tr_b16 v[212:213], v3 offset:3072
    s_add_u32 s44, s44, 4096
    buffer_load_dwordx4 a[68:71], v10, s[4:7], s44 offen offset:0 sc1
    v_mfma_f32_32x32x16_bf16 v[64:79], v[196:199], a[20:23], v[64:79]
    ds_read_b64_tr_b16 v[214:215], v3 offset:3328
    s_waitcnt lgkmcnt(6)
    v_mfma_f32_32x32x16_bf16 v[144:159], v[200:203], a[16:19], v[144:159]
    ds_read_b64_tr_b16 v[192:193], v1 offset:32768
    ds_read_b64_tr_b16 v[194:195], v1 offset:33280
    buffer_load_dwordx4 a[72:75], v10, s[4:7], s43 offen offset:1024 sc1
    s_waitcnt vmcnt(11) lgkmcnt(4)
    v_mfma_f32_32x32x16_bf16 v[16:31], v[204:207], a[24:27], v[16:31]
    ds_read_b64_tr_b16 v[196:197], v2 offset:32768
    v_mfma_f32_32x32x16_bf16 v[32:47], v[204:207], a[28:31], v[32:47]
    ds_read_b64_tr_b16 v[198:199], v2 offset:33280
    buffer_load_dwordx4 a[76:79], v10, s[4:7], s44 offen offset:1024 sc1
    v_mfma_f32_32x32x16_bf16 v[48:63], v[208:211], a[24:27], v[48:63]
    ds_read_b64_tr_b16 v[200:201], v3 offset:4096
    v_mfma_f32_32x32x16_bf16 v[64:79], v[208:211], a[28:31], v[64:79]
    ds_read_b64_tr_b16 v[202:203], v3 offset:4352
    buffer_load_dwordx4 a[80:83], v10, s[4:7], s43 offen offset:2048 sc1
    s_waitcnt lgkmcnt(6)
    v_mfma_f32_32x32x16_bf16 v[144:159], v[212:215], a[24:27], v[144:159]
    ds_read_b64_tr_b16 v[204:205], v1 offset:34816
    ds_read_b64_tr_b16 v[206:207], v1 offset:35328
    s_waitcnt vmcnt(11) lgkmcnt(4)
    v_mfma_f32_32x32x16_bf16 v[16:31], v[192:195], a[32:35], v[16:31]
    ds_read_b64_tr_b16 v[208:209], v2 offset:34816
    buffer_load_dwordx4 a[84:87], v10, s[4:7], s44 offen offset:2048 sc1
    v_mfma_f32_32x32x16_bf16 v[32:47], v[192:195], a[36:39], v[32:47]
    ds_read_b64_tr_b16 v[210:211], v2 offset:35328
    v_mfma_f32_32x32x16_bf16 v[48:63], v[196:199], a[32:35], v[48:63]
    ds_read_b64_tr_b16 v[212:213], v3 offset:5120
    buffer_load_dwordx4 a[88:91], v10, s[4:7], s43 offen offset:3072 sc1
    v_mfma_f32_32x32x16_bf16 v[64:79], v[196:199], a[36:39], v[64:79]
    ds_read_b64_tr_b16 v[214:215], v3 offset:5376
    s_waitcnt lgkmcnt(6)
    v_mfma_f32_32x32x16_bf16 v[144:159], v[200:203], a[32:35], v[144:159]
    s_barrier
    ds_read_b64_tr_b16 v[192:193], v1 offset:36864
    ds_read_b64_tr_b16 v[194:195], v1 offset:37376
    s_waitcnt vmcnt(11) lgkmcnt(4)
    v_mfma_f32_32x32x16_bf16 v[16:31], v[204:207], a[40:43], v[16:31]
    ds_read_b64_tr_b16 v[196:197], v2 offset:36864
    buffer_load_dwordx4 a[92:95], v10, s[4:7], s44 offen offset:3072 sc1
    v_mfma_f32_32x32x16_bf16 v[32:47], v[204:207], a[44:47], v[32:47]
    ds_read_b64_tr_b16 v[198:199], v2 offset:37376
    v_mfma_f32_32x32x16_bf16 v[48:63], v[208:211], a[40:43], v[48:63]
    ds_read_b64_tr_b16 v[200:201], v3 offset:6144
    s_add_u32 s43, s43, 4096
    buffer_load_dwordx4 a[96:99], v10, s[4:7], s43 offen offset:0 sc1
    v_mfma_f32_32x32x16_bf16 v[64:79], v[208:211], a[44:47], v[64:79]
    ds_read_b64_tr_b16 v[202:203], v3 offset:6400
    s_waitcnt lgkmcnt(6)
    v_mfma_f32_32x32x16_bf16 v[144:159], v[212:215], a[40:43], v[144:159]
    ds_read_b64_tr_b16 v[204:205], v1 offset:38912
    ds_read_b64_tr_b16 v[206:207], v1 offset:39424
    s_add_u32 s44, s44, 4096
    buffer_load_dwordx4 a[100:103], v10, s[4:7], s44 offen offset:0 sc1
    s_waitcnt vmcnt(12) lgkmcnt(4)
    v_mfma_f32_32x32x16_bf16 v[16:31], v[192:195], a[48:51], v[16:31]
    ds_read_b64_tr_b16 v[208:209], v2 offset:38912
    v_mfma_f32_32x32x16_bf16 v[32:47], v[192:195], a[52:55], v[32:47]
    ds_read_b64_tr_b16 v[210:211], v2 offset:39424
    buffer_load_dwordx4 a[104:107], v10, s[4:7], s43 offen offset:1024 sc1
    v_mfma_f32_32x32x16_bf16 v[48:63], v[196:199], a[48:51], v[48:63]
    ds_read_b64_tr_b16 v[212:213], v3 offset:7168
    v_mfma_f32_32x32x16_bf16 v[64:79], v[196:199], a[52:55], v[64:79]
    ds_read_b64_tr_b16 v[214:215], v3 offset:7424
    buffer_load_dwordx4 a[108:111], v10, s[4:7], s44 offen offset:1024 sc1
    s_waitcnt lgkmcnt(6)
    v_mfma_f32_32x32x16_bf16 v[144:159], v[200:203], a[48:51], v[144:159]
    ds_read_b64_tr_b16 v[192:193], v1 offset:40960
    ds_read_b64_tr_b16 v[194:195], v1 offset:41472
    s_waitcnt vmcnt(12) lgkmcnt(4)
    v_mfma_f32_32x32x16_bf16 v[16:31], v[204:207], a[56:59], v[16:31]
    ds_read_b64_tr_b16 v[196:197], v2 offset:40960
    s_add_u32 m0, s45, 126976
    s_add_u32 s50, s46, 2654208
    buffer_load_dwordx4 v7, s[8:11], s50 offen offset:0 lds
    v_mfma_f32_32x32x16_bf16 v[32:47], v[204:207], a[60:63], v[32:47]
    ds_read_b64_tr_b16 v[198:199], v2 offset:41472
    v_mfma_f32_32x32x16_bf16 v[48:63], v[208:211], a[56:59], v[48:63]
    ds_read_b64_tr_b16 v[200:201], v3 offset:8192
    buffer_load_dwordx4 v8, s[8:11], s50 offen offset:1024 lds
    v_mfma_f32_32x32x16_bf16 v[64:79], v[208:211], a[60:63], v[64:79]
    ds_read_b64_tr_b16 v[202:203], v3 offset:8448
    s_waitcnt lgkmcnt(6)
    v_mfma_f32_32x32x16_bf16 v[144:159], v[212:215], a[56:59], v[144:159]
    ds_read_b64_tr_b16 v[204:205], v1 offset:43008
    ds_read_b64_tr_b16 v[206:207], v1 offset:43520
    buffer_load_dwordx4 v9, s[8:11], s50 offen offset:2048 lds
    s_waitcnt vmcnt(13) lgkmcnt(4)
    v_mfma_f32_32x32x16_bf16 v[16:31], v[192:195], a[64:67], v[16:31]
    ds_read_b64_tr_b16 v[208:209], v2 offset:43008
    v_mfma_f32_32x32x16_bf16 v[32:47], v[192:195], a[68:71], v[32:47]
    ds_read_b64_tr_b16 v[210:211], v2 offset:43520
    buffer_load_dwordx4 a[112:115], v10, s[4:7], s43 offen offset:2048 sc1
    v_mfma_f32_32x32x16_bf16 v[48:63], v[196:199], a[64:67], v[48:63]
    ds_read_b64_tr_b16 v[212:213], v3 offset:9216
    v_mfma_f32_32x32x16_bf16 v[64:79], v[196:199], a[68:71], v[64:79]
    ds_read_b64_tr_b16 v[214:215], v3 offset:9472
    buffer_load_dwordx4 a[116:119], v10, s[4:7], s44 offen offset:2048 sc1
    s_waitcnt lgkmcnt(6)
    v_mfma_f32_32x32x16_bf16 v[144:159], v[200:203], a[64:67], v[144:159]
    ds_read_b64_tr_b16 v[192:193], v1 offset:45056
    ds_read_b64_tr_b16 v[194:195], v1 offset:45568
    s_waitcnt vmcnt(13) lgkmcnt(4)
    v_mfma_f32_32x32x16_bf16 v[16:31], v[204:207], a[72:75], v[16:31]
    ds_read_b64_tr_b16 v[196:197], v2 offset:45056
    buffer_load_dwordx4 a[120:123], v10, s[4:7], s43 offen offset:3072 sc1
    v_mfma_f32_32x32x16_bf16 v[32:47], v[204:207], a[76:79], v[32:47]
    ds_read_b64_tr_b16 v[198:199], v2 offset:45568
    v_mfma_f32_32x32x16_bf16 v[48:63], v[208:211], a[72:75], v[48:63]
    ds_read_b64_tr_b16 v[200:201], v3 offset:10240
    buffer_load_dwordx4 a[124:127], v10, s[4:7], s44 offen offset:3072 sc1
    v_mfma_f32_32x32x16_bf16 v[64:79], v[208:211], a[76:79], v[64:79]
    ds_read_b64_tr_b16 v[202:203], v3 offset:10496
    s_waitcnt lgkmcnt(6)
    v_mfma_f32_32x32x16_bf16 v[144:159], v[212:215], a[72:75], v[144:159]
    ds_read_b64_tr_b16 v[204:205], v1 offset:47104
    ds_read_b64_tr_b16 v[206:207], v1 offset:47616
    s_waitcnt vmcnt(13) lgkmcnt(4)
    v_mfma_f32_32x32x16_bf16 v[16:31], v[192:195], a[80:83], v[16:31]
    ds_read_b64_tr_b16 v[208:209], v2 offset:47104
    s_add_u32 s43, s43, 4096
    buffer_load_dwordx4 a[128:131], v10, s[4:7], s43 offen offset:0 sc1
    v_mfma_f32_32x32x16_bf16 v[32:47], v[192:195], a[84:87], v[32:47]
    ds_read_b64_tr_b16 v[210:211], v2 offset:47616
    v_mfma_f32_32x32x16_bf16 v[48:63], v[196:199], a[80:83], v[48:63]
    ds_read_b64_tr_b16 v[212:213], v3 offset:11264
    s_add_u32 s44, s44, 4096
    buffer_load_dwordx4 a[132:135], v10, s[4:7], s44 offen offset:0 sc1
    v_mfma_f32_32x32x16_bf16 v[64:79], v[196:199], a[84:87], v[64:79]
    ds_read_b64_tr_b16 v[214:215], v3 offset:11520
    s_waitcnt lgkmcnt(6)
    v_mfma_f32_32x32x16_bf16 v[144:159], v[200:203], a[80:83], v[144:159]
    s_barrier
    ds_read_b64_tr_b16 v[192:193], v1 offset:49152
    ds_read_b64_tr_b16 v[194:195], v1 offset:49664
    buffer_load_dwordx4 a[136:139], v10, s[4:7], s43 offen offset:1024 sc1
    s_waitcnt vmcnt(14) lgkmcnt(4)
    v_mfma_f32_32x32x16_bf16 v[16:31], v[204:207], a[88:91], v[16:31]
    ds_read_b64_tr_b16 v[196:197], v2 offset:49152
    v_mfma_f32_32x32x16_bf16 v[32:47], v[204:207], a[92:95], v[32:47]
    ds_read_b64_tr_b16 v[198:199], v2 offset:49664
    buffer_load_dwordx4 a[140:143], v10, s[4:7], s44 offen offset:1024 sc1
    v_mfma_f32_32x32x16_bf16 v[48:63], v[208:211], a[88:91], v[48:63]
    ds_read_b64_tr_b16 v[200:201], v3 offset:12288
    v_mfma_f32_32x32x16_bf16 v[64:79], v[208:211], a[92:95], v[64:79]
    ds_read_b64_tr_b16 v[202:203], v3 offset:12544
    buffer_load_dwordx4 a[144:147], v10, s[4:7], s43 offen offset:2048 sc1
    s_waitcnt lgkmcnt(6)
    v_mfma_f32_32x32x16_bf16 v[144:159], v[212:215], a[88:91], v[144:159]
    ds_read_b64_tr_b16 v[204:205], v1 offset:51200
    ds_read_b64_tr_b16 v[206:207], v1 offset:51712
    s_waitcnt vmcnt(14) lgkmcnt(4)
    v_mfma_f32_32x32x16_bf16 v[16:31], v[192:195], a[96:99], v[16:31]
    ds_read_b64_tr_b16 v[208:209], v2 offset:51200
    buffer_load_dwordx4 a[148:151], v10, s[4:7], s44 offen offset:2048 sc1
    v_mfma_f32_32x32x16_bf16 v[32:47], v[192:195], a[100:103], v[32:47]
    ds_read_b64_tr_b16 v[210:211], v2 offset:51712
    v_mfma_f32_32x32x16_bf16 v[48:63], v[196:199], a[96:99], v[48:63]
    ds_read_b64_tr_b16 v[212:213], v3 offset:13312
    buffer_load_dwordx4 a[152:155], v10, s[4:7], s43 offen offset:3072 sc1
    v_mfma_f32_32x32x16_bf16 v[64:79], v[196:199], a[100:103], v[64:79]
    ds_read_b64_tr_b16 v[214:215], v3 offset:13568
    s_waitcnt lgkmcnt(6)
    v_mfma_f32_32x32x16_bf16 v[144:159], v[200:203], a[96:99], v[144:159]
    ds_read_b64_tr_b16 v[192:193], v1 offset:53248
    ds_read_b64_tr_b16 v[194:195], v1 offset:53760
    buffer_load_dwordx4 a[156:159], v10, s[4:7], s44 offen offset:3072 sc1
    s_waitcnt vmcnt(15) lgkmcnt(4)
    v_mfma_f32_32x32x16_bf16 v[16:31], v[204:207], a[104:107], v[16:31]
    ds_read_b64_tr_b16 v[196:197], v2 offset:53248
    v_mfma_f32_32x32x16_bf16 v[32:47], v[204:207], a[108:111], v[32:47]
    ds_read_b64_tr_b16 v[198:199], v2 offset:53760
    s_add_u32 m0, s45, 139264
    s_add_u32 s50, s46, 3538944
    buffer_load_dwordx4 v7, s[8:11], s50 offen offset:0 lds
    v_mfma_f32_32x32x16_bf16 v[48:63], v[208:211], a[104:107], v[48:63]
    ds_read_b64_tr_b16 v[200:201], v3 offset:14336
    v_mfma_f32_32x32x16_bf16 v[64:79], v[208:211], a[108:111], v[64:79]
    ds_read_b64_tr_b16 v[202:203], v3 offset:14592
    buffer_load_dwordx4 v8, s[8:11], s50 offen offset:1024 lds
    s_waitcnt lgkmcnt(6)
    v_mfma_f32_32x32x16_bf16 v[144:159], v[212:215], a[104:107], v[144:159]
    ds_read_b64_tr_b16 v[204:205], v1 offset:55296
    ds_read_b64_tr_b16 v[206:207], v1 offset:55808
    s_waitcnt vmcnt(12) lgkmcnt(4)
    v_mfma_f32_32x32x16_bf16 v[16:31], v[192:195], a[112:115], v[16:31]
    ds_read_b64_tr_b16 v[208:209], v2 offset:55296
    buffer_load_dwordx4 v9, s[8:11], s50 offen offset:2048 lds
    v_mfma_f32_32x32x16_bf16 v[32:47], v[192:195], a[116:119], v[32:47]
    ds_read_b64_tr_b16 v[210:211], v2 offset:55808
    v_mfma_f32_32x32x16_bf16 v[48:63], v[196:199], a[112:115], v[48:63]
    ds_read_b64_tr_b16 v[212:213], v3 offset:15360
    s_add_u32 m0, s45, 77824
    s_add_u32 s50, s47, 3538944
    buffer_load_dwordx4 v245, s[8:11], s50 offen offset:0 lds
    v_mfma_f32_32x32x16_bf16 v[64:79], v[196:199], a[116:119], v[64:79]
    ds_read_b64_tr_b16 v[214:215], v3 offset:15616
    s_waitcnt lgkmcnt(6)
    v_mfma_f32_32x32x16_bf16 v[144:159], v[200:203], a[112:115], v[144:159]
    ds_read_b64_tr_b16 v[192:193], v1 offset:57344
    ds_read_b64_tr_b16 v[194:195], v1 offset:57856
    s_waitcnt vmcnt(12) lgkmcnt(4)
    v_mfma_f32_32x32x16_bf16 v[16:31], v[204:207], a[120:123], v[16:31]
    ds_read_b64_tr_b16 v[196:197], v2 offset:57344
    buffer_load_dwordx4 v247, s[8:11], s50 offen offset:1024 lds
    v_mfma_f32_32x32x16_bf16 v[32:47], v[204:207], a[124:127], v[32:47]
    ds_read_b64_tr_b16 v[198:199], v2 offset:57856
    v_mfma_f32_32x32x16_bf16 v[48:63], v[208:211], a[120:123], v[48:63]
    ds_read_b64_tr_b16 v[200:201], v3 offset:16384
    buffer_load_dwordx4 v249, s[8:11], s50 offen offset:2048 lds
    v_mfma_f32_32x32x16_bf16 v[64:79], v[208:211], a[124:127], v[64:79]
    ds_read_b64_tr_b16 v[202:203], v3 offset:16640
    s_waitcnt lgkmcnt(6)
    v_mfma_f32_32x32x16_bf16 v[144:159], v[212:215], a[120:123], v[144:159]
    ds_read_b64_tr_b16 v[204:205], v1 offset:59392
    ds_read_b64_tr_b16 v[206:207], v1 offset:59904
    s_add_u32 s43, s43, 4096
    buffer_load_dwordx4 a[160:163], v10, s[4:7], s43 offen offset:0 sc1
    s_waitcnt vmcnt(13) lgkmcnt(4)
    v_mfma_f32_32x32x16_bf16 v[16:31], v[192:195], a[128:131], v[16:31]
    ds_read_b64_tr_b16 v[208:209], v2 offset:59392
    v_mfma_f32_32x32x16_bf16 v[32:47], v[192:195], a[132:135], v[32:47]
    ds_read_b64_tr_b16 v[210:211], v2 offset:59904
    s_add_u32 s44, s44, 4096
    buffer_load_dwordx4 a[164:167], v10, s[4:7], s44 offen offset:0 sc1
    v_mfma_f32_32x32x16_bf16 v[48:63], v[196:199], a[128:131], v[48:63]
    ds_read_b64_tr_b16 v[212:213], v3 offset:17408
    v_mfma_f32_32x32x16_bf16 v[64:79], v[196:199], a[132:135], v[64:79]
    ds_read_b64_tr_b16 v[214:215], v3 offset:17664
    buffer_load_dwordx4 a[168:171], v10, s[4:7], s43 offen offset:1024 sc1
    s_waitcnt lgkmcnt(6)
    v_mfma_f32_32x32x16_bf16 v[144:159], v[200:203], a[128:131], v[144:159]
    s_barrier
    ds_read_b64_tr_b16 v[192:193], v4 offset:0
    ds_read_b64_tr_b16 v[194:195], v4 offset:512
    s_waitcnt vmcnt(13) lgkmcnt(4)
    v_mfma_f32_32x32x16_bf16 v[16:31], v[204:207], a[136:139], v[16:31]
    ds_read_b64_tr_b16 v[196:197], v5 offset:0
    buffer_load_dwordx4 a[172:175], v10, s[4:7], s44 offen offset:1024 sc1
    v_mfma_f32_32x32x16_bf16 v[32:47], v[204:207], a[140:143], v[32:47]
    ds_read_b64_tr_b16 v[198:199], v5 offset:512
    v_mfma_f32_32x32x16_bf16 v[48:63], v[208:211], a[136:139], v[48:63]
    ds_read_b64_tr_b16 v[200:201], v3 offset:18432
    buffer_load_dwordx4 a[176:179], v10, s[4:7], s43 offen offset:2048 sc1
    v_mfma_f32_32x32x16_bf16 v[64:79], v[208:211], a[140:143], v[64:79]
    ds_read_b64_tr_b16 v[202:203], v3 offset:18688
    s_waitcnt lgkmcnt(6)
    v_mfma_f32_32x32x16_bf16 v[144:159], v[212:215], a[136:139], v[144:159]
    ds_read_b64_tr_b16 v[204:205], v4 offset:2048
    ds_read_b64_tr_b16 v[206:207], v4 offset:2560
    buffer_load_dwordx4 a[180:183], v10, s[4:7], s44 offen offset:2048 sc1
    s_waitcnt vmcnt(14) lgkmcnt(4)
    v_mfma_f32_32x32x16_bf16 v[16:31], v[192:195], a[144:147], v[16:31]
    ds_read_b64_tr_b16 v[208:209], v5 offset:2048
    v_mfma_f32_32x32x16_bf16 v[32:47], v[192:195], a[148:151], v[32:47]
    ds_read_b64_tr_b16 v[210:211], v5 offset:2560
    buffer_load_dwordx4 a[184:187], v10, s[4:7], s43 offen offset:3072 sc1
    v_mfma_f32_32x32x16_bf16 v[48:63], v[196:199], a[144:147], v[48:63]
    ds_read_b64_tr_b16 v[212:213], v3 offset:19456
    v_mfma_f32_32x32x16_bf16 v[64:79], v[196:199], a[148:151], v[64:79]
    ds_read_b64_tr_b16 v[214:215], v3 offset:19712
    buffer_load_dwordx4 a[188:191], v10, s[4:7], s44 offen offset:3072 sc1
    s_waitcnt lgkmcnt(6)
    v_mfma_f32_32x32x16_bf16 v[144:159], v[200:203], a[144:147], v[144:159]
    ds_read_b64_tr_b16 v[192:193], v4 offset:4096
    ds_read_b64_tr_b16 v[194:195], v4 offset:4608
    s_waitcnt vmcnt(14) lgkmcnt(4)
    v_mfma_f32_32x32x16_bf16 v[16:31], v[204:207], a[152:155], v[16:31]
    ds_read_b64_tr_b16 v[196:197], v5 offset:4096
    s_add_u32 s43, s43, 4096
    buffer_load_dwordx4 a[192:195], v10, s[4:7], s43 offen offset:0 sc1
    v_mfma_f32_32x32x16_bf16 v[32:47], v[204:207], a[156:159], v[32:47]
    ds_read_b64_tr_b16 v[198:199], v5 offset:4608
    v_mfma_f32_32x32x16_bf16 v[48:63], v[208:211], a[152:155], v[48:63]
    ds_read_b64_tr_b16 v[200:201], v3 offset:20480
    s_add_u32 s44, s44, 4096
    buffer_load_dwordx4 a[196:199], v10, s[4:7], s44 offen offset:0 sc1
    v_mfma_f32_32x32x16_bf16 v[64:79], v[208:211], a[156:159], v[64:79]
    ds_read_b64_tr_b16 v[202:203], v3 offset:20736
    s_waitcnt lgkmcnt(6)
    v_mfma_f32_32x32x16_bf16 v[144:159], v[212:215], a[152:155], v[144:159]
    ds_read_b64_tr_b16 v[204:205], v4 offset:6144
    ds_read_b64_tr_b16 v[206:207], v4 offset:6656
    s_waitcnt vmcnt(8) lgkmcnt(4)
    v_mfma_f32_32x32x16_bf16 v[16:31], v[192:195], a[160:163], v[16:31]
    ds_read_b64_tr_b16 v[208:209], v5 offset:6144
    buffer_load_dwordx4 a[200:203], v10, s[4:7], s43 offen offset:1024 sc1
    v_mfma_f32_32x32x16_bf16 v[32:47], v[192:195], a[164:167], v[32:47]
    ds_read_b64_tr_b16 v[210:211], v5 offset:6656
    v_mfma_f32_32x32x16_bf16 v[48:63], v[196:199], a[160:163], v[48:63]
    ds_read_b64_tr_b16 v[212:213], v3 offset:21504
    buffer_load_dwordx4 a[204:207], v10, s[4:7], s44 offen offset:1024 sc1
    v_mfma_f32_32x32x16_bf16 v[64:79], v[196:199], a[164:167], v[64:79]
    ds_read_b64_tr_b16 v[214:215], v3 offset:21760
    s_waitcnt lgkmcnt(6)
    v_mfma_f32_32x32x16_bf16 v[144:159], v[200:203], a[160:163], v[144:159]
    ds_read_b64_tr_b16 v[192:193], v4 offset:8192
    ds_read_b64_tr_b16 v[194:195], v4 offset:8704
    s_add_u32 m0, s45, 151552
    s_add_u32 s50, s46, 4423680
    buffer_load_dwordx4 v7, s[8:11], s50 offen offset:0 lds
    s_waitcnt vmcnt(9) lgkmcnt(4)
    v_mfma_f32_32x32x16_bf16 v[16:31], v[204:207], a[168:171], v[16:31]
    ds_read_b64_tr_b16 v[196:197], v5 offset:8192
    v_mfma_f32_32x32x16_bf16 v[32:47], v[204:207], a[172:175], v[32:47]
    ds_read_b64_tr_b16 v[198:199], v5 offset:8704
    buffer_load_dwordx4 v8, s[8:11], s50 offen offset:1024 lds
    v_mfma_f32_32x32x16_bf16 v[48:63], v[208:211], a[168:171], v[48:63]
    ds_read_b64_tr_b16 v[200:201], v3 offset:22528
    v_mfma_f32_32x32x16_bf16 v[64:79], v[208:211], a[172:175], v[64:79]
    ds_read_b64_tr_b16 v[202:203], v3 offset:22784
    buffer_load_dwordx4 v9, s[8:11], s50 offen offset:2048 lds
    s_waitcnt lgkmcnt(6)
    v_mfma_f32_32x32x16_bf16 v[144:159], v[212:215], a[168:171], v[144:159]
    ds_read_b64_tr_b16 v[204:205], v4 offset:10240
    ds_read_b64_tr_b16 v[206:207], v4 offset:10752
    s_waitcnt vmcnt(9) lgkmcnt(4)
    v_mfma_f32_32x32x16_bf16 v[16:31], v[192:195], a[176:179], v[16:31]
    ds_read_b64_tr_b16 v[208:209], v5 offset:10240
    buffer_load_dwordx4 a[208:211], v10, s[4:7], s43 offen offset:2048 sc1
    v_mfma_f32_32x32x16_bf16 v[32:47], v[192:195], a[180:183], v[32:47]
    ds_read_b64_tr_b16 v[210:211], v5 offset:10752
    v_mfma_f32_32x32x16_bf16 v[48:63], v[196:199], a[176:179], v[48:63]
    ds_read_b64_tr_b16 v[212:213], v3 offset:23552
    buffer_load_dwordx4 a[212:215], v10, s[4:7], s44 offen offset:2048 sc1
    v_mfma_f32_32x32x16_bf16 v[64:79], v[196:199], a[180:183], v[64:79]
    ds_read_b64_tr_b16 v[214:215], v3 offset:23808
    s_waitcnt lgkmcnt(6)
    v_mfma_f32_32x32x16_bf16 v[144:159], v[200:203], a[176:179], v[144:159]
    s_barrier
    ds_read_b64_tr_b16 v[192:193], v4 offset:12288
    ds_read_b64_tr_b16 v[194:195], v4 offset:12800
    buffer_load_dwordx4 a[216:219], v10, s[4:7], s43 offen offset:3072 sc1
    s_waitcnt vmcnt(10) lgkmcnt(4)
    v_mfma_f32_32x32x16_bf16 v[16:31], v[204:207], a[184:187], v[16:31]
    ds_read_b64_tr_b16 v[196:197], v5 offset:12288
    v_mfma_f32_32x32x16_bf16 v[32:47], v[204:207], a[188:191], v[32:47]
    ds_read_b64_tr_b16 v[198:199], v5 offset:12800
    buffer_load_dwordx4 a[220:223], v10, s[4:7], s44 offen offset:3072 sc1
    v_mfma_f32_32x32x16_bf16 v[48:63], v[208:211], a[184:187], v[48:63]
    ds_read_b64_tr_b16 v[200:201], v3 offset:24576
    v_mfma_f32_32x32x16_bf16 v[64:79], v[208:211], a[188:191], v[64:79]
    ds_read_b64_tr_b16 v[202:203], v3 offset:24832
    s_add_u32 s43, s43, 4096
    buffer_load_dwordx4 a[224:227], v10, s[4:7], s43 offen offset:0 sc1
    s_waitcnt lgkmcnt(6)
    v_mfma_f32_32x32x16_bf16 v[144:159], v[212:215], a[184:187], v[144:159]
    ds_read_b64_tr_b16 v[204:205], v4 offset:14336
    ds_read_b64_tr_b16 v[206:207], v4 offset:14848
    s_waitcnt vmcnt(10) lgkmcnt(4)
    v_mfma_f32_32x32x16_bf16 v[16:31], v[192:195], a[192:195], v[16:31]
    ds_read_b64_tr_b16 v[208:209], v5 offset:14336
    s_add_u32 s44, s44, 4096
    buffer_load_dwordx4 a[228:231], v10, s[4:7], s44 offen offset:0 sc1
    v_mfma_f32_32x32x16_bf16 v[32:47], v[192:195], a[196:199], v[32:47]
    ds_read_b64_tr_b16 v[210:211], v5 offset:14848
    v_mfma_f32_32x32x16_bf16 v[48:63], v[196:199], a[192:195], v[48:63]
    ds_read_b64_tr_b16 v[212:213], v3 offset:25600
    buffer_load_dwordx4 a[232:235], v10, s[4:7], s43 offen offset:1024 sc1
    v_mfma_f32_32x32x16_bf16 v[64:79], v[196:199], a[196:199], v[64:79]
    ds_read_b64_tr_b16 v[214:215], v3 offset:25856
    s_waitcnt lgkmcnt(6)
    v_mfma_f32_32x32x16_bf16 v[144:159], v[200:203], a[192:195], v[144:159]
    ds_read_b64_tr_b16 v[192:193], v4 offset:16384
    ds_read_b64_tr_b16 v[194:195], v4 offset:16896
    s_waitcnt vmcnt(10) lgkmcnt(4)
    v_mfma_f32_32x32x16_bf16 v[16:31], v[204:207], a[200:203], v[16:31]
    ds_read_b64_tr_b16 v[196:197], v5 offset:16384
    buffer_load_dwordx4 a[236:239], v10, s[4:7], s44 offen offset:1024 sc1
    v_mfma_f32_32x32x16_bf16 v[32:47], v[204:207], a[204:207], v[32:47]
    ds_read_b64_tr_b16 v[198:199], v5 offset:16896
    v_mfma_f32_32x32x16_bf16 v[48:63], v[208:211], a[200:203], v[48:63]
    ds_read_b64_tr_b16 v[200:201], v3 offset:26624
    buffer_load_dwordx4 a[240:243], v10, s[4:7], s43 offen offset:2048 sc1
    v_mfma_f32_32x32x16_bf16 v[64:79], v[208:211], a[204:207], v[64:79]
    ds_read_b64_tr_b16 v[202:203], v3 offset:26880
    s_waitcnt lgkmcnt(6)
    v_mfma_f32_32x32x16_bf16 v[144:159], v[212:215], a[200:203], v[144:159]
    ds_read_b64_tr_b16 v[204:205], v4 offset:18432
    ds_read_b64_tr_b16 v[206:207], v4 offset:18944
    buffer_load_dwordx4 a[244:247], v10, s[4:7], s44 offen offset:2048 sc1
    s_waitcnt vmcnt(8) lgkmcnt(4)
    v_mfma_f32_32x32x16_bf16 v[16:31], v[192:195], a[208:211], v[16:31]
    ds_read_b64_tr_b16 v[208:209], v5 offset:18432
    v_mfma_f32_32x32x16_bf16 v[32:47], v[192:195], a[212:215], v[32:47]
    ds_read_b64_tr_b16 v[210:211], v5 offset:18944
    buffer_load_dwordx4 a[248:251], v10, s[4:7], s43 offen offset:3072 sc1
    v_mfma_f32_32x32x16_bf16 v[48:63], v[196:199], a[208:211], v[48:63]
    ds_read_b64_tr_b16 v[212:213], v3 offset:27648
    v_mfma_f32_32x32x16_bf16 v[64:79], v[196:199], a[212:215], v[64:79]
    ds_read_b64_tr_b16 v[214:215], v3 offset:27904
    buffer_load_dwordx4 a[252:255], v10, s[4:7], s44 offen offset:3072 sc1
    s_waitcnt lgkmcnt(6)
    v_mfma_f32_32x32x16_bf16 v[144:159], v[200:203], a[208:211], v[144:159]
    ds_read_b64_tr_b16 v[192:193], v4 offset:20480
    ds_read_b64_tr_b16 v[194:195], v4 offset:20992
    s_waitcnt vmcnt(8) lgkmcnt(4)
    v_mfma_f32_32x32x16_bf16 v[16:31], v[204:207], a[216:219], v[16:31]
    ds_read_b64_tr_b16 v[196:197], v5 offset:20480
    s_add_u32 s43, s43, 4096
    buffer_load_dwordx4 v[160:163], v10, s[4:7], s43 offen offset:0 sc1
    v_mfma_f32_32x32x16_bf16 v[32:47], v[204:207], a[220:223], v[32:47]
    ds_read_b64_tr_b16 v[198:199], v5 offset:20992
    v_mfma_f32_32x32x16_bf16 v[48:63], v[208:211], a[216:219], v[48:63]
    ds_read_b64_tr_b16 v[200:201], v3 offset:28672
    s_add_u32 s44, s44, 4096
    buffer_load_dwordx4 v[164:167], v10, s[4:7], s44 offen offset:0 sc1
    v_mfma_f32_32x32x16_bf16 v[64:79], v[208:211], a[220:223], v[64:79]
    ds_read_b64_tr_b16 v[202:203], v3 offset:28928
    s_waitcnt lgkmcnt(6)
    v_mfma_f32_32x32x16_bf16 v[144:159], v[212:215], a[216:219], v[144:159]
    ds_read_b64_tr_b16 v[204:205], v4 offset:22528
    ds_read_b64_tr_b16 v[206:207], v4 offset:23040
    buffer_load_dwordx4 v[168:171], v10, s[4:7], s43 offen offset:1024 sc1
    s_waitcnt vmcnt(9) lgkmcnt(4)
    v_mfma_f32_32x32x16_bf16 v[16:31], v[192:195], a[224:227], v[16:31]
    ds_read_b64_tr_b16 v[208:209], v5 offset:22528
    v_mfma_f32_32x32x16_bf16 v[32:47], v[192:195], a[228:231], v[32:47]
    ds_read_b64_tr_b16 v[210:211], v5 offset:23040
    buffer_load_dwordx4 v[172:175], v10, s[4:7], s44 offen offset:1024 sc1
    v_mfma_f32_32x32x16_bf16 v[48:63], v[196:199], a[224:227], v[48:63]
    ds_read_b64_tr_b16 v[212:213], v3 offset:29696
    v_mfma_f32_32x32x16_bf16 v[64:79], v[196:199], a[228:231], v[64:79]
    ds_read_b64_tr_b16 v[214:215], v3 offset:29952
    buffer_load_dwordx4 v[176:179], v10, s[4:7], s43 offen offset:2048 sc1
    s_waitcnt lgkmcnt(6)
    v_mfma_f32_32x32x16_bf16 v[144:159], v[200:203], a[224:227], v[144:159]
    s_barrier
    ds_read_b64_tr_b16 v[192:193], v4 offset:24576
    ds_read_b64_tr_b16 v[194:195], v4 offset:25088
    s_waitcnt vmcnt(9) lgkmcnt(4)
    v_mfma_f32_32x32x16_bf16 v[16:31], v[204:207], a[232:235], v[16:31]
    ds_read_b64_tr_b16 v[196:197], v5 offset:24576
    buffer_load_dwordx4 v[180:183], v10, s[4:7], s44 offen offset:2048 sc1
    v_mfma_f32_32x32x16_bf16 v[32:47], v[204:207], a[236:239], v[32:47]
    ds_read_b64_tr_b16 v[198:199], v5 offset:25088
    v_mfma_f32_32x32x16_bf16 v[48:63], v[208:211], a[232:235], v[48:63]
    ds_read_b64_tr_b16 v[200:201], v3 offset:30720
    buffer_load_dwordx4 v[184:187], v10, s[4:7], s43 offen offset:3072 sc1
    v_mfma_f32_32x32x16_bf16 v[64:79], v[208:211], a[236:239], v[64:79]
    ds_read_b64_tr_b16 v[202:203], v3 offset:30976
    s_waitcnt lgkmcnt(6)
    v_mfma_f32_32x32x16_bf16 v[144:159], v[212:215], a[232:235], v[144:159]
    ds_read_b64_tr_b16 v[204:205], v4 offset:26624
    ds_read_b64_tr_b16 v[206:207], v4 offset:27136
    s_waitcnt vmcnt(9) lgkmcnt(4)
    v_mfma_f32_32x32x16_bf16 v[16:31], v[192:195], a[240:243], v[16:31]
    ds_read_b64_tr_b16 v[208:209], v5 offset:26624
    buffer_load_dwordx4 v[188:191], v10, s[4:7], s44 offen offset:3072 sc1
    v_mfma_f32_32x32x16_bf16 v[32:47], v[192:195], a[244:247], v[32:47]
    ds_read_b64_tr_b16 v[210:211], v5 offset:27136
    v_mfma_f32_32x32x16_bf16 v[48:63], v[196:199], a[240:243], v[48:63]
    ds_read_b64_tr_b16 v[212:213], v3 offset:31744
    s_add_u32 m0, s45, 4096
    s_add_u32 s50, s49, 0
    buffer_load_dwordx4 v14, s[12:15], s50 offen offset:0 lds
    v_mfma_f32_32x32x16_bf16 v[64:79], v[196:199], a[244:247], v[64:79]
    ds_read_b64_tr_b16 v[214:215], v3 offset:32000
    s_waitcnt lgkmcnt(6)
    v_mfma_f32_32x32x16_bf16 v[144:159], v[200:203], a[240:243], v[144:159]
    ds_read_b64_tr_b16 v[192:193], v4 offset:28672
    ds_read_b64_tr_b16 v[194:195], v4 offset:29184
    buffer_load_dwordx4 v15, s[12:15], s50 offen offset:1024 lds
    s_waitcnt vmcnt(10) lgkmcnt(4)
    v_mfma_f32_32x32x16_bf16 v[16:31], v[204:207], a[248:251], v[16:31]
    ds_read_b64_tr_b16 v[196:197], v5 offset:28672
    v_mfma_f32_32x32x16_bf16 v[32:47], v[204:207], a[252:255], v[32:47]
    ds_read_b64_tr_b16 v[198:199], v5 offset:29184
    buffer_load_dwordx4 v223, s[12:15], s50 offen offset:2048 lds
    v_mfma_f32_32x32x16_bf16 v[48:63], v[208:211], a[248:251], v[48:63]
    ds_read_b64_tr_b16 v[200:201], v3 offset:32768
    v_mfma_f32_32x32x16_bf16 v[64:79], v[208:211], a[252:255], v[64:79]
    ds_read_b64_tr_b16 v[202:203], v3 offset:33024
    s_add_u32 m0, s45, 16384
    s_add_u32 s50, s49, 331776
    buffer_load_dwordx4 v14, s[12:15], s50 offen offset:0 lds
    s_waitcnt lgkmcnt(6)
    v_mfma_f32_32x32x16_bf16 v[144:159], v[212:215], a[248:251], v[144:159]
    ds_read_b64_tr_b16 v[204:205], v4 offset:30720
    ds_read_b64_tr_b16 v[206:207], v4 offset:31232
    s_waitcnt vmcnt(10) lgkmcnt(4)
    v_mfma_f32_32x32x16_bf16 v[16:31], v[192:195], v[160:163], v[16:31]
    ds_read_b64_tr_b16 v[208:209], v5 offset:30720
    buffer_load_dwordx4 v15, s[12:15], s50 offen offset:1024 lds
    v_mfma_f32_32x32x16_bf16 v[32:47], v[192:195], v[164:167], v[32:47]
    ds_read_b64_tr_b16 v[210:211], v5 offset:31232
    v_mfma_f32_32x32x16_bf16 v[48:63], v[196:199], v[160:163], v[48:63]
    ds_read_b64_tr_b16 v[212:213], v3 offset:33792
    buffer_load_dwordx4 v223, s[12:15], s50 offen offset:2048 lds
    v_mfma_f32_32x32x16_bf16 v[64:79], v[196:199], v[164:167], v[64:79]
    ds_read_b64_tr_b16 v[214:215], v3 offset:34048
    s_waitcnt lgkmcnt(6)
    v_mfma_f32_32x32x16_bf16 v[144:159], v[200:203], v[160:163], v[144:159]
    ds_read_b64_tr_b16 v[192:193], v4 offset:32768
    ds_read_b64_tr_b16 v[194:195], v4 offset:33280
    s_add_u32 m0, s45, 28672
    s_add_u32 s50, s49, 663552
    buffer_load_dwordx4 v14, s[12:15], s50 offen offset:0 lds
    s_waitcnt vmcnt(11) lgkmcnt(4)
    v_mfma_f32_32x32x16_bf16 v[16:31], v[204:207], v[168:171], v[16:31]
    ds_read_b64_tr_b16 v[196:197], v5 offset:32768
    v_mfma_f32_32x32x16_bf16 v[32:47], v[204:207], v[172:175], v[32:47]
    ds_read_b64_tr_b16 v[198:199], v5 offset:33280
    buffer_load_dwordx4 v15, s[12:15], s50 offen offset:1024 lds
    v_mfma_f32_32x32x16_bf16 v[48:63], v[208:211], v[168:171], v[48:63]
    ds_read_b64_tr_b16 v[200:201], v3 offset:34816
    v_mfma_f32_32x32x16_bf16 v[64:79], v[208:211], v[172:175], v[64:79]
    ds_read_b64_tr_b16 v[202:203], v3 offset:35072
    buffer_load_dwordx4 v223, s[12:15], s50 offen offset:2048 lds
    s_waitcnt lgkmcnt(6)
    v_mfma_f32_32x32x16_bf16 v[144:159], v[212:215], v[168:171], v[144:159]
    ds_read_b64_tr_b16 v[204:205], v4 offset:34816
    ds_read_b64_tr_b16 v[206:207], v4 offset:35328
    v_subrev_u32 v245, 61440, v1
    v_subrev_u32 v247, 61440, v2
    s_waitcnt vmcnt(11) lgkmcnt(4)
    v_mfma_f32_32x32x16_bf16 v[16:31], v[192:195], v[176:179], v[16:31]
    ds_read_b64_tr_b16 v[208:209], v5 offset:34816
    s_add_u32 m0, s45, 40960
    s_add_u32 s50, s49, 995328
    buffer_load_dwordx4 v14, s[12:15], s50 offen offset:0 lds
    v_mfma_f32_32x32x16_bf16 v[32:47], v[192:195], v[180:183], v[32:47]
    ds_read_b64_tr_b16 v[210:211], v5 offset:35328
    v_mfma_f32_32x32x16_bf16 v[48:63], v[196:199], v[176:179], v[48:63]
    ds_read_b64_tr_b16 v[212:213], v3 offset:35840
    buffer_load_dwordx4 v15, s[12:15], s50 offen offset:1024 lds
    v_mfma_f32_32x32x16_bf16 v[64:79], v[196:199], v[180:183], v[64:79]
    ds_read_b64_tr_b16 v[214:215], v3 offset:36096
    s_waitcnt lgkmcnt(6)
    v_mfma_f32_32x32x16_bf16 v[144:159], v[200:203], v[176:179], v[144:159]
    s_waitcnt vmcnt(8)
    s_barrier
    ds_read_b64_tr_b16 v[192:193], v245 offset:0
    ds_read_b64_tr_b16 v[194:195], v245 offset:512
    s_waitcnt lgkmcnt(4)
    v_mfma_f32_32x32x16_bf16 v[16:31], v[204:207], v[184:187], v[16:31]
    ds_read_b64_tr_b16 v[196:197], v245 offset:2048
    buffer_load_dwordx4 v223, s[12:15], s50 offen offset:2048 lds
    v_mfma_f32_32x32x16_bf16 v[32:47], v[204:207], v[188:191], v[32:47]
    ds_read_b64_tr_b16 v[198:199], v245 offset:2560
    v_mfma_f32_32x32x16_bf16 v[48:63], v[208:211], v[184:187], v[48:63]
    ds_read_b64_tr_b16 v[200:201], v245 offset:4096
    s_add_u32 m0, s45, 53248
    s_add_u32 s50, s49, 1327104
    buffer_load_dwordx4 v14, s[12:15], s50 offen offset:0 lds
    v_mfma_f32_32x32x16_bf16 v[64:79], v[208:211], v[188:191], v[64:79]
    ds_read_b64_tr_b16 v[202:203], v245 offset:4608
    s_waitcnt lgkmcnt(6)
    v_mfma_f32_32x32x16_bf16 v[144:159], v[212:215], v[184:187], v[144:159]
    ds_read_b64_tr_b16 v[204:205], v245 offset:6144
    ds_read_b64_tr_b16 v[206:207], v245 offset:6656
    buffer_load_dwordx4 v15, s[12:15], s50 offen offset:1024 lds
    s_waitcnt lgkmcnt(4)
    v_mfma_f32_32x32x16_bf16 v[80:95], v[192:195], a[0:3], 0
    ds_read_b64_tr_b16 v[208:209], v245 offset:8192
    v_mfma_f32_32x32x16_bf16 v[96:111], v[192:195], a[4:7], 0
    ds_read_b64_tr_b16 v[210:211], v245 offset:8704
    buffer_load_dwordx4 v223, s[12:15], s50 offen offset:2048 lds
    v_mfma_f32_32x32x16_bf16 v[80:95], v[196:199], a[8:11], v[80:95]
    ds_read_b64_tr_b16 v[212:213], v245 offset:10240
    v_add_u32 v222, 0, v255
    global_load_dword v254, v222, s[84:85]
    v_fma_f32 v224, -v16, v16, -s52
    v_fma_f32 v225, -v17, v17, -s52
    v_fma_f32 v226, -v18, v18, -s52
    v_fma_f32 v227, -v19, v19, -s52
    v_mul_f32 v224, v224, v16
    v_mul_f32 v225, v225, v17
    v_mfma_f32_32x32x16_bf16 v[96:111], v[196:199], a[12:15], v[96:111]
    ds_read_b64_tr_b16 v[214:215], v245 offset:10752
    s_add_u32 m0, s45, 65536
    s_add_u32 s50, s49, 1658880
    buffer_load_dwordx4 v14, s[12:15], s50 offen offset:0 lds
    v_mul_f32 v226, v226, v18
    v_mul_f32 v227, v227, v19
    v_exp_f32 v224, v224
    s_waitcnt lgkmcnt(4)
    v_mfma_f32_32x32x16_bf16 v[80:95], v[200:203], a[16:19], v[80:95]
    s_waitcnt vmcnt(11)
    s_barrier
    ds_read_b64_tr_b16 v[192:193], v245 offset:12288
    v_exp_f32 v225, v225
    v_exp_f32 v226, v226
    v_exp_f32 v227, v227
    v_mfma_f32_32x32x16_bf16 v[96:111], v[200:203], a[20:23], v[96:111]
    ds_read_b64_tr_b16 v[194:195], v245 offset:12800
    buffer_load_dwordx4 v15, s[12:15], s50 offen offset:1024 lds
    v_add_f32 v224, 1.0, v224
    v_add_f32 v225, 1.0, v225
    v_add_f32 v226, 1.0, v226
    v_add_f32 v227, 1.0, v227
    v_rcp_f32 v224, v224
    v_mfma_f32_32x32x16_bf16 v[80:95], v[204:207], a[24:27], v[80:95]
    ds_read_b64_tr_b16 v[196:197], v245 offset:14336
    v_rcp_f32 v225, v225
    v_rcp_f32 v226, v226
    v_rcp_f32 v227, v227
    v_mul_f32 v224, v224, v16
    v_mul_f32 v225, v225, v17
    v_mul_f32 v226, v226, v18
    v_mfma_f32_32x32x16_bf16 v[96:111], v[204:207], a[28:31], v[96:111]
    ds_read_b64_tr_b16 v[198:199], v245 offset:14848
    buffer_load_dwordx4 v223, s[12:15], s50 offen offset:2048 lds
    v_mul_f32 v227, v227, v19
    v_add_f32 v216, v216, v224
    v_fmac_f32 v217, v224, v224
    v_add_f32 v216, v216, v225
    v_fmac_f32 v217, v225, v225
    v_add_f32 v216, v216, v226
    s_waitcnt lgkmcnt(4)
    v_mfma_f32_32x32x16_bf16 v[80:95], v[208:211], a[32:35], v[80:95]
    ds_read_b64_tr_b16 v[200:201], v245 offset:16384
    v_fmac_f32 v217, v226, v226
    v_add_f32 v216, v216, v227
    v_fmac_f32 v217, v227, v227
    v_cvt_pk_bf16_f32 v16, v224, v225
    v_cvt_pk_bf16_f32 v17, v226, v227
    v_fma_f32 v228, -v20, v20, -s52
    v_fma_f32 v229, -v21, v21, -s52
    v_fma_f32 v230, -v22, v22, -s52
    v_mfma_f32_32x32x16_bf16 v[96:111], v[208:211], a[36:39], v[96:111]
    ds_read_b64_tr_b16 v[202:203], v245 offset:16896
    v_fma_f32 v231, -v23, v23, -s52
    v_mul_f32 v228, v228, v20
    v_mul_f32 v229, v229, v21
    v_mul_f32 v230, v230, v22
    v_mul_f32 v231, v231, v23
    v_exp_f32 v228, v228
    v_mfma_f32_32x32x16_bf16 v[80:95], v[212:215], a[40:43], v[80:95]
    ds_read_b64_tr_b16 v[204:205], v245 offset:18432
    v_exp_f32 v229, v229
    v_exp_f32 v230, v230
    v_exp_f32 v231, v231
    v_add_f32 v228, 1.0, v228
    v_add_f32 v229, 1.0, v229
    v_add_f32 v230, 1.0, v230
    v_mfma_f32_32x32x16_bf16 v[96:111], v[212:215], a[44:47], v[96:111]
    ds_read_b64_tr_b16 v[206:207], v245 offset:18944
    v_add_f32 v231, 1.0, v231
    v_rcp_f32 v228, v228
    v_rcp_f32 v229, v229
    v_rcp_f32 v230, v230
    s_waitcnt lgkmcnt(4)
    v_mfma_f32_32x32x16_bf16 v[80:95], v[192:195], a[48:51], v[80:95]
    ds_read_b64_tr_b16 v[208:209], v245 offset:20480
    v_rcp_f32 v231, v231
    v_mul_f32 v228, v228, v20
    v_mul_f32 v229, v229, v21
    v_mul_f32 v230, v230, v22
    v_mul_f32 v231, v231, v23
    v_add_f32 v216, v216, v228
    v_fmac_f32 v217, v228, v228
    v_mfma_f32_32x32x16_bf16 v[96:111], v[192:195], a[52:55], v[96:111]
    ds_read_b64_tr_b16 v[210:211], v245 offset:20992
    s_add_u32 m0, s45, 90112
    s_add_u32 s50, s48, 0
    buffer_load_dwordx4 v7, s[8:11], s50 offen offset:0 lds
    v_add_f32 v216, v216, v229
    v_fmac_f32 v217, v229, v229
    v_add_f32 v216, v216, v230
    v_fmac_f32 v217, v230, v230
    v_add_f32 v216, v216, v231
    v_mfma_f32_32x32x16_bf16 v[80:95], v[196:199], a[56:59], v[80:95]
    ds_read_b64_tr_b16 v[212:213], v245 offset:22528
    v_fmac_f32 v217, v231, v231
    v_cvt_pk_bf16_f32 v18, v228, v229
    v_cvt_pk_bf16_f32 v19, v230, v231
    v_add_u32 v222, 2097152, v255
    global_load_dword v254, v222, s[84:85]
    v_fma_f32 v224, -v24, v24, -s52
    v_fma_f32 v225, -v25, v25, -s52
    v_fma_f32 v226, -v26, v26, -s52
    v_mfma_f32_32x32x16_bf16 v[96:111], v[196:199], a[60:63], v[96:111]
    ds_read_b64_tr_b16 v[214:215], v245 offset:23040
    v_fma_f32 v227, -v27, v27, -s52
    v_mul_f32 v224, v224, v24
    v_mul_f32 v225, v225, v25
    v_mul_f32 v226, v226, v26
    v_mul_f32 v227, v227, v27
    v_exp_f32 v224, v224
    s_waitcnt lgkmcnt(4)
    v_mfma_f32_32x32x16_bf16 v[80:95], v[200:203], a[64:67], v[80:95]
    s_waitcnt vmcnt(9)
    s_barrier
    ds_read_b64_tr_b16 v[192:193], v245 offset:24576
    v_exp_f32 v225, v225
    v_exp_f32 v226, v226
    v_exp_f32 v227, v227
    v_mfma_f32_32x32x16_bf16 v[96:111], v[200:203], a[68:71], v[96:111]
    ds_read_b64_tr_b16 v[194:195], v245 offset:25088
    v_add_f32 v224, 1.0, v224
    v_add_f32 v225, 1.0, v225
    v_add_f32 v226, 1.0, v226
    v_add_f32 v227, 1.0, v227
    v_rcp_f32 v224, v224
    v_rcp_f32 v225, v225
    v_mfma_f32_32x32x16_bf16 v[80:95], v[204:207], a[72:75], v[80:95]
    ds_read_b64_tr_b16 v[196:197], v245 offset:26624
    v_rcp_f32 v226, v226
    v_rcp_f32 v227, v227
    v_mul_f32 v224, v224, v24
    v_mul_f32 v225, v225, v25
    v_mul_f32 v226, v226, v26
    v_mul_f32 v227, v227, v27
    v_mfma_f32_32x32x16_bf16 v[96:111], v[204:207], a[76:79], v[96:111]
    ds_read_b64_tr_b16 v[198:199], v245 offset:27136
    buffer_load_dwordx4 v8, s[8:11], s50 offen offset:1024 lds
    v_add_f32 v216, v216, v224
    v_fmac_f32 v217, v224, v224
    v_add_f32 v216, v216, v225
    v_fmac_f32 v217, v225, v225
    v_add_f32 v216, v216, v226
    v_fmac_f32 v217, v226, v226
    s_waitcnt lgkmcnt(4)
    v_mfma_f32_32x32x16_bf16 v[80:95], v[208:211], a[80:83], v[80:95]
    ds_read_b64_tr_b16 v[200:201], v245 offset:28672
    v_add_f32 v216, v216, v227
    v_fmac_f32 v217, v227, v227
    v_cvt_pk_bf16_f32 v20, v224, v225
    v_cvt_pk_bf16_f32 v21, v226, v227
    v_fma_f32 v228, -v28, v28, -s52
    v_fma_f32 v229, -v29, v29, -s52
    v_fma_f32 v230, -v30, v30, -s52
    v_fma_f32 v231, -v31, v31, -s52
    v_mfma_f32_32x32x16_bf16 v[96:111], v[208:211], a[84:87], v[96:111]
    ds_read_b64_tr_b16 v[202:203], v245 offset:29184
    v_mul_f32 v228, v228, v28
    v_mul_f32 v229, v229, v29
    v_mul_f32 v230, v230, v30
    v_mul_f32 v231, v231, v31
    v_exp_f32 v228, v228
    v_exp_f32 v229, v229
    v_mfma_f32_32x32x16_bf16 v[80:95], v[212:215], a[88:91], v[80:95]
    ds_read_b64_tr_b16 v[204:205], v245 offset:30720
    v_exp_f32 v230, v230
    v_exp_f32 v231, v231
    v_add_f32 v228, 1.0, v228
    v_add_f32 v229, 1.0, v229
    v_add_f32 v230, 1.0, v230
    v_add_f32 v231, 1.0, v231
    v_mfma_f32_32x32x16_bf16 v[96:111], v[212:215], a[92:95], v[96:111]
    ds_read_b64_tr_b16 v[206:207], v245 offset:31232
    v_rcp_f32 v228, v228
    v_rcp_f32 v229, v229
    v_rcp_f32 v230, v230
    s_waitcnt lgkmcnt(4)
    v_mfma_f32_32x32x16_bf16 v[80:95], v[192:195], a[96:99], v[80:95]
    ds_read_b64_tr_b16 v[208:209], v245 offset:32768
    v_rcp_f32 v231, v231
    v_mul_f32 v228, v228, v28
    v_mul_f32 v229, v229, v29
    v_mul_f32 v230, v230, v30
    v_mul_f32 v231, v231, v31
    v_add_f32 v216, v216, v228
    v_fmac_f32 v217, v228, v228
    v_add_f32 v216, v216, v229
    v_mfma_f32_32x32x16_bf16 v[96:111], v[192:195], a[100:103], v[96:111]
    ds_read_b64_tr_b16 v[210:211], v245 offset:33280
    buffer_load_dwordx4 v9, s[8:11], s50 offen offset:2048 lds
    v_fmac_f32 v217, v229, v229
    v_add_f32 v216, v216, v230
    v_fmac_f32 v217, v230, v230
    v_add_f32 v216, v216, v231
    v_fmac_f32 v217, v231, v231
    v_cvt_pk_bf16_f32 v22, v228, v229
    v_cvt_pk_bf16_f32 v23, v230, v231
    v_mfma_f32_32x32x16_bf16 v[80:95], v[196:199], a[104:107], v[80:95]
    ds_read_b64_tr_b16 v[212:213], v245 offset:34816
    v_add_u32 v222, 4194304, v255
    global_load_dword v254, v222, s[84:85]
    v_fma_f32 v224, -v32, v32, -s52
    v_fma_f32 v225, -v33, v33, -s52
    v_fma_f32 v226, -v34, v34, -s52
    v_fma_f32 v227, -v35, v35, -s52
    v_mul_f32 v224, v224, v32
    v_mul_f32 v225, v225, v33
    v_mfma_f32_32x32x16_bf16 v[96:111], v[196:199], a[108:111], v[96:111]
    ds_read_b64_tr_b16 v[214:215], v245 offset:35328
    v_mul_f32 v226, v226, v34
    v_mul_f32 v227, v227, v35
    v_exp_f32 v224, v224
    v_exp_f32 v225, v225
    s_waitcnt lgkmcnt(4)
    v_mfma_f32_32x32x16_bf16 v[80:95], v[200:203], a[112:115], v[80:95]
    ds_read_b64_tr_b16 v[192:193], v245 offset:36864
    v_exp_f32 v226, v226
    v_exp_f32 v227, v227
    v_add_f32 v224, 1.0, v224
    v_add_f32 v225, 1.0, v225
    v_add_f32 v226, 1.0, v226
    v_add_f32 v227, 1.0, v227
    v_mfma_f32_32x32x16_bf16 v[96:111], v[200:203], a[116:119], v[96:111]
    ds_read_b64_tr_b16 v[194:195], v245 offset:37376
    v_rcp_f32 v224, v224
    v_rcp_f32 v225, v225
    v_rcp_f32 v226, v226
    v_rcp_f32 v227, v227
    v_mul_f32 v224, v224, v32
    v_mfma_f32_32x32x16_bf16 v[80:95], v[204:207], a[120:123], v[80:95]
    ds_read_b64_tr_b16 v[196:197], v245 offset:38912
    v_mul_f32 v225, v225, v33
    v_mul_f32 v226, v226, v34
    v_mul_f32 v227, v227, v35
    v_add_f32 v218, v218, v224
    v_fmac_f32 v219, v224, v224
    v_add_f32 v218, v218, v225
    v_fmac_f32 v219, v225, v225
    v_add_f32 v218, v218, v226
    v_mfma_f32_32x32x16_bf16 v[96:111], v[204:207], a[124:127], v[96:111]
    ds_read_b64_tr_b16 v[198:199], v245 offset:39424
    s_add_u32 m0, s45, 102400
    s_add_u32 s50, s48, 884736
    buffer_load_dwordx4 v7, s[8:11], s50 offen offset:0 lds
    v_fmac_f32 v219, v226, v226
    v_add_f32 v218, v218, v227
    v_fmac_f32 v219, v227, v227
    v_cvt_pk_bf16_f32 v24, v224, v225
    s_waitcnt lgkmcnt(4)
    v_mfma_f32_32x32x16_bf16 v[80:95], v[208:211], a[128:131], v[80:95]
    ds_read_b64_tr_b16 v[200:201], v245 offset:40960
    v_cvt_pk_bf16_f32 v25, v226, v227
    v_fma_f32 v228, -v36, v36, -s52
    v_fma_f32 v229, -v37, v37, -s52
    v_fma_f32 v230, -v38, v38, -s52
    v_fma_f32 v231, -v39, v39, -s52
    v_mul_f32 v228, v228, v36
    v_mul_f32 v229, v229, v37
    v_mul_f32 v230, v230, v38
    v_mfma_f32_32x32x16_bf16 v[96:111], v[208:211], a[132:135], v[96:111]
    ds_read_b64_tr_b16 v[202:203], v245 offset:41472
    v_mul_f32 v231, v231, v39
    v_exp_f32 v228, v228
    v_exp_f32 v229, v229
    v_exp_f32 v230, v230
    v_mfma_f32_32x32x16_bf16 v[80:95], v[212:215], a[136:139], v[80:95]
    ds_read_b64_tr_b16 v[204:205], v245 offset:43008
    v_exp_f32 v231, v231
    v_add_f32 v228, 1.0, v228
    v_add_f32 v229, 1.0, v229
    v_add_f32 v230, 1.0, v230
    v_add_f32 v231, 1.0, v231
    v_rcp_f32 v228, v228
    v_mfma_f32_32x32x16_bf16 v[96:111], v[212:215], a[140:143], v[96:111]
    ds_read_b64_tr_b16 v[206:207], v245 offset:43520
    v_rcp_f32 v229, v229
    v_rcp_f32 v230, v230
    v_rcp_f32 v231, v231
    v_mul_f32 v228, v228, v36
    v_mul_f32 v229, v229, v37
    s_waitcnt lgkmcnt(4)
    v_mfma_f32_32x32x16_bf16 v[80:95], v[192:195], a[144:147], v[80:95]
    ds_read_b64_tr_b16 v[208:209], v245 offset:45056
    v_mul_f32 v230, v230, v38
    v_mul_f32 v231, v231, v39
    v_add_f32 v218, v218, v228
    v_fmac_f32 v219, v228, v228
    v_add_f32 v218, v218, v229
    v_fmac_f32 v219, v229, v229
    v_add_f32 v218, v218, v230
    v_fmac_f32 v219, v230, v230
    v_mfma_f32_32x32x16_bf16 v[96:111], v[192:195], a[148:151], v[96:111]
    ds_read_b64_tr_b16 v[210:211], v245 offset:45568
    buffer_load_dwordx4 v8, s[8:11], s50 offen offset:1024 lds
    v_add_f32 v218, v218, v231
    v_fmac_f32 v219, v231, v231
    v_cvt_pk_bf16_f32 v26, v228, v229
    v_cvt_pk_bf16_f32 v27, v230, v231
    v_add_u32 v222, 6291456, v255
    global_load_dword v254, v222, s[84:85]
    v_fma_f32 v224, -v40, v40, -s52
    v_mfma_f32_32x32x16_bf16 v[80:95], v[196:199], a[152:155], v[80:95]
    ds_read_b64_tr_b16 v[212:213], v245 offset:47104
    v_fma_f32 v225, -v41, v41, -s52
    v_fma_f32 v226, -v42, v42, -s52
    v_fma_f32 v227, -v43, v43, -s52
    v_mul_f32 v224, v224, v40
    v_mul_f32 v225, v225, v41
    v_mul_f32 v226, v226, v42
    v_mul_f32 v227, v227, v43
    v_mfma_f32_32x32x16_bf16 v[96:111], v[196:199], a[156:159], v[96:111]
    ds_read_b64_tr_b16 v[214:215], v245 offset:47616
    v_exp_f32 v224, v224
    v_exp_f32 v225, v225
    v_exp_f32 v226, v226
    v_exp_f32 v227, v227
    s_waitcnt lgkmcnt(4)
    v_mfma_f32_32x32x16_bf16 v[80:95], v[200:203], a[160:163], v[80:95]
    s_waitcnt vmcnt(8)
    s_barrier
    ds_read_b64_tr_b16 v[192:193], v245 offset:49152
    v_add_f32 v224, 1.0, v224
    v_add_f32 v225, 1.0, v225
    v_add_f32 v226, 1.0, v226
    v_add_f32 v227, 1.0, v227
    v_rcp_f32 v224, v224
    v_mfma_f32_32x32x16_bf16 v[96:111], v[200:203], a[164:167], v[96:111]
    ds_read_b64_tr_b16 v[194:195], v245 offset:49664
    v_rcp_f32 v225, v225
    v_rcp_f32 v226, v226
    v_rcp_f32 v227, v227
    v_mul_f32 v224, v224, v40
    v_mul_f32 v225, v225, v41
    v_mfma_f32_32x32x16_bf16 v[80:95], v[204:207], a[168:171], v[80:95]
    ds_read_b64_tr_b16 v[196:197], v245 offset:51200
    v_mul_f32 v226, v226, v42
    v_mul_f32 v227, v227, v43
    v_add_f32 v218, v218, v224
    v_fmac_f32 v219, v224, v224
    v_add_f32 v218, v218, v225
    v_fmac_f32 v219, v225, v225
    v_add_f32 v218, v218, v226
    v_fmac_f32 v219, v226, v226
    v_mfma_f32_32x32x16_bf16 v[96:111], v[204:207], a[172:175], v[96:111]
    ds_read_b64_tr_b16 v[198:199], v245 offset:51712
    buffer_load_dwordx4 v9, s[8:11], s50 offen offset:2048 lds
    v_add_f32 v218, v218, v227
    v_fmac_f32 v219, v227, v227
    v_cvt_pk_bf16_f32 v28, v224, v225
    v_cvt_pk_bf16_f32 v29, v226, v227
    v_fma_f32 v228, -v44, v44, -s52
    v_fma_f32 v229, -v45, v45, -s52
    s_waitcnt lgkmcnt(4)
    v_mfma_f32_32x32x16_bf16 v[80:95], v[208:211], a[176:179], v[80:95]
    ds_read_b64_tr_b16 v[200:201], v245 offset:53248
    v_fma_f32 v230, -v46, v46, -s52
    v_fma_f32 v231, -v47, v47, -s52
    v_mul_f32 v228, v228, v44
    v_mul_f32 v229, v229, v45
    v_mul_f32 v230, v230, v46
    v_mul_f32 v231, v231, v47
    v_exp_f32 v228, v228
    v_mfma_f32_32x32x16_bf16 v[96:111], v[208:211], a[180:183], v[96:111]
    ds_read_b64_tr_b16 v[202:203], v245 offset:53760
    v_exp_f32 v229, v229
    v_exp_f32 v230, v230
    v_exp_f32 v231, v231
    v_add_f32 v228, 1.0, v228
    v_add_f32 v229, 1.0, v229
    v_mfma_f32_32x32x16_bf16 v[80:95], v[212:215], a[184:187], v[80:95]
    ds_read_b64_tr_b16 v[204:205], v245 offset:55296
    v_add_f32 v230, 1.0, v230
    v_add_f32 v231, 1.0, v231
    v_rcp_f32 v228, v228
    v_rcp_f32 v229, v229
    v_rcp_f32 v230, v230
    v_mfma_f32_32x32x16_bf16 v[96:111], v[212:215], a[188:191], v[96:111]
    ds_read_b64_tr_b16 v[206:207], v245 offset:55808
    v_rcp_f32 v231, v231
    v_mul_f32 v228, v228, v44
    v_mul_f32 v229, v229, v45
    v_mul_f32 v230, v230, v46
    v_mul_f32 v231, v231, v47
    v_add_f32 v218, v218, v228
    s_waitcnt lgkmcnt(4)
    v_mfma_f32_32x32x16_bf16 v[80:95], v[192:195], a[192:195], v[80:95]
    ds_read_b64_tr_b16 v[208:209], v245 offset:57344
    v_fmac_f32 v219, v228, v228
    v_add_f32 v218, v218, v229
    v_fmac_f32 v219, v229, v229
    v_add_f32 v218, v218, v230
    v_fmac_f32 v219, v230, v230
    v_add_f32 v218, v218, v231
    v_fmac_f32 v219, v231, v231
    v_cvt_pk_bf16_f32 v30, v228, v229
    v_mfma_f32_32x32x16_bf16 v[96:111], v[192:195], a[196:199], v[96:111]
    ds_read_b64_tr_b16 v[210:211], v245 offset:57856
    s_add_u32 m0, s45, 114688
    s_add_u32 s50, s48, 1769472
    buffer_load_dwordx4 v7, s[8:11], s50 offen offset:0 lds
    v_cvt_pk_bf16_f32 v31, v230, v231
    global_load_dword v254, v255, s[86:87]
    v_fma_f32 v224, -v48, v48, -s52
    v_fma_f32 v225, -v49, v49, -s52
    v_fma_f32 v226, -v50, v50, -s52
    v_mfma_f32_32x32x16_bf16 v[80:95], v[196:199], a[200:203], v[80:95]
    ds_read_b64_tr_b16 v[212:213], v245 offset:59392
    v_fma_f32 v227, -v51, v51, -s52
    v_mul_f32 v224, v224, v48
    v_mul_f32 v225, v225, v49
    v_mul_f32 v226, v226, v50
    v_mul_f32 v227, v227, v51
    v_exp_f32 v224, v224
    v_mfma_f32_32x32x16_bf16 v[96:111], v[196:199], a[204:207], v[96:111]
    ds_read_b64_tr_b16 v[214:215], v245 offset:59904
    v_exp_f32 v225, v225
    v_exp_f32 v226, v226
    v_exp_f32 v227, v227
    v_add_f32 v224, 1.0, v224
    v_add_f32 v225, 1.0, v225
    s_waitcnt lgkmcnt(4)
    v_mfma_f32_32x32x16_bf16 v[80:95], v[200:203], a[208:211], v[80:95]
    ds_read_b64_tr_b16 v[192:193], v1 offset:0
    v_add_f32 v226, 1.0, v226
    v_add_f32 v227, 1.0, v227
    v_rcp_f32 v224, v224
    v_rcp_f32 v225, v225
    v_rcp_f32 v226, v226
    v_mfma_f32_32x32x16_bf16 v[96:111], v[200:203], a[212:215], v[96:111]
    ds_read_b64_tr_b16 v[194:195], v1 offset:512
    v_rcp_f32 v227, v227
    v_mul_f32 v224, v224, v48
    v_mul_f32 v225, v225, v49
    v_mul_f32 v226, v226, v50
    v_mul_f32 v227, v227, v51
    v_add_f32 v216, v216, v224
    v_fmac_f32 v217, v224, v224
    v_mfma_f32_32x32x16_bf16 v[80:95], v[204:207], a[216:219], v[80:95]
    ds_read_b64_tr_b16 v[196:197], v1 offset:2048
    v_add_f32 v216, v216, v225
    v_fmac_f32 v217, v225, v225
    v_add_f32 v216, v216, v226
    v_fmac_f32 v217, v226, v226
    v_add_f32 v216, v216, v227
    v_fmac_f32 v217, v227, v227
    v_cvt_pk_bf16_f32 v32, v224, v225
    v_cvt_pk_bf16_f32 v33, v226, v227
    v_mfma_f32_32x32x16_bf16 v[96:111], v[204:207], a[220:223], v[96:111]
    ds_read_b64_tr_b16 v[198:199], v1 offset:2560
    buffer_load_dwordx4 v8, s[8:11], s50 offen offset:1024 lds
    v_fma_f32 v228, -v52, v52, -s52
    v_fma_f32 v229, -v53, v53, -s52
    v_fma_f32 v230, -v54, v54, -s52
    v_fma_f32 v231, -v55, v55, -s52
    v_mul_f32 v228, v228, v52
    v_mul_f32 v229, v229, v53
    s_waitcnt lgkmcnt(4)
    v_mfma_f32_32x32x16_bf16 v[80:95], v[208:211], a[224:227], v[80:95]
    ds_read_b64_tr_b16 v[200:201], v1 offset:4096
    v_mul_f32 v230, v230, v54
    v_mul_f32 v231, v231, v55
    v_exp_f32 v228, v228
    v_exp_f32 v229, v229
    v_exp_f32 v230, v230
    v_mfma_f32_32x32x16_bf16 v[96:111], v[208:211], a[228:231], v[96:111]
    ds_read_b64_tr_b16 v[202:203], v1 offset:4608
    v_exp_f32 v231, v231
    v_add_f32 v228, 1.0, v228
    v_add_f32 v229, 1.0, v229
    v_add_f32 v230, 1.0, v230
    v_add_f32 v231, 1.0, v231
    v_rcp_f32 v228, v228
    v_mfma_f32_32x32x16_bf16 v[80:95], v[212:215], a[232:235], v[80:95]
    ds_read_b64_tr_b16 v[204:205], v1 offset:6144
    v_rcp_f32 v229, v229
    v_rcp_f32 v230, v230
    v_rcp_f32 v231, v231
    v_mul_f32 v228, v228, v52
    v_mul_f32 v229, v229, v53
    v_mfma_f32_32x32x16_bf16 v[96:111], v[212:215], a[236:239], v[96:111]
    ds_read_b64_tr_b16 v[206:207], v1 offset:6656
    v_mul_f32 v230, v230, v54
    v_mul_f32 v231, v231, v55
    v_add_f32 v216, v216, v228
    v_fmac_f32 v217, v228, v228
    v_add_f32 v216, v216, v229
    v_fmac_f32 v217, v229, v229
    v_add_f32 v216, v216, v230
    s_waitcnt lgkmcnt(4)
    v_mfma_f32_32x32x16_bf16 v[80:95], v[192:195], a[240:243], v[80:95]
    ds_read_b64_tr_b16 v[208:209], v1 offset:8192
    v_fmac_f32 v217, v230, v230
    v_add_f32 v216, v216, v231
    v_fmac_f32 v217, v231, v231
    v_cvt_pk_bf16_f32 v34, v228, v229
    v_cvt_pk_bf16_f32 v35, v230, v231
    v_lshrrev_b32 v255, 1, v255
    v_add_u32 v222, 2097152, v255
    v_min_u32 v222, 2654204, v222
    v_mfma_f32_32x32x16_bf16 v[96:111], v[192:195], a[244:247], v[96:111]
    ds_read_b64_tr_b16 v[210:211], v1 offset:8704
    buffer_load_dwordx4 v9, s[8:11], s50 offen offset:2048 lds
    global_load_dword v254, v222, s[86:87]
    v_fma_f32 v224, -v56, v56, -s52
    v_fma_f32 v225, -v57, v57, -s52
    v_fma_f32 v226, -v58, v58, -s52
    v_fma_f32 v227, -v59, v59, -s52
    v_mul_f32 v224, v224, v56
    v_mul_f32 v225, v225, v57
    v_mfma_f32_32x32x16_bf16 v[80:95], v[196:199], a[248:251], v[80:95]
    ds_read_b64_tr_b16 v[212:213], v1 offset:10240
    v_mul_f32 v226, v226, v58
    v_mul_f32 v227, v227, v59
    v_exp_f32 v224, v224
    v_exp_f32 v225, v225
    v_exp_f32 v226, v226
    v_mfma_f32_32x32x16_bf16 v[96:111], v[196:199], a[252:255], v[96:111]
    ds_read_b64_tr_b16 v[214:215], v1 offset:10752
    v_exp_f32 v227, v227
    v_add_f32 v224, 1.0, v224
    v_add_f32 v225, 1.0, v225
    v_add_f32 v226, 1.0, v226
    v_add_f32 v227, 1.0, v227
    s_waitcnt lgkmcnt(4)
    v_mfma_f32_32x32x16_bf16 v[80:95], v[200:203], v[160:163], v[80:95]
    ds_read_b64_tr_b16 v[192:193], v247 offset:0
    v_rcp_f32 v224, v224
    v_rcp_f32 v225, v225
    v_rcp_f32 v226, v226
    v_rcp_f32 v227, v227
    v_mul_f32 v224, v224, v56
    v_mfma_f32_32x32x16_bf16 v[96:111], v[200:203], v[164:167], v[96:111]
    ds_read_b64_tr_b16 v[194:195], v247 offset:512
    v_mul_f32 v225, v225, v57
    v_mul_f32 v226, v226, v58
    v_mul_f32 v227, v227, v59
    v_add_f32 v216, v216, v224
    v_fmac_f32 v217, v224, v224
    v_add_f32 v216, v216, v225
    v_fmac_f32 v217, v225, v225
    v_add_f32 v216, v216, v226
    v_mfma_f32_32x32x16_bf16 v[80:95], v[204:207], v[168:171], v[80:95]
    ds_read_b64_tr_b16 v[196:197], v247 offset:2048
    v_fmac_f32 v217, v226, v226
    v_add_f32 v216, v216, v227
    v_fmac_f32 v217, v227, v227
    v_cvt_pk_bf16_f32 v36, v224, v225
    v_cvt_pk_bf16_f32 v37, v226, v227
    v_fma_f32 v228, -v60, v60, -s52
    v_fma_f32 v229, -v61, v61, -s52
    v_fma_f32 v230, -v62, v62, -s52
    v_mfma_f32_32x32x16_bf16 v[96:111], v[204:207], v[172:175], v[96:111]
    ds_read_b64_tr_b16 v[198:199], v247 offset:2560
    s_add_u32 m0, s45, 126976
    s_add_u32 s50, s48, 2654208
    buffer_load_dwordx4 v7, s[8:11], s50 offen offset:0 lds
    v_fma_f32 v231, -v63, v63, -s52
    v_mul_f32 v228, v228, v60
    v_mul_f32 v229, v229, v61
    v_mul_f32 v230, v230, v62
    s_waitcnt lgkmcnt(4)
    v_mfma_f32_32x32x16_bf16 v[80:95], v[208:211], v[176:179], v[80:95]
    ds_read_b64_tr_b16 v[200:201], v247 offset:4096
    v_mul_f32 v231, v231, v63
    v_exp_f32 v228, v228
    v_exp_f32 v229, v229
    v_exp_f32 v230, v230
    v_mfma_f32_32x32x16_bf16 v[96:111], v[208:211], v[180:183], v[96:111]
    ds_read_b64_tr_b16 v[202:203], v247 offset:4608
    v_exp_f32 v231, v231
    v_add_f32 v228, 1.0, v228
    v_add_f32 v229, 1.0, v229
    v_add_f32 v230, 1.0, v230
    v_add_f32 v231, 1.0, v231
    v_rcp_f32 v228, v228
    v_mfma_f32_32x32x16_bf16 v[80:95], v[212:215], v[184:187], v[80:95]
    ds_read_b64_tr_b16 v[204:205], v247 offset:6144
    v_rcp_f32 v229, v229
    v_rcp_f32 v230, v230
    v_rcp_f32 v231, v231
    v_mul_f32 v228, v228, v60
    v_mul_f32 v229, v229, v61
    v_mul_f32 v230, v230, v62
    v_mfma_f32_32x32x16_bf16 v[96:111], v[212:215], v[188:191], v[96:111]
    ds_read_b64_tr_b16 v[206:207], v247 offset:6656
    v_mul_f32 v231, v231, v63
    v_add_f32 v216, v216, v228
    v_fmac_f32 v217, v228, v228
    v_add_f32 v216, v216, v229
    v_fmac_f32 v217, v229, v229
    v_add_f32 v216, v216, v230
    v_fmac_f32 v217, v230, v230
    s_waitcnt lgkmcnt(4)
    v_mfma_f32_32x32x16_bf16 v[112:127], v[192:195], a[0:3], 0
    ds_read_b64_tr_b16 v[208:209], v247 offset:8192
    v_add_f32 v216, v216, v231
    v_fmac_f32 v217, v231, v231
    v_cvt_pk_bf16_f32 v38, v228, v229
    v_cvt_pk_bf16_f32 v39, v230, v231
    v_min_u32 v222, 663548, v255
    global_load_dword v254, v222, s[88:89]
    v_fma_f32 v224, -v64, v64, -s52
    v_fma_f32 v225, -v65, v65, -s52
    v_mfma_f32_32x32x16_bf16 v[128:143], v[192:195], a[4:7], 0
    ds_read_b64_tr_b16 v[210:211], v247 offset:8704
    buffer_load_dwordx4 v8, s[8:11], s50 offen offset:1024 lds
    v_fma_f32 v226, -v66, v66, -s52
    v_fma_f32 v227, -v67, v67, -s52
    v_mul_f32 v224, v224, v64
    v_mul_f32 v225, v225, v65
    v_mul_f32 v226, v226, v66
    v_mul_f32 v227, v227, v67
    v_mfma_f32_32x32x16_bf16 v[112:127], v[196:199], a[8:11], v[112:127]
    ds_read_b64_tr_b16 v[212:213], v247 offset:10240
    v_exp_f32 v224, v224
    v_exp_f32 v225, v225
    v_exp_f32 v226, v226
    v_exp_f32 v227, v227
    v_add_f32 v224, 1.0, v224
    v_mfma_f32_32x32x16_bf16 v[128:143], v[196:199], a[12:15], v[128:143]
    ds_read_b64_tr_b16 v[214:215], v247 offset:10752
    v_add_f32 v225, 1.0, v225
    v_add_f32 v226, 1.0, v226
    v_add_f32 v227, 1.0, v227
    v_rcp_f32 v224, v224
    v_rcp_f32 v225, v225
    s_waitcnt lgkmcnt(4)
    v_mfma_f32_32x32x16_bf16 v[112:127], v[200:203], a[16:19], v[112:127]
    ds_read_b64_tr_b16 v[192:193], v247 offset:12288
    v_rcp_f32 v226, v226
    v_rcp_f32 v227, v227
    v_mul_f32 v224, v224, v64
    v_mul_f32 v225, v225, v65
    v_mul_f32 v226, v226, v66
    v_mul_f32 v227, v227, v67
    v_mfma_f32_32x32x16_bf16 v[128:143], v[200:203], a[20:23], v[128:143]
    ds_read_b64_tr_b16 v[194:195], v247 offset:12800
    v_add_f32 v218, v218, v224
    v_fmac_f32 v219, v224, v224
    v_add_f32 v218, v218, v225
    v_fmac_f32 v219, v225, v225
    v_add_f32 v218, v218, v226
    v_fmac_f32 v219, v226, v226
    v_add_f32 v218, v218, v227
    v_fmac_f32 v219, v227, v227
    v_mfma_f32_32x32x16_bf16 v[112:127], v[204:207], a[24:27], v[112:127]
    ds_read_b64_tr_b16 v[196:197], v247 offset:14336
    v_cvt_pk_bf16_f32 v40, v224, v225
    v_cvt_pk_bf16_f32 v41, v226, v227
    v_fma_f32 v228, -v68, v68, -s52
    v_fma_f32 v229, -v69, v69, -s52
    v_fma_f32 v230, -v70, v70, -s52
    v_fma_f32 v231, -v71, v71, -s52
    v_mul_f32 v228, v228, v68
    v_mul_f32 v229, v229, v69
    v_mfma_f32_32x32x16_bf16 v[128:143], v[204:207], a[28:31], v[128:143]
    ds_read_b64_tr_b16 v[198:199], v247 offset:14848
    buffer_load_dwordx4 v9, s[8:11], s50 offen offset:2048 lds
    v_mul_f32 v230, v230, v70
    v_mul_f32 v231, v231, v71
    v_exp_f32 v228, v228
    v_exp_f32 v229, v229
    s_waitcnt lgkmcnt(4)
    v_mfma_f32_32x32x16_bf16 v[112:127], v[208:211], a[32:35], v[112:127]
    ds_read_b64_tr_b16 v[200:201], v247 offset:16384
    v_exp_f32 v230, v230
    v_exp_f32 v231, v231
    v_add_f32 v228, 1.0, v228
    v_add_f32 v229, 1.0, v229
    v_add_f32 v230, 1.0, v230
    v_add_f32 v231, 1.0, v231
    v_mfma_f32_32x32x16_bf16 v[128:143], v[208:211], a[36:39], v[128:143]
    ds_read_b64_tr_b16 v[202:203], v247 offset:16896
    v_rcp_f32 v228, v228
    v_rcp_f32 v229, v229
    v_rcp_f32 v230, v230
    v_rcp_f32 v231, v231
    v_mfma_f32_32x32x16_bf16 v[112:127], v[212:215], a[40:43], v[112:127]
    ds_read_b64_tr_b16 v[204:205], v247 offset:18432
    v_mul_f32 v228, v228, v68
    v_mul_f32 v229, v229, v69
    v_mul_f32 v230, v230, v70
    v_mul_f32 v231, v231, v71
    v_add_f32 v218, v218, v228
    v_fmac_f32 v219, v228, v228
    v_add_f32 v218, v218, v229
    v_fmac_f32 v219, v229, v229
    v_mfma_f32_32x32x16_bf16 v[128:143], v[212:215], a[44:47], v[128:143]
    ds_read_b64_tr_b16 v[206:207], v247 offset:18944
    v_add_f32 v218, v218, v230
    v_fmac_f32 v219, v230, v230
    v_add_f32 v218, v218, v231
    v_fmac_f32 v219, v231, v231
    v_cvt_pk_bf16_f32 v42, v228, v229
    v_cvt_pk_bf16_f32 v43, v230, v231
    v_fma_f32 v224, -v72, v72, -s52
    s_waitcnt lgkmcnt(4)
    v_mfma_f32_32x32x16_bf16 v[112:127], v[192:195], a[48:51], v[112:127]
    ds_read_b64_tr_b16 v[208:209], v247 offset:20480
    v_fma_f32 v225, -v73, v73, -s52
    v_fma_f32 v226, -v74, v74, -s52
    v_fma_f32 v227, -v75, v75, -s52
    v_mul_f32 v224, v224, v72
    v_mul_f32 v225, v225, v73
    v_mul_f32 v226, v226, v74
    v_mul_f32 v227, v227, v75
    v_mfma_f32_32x32x16_bf16 v[128:143], v[192:195], a[52:55], v[128:143]
    ds_read_b64_tr_b16 v[210:211], v247 offset:20992
    s_add_u32 m0, s45, 139264
    s_add_u32 s50, s48, 3538944
    buffer_load_dwordx4 v7, s[8:11], s50 offen offset:0 lds
    v_exp_f32 v224, v224
    v_exp_f32 v225, v225
    v_exp_f32 v226, v226
    v_mfma_f32_32x32x16_bf16 v[112:127], v[196:199], a[56:59], v[112:127]
    ds_read_b64_tr_b16 v[212:213], v247 offset:22528
    v_exp_f32 v227, v227
    v_add_f32 v224, 1.0, v224
    v_add_f32 v225, 1.0, v225
    v_add_f32 v226, 1.0, v226
    v_add_f32 v227, 1.0, v227
    v_rcp_f32 v224, v224
    v_mfma_f32_32x32x16_bf16 v[128:143], v[196:199], a[60:63], v[128:143]
    ds_read_b64_tr_b16 v[214:215], v247 offset:23040
    v_rcp_f32 v225, v225
    v_rcp_f32 v226, v226
    v_rcp_f32 v227, v227
    v_mul_f32 v224, v224, v72
    s_waitcnt lgkmcnt(4)
    v_mfma_f32_32x32x16_bf16 v[112:127], v[200:203], a[64:67], v[112:127]
    ds_read_b64_tr_b16 v[192:193], v247 offset:24576
    v_mul_f32 v225, v225, v73
    v_mul_f32 v226, v226, v74
    v_mul_f32 v227, v227, v75
    v_add_f32 v218, v218, v224
    v_fmac_f32 v219, v224, v224
    v_add_f32 v218, v218, v225
    v_fmac_f32 v219, v225, v225
    v_add_f32 v218, v218, v226
    v_mfma_f32_32x32x16_bf16 v[128:143], v[200:203], a[68:71], v[128:143]
    ds_read_b64_tr_b16 v[194:195], v247 offset:25088
    v_fmac_f32 v219, v226, v226
    v_add_f32 v218, v218, v227
    v_fmac_f32 v219, v227, v227
    v_cvt_pk_bf16_f32 v44, v224, v225
    v_cvt_pk_bf16_f32 v45, v226, v227
    v_fma_f32 v228, -v76, v76, -s52
    v_fma_f32 v229, -v77, v77, -s52
    v_fma_f32 v230, -v78, v78, -s52
    v_mfma_f32_32x32x16_bf16 v[112:127], v[204:207], a[72:75], v[112:127]
    ds_read_b64_tr_b16 v[196:197], v247 offset:26624
    v_fma_f32 v231, -v79, v79, -s52
    v_mul_f32 v228, v228, v76
    v_mul_f32 v229, v229, v77
    v_mul_f32 v230, v230, v78
    v_mul_f32 v231, v231, v79
    v_exp_f32 v228, v228
    v_mfma_f32_32x32x16_bf16 v[128:143], v[204:207], a[76:79], v[128:143]
    ds_read_b64_tr_b16 v[198:199], v247 offset:27136
    buffer_load_dwordx4 v8, s[8:11], s50 offen offset:1024 lds
    v_exp_f32 v229, v229
    v_exp_f32 v230, v230
    v_exp_f32 v231, v231
    v_add_f32 v228, 1.0, v228
    s_waitcnt lgkmcnt(4)
    v_mfma_f32_32x32x16_bf16 v[112:127], v[208:211], a[80:83], v[112:127]
    ds_read_b64_tr_b16 v[200:201], v247 offset:28672
    v_add_f32 v229, 1.0, v229
    v_add_f32 v230, 1.0, v230
    v_add_f32 v231, 1.0, v231
    v_rcp_f32 v228, v228
    v_rcp_f32 v229, v229
    v_mfma_f32_32x32x16_bf16 v[128:143], v[208:211], a[84:87], v[128:143]
    ds_read_b64_tr_b16 v[202:203], v247 offset:29184
    v_rcp_f32 v230, v230
    v_rcp_f32 v231, v231
    v_mul_f32 v228, v228, v76
    v_mul_f32 v229, v229, v77
    v_mul_f32 v230, v230, v78
    v_mul_f32 v231, v231, v79
    v_add_f32 v218, v218, v228
    v_mfma_f32_32x32x16_bf16 v[112:127], v[212:215], a[88:91], v[112:127]
    ds_read_b64_tr_b16 v[204:205], v247 offset:30720
    v_fmac_f32 v219, v228, v228
    v_add_f32 v218, v218, v229
    v_fmac_f32 v219, v229, v229
    v_add_f32 v218, v218, v230
    v_fmac_f32 v219, v230, v230
    v_add_f32 v218, v218, v231
    v_fmac_f32 v219, v231, v231
    v_cvt_pk_bf16_f32 v46, v228, v229
    v_mfma_f32_32x32x16_bf16 v[128:143], v[212:215], a[92:95], v[128:143]
    ds_read_b64_tr_b16 v[206:207], v247 offset:31232
    v_cvt_pk_bf16_f32 v47, v230, v231
    v_fma_f32 v224, -v144, v144, -s52
    v_fma_f32 v225, -v145, v145, -s52
    v_fma_f32 v226, -v146, v146, -s52
    v_fma_f32 v227, -v147, v147, -s52
    v_mul_f32 v224, v224, v144
    v_mul_f32 v225, v225, v145
    s_waitcnt lgkmcnt(4)
    v_mfma_f32_32x32x16_bf16 v[112:127], v[192:195], a[96:99], v[112:127]
    ds_read_b64_tr_b16 v[208:209], v247 offset:32768
    v_mul_f32 v226, v226, v146
    v_mul_f32 v227, v227, v147
    v_exp_f32 v224, v224
    v_exp_f32 v225, v225
    v_exp_f32 v226, v226
    v_mfma_f32_32x32x16_bf16 v[128:143], v[192:195], a[100:103], v[128:143]
    ds_read_b64_tr_b16 v[210:211], v247 offset:33280
    buffer_load_dwordx4 v9, s[8:11], s50 offen offset:2048 lds
    v_exp_f32 v227, v227
    v_add_f32 v224, 1.0, v224
    v_add_f32 v225, 1.0, v225
    v_add_f32 v226, 1.0, v226
    v_add_f32 v227, 1.0, v227
    v_mfma_f32_32x32x16_bf16 v[112:127], v[196:199], a[104:107], v[112:127]
    ds_read_b64_tr_b16 v[212:213], v247 offset:34816
    v_rcp_f32 v224, v224
    v_rcp_f32 v225, v225
    v_rcp_f32 v226, v226
    v_rcp_f32 v227, v227
    v_mul_f32 v224, v224, v144
    v_mfma_f32_32x32x16_bf16 v[128:143], v[196:199], a[108:111], v[128:143]
    ds_read_b64_tr_b16 v[214:215], v247 offset:35328
    v_mul_f32 v225, v225, v145
    v_mul_f32 v226, v226, v146
    v_mul_f32 v227, v227, v147
    v_add_f32 v220, v220, v224
    v_fmac_f32 v221, v224, v224
    v_add_f32 v220, v220, v225
    v_fmac_f32 v221, v225, v225
    s_waitcnt lgkmcnt(4)
    v_mfma_f32_32x32x16_bf16 v[112:127], v[200:203], a[112:115], v[112:127]
    ds_read_b64_tr_b16 v[192:193], v247 offset:36864
    v_add_f32 v220, v220, v226
    v_fmac_f32 v221, v226, v226
    v_add_f32 v220, v220, v227
    v_fmac_f32 v221, v227, v227
    v_cvt_pk_bf16_f32 v144, v224, v225
    v_cvt_pk_bf16_f32 v145, v226, v227
    v_fma_f32 v228, -v148, v148, -s52
    v_fma_f32 v229, -v149, v149, -s52
    v_mfma_f32_32x32x16_bf16 v[128:143], v[200:203], a[116:119], v[128:143]
    ds_read_b64_tr_b16 v[194:195], v247 offset:37376
    v_fma_f32 v230, -v150, v150, -s52
    v_fma_f32 v231, -v151, v151, -s52
    v_mul_f32 v228, v228, v148
    v_mul_f32 v229, v229, v149
    v_mul_f32 v230, v230, v150
    v_mul_f32 v231, v231, v151
    v_exp_f32 v228, v228
    v_mfma_f32_32x32x16_bf16 v[112:127], v[204:207], a[120:123], v[112:127]
    ds_read_b64_tr_b16 v[196:197], v247 offset:38912
    v_exp_f32 v229, v229
    v_exp_f32 v230, v230
    v_exp_f32 v231, v231
    v_add_f32 v228, 1.0, v228
    v_add_f32 v229, 1.0, v229
    v_mfma_f32_32x32x16_bf16 v[128:143], v[204:207], a[124:127], v[128:143]
    ds_read_b64_tr_b16 v[198:199], v247 offset:39424
    s_add_u32 m0, s45, 151552
    s_add_u32 s50, s48, 4423680
    buffer_load_dwordx4 v7, s[8:11], s50 offen offset:0 lds
    v_add_f32 v230, 1.0, v230
    v_add_f32 v231, 1.0, v231
    v_rcp_f32 v228, v228
    s_waitcnt lgkmcnt(4)
    v_mfma_f32_32x32x16_bf16 v[112:127], v[208:211], a[128:131], v[112:127]
    ds_read_b64_tr_b16 v[200:201], v247 offset:40960
    v_rcp_f32 v229, v229
    v_rcp_f32 v230, v230
    v_rcp_f32 v231, v231
    v_mul_f32 v228, v228, v148
    v_mul_f32 v229, v229, v149
    v_mfma_f32_32x32x16_bf16 v[128:143], v[208:211], a[132:135], v[128:143]
    ds_read_b64_tr_b16 v[202:203], v247 offset:41472
    v_mul_f32 v230, v230, v150
    v_mul_f32 v231, v231, v151
    v_add_f32 v220, v220, v228
    v_fmac_f32 v221, v228, v228
    v_add_f32 v220, v220, v229
    v_fmac_f32 v221, v229, v229
    v_add_f32 v220, v220, v230
    v_fmac_f32 v221, v230, v230
    v_mfma_f32_32x32x16_bf16 v[112:127], v[212:215], a[136:139], v[112:127]
    ds_read_b64_tr_b16 v[204:205], v247 offset:43008
    v_add_f32 v220, v220, v231
    v_fmac_f32 v221, v231, v231
    v_cvt_pk_bf16_f32 v146, v228, v229
    v_cvt_pk_bf16_f32 v147, v230, v231
    buffer_store_dwordx4 v[144:147], v11, s[32:35], s56 offen offset:0 sc1
    v_fma_f32 v224, -v152, v152, -s52
    v_fma_f32 v225, -v153, v153, -s52
    v_fma_f32 v226, -v154, v154, -s52
    v_mfma_f32_32x32x16_bf16 v[128:143], v[212:215], a[140:143], v[128:143]
    ds_read_b64_tr_b16 v[206:207], v247 offset:43520
    v_fma_f32 v227, -v155, v155, -s52
    v_mul_f32 v224, v224, v152
    v_mul_f32 v225, v225, v153
    v_mul_f32 v226, v226, v154
    v_mul_f32 v227, v227, v155
    v_exp_f32 v224, v224
    s_waitcnt lgkmcnt(4)
    v_mfma_f32_32x32x16_bf16 v[112:127], v[192:195], a[144:147], v[112:127]
    ds_read_b64_tr_b16 v[208:209], v247 offset:45056
    v_exp_f32 v225, v225
    v_exp_f32 v226, v226
    v_exp_f32 v227, v227
    v_add_f32 v224, 1.0, v224
    v_add_f32 v225, 1.0, v225
    v_mfma_f32_32x32x16_bf16 v[128:143], v[192:195], a[148:151], v[128:143]
    ds_read_b64_tr_b16 v[210:211], v247 offset:45568
    buffer_load_dwordx4 v8, s[8:11], s50 offen offset:1024 lds
    v_add_f32 v226, 1.0, v226
    v_add_f32 v227, 1.0, v227
    v_rcp_f32 v224, v224
    v_rcp_f32 v225, v225
    v_mfma_f32_32x32x16_bf16 v[112:127], v[196:199], a[152:155], v[112:127]
    ds_read_b64_tr_b16 v[212:213], v247 offset:47104
    v_rcp_f32 v226, v226
    v_rcp_f32 v227, v227
    v_mul_f32 v224, v224, v152
    v_mul_f32 v225, v225, v153
    v_mul_f32 v226, v226, v154
    v_mul_f32 v227, v227, v155
    v_add_f32 v220, v220, v224
    v_mfma_f32_32x32x16_bf16 v[128:143], v[196:199], a[156:159], v[128:143]
    ds_read_b64_tr_b16 v[214:215], v247 offset:47616
    v_fmac_f32 v221, v224, v224
    v_add_f32 v220, v220, v225
    v_fmac_f32 v221, v225, v225
    v_add_f32 v220, v220, v226
    v_fmac_f32 v221, v226, v226
    v_add_f32 v220, v220, v227
    v_fmac_f32 v221, v227, v227
    s_waitcnt lgkmcnt(4)
    v_mfma_f32_32x32x16_bf16 v[112:127], v[200:203], a[160:163], v[112:127]
    ds_read_b64_tr_b16 v[192:193], v247 offset:49152
    v_cvt_pk_bf16_f32 v148, v224, v225
    v_cvt_pk_bf16_f32 v149, v226, v227
    v_fma_f32 v228, -v156, v156, -s52
    v_fma_f32 v229, -v157, v157, -s52
    v_fma_f32 v230, -v158, v158, -s52
    v_fma_f32 v231, -v159, v159, -s52
    v_mul_f32 v228, v228, v156
    v_mul_f32 v229, v229, v157
    v_mfma_f32_32x32x16_bf16 v[128:143], v[200:203], a[164:167], v[128:143]
    ds_read_b64_tr_b16 v[194:195], v247 offset:49664
    v_mul_f32 v230, v230, v158
    v_mul_f32 v231, v231, v159
    v_exp_f32 v228, v228
    v_exp_f32 v229, v229
    v_exp_f32 v230, v230
    v_mfma_f32_32x32x16_bf16 v[112:127], v[204:207], a[168:171], v[112:127]
    ds_read_b64_tr_b16 v[196:197], v247 offset:51200
    v_exp_f32 v231, v231
    v_add_f32 v228, 1.0, v228
    v_add_f32 v229, 1.0, v229
    v_add_f32 v230, 1.0, v230
    v_add_f32 v231, 1.0, v231
    v_rcp_f32 v228, v228
    v_mfma_f32_32x32x16_bf16 v[128:143], v[204:207], a[172:175], v[128:143]
    ds_read_b64_tr_b16 v[198:199], v247 offset:51712
    buffer_load_dwordx4 v9, s[8:11], s50 offen offset:2048 lds
    v_rcp_f32 v229, v229
    v_rcp_f32 v230, v230
    v_rcp_f32 v231, v231
    s_waitcnt lgkmcnt(4)
    v_mfma_f32_32x32x16_bf16 v[112:127], v[208:211], a[176:179], v[112:127]
    ds_read_b64_tr_b16 v[200:201], v247 offset:53248
    v_mul_f32 v228, v228, v156
    v_mul_f32 v229, v229, v157
    v_mul_f32 v230, v230, v158
    v_mul_f32 v231, v231, v159
    v_add_f32 v220, v220, v228
    v_fmac_f32 v221, v228, v228
    v_add_f32 v220, v220, v229
    v_fmac_f32 v221, v229, v229
    v_mfma_f32_32x32x16_bf16 v[128:143], v[208:211], a[180:183], v[128:143]
    ds_read_b64_tr_b16 v[202:203], v247 offset:53760
    v_add_f32 v220, v220, v230
    v_fmac_f32 v221, v230, v230
    v_add_f32 v220, v220, v231
    v_fmac_f32 v221, v231, v231
    v_cvt_pk_bf16_f32 v150, v228, v229
    v_cvt_pk_bf16_f32 v151, v230, v231
    buffer_store_dwordx4 v[148:151], v11, s[32:35], s56 offen offset:256 sc1
    v_fma_f32 v216, v220, s53, v216
    v_mfma_f32_32x32x16_bf16 v[112:127], v[212:215], a[184:187], v[112:127]
    ds_read_b64_tr_b16 v[204:205], v247 offset:55296
    v_fma_f32 v217, v221, s53, v217
    v_permlane32_swap_b32 v218, v219
    s_nop 0
    v_permlane32_swap_b32 v216, v217
    v_add_f32 v216, v216, v217
    v_add_f32 v218, v218, v219
    buffer_atomic_add_f32 v216, v13, s[28:31], s59 offen offset:0
    buffer_atomic_add_f32 v218, v13, s[28:31], s59 offen offset:256
    v_mfma_f32_32x32x16_bf16 v[128:143], v[212:215], a[188:191], v[128:143]
    ds_read_b64_tr_b16 v[206:207], v247 offset:55808
    v_mul_f32 v80, s60, v80
    v_mul_f32 v81, s60, v81
    v_mul_f32 v82, s60, v82
    v_mul_f32 v83, s60, v83
    s_waitcnt lgkmcnt(4)
    v_mfma_f32_32x32x16_bf16 v[112:127], v[192:195], a[192:195], v[112:127]
    ds_read_b64_tr_b16 v[208:209], v247 offset:57344
    v_cvt_pk_bf16_f32 v232, v80, v81
    v_cvt_pk_bf16_f32 v233, v82, v83
    buffer_store_dwordx2 v[232:233], v12, s[24:27], s57 offen offset:0 sc1
    v_mul_f32 v84, s60, v84
    v_mul_f32 v85, s60, v85
    v_mfma_f32_32x32x16_bf16 v[128:143], v[192:195], a[196:199], v[128:143]
    ds_read_b64_tr_b16 v[210:211], v247 offset:57856
    v_mul_f32 v86, s60, v86
    v_mul_f32 v87, s60, v87
    v_cvt_pk_bf16_f32 v236, v84, v85
    v_cvt_pk_bf16_f32 v237, v86, v87
    buffer_store_dwordx2 v[236:237], v12, s[24:27], s57 offen offset:256 sc1
    v_mfma_f32_32x32x16_bf16 v[112:127], v[196:199], a[200:203], v[112:127]
    ds_read_b64_tr_b16 v[212:213], v247 offset:59392
    v_mul_f32 v88, s60, v88
    v_mul_f32 v89, s60, v89
    v_mul_f32 v90, s60, v90
    v_mul_f32 v91, s60, v91
    v_cvt_pk_bf16_f32 v240, v88, v89
    v_mfma_f32_32x32x16_bf16 v[128:143], v[196:199], a[204:207], v[128:143]
    ds_read_b64_tr_b16 v[214:215], v247 offset:59904
    v_cvt_pk_bf16_f32 v241, v90, v91
    buffer_store_dwordx2 v[240:241], v12, s[24:27], s57 offen offset:512 sc1
    v_mul_f32 v92, s60, v92
    v_mul_f32 v93, s60, v93
    s_waitcnt lgkmcnt(4)
    v_mfma_f32_32x32x16_bf16 v[112:127], v[200:203], a[208:211], v[112:127]
    ds_read_b64_tr_b16 v[192:193], v2 offset:0
    v_mul_f32 v94, s60, v94
    v_mul_f32 v95, s60, v95
    v_cvt_pk_bf16_f32 v232, v92, v93
    v_cvt_pk_bf16_f32 v233, v94, v95
    buffer_store_dwordx2 v[232:233], v12, s[24:27], s57 offen offset:768 sc1
    v_mfma_f32_32x32x16_bf16 v[128:143], v[200:203], a[212:215], v[128:143]
    ds_read_b64_tr_b16 v[194:195], v2 offset:512
    v_mul_f32 v96, s60, v96
    v_mul_f32 v97, s60, v97
    v_mul_f32 v98, s60, v98
    v_mul_f32 v99, s60, v99
    v_cvt_pk_bf16_f32 v236, v96, v97
    v_mfma_f32_32x32x16_bf16 v[112:127], v[204:207], a[216:219], v[112:127]
    ds_read_b64_tr_b16 v[196:197], v2 offset:2048
    v_cvt_pk_bf16_f32 v237, v98, v99
    buffer_store_dwordx2 v[236:237], v12, s[24:27], s58 offen offset:0 sc1
    v_mul_f32 v100, s60, v100
    v_mul_f32 v101, s60, v101
    v_mul_f32 v102, s60, v102
    v_mfma_f32_32x32x16_bf16 v[128:143], v[204:207], a[220:223], v[128:143]
    ds_read_b64_tr_b16 v[198:199], v2 offset:2560
    v_mul_f32 v103, s60, v103
    v_cvt_pk_bf16_f32 v240, v100, v101
    v_cvt_pk_bf16_f32 v241, v102, v103
    buffer_store_dwordx2 v[240:241], v12, s[24:27], s58 offen offset:256 sc1
    s_waitcnt lgkmcnt(4)
    v_mfma_f32_32x32x16_bf16 v[112:127], v[208:211], a[224:227], v[112:127]
    ds_read_b64_tr_b16 v[200:201], v2 offset:4096
    v_mul_f32 v104, s60, v104
    v_mul_f32 v105, s60, v105
    v_mul_f32 v106, s60, v106
    v_mul_f32 v107, s60, v107
    v_cvt_pk_bf16_f32 v232, v104, v105
    v_mfma_f32_32x32x16_bf16 v[128:143], v[208:211], a[228:231], v[128:143]
    ds_read_b64_tr_b16 v[202:203], v2 offset:4608
    v_cvt_pk_bf16_f32 v233, v106, v107
    buffer_store_dwordx2 v[232:233], v12, s[24:27], s58 offen offset:512 sc1
    v_mul_f32 v108, s60, v108
    v_mul_f32 v109, s60, v109
    v_mul_f32 v110, s60, v110
    v_mfma_f32_32x32x16_bf16 v[112:127], v[212:215], a[232:235], v[112:127]
    ds_read_b64_tr_b16 v[204:205], v2 offset:6144
    v_mul_f32 v111, s60, v111
    v_cvt_pk_bf16_f32 v236, v108, v109
    v_cvt_pk_bf16_f32 v237, v110, v111
    buffer_store_dwordx2 v[236:237], v12, s[24:27], s58 offen offset:768 sc1
    v_mfma_f32_32x32x16_bf16 v[128:143], v[212:215], a[236:239], v[128:143]
    ds_read_b64_tr_b16 v[206:207], v2 offset:6656
    s_waitcnt lgkmcnt(4)
    v_mfma_f32_32x32x16_bf16 v[112:127], v[192:195], a[240:243], v[112:127]
    ds_read_b64_tr_b16 v[208:209], v2 offset:8192
    v_mfma_f32_32x32x16_bf16 v[128:143], v[192:195], a[244:247], v[128:143]
    ds_read_b64_tr_b16 v[210:211], v2 offset:8704
    v_mfma_f32_32x32x16_bf16 v[112:127], v[196:199], a[248:251], v[112:127]
    ds_read_b64_tr_b16 v[212:213], v2 offset:10240
    v_mfma_f32_32x32x16_bf16 v[128:143], v[196:199], a[252:255], v[128:143]
    ds_read_b64_tr_b16 v[214:215], v2 offset:10752
    s_waitcnt lgkmcnt(4)
    v_mfma_f32_32x32x16_bf16 v[112:127], v[200:203], v[160:163], v[112:127]
    s_waitcnt vmcnt(11)
    s_barrier
    ds_read_b64_tr_b16 v[192:193], v1 offset:24576
    v_mfma_f32_32x32x16_bf16 v[128:143], v[200:203], v[164:167], v[128:143]
    ds_read_b64_tr_b16 v[194:195], v1 offset:25088
    v_mfma_f32_32x32x16_bf16 v[112:127], v[204:207], v[168:171], v[112:127]
    ds_read_b64_tr_b16 v[196:197], v1 offset:26624
    v_mfma_f32_32x32x16_bf16 v[128:143], v[204:207], v[172:175], v[128:143]
    ds_read_b64_tr_b16 v[198:199], v1 offset:27136
    s_waitcnt vmcnt(8)
    v_mov_b32 v222, 1
    buffer_atomic_add v222, v252, s[28:31], s63 offen
    s_waitcnt lgkmcnt(4)
    v_mfma_f32_32x32x16_bf16 v[112:127], v[208:211], v[176:179], v[112:127]
    ds_read_b64_tr_b16 v[200:201], v1 offset:28672
    v_mfma_f32_32x32x16_bf16 v[128:143], v[208:211], v[180:183], v[128:143]
    ds_read_b64_tr_b16 v[202:203], v1 offset:29184
    v_mfma_f32_32x32x16_bf16 v[112:127], v[212:215], v[184:187], v[112:127]
    ds_read_b64_tr_b16 v[204:205], v1 offset:30720
    v_mfma_f32_32x32x16_bf16 v[128:143], v[212:215], v[188:191], v[128:143]
    ds_read_b64_tr_b16 v[206:207], v1 offset:31232
    s_waitcnt lgkmcnt(4)
    v_mfma_f32_32x32x16_bf16 v[48:63], v[192:195], a[0:3], 0
    ds_read_b64_tr_b16 v[208:209], v1 offset:32768
    v_mfma_f32_32x32x16_bf16 v[64:79], v[192:195], a[4:7], 0
    ds_read_b64_tr_b16 v[210:211], v1 offset:33280
    v_mfma_f32_32x32x16_bf16 v[48:63], v[196:199], a[8:11], v[48:63]
    ds_read_b64_tr_b16 v[212:213], v1 offset:34816
    s_nop 1
    v_mul_f32 v112, s60, v112
    v_mul_f32 v113, s60, v113
    v_mul_f32 v114, s60, v114
    v_mul_f32 v115, s60, v115
    v_cvt_pk_bf16_f32 v240, v112, v113
    v_mfma_f32_32x32x16_bf16 v[64:79], v[196:199], a[12:15], v[64:79]
    ds_read_b64_tr_b16 v[214:215], v1 offset:35328
    v_cvt_pk_bf16_f32 v241, v114, v115
    buffer_store_dwordx2 v[240:241], v12, s[24:27], s57 offen offset:2048 sc1
    v_mul_f32 v116, s60, v116
    v_mul_f32 v117, s60, v117
    s_waitcnt lgkmcnt(4)
    v_mfma_f32_32x32x16_bf16 v[48:63], v[200:203], a[16:19], v[48:63]
    ds_read_b64_tr_b16 v[192:193], v1 offset:36864
    v_mul_f32 v118, s60, v118
    v_mul_f32 v119, s60, v119
    v_cvt_pk_bf16_f32 v232, v116, v117
    v_cvt_pk_bf16_f32 v233, v118, v119
    buffer_store_dwordx2 v[232:233], v12, s[24:27], s57 offen offset:2304 sc1
    v_mfma_f32_32x32x16_bf16 v[64:79], v[200:203], a[20:23], v[64:79]
    ds_read_b64_tr_b16 v[194:195], v1 offset:37376
    v_mul_f32 v120, s60, v120
    v_mul_f32 v121, s60, v121
    v_mul_f32 v122, s60, v122
    v_mul_f32 v123, s60, v123
    v_cvt_pk_bf16_f32 v236, v120, v121
    v_mfma_f32_32x32x16_bf16 v[48:63], v[204:207], a[24:27], v[48:63]
    ds_read_b64_tr_b16 v[196:197], v1 offset:38912
    v_cvt_pk_bf16_f32 v237, v122, v123
    buffer_store_dwordx2 v[236:237], v12, s[24:27], s57 offen offset:2560 sc1
    v_mul_f32 v124, s60, v124
    v_mul_f32 v125, s60, v125
    v_mul_f32 v126, s60, v126
    v_mfma_f32_32x32x16_bf16 v[64:79], v[204:207], a[28:31], v[64:79]
    ds_read_b64_tr_b16 v[198:199], v1 offset:39424
    v_mul_f32 v127, s60, v127
    v_cvt_pk_bf16_f32 v240, v124, v125
    v_cvt_pk_bf16_f32 v241, v126, v127
    buffer_store_dwordx2 v[240:241], v12, s[24:27], s57 offen offset:2816 sc1
    s_waitcnt lgkmcnt(4)
    v_mfma_f32_32x32x16_bf16 v[48:63], v[208:211], a[32:35], v[48:63]
    ds_read_b64_tr_b16 v[200:201], v1 offset:40960
    v_mul_f32 v128, s60, v128
    v_mul_f32 v129, s60, v129
    v_mul_f32 v130, s60, v130
    v_mul_f32 v131, s60, v131
    v_cvt_pk_bf16_f32 v232, v128, v129
    v_mfma_f32_32x32x16_bf16 v[64:79], v[208:211], a[36:39], v[64:79]
    ds_read_b64_tr_b16 v[202:203], v1 offset:41472
    v_cvt_pk_bf16_f32 v233, v130, v131
    buffer_store_dwordx2 v[232:233], v12, s[24:27], s58 offen offset:2048 sc1
    v_mul_f32 v132, s60, v132
    v_mul_f32 v133, s60, v133
    v_mul_f32 v134, s60, v134
    v_mfma_f32_32x32x16_bf16 v[48:63], v[212:215], a[40:43], v[48:63]
    ds_read_b64_tr_b16 v[204:205], v1 offset:43008
    v_mul_f32 v135, s60, v135
    v_cvt_pk_bf16_f32 v236, v132, v133
    v_cvt_pk_bf16_f32 v237, v134, v135
    buffer_store_dwordx2 v[236:237], v12, s[24:27], s58 offen offset:2304 sc1
    v_mul_f32 v136, s60, v136
    v_mfma_f32_32x32x16_bf16 v[64:79], v[212:215], a[44:47], v[64:79]
    ds_read_b64_tr_b16 v[206:207], v1 offset:43520
    v_mul_f32 v137, s60, v137
    v_mul_f32 v138, s60, v138
    v_mul_f32 v139, s60, v139
    v_cvt_pk_bf16_f32 v240, v136, v137
    s_waitcnt lgkmcnt(4)
    v_mfma_f32_32x32x16_bf16 v[48:63], v[192:195], a[48:51], v[48:63]
    ds_read_b64_tr_b16 v[208:209], v1 offset:45056
    v_cvt_pk_bf16_f32 v241, v138, v139
    buffer_store_dwordx2 v[240:241], v12, s[24:27], s58 offen offset:2560 sc1
    v_mul_f32 v140, s60, v140
    v_mul_f32 v141, s60, v141
    v_mul_f32 v142, s60, v142
    v_mfma_f32_32x32x16_bf16 v[64:79], v[192:195], a[52:55], v[64:79]
    ds_read_b64_tr_b16 v[210:211], v1 offset:45568
    v_mul_f32 v143, s60, v143
    v_cvt_pk_bf16_f32 v232, v140, v141
    v_cvt_pk_bf16_f32 v233, v142, v143
    buffer_store_dwordx2 v[232:233], v12, s[24:27], s58 offen offset:2816 sc1
    v_mfma_f32_32x32x16_bf16 v[48:63], v[196:199], a[56:59], v[48:63]
    ds_read_b64_tr_b16 v[212:213], v1 offset:47104
    v_mfma_f32_32x32x16_bf16 v[64:79], v[196:199], a[60:63], v[64:79]
    ds_read_b64_tr_b16 v[214:215], v1 offset:47616
    s_waitcnt lgkmcnt(4)
    v_mfma_f32_32x32x16_bf16 v[48:63], v[200:203], a[64:67], v[48:63]
    ds_read_b64_tr_b16 v[192:193], v1 offset:49152
    v_mfma_f32_32x32x16_bf16 v[64:79], v[200:203], a[68:71], v[64:79]
    ds_read_b64_tr_b16 v[194:195], v1 offset:49664
    v_mfma_f32_32x32x16_bf16 v[48:63], v[204:207], a[72:75], v[48:63]
    ds_read_b64_tr_b16 v[196:197], v1 offset:51200
    v_mfma_f32_32x32x16_bf16 v[64:79], v[204:207], a[76:79], v[64:79]
    ds_read_b64_tr_b16 v[198:199], v1 offset:51712
    s_waitcnt lgkmcnt(4)
    v_mfma_f32_32x32x16_bf16 v[48:63], v[208:211], a[80:83], v[48:63]
    ds_read_b64_tr_b16 v[200:201], v1 offset:53248
    v_mfma_f32_32x32x16_bf16 v[64:79], v[208:211], a[84:87], v[64:79]
    ds_read_b64_tr_b16 v[202:203], v1 offset:53760
    v_mfma_f32_32x32x16_bf16 v[48:63], v[212:215], a[88:91], v[48:63]
    ds_read_b64_tr_b16 v[204:205], v1 offset:55296
    v_mfma_f32_32x32x16_bf16 v[64:79], v[212:215], a[92:95], v[64:79]
    ds_read_b64_tr_b16 v[206:207], v1 offset:55808
    s_waitcnt lgkmcnt(4)
    v_mfma_f32_32x32x16_bf16 v[48:63], v[192:195], a[96:99], v[48:63]
    ds_read_b64_tr_b16 v[208:209], v1 offset:57344
    v_mfma_f32_32x32x16_bf16 v[64:79], v[192:195], a[100:103], v[64:79]
    ds_read_b64_tr_b16 v[210:211], v1 offset:57856
    v_mfma_f32_32x32x16_bf16 v[48:63], v[196:199], a[104:107], v[48:63]
    ds_read_b64_tr_b16 v[212:213], v1 offset:59392
    v_mfma_f32_32x32x16_bf16 v[64:79], v[196:199], a[108:111], v[64:79]
    ds_read_b64_tr_b16 v[214:215], v1 offset:59904
    v_mov_b32 v253, 0
    buffer_atomic_add v253, v252, s[28:31], s63 offen sc0
    s_waitcnt lgkmcnt(4)
    v_mfma_f32_32x32x16_bf16 v[48:63], v[200:203], a[112:115], v[48:63]
    ds_read_b64_tr_b16 v[192:193], v4 offset:0
    v_mfma_f32_32x32x16_bf16 v[64:79], v[200:203], a[116:119], v[64:79]
    ds_read_b64_tr_b16 v[194:195], v4 offset:512
    v_mfma_f32_32x32x16_bf16 v[48:63], v[204:207], a[120:123], v[48:63]
    ds_read_b64_tr_b16 v[196:197], v4 offset:2048
    v_mfma_f32_32x32x16_bf16 v[64:79], v[204:207], a[124:127], v[64:79]
    ds_read_b64_tr_b16 v[198:199], v4 offset:2560
    s_waitcnt lgkmcnt(4)
    v_mfma_f32_32x32x16_bf16 v[48:63], v[208:211], a[128:131], v[48:63]
    ds_read_b64_tr_b16 v[200:201], v4 offset:4096
    v_mfma_f32_32x32x16_bf16 v[64:79], v[208:211], a[132:135], v[64:79]
    ds_read_b64_tr_b16 v[202:203], v4 offset:4608
    v_mfma_f32_32x32x16_bf16 v[48:63], v[212:215], a[136:139], v[48:63]
    ds_read_b64_tr_b16 v[204:205], v4 offset:6144
    v_mfma_f32_32x32x16_bf16 v[64:79], v[212:215], a[140:143], v[64:79]
    ds_read_b64_tr_b16 v[206:207], v4 offset:6656
    s_waitcnt lgkmcnt(4)
    v_mfma_f32_32x32x16_bf16 v[48:63], v[192:195], a[144:147], v[48:63]
    ds_read_b64_tr_b16 v[208:209], v4 offset:8192
    v_mfma_f32_32x32x16_bf16 v[64:79], v[192:195], a[148:151], v[64:79]
    ds_read_b64_tr_b16 v[210:211], v4 offset:8704
    v_mfma_f32_32x32x16_bf16 v[48:63], v[196:199], a[152:155], v[48:63]
    ds_read_b64_tr_b16 v[212:213], v4 offset:10240
    v_mfma_f32_32x32x16_bf16 v[64:79], v[196:199], a[156:159], v[64:79]
    ds_read_b64_tr_b16 v[214:215], v4 offset:10752
    s_waitcnt lgkmcnt(4)
    v_mfma_f32_32x32x16_bf16 v[48:63], v[200:203], a[160:163], v[48:63]
    ds_read_b64_tr_b16 v[192:193], v4 offset:12288
    v_mfma_f32_32x32x16_bf16 v[64:79], v[200:203], a[164:167], v[64:79]
    ds_read_b64_tr_b16 v[194:195], v4 offset:12800
    v_mfma_f32_32x32x16_bf16 v[48:63], v[204:207], a[168:171], v[48:63]
    ds_read_b64_tr_b16 v[196:197], v4 offset:14336
    v_mfma_f32_32x32x16_bf16 v[64:79], v[204:207], a[172:175], v[64:79]
    ds_read_b64_tr_b16 v[198:199], v4 offset:14848
    s_waitcnt lgkmcnt(4)
    v_mfma_f32_32x32x16_bf16 v[48:63], v[208:211], a[176:179], v[48:63]
    ds_read_b64_tr_b16 v[200:201], v4 offset:16384
    s_waitcnt vmcnt(0)
    s_mov_b32 s51, 0
k1_kernel_pl5:
    v_readfirstlane_b32 s64, v253
    s_nop 0
    s_and_b32 s64, s64, 255
    s_cmp_ge_u32 s64, 32
    s_cbranch_scc1 k1_kernel_pd6
    s_add_u32 s51, s51, 1
    s_cmp_ge_u32 s51, 100000
    s_cbranch_scc1 k1_kernel_pd6
    s_sleep 4
    v_mov_b32 v253, 0
    buffer_atomic_add v253, v252, s[28:31], s63 offen sc0
    s_waitcnt vmcnt(0)
    s_branch k1_kernel_pl5
k1_kernel_pd6:
    v_mfma_f32_32x32x16_bf16 v[64:79], v[208:211], a[180:183], v[64:79]
    ds_read_b64_tr_b16 v[202:203], v4 offset:16896
    buffer_load_dword v216, v13, s[28:31], s59 offen offset:0 sc1
    buffer_load_dword v218, v13, s[28:31], s59 offen offset:256 sc1
    v_mfma_f32_32x32x16_bf16 v[48:63], v[212:215], a[184:187], v[48:63]
    ds_read_b64_tr_b16 v[204:205], v4 offset:18432
    s_barrier
    v_mov_b32 v222, 1
    buffer_atomic_add v222, v251, s[28:31], 0 offen
    v_mfma_f32_32x32x16_bf16 v[64:79], v[212:215], a[188:191], v[64:79]
    ds_read_b64_tr_b16 v[206:207], v4 offset:18944
    s_waitcnt lgkmcnt(4)
    v_mfma_f32_32x32x16_bf16 v[48:63], v[192:195], a[192:195], v[48:63]
    ds_read_b64_tr_b16 v[208:209], v4 offset:20480
    v_mfma_f32_32x32x16_bf16 v[64:79], v[192:195], a[196:199], v[64:79]
    ds_read_b64_tr_b16 v[210:211], v4 offset:20992
    v_mfma_f32_32x32x16_bf16 v[48:63], v[196:199], a[200:203], v[48:63]
    ds_read_b64_tr_b16 v[212:213], v4 offset:22528
    v_mfma_f32_32x32x16_bf16 v[64:79], v[196:199], a[204:207], v[64:79]
    ds_read_b64_tr_b16 v[214:215], v4 offset:23040
    s_waitcnt lgkmcnt(4)
    v_mfma_f32_32x32x16_bf16 v[48:63], v[200:203], a[208:211], v[48:63]
    ds_read_b64_tr_b16 v[192:193], v4 offset:24576
    v_mfma_f32_32x32x16_bf16 v[64:79], v[200:203], a[212:215], v[64:79]
    ds_read_b64_tr_b16 v[194:195], v4 offset:25088
    v_mfma_f32_32x32x16_bf16 v[48:63], v[204:207], a[216:219], v[48:63]
    ds_read_b64_tr_b16 v[196:197], v4 offset:26624
    v_mfma_f32_32x32x16_bf16 v[64:79], v[204:207], a[220:223], v[64:79]
    ds_read_b64_tr_b16 v[198:199], v4 offset:27136
    s_waitcnt lgkmcnt(4)
    v_mfma_f32_32x32x16_bf16 v[48:63], v[208:211], a[224:227], v[48:63]
    ds_read_b64_tr_b16 v[200:201], v4 offset:28672
    v_mfma_f32_32x32x16_bf16 v[64:79], v[208:211], a[228:231], v[64:79]
    ds_read_b64_tr_b16 v[202:203], v4 offset:29184
    v_mfma_f32_32x32x16_bf16 v[48:63], v[212:215], a[232:235], v[48:63]
    ds_read_b64_tr_b16 v[204:205], v4 offset:30720
    v_mfma_f32_32x32x16_bf16 v[64:79], v[212:215], a[236:239], v[64:79]
    ds_read_b64_tr_b16 v[206:207], v4 offset:31232
    s_waitcnt lgkmcnt(4)
    v_mfma_f32_32x32x16_bf16 v[48:63], v[192:195], a[240:243], v[48:63]
    ds_read_b64_tr_b16 v[208:209], v4 offset:32768
    s_waitcnt vmcnt(2)
    v_mov_b32 v217, v216
    s_waitcnt vmcnt(1)
    v_mov_b32 v219, v218
    v_mfma_f32_32x32x16_bf16 v[64:79], v[192:195], a[244:247], v[64:79]
    ds_read_b64_tr_b16 v[210:211], v4 offset:33280
    v_mov_b32 v244, 0x361367a4
    v_mov_b32 v248, 0x361367a4
    v_permlane32_swap_b32 v216, v217
    v_permlane32_swap_b32 v218, v219
    v_mul_f32 v216, 0x39e38e39, v216
    v_mfma_f32_32x32x16_bf16 v[48:63], v[196:199], a[248:251], v[48:63]
    ds_read_b64_tr_b16 v[212:213], v4 offset:34816
    v_mul_f32 v218, 0x39e38e39, v218
    v_fmac_f32 v244, 0x39e38e39, v217
    v_fmac_f32 v248, 0x39e38e39, v219
    v_fma_f32 v244, -v216, v216, v244
    v_fma_f32 v248, -v218, v218, v248
    v_mfma_f32_32x32x16_bf16 v[64:79], v[196:199], a[252:255], v[64:79]
    ds_read_b64_tr_b16 v[214:215], v4 offset:35328
    v_max_f32 v244, 0x361367a4, v244
    v_max_f32 v248, 0x361367a4, v248
    v_rsq_f32 v244, v244
    s_waitcnt lgkmcnt(4)
    v_mfma_f32_32x32x16_bf16 v[48:63], v[200:203], v[160:163], v[48:63]
    ds_read_b64_tr_b16 v[192:193], v2 offset:24576
    v_rsq_f32 v248, v248
    v_mul_f32 v244, 0x40088e99, v244
    v_mul_f32 v248, 0x40088e99, v248
    v_mul_f32 v246, -v216, v244
    v_mfma_f32_32x32x16_bf16 v[64:79], v[200:203], v[164:167], v[64:79]
    ds_read_b64_tr_b16 v[194:195], v2 offset:25088
    v_mul_f32 v250, -v218, v248
    v_lshlrev_b32 v152, 16, v16
    v_and_b32 v153, s62, v16
    v_lshlrev_b32 v154, 16, v17
    v_and_b32 v155, s62, v17
    v_lshlrev_b32 v156, 16, v18
    v_mfma_f32_32x32x16_bf16 v[48:63], v[204:207], v[168:171], v[48:63]
    ds_read_b64_tr_b16 v[196:197], v2 offset:26624
    v_and_b32 v157, s62, v18
    v_lshlrev_b32 v158, 16, v19
    v_and_b32 v159, s62, v19
    v_fma_f32 v152, v152, v244, v246
    v_fma_f32 v153, v153, v244, v246
    v_fma_f32 v154, v154, v244, v246
    v_mfma_f32_32x32x16_bf16 v[64:79], v[204:207], v[172:175], v[64:79]
    ds_read_b64_tr_b16 v[198:199], v2 offset:27136
    v_fma_f32 v155, v155, v244, v246
    v_fma_f32 v156, v156, v244, v246
    v_fma_f32 v157, v157, v244, v246
    v_fma_f32 v158, v158, v244, v246
    v_fma_f32 v159, v159, v244, v246
    s_waitcnt lgkmcnt(4)
    v_mfma_f32_32x32x16_bf16 v[48:63], v[208:211], v[176:179], v[48:63]
    ds_read_b64_tr_b16 v[200:201], v2 offset:28672
    v_cvt_pk_bf16_f32 v16, v152, v153
    v_cvt_pk_bf16_f32 v17, v154, v155
    v_cvt_pk_bf16_f32 v18, v156, v157
    v_cvt_pk_bf16_f32 v19, v158, v159
    buffer_store_dwordx4 v[16:19], v11, s[20:23], s54 offen offset:0 sc1
    v_lshlrev_b32 v152, 16, v20
    v_mfma_f32_32x32x16_bf16 v[64:79], v[208:211], v[180:183], v[64:79]
    ds_read_b64_tr_b16 v[202:203], v2 offset:29184
    v_and_b32 v153, s62, v20
    v_lshlrev_b32 v154, 16, v21
    v_and_b32 v155, s62, v21
    v_lshlrev_b32 v156, 16, v22
    v_and_b32 v157, s62, v22
    v_lshlrev_b32 v158, 16, v23
    v_mfma_f32_32x32x16_bf16 v[48:63], v[212:215], v[184:187], v[48:63]
    ds_read_b64_tr_b16 v[204:205], v2 offset:30720
    v_and_b32 v159, s62, v23
    v_fma_f32 v152, v152, v244, v246
    v_fma_f32 v153, v153, v244, v246
    v_fma_f32 v154, v154, v244, v246
    v_fma_f32 v155, v155, v244, v246
    v_fma_f32 v156, v156, v244, v246
    v_mfma_f32_32x32x16_bf16 v[64:79], v[212:215], v[188:191], v[64:79]
    ds_read_b64_tr_b16 v[206:207], v2 offset:31232
    v_fma_f32 v157, v157, v244, v246
    v_fma_f32 v158, v158, v244, v246
    v_fma_f32 v159, v159, v244, v246
    v_cvt_pk_bf16_f32 v20, v152, v153
    v_cvt_pk_bf16_f32 v21, v154, v155
    s_waitcnt lgkmcnt(4)
    v_mfma_f32_32x32x16_bf16 v[80:95], v[192:195], a[0:3], 0
    ds_read_b64_tr_b16 v[208:209], v2 offset:32768
    v_cvt_pk_bf16_f32 v22, v156, v157
    v_cvt_pk_bf16_f32 v23, v158, v159
    buffer_store_dwordx4 v[20:23], v11, s[20:23], s54 offen offset:256 sc1
    v_lshlrev_b32 v152, 16, v24
    v_and_b32 v153, s62, v24
    v_lshlrev_b32 v154, 16, v25
    v_mfma_f32_32x32x16_bf16 v[96:111], v[192:195], a[4:7], 0
    ds_read_b64_tr_b16 v[210:211], v2 offset:33280
    v_and_b32 v155, s62, v25
    v_lshlrev_b32 v156, 16, v26
    v_and_b32 v157, s62, v26
    v_lshlrev_b32 v158, 16, v27
    v_and_b32 v159, s62, v27
    v_fma_f32 v152, v152, v248, v250
    v_mfma_f32_32x32x16_bf16 v[80:95], v[196:199], a[8:11], v[80:95]
    ds_read_b64_tr_b16 v[212:213], v2 offset:34816
    v_fma_f32 v153, v153, v248, v250
    v_fma_f32 v154, v154, v248, v250
    v_fma_f32 v155, v155, v248, v250
    v_fma_f32 v156, v156, v248, v250
    v_fma_f32 v157, v157, v248, v250
    v_fma_f32 v158, v158, v248, v250
    v_mfma_f32_32x32x16_bf16 v[96:111], v[196:199], a[12:15], v[96:111]
    ds_read_b64_tr_b16 v[214:215], v2 offset:35328
    v_fma_f32 v159, v159, v248, v250
    v_cvt_pk_bf16_f32 v24, v152, v153
    v_cvt_pk_bf16_f32 v25, v154, v155
    v_cvt_pk_bf16_f32 v26, v156, v157
    v_cvt_pk_bf16_f32 v27, v158, v159
    s_waitcnt lgkmcnt(4)
    v_mfma_f32_32x32x16_bf16 v[80:95], v[200:203], a[16:19], v[80:95]
    ds_read_b64_tr_b16 v[192:193], v2 offset:36864
    buffer_store_dwordx4 v[24:27], v11, s[20:23], s55 offen offset:0 sc1
    v_lshlrev_b32 v152, 16, v28
    v_and_b32 v153, s62, v28
    v_lshlrev_b32 v154, 16, v29
    v_and_b32 v155, s62, v29
    v_lshlrev_b32 v156, 16, v30
    v_mfma_f32_32x32x16_bf16 v[96:111], v[200:203], a[20:23], v[96:111]
    ds_read_b64_tr_b16 v[194:195], v2 offset:37376
    v_and_b32 v157, s62, v30
    v_lshlrev_b32 v158, 16, v31
    v_and_b32 v159, s62, v31
    v_fma_f32 v152, v152, v248, v250
    v_fma_f32 v153, v153, v248, v250
    v_fma_f32 v154, v154, v248, v250
    v_mfma_f32_32x32x16_bf16 v[80:95], v[204:207], a[24:27], v[80:95]
    ds_read_b64_tr_b16 v[196:197], v2 offset:38912
    v_fma_f32 v155, v155, v248, v250
    v_fma_f32 v156, v156, v248, v250
    v_fma_f32 v157, v157, v248, v250
    v_fma_f32 v158, v158, v248, v250
    v_fma_f32 v159, v159, v248, v250
    v_cvt_pk_bf16_f32 v28, v152, v153
    v_mfma_f32_32x32x16_bf16 v[96:111], v[204:207], a[28:31], v[96:111]
    ds_read_b64_tr_b16 v[198:199], v2 offset:39424
    v_cvt_pk_bf16_f32 v29, v154, v155
    v_cvt_pk_bf16_f32 v30, v156, v157
    v_cvt_pk_bf16_f32 v31, v158, v159
    buffer_store_dwordx4 v[28:31], v11, s[20:23], s55 offen offset:256 sc1
    v_lshlrev_b32 v152, 16, v32
    s_waitcnt lgkmcnt(4)
    v_mfma_f32_32x32x16_bf16 v[80:95], v[208:211], a[32:35], v[80:95]
    ds_read_b64_tr_b16 v[200:201], v2 offset:40960
    v_and_b32 v153, s62, v32
    v_lshlrev_b32 v154, 16, v33
    v_and_b32 v155, s62, v33
    v_lshlrev_b32 v156, 16, v34
    v_and_b32 v157, s62, v34
    v_lshlrev_b32 v158, 16, v35
    v_mfma_f32_32x32x16_bf16 v[96:111], v[208:211], a[36:39], v[96:111]
    ds_read_b64_tr_b16 v[202:203], v2 offset:41472
    v_and_b32 v159, s62, v35
    v_fma_f32 v152, v152, v244, v246
    v_fma_f32 v153, v153, v244, v246
    v_fma_f32 v154, v154, v244, v246
    v_fma_f32 v155, v155, v244, v246
    v_fma_f32 v156, v156, v244, v246
    v_mfma_f32_32x32x16_bf16 v[80:95], v[212:215], a[40:43], v[80:95]
    ds_read_b64_tr_b16 v[204:205], v2 offset:43008
    v_fma_f32 v157, v157, v244, v246
    v_fma_f32 v158, v158, v244, v246
    v_fma_f32 v159, v159, v244, v246
    v_cvt_pk_bf16_f32 v32, v152, v153
    v_cvt_pk_bf16_f32 v33, v154, v155
    v_cvt_pk_bf16_f32 v34, v156, v157
    v_mfma_f32_32x32x16_bf16 v[96:111], v[212:215], a[44:47], v[96:111]
    ds_read_b64_tr_b16 v[206:207], v2 offset:43520
    v_cvt_pk_bf16_f32 v35, v158, v159
    buffer_store_dwordx4 v[32:35], v11, s[20:23], s54 offen offset:1024 sc1
    v_lshlrev_b32 v152, 16, v36
    v_and_b32 v153, s62, v36
    v_lshlrev_b32 v154, 16, v37
    s_waitcnt lgkmcnt(4)
    v_mfma_f32_32x32x16_bf16 v[80:95], v[192:195], a[48:51], v[80:95]
    ds_read_b64_tr_b16 v[208:209], v2 offset:45056
    v_and_b32 v155, s62, v37
    v_lshlrev_b32 v156, 16, v38
    v_and_b32 v157, s62, v38
    v_lshlrev_b32 v158, 16, v39
    v_and_b32 v159, s62, v39
    v_fma_f32 v152, v152, v244, v246
    v_mfma_f32_32x32x16_bf16 v[96:111], v[192:195], a[52:55], v[96:111]
    ds_read_b64_tr_b16 v[210:211], v2 offset:45568
    v_fma_f32 v153, v153, v244, v246
    v_fma_f32 v154, v154, v244, v246
    v_fma_f32 v155, v155, v244, v246
    v_fma_f32 v156, v156, v244, v246
    v_fma_f32 v157, v157, v244, v246
    v_fma_f32 v158, v158, v244, v246
    v_mfma_f32_32x32x16_bf16 v[80:95], v[196:199], a[56:59], v[80:95]
    ds_read_b64_tr_b16 v[212:213], v2 offset:47104
    v_fma_f32 v159, v159, v244, v246
    v_cvt_pk_bf16_f32 v36, v152, v153
    v_cvt_pk_bf16_f32 v37, v154, v155
    v_cvt_pk_bf16_f32 v38, v156, v157
    v_cvt_pk_bf16_f32 v39, v158, v159
    buffer_store_dwordx4 v[36:39], v11, s[20:23], s54 offen offset:1280 sc1
    v_mfma_f32_32x32x16_bf16 v[96:111], v[196:199], a[60:63], v[96:111]
    ds_read_b64_tr_b16 v[214:215], v2 offset:47616
    v_lshlrev_b32 v152, 16, v40
    v_and_b32 v153, s62, v40
    v_lshlrev_b32 v154, 16, v41
    v_and_b32 v155, s62, v41
    v_lshlrev_b32 v156, 16, v42
    s_waitcnt lgkmcnt(4)
    v_mfma_f32_32x32x16_bf16 v[80:95], v[200:203], a[64:67], v[80:95]
    ds_read_b64_tr_b16 v[192:193], v2 offset:49152
    v_and_b32 v157, s62, v42
    v_lshlrev_b32 v158, 16, v43
    v_and_b32 v159, s62, v43
    v_fma_f32 v152, v152, v248, v250
    v_fma_f32 v153, v153, v248, v250
    v_fma_f32 v154, v154, v248, v250
    v_mfma_f32_32x32x16_bf16 v[96:111], v[200:203], a[68:71], v[96:111]
    ds_read_b64_tr_b16 v[194:195], v2 offset:49664
    v_fma_f32 v155, v155, v248, v250
    v_fma_f32 v156, v156, v248, v250
    v_fma_f32 v157, v157, v248, v250
    v_fma_f32 v158, v158, v248, v250
    v_fma_f32 v159, v159, v248, v250
    v_cvt_pk_bf16_f32 v40, v152, v153
    v_mfma_f32_32x32x16_bf16 v[80:95], v[204:207], a[72:75], v[80:95]
    ds_read_b64_tr_b16 v[196:197], v2 offset:51200
    v_cvt_pk_bf16_f32 v41, v154, v155
    v_cvt_pk_bf16_f32 v42, v156, v157
    v_cvt_pk_bf16_f32 v43, v158, v159
    buffer_store_dwordx4 v[40:43], v11, s[20:23], s55 offen offset:1024 sc1
    v_lshlrev_b32 v152, 16, v44
    v_and_b32 v153, s62, v44
    v_mfma_f32_32x32x16_bf16 v[96:111], v[204:207], a[76:79], v[96:111]
    ds_read_b64_tr_b16 v[198:199], v2 offset:51712
    v_lshlrev_b32 v154, 16, v45
    v_and_b32 v155, s62, v45
    v_lshlrev_b32 v156, 16, v46
    v_and_b32 v157, s62, v46
    v_lshlrev_b32 v158, 16, v47
    s_waitcnt lgkmcnt(4)
    v_mfma_f32_32x32x16_bf16 v[80:95], v[208:211], a[80:83], v[80:95]
    ds_read_b64_tr_b16 v[200:201], v2 offset:53248
    v_and_b32 v159, s62, v47
    v_fma_f32 v152, v152, v248, v250
    v_fma_f32 v153, v153, v248, v250
    v_fma_f32 v154, v154, v248, v250
    v_fma_f32 v155, v155, v248, v250
    v_fma_f32 v156, v156, v248, v250
    v_mfma_f32_32x32x16_bf16 v[96:111], v[208:211], a[84:87], v[96:111]
    ds_read_b64_tr_b16 v[202:203], v2 offset:53760
    v_fma_f32 v157, v157, v248, v250
    v_fma_f32 v158, v158, v248, v250
    v_fma_f32 v159, v159, v248, v250
    v_cvt_pk_bf16_f32 v44, v152, v153
    v_cvt_pk_bf16_f32 v45, v154, v155
    v_cvt_pk_bf16_f32 v46, v156, v157
    v_mfma_f32_32x32x16_bf16 v[80:95], v[212:215], a[88:91], v[80:95]
    ds_read_b64_tr_b16 v[204:205], v2 offset:55296
    v_cvt_pk_bf16_f32 v47, v158, v159
    buffer_store_dwordx4 v[44:47], v11, s[20:23], s55 offen offset:1280 sc1
    v_lshlrev_b32 v152, 16, v144
    v_and_b32 v153, s62, v144
    v_lshlrev_b32 v154, 16, v145
    v_and_b32 v155, s62, v145
    v_mfma_f32_32x32x16_bf16 v[96:111], v[212:215], a[92:95], v[96:111]
    ds_read_b64_tr_b16 v[206:207], v2 offset:55808
    v_lshlrev_b32 v156, 16, v146
    v_and_b32 v157, s62, v146
    v_lshlrev_b32 v158, 16, v147
    v_and_b32 v159, s62, v147
    v_fma_f32 v152, v152, v244, v246
    s_waitcnt lgkmcnt(4)
    v_mfma_f32_32x32x16_bf16 v[80:95], v[192:195], a[96:99], v[80:95]
    ds_read_b64_tr_b16 v[208:209], v2 offset:57344
    v_fma_f32 v153, v153, v244, v246
    v_fma_f32 v154, v154, v244, v246
    v_fma_f32 v155, v155, v244, v246
    v_fma_f32 v156, v156, v244, v246
    v_fma_f32 v157, v157, v244, v246
    v_fma_f32 v158, v158, v244, v246
    v_mfma_f32_32x32x16_bf16 v[96:111], v[192:195], a[100:103], v[96:111]
    ds_read_b64_tr_b16 v[210:211], v2 offset:57856
    v_fma_f32 v159, v159, v244, v246
    v_cvt_pk_bf16_f32 v144, v152, v153
    v_cvt_pk_bf16_f32 v145, v154, v155
    v_cvt_pk_bf16_f32 v146, v156, v157
    v_cvt_pk_bf16_f32 v147, v158, v159
    buffer_store_dwordx4 v[144:147], v11, s[36:39], s56 offen offset:0 sc1
    v_mfma_f32_32x32x16_bf16 v[80:95], v[196:199], a[104:107], v[80:95]
    ds_read_b64_tr_b16 v[212:213], v2 offset:59392
    v_lshlrev_b32 v152, 16, v148
    v_and_b32 v153, s62, v148
    v_lshlrev_b32 v154, 16, v149
    v_and_b32 v155, s62, v149
    v_lshlrev_b32 v156, 16, v150
    v_and_b32 v157, s62, v150
    v_mfma_f32_32x32x16_bf16 v[96:111], v[196:199], a[108:111], v[96:111]
    ds_read_b64_tr_b16 v[214:215], v2 offset:59904
    v_lshlrev_b32 v158, 16, v151
    v_and_b32 v159, s62, v151
    v_fma_f32 v152, v152, v244, v246
    v_fma_f32 v153, v153, v244, v246
    v_fma_f32 v154, v154, v244, v246
    s_waitcnt lgkmcnt(4)
    v_mfma_f32_32x32x16_bf16 v[80:95], v[200:203], a[112:115], v[80:95]
    ds_read_b64_tr_b16 v[192:193], v5 offset:0
    v_fma_f32 v155, v155, v244, v246
    v_fma_f32 v156, v156, v244, v246
    v_fma_f32 v157, v157, v244, v246
    v_fma_f32 v158, v158, v244, v246
    v_fma_f32 v159, v159, v244, v246
    v_cvt_pk_bf16_f32 v148, v152, v153
    v_mfma_f32_32x32x16_bf16 v[96:111], v[200:203], a[116:119], v[96:111]
    ds_read_b64_tr_b16 v[194:195], v5 offset:512
    v_cvt_pk_bf16_f32 v149, v154, v155
    v_cvt_pk_bf16_f32 v150, v156, v157
    v_cvt_pk_bf16_f32 v151, v158, v159
    buffer_store_dwordx4 v[148:151], v11, s[36:39], s56 offen offset:256 sc1
    v_fma_f32 v224, -v48, v48, -s52
    v_fma_f32 v225, -v49, v49, -s52
    v_mfma_f32_32x32x16_bf16 v[80:95], v[204:207], a[120:123], v[80:95]
    ds_read_b64_tr_b16 v[196:197], v5 offset:2048
    v_fma_f32 v226, -v50, v50, -s52
    v_fma_f32 v227, -v51, v51, -s52
    v_mul_f32 v224, v224, v48
    v_mul_f32 v225, v225, v49
    v_mul_f32 v226, v226, v50
    v_mul_f32 v227, v227, v51
    v_mfma_f32_32x32x16_bf16 v[96:111], v[204:207], a[124:127], v[96:111]
    ds_read_b64_tr_b16 v[198:199], v5 offset:2560
    v_exp_f32 v224, v224
    v_exp_f32 v225, v225
    s_waitcnt lgkmcnt(4)
    v_mfma_f32_32x32x16_bf16 v[80:95], v[208:211], a[128:131], v[80:95]
    ds_read_b64_tr_b16 v[200:201], v5 offset:4096
    v_exp_f32 v226, v226
    v_exp_f32 v227, v227
    v_add_f32 v224, 1.0, v224
    v_add_f32 v225, 1.0, v225
    v_add_f32 v226, 1.0, v226
    v_mfma_f32_32x32x16_bf16 v[96:111], v[208:211], a[132:135], v[96:111]
    ds_read_b64_tr_b16 v[202:203], v5 offset:4608
    v_add_f32 v227, 1.0, v227
    v_rcp_f32 v224, v224
    v_rcp_f32 v225, v225
    v_mfma_f32_32x32x16_bf16 v[80:95], v[212:215], a[136:139], v[80:95]
    ds_read_b64_tr_b16 v[204:205], v5 offset:6144
    v_rcp_f32 v226, v226
    v_rcp_f32 v227, v227
    v_mul_f32 v224, v224, v48
    v_mul_f32 v225, v225, v49
    v_mul_f32 v226, v226, v50
    v_mfma_f32_32x32x16_bf16 v[96:111], v[212:215], a[140:143], v[96:111]
    ds_read_b64_tr_b16 v[206:207], v5 offset:6656
    v_mul_f32 v227, v227, v51
    v_cvt_pk_bf16_f32 v236, v224, v225
    v_cvt_pk_bf16_f32 v237, v226, v227
    v_fma_f32 v228, -v52, v52, -s52
    v_fma_f32 v229, -v53, v53, -s52
    s_waitcnt lgkmcnt(4)
    v_mfma_f32_32x32x16_bf16 v[80:95], v[192:195], a[144:147], v[80:95]
    ds_read_b64_tr_b16 v[208:209], v5 offset:8192
    v_fma_f32 v230, -v54, v54, -s52
    v_fma_f32 v231, -v55, v55, -s52
    v_mul_f32 v228, v228, v52
    v_mul_f32 v229, v229, v53
    v_mul_f32 v230, v230, v54
    v_mul_f32 v231, v231, v55
    v_mfma_f32_32x32x16_bf16 v[96:111], v[192:195], a[148:151], v[96:111]
    ds_read_b64_tr_b16 v[210:211], v5 offset:8704
    v_exp_f32 v228, v228
    v_exp_f32 v229, v229
    v_exp_f32 v230, v230
    v_mfma_f32_32x32x16_bf16 v[80:95], v[196:199], a[152:155], v[80:95]
    ds_read_b64_tr_b16 v[212:213], v5 offset:10240
    v_exp_f32 v231, v231
    v_add_f32 v228, 1.0, v228
    v_add_f32 v229, 1.0, v229
    v_add_f32 v230, 1.0, v230
    v_add_f32 v231, 1.0, v231
    v_mfma_f32_32x32x16_bf16 v[96:111], v[196:199], a[156:159], v[96:111]
    ds_read_b64_tr_b16 v[214:215], v5 offset:10752
    v_rcp_f32 v228, v228
    v_rcp_f32 v229, v229
    s_waitcnt lgkmcnt(4)
    v_mfma_f32_32x32x16_bf16 v[80:95], v[200:203], a[160:163], v[80:95]
    ds_read_b64_tr_b16 v[192:193], v5 offset:12288
    v_rcp_f32 v230, v230
    v_rcp_f32 v231, v231
    v_mul_f32 v228, v228, v52
    v_mul_f32 v229, v229, v53
    v_mul_f32 v230, v230, v54
    v_mfma_f32_32x32x16_bf16 v[96:111], v[200:203], a[164:167], v[96:111]
    ds_read_b64_tr_b16 v[194:195], v5 offset:12800
    v_mul_f32 v231, v231, v55
    v_cvt_pk_bf16_f32 v238, v228, v229
    v_cvt_pk_bf16_f32 v239, v230, v231
    buffer_store_dwordx4 v[236:239], v11, s[16:19], s54 offen offset:0 sc1
    v_fma_f32 v224, -v56, v56, -s52
    v_fma_f32 v225, -v57, v57, -s52
    v_mfma_f32_32x32x16_bf16 v[80:95], v[204:207], a[168:171], v[80:95]
    ds_read_b64_tr_b16 v[196:197], v5 offset:14336
    v_fma_f32 v226, -v58, v58, -s52
    v_fma_f32 v227, -v59, v59, -s52
    v_mul_f32 v224, v224, v56
    v_mul_f32 v225, v225, v57
    v_mul_f32 v226, v226, v58
    v_mul_f32 v227, v227, v59
    v_mfma_f32_32x32x16_bf16 v[96:111], v[204:207], a[172:175], v[96:111]
    ds_read_b64_tr_b16 v[198:199], v5 offset:14848
    v_exp_f32 v224, v224
    v_exp_f32 v225, v225
    s_waitcnt lgkmcnt(4)
    v_mfma_f32_32x32x16_bf16 v[80:95], v[208:211], a[176:179], v[80:95]
    ds_read_b64_tr_b16 v[200:201], v5 offset:16384
    v_exp_f32 v226, v226
    v_exp_f32 v227, v227
    v_add_f32 v224, 1.0, v224
    v_add_f32 v225, 1.0, v225
    v_add_f32 v226, 1.0, v226
    v_mfma_f32_32x32x16_bf16 v[96:111], v[208:211], a[180:183], v[96:111]
    ds_read_b64_tr_b16 v[202:203], v5 offset:16896
    v_add_f32 v227, 1.0, v227
    v_rcp_f32 v224, v224
    v_rcp_f32 v225, v225
    v_mfma_f32_32x32x16_bf16 v[80:95], v[212:215], a[184:187], v[80:95]
    ds_read_b64_tr_b16 v[204:205], v5 offset:18432
    v_rcp_f32 v226, v226
    v_rcp_f32 v227, v227
    v_mul_f32 v224, v224, v56
    v_mul_f32 v225, v225, v57
    v_mul_f32 v226, v226, v58
    v_mfma_f32_32x32x16_bf16 v[96:111], v[212:215], a[188:191], v[96:111]
    ds_read_b64_tr_b16 v[206:207], v5 offset:18944
    v_mul_f32 v227, v227, v59
    v_cvt_pk_bf16_f32 v242, v224, v225
    v_cvt_pk_bf16_f32 v243, v226, v227
    v_fma_f32 v228, -v60, v60, -s52
    v_fma_f32 v229, -v61, v61, -s52
    s_waitcnt lgkmcnt(4)
    v_mfma_f32_32x32x16_bf16 v[80:95], v[192:195], a[192:195], v[80:95]
    ds_read_b64_tr_b16 v[208:209], v5 offset:20480
    v_fma_f32 v230, -v62, v62, -s52
    v_fma_f32 v231, -v63, v63, -s52
    v_mul_f32 v228, v228, v60
    v_mul_f32 v229, v229, v61
    v_mul_f32 v230, v230, v62
    v_mul_f32 v231, v231, v63
    v_mfma_f32_32x32x16_bf16 v[96:111], v[192:195], a[196:199], v[96:111]
    ds_read_b64_tr_b16 v[210:211], v5 offset:20992
    v_exp_f32 v228, v228
    v_exp_f32 v229, v229
    v_exp_f32 v230, v230
    v_mfma_f32_32x32x16_bf16 v[80:95], v[196:199], a[200:203], v[80:95]
    ds_read_b64_tr_b16 v[212:213], v5 offset:22528
    v_exp_f32 v231, v231
    v_add_f32 v228, 1.0, v228
    v_add_f32 v229, 1.0, v229
    v_add_f32 v230, 1.0, v230
    v_add_f32 v231, 1.0, v231
    v_mfma_f32_32x32x16_bf16 v[96:111], v[196:199], a[204:207], v[96:111]
    ds_read_b64_tr_b16 v[214:215], v5 offset:23040
    v_rcp_f32 v228, v228
    v_rcp_f32 v229, v229
    s_waitcnt lgkmcnt(4)
    v_mfma_f32_32x32x16_bf16 v[80:95], v[200:203], a[208:211], v[80:95]
    ds_read_b64_tr_b16 v[192:193], v5 offset:24576
    v_rcp_f32 v230, v230
    v_rcp_f32 v231, v231
    v_mul_f32 v228, v228, v60
    v_mul_f32 v229, v229, v61
    v_mul_f32 v230, v230, v62
    v_mfma_f32_32x32x16_bf16 v[96:111], v[200:203], a[212:215], v[96:111]
    ds_read_b64_tr_b16 v[194:195], v5 offset:25088
    v_mul_f32 v231, v231, v63
    v_cvt_pk_bf16_f32 v240, v228, v229
    v_cvt_pk_bf16_f32 v241, v230, v231
    buffer_store_dwordx4 v[240:243], v11, s[16:19], s54 offen offset:256 sc1
    v_mfma_f32_32x32x16_bf16 v[80:95], v[204:207], a[216:219], v[80:95]
    ds_read_b64_tr_b16 v[196:197], v5 offset:26624
    s_waitcnt vmcnt(2)
    s_barrier
    v_mov_b32 v222, 1
    buffer_atomic_add v222, v6, s[28:31], 0 offen
    v_fma_f32 v224, -v64, v64, -s52
    v_fma_f32 v225, -v65, v65, -s52
    v_fma_f32 v226, -v66, v66, -s52
    v_mfma_f32_32x32x16_bf16 v[96:111], v[204:207], a[220:223], v[96:111]
    ds_read_b64_tr_b16 v[198:199], v5 offset:27136
    v_fma_f32 v227, -v67, v67, -s52
    v_mul_f32 v224, v224, v64
    v_mul_f32 v225, v225, v65
    v_mul_f32 v226, v226, v66
    v_mul_f32 v227, v227, v67
    s_waitcnt lgkmcnt(4)
    v_mfma_f32_32x32x16_bf16 v[80:95], v[208:211], a[224:227], v[80:95]
    ds_read_b64_tr_b16 v[200:201], v5 offset:28672
    v_exp_f32 v224, v224
    v_exp_f32 v225, v225
    v_exp_f32 v226, v226
    v_mfma_f32_32x32x16_bf16 v[96:111], v[208:211], a[228:231], v[96:111]
    ds_read_b64_tr_b16 v[202:203], v5 offset:29184
    v_exp_f32 v227, v227
    v_add_f32 v224, 1.0, v224
    v_add_f32 v225, 1.0, v225
    v_add_f32 v226, 1.0, v226
    v_add_f32 v227, 1.0, v227
    v_mfma_f32_32x32x16_bf16 v[80:95], v[212:215], a[232:235], v[80:95]
    ds_read_b64_tr_b16 v[204:205], v5 offset:30720
    v_rcp_f32 v224, v224
    v_rcp_f32 v225, v225
    v_rcp_f32 v226, v226
    v_mfma_f32_32x32x16_bf16 v[96:111], v[212:215], a[236:239], v[96:111]
    ds_read_b64_tr_b16 v[206:207], v5 offset:31232
    v_rcp_f32 v227, v227
    v_mul_f32 v224, v224, v64
    v_mul_f32 v225, v225, v65
    v_mul_f32 v226, v226, v66
    s_waitcnt lgkmcnt(4)
    v_mfma_f32_32x32x16_bf16 v[80:95], v[192:195], a[240:243], v[80:95]
    ds_read_b64_tr_b16 v[208:209], v5 offset:32768
    v_mul_f32 v227, v227, v67
    v_cvt_pk_bf16_f32 v232, v224, v225
    v_cvt_pk_bf16_f32 v233, v226, v227
    v_fma_f32 v228, -v68, v68, -s52
    v_fma_f32 v229, -v69, v69, -s52
    v_fma_f32 v230, -v70, v70, -s52
    v_mfma_f32_32x32x16_bf16 v[96:111], v[192:195], a[244:247], v[96:111]
    ds_read_b64_tr_b16 v[210:211], v5 offset:33280
    v_fma_f32 v231, -v71, v71, -s52
    v_mul_f32 v228, v228, v68
    v_mul_f32 v229, v229, v69
    v_mul_f32 v230, v230, v70
    v_mul_f32 v231, v231, v71
    v_mfma_f32_32x32x16_bf16 v[80:95], v[196:199], a[248:251], v[80:95]
    ds_read_b64_tr_b16 v[212:213], v5 offset:34816
    v_exp_f32 v228, v228
    v_exp_f32 v229, v229
    v_exp_f32 v230, v230
    v_mfma_f32_32x32x16_bf16 v[96:111], v[196:199], a[252:255], v[96:111]
    ds_read_b64_tr_b16 v[214:215], v5 offset:35328
    v_exp_f32 v231, v231
    v_add_f32 v228, 1.0, v228
    v_add_f32 v229, 1.0, v229
    v_add_f32 v230, 1.0, v230
    v_add_f32 v231, 1.0, v231
    s_waitcnt lgkmcnt(4)
    v_mfma_f32_32x32x16_bf16 v[80:95], v[200:203], v[160:163], v[80:95]
    v_rcp_f32 v228, v228
    v_rcp_f32 v229, v229
    v_rcp_f32 v230, v230
    v_mfma_f32_32x32x16_bf16 v[96:111], v[200:203], v[164:167], v[96:111]
    v_rcp_f32 v231, v231
    v_mul_f32 v228, v228, v68
    v_mul_f32 v229, v229, v69
    v_mul_f32 v230, v230, v70
    v_mul_f32 v231, v231, v71
    v_cvt_pk_bf16_f32 v234, v228, v229
    v_cvt_pk_bf16_f32 v235, v230, v231
    v_mfma_f32_32x32x16_bf16 v[80:95], v[204:207], v[168:171], v[80:95]
    buffer_store_dwordx4 v[232:235], v11, s[16:19], s55 offen offset:0 sc1
    v_fma_f32 v224, -v72, v72, -s52
    v_fma_f32 v225, -v73, v73, -s52
    v_fma_f32 v226, -v74, v74, -s52
    v_fma_f32 v227, -v75, v75, -s52
    v_mul_f32 v224, v224, v72
    v_mul_f32 v225, v225, v73
    v_mfma_f32_32x32x16_bf16 v[96:111], v[204:207], v[172:175], v[96:111]
    v_mul_f32 v226, v226, v74
    v_mul_f32 v227, v227, v75
    v_exp_f32 v224, v224
    v_exp_f32 v225, v225
    s_waitcnt lgkmcnt(0)
    v_mfma_f32_32x32x16_bf16 v[80:95], v[208:211], v[176:179], v[80:95]
    v_exp_f32 v226, v226
    v_exp_f32 v227, v227
    v_add_f32 v224, 1.0, v224
    v_add_f32 v225, 1.0, v225
    v_add_f32 v226, 1.0, v226
    v_mfma_f32_32x32x16_bf16 v[96:111], v[208:211], v[180:183], v[96:111]
    v_add_f32 v227, 1.0, v227
    v_rcp_f32 v224, v224
    v_rcp_f32 v225, v225
    v_rcp_f32 v226, v226
    v_mfma_f32_32x32x16_bf16 v[80:95], v[212:215], v[184:187], v[80:95]
    v_rcp_f32 v227, v227
    v_mul_f32 v224, v224, v72
    v_mul_f32 v225, v225, v73
    v_mul_f32 v226, v226, v74
    v_mul_f32 v227, v227, v75
    v_cvt_pk_bf16_f32 v238, v224, v225
    v_mfma_f32_32x32x16_bf16 v[96:111], v[212:215], v[188:191], v[96:111]
    v_cvt_pk_bf16_f32 v239, v226, v227
    v_fma_f32 v228, -v76, v76, -s52
    v_fma_f32 v229, -v77, v77, -s52
    v_fma_f32 v230, -v78, v78, -s52
    v_fma_f32 v231, -v79, v79, -s52
    v_mul_f32 v228, v228, v76
    v_mul_f32 v229, v229, v77
    v_mul_f32 v230, v230, v78
    v_mul_f32 v231, v231, v79
    v_exp_f32 v228, v228
    v_exp_f32 v229, v229
    v_exp_f32 v230, v230
    v_exp_f32 v231, v231
    v_add_f32 v228, 1.0, v228
    v_add_f32 v229, 1.0, v229
    v_add_f32 v230, 1.0, v230
    v_add_f32 v231, 1.0, v231
    v_rcp_f32 v228, v228
    v_rcp_f32 v229, v229
    v_rcp_f32 v230, v230
    v_rcp_f32 v231, v231
    v_mul_f32 v228, v228, v76
    v_mul_f32 v229, v229, v77
    v_mul_f32 v230, v230, v78
    v_mul_f32 v231, v231, v79
    v_cvt_pk_bf16_f32 v236, v228, v229
    v_cvt_pk_bf16_f32 v237, v230, v231
    buffer_store_dwordx4 v[236:239], v11, s[16:19], s55 offen offset:256 sc1
    s_branch k1_fin
k1_qk1:
    buffer_load_dwordx4 a[24:27], v10, s[4:7], s43 offen offset:3072 sc1
    buffer_load_dwordx4 a[28:31], v10, s[4:7], s44 offen offset:3072 sc1
    s_add_u32 s43, s43, 4096
    buffer_load_dwordx4 a[32:35], v10, s[4:7], s43 offen offset:0 sc1
    s_add_u32 s44, s44, 4096
    buffer_load_dwordx4 a[36:39], v10, s[4:7], s44 offen offset:0 sc1
    buffer_load_dwordx4 a[40:43], v10, s[4:7], s43 offen offset:1024 sc1
    buffer_load_dwordx4 a[44:47], v10, s[4:7], s44 offen offset:1024 sc1
    s_waitcnt vmcnt(21)
    s_barrier
    ds_read_b64_tr_b16 v[192:193], v1 offset:24576
    ds_read_b64_tr_b16 v[194:195], v1 offset:25088
    ds_read_b64_tr_b16 v[196:197], v2 offset:24576
    ds_read_b64_tr_b16 v[198:199], v2 offset:25088
    ds_read_b64_tr_b16 v[200:201], v3 offset:0
    ds_read_b64_tr_b16 v[202:203], v3 offset:256
    ds_read_b64_tr_b16 v[204:205], v1 offset:26624
    ds_read_b64_tr_b16 v[206:207], v1 offset:27136
    s_waitcnt vmcnt(10) lgkmcnt(4)
    v_mfma_f32_32x32x16_bf16 v[16:31], v[192:195], a[0:3], 0
    ds_read_b64_tr_b16 v[208:209], v2 offset:26624
    v_mfma_f32_32x32x16_bf16 v[32:47], v[192:195], a[4:7], 0
    ds_read_b64_tr_b16 v[210:211], v2 offset:27136
    v_mfma_f32_32x32x16_bf16 v[48:63], v[196:199], a[0:3], 0
    ds_read_b64_tr_b16 v[212:213], v3 offset:1024
    buffer_load_dwordx4 a[48:51], v10, s[4:7], s43 offen offset:2048 sc1
    v_mfma_f32_32x32x16_bf16 v[64:79], v[196:199], a[4:7], 0
    ds_read_b64_tr_b16 v[214:215], v3 offset:1280
    s_waitcnt lgkmcnt(6)
    v_mfma_f32_32x32x16_bf16 v[144:159], v[200:203], a[4:7], 0
    ds_read_b64_tr_b16 v[192:193], v1 offset:28672
    ds_read_b64_tr_b16 v[194:195], v1 offset:29184
    buffer_load_dwordx4 a[52:55], v10, s[4:7], s44 offen offset:2048 sc1
    s_waitcnt vmcnt(10) lgkmcnt(4)
    v_mfma_f32_32x32x16_bf16 v[16:31], v[204:207], a[8:11], v[16:31]
    ds_read_b64_tr_b16 v[196:197], v2 offset:28672
    v_mfma_f32_32x32x16_bf16 v[32:47], v[204:207], a[12:15], v[32:47]
    ds_read_b64_tr_b16 v[198:199], v2 offset:29184
    buffer_load_dwordx4 a[56:59], v10, s[4:7], s43 offen offset:3072 sc1
    v_mfma_f32_32x32x16_bf16 v[48:63], v[208:211], a[8:11], v[48:63]
    ds_read_b64_tr_b16 v[200:201], v3 offset:2048
    v_mfma_f32_32x32x16_bf16 v[64:79], v[208:211], a[12:15], v[64:79]
    ds_read_b64_tr_b16 v[202:203], v3 offset:2304
    buffer_load_dwordx4 a[60:63], v10, s[4:7], s44 offen offset:3072 sc1
    s_waitcnt lgkmcnt(6)
    v_mfma_f32_32x32x16_bf16 v[144:159], v[212:215], a[12:15], v[144:159]
    ds_read_b64_tr_b16 v[204:205], v1 offset:30720
    ds_read_b64_tr_b16 v[206:207], v1 offset:31232
    s_waitcnt vmcnt(10) lgkmcnt(4)
    v_mfma_f32_32x32x16_bf16 v[16:31], v[192:195], a[16:19], v[16:31]
    ds_read_b64_tr_b16 v[208:209], v2 offset:30720
    s_add_u32 s43, s43, 4096
    buffer_load_dwordx4 a[64:67], v10, s[4:7], s43 offen offset:0 sc1
    v_mfma_f32_32x32x16_bf16 v[32:47], v[192:195], a[20:23], v[32:47]
    ds_read_b64_tr_b16 v[210:211], v2 offset:31232
    v_mfma_f32_32x32x16_bf16 v[48:63], v[196:199], a[16:19], v[48:63]
    ds_read_b64_tr_b16 v[212:213], v3 offset:3072
    s_add_u32 s44, s44, 4096
    buffer_load_dwordx4 a[68:71], v10, s[4:7], s44 offen offset:0 sc1
    v_mfma_f32_32x32x16_bf16 v[64:79], v[196:199], a[20:23], v[64:79]
    ds_read_b64_tr_b16 v[214:215], v3 offset:3328
    s_waitcnt lgkmcnt(6)
    v_mfma_f32_32x32x16_bf16 v[144:159], v[200:203], a[20:23], v[144:159]
    ds_read_b64_tr_b16 v[192:193], v1 offset:32768
    ds_read_b64_tr_b16 v[194:195], v1 offset:33280
    buffer_load_dwordx4 a[72:75], v10, s[4:7], s43 offen offset:1024 sc1
    s_waitcnt vmcnt(11) lgkmcnt(4)
    v_mfma_f32_32x32x16_bf16 v[16:31], v[204:207], a[24:27], v[16:31]
    ds_read_b64_tr_b16 v[196:197], v2 offset:32768
    v_mfma_f32_32x32x16_bf16 v[32:47], v[204:207], a[28:31], v[32:47]
    ds_read_b64_tr_b16 v[198:199], v2 offset:33280
    buffer_load_dwordx4 a[76:79], v10, s[4:7], s44 offen offset:1024 sc1
    v_mfma_f32_32x32x16_bf16 v[48:63], v[208:211], a[24:27], v[48:63]
    ds_read_b64_tr_b16 v[200:201], v3 offset:4096
    v_mfma_f32_32x32x16_bf16 v[64:79], v[208:211], a[28:31], v[64:79]
    ds_read_b64_tr_b16 v[202:203], v3 offset:4352
    buffer_load_dwordx4 a[80:83], v10, s[4:7], s43 offen offset:2048 sc1
    s_waitcnt lgkmcnt(6)
    v_mfma_f32_32x32x16_bf16 v[144:159], v[212:215], a[28:31], v[144:159]
    ds_read_b64_tr_b16 v[204:205], v1 offset:34816
    ds_read_b64_tr_b16 v[206:207], v1 offset:35328
    s_waitcnt vmcnt(11) lgkmcnt(4)
    v_mfma_f32_32x32x16_bf16 v[16:31], v[192:195], a[32:35], v[16:31]
    ds_read_b64_tr_b16 v[208:209], v2 offset:34816
    buffer_load_dwordx4 a[84:87], v10, s[4:7], s44 offen offset:2048 sc1
    v_mfma_f32_32x32x16_bf16 v[32:47], v[192:195], a[36:39], v[32:47]
    ds_read_b64_tr_b16 v[210:211], v2 offset:35328
    v_mfma_f32_32x32x16_bf16 v[48:63], v[196:199], a[32:35], v[48:63]
    ds_read_b64_tr_b16 v[212:213], v3 offset:5120
    buffer_load_dwordx4 a[88:91], v10, s[4:7], s43 offen offset:3072 sc1
    v_mfma_f32_32x32x16_bf16 v[64:79], v[196:199], a[36:39], v[64:79]
    ds_read_b64_tr_b16 v[214:215], v3 offset:5376
    s_waitcnt lgkmcnt(6)
    v_mfma_f32_32x32x16_bf16 v[144:159], v[200:203], a[36:39], v[144:159]
    s_barrier
    ds_read_b64_tr_b16 v[192:193], v1 offset:36864
    ds_read_b64_tr_b16 v[194:195], v1 offset:37376
    s_waitcnt vmcnt(11) lgkmcnt(4)
    v_mfma_f32_32x32x16_bf16 v[16:31], v[204:207], a[40:43], v[16:31]
    ds_read_b64_tr_b16 v[196:197], v2 offset:36864
    buffer_load_dwordx4 a[92:95], v10, s[4:7], s44 offen offset:3072 sc1
    v_mfma_f32_32x32x16_bf16 v[32:47], v[204:207], a[44:47], v[32:47]
    ds_read_b64_tr_b16 v[198:199], v2 offset:37376
    v_mfma_f32_32x32x16_bf16 v[48:63], v[208:211], a[40:43], v[48:63]
    ds_read_b64_tr_b16 v[200:201], v3 offset:6144
    s_add_u32 s43, s43, 4096
    buffer_load_dwordx4 a[96:99], v10, s[4:7], s43 offen offset:0 sc1
    v_mfma_f32_32x32x16_bf16 v[64:79], v[208:211], a[44:47], v[64:79]
    ds_read_b64_tr_b16 v[202:203], v3 offset:6400
    s_waitcnt lgkmcnt(6)
    v_mfma_f32_32x32x16_bf16 v[144:159], v[212:215], a[44:47], v[144:159]
    ds_read_b64_tr_b16 v[204:205], v1 offset:38912
    ds_read_b64_tr_b16 v[206:207], v1 offset:39424
    s_add_u32 s44, s44, 4096
    buffer_load_dwordx4 a[100:103], v10, s[4:7], s44 offen offset:0 sc1
    s_waitcnt vmcnt(12) lgkmcnt(4)
    v_mfma_f32_32x32x16_bf16 v[16:31], v[192:195], a[48:51], v[16:31]
    ds_read_b64_tr_b16 v[208:209], v2 offset:38912
    v_mfma_f32_32x32x16_bf16 v[32:47], v[192:195], a[52:55], v[32:47]
    ds_read_b64_tr_b16 v[210:211], v2 offset:39424
    buffer_load_dwordx4 a[104:107], v10, s[4:7], s43 offen offset:1024 sc1
    v_mfma_f32_32x32x16_bf16 v[48:63], v[196:199], a[48:51], v[48:63]
    ds_read_b64_tr_b16 v[212:213], v3 offset:7168
    v_mfma_f32_32x32x16_bf16 v[64:79], v[196:199], a[52:55], v[64:79]
    ds_read_b64_tr_b16 v[214:215], v3 offset:7424
    buffer_load_dwordx4 a[108:111], v10, s[4:7], s44 offen offset:1024 sc1
    s_waitcnt lgkmcnt(6)
    v_mfma_f32_32x32x16_bf16 v[144:159], v[200:203], a[52:55], v[144:159]
    ds_read_b64_tr_b16 v[192:193], v1 offset:40960
    ds_read_b64_tr_b16 v[194:195], v1 offset:41472
    s_waitcnt vmcnt(12) lgkmcnt(4)
    v_mfma_f32_32x32x16_bf16 v[16:31], v[204:207], a[56:59], v[16:31]
    ds_read_b64_tr_b16 v[196:197], v2 offset:40960
    s_add_u32 m0, s45, 126976
    s_add_u32 s50, s46, 2654208
    buffer_load_dwordx4 v7, s[8:11], s50 offen offset:0 lds
    v_mfma_f32_32x32x16_bf16 v[32:47], v[204:207], a[60:63], v[32:47]
    ds_read_b64_tr_b16 v[198:199], v2 offset:41472
    v_mfma_f32_32x32x16_bf16 v[48:63], v[208:211], a[56:59], v[48:63]
    ds_read_b64_tr_b16 v[200:201], v3 offset:8192
    buffer_load_dwordx4 v8, s[8:11], s50 offen offset:1024 lds
    v_mfma_f32_32x32x16_bf16 v[64:79], v[208:211], a[60:63], v[64:79]
    ds_read_b64_tr_b16 v[202:203], v3 offset:8448
    s_waitcnt lgkmcnt(6)
    v_mfma_f32_32x32x16_bf16 v[144:159], v[212:215], a[60:63], v[144:159]
    ds_read_b64_tr_b16 v[204:205], v1 offset:43008
    ds_read_b64_tr_b16 v[206:207], v1 offset:43520
    buffer_load_dwordx4 v9, s[8:11], s50 offen offset:2048 lds
    s_waitcnt vmcnt(13) lgkmcnt(4)
    v_mfma_f32_32x32x16_bf16 v[16:31], v[192:195], a[64:67], v[16:31]
    ds_read_b64_tr_b16 v[208:209], v2 offset:43008
    v_mfma_f32_32x32x16_bf16 v[32:47], v[192:195], a[68:71], v[32:47]
    ds_read_b64_tr_b16 v[210:211], v2 offset:43520
    buffer_load_dwordx4 a[112:115], v10, s[4:7], s43 offen offset:2048 sc1
    v_mfma_f32_32x32x16_bf16 v[48:63], v[196:199], a[64:67], v[48:63]
    ds_read_b64_tr_b16 v[212:213], v3 offset:9216
    v_mfma_f32_32x32x16_bf16 v[64:79], v[196:199], a[68:71], v[64:79]
    ds_read_b64_tr_b16 v[214:215], v3 offset:9472
    buffer_load_dwordx4 a[116:119], v10, s[4:7], s44 offen offset:2048 sc1
    s_waitcnt lgkmcnt(6)
    v_mfma_f32_32x32x16_bf16 v[144:159], v[200:203], a[68:71], v[144:159]
    ds_read_b64_tr_b16 v[192:193], v1 offset:45056
    ds_read_b64_tr_b16 v[194:195], v1 offset:45568
    s_waitcnt vmcnt(13) lgkmcnt(4)
    v_mfma_f32_32x32x16_bf16 v[16:31], v[204:207], a[72:75], v[16:31]
    ds_read_b64_tr_b16 v[196:197], v2 offset:45056
    buffer_load_dwordx4 a[120:123], v10, s[4:7], s43 offen offset:3072 sc1
    v_mfma_f32_32x32x16_bf16 v[32:47], v[204:207], a[76:79], v[32:47]
    ds_read_b64_tr_b16 v[198:199], v2 offset:45568
    v_mfma_f32_32x32x16_bf16 v[48:63], v[208:211], a[72:75], v[48:63]
    ds_read_b64_tr_b16 v[200:201], v3 offset:10240
    buffer_load_dwordx4 a[124:127], v10, s[4:7], s44 offen offset:3072 sc1
    v_mfma_f32_32x32x16_bf16 v[64:79], v[208:211], a[76:79], v[64:79]
    ds_read_b64_tr_b16 v[202:203], v3 offset:10496
    s_waitcnt lgkmcnt(6)
    v_mfma_f32_32x32x16_bf16 v[144:159], v[212:215], a[76:79], v[144:159]
    ds_read_b64_tr_b16 v[204:205], v1 offset:47104
    ds_read_b64_tr_b16 v[206:207], v1 offset:47616
    s_waitcnt vmcnt(13) lgkmcnt(4)
    v_mfma_f32_32x32x16_bf16 v[16:31], v[192:195], a[80:83], v[16:31]
    ds_read_b64_tr_b16 v[208:209], v2 offset:47104
    s_add_u32 s43, s43, 4096
    buffer_load_dwordx4 a[128:131], v10, s[4:7], s43 offen offset:0 sc1
    v_mfma_f32_32x32x16_bf16 v[32:47], v[192:195], a[84:87], v[32:47]
    ds_read_b64_tr_b16 v[210:211], v2 offset:47616
    v_mfma_f32_32x32x16_bf16 v[48:63], v[196:199], a[80:83], v[48:63]
    ds_read_b64_tr_b16 v[212:213], v3 offset:11264
    s_add_u32 s44, s44, 4096
    buffer_load_dwordx4 a[132:135], v10, s[4:7], s44 offen offset:0 sc1
    v_mfma_f32_32x32x16_bf16 v[64:79], v[196:199], a[84:87], v[64:79]
    ds_read_b64_tr_b16 v[214:215], v3 offset:11520
    s_waitcnt lgkmcnt(6)
    v_mfma_f32_32x32x16_bf16 v[144:159], v[200:203], a[84:87], v[144:159]
    s_barrier
    ds_read_b64_tr_b16 v[192:193], v1 offset:49152
    ds_read_b64_tr_b16 v[194:195], v1 offset:49664
    buffer_load_dwordx4 a[136:139], v10, s[4:7], s43 offen offset:1024 sc1
    s_waitcnt vmcnt(14) lgkmcnt(4)
    v_mfma_f32_32x32x16_bf16 v[16:31], v[204:207], a[88:91], v[16:31]
    ds_read_b64_tr_b16 v[196:197], v2 offset:49152
    v_mfma_f32_32x32x16_bf16 v[32:47], v[204:207], a[92:95], v[32:47]
    ds_read_b64_tr_b16 v[198:199], v2 offset:49664
    buffer_load_dwordx4 a[140:143], v10, s[4:7], s44 offen offset:1024 sc1
    v_mfma_f32_32x32x16_bf16 v[48:63], v[208:211], a[88:91], v[48:63]
    ds_read_b64_tr_b16 v[200:201], v3 offset:12288
    v_mfma_f32_32x32x16_bf16 v[64:79], v[208:211], a[92:95], v[64:79]
    ds_read_b64_tr_b16 v[202:203], v3 offset:12544
    buffer_load_dwordx4 a[144:147], v10, s[4:7], s43 offen offset:2048 sc1
    s_waitcnt lgkmcnt(6)
    v_mfma_f32_32x32x16_bf16 v[144:159], v[212:215], a[92:95], v[144:159]
    ds_read_b64_tr_b16 v[204:205], v1 offset:51200
    ds_read_b64_tr_b16 v[206:207], v1 offset:51712
    s_waitcnt vmcnt(14) lgkmcnt(4)
    v_mfma_f32_32x32x16_bf16 v[16:31], v[192:195], a[96:99], v[16:31]
    ds_read_b64_tr_b16 v[208:209], v2 offset:51200
    buffer_load_dwordx4 a[148:151], v10, s[4:7], s44 offen offset:2048 sc1
    v_mfma_f32_32x32x16_bf16 v[32:47], v[192:195], a[100:103], v[32:47]
    ds_read_b64_tr_b16 v[210:211], v2 offset:51712
    v_mfma_f32_32x32x16_bf16 v[48:63], v[196:199], a[96:99], v[48:63]
    ds_read_b64_tr_b16 v[212:213], v3 offset:13312
    buffer_load_dwordx4 a[152:155], v10, s[4:7], s43 offen offset:3072 sc1
    v_mfma_f32_32x32x16_bf16 v[64:79], v[196:199], a[100:103], v[64:79]
    ds_read_b64_tr_b16 v[214:215], v3 offset:13568
    s_waitcnt lgkmcnt(6)
    v_mfma_f32_32x32x16_bf16 v[144:159], v[200:203], a[100:103], v[144:159]
    ds_read_b64_tr_b16 v[192:193], v1 offset:53248
    ds_read_b64_tr_b16 v[194:195], v1 offset:53760
    buffer_load_dwordx4 a[156:159], v10, s[4:7], s44 offen offset:3072 sc1
    s_waitcnt vmcnt(15) lgkmcnt(4)
    v_mfma_f32_32x32x16_bf16 v[16:31], v[204:207], a[104:107], v[16:31]
    ds_read_b64_tr_b16 v[196:197], v2 offset:53248
    v_mfma_f32_32x32x16_bf16 v[32:47], v[204:207], a[108:111], v[32:47]
    ds_read_b64_tr_b16 v[198:199], v2 offset:53760
    s_add_u32 m0, s45, 139264
    s_add_u32 s50, s46, 3538944
    buffer_load_dwordx4 v7, s[8:11], s50 offen offset:0 lds
    v_mfma_f32_32x32x16_bf16 v[48:63], v[208:211], a[104:107], v[48:63]
    ds_read_b64_tr_b16 v[200:201], v3 offset:14336
    v_mfma_f32_32x32x16_bf16 v[64:79], v[208:211], a[108:111], v[64:79]
    ds_read_b64_tr_b16 v[202:203], v3 offset:14592
    buffer_load_dwordx4 v8, s[8:11], s50 offen offset:1024 lds
    s_waitcnt lgkmcnt(6)
    v_mfma_f32_32x32x16_bf16 v[144:159], v[212:215], a[108:111], v[144:159]
    ds_read_b64_tr_b16 v[204:205], v1 offset:55296
    ds_read_b64_tr_b16 v[206:207], v1 offset:55808
    s_waitcnt vmcnt(12) lgkmcnt(4)
    v_mfma_f32_32x32x16_bf16 v[16:31], v[192:195], a[112:115], v[16:31]
    ds_read_b64_tr_b16 v[208:209], v2 offset:55296
    buffer_load_dwordx4 v9, s[8:11], s50 offen offset:2048 lds
    v_mfma_f32_32x32x16_bf16 v[32:47], v[192:195], a[116:119], v[32:47]
    ds_read_b64_tr_b16 v[210:211], v2 offset:55808
    v_mfma_f32_32x32x16_bf16 v[48:63], v[196:199], a[112:115], v[48:63]
    ds_read_b64_tr_b16 v[212:213], v3 offset:15360
    s_add_u32 m0, s45, 77824
    s_add_u32 s50, s47, 3538944
    buffer_load_dwordx4 v245, s[8:11], s50 offen offset:0 lds
    v_mfma_f32_32x32x16_bf16 v[64:79], v[196:199], a[116:119], v[64:79]
    ds_read_b64_tr_b16 v[214:215], v3 offset:15616
    s_waitcnt lgkmcnt(6)
    v_mfma_f32_32x32x16_bf16 v[144:159], v[200:203], a[116:119], v[144:159]
    ds_read_b64_tr_b16 v[192:193], v1 offset:57344
    ds_read_b64_tr_b16 v[194:195], v1 offset:57856
    s_waitcnt vmcnt(12) lgkmcnt(4)
    v_mfma_f32_32x32x16_bf16 v[16:31], v[204:207], a[120:123], v[16:31]
    ds_read_b64_tr_b16 v[196:197], v2 offset:57344
    buffer_load_dwordx4 v247, s[8:11], s50 offen offset:1024 lds
    v_mfma_f32_32x32x16_bf16 v[32:47], v[204:207], a[124:127], v[32:47]
    ds_read_b64_tr_b16 v[198:199], v2 offset:57856
    v_mfma_f32_32x32x16_bf16 v[48:63], v[208:211], a[120:123], v[48:63]
    ds_read_b64_tr_b16 v[200:201], v3 offset:16384
    buffer_load_dwordx4 v249, s[8:11], s50 offen offset:2048 lds
    v_mfma_f32_32x32x16_bf16 v[64:79], v[208:211], a[124:127], v[64:79]
    ds_read_b64_tr_b16 v[202:203], v3 offset:16640
    s_waitcnt lgkmcnt(6)
    v_mfma_f32_32x32x16_bf16 v[144:159], v[212:215], a[124:127], v[144:159]
    ds_read_b64_tr_b16 v[204:205], v1 offset:59392
    ds_read_b64_tr_b16 v[206:207], v1 offset:59904
    s_add_u32 s43, s43, 4096
    buffer_load_dwordx4 a[160:163], v10, s[4:7], s43 offen offset:0 sc1
    s_waitcnt vmcnt(13) lgkmcnt(4)
    v_mfma_f32_32x32x16_bf16 v[16:31], v[192:195], a[128:131], v[16:31]
    ds_read_b64_tr_b16 v[208:209], v2 offset:59392
    v_mfma_f32_32x32x16_bf16 v[32:47], v[192:195], a[132:135], v[32:47]
    ds_read_b64_tr_b16 v[210:211], v2 offset:59904
    s_add_u32 s44, s44, 4096
    buffer_load_dwordx4 a[164:167], v10, s[4:7], s44 offen offset:0 sc1
    v_mfma_f32_32x32x16_bf16 v[48:63], v[196:199], a[128:131], v[48:63]
    ds_read_b64_tr_b16 v[212:213], v3 offset:17408
    v_mfma_f32_32x32x16_bf16 v[64:79], v[196:199], a[132:135], v[64:79]
    ds_read_b64_tr_b16 v[214:215], v3 offset:17664
    buffer_load_dwordx4 a[168:171], v10, s[4:7], s43 offen offset:1024 sc1
    s_waitcnt lgkmcnt(6)
    v_mfma_f32_32x32x16_bf16 v[144:159], v[200:203], a[132:135], v[144:159]
    s_barrier
    ds_read_b64_tr_b16 v[192:193], v4 offset:0
    ds_read_b64_tr_b16 v[194:195], v4 offset:512
    s_waitcnt vmcnt(13) lgkmcnt(4)
    v_mfma_f32_32x32x16_bf16 v[16:31], v[204:207], a[136:139], v[16:31]
    ds_read_b64_tr_b16 v[196:197], v5 offset:0
    buffer_load_dwordx4 a[172:175], v10, s[4:7], s44 offen offset:1024 sc1
    v_mfma_f32_32x32x16_bf16 v[32:47], v[204:207], a[140:143], v[32:47]
    ds_read_b64_tr_b16 v[198:199], v5 offset:512
    v_mfma_f32_32x32x16_bf16 v[48:63], v[208:211], a[136:139], v[48:63]
    ds_read_b64_tr_b16 v[200:201], v3 offset:18432
    buffer_load_dwordx4 a[176:179], v10, s[4:7], s43 offen offset:2048 sc1
    v_mfma_f32_32x32x16_bf16 v[64:79], v[208:211], a[140:143], v[64:79]
    ds_read_b64_tr_b16 v[202:203], v3 offset:18688
    s_waitcnt lgkmcnt(6)
    v_mfma_f32_32x32x16_bf16 v[144:159], v[212:215], a[140:143], v[144:159]
    ds_read_b64_tr_b16 v[204:205], v4 offset:2048
    ds_read_b64_tr_b16 v[206:207], v4 offset:2560
    buffer_load_dwordx4 a[180:183], v10, s[4:7], s44 offen offset:2048 sc1
    s_waitcnt vmcnt(14) lgkmcnt(4)
    v_mfma_f32_32x32x16_bf16 v[16:31], v[192:195], a[144:147], v[16:31]
    ds_read_b64_tr_b16 v[208:209], v5 offset:2048
    v_mfma_f32_32x32x16_bf16 v[32:47], v[192:195], a[148:151], v[32:47]
    ds_read_b64_tr_b16 v[210:211], v5 offset:2560
    buffer_load_dwordx4 a[184:187], v10, s[4:7], s43 offen offset:3072 sc1
    v_mfma_f32_32x32x16_bf16 v[48:63], v[196:199], a[144:147], v[48:63]
    ds_read_b64_tr_b16 v[212:213], v3 offset:19456
    v_mfma_f32_32x32x16_bf16 v[64:79], v[196:199], a[148:151], v[64:79]
    ds_read_b64_tr_b16 v[214:215], v3 offset:19712
    buffer_load_dwordx4 a[188:191], v10, s[4:7], s44 offen offset:3072 sc1
    s_waitcnt lgkmcnt(6)
    v_mfma_f32_32x32x16_bf16 v[144:159], v[200:203], a[148:151], v[144:159]
    ds_read_b64_tr_b16 v[192:193], v4 offset:4096
    ds_read_b64_tr_b16 v[194:195], v4 offset:4608
    s_waitcnt vmcnt(14) lgkmcnt(4)
    v_mfma_f32_32x32x16_bf16 v[16:31], v[204:207], a[152:155], v[16:31]
    ds_read_b64_tr_b16 v[196:197], v5 offset:4096
    s_add_u32 s43, s43, 4096
    buffer_load_dwordx4 a[192:195], v10, s[4:7], s43 offen offset:0 sc1
    v_mfma_f32_32x32x16_bf16 v[32:47], v[204:207], a[156:159], v[32:47]
    ds_read_b64_tr_b16 v[198:199], v5 offset:4608
    v_mfma_f32_32x32x16_bf16 v[48:63], v[208:211], a[152:155], v[48:63]
    ds_read_b64_tr_b16 v[200:201], v3 offset:20480
    s_add_u32 s44, s44, 4096
    buffer_load_dwordx4 a[196:199], v10, s[4:7], s44 offen offset:0 sc1
    v_mfma_f32_32x32x16_bf16 v[64:79], v[208:211], a[156:159], v[64:79]
    ds_read_b64_tr_b16 v[202:203], v3 offset:20736
    s_waitcnt lgkmcnt(6)
    v_mfma_f32_32x32x16_bf16 v[144:159], v[212:215], a[156:159], v[144:159]
    ds_read_b64_tr_b16 v[204:205], v4 offset:6144
    ds_read_b64_tr_b16 v[206:207], v4 offset:6656
    s_waitcnt vmcnt(8) lgkmcnt(4)
    v_mfma_f32_32x32x16_bf16 v[16:31], v[192:195], a[160:163], v[16:31]
    ds_read_b64_tr_b16 v[208:209], v5 offset:6144
    buffer_load_dwordx4 a[200:203], v10, s[4:7], s43 offen offset:1024 sc1
    v_mfma_f32_32x32x16_bf16 v[32:47], v[192:195], a[164:167], v[32:47]
    ds_read_b64_tr_b16 v[210:211], v5 offset:6656
    v_mfma_f32_32x32x16_bf16 v[48:63], v[196:199], a[160:163], v[48:63]
    ds_read_b64_tr_b16 v[212:213], v3 offset:21504
    buffer_load_dwordx4 a[204:207], v10, s[4:7], s44 offen offset:1024 sc1
    v_mfma_f32_32x32x16_bf16 v[64:79], v[196:199], a[164:167], v[64:79]
    ds_read_b64_tr_b16 v[214:215], v3 offset:21760
    s_waitcnt lgkmcnt(6)
    v_mfma_f32_32x32x16_bf16 v[144:159], v[200:203], a[164:167], v[144:159]
    ds_read_b64_tr_b16 v[192:193], v4 offset:8192
    ds_read_b64_tr_b16 v[194:195], v4 offset:8704
    s_add_u32 m0, s45, 151552
    s_add_u32 s50, s46, 4423680
    buffer_load_dwordx4 v7, s[8:11], s50 offen offset:0 lds
    s_waitcnt vmcnt(9) lgkmcnt(4)
    v_mfma_f32_32x32x16_bf16 v[16:31], v[204:207], a[168:171], v[16:31]
    ds_read_b64_tr_b16 v[196:197], v5 offset:8192
    v_mfma_f32_32x32x16_bf16 v[32:47], v[204:207], a[172:175], v[32:47]
    ds_read_b64_tr_b16 v[198:199], v5 offset:8704
    buffer_load_dwordx4 v8, s[8:11], s50 offen offset:1024 lds
    v_mfma_f32_32x32x16_bf16 v[48:63], v[208:211], a[168:171], v[48:63]
    ds_read_b64_tr_b16 v[200:201], v3 offset:22528
    v_mfma_f32_32x32x16_bf16 v[64:79], v[208:211], a[172:175], v[64:79]
    ds_read_b64_tr_b16 v[202:203], v3 offset:22784
    buffer_load_dwordx4 v9, s[8:11], s50 offen offset:2048 lds
    s_waitcnt lgkmcnt(6)
    v_mfma_f32_32x32x16_bf16 v[144:159], v[212:215], a[172:175], v[144:159]
    ds_read_b64_tr_b16 v[204:205], v4 offset:10240
    ds_read_b64_tr_b16 v[206:207], v4 offset:10752
    s_waitcnt vmcnt(9) lgkmcnt(4)
    v_mfma_f32_32x32x16_bf16 v[16:31], v[192:195], a[176:179], v[16:31]
    ds_read_b64_tr_b16 v[208:209], v5 offset:10240
    buffer_load_dwordx4 a[208:211], v10, s[4:7], s43 offen offset:2048 sc1
    v_mfma_f32_32x32x16_bf16 v[32:47], v[192:195], a[180:183], v[32:47]
    ds_read_b64_tr_b16 v[210:211], v5 offset:10752
    v_mfma_f32_32x32x16_bf16 v[48:63], v[196:199], a[176:179], v[48:63]
    ds_read_b64_tr_b16 v[212:213], v3 offset:23552
    buffer_load_dwordx4 a[212:215], v10, s[4:7], s44 offen offset:2048 sc1
    v_mfma_f32_32x32x16_bf16 v[64:79], v[196:199], a[180:183], v[64:79]
    ds_read_b64_tr_b16 v[214:215], v3 offset:23808
    s_waitcnt lgkmcnt(6)
    v_mfma_f32_32x32x16_bf16 v[144:159], v[200:203], a[180:183], v[144:159]
    s_barrier
    ds_read_b64_tr_b16 v[192:193], v4 offset:12288
    ds_read_b64_tr_b16 v[194:195], v4 offset:12800
    buffer_load_dwordx4 a[216:219], v10, s[4:7], s43 offen offset:3072 sc1
    s_waitcnt vmcnt(10) lgkmcnt(4)
    v_mfma_f32_32x32x16_bf16 v[16:31], v[204:207], a[184:187], v[16:31]
    ds_read_b64_tr_b16 v[196:197], v5 offset:12288
    v_mfma_f32_32x32x16_bf16 v[32:47], v[204:207], a[188:191], v[32:47]
    ds_read_b64_tr_b16 v[198:199], v5 offset:12800
    buffer_load_dwordx4 a[220:223], v10, s[4:7], s44 offen offset:3072 sc1
    v_mfma_f32_32x32x16_bf16 v[48:63], v[208:211], a[184:187], v[48:63]
    ds_read_b64_tr_b16 v[200:201], v3 offset:24576
    v_mfma_f32_32x32x16_bf16 v[64:79], v[208:211], a[188:191], v[64:79]
    ds_read_b64_tr_b16 v[202:203], v3 offset:24832
    s_add_u32 s43, s43, 4096
    buffer_load_dwordx4 a[224:227], v10, s[4:7], s43 offen offset:0 sc1
    s_waitcnt lgkmcnt(6)
    v_mfma_f32_32x32x16_bf16 v[144:159], v[212:215], a[188:191], v[144:159]
    ds_read_b64_tr_b16 v[204:205], v4 offset:14336
    ds_read_b64_tr_b16 v[206:207], v4 offset:14848
    s_waitcnt vmcnt(10) lgkmcnt(4)
    v_mfma_f32_32x32x16_bf16 v[16:31], v[192:195], a[192:195], v[16:31]
    ds_read_b64_tr_b16 v[208:209], v5 offset:14336
    s_add_u32 s44, s44, 4096
    buffer_load_dwordx4 a[228:231], v10, s[4:7], s44 offen offset:0 sc1
    v_mfma_f32_32x32x16_bf16 v[32:47], v[192:195], a[196:199], v[32:47]
    ds_read_b64_tr_b16 v[210:211], v5 offset:14848
    v_mfma_f32_32x32x16_bf16 v[48:63], v[196:199], a[192:195], v[48:63]
    ds_read_b64_tr_b16 v[212:213], v3 offset:25600
    buffer_load_dwordx4 a[232:235], v10, s[4:7], s43 offen offset:1024 sc1
    v_mfma_f32_32x32x16_bf16 v[64:79], v[196:199], a[196:199], v[64:79]
    ds_read_b64_tr_b16 v[214:215], v3 offset:25856
    s_waitcnt lgkmcnt(6)
    v_mfma_f32_32x32x16_bf16 v[144:159], v[200:203], a[196:199], v[144:159]
    ds_read_b64_tr_b16 v[192:193], v4 offset:16384
    ds_read_b64_tr_b16 v[194:195], v4 offset:16896
    s_waitcnt vmcnt(10) lgkmcnt(4)
    v_mfma_f32_32x32x16_bf16 v[16:31], v[204:207], a[200:203], v[16:31]
    ds_read_b64_tr_b16 v[196:197], v5 offset:16384
    buffer_load_dwordx4 a[236:239], v10, s[4:7], s44 offen offset:1024 sc1
    v_mfma_f32_32x32x16_bf16 v[32:47], v[204:207], a[204:207], v[32:47]
    ds_read_b64_tr_b16 v[198:199], v5 offset:16896
    v_mfma_f32_32x32x16_bf16 v[48:63], v[208:211], a[200:203], v[48:63]
    ds_read_b64_tr_b16 v[200:201], v3 offset:26624
    buffer_load_dwordx4 a[240:243], v10, s[4:7], s43 offen offset:2048 sc1
    v_mfma_f32_32x32x16_bf16 v[64:79], v[208:211], a[204:207], v[64:79]
    ds_read_b64_tr_b16 v[202:203], v3 offset:26880
    s_waitcnt lgkmcnt(6)
    v_mfma_f32_32x32x16_bf16 v[144:159], v[212:215], a[204:207], v[144:159]
    ds_read_b64_tr_b16 v[204:205], v4 offset:18432
    ds_read_b64_tr_b16 v[206:207], v4 offset:18944
    buffer_load_dwordx4 a[244:247], v10, s[4:7], s44 offen offset:2048 sc1
    s_waitcnt vmcnt(8) lgkmcnt(4)
    v_mfma_f32_32x32x16_bf16 v[16:31], v[192:195], a[208:211], v[16:31]
    ds_read_b64_tr_b16 v[208:209], v5 offset:18432
    v_mfma_f32_32x32x16_bf16 v[32:47], v[192:195], a[212:215], v[32:47]
    ds_read_b64_tr_b16 v[210:211], v5 offset:18944
    buffer_load_dwordx4 a[248:251], v10, s[4:7], s43 offen offset:3072 sc1
    v_mfma_f32_32x32x16_bf16 v[48:63], v[196:199], a[208:211], v[48:63]
    ds_read_b64_tr_b16 v[212:213], v3 offset:27648
    v_mfma_f32_32x32x16_bf16 v[64:79], v[196:199], a[212:215], v[64:79]
    ds_read_b64_tr_b16 v[214:215], v3 offset:27904
    buffer_load_dwordx4 a[252:255], v10, s[4:7], s44 offen offset:3072 sc1
    s_waitcnt lgkmcnt(6)
    v_mfma_f32_32x32x16_bf16 v[144:159], v[200:203], a[212:215], v[144:159]
    ds_read_b64_tr_b16 v[192:193], v4 offset:20480
    ds_read_b64_tr_b16 v[194:195], v4 offset:20992
    s_waitcnt vmcnt(8) lgkmcnt(4)
    v_mfma_f32_32x32x16_bf16 v[16:31], v[204:207], a[216:219], v[16:31]
    ds_read_b64_tr_b16 v[196:197], v5 offset:20480
    s_add_u32 s43, s43, 4096
    buffer_load_dwordx4 v[160:163], v10, s[4:7], s43 offen offset:0 sc1
    v_mfma_f32_32x32x16_bf16 v[32:47], v[204:207], a[220:223], v[32:47]
    ds_read_b64_tr_b16 v[198:199], v5 offset:20992
    v_mfma_f32_32x32x16_bf16 v[48:63], v[208:211], a[216:219], v[48:63]
    ds_read_b64_tr_b16 v[200:201], v3 offset:28672
    s_add_u32 s44, s44, 4096
    buffer_load_dwordx4 v[164:167], v10, s[4:7], s44 offen offset:0 sc1
    v_mfma_f32_32x32x16_bf16 v[64:79], v[208:211], a[220:223], v[64:79]
    ds_read_b64_tr_b16 v[202:203], v3 offset:28928
    s_waitcnt lgkmcnt(6)
    v_mfma_f32_32x32x16_bf16 v[144:159], v[212:215], a[220:223], v[144:159]
    ds_read_b64_tr_b16 v[204:205], v4 offset:22528
    ds_read_b64_tr_b16 v[206:207], v4 offset:23040
    buffer_load_dwordx4 v[168:171], v10, s[4:7], s43 offen offset:1024 sc1
    s_waitcnt vmcnt(9) lgkmcnt(4)
    v_mfma_f32_32x32x16_bf16 v[16:31], v[192:195], a[224:227], v[16:31]
    ds_read_b64_tr_b16 v[208:209], v5 offset:22528
    v_mfma_f32_32x32x16_bf16 v[32:47], v[192:195], a[228:231], v[32:47]
    ds_read_b64_tr_b16 v[210:211], v5 offset:23040
    buffer_load_dwordx4 v[172:175], v10, s[4:7], s44 offen offset:1024 sc1
    v_mfma_f32_32x32x16_bf16 v[48:63], v[196:199], a[224:227], v[48:63]
    ds_read_b64_tr_b16 v[212:213], v3 offset:29696
    v_mfma_f32_32x32x16_bf16 v[64:79], v[196:199], a[228:231], v[64:79]
    ds_read_b64_tr_b16 v[214:215], v3 offset:29952
    buffer_load_dwordx4 v[176:179], v10, s[4:7], s43 offen offset:2048 sc1
    s_waitcnt lgkmcnt(6)
    v_mfma_f32_32x32x16_bf16 v[144:159], v[200:203], a[228:231], v[144:159]
    s_barrier
    ds_read_b64_tr_b16 v[192:193], v4 offset:24576
    ds_read_b64_tr_b16 v[194:195], v4 offset:25088
    s_waitcnt vmcnt(9) lgkmcnt(4)
    v_mfma_f32_32x32x16_bf16 v[16:31], v[204:207], a[232:235], v[16:31]
    ds_read_b64_tr_b16 v[196:197], v5 offset:24576
    buffer_load_dwordx4 v[180:183], v10, s[4:7], s44 offen offset:2048 sc1
    v_mfma_f32_32x32x16_bf16 v[32:47], v[204:207], a[236:239], v[32:47]
    ds_read_b64_tr_b16 v[198:199], v5 offset:25088
    v_mfma_f32_32x32x16_bf16 v[48:63], v[208:211], a[232:235], v[48:63]
    ds_read_b64_tr_b16 v[200:201], v3 offset:30720
    buffer_load_dwordx4 v[184:187], v10, s[4:7], s43 offen offset:3072 sc1
    v_mfma_f32_32x32x16_bf16 v[64:79], v[208:211], a[236:239], v[64:79]
    ds_read_b64_tr_b16 v[202:203], v3 offset:30976
    s_waitcnt lgkmcnt(6)
    v_mfma_f32_32x32x16_bf16 v[144:159], v[212:215], a[236:239], v[144:159]
    ds_read_b64_tr_b16 v[204:205], v4 offset:26624
    ds_read_b64_tr_b16 v[206:207], v4 offset:27136
    s_waitcnt vmcnt(9) lgkmcnt(4)
    v_mfma_f32_32x32x16_bf16 v[16:31], v[192:195], a[240:243], v[16:31]
    ds_read_b64_tr_b16 v[208:209], v5 offset:26624
    buffer_load_dwordx4 v[188:191], v10, s[4:7], s44 offen offset:3072 sc1
    v_mfma_f32_32x32x16_bf16 v[32:47], v[192:195], a[244:247], v[32:47]
    ds_read_b64_tr_b16 v[210:211], v5 offset:27136
    v_mfma_f32_32x32x16_bf16 v[48:63], v[196:199], a[240:243], v[48:63]
    ds_read_b64_tr_b16 v[212:213], v3 offset:31744
    s_add_u32 m0, s45, 4096
    s_add_u32 s50, s49, 0
    buffer_load_dwordx4 v14, s[12:15], s50 offen offset:0 lds
    v_mfma_f32_32x32x16_bf16 v[64:79], v[196:199], a[244:247], v[64:79]
    ds_read_b64_tr_b16 v[214:215], v3 offset:32000
    s_waitcnt lgkmcnt(6)
    v_mfma_f32_32x32x16_bf16 v[144:159], v[200:203], a[244:247], v[144:159]
    ds_read_b64_tr_b16 v[192:193], v4 offset:28672
    ds_read_b64_tr_b16 v[194:195], v4 offset:29184
    buffer_load_dwordx4 v15, s[12:15], s50 offen offset:1024 lds
    s_waitcnt vmcnt(10) lgkmcnt(4)
    v_mfma_f32_32x32x16_bf16 v[16:31], v[204:207], a[248:251], v[16:31]
    ds_read_b64_tr_b16 v[196:197], v5 offset:28672
    v_mfma_f32_32x32x16_bf16 v[32:47], v[204:207], a[252:255], v[32:47]
    ds_read_b64_tr_b16 v[198:199], v5 offset:29184
    buffer_load_dwordx4 v223, s[12:15], s50 offen offset:2048 lds
    v_mfma_f32_32x32x16_bf16 v[48:63], v[208:211], a[248:251], v[48:63]
    ds_read_b64_tr_b16 v[200:201], v3 offset:32768
    v_mfma_f32_32x32x16_bf16 v[64:79], v[208:211], a[252:255], v[64:79]
    ds_read_b64_tr_b16 v[202:203], v3 offset:33024
    s_add_u32 m0, s45, 16384
    s_add_u32 s50, s49, 331776
    buffer_load_dwordx4 v14, s[12:15], s50 offen offset:0 lds
    s_waitcnt lgkmcnt(6)
    v_mfma_f32_32x32x16_bf16 v[144:159], v[212:215], a[252:255], v[144:159]
    ds_read_b64_tr_b16 v[204:205], v4 offset:30720
    ds_read_b64_tr_b16 v[206:207], v4 offset:31232
    s_waitcnt vmcnt(10) lgkmcnt(4)
    v_mfma_f32_32x32x16_bf16 v[16:31], v[192:195], v[160:163], v[16:31]
    ds_read_b64_tr_b16 v[208:209], v5 offset:30720
    buffer_load_dwordx4 v15, s[12:15], s50 offen offset:1024 lds
    v_mfma_f32_32x32x16_bf16 v[32:47], v[192:195], v[164:167], v[32:47]
    ds_read_b64_tr_b16 v[210:211], v5 offset:31232
    v_mfma_f32_32x32x16_bf16 v[48:63], v[196:199], v[160:163], v[48:63]
    ds_read_b64_tr_b16 v[212:213], v3 offset:33792
    buffer_load_dwordx4 v223, s[12:15], s50 offen offset:2048 lds
    v_mfma_f32_32x32x16_bf16 v[64:79], v[196:199], v[164:167], v[64:79]
    ds_read_b64_tr_b16 v[214:215], v3 offset:34048
    s_waitcnt lgkmcnt(6)
    v_mfma_f32_32x32x16_bf16 v[144:159], v[200:203], v[164:167], v[144:159]
    ds_read_b64_tr_b16 v[192:193], v4 offset:32768
    ds_read_b64_tr_b16 v[194:195], v4 offset:33280
    s_add_u32 m0, s45, 28672
    s_add_u32 s50, s49, 663552
    buffer_load_dwordx4 v14, s[12:15], s50 offen offset:0 lds
    s_waitcnt vmcnt(11) lgkmcnt(4)
    v_mfma_f32_32x32x16_bf16 v[16:31], v[204:207], v[168:171], v[16:31]
    ds_read_b64_tr_b16 v[196:197], v5 offset:32768
    v_mfma_f32_32x32x16_bf16 v[32:47], v[204:207], v[172:175], v[32:47]
    ds_read_b64_tr_b16 v[198:199], v5 offset:33280
    buffer_load_dwordx4 v15, s[12:15], s50 offen offset:1024 lds
    v_mfma_f32_32x32x16_bf16 v[48:63], v[208:211], v[168:171], v[48:63]
    ds_read_b64_tr_b16 v[200:201], v3 offset:34816
    v_mfma_f32_32x32x16_bf16 v[64:79], v[208:211], v[172:175], v[64:79]
    ds_read_b64_tr_b16 v[202:203], v3 offset:35072
    buffer_load_dwordx4 v223, s[12:15], s50 offen offset:2048 lds
    s_waitcnt lgkmcnt(6)
    v_mfma_f32_32x32x16_bf16 v[144:159], v[212:215], v[172:175], v[144:159]
    ds_read_b64_tr_b16 v[204:205], v4 offset:34816
    ds_read_b64_tr_b16 v[206:207], v4 offset:35328
    v_subrev_u32 v245, 61440, v1
    v_subrev_u32 v247, 61440, v2
    s_waitcnt vmcnt(11) lgkmcnt(4)
    v_mfma_f32_32x32x16_bf16 v[16:31], v[192:195], v[176:179], v[16:31]
    ds_read_b64_tr_b16 v[208:209], v5 offset:34816
    s_add_u32 m0, s45, 40960
    s_add_u32 s50, s49, 995328
    buffer_load_dwordx4 v14, s[12:15], s50 offen offset:0 lds
    v_mfma_f32_32x32x16_bf16 v[32:47], v[192:195], v[180:183], v[32:47]
    ds_read_b64_tr_b16 v[210:211], v5 offset:35328
    v_mfma_f32_32x32x16_bf16 v[48:63], v[196:199], v[176:179], v[48:63]
    ds_read_b64_tr_b16 v[212:213], v3 offset:35840
    buffer_load_dwordx4 v15, s[12:15], s50 offen offset:1024 lds
    v_mfma_f32_32x32x16_bf16 v[64:79], v[196:199], v[180:183], v[64:79]
    ds_read_b64_tr_b16 v[214:215], v3 offset:36096
    s_waitcnt lgkmcnt(6)
    v_mfma_f32_32x32x16_bf16 v[144:159], v[200:203], v[180:183], v[144:159]
    s_waitcnt vmcnt(8)
    s_barrier
    ds_read_b64_tr_b16 v[192:193], v245 offset:0
    ds_read_b64_tr_b16 v[194:195], v245 offset:512
    s_waitcnt lgkmcnt(4)
    v_mfma_f32_32x32x16_bf16 v[16:31], v[204:207], v[184:187], v[16:31]
    ds_read_b64_tr_b16 v[196:197], v245 offset:2048
    buffer_load_dwordx4 v223, s[12:15], s50 offen offset:2048 lds
    v_mfma_f32_32x32x16_bf16 v[32:47], v[204:207], v[188:191], v[32:47]
    ds_read_b64_tr_b16 v[198:199], v245 offset:2560
    v_mfma_f32_32x32x16_bf16 v[48:63], v[208:211], v[184:187], v[48:63]
    ds_read_b64_tr_b16 v[200:201], v245 offset:4096
    s_add_u32 m0, s45, 53248
    s_add_u32 s50, s49, 1327104
    buffer_load_dwordx4 v14, s[12:15], s50 offen offset:0 lds
    v_mfma_f32_32x32x16_bf16 v[64:79], v[208:211], v[188:191], v[64:79]
    ds_read_b64_tr_b16 v[202:203], v245 offset:4608
    s_waitcnt lgkmcnt(6)
    v_mfma_f32_32x32x16_bf16 v[144:159], v[212:215], v[188:191], v[144:159]
    ds_read_b64_tr_b16 v[204:205], v245 offset:6144
    ds_read_b64_tr_b16 v[206:207], v245 offset:6656
    buffer_load_dwordx4 v15, s[12:15], s50 offen offset:1024 lds
    s_waitcnt lgkmcnt(4)
    v_mfma_f32_32x32x16_bf16 v[80:95], v[192:195], a[0:3], 0
    ds_read_b64_tr_b16 v[208:209], v245 offset:8192
    v_mfma_f32_32x32x16_bf16 v[96:111], v[192:195], a[4:7], 0
    ds_read_b64_tr_b16 v[210:211], v245 offset:8704
    buffer_load_dwordx4 v223, s[12:15], s50 offen offset:2048 lds
    v_mfma_f32_32x32x16_bf16 v[80:95], v[196:199], a[8:11], v[80:95]
    ds_read_b64_tr_b16 v[212:213], v245 offset:10240
    v_add_u32 v222, 0, v255
    global_load_dword v254, v222, s[84:85]
    v_fma_f32 v224, -v16, v16, -s52
    v_fma_f32 v225, -v17, v17, -s52
    v_fma_f32 v226, -v18, v18, -s52
    v_fma_f32 v227, -v19, v19, -s52
    v_mul_f32 v224, v224, v16
    v_mul_f32 v225, v225, v17
    v_mfma_f32_32x32x16_bf16 v[96:111], v[196:199], a[12:15], v[96:111]
    ds_read_b64_tr_b16 v[214:215], v245 offset:10752
    s_add_u32 m0, s45, 65536
    s_add_u32 s50, s49, 1658880
    buffer_load_dwordx4 v14, s[12:15], s50 offen offset:0 lds
    v_mul_f32 v226, v226, v18
    v_mul_f32 v227, v227, v19
    v_exp_f32 v224, v224
    s_waitcnt lgkmcnt(4)
    v_mfma_f32_32x32x16_bf16 v[80:95], v[200:203], a[16:19], v[80:95]
    s_waitcnt vmcnt(11)
    s_barrier
    ds_read_b64_tr_b16 v[192:193], v245 offset:12288
    v_exp_f32 v225, v225
    v_exp_f32 v226, v226
    v_exp_f32 v227, v227
    v_mfma_f32_32x32x16_bf16 v[96:111], v[200:203], a[20:23], v[96:111]
    ds_read_b64_tr_b16 v[194:195], v245 offset:12800
    buffer_load_dwordx4 v15, s[12:15], s50 offen offset:1024 lds
    v_add_f32 v224, 1.0, v224
    v_add_f32 v225, 1.0, v225
    v_add_f32 v226, 1.0, v226
    v_add_f32 v227, 1.0, v227
    v_rcp_f32 v224, v224
    v_mfma_f32_32x32x16_bf16 v[80:95], v[204:207], a[24:27], v[80:95]
    ds_read_b64_tr_b16 v[196:197], v245 offset:14336
    v_rcp_f32 v225, v225
    v_rcp_f32 v226, v226
    v_rcp_f32 v227, v227
    v_mul_f32 v224, v224, v16
    v_mul_f32 v225, v225, v17
    v_mul_f32 v226, v226, v18
    v_mfma_f32_32x32x16_bf16 v[96:111], v[204:207], a[28:31], v[96:111]
    ds_read_b64_tr_b16 v[198:199], v245 offset:14848
    buffer_load_dwordx4 v223, s[12:15], s50 offen offset:2048 lds
    v_mul_f32 v227, v227, v19
    v_add_f32 v216, v216, v224
    v_fmac_f32 v217, v224, v224
    v_add_f32 v216, v216, v225
    v_fmac_f32 v217, v225, v225
    v_add_f32 v216, v216, v226
    s_waitcnt lgkmcnt(4)
    v_mfma_f32_32x32x16_bf16 v[80:95], v[208:211], a[32:35], v[80:95]
    ds_read_b64_tr_b16 v[200:201], v245 offset:16384
    v_fmac_f32 v217, v226, v226
    v_add_f32 v216, v216, v227
    v_fmac_f32 v217, v227, v227
    v_cvt_pk_bf16_f32 v16, v224, v225
    v_cvt_pk_bf16_f32 v17, v226, v227
    v_fma_f32 v228, -v20, v20, -s52
    v_fma_f32 v229, -v21, v21, -s52
    v_fma_f32 v230, -v22, v22, -s52
    v_mfma_f32_32x32x16_bf16 v[96:111], v[208:211], a[36:39], v[96:111]
    ds_read_b64_tr_b16 v[202:203], v245 offset:16896
    v_fma_f32 v231, -v23, v23, -s52
    v_mul_f32 v228, v228, v20
    v_mul_f32 v229, v229, v21
    v_mul_f32 v230, v230, v22
    v_mul_f32 v231, v231, v23
    v_exp_f32 v228, v228
    v_mfma_f32_32x32x16_bf16 v[80:95], v[212:215], a[40:43], v[80:95]
    ds_read_b64_tr_b16 v[204:205], v245 offset:18432
    v_exp_f32 v229, v229
    v_exp_f32 v230, v230
    v_exp_f32 v231, v231
    v_add_f32 v228, 1.0, v228
    v_add_f32 v229, 1.0, v229
    v_add_f32 v230, 1.0, v230
    v_mfma_f32_32x32x16_bf16 v[96:111], v[212:215], a[44:47], v[96:111]
    ds_read_b64_tr_b16 v[206:207], v245 offset:18944
    v_add_f32 v231, 1.0, v231
    v_rcp_f32 v228, v228
    v_rcp_f32 v229, v229
    v_rcp_f32 v230, v230
    s_waitcnt lgkmcnt(4)
    v_mfma_f32_32x32x16_bf16 v[80:95], v[192:195], a[48:51], v[80:95]
    ds_read_b64_tr_b16 v[208:209], v245 offset:20480
    v_rcp_f32 v231, v231
    v_mul_f32 v228, v228, v20
    v_mul_f32 v229, v229, v21
    v_mul_f32 v230, v230, v22
    v_mul_f32 v231, v231, v23
    v_add_f32 v216, v216, v228
    v_fmac_f32 v217, v228, v228
    v_mfma_f32_32x32x16_bf16 v[96:111], v[192:195], a[52:55], v[96:111]
    ds_read_b64_tr_b16 v[210:211], v245 offset:20992
    s_add_u32 m0, s45, 90112
    s_add_u32 s50, s48, 0
    buffer_load_dwordx4 v7, s[8:11], s50 offen offset:0 lds
    v_add_f32 v216, v216, v229
    v_fmac_f32 v217, v229, v229
    v_add_f32 v216, v216, v230
    v_fmac_f32 v217, v230, v230
    v_add_f32 v216, v216, v231
    v_mfma_f32_32x32x16_bf16 v[80:95], v[196:199], a[56:59], v[80:95]
    ds_read_b64_tr_b16 v[212:213], v245 offset:22528
    v_fmac_f32 v217, v231, v231
    v_cvt_pk_bf16_f32 v18, v228, v229
    v_cvt_pk_bf16_f32 v19, v230, v231
    v_add_u32 v222, 2097152, v255
    global_load_dword v254, v222, s[84:85]
    v_fma_f32 v224, -v24, v24, -s52
    v_fma_f32 v225, -v25, v25, -s52
    v_fma_f32 v226, -v26, v26, -s52
    v_mfma_f32_32x32x16_bf16 v[96:111], v[196:199], a[60:63], v[96:111]
    ds_read_b64_tr_b16 v[214:215], v245 offset:23040
    v_fma_f32 v227, -v27, v27, -s52
    v_mul_f32 v224, v224, v24
    v_mul_f32 v225, v225, v25
    v_mul_f32 v226, v226, v26
    v_mul_f32 v227, v227, v27
    v_exp_f32 v224, v224
    s_waitcnt lgkmcnt(4)
    v_mfma_f32_32x32x16_bf16 v[80:95], v[200:203], a[64:67], v[80:95]
    s_waitcnt vmcnt(9)
    s_barrier
    ds_read_b64_tr_b16 v[192:193], v245 offset:24576
    v_exp_f32 v225, v225
    v_exp_f32 v226, v226
    v_exp_f32 v227, v227
    v_mfma_f32_32x32x16_bf16 v[96:111], v[200:203], a[68:71], v[96:111]
    ds_read_b64_tr_b16 v[194:195], v245 offset:25088
    v_add_f32 v224, 1.0, v224
    v_add_f32 v225, 1.0, v225
    v_add_f32 v226, 1.0, v226
    v_add_f32 v227, 1.0, v227
    v_rcp_f32 v224, v224
    v_rcp_f32 v225, v225
    v_mfma_f32_32x32x16_bf16 v[80:95], v[204:207], a[72:75], v[80:95]
    ds_read_b64_tr_b16 v[196:197], v245 offset:26624
    v_rcp_f32 v226, v226
    v_rcp_f32 v227, v227
    v_mul_f32 v224, v224, v24
    v_mul_f32 v225, v225, v25
    v_mul_f32 v226, v226, v26
    v_mul_f32 v227, v227, v27
    v_mfma_f32_32x32x16_bf16 v[96:111], v[204:207], a[76:79], v[96:111]
    ds_read_b64_tr_b16 v[198:199], v245 offset:27136
    buffer_load_dwordx4 v8, s[8:11], s50 offen offset:1024 lds
    v_add_f32 v216, v216, v224
    v_fmac_f32 v217, v224, v224
    v_add_f32 v216, v216, v225
    v_fmac_f32 v217, v225, v225
    v_add_f32 v216, v216, v226
    v_fmac_f32 v217, v226, v226
    s_waitcnt lgkmcnt(4)
    v_mfma_f32_32x32x16_bf16 v[80:95], v[208:211], a[80:83], v[80:95]
    ds_read_b64_tr_b16 v[200:201], v245 offset:28672
    v_add_f32 v216, v216, v227
    v_fmac_f32 v217, v227, v227
    v_cvt_pk_bf16_f32 v20, v224, v225
    v_cvt_pk_bf16_f32 v21, v226, v227
    v_fma_f32 v228, -v28, v28, -s52
    v_fma_f32 v229, -v29, v29, -s52
    v_fma_f32 v230, -v30, v30, -s52
    v_fma_f32 v231, -v31, v31, -s52
    v_mfma_f32_32x32x16_bf16 v[96:111], v[208:211], a[84:87], v[96:111]
    ds_read_b64_tr_b16 v[202:203], v245 offset:29184
    v_mul_f32 v228, v228, v28
    v_mul_f32 v229, v229, v29
    v_mul_f32 v230, v230, v30
    v_mul_f32 v231, v231, v31
    v_exp_f32 v228, v228
    v_exp_f32 v229, v229
    v_mfma_f32_32x32x16_bf16 v[80:95], v[212:215], a[88:91], v[80:95]
    ds_read_b64_tr_b16 v[204:205], v245 offset:30720
    v_exp_f32 v230, v230
    v_exp_f32 v231, v231
    v_add_f32 v228, 1.0, v228
    v_add_f32 v229, 1.0, v229
    v_add_f32 v230, 1.0, v230
    v_add_f32 v231, 1.0, v231
    v_mfma_f32_32x32x16_bf16 v[96:111], v[212:215], a[92:95], v[96:111]
    ds_read_b64_tr_b16 v[206:207], v245 offset:31232
    v_rcp_f32 v228, v228
    v_rcp_f32 v229, v229
    v_rcp_f32 v230, v230
    s_waitcnt lgkmcnt(4)
    v_mfma_f32_32x32x16_bf16 v[80:95], v[192:195], a[96:99], v[80:95]
    ds_read_b64_tr_b16 v[208:209], v245 offset:32768
    v_rcp_f32 v231, v231
    v_mul_f32 v228, v228, v28
    v_mul_f32 v229, v229, v29
    v_mul_f32 v230, v230, v30
    v_mul_f32 v231, v231, v31
    v_add_f32 v216, v216, v228
    v_fmac_f32 v217, v228, v228
    v_add_f32 v216, v216, v229
    v_mfma_f32_32x32x16_bf16 v[96:111], v[192:195], a[100:103], v[96:111]
    ds_read_b64_tr_b16 v[210:211], v245 offset:33280
    buffer_load_dwordx4 v9, s[8:11], s50 offen offset:2048 lds
    v_fmac_f32 v217, v229, v229
    v_add_f32 v216, v216, v230
    v_fmac_f32 v217, v230, v230
    v_add_f32 v216, v216, v231
    v_fmac_f32 v217, v231, v231
    v_cvt_pk_bf16_f32 v22, v228, v229
    v_cvt_pk_bf16_f32 v23, v230, v231
    v_mfma_f32_32x32x16_bf16 v[80:95], v[196:199], a[104:107], v[80:95]
    ds_read_b64_tr_b16 v[212:213], v245 offset:34816
    v_add_u32 v222, 4194304, v255
    global_load_dword v254, v222, s[84:85]
    v_fma_f32 v224, -v32, v32, -s52
    v_fma_f32 v225, -v33, v33, -s52
    v_fma_f32 v226, -v34, v34, -s52
    v_fma_f32 v227, -v35, v35, -s52
    v_mul_f32 v224, v224, v32
    v_mul_f32 v225, v225, v33
    v_mfma_f32_32x32x16_bf16 v[96:111], v[196:199], a[108:111], v[96:111]
    ds_read_b64_tr_b16 v[214:215], v245 offset:35328
    v_mul_f32 v226, v226, v34
    v_mul_f32 v227, v227, v35
    v_exp_f32 v224, v224
    v_exp_f32 v225, v225
    s_waitcnt lgkmcnt(4)
    v_mfma_f32_32x32x16_bf16 v[80:95], v[200:203], a[112:115], v[80:95]
    ds_read_b64_tr_b16 v[192:193], v245 offset:36864
    v_exp_f32 v226, v226
    v_exp_f32 v227, v227
    v_add_f32 v224, 1.0, v224
    v_add_f32 v225, 1.0, v225
    v_add_f32 v226, 1.0, v226
    v_add_f32 v227, 1.0, v227
    v_mfma_f32_32x32x16_bf16 v[96:111], v[200:203], a[116:119], v[96:111]
    ds_read_b64_tr_b16 v[194:195], v245 offset:37376
    v_rcp_f32 v224, v224
    v_rcp_f32 v225, v225
    v_rcp_f32 v226, v226
    v_rcp_f32 v227, v227
    v_mul_f32 v224, v224, v32
    v_mfma_f32_32x32x16_bf16 v[80:95], v[204:207], a[120:123], v[80:95]
    ds_read_b64_tr_b16 v[196:197], v245 offset:38912
    v_mul_f32 v225, v225, v33
    v_mul_f32 v226, v226, v34
    v_mul_f32 v227, v227, v35
    v_add_f32 v218, v218, v224
    v_fmac_f32 v219, v224, v224
    v_add_f32 v218, v218, v225
    v_fmac_f32 v219, v225, v225
    v_add_f32 v218, v218, v226
    v_mfma_f32_32x32x16_bf16 v[96:111], v[204:207], a[124:127], v[96:111]
    ds_read_b64_tr_b16 v[198:199], v245 offset:39424
    s_add_u32 m0, s45, 102400
    s_add_u32 s50, s48, 884736
    buffer_load_dwordx4 v7, s[8:11], s50 offen offset:0 lds
    v_fmac_f32 v219, v226, v226
    v_add_f32 v218, v218, v227
    v_fmac_f32 v219, v227, v227
    v_cvt_pk_bf16_f32 v24, v224, v225
    s_waitcnt lgkmcnt(4)
    v_mfma_f32_32x32x16_bf16 v[80:95], v[208:211], a[128:131], v[80:95]
    ds_read_b64_tr_b16 v[200:201], v245 offset:40960
    v_cvt_pk_bf16_f32 v25, v226, v227
    v_fma_f32 v228, -v36, v36, -s52
    v_fma_f32 v229, -v37, v37, -s52
    v_fma_f32 v230, -v38, v38, -s52
    v_fma_f32 v231, -v39, v39, -s52
    v_mul_f32 v228, v228, v36
    v_mul_f32 v229, v229, v37
    v_mul_f32 v230, v230, v38
    v_mfma_f32_32x32x16_bf16 v[96:111], v[208:211], a[132:135], v[96:111]
    ds_read_b64_tr_b16 v[202:203], v245 offset:41472
    v_mul_f32 v231, v231, v39
    v_exp_f32 v228, v228
    v_exp_f32 v229, v229
    v_exp_f32 v230, v230
    v_mfma_f32_32x32x16_bf16 v[80:95], v[212:215], a[136:139], v[80:95]
    ds_read_b64_tr_b16 v[204:205], v245 offset:43008
    v_exp_f32 v231, v231
    v_add_f32 v228, 1.0, v228
    v_add_f32 v229, 1.0, v229
    v_add_f32 v230, 1.0, v230
    v_add_f32 v231, 1.0, v231
    v_rcp_f32 v228, v228
    v_mfma_f32_32x32x16_bf16 v[96:111], v[212:215], a[140:143], v[96:111]
    ds_read_b64_tr_b16 v[206:207], v245 offset:43520
    v_rcp_f32 v229, v229
    v_rcp_f32 v230, v230
    v_rcp_f32 v231, v231
    v_mul_f32 v228, v228, v36
    v_mul_f32 v229, v229, v37
    s_waitcnt lgkmcnt(4)
    v_mfma_f32_32x32x16_bf16 v[80:95], v[192:195], a[144:147], v[80:95]
    ds_read_b64_tr_b16 v[208:209], v245 offset:45056
    v_mul_f32 v230, v230, v38
    v_mul_f32 v231, v231, v39
    v_add_f32 v218, v218, v228
    v_fmac_f32 v219, v228, v228
    v_add_f32 v218, v218, v229
    v_fmac_f32 v219, v229, v229
    v_add_f32 v218, v218, v230
    v_fmac_f32 v219, v230, v230
    v_mfma_f32_32x32x16_bf16 v[96:111], v[192:195], a[148:151], v[96:111]
    ds_read_b64_tr_b16 v[210:211], v245 offset:45568
    buffer_load_dwordx4 v8, s[8:11], s50 offen offset:1024 lds
    v_add_f32 v218, v218, v231
    v_fmac_f32 v219, v231, v231
    v_cvt_pk_bf16_f32 v26, v228, v229
    v_cvt_pk_bf16_f32 v27, v230, v231
    v_add_u32 v222, 6291456, v255
    global_load_dword v254, v222, s[84:85]
    v_fma_f32 v224, -v40, v40, -s52
    v_mfma_f32_32x32x16_bf16 v[80:95], v[196:199], a[152:155], v[80:95]
    ds_read_b64_tr_b16 v[212:213], v245 offset:47104
    v_fma_f32 v225, -v41, v41, -s52
    v_fma_f32 v226, -v42, v42, -s52
    v_fma_f32 v227, -v43, v43, -s52
    v_mul_f32 v224, v224, v40
    v_mul_f32 v225, v225, v41
    v_mul_f32 v226, v226, v42
    v_mul_f32 v227, v227, v43
    v_mfma_f32_32x32x16_bf16 v[96:111], v[196:199], a[156:159], v[96:111]
    ds_read_b64_tr_b16 v[214:215], v245 offset:47616
    v_exp_f32 v224, v224
    v_exp_f32 v225, v225
    v_exp_f32 v226, v226
    v_exp_f32 v227, v227
    s_waitcnt lgkmcnt(4)
    v_mfma_f32_32x32x16_bf16 v[80:95], v[200:203], a[160:163], v[80:95]
    s_waitcnt vmcnt(8)
    s_barrier
    ds_read_b64_tr_b16 v[192:193], v245 offset:49152
    v_add_f32 v224, 1.0, v224
    v_add_f32 v225, 1.0, v225
    v_add_f32 v226, 1.0, v226
    v_add_f32 v227, 1.0, v227
    v_rcp_f32 v224, v224
    v_mfma_f32_32x32x16_bf16 v[96:111], v[200:203], a[164:167], v[96:111]
    ds_read_b64_tr_b16 v[194:195], v245 offset:49664
    v_rcp_f32 v225, v225
    v_rcp_f32 v226, v226
    v_rcp_f32 v227, v227
    v_mul_f32 v224, v224, v40
    v_mul_f32 v225, v225, v41
    v_mfma_f32_32x32x16_bf16 v[80:95], v[204:207], a[168:171], v[80:95]
    ds_read_b64_tr_b16 v[196:197], v245 offset:51200
    v_mul_f32 v226, v226, v42
    v_mul_f32 v227, v227, v43
    v_add_f32 v218, v218, v224
    v_fmac_f32 v219, v224, v224
    v_add_f32 v218, v218, v225
    v_fmac_f32 v219, v225, v225
    v_add_f32 v218, v218, v226
    v_fmac_f32 v219, v226, v226
    v_mfma_f32_32x32x16_bf16 v[96:111], v[204:207], a[172:175], v[96:111]
    ds_read_b64_tr_b16 v[198:199], v245 offset:51712
    buffer_load_dwordx4 v9, s[8:11], s50 offen offset:2048 lds
    v_add_f32 v218, v218, v227
    v_fmac_f32 v219, v227, v227
    v_cvt_pk_bf16_f32 v28, v224, v225
    v_cvt_pk_bf16_f32 v29, v226, v227
    v_fma_f32 v228, -v44, v44, -s52
    v_fma_f32 v229, -v45, v45, -s52
    s_waitcnt lgkmcnt(4)
    v_mfma_f32_32x32x16_bf16 v[80:95], v[208:211], a[176:179], v[80:95]
    ds_read_b64_tr_b16 v[200:201], v245 offset:53248
    v_fma_f32 v230, -v46, v46, -s52
    v_fma_f32 v231, -v47, v47, -s52
    v_mul_f32 v228, v228, v44
    v_mul_f32 v229, v229, v45
    v_mul_f32 v230, v230, v46
    v_mul_f32 v231, v231, v47
    v_exp_f32 v228, v228
    v_mfma_f32_32x32x16_bf16 v[96:111], v[208:211], a[180:183], v[96:111]
    ds_read_b64_tr_b16 v[202:203], v245 offset:53760
    v_exp_f32 v229, v229
    v_exp_f32 v230, v230
    v_exp_f32 v231, v231
    v_add_f32 v228, 1.0, v228
    v_add_f32 v229, 1.0, v229
    v_mfma_f32_32x32x16_bf16 v[80:95], v[212:215], a[184:187], v[80:95]
    ds_read_b64_tr_b16 v[204:205], v245 offset:55296
    v_add_f32 v230, 1.0, v230
    v_add_f32 v231, 1.0, v231
    v_rcp_f32 v228, v228
    v_rcp_f32 v229, v229
    v_rcp_f32 v230, v230
    v_mfma_f32_32x32x16_bf16 v[96:111], v[212:215], a[188:191], v[96:111]
    ds_read_b64_tr_b16 v[206:207], v245 offset:55808
    v_rcp_f32 v231, v231
    v_mul_f32 v228, v228, v44
    v_mul_f32 v229, v229, v45
    v_mul_f32 v230, v230, v46
    v_mul_f32 v231, v231, v47
    v_add_f32 v218, v218, v228
    s_waitcnt lgkmcnt(4)
    v_mfma_f32_32x32x16_bf16 v[80:95], v[192:195], a[192:195], v[80:95]
    ds_read_b64_tr_b16 v[208:209], v245 offset:57344
    v_fmac_f32 v219, v228, v228
    v_add_f32 v218, v218, v229
    v_fmac_f32 v219, v229, v229
    v_add_f32 v218, v218, v230
    v_fmac_f32 v219, v230, v230
    v_add_f32 v218, v218, v231
    v_fmac_f32 v219, v231, v231
    v_cvt_pk_bf16_f32 v30, v228, v229
    v_mfma_f32_32x32x16_bf16 v[96:111], v[192:195], a[196:199], v[96:111]
    ds_read_b64_tr_b16 v[210:211], v245 offset:57856
    s_add_u32 m0, s45, 114688
    s_add_u32 s50, s48, 1769472
    buffer_load_dwordx4 v7, s[8:11], s50 offen offset:0 lds
    v_cvt_pk_bf16_f32 v31, v230, v231
    global_load_dword v254, v255, s[86:87]
    v_fma_f32 v224, -v48, v48, -s52
    v_fma_f32 v225, -v49, v49, -s52
    v_fma_f32 v226, -v50, v50, -s52
    v_mfma_f32_32x32x16_bf16 v[80:95], v[196:199], a[200:203], v[80:95]
    ds_read_b64_tr_b16 v[212:213], v245 offset:59392
    v_fma_f32 v227, -v51, v51, -s52
    v_mul_f32 v224, v224, v48
    v_mul_f32 v225, v225, v49
    v_mul_f32 v226, v226, v50
    v_mul_f32 v227, v227, v51
    v_exp_f32 v224, v224
    v_mfma_f32_32x32x16_bf16 v[96:111], v[196:199], a[204:207], v[96:111]
    ds_read_b64_tr_b16 v[214:215], v245 offset:59904
    v_exp_f32 v225, v225
    v_exp_f32 v226, v226
    v_exp_f32 v227, v227
    v_add_f32 v224, 1.0, v224
    v_add_f32 v225, 1.0, v225
    s_waitcnt lgkmcnt(4)
    v_mfma_f32_32x32x16_bf16 v[80:95], v[200:203], a[208:211], v[80:95]
    ds_read_b64_tr_b16 v[192:193], v1 offset:0
    v_add_f32 v226, 1.0, v226
    v_add_f32 v227, 1.0, v227
    v_rcp_f32 v224, v224
    v_rcp_f32 v225, v225
    v_rcp_f32 v226, v226
    v_mfma_f32_32x32x16_bf16 v[96:111], v[200:203], a[212:215], v[96:111]
    ds_read_b64_tr_b16 v[194:195], v1 offset:512
    v_rcp_f32 v227, v227
    v_mul_f32 v224, v224, v48
    v_mul_f32 v225, v225, v49
    v_mul_f32 v226, v226, v50
    v_mul_f32 v227, v227, v51
    v_add_f32 v216, v216, v224
    v_fmac_f32 v217, v224, v224
    v_mfma_f32_32x32x16_bf16 v[80:95], v[204:207], a[216:219], v[80:95]
    ds_read_b64_tr_b16 v[196:197], v1 offset:2048
    v_add_f32 v216, v216, v225
    v_fmac_f32 v217, v225, v225
    v_add_f32 v216, v216, v226
    v_fmac_f32 v217, v226, v226
    v_add_f32 v216, v216, v227
    v_fmac_f32 v217, v227, v227
    v_cvt_pk_bf16_f32 v32, v224, v225
    v_cvt_pk_bf16_f32 v33, v226, v227
    v_mfma_f32_32x32x16_bf16 v[96:111], v[204:207], a[220:223], v[96:111]
    ds_read_b64_tr_b16 v[198:199], v1 offset:2560
    buffer_load_dwordx4 v8, s[8:11], s50 offen offset:1024 lds
    v_fma_f32 v228, -v52, v52, -s52
    v_fma_f32 v229, -v53, v53, -s52
    v_fma_f32 v230, -v54, v54, -s52
    v_fma_f32 v231, -v55, v55, -s52
    v_mul_f32 v228, v228, v52
    v_mul_f32 v229, v229, v53
    s_waitcnt lgkmcnt(4)
    v_mfma_f32_32x32x16_bf16 v[80:95], v[208:211], a[224:227], v[80:95]
    ds_read_b64_tr_b16 v[200:201], v1 offset:4096
    v_mul_f32 v230, v230, v54
    v_mul_f32 v231, v231, v55
    v_exp_f32 v228, v228
    v_exp_f32 v229, v229
    v_exp_f32 v230, v230
    v_mfma_f32_32x32x16_bf16 v[96:111], v[208:211], a[228:231], v[96:111]
    ds_read_b64_tr_b16 v[202:203], v1 offset:4608
    v_exp_f32 v231, v231
    v_add_f32 v228, 1.0, v228
    v_add_f32 v229, 1.0, v229
    v_add_f32 v230, 1.0, v230
    v_add_f32 v231, 1.0, v231
    v_rcp_f32 v228, v228
    v_mfma_f32_32x32x16_bf16 v[80:95], v[212:215], a[232:235], v[80:95]
    ds_read_b64_tr_b16 v[204:205], v1 offset:6144
    v_rcp_f32 v229, v229
    v_rcp_f32 v230, v230
    v_rcp_f32 v231, v231
    v_mul_f32 v228, v228, v52
    v_mul_f32 v229, v229, v53
    v_mfma_f32_32x32x16_bf16 v[96:111], v[212:215], a[236:239], v[96:111]
    ds_read_b64_tr_b16 v[206:207], v1 offset:6656
    v_mul_f32 v230, v230, v54
    v_mul_f32 v231, v231, v55
    v_add_f32 v216, v216, v228
    v_fmac_f32 v217, v228, v228
    v_add_f32 v216, v216, v229
    v_fmac_f32 v217, v229, v229
    v_add_f32 v216, v216, v230
    s_waitcnt lgkmcnt(4)
    v_mfma_f32_32x32x16_bf16 v[80:95], v[192:195], a[240:243], v[80:95]
    ds_read_b64_tr_b16 v[208:209], v1 offset:8192
    v_fmac_f32 v217, v230, v230
    v_add_f32 v216, v216, v231
    v_fmac_f32 v217, v231, v231
    v_cvt_pk_bf16_f32 v34, v228, v229
    v_cvt_pk_bf16_f32 v35, v230, v231
    v_lshrrev_b32 v255, 1, v255
    v_add_u32 v222, 2097152, v255
    v_min_u32 v222, 2654204, v222
    v_mfma_f32_32x32x16_bf16 v[96:111], v[192:195], a[244:247], v[96:111]
    ds_read_b64_tr_b16 v[210:211], v1 offset:8704
    buffer_load_dwordx4 v9, s[8:11], s50 offen offset:2048 lds
    global_load_dword v254, v222, s[86:87]
    v_fma_f32 v224, -v56, v56, -s52
    v_fma_f32 v225, -v57, v57, -s52
    v_fma_f32 v226, -v58, v58, -s52
    v_fma_f32 v227, -v59, v59, -s52
    v_mul_f32 v224, v224, v56
    v_mul_f32 v225, v225, v57
    v_mfma_f32_32x32x16_bf16 v[80:95], v[196:199], a[248:251], v[80:95]
    ds_read_b64_tr_b16 v[212:213], v1 offset:10240
    v_mul_f32 v226, v226, v58
    v_mul_f32 v227, v227, v59
    v_exp_f32 v224, v224
    v_exp_f32 v225, v225
    v_exp_f32 v226, v226
    v_mfma_f32_32x32x16_bf16 v[96:111], v[196:199], a[252:255], v[96:111]
    ds_read_b64_tr_b16 v[214:215], v1 offset:10752
    v_exp_f32 v227, v227
    v_add_f32 v224, 1.0, v224
    v_add_f32 v225, 1.0, v225
    v_add_f32 v226, 1.0, v226
    v_add_f32 v227, 1.0, v227
    s_waitcnt lgkmcnt(4)
    v_mfma_f32_32x32x16_bf16 v[80:95], v[200:203], v[160:163], v[80:95]
    ds_read_b64_tr_b16 v[192:193], v247 offset:0
    v_rcp_f32 v224, v224
    v_rcp_f32 v225, v225
    v_rcp_f32 v226, v226
    v_rcp_f32 v227, v227
    v_mul_f32 v224, v224, v56
    v_mfma_f32_32x32x16_bf16 v[96:111], v[200:203], v[164:167], v[96:111]
    ds_read_b64_tr_b16 v[194:195], v247 offset:512
    v_mul_f32 v225, v225, v57
    v_mul_f32 v226, v226, v58
    v_mul_f32 v227, v227, v59
    v_add_f32 v216, v216, v224
    v_fmac_f32 v217, v224, v224
    v_add_f32 v216, v216, v225
    v_fmac_f32 v217, v225, v225
    v_add_f32 v216, v216, v226
    v_mfma_f32_32x32x16_bf16 v[80:95], v[204:207], v[168:171], v[80:95]
    ds_read_b64_tr_b16 v[196:197], v247 offset:2048
    v_fmac_f32 v217, v226, v226
    v_add_f32 v216, v216, v227
    v_fmac_f32 v217, v227, v227
    v_cvt_pk_bf16_f32 v36, v224, v225
    v_cvt_pk_bf16_f32 v37, v226, v227
    v_fma_f32 v228, -v60, v60, -s52
    v_fma_f32 v229, -v61, v61, -s52
    v_fma_f32 v230, -v62, v62, -s52
    v_mfma_f32_32x32x16_bf16 v[96:111], v[204:207], v[172:175], v[96:111]
    ds_read_b64_tr_b16 v[198:199], v247 offset:2560
    s_add_u32 m0, s45, 126976
    s_add_u32 s50, s48, 2654208
    buffer_load_dwordx4 v7, s[8:11], s50 offen offset:0 lds
    v_fma_f32 v231, -v63, v63, -s52
    v_mul_f32 v228, v228, v60
    v_mul_f32 v229, v229, v61
    v_mul_f32 v230, v230, v62
    s_waitcnt lgkmcnt(4)
    v_mfma_f32_32x32x16_bf16 v[80:95], v[208:211], v[176:179], v[80:95]
    ds_read_b64_tr_b16 v[200:201], v247 offset:4096
    v_mul_f32 v231, v231, v63
    v_exp_f32 v228, v228
    v_exp_f32 v229, v229
    v_exp_f32 v230, v230
    v_mfma_f32_32x32x16_bf16 v[96:111], v[208:211], v[180:183], v[96:111]
    ds_read_b64_tr_b16 v[202:203], v247 offset:4608
    v_exp_f32 v231, v231
    v_add_f32 v228, 1.0, v228
    v_add_f32 v229, 1.0, v229
    v_add_f32 v230, 1.0, v230
    v_add_f32 v231, 1.0, v231
    v_rcp_f32 v228, v228
    v_mfma_f32_32x32x16_bf16 v[80:95], v[212:215], v[184:187], v[80:95]
    ds_read_b64_tr_b16 v[204:205], v247 offset:6144
    v_rcp_f32 v229, v229
    v_rcp_f32 v230, v230
    v_rcp_f32 v231, v231
    v_mul_f32 v228, v228, v60
    v_mul_f32 v229, v229, v61
    v_mul_f32 v230, v230, v62
    v_mfma_f32_32x32x16_bf16 v[96:111], v[212:215], v[188:191], v[96:111]
    ds_read_b64_tr_b16 v[206:207], v247 offset:6656
    v_mul_f32 v231, v231, v63
    v_add_f32 v216, v216, v228
    v_fmac_f32 v217, v228, v228
    v_add_f32 v216, v216, v229
    v_fmac_f32 v217, v229, v229
    v_add_f32 v216, v216, v230
    v_fmac_f32 v217, v230, v230
    s_waitcnt lgkmcnt(4)
    v_mfma_f32_32x32x16_bf16 v[112:127], v[192:195], a[0:3], 0
    ds_read_b64_tr_b16 v[208:209], v247 offset:8192
    v_add_f32 v216, v216, v231
    v_fmac_f32 v217, v231, v231
    v_cvt_pk_bf16_f32 v38, v228, v229
    v_cvt_pk_bf16_f32 v39, v230, v231
    v_min_u32 v222, 663548, v255
    global_load_dword v254, v222, s[88:89]
    v_fma_f32 v224, -v64, v64, -s52
    v_fma_f32 v225, -v65, v65, -s52
    v_mfma_f32_32x32x16_bf16 v[128:143], v[192:195], a[4:7], 0
    ds_read_b64_tr_b16 v[210:211], v247 offset:8704
    buffer_load_dwordx4 v8, s[8:11], s50 offen offset:1024 lds
    v_fma_f32 v226, -v66, v66, -s52
    v_fma_f32 v227, -v67, v67, -s52
    v_mul_f32 v224, v224, v64
    v_mul_f32 v225, v225, v65
    v_mul_f32 v226, v226, v66
    v_mul_f32 v227, v227, v67
    v_mfma_f32_32x32x16_bf16 v[112:127], v[196:199], a[8:11], v[112:127]
    ds_read_b64_tr_b16 v[212:213], v247 offset:10240
    v_exp_f32 v224, v224
    v_exp_f32 v225, v225
    v_exp_f32 v226, v226
    v_exp_f32 v227, v227
    v_add_f32 v224, 1.0, v224
    v_mfma_f32_32x32x16_bf16 v[128:143], v[196:199], a[12:15], v[128:143]
    ds_read_b64_tr_b16 v[214:215], v247 offset:10752
    v_add_f32 v225, 1.0, v225
    v_add_f32 v226, 1.0, v226
    v_add_f32 v227, 1.0, v227
    v_rcp_f32 v224, v224
    v_rcp_f32 v225, v225
    s_waitcnt lgkmcnt(4)
    v_mfma_f32_32x32x16_bf16 v[112:127], v[200:203], a[16:19], v[112:127]
    ds_read_b64_tr_b16 v[192:193], v247 offset:12288
    v_rcp_f32 v226, v226
    v_rcp_f32 v227, v227
    v_mul_f32 v224, v224, v64
    v_mul_f32 v225, v225, v65
    v_mul_f32 v226, v226, v66
    v_mul_f32 v227, v227, v67
    v_mfma_f32_32x32x16_bf16 v[128:143], v[200:203], a[20:23], v[128:143]
    ds_read_b64_tr_b16 v[194:195], v247 offset:12800
    v_add_f32 v218, v218, v224
    v_fmac_f32 v219, v224, v224
    v_add_f32 v218, v218, v225
    v_fmac_f32 v219, v225, v225
    v_add_f32 v218, v218, v226
    v_fmac_f32 v219, v226, v226
    v_add_f32 v218, v218, v227
    v_fmac_f32 v219, v227, v227
    v_mfma_f32_32x32x16_bf16 v[112:127], v[204:207], a[24:27], v[112:127]
    ds_read_b64_tr_b16 v[196:197], v247 offset:14336
    v_cvt_pk_bf16_f32 v40, v224, v225
    v_cvt_pk_bf16_f32 v41, v226, v227
    v_fma_f32 v228, -v68, v68, -s52
    v_fma_f32 v229, -v69, v69, -s52
    v_fma_f32 v230, -v70, v70, -s52
    v_fma_f32 v231, -v71, v71, -s52
    v_mul_f32 v228, v228, v68
    v_mul_f32 v229, v229, v69
    v_mfma_f32_32x32x16_bf16 v[128:143], v[204:207], a[28:31], v[128:143]
    ds_read_b64_tr_b16 v[198:199], v247 offset:14848
    buffer_load_dwordx4 v9, s[8:11], s50 offen offset:2048 lds
    v_mul_f32 v230, v230, v70
    v_mul_f32 v231, v231, v71
    v_exp_f32 v228, v228
    v_exp_f32 v229, v229
    s_waitcnt lgkmcnt(4)
    v_mfma_f32_32x32x16_bf16 v[112:127], v[208:211], a[32:35], v[112:127]
    ds_read_b64_tr_b16 v[200:201], v247 offset:16384
    v_exp_f32 v230, v230
    v_exp_f32 v231, v231
    v_add_f32 v228, 1.0, v228
    v_add_f32 v229, 1.0, v229
    v_add_f32 v230, 1.0, v230
    v_add_f32 v231, 1.0, v231
    v_mfma_f32_32x32x16_bf16 v[128:143], v[208:211], a[36:39], v[128:143]
    ds_read_b64_tr_b16 v[202:203], v247 offset:16896
    v_rcp_f32 v228, v228
    v_rcp_f32 v229, v229
    v_rcp_f32 v230, v230
    v_rcp_f32 v231, v231
    v_mfma_f32_32x32x16_bf16 v[112:127], v[212:215], a[40:43], v[112:127]
    ds_read_b64_tr_b16 v[204:205], v247 offset:18432
    v_mul_f32 v228, v228, v68
    v_mul_f32 v229, v229, v69
    v_mul_f32 v230, v230, v70
    v_mul_f32 v231, v231, v71
    v_add_f32 v218, v218, v228
    v_fmac_f32 v219, v228, v228
    v_add_f32 v218, v218, v229
    v_fmac_f32 v219, v229, v229
    v_mfma_f32_32x32x16_bf16 v[128:143], v[212:215], a[44:47], v[128:143]
    ds_read_b64_tr_b16 v[206:207], v247 offset:18944
    v_add_f32 v218, v218, v230
    v_fmac_f32 v219, v230, v230
    v_add_f32 v218, v218, v231
    v_fmac_f32 v219, v231, v231
    v_cvt_pk_bf16_f32 v42, v228, v229
    v_cvt_pk_bf16_f32 v43, v230, v231
    v_fma_f32 v224, -v72, v72, -s52
    s_waitcnt lgkmcnt(4)
    v_mfma_f32_32x32x16_bf16 v[112:127], v[192:195], a[48:51], v[112:127]
    ds_read_b64_tr_b16 v[208:209], v247 offset:20480
    v_fma_f32 v225, -v73, v73, -s52
    v_fma_f32 v226, -v74, v74, -s52
    v_fma_f32 v227, -v75, v75, -s52
    v_mul_f32 v224, v224, v72
    v_mul_f32 v225, v225, v73
    v_mul_f32 v226, v226, v74
    v_mul_f32 v227, v227, v75
    v_mfma_f32_32x32x16_bf16 v[128:143], v[192:195], a[52:55], v[128:143]
    ds_read_b64_tr_b16 v[210:211], v247 offset:20992
    s_add_u32 m0, s45, 139264
    s_add_u32 s50, s48, 3538944
    buffer_load_dwordx4 v7, s[8:11], s50 offen offset:0 lds
    v_exp_f32 v224, v224
    v_exp_f32 v225, v225
    v_exp_f32 v226, v226
    v_mfma_f32_32x32x16_bf16 v[112:127], v[196:199], a[56:59], v[112:127]
    ds_read_b64_tr_b16 v[212:213], v247 offset:22528
    v_exp_f32 v227, v227
    v_add_f32 v224, 1.0, v224
    v_add_f32 v225, 1.0, v225
    v_add_f32 v226, 1.0, v226
    v_add_f32 v227, 1.0, v227
    v_rcp_f32 v224, v224
    v_mfma_f32_32x32x16_bf16 v[128:143], v[196:199], a[60:63], v[128:143]
    ds_read_b64_tr_b16 v[214:215], v247 offset:23040
    v_rcp_f32 v225, v225
    v_rcp_f32 v226, v226
    v_rcp_f32 v227, v227
    v_mul_f32 v224, v224, v72
    s_waitcnt lgkmcnt(4)
    v_mfma_f32_32x32x16_bf16 v[112:127], v[200:203], a[64:67], v[112:127]
    ds_read_b64_tr_b16 v[192:193], v247 offset:24576
    v_mul_f32 v225, v225, v73
    v_mul_f32 v226, v226, v74
    v_mul_f32 v227, v227, v75
    v_add_f32 v218, v218, v224
    v_fmac_f32 v219, v224, v224
    v_add_f32 v218, v218, v225
    v_fmac_f32 v219, v225, v225
    v_add_f32 v218, v218, v226
    v_mfma_f32_32x32x16_bf16 v[128:143], v[200:203], a[68:71], v[128:143]
    ds_read_b64_tr_b16 v[194:195], v247 offset:25088
    v_fmac_f32 v219, v226, v226
    v_add_f32 v218, v218, v227
    v_fmac_f32 v219, v227, v227
    v_cvt_pk_bf16_f32 v44, v224, v225
    v_cvt_pk_bf16_f32 v45, v226, v227
    v_fma_f32 v228, -v76, v76, -s52
    v_fma_f32 v229, -v77, v77, -s52
    v_fma_f32 v230, -v78, v78, -s52
    v_mfma_f32_32x32x16_bf16 v[112:127], v[204:207], a[72:75], v[112:127]
    ds_read_b64_tr_b16 v[196:197], v247 offset:26624
    v_fma_f32 v231, -v79, v79, -s52
    v_mul_f32 v228, v228, v76
    v_mul_f32 v229, v229, v77
    v_mul_f32 v230, v230, v78
    v_mul_f32 v231, v231, v79
    v_exp_f32 v228, v228
    v_mfma_f32_32x32x16_bf16 v[128:143], v[204:207], a[76:79], v[128:143]
    ds_read_b64_tr_b16 v[198:199], v247 offset:27136
    buffer_load_dwordx4 v8, s[8:11], s50 offen offset:1024 lds
    v_exp_f32 v229, v229
    v_exp_f32 v230, v230
    v_exp_f32 v231, v231
    v_add_f32 v228, 1.0, v228
    s_waitcnt lgkmcnt(4)
    v_mfma_f32_32x32x16_bf16 v[112:127], v[208:211], a[80:83], v[112:127]
    ds_read_b64_tr_b16 v[200:201], v247 offset:28672
    v_add_f32 v229, 1.0, v229
    v_add_f32 v230, 1.0, v230
    v_add_f32 v231, 1.0, v231
    v_rcp_f32 v228, v228
    v_rcp_f32 v229, v229
    v_mfma_f32_32x32x16_bf16 v[128:143], v[208:211], a[84:87], v[128:143]
    ds_read_b64_tr_b16 v[202:203], v247 offset:29184
    v_rcp_f32 v230, v230
    v_rcp_f32 v231, v231
    v_mul_f32 v228, v228, v76
    v_mul_f32 v229, v229, v77
    v_mul_f32 v230, v230, v78
    v_mul_f32 v231, v231, v79
    v_add_f32 v218, v218, v228
    v_mfma_f32_32x32x16_bf16 v[112:127], v[212:215], a[88:91], v[112:127]
    ds_read_b64_tr_b16 v[204:205], v247 offset:30720
    v_fmac_f32 v219, v228, v228
    v_add_f32 v218, v218, v229
    v_fmac_f32 v219, v229, v229
    v_add_f32 v218, v218, v230
    v_fmac_f32 v219, v230, v230
    v_add_f32 v218, v218, v231
    v_fmac_f32 v219, v231, v231
    v_cvt_pk_bf16_f32 v46, v228, v229
    v_mfma_f32_32x32x16_bf16 v[128:143], v[212:215], a[92:95], v[128:143]
    ds_read_b64_tr_b16 v[206:207], v247 offset:31232
    v_cvt_pk_bf16_f32 v47, v230, v231
    v_fma_f32 v224, -v144, v144, -s52
    v_fma_f32 v225, -v145, v145, -s52
    v_fma_f32 v226, -v146, v146, -s52
    v_fma_f32 v227, -v147, v147, -s52
    v_mul_f32 v224, v224, v144
    v_mul_f32 v225, v225, v145
    s_waitcnt lgkmcnt(4)
    v_mfma_f32_32x32x16_bf16 v[112:127], v[192:195], a[96:99], v[112:127]
    ds_read_b64_tr_b16 v[208:209], v247 offset:32768
    v_mul_f32 v226, v226, v146
    v_mul_f32 v227, v227, v147
    v_exp_f32 v224, v224
    v_exp_f32 v225, v225
    v_exp_f32 v226, v226
    v_mfma_f32_32x32x16_bf16 v[128:143], v[192:195], a[100:103], v[128:143]
    ds_read_b64_tr_b16 v[210:211], v247 offset:33280
    buffer_load_dwordx4 v9, s[8:11], s50 offen offset:2048 lds
    v_exp_f32 v227, v227
    v_add_f32 v224, 1.0, v224
    v_add_f32 v225, 1.0, v225
    v_add_f32 v226, 1.0, v226
    v_add_f32 v227, 1.0, v227
    v_mfma_f32_32x32x16_bf16 v[112:127], v[196:199], a[104:107], v[112:127]
    ds_read_b64_tr_b16 v[212:213], v247 offset:34816
    v_rcp_f32 v224, v224
    v_rcp_f32 v225, v225
    v_rcp_f32 v226, v226
    v_rcp_f32 v227, v227
    v_mul_f32 v224, v224, v144
    v_mfma_f32_32x32x16_bf16 v[128:143], v[196:199], a[108:111], v[128:143]
    ds_read_b64_tr_b16 v[214:215], v247 offset:35328
    v_mul_f32 v225, v225, v145
    v_mul_f32 v226, v226, v146
    v_mul_f32 v227, v227, v147
    v_add_f32 v220, v220, v224
    v_fmac_f32 v221, v224, v224
    v_add_f32 v220, v220, v225
    v_fmac_f32 v221, v225, v225
    s_waitcnt lgkmcnt(4)
    v_mfma_f32_32x32x16_bf16 v[112:127], v[200:203], a[112:115], v[112:127]
    ds_read_b64_tr_b16 v[192:193], v247 offset:36864
    v_add_f32 v220, v220, v226
    v_fmac_f32 v221, v226, v226
    v_add_f32 v220, v220, v227
    v_fmac_f32 v221, v227, v227
    v_cvt_pk_bf16_f32 v144, v224, v225
    v_cvt_pk_bf16_f32 v145, v226, v227
    v_fma_f32 v228, -v148, v148, -s52
    v_fma_f32 v229, -v149, v149, -s52
    v_mfma_f32_32x32x16_bf16 v[128:143], v[200:203], a[116:119], v[128:143]
    ds_read_b64_tr_b16 v[194:195], v247 offset:37376
    v_fma_f32 v230, -v150, v150, -s52
    v_fma_f32 v231, -v151, v151, -s52
    v_mul_f32 v228, v228, v148
    v_mul_f32 v229, v229, v149
    v_mul_f32 v230, v230, v150
    v_mul_f32 v231, v231, v151
    v_exp_f32 v228, v228
    v_mfma_f32_32x32x16_bf16 v[112:127], v[204:207], a[120:123], v[112:127]
    ds_read_b64_tr_b16 v[196:197], v247 offset:38912
    v_exp_f32 v229, v229
    v_exp_f32 v230, v230
    v_exp_f32 v231, v231
    v_add_f32 v228, 1.0, v228
    v_add_f32 v229, 1.0, v229
    v_mfma_f32_32x32x16_bf16 v[128:143], v[204:207], a[124:127], v[128:143]
    ds_read_b64_tr_b16 v[198:199], v247 offset:39424
    s_add_u32 m0, s45, 151552
    s_add_u32 s50, s48, 4423680
    buffer_load_dwordx4 v7, s[8:11], s50 offen offset:0 lds
    v_add_f32 v230, 1.0, v230
    v_add_f32 v231, 1.0, v231
    v_rcp_f32 v228, v228
    s_waitcnt lgkmcnt(4)
    v_mfma_f32_32x32x16_bf16 v[112:127], v[208:211], a[128:131], v[112:127]
    ds_read_b64_tr_b16 v[200:201], v247 offset:40960
    v_rcp_f32 v229, v229
    v_rcp_f32 v230, v230
    v_rcp_f32 v231, v231
    v_mul_f32 v228, v228, v148
    v_mul_f32 v229, v229, v149
    v_mfma_f32_32x32x16_bf16 v[128:143], v[208:211], a[132:135], v[128:143]
    ds_read_b64_tr_b16 v[202:203], v247 offset:41472
    v_mul_f32 v230, v230, v150
    v_mul_f32 v231, v231, v151
    v_add_f32 v220, v220, v228
    v_fmac_f32 v221, v228, v228
    v_add_f32 v220, v220, v229
    v_fmac_f32 v221, v229, v229
    v_add_f32 v220, v220, v230
    v_fmac_f32 v221, v230, v230
    v_mfma_f32_32x32x16_bf16 v[112:127], v[212:215], a[136:139], v[112:127]
    ds_read_b64_tr_b16 v[204:205], v247 offset:43008
    v_add_f32 v220, v220, v231
    v_fmac_f32 v221, v231, v231
    v_cvt_pk_bf16_f32 v146, v228, v229
    v_cvt_pk_bf16_f32 v147, v230, v231
    buffer_store_dwordx4 v[144:147], v11, s[32:35], s56 offen offset:0 sc1
    v_fma_f32 v224, -v152, v152, -s52
    v_fma_f32 v225, -v153, v153, -s52
    v_fma_f32 v226, -v154, v154, -s52
    v_mfma_f32_32x32x16_bf16 v[128:143], v[212:215], a[140:143], v[128:143]
    ds_read_b64_tr_b16 v[206:207], v247 offset:43520
    v_fma_f32 v227, -v155, v155, -s52
    v_mul_f32 v224, v224, v152
    v_mul_f32 v225, v225, v153
    v_mul_f32 v226, v226, v154
    v_mul_f32 v227, v227, v155
    v_exp_f32 v224, v224
    s_waitcnt lgkmcnt(4)
    v_mfma_f32_32x32x16_bf16 v[112:127], v[192:195], a[144:147], v[112:127]
    ds_read_b64_tr_b16 v[208:209], v247 offset:45056
    v_exp_f32 v225, v225
    v_exp_f32 v226, v226
    v_exp_f32 v227, v227
    v_add_f32 v224, 1.0, v224
    v_add_f32 v225, 1.0, v225
    v_mfma_f32_32x32x16_bf16 v[128:143], v[192:195], a[148:151], v[128:143]
    ds_read_b64_tr_b16 v[210:211], v247 offset:45568
    buffer_load_dwordx4 v8, s[8:11], s50 offen offset:1024 lds
    v_add_f32 v226, 1.0, v226
    v_add_f32 v227, 1.0, v227
    v_rcp_f32 v224, v224
    v_rcp_f32 v225, v225
    v_mfma_f32_32x32x16_bf16 v[112:127], v[196:199], a[152:155], v[112:127]
    ds_read_b64_tr_b16 v[212:213], v247 offset:47104
    v_rcp_f32 v226, v226
    v_rcp_f32 v227, v227
    v_mul_f32 v224, v224, v152
    v_mul_f32 v225, v225, v153
    v_mul_f32 v226, v226, v154
    v_mul_f32 v227, v227, v155
    v_add_f32 v220, v220, v224
    v_mfma_f32_32x32x16_bf16 v[128:143], v[196:199], a[156:159], v[128:143]
    ds_read_b64_tr_b16 v[214:215], v247 offset:47616
    v_fmac_f32 v221, v224, v224
    v_add_f32 v220, v220, v225
    v_fmac_f32 v221, v225, v225
    v_add_f32 v220, v220, v226
    v_fmac_f32 v221, v226, v226
    v_add_f32 v220, v220, v227
    v_fmac_f32 v221, v227, v227
    s_waitcnt lgkmcnt(4)
    v_mfma_f32_32x32x16_bf16 v[112:127], v[200:203], a[160:163], v[112:127]
    ds_read_b64_tr_b16 v[192:193], v247 offset:49152
    v_cvt_pk_bf16_f32 v148, v224, v225
    v_cvt_pk_bf16_f32 v149, v226, v227
    v_fma_f32 v228, -v156, v156, -s52
    v_fma_f32 v229, -v157, v157, -s52
    v_fma_f32 v230, -v158, v158, -s52
    v_fma_f32 v231, -v159, v159, -s52
    v_mul_f32 v228, v228, v156
    v_mul_f32 v229, v229, v157
    v_mfma_f32_32x32x16_bf16 v[128:143], v[200:203], a[164:167], v[128:143]
    ds_read_b64_tr_b16 v[194:195], v247 offset:49664
    v_mul_f32 v230, v230, v158
    v_mul_f32 v231, v231, v159
    v_exp_f32 v228, v228
    v_exp_f32 v229, v229
    v_exp_f32 v230, v230
    v_mfma_f32_32x32x16_bf16 v[112:127], v[204:207], a[168:171], v[112:127]
    ds_read_b64_tr_b16 v[196:197], v247 offset:51200
    v_exp_f32 v231, v231
    v_add_f32 v228, 1.0, v228
    v_add_f32 v229, 1.0, v229
    v_add_f32 v230, 1.0, v230
    v_add_f32 v231, 1.0, v231
    v_rcp_f32 v228, v228
    v_mfma_f32_32x32x16_bf16 v[128:143], v[204:207], a[172:175], v[128:143]
    ds_read_b64_tr_b16 v[198:199], v247 offset:51712
    buffer_load_dwordx4 v9, s[8:11], s50 offen offset:2048 lds
    v_rcp_f32 v229, v229
    v_rcp_f32 v230, v230
    v_rcp_f32 v231, v231
    s_waitcnt lgkmcnt(4)
    v_mfma_f32_32x32x16_bf16 v[112:127], v[208:211], a[176:179], v[112:127]
    ds_read_b64_tr_b16 v[200:201], v247 offset:53248
    v_mul_f32 v228, v228, v156
    v_mul_f32 v229, v229, v157
    v_mul_f32 v230, v230, v158
    v_mul_f32 v231, v231, v159
    v_add_f32 v220, v220, v228
    v_fmac_f32 v221, v228, v228
    v_add_f32 v220, v220, v229
    v_fmac_f32 v221, v229, v229
    v_mfma_f32_32x32x16_bf16 v[128:143], v[208:211], a[180:183], v[128:143]
    ds_read_b64_tr_b16 v[202:203], v247 offset:53760
    v_add_f32 v220, v220, v230
    v_fmac_f32 v221, v230, v230
    v_add_f32 v220, v220, v231
    v_fmac_f32 v221, v231, v231
    v_cvt_pk_bf16_f32 v150, v228, v229
    v_cvt_pk_bf16_f32 v151, v230, v231
    buffer_store_dwordx4 v[148:151], v11, s[32:35], s56 offen offset:256 sc1
    v_fma_f32 v218, v220, s53, v218
    v_mfma_f32_32x32x16_bf16 v[112:127], v[212:215], a[184:187], v[112:127]
    ds_read_b64_tr_b16 v[204:205], v247 offset:55296
    v_fma_f32 v219, v221, s53, v219
    v_permlane32_swap_b32 v216, v217
    s_nop 0
    v_permlane32_swap_b32 v218, v219
    v_add_f32 v216, v216, v217
    v_add_f32 v218, v218, v219
    buffer_atomic_add_f32 v216, v13, s[28:31], s59 offen offset:0
    buffer_atomic_add_f32 v218, v13, s[28:31], s59 offen offset:256
    v_mfma_f32_32x32x16_bf16 v[128:143], v[212:215], a[188:191], v[128:143]
    ds_read_b64_tr_b16 v[206:207], v247 offset:55808
    v_mul_f32 v80, s60, v80
    v_mul_f32 v81, s60, v81
    v_mul_f32 v82, s60, v82
    v_mul_f32 v83, s60, v83
    s_waitcnt lgkmcnt(4)
    v_mfma_f32_32x32x16_bf16 v[112:127], v[192:195], a[192:195], v[112:127]
    ds_read_b64_tr_b16 v[208:209], v247 offset:57344
    v_cvt_pk_bf16_f32 v232, v80, v81
    v_cvt_pk_bf16_f32 v233, v82, v83
    buffer_store_dwordx2 v[232:233], v12, s[24:27], s57 offen offset:0 sc1
    v_mul_f32 v84, s60, v84
    v_mul_f32 v85, s60, v85
    v_mfma_f32_32x32x16_bf16 v[128:143], v[192:195], a[196:199], v[128:143]
    ds_read_b64_tr_b16 v[210:211], v247 offset:57856
    v_mul_f32 v86, s60, v86
    v_mul_f32 v87, s60, v87
    v_cvt_pk_bf16_f32 v236, v84, v85
    v_cvt_pk_bf16_f32 v237, v86, v87
    buffer_store_dwordx2 v[236:237], v12, s[24:27], s57 offen offset:256 sc1
    v_mfma_f32_32x32x16_bf16 v[112:127], v[196:199], a[200:203], v[112:127]
    ds_read_b64_tr_b16 v[212:213], v247 offset:59392
    v_mul_f32 v88, s60, v88
    v_mul_f32 v89, s60, v89
    v_mul_f32 v90, s60, v90
    v_mul_f32 v91, s60, v91
    v_cvt_pk_bf16_f32 v240, v88, v89
    v_mfma_f32_32x32x16_bf16 v[128:143], v[196:199], a[204:207], v[128:143]
    ds_read_b64_tr_b16 v[214:215], v247 offset:59904
    v_cvt_pk_bf16_f32 v241, v90, v91
    buffer_store_dwordx2 v[240:241], v12, s[24:27], s57 offen offset:512 sc1
    v_mul_f32 v92, s60, v92
    v_mul_f32 v93, s60, v93
    s_waitcnt lgkmcnt(4)
    v_mfma_f32_32x32x16_bf16 v[112:127], v[200:203], a[208:211], v[112:127]
    ds_read_b64_tr_b16 v[192:193], v2 offset:0
    v_mul_f32 v94, s60, v94
    v_mul_f32 v95, s60, v95
    v_cvt_pk_bf16_f32 v232, v92, v93
    v_cvt_pk_bf16_f32 v233, v94, v95
    buffer_store_dwordx2 v[232:233], v12, s[24:27], s57 offen offset:768 sc1
    v_mfma_f32_32x32x16_bf16 v[128:143], v[200:203], a[212:215], v[128:143]
    ds_read_b64_tr_b16 v[194:195], v2 offset:512
    v_mul_f32 v96, s60, v96
    v_mul_f32 v97, s60, v97
    v_mul_f32 v98, s60, v98
    v_mul_f32 v99, s60, v99
    v_cvt_pk_bf16_f32 v236, v96, v97
    v_mfma_f32_32x32x16_bf16 v[112:127], v[204:207], a[216:219], v[112:127]
    ds_read_b64_tr_b16 v[196:197], v2 offset:2048
    v_cvt_pk_bf16_f32 v237, v98, v99
    buffer_store_dwordx2 v[236:237], v12, s[24:27], s58 offen offset:0 sc1
    v_mul_f32 v100, s60, v100
    v_mul_f32 v101, s60, v101
    v_mul_f32 v102, s60, v102
    v_mfma_f32_32x32x16_bf16 v[128:143], v[204:207], a[220:223], v[128:143]
    ds_read_b64_tr_b16 v[198:199], v2 offset:2560
    v_mul_f32 v103, s60, v103
    v_cvt_pk_bf16_f32 v240, v100, v101
    v_cvt_pk_bf16_f32 v241, v102, v103
    buffer_store_dwordx2 v[240:241], v12, s[24:27], s58 offen offset:256 sc1
    s_waitcnt lgkmcnt(4)
    v_mfma_f32_32x32x16_bf16 v[112:127], v[208:211], a[224:227], v[112:127]
    ds_read_b64_tr_b16 v[200:201], v2 offset:4096
    v_mul_f32 v104, s60, v104
    v_mul_f32 v105, s60, v105
    v_mul_f32 v106, s60, v106
    v_mul_f32 v107, s60, v107
    v_cvt_pk_bf16_f32 v232, v104, v105
    v_mfma_f32_32x32x16_bf16 v[128:143], v[208:211], a[228:231], v[128:143]
    ds_read_b64_tr_b16 v[202:203], v2 offset:4608
    v_cvt_pk_bf16_f32 v233, v106, v107
    buffer_store_dwordx2 v[232:233], v12, s[24:27], s58 offen offset:512 sc1
    v_mul_f32 v108, s60, v108
    v_mul_f32 v109, s60, v109
    v_mul_f32 v110, s60, v110
    v_mfma_f32_32x32x16_bf16 v[112:127], v[212:215], a[232:235], v[112:127]
    ds_read_b64_tr_b16 v[204:205], v2 offset:6144
    v_mul_f32 v111, s60, v111
    v_cvt_pk_bf16_f32 v236, v108, v109
    v_cvt_pk_bf16_f32 v237, v110, v111
    buffer_store_dwordx2 v[236:237], v12, s[24:27], s58 offen offset:768 sc1
    v_mfma_f32_32x32x16_bf16 v[128:143], v[212:215], a[236:239], v[128:143]
    ds_read_b64_tr_b16 v[206:207], v2 offset:6656
    s_waitcnt lgkmcnt(4)
    v_mfma_f32_32x32x16_bf16 v[112:127], v[192:195], a[240:243], v[112:127]
    ds_read_b64_tr_b16 v[208:209], v2 offset:8192
    v_mfma_f32_32x32x16_bf16 v[128:143], v[192:195], a[244:247], v[128:143]
    ds_read_b64_tr_b16 v[210:211], v2 offset:8704
    v_mfma_f32_32x32x16_bf16 v[112:127], v[196:199], a[248:251], v[112:127]
    ds_read_b64_tr_b16 v[212:213], v2 offset:10240
    v_mfma_f32_32x32x16_bf16 v[128:143], v[196:199], a[252:255], v[128:143]
    ds_read_b64_tr_b16 v[214:215], v2 offset:10752
    s_waitcnt lgkmcnt(4)
    v_mfma_f32_32x32x16_bf16 v[112:127], v[200:203], v[160:163], v[112:127]
    s_waitcnt vmcnt(11)
    s_barrier
    ds_read_b64_tr_b16 v[192:193], v1 offset:24576
    v_mfma_f32_32x32x16_bf16 v[128:143], v[200:203], v[164:167], v[128:143]
    ds_read_b64_tr_b16 v[194:195], v1 offset:25088
    v_mfma_f32_32x32x16_bf16 v[112:127], v[204:207], v[168:171], v[112:127]
    ds_read_b64_tr_b16 v[196:197], v1 offset:26624
    v_mfma_f32_32x32x16_bf16 v[128:143], v[204:207], v[172:175], v[128:143]
    ds_read_b64_tr_b16 v[198:199], v1 offset:27136
    s_waitcnt vmcnt(8)
    v_mov_b32 v222, 1
    buffer_atomic_add v222, v252, s[28:31], s63 offen
    s_waitcnt lgkmcnt(4)
    v_mfma_f32_32x32x16_bf16 v[112:127], v[208:211], v[176:179], v[112:127]
    ds_read_b64_tr_b16 v[200:201], v1 offset:28672
    v_mfma_f32_32x32x16_bf16 v[128:143], v[208:211], v[180:183], v[128:143]
    ds_read_b64_tr_b16 v[202:203], v1 offset:29184
    v_mfma_f32_32x32x16_bf16 v[112:127], v[212:215], v[184:187], v[112:127]
    ds_read_b64_tr_b16 v[204:205], v1 offset:30720
    v_mfma_f32_32x32x16_bf16 v[128:143], v[212:215], v[188:191], v[128:143]
    ds_read_b64_tr_b16 v[206:207], v1 offset:31232
    s_waitcnt lgkmcnt(4)
    v_mfma_f32_32x32x16_bf16 v[48:63], v[192:195], a[0:3], 0
    ds_read_b64_tr_b16 v[208:209], v1 offset:32768
    v_mfma_f32_32x32x16_bf16 v[64:79], v[192:195], a[4:7], 0
    ds_read_b64_tr_b16 v[210:211], v1 offset:33280
    v_mfma_f32_32x32x16_bf16 v[48:63], v[196:199], a[8:11], v[48:63]
    ds_read_b64_tr_b16 v[212:213], v1 offset:34816
    s_nop 1
    v_mul_f32 v112, s60, v112
    v_mul_f32 v113, s60, v113
    v_mul_f32 v114, s60, v114
    v_mul_f32 v115, s60, v115
    v_cvt_pk_bf16_f32 v240, v112, v113
    v_mfma_f32_32x32x16_bf16 v[64:79], v[196:199], a[12:15], v[64:79]
    ds_read_b64_tr_b16 v[214:215], v1 offset:35328
    v_cvt_pk_bf16_f32 v241, v114, v115
    buffer_store_dwordx2 v[240:241], v12, s[24:27], s57 offen offset:2048 sc1
    v_mul_f32 v116, s60, v116
    v_mul_f32 v117, s60, v117
    s_waitcnt lgkmcnt(4)
    v_mfma_f32_32x32x16_bf16 v[48:63], v[200:203], a[16:19], v[48:63]
    ds_read_b64_tr_b16 v[192:193], v1 offset:36864
    v_mul_f32 v118, s60, v118
    v_mul_f32 v119, s60, v119
    v_cvt_pk_bf16_f32 v232, v116, v117
    v_cvt_pk_bf16_f32 v233, v118, v119
    buffer_store_dwordx2 v[232:233], v12, s[24:27], s57 offen offset:2304 sc1
    v_mfma_f32_32x32x16_bf16 v[64:79], v[200:203], a[20:23], v[64:79]
    ds_read_b64_tr_b16 v[194:195], v1 offset:37376
    v_mul_f32 v120, s60, v120
    v_mul_f32 v121, s60, v121
    v_mul_f32 v122, s60, v122
    v_mul_f32 v123, s60, v123
    v_cvt_pk_bf16_f32 v236, v120, v121
    v_mfma_f32_32x32x16_bf16 v[48:63], v[204:207], a[24:27], v[48:63]
    ds_read_b64_tr_b16 v[196:197], v1 offset:38912
    v_cvt_pk_bf16_f32 v237, v122, v123
    buffer_store_dwordx2 v[236:237], v12, s[24:27], s57 offen offset:2560 sc1
    v_mul_f32 v124, s60, v124
    v_mul_f32 v125, s60, v125
    v_mul_f32 v126, s60, v126
    v_mfma_f32_32x32x16_bf16 v[64:79], v[204:207], a[28:31], v[64:79]
    ds_read_b64_tr_b16 v[198:199], v1 offset:39424
    v_mul_f32 v127, s60, v127
    v_cvt_pk_bf16_f32 v240, v124, v125
    v_cvt_pk_bf16_f32 v241, v126, v127
    buffer_store_dwordx2 v[240:241], v12, s[24:27], s57 offen offset:2816 sc1
    s_waitcnt lgkmcnt(4)
    v_mfma_f32_32x32x16_bf16 v[48:63], v[208:211], a[32:35], v[48:63]
    ds_read_b64_tr_b16 v[200:201], v1 offset:40960
    v_mul_f32 v128, s60, v128
    v_mul_f32 v129, s60, v129
    v_mul_f32 v130, s60, v130
    v_mul_f32 v131, s60, v131
    v_cvt_pk_bf16_f32 v232, v128, v129
    v_mfma_f32_32x32x16_bf16 v[64:79], v[208:211], a[36:39], v[64:79]
    ds_read_b64_tr_b16 v[202:203], v1 offset:41472
    v_cvt_pk_bf16_f32 v233, v130, v131
    buffer_store_dwordx2 v[232:233], v12, s[24:27], s58 offen offset:2048 sc1
    v_mul_f32 v132, s60, v132
    v_mul_f32 v133, s60, v133
    v_mul_f32 v134, s60, v134
    v_mfma_f32_32x32x16_bf16 v[48:63], v[212:215], a[40:43], v[48:63]
    ds_read_b64_tr_b16 v[204:205], v1 offset:43008
    v_mul_f32 v135, s60, v135
    v_cvt_pk_bf16_f32 v236, v132, v133
    v_cvt_pk_bf16_f32 v237, v134, v135
    buffer_store_dwordx2 v[236:237], v12, s[24:27], s58 offen offset:2304 sc1
    v_mul_f32 v136, s60, v136
    v_mfma_f32_32x32x16_bf16 v[64:79], v[212:215], a[44:47], v[64:79]
    ds_read_b64_tr_b16 v[206:207], v1 offset:43520
    v_mul_f32 v137, s60, v137
    v_mul_f32 v138, s60, v138
    v_mul_f32 v139, s60, v139
    v_cvt_pk_bf16_f32 v240, v136, v137
    s_waitcnt lgkmcnt(4)
    v_mfma_f32_32x32x16_bf16 v[48:63], v[192:195], a[48:51], v[48:63]
    ds_read_b64_tr_b16 v[208:209], v1 offset:45056
    v_cvt_pk_bf16_f32 v241, v138, v139
    buffer_store_dwordx2 v[240:241], v12, s[24:27], s58 offen offset:2560 sc1
    v_mul_f32 v140, s60, v140
    v_mul_f32 v141, s60, v141
    v_mul_f32 v142, s60, v142
    v_mfma_f32_32x32x16_bf16 v[64:79], v[192:195], a[52:55], v[64:79]
    ds_read_b64_tr_b16 v[210:211], v1 offset:45568
    v_mul_f32 v143, s60, v143
    v_cvt_pk_bf16_f32 v232, v140, v141
    v_cvt_pk_bf16_f32 v233, v142, v143
    buffer_store_dwordx2 v[232:233], v12, s[24:27], s58 offen offset:2816 sc1
    v_mfma_f32_32x32x16_bf16 v[48:63], v[196:199], a[56:59], v[48:63]
    ds_read_b64_tr_b16 v[212:213], v1 offset:47104
    v_mfma_f32_32x32x16_bf16 v[64:79], v[196:199], a[60:63], v[64:79]
    ds_read_b64_tr_b16 v[214:215], v1 offset:47616
    s_waitcnt lgkmcnt(4)
    v_mfma_f32_32x32x16_bf16 v[48:63], v[200:203], a[64:67], v[48:63]
    ds_read_b64_tr_b16 v[192:193], v1 offset:49152
    v_mfma_f32_32x32x16_bf16 v[64:79], v[200:203], a[68:71], v[64:79]
    ds_read_b64_tr_b16 v[194:195], v1 offset:49664
    v_mfma_f32_32x32x16_bf16 v[48:63], v[204:207], a[72:75], v[48:63]
    ds_read_b64_tr_b16 v[196:197], v1 offset:51200
    v_mfma_f32_32x32x16_bf16 v[64:79], v[204:207], a[76:79], v[64:79]
    ds_read_b64_tr_b16 v[198:199], v1 offset:51712
    s_waitcnt lgkmcnt(4)
    v_mfma_f32_32x32x16_bf16 v[48:63], v[208:211], a[80:83], v[48:63]
    ds_read_b64_tr_b16 v[200:201], v1 offset:53248
    v_mfma_f32_32x32x16_bf16 v[64:79], v[208:211], a[84:87], v[64:79]
    ds_read_b64_tr_b16 v[202:203], v1 offset:53760
    v_mfma_f32_32x32x16_bf16 v[48:63], v[212:215], a[88:91], v[48:63]
    ds_read_b64_tr_b16 v[204:205], v1 offset:55296
    v_mfma_f32_32x32x16_bf16 v[64:79], v[212:215], a[92:95], v[64:79]
    ds_read_b64_tr_b16 v[206:207], v1 offset:55808
    s_waitcnt lgkmcnt(4)
    v_mfma_f32_32x32x16_bf16 v[48:63], v[192:195], a[96:99], v[48:63]
    ds_read_b64_tr_b16 v[208:209], v1 offset:57344
    v_mfma_f32_32x32x16_bf16 v[64:79], v[192:195], a[100:103], v[64:79]
    ds_read_b64_tr_b16 v[210:211], v1 offset:57856
    v_mfma_f32_32x32x16_bf16 v[48:63], v[196:199], a[104:107], v[48:63]
    ds_read_b64_tr_b16 v[212:213], v1 offset:59392
    v_mfma_f32_32x32x16_bf16 v[64:79], v[196:199], a[108:111], v[64:79]
    ds_read_b64_tr_b16 v[214:215], v1 offset:59904
    v_mov_b32 v253, 0
    buffer_atomic_add v253, v252, s[28:31], s63 offen sc0
    s_waitcnt lgkmcnt(4)
    v_mfma_f32_32x32x16_bf16 v[48:63], v[200:203], a[112:115], v[48:63]
    ds_read_b64_tr_b16 v[192:193], v4 offset:0
    v_mfma_f32_32x32x16_bf16 v[64:79], v[200:203], a[116:119], v[64:79]
    ds_read_b64_tr_b16 v[194:195], v4 offset:512
    v_mfma_f32_32x32x16_bf16 v[48:63], v[204:207], a[120:123], v[48:63]
    ds_read_b64_tr_b16 v[196:197], v4 offset:2048
    v_mfma_f32_32x32x16_bf16 v[64:79], v[204:207], a[124:127], v[64:79]
    ds_read_b64_tr_b16 v[198:199], v4 offset:2560
    s_waitcnt lgkmcnt(4)
    v_mfma_f32_32x32x16_bf16 v[48:63], v[208:211], a[128:131], v[48:63]
    ds_read_b64_tr_b16 v[200:201], v4 offset:4096
    v_mfma_f32_32x32x16_bf16 v[64:79], v[208:211], a[132:135], v[64:79]
    ds_read_b64_tr_b16 v[202:203], v4 offset:4608
    v_mfma_f32_32x32x16_bf16 v[48:63], v[212:215], a[136:139], v[48:63]
    ds_read_b64_tr_b16 v[204:205], v4 offset:6144
    v_mfma_f32_32x32x16_bf16 v[64:79], v[212:215], a[140:143], v[64:79]
    ds_read_b64_tr_b16 v[206:207], v4 offset:6656
    s_waitcnt lgkmcnt(4)
    v_mfma_f32_32x32x16_bf16 v[48:63], v[192:195], a[144:147], v[48:63]
    ds_read_b64_tr_b16 v[208:209], v4 offset:8192
    v_mfma_f32_32x32x16_bf16 v[64:79], v[192:195], a[148:151], v[64:79]
    ds_read_b64_tr_b16 v[210:211], v4 offset:8704
    v_mfma_f32_32x32x16_bf16 v[48:63], v[196:199], a[152:155], v[48:63]
    ds_read_b64_tr_b16 v[212:213], v4 offset:10240
    v_mfma_f32_32x32x16_bf16 v[64:79], v[196:199], a[156:159], v[64:79]
    ds_read_b64_tr_b16 v[214:215], v4 offset:10752
    s_waitcnt lgkmcnt(4)
    v_mfma_f32_32x32x16_bf16 v[48:63], v[200:203], a[160:163], v[48:63]
    ds_read_b64_tr_b16 v[192:193], v4 offset:12288
    v_mfma_f32_32x32x16_bf16 v[64:79], v[200:203], a[164:167], v[64:79]
    ds_read_b64_tr_b16 v[194:195], v4 offset:12800
    v_mfma_f32_32x32x16_bf16 v[48:63], v[204:207], a[168:171], v[48:63]
    ds_read_b64_tr_b16 v[196:197], v4 offset:14336
    v_mfma_f32_32x32x16_bf16 v[64:79], v[204:207], a[172:175], v[64:79]
    ds_read_b64_tr_b16 v[198:199], v4 offset:14848
    s_waitcnt lgkmcnt(4)
    v_mfma_f32_32x32x16_bf16 v[48:63], v[208:211], a[176:179], v[48:63]
    ds_read_b64_tr_b16 v[200:201], v4 offset:16384
    s_waitcnt vmcnt(0)
    s_mov_b32 s51, 0
k1_kernel_pl7:
    v_readfirstlane_b32 s64, v253
    s_nop 0
    s_and_b32 s64, s64, 255
    s_cmp_ge_u32 s64, 32
    s_cbranch_scc1 k1_kernel_pd8
    s_add_u32 s51, s51, 1
    s_cmp_ge_u32 s51, 100000
    s_cbranch_scc1 k1_kernel_pd8
    s_sleep 4
    v_mov_b32 v253, 0
    buffer_atomic_add v253, v252, s[28:31], s63 offen sc0
    s_waitcnt vmcnt(0)
    s_branch k1_kernel_pl7
k1_kernel_pd8:
    v_mfma_f32_32x32x16_bf16 v[64:79], v[208:211], a[180:183], v[64:79]
    ds_read_b64_tr_b16 v[202:203], v4 offset:16896
    buffer_load_dword v216, v13, s[28:31], s59 offen offset:0 sc1
    buffer_load_dword v218, v13, s[28:31], s59 offen offset:256 sc1
    v_mfma_f32_32x32x16_bf16 v[48:63], v[212:215], a[184:187], v[48:63]
    ds_read_b64_tr_b16 v[204:205], v4 offset:18432
    s_barrier
    v_mov_b32 v222, 1
    buffer_atomic_add v222, v251, s[28:31], 0 offen
    v_mfma_f32_32x32x16_bf16 v[64:79], v[212:215], a[188:191], v[64:79]
    ds_read_b64_tr_b16 v[206:207], v4 offset:18944
    s_waitcnt lgkmcnt(4)
    v_mfma_f32_32x32x16_bf16 v[48:63], v[192:195], a[192:195], v[48:63]
    ds_read_b64_tr_b16 v[208:209], v4 offset:20480
    v_mfma_f32_32x32x16_bf16 v[64:79], v[192:195], a[196:199], v[64:79]
    ds_read_b64_tr_b16 v[210:211], v4 offset:20992
    v_mfma_f32_32x32x16_bf16 v[48:63], v[196:199], a[200:203], v[48:63]
    ds_read_b64_tr_b16 v[212:213], v4 offset:22528
    v_mfma_f32_32x32x16_bf16 v[64:79], v[196:199], a[204:207], v[64:79]
    ds_read_b64_tr_b16 v[214:215], v4 offset:23040
    s_waitcnt lgkmcnt(4)
    v_mfma_f32_32x32x16_bf16 v[48:63], v[200:203], a[208:211], v[48:63]
    ds_read_b64_tr_b16 v[192:193], v4 offset:24576
    v_mfma_f32_32x32x16_bf16 v[64:79], v[200:203], a[212:215], v[64:79]
    ds_read_b64_tr_b16 v[194:195], v4 offset:25088
    v_mfma_f32_32x32x16_bf16 v[48:63], v[204:207], a[216:219], v[48:63]
    ds_read_b64_tr_b16 v[196:197], v4 offset:26624
    v_mfma_f32_32x32x16_bf16 v[64:79], v[204:207], a[220:223], v[64:79]
    ds_read_b64_tr_b16 v[198:199], v4 offset:27136
    s_waitcnt lgkmcnt(4)
    v_mfma_f32_32x32x16_bf16 v[48:63], v[208:211], a[224:227], v[48:63]
    ds_read_b64_tr_b16 v[200:201], v4 offset:28672
    v_mfma_f32_32x32x16_bf16 v[64:79], v[208:211], a[228:231], v[64:79]
    ds_read_b64_tr_b16 v[202:203], v4 offset:29184
    v_mfma_f32_32x32x16_bf16 v[48:63], v[212:215], a[232:235], v[48:63]
    ds_read_b64_tr_b16 v[204:205], v4 offset:30720
    v_mfma_f32_32x32x16_bf16 v[64:79], v[212:215], a[236:239], v[64:79]
    ds_read_b64_tr_b16 v[206:207], v4 offset:31232
    s_waitcnt lgkmcnt(4)
    v_mfma_f32_32x32x16_bf16 v[48:63], v[192:195], a[240:243], v[48:63]
    ds_read_b64_tr_b16 v[208:209], v4 offset:32768
    s_waitcnt vmcnt(2)
    v_mov_b32 v217, v216
    s_waitcnt vmcnt(1)
    v_mov_b32 v219, v218
    v_mfma_f32_32x32x16_bf16 v[64:79], v[192:195], a[244:247], v[64:79]
    ds_read_b64_tr_b16 v[210:211], v4 offset:33280
    v_mov_b32 v244, 0x361367a4
    v_mov_b32 v248, 0x361367a4
    v_permlane32_swap_b32 v216, v217
    v_permlane32_swap_b32 v218, v219
    v_mul_f32 v216, 0x39e38e39, v216
    v_mfma_f32_32x32x16_bf16 v[48:63], v[196:199], a[248:251], v[48:63]
    ds_read_b64_tr_b16 v[212:213], v4 offset:34816
    v_mul_f32 v218, 0x39e38e39, v218
    v_fmac_f32 v244, 0x39e38e39, v217
    v_fmac_f32 v248, 0x39e38e39, v219
    v_fma_f32 v244, -v216, v216, v244
    v_fma_f32 v248, -v218, v218, v248
    v_mfma_f32_32x32x16_bf16 v[64:79], v[196:199], a[252:255], v[64:79]
    ds_read_b64_tr_b16 v[214:215], v4 offset:35328
    v_max_f32 v244, 0x361367a4, v244
    v_max_f32 v248, 0x361367a4, v248
    v_rsq_f32 v244, v244
    s_waitcnt lgkmcnt(4)
    v_mfma_f32_32x32x16_bf16 v[48:63], v[200:203], v[160:163], v[48:63]
    ds_read_b64_tr_b16 v[192:193], v2 offset:24576
    v_rsq_f32 v248, v248
    v_mul_f32 v244, 0x40088e99, v244
    v_mul_f32 v248, 0x40088e99, v248
    v_mul_f32 v246, -v216, v244
    v_mfma_f32_32x32x16_bf16 v[64:79], v[200:203], v[164:167], v[64:79]
    ds_read_b64_tr_b16 v[194:195], v2 offset:25088
    v_mul_f32 v250, -v218, v248
    v_lshlrev_b32 v152, 16, v16
    v_and_b32 v153, s62, v16
    v_lshlrev_b32 v154, 16, v17
    v_and_b32 v155, s62, v17
    v_lshlrev_b32 v156, 16, v18
    v_mfma_f32_32x32x16_bf16 v[48:63], v[204:207], v[168:171], v[48:63]
    ds_read_b64_tr_b16 v[196:197], v2 offset:26624
    v_and_b32 v157, s62, v18
    v_lshlrev_b32 v158, 16, v19
    v_and_b32 v159, s62, v19
    v_fma_f32 v152, v152, v244, v246
    v_fma_f32 v153, v153, v244, v246
    v_fma_f32 v154, v154, v244, v246
    v_mfma_f32_32x32x16_bf16 v[64:79], v[204:207], v[172:175], v[64:79]
    ds_read_b64_tr_b16 v[198:199], v2 offset:27136
    v_fma_f32 v155, v155, v244, v246
    v_fma_f32 v156, v156, v244, v246
    v_fma_f32 v157, v157, v244, v246
    v_fma_f32 v158, v158, v244, v246
    v_fma_f32 v159, v159, v244, v246
    s_waitcnt lgkmcnt(4)
    v_mfma_f32_32x32x16_bf16 v[48:63], v[208:211], v[176:179], v[48:63]
    ds_read_b64_tr_b16 v[200:201], v2 offset:28672
    v_cvt_pk_bf16_f32 v16, v152, v153
    v_cvt_pk_bf16_f32 v17, v154, v155
    v_cvt_pk_bf16_f32 v18, v156, v157
    v_cvt_pk_bf16_f32 v19, v158, v159
    buffer_store_dwordx4 v[16:19], v11, s[20:23], s54 offen offset:0 sc1
    v_lshlrev_b32 v152, 16, v20
    v_mfma_f32_32x32x16_bf16 v[64:79], v[208:211], v[180:183], v[64:79]
    ds_read_b64_tr_b16 v[202:203], v2 offset:29184
    v_and_b32 v153, s62, v20
    v_lshlrev_b32 v154, 16, v21
    v_and_b32 v155, s62, v21
    v_lshlrev_b32 v156, 16, v22
    v_and_b32 v157, s62, v22
    v_lshlrev_b32 v158, 16, v23
    v_mfma_f32_32x32x16_bf16 v[48:63], v[212:215], v[184:187], v[48:63]
    ds_read_b64_tr_b16 v[204:205], v2 offset:30720
    v_and_b32 v159, s62, v23
    v_fma_f32 v152, v152, v244, v246
    v_fma_f32 v153, v153, v244, v246
    v_fma_f32 v154, v154, v244, v246
    v_fma_f32 v155, v155, v244, v246
    v_fma_f32 v156, v156, v244, v246
    v_mfma_f32_32x32x16_bf16 v[64:79], v[212:215], v[188:191], v[64:79]
    ds_read_b64_tr_b16 v[206:207], v2 offset:31232
    v_fma_f32 v157, v157, v244, v246
    v_fma_f32 v158, v158, v244, v246
    v_fma_f32 v159, v159, v244, v246
    v_cvt_pk_bf16_f32 v20, v152, v153
    v_cvt_pk_bf16_f32 v21, v154, v155
    s_waitcnt lgkmcnt(4)
    v_mfma_f32_32x32x16_bf16 v[80:95], v[192:195], a[0:3], 0
    ds_read_b64_tr_b16 v[208:209], v2 offset:32768
    v_cvt_pk_bf16_f32 v22, v156, v157
    v_cvt_pk_bf16_f32 v23, v158, v159
    buffer_store_dwordx4 v[20:23], v11, s[20:23], s54 offen offset:256 sc1
    v_lshlrev_b32 v152, 16, v24
    v_and_b32 v153, s62, v24
    v_lshlrev_b32 v154, 16, v25
    v_mfma_f32_32x32x16_bf16 v[96:111], v[192:195], a[4:7], 0
    ds_read_b64_tr_b16 v[210:211], v2 offset:33280
    v_and_b32 v155, s62, v25
    v_lshlrev_b32 v156, 16, v26
    v_and_b32 v157, s62, v26
    v_lshlrev_b32 v158, 16, v27
    v_and_b32 v159, s62, v27
    v_fma_f32 v152, v152, v248, v250
    v_mfma_f32_32x32x16_bf16 v[80:95], v[196:199], a[8:11], v[80:95]
    ds_read_b64_tr_b16 v[212:213], v2 offset:34816
    v_fma_f32 v153, v153, v248, v250
    v_fma_f32 v154, v154, v248, v250
    v_fma_f32 v155, v155, v248, v250
    v_fma_f32 v156, v156, v248, v250
    v_fma_f32 v157, v157, v248, v250
    v_fma_f32 v158, v158, v248, v250
    v_mfma_f32_32x32x16_bf16 v[96:111], v[196:199], a[12:15], v[96:111]
    ds_read_b64_tr_b16 v[214:215], v2 offset:35328
    v_fma_f32 v159, v159, v248, v250
    v_cvt_pk_bf16_f32 v24, v152, v153
    v_cvt_pk_bf16_f32 v25, v154, v155
    v_cvt_pk_bf16_f32 v26, v156, v157
    v_cvt_pk_bf16_f32 v27, v158, v159
    s_waitcnt lgkmcnt(4)
    v_mfma_f32_32x32x16_bf16 v[80:95], v[200:203], a[16:19], v[80:95]
    ds_read_b64_tr_b16 v[192:193], v2 offset:36864
    buffer_store_dwordx4 v[24:27], v11, s[20:23], s55 offen offset:0 sc1
    v_lshlrev_b32 v152, 16, v28
    v_and_b32 v153, s62, v28
    v_lshlrev_b32 v154, 16, v29
    v_and_b32 v155, s62, v29
    v_lshlrev_b32 v156, 16, v30
    v_mfma_f32_32x32x16_bf16 v[96:111], v[200:203], a[20:23], v[96:111]
    ds_read_b64_tr_b16 v[194:195], v2 offset:37376
    v_and_b32 v157, s62, v30
    v_lshlrev_b32 v158, 16, v31
    v_and_b32 v159, s62, v31
    v_fma_f32 v152, v152, v248, v250
    v_fma_f32 v153, v153, v248, v250
    v_fma_f32 v154, v154, v248, v250
    v_mfma_f32_32x32x16_bf16 v[80:95], v[204:207], a[24:27], v[80:95]
    ds_read_b64_tr_b16 v[196:197], v2 offset:38912
    v_fma_f32 v155, v155, v248, v250
    v_fma_f32 v156, v156, v248, v250
    v_fma_f32 v157, v157, v248, v250
    v_fma_f32 v158, v158, v248, v250
    v_fma_f32 v159, v159, v248, v250
    v_cvt_pk_bf16_f32 v28, v152, v153
    v_mfma_f32_32x32x16_bf16 v[96:111], v[204:207], a[28:31], v[96:111]
    ds_read_b64_tr_b16 v[198:199], v2 offset:39424
    v_cvt_pk_bf16_f32 v29, v154, v155
    v_cvt_pk_bf16_f32 v30, v156, v157
    v_cvt_pk_bf16_f32 v31, v158, v159
    buffer_store_dwordx4 v[28:31], v11, s[20:23], s55 offen offset:256 sc1
    v_lshlrev_b32 v152, 16, v32
    s_waitcnt lgkmcnt(4)
    v_mfma_f32_32x32x16_bf16 v[80:95], v[208:211], a[32:35], v[80:95]
    ds_read_b64_tr_b16 v[200:201], v2 offset:40960
    v_and_b32 v153, s62, v32
    v_lshlrev_b32 v154, 16, v33
    v_and_b32 v155, s62, v33
    v_lshlrev_b32 v156, 16, v34
    v_and_b32 v157, s62, v34
    v_lshlrev_b32 v158, 16, v35
    v_mfma_f32_32x32x16_bf16 v[96:111], v[208:211], a[36:39], v[96:111]
    ds_read_b64_tr_b16 v[202:203], v2 offset:41472
    v_and_b32 v159, s62, v35
    v_fma_f32 v152, v152, v244, v246
    v_fma_f32 v153, v153, v244, v246
    v_fma_f32 v154, v154, v244, v246
    v_fma_f32 v155, v155, v244, v246
    v_fma_f32 v156, v156, v244, v246
    v_mfma_f32_32x32x16_bf16 v[80:95], v[212:215], a[40:43], v[80:95]
    ds_read_b64_tr_b16 v[204:205], v2 offset:43008
    v_fma_f32 v157, v157, v244, v246
    v_fma_f32 v158, v158, v244, v246
    v_fma_f32 v159, v159, v244, v246
    v_cvt_pk_bf16_f32 v32, v152, v153
    v_cvt_pk_bf16_f32 v33, v154, v155
    v_cvt_pk_bf16_f32 v34, v156, v157
    v_mfma_f32_32x32x16_bf16 v[96:111], v[212:215], a[44:47], v[96:111]
    ds_read_b64_tr_b16 v[206:207], v2 offset:43520
    v_cvt_pk_bf16_f32 v35, v158, v159
    buffer_store_dwordx4 v[32:35], v11, s[20:23], s54 offen offset:1024 sc1
    v_lshlrev_b32 v152, 16, v36
    v_and_b32 v153, s62, v36
    v_lshlrev_b32 v154, 16, v37
    s_waitcnt lgkmcnt(4)
    v_mfma_f32_32x32x16_bf16 v[80:95], v[192:195], a[48:51], v[80:95]
    ds_read_b64_tr_b16 v[208:209], v2 offset:45056
    v_and_b32 v155, s62, v37
    v_lshlrev_b32 v156, 16, v38
    v_and_b32 v157, s62, v38
    v_lshlrev_b32 v158, 16, v39
    v_and_b32 v159, s62, v39
    v_fma_f32 v152, v152, v244, v246
    v_mfma_f32_32x32x16_bf16 v[96:111], v[192:195], a[52:55], v[96:111]
    ds_read_b64_tr_b16 v[210:211], v2 offset:45568
    v_fma_f32 v153, v153, v244, v246
    v_fma_f32 v154, v154, v244, v246
    v_fma_f32 v155, v155, v244, v246
    v_fma_f32 v156, v156, v244, v246
    v_fma_f32 v157, v157, v244, v246
    v_fma_f32 v158, v158, v244, v246
    v_mfma_f32_32x32x16_bf16 v[80:95], v[196:199], a[56:59], v[80:95]
    ds_read_b64_tr_b16 v[212:213], v2 offset:47104
    v_fma_f32 v159, v159, v244, v246
    v_cvt_pk_bf16_f32 v36, v152, v153
    v_cvt_pk_bf16_f32 v37, v154, v155
    v_cvt_pk_bf16_f32 v38, v156, v157
    v_cvt_pk_bf16_f32 v39, v158, v159
    buffer_store_dwordx4 v[36:39], v11, s[20:23], s54 offen offset:1280 sc1
    v_mfma_f32_32x32x16_bf16 v[96:111], v[196:199], a[60:63], v[96:111]
    ds_read_b64_tr_b16 v[214:215], v2 offset:47616
    v_lshlrev_b32 v152, 16, v40
    v_and_b32 v153, s62, v40
    v_lshlrev_b32 v154, 16, v41
    v_and_b32 v155, s62, v41
    v_lshlrev_b32 v156, 16, v42
    s_waitcnt lgkmcnt(4)
    v_mfma_f32_32x32x16_bf16 v[80:95], v[200:203], a[64:67], v[80:95]
    ds_read_b64_tr_b16 v[192:193], v2 offset:49152
    v_and_b32 v157, s62, v42
    v_lshlrev_b32 v158, 16, v43
    v_and_b32 v159, s62, v43
    v_fma_f32 v152, v152, v248, v250
    v_fma_f32 v153, v153, v248, v250
    v_fma_f32 v154, v154, v248, v250
    v_mfma_f32_32x32x16_bf16 v[96:111], v[200:203], a[68:71], v[96:111]
    ds_read_b64_tr_b16 v[194:195], v2 offset:49664
    v_fma_f32 v155, v155, v248, v250
    v_fma_f32 v156, v156, v248, v250
    v_fma_f32 v157, v157, v248, v250
    v_fma_f32 v158, v158, v248, v250
    v_fma_f32 v159, v159, v248, v250
    v_cvt_pk_bf16_f32 v40, v152, v153
    v_mfma_f32_32x32x16_bf16 v[80:95], v[204:207], a[72:75], v[80:95]
    ds_read_b64_tr_b16 v[196:197], v2 offset:51200
    v_cvt_pk_bf16_f32 v41, v154, v155
    v_cvt_pk_bf16_f32 v42, v156, v157
    v_cvt_pk_bf16_f32 v43, v158, v159
    buffer_store_dwordx4 v[40:43], v11, s[20:23], s55 offen offset:1024 sc1
    v_lshlrev_b32 v152, 16, v44
    v_and_b32 v153, s62, v44
    v_mfma_f32_32x32x16_bf16 v[96:111], v[204:207], a[76:79], v[96:111]
    ds_read_b64_tr_b16 v[198:199], v2 offset:51712
    v_lshlrev_b32 v154, 16, v45
    v_and_b32 v155, s62, v45
    v_lshlrev_b32 v156, 16, v46
    v_and_b32 v157, s62, v46
    v_lshlrev_b32 v158, 16, v47
    s_waitcnt lgkmcnt(4)
    v_mfma_f32_32x32x16_bf16 v[80:95], v[208:211], a[80:83], v[80:95]
    ds_read_b64_tr_b16 v[200:201], v2 offset:53248
    v_and_b32 v159, s62, v47
    v_fma_f32 v152, v152, v248, v250
    v_fma_f32 v153, v153, v248, v250
    v_fma_f32 v154, v154, v248, v250
    v_fma_f32 v155, v155, v248, v250
    v_fma_f32 v156, v156, v248, v250
    v_mfma_f32_32x32x16_bf16 v[96:111], v[208:211], a[84:87], v[96:111]
    ds_read_b64_tr_b16 v[202:203], v2 offset:53760
    v_fma_f32 v157, v157, v248, v250
    v_fma_f32 v158, v158, v248, v250
    v_fma_f32 v159, v159, v248, v250
    v_cvt_pk_bf16_f32 v44, v152, v153
    v_cvt_pk_bf16_f32 v45, v154, v155
    v_cvt_pk_bf16_f32 v46, v156, v157
    v_mfma_f32_32x32x16_bf16 v[80:95], v[212:215], a[88:91], v[80:95]
    ds_read_b64_tr_b16 v[204:205], v2 offset:55296
    v_cvt_pk_bf16_f32 v47, v158, v159
    buffer_store_dwordx4 v[44:47], v11, s[20:23], s55 offen offset:1280 sc1
    v_lshlrev_b32 v152, 16, v144
    v_and_b32 v153, s62, v144
    v_lshlrev_b32 v154, 16, v145
    v_and_b32 v155, s62, v145
    v_mfma_f32_32x32x16_bf16 v[96:111], v[212:215], a[92:95], v[96:111]
    ds_read_b64_tr_b16 v[206:207], v2 offset:55808
    v_lshlrev_b32 v156, 16, v146
    v_and_b32 v157, s62, v146
    v_lshlrev_b32 v158, 16, v147
    v_and_b32 v159, s62, v147
    v_fma_f32 v152, v152, v248, v250
    s_waitcnt lgkmcnt(4)
    v_mfma_f32_32x32x16_bf16 v[80:95], v[192:195], a[96:99], v[80:95]
    ds_read_b64_tr_b16 v[208:209], v2 offset:57344
    v_fma_f32 v153, v153, v248, v250
    v_fma_f32 v154, v154, v248, v250
    v_fma_f32 v155, v155, v248, v250
    v_fma_f32 v156, v156, v248, v250
    v_fma_f32 v157, v157, v248, v250
    v_fma_f32 v158, v158, v248, v250
    v_mfma_f32_32x32x16_bf16 v[96:111], v[192:195], a[100:103], v[96:111]
    ds_read_b64_tr_b16 v[210:211], v2 offset:57856
    v_fma_f32 v159, v159, v248, v250
    v_cvt_pk_bf16_f32 v144, v152, v153
    v_cvt_pk_bf16_f32 v145, v154, v155
    v_cvt_pk_bf16_f32 v146, v156, v157
    v_cvt_pk_bf16_f32 v147, v158, v159
    buffer_store_dwordx4 v[144:147], v11, s[36:39], s56 offen offset:0 sc1
    v_mfma_f32_32x32x16_bf16 v[80:95], v[196:199], a[104:107], v[80:95]
    ds_read_b64_tr_b16 v[212:213], v2 offset:59392
    v_lshlrev_b32 v152, 16, v148
    v_and_b32 v153, s62, v148
    v_lshlrev_b32 v154, 16, v149
    v_and_b32 v155, s62, v149
    v_lshlrev_b32 v156, 16, v150
    v_and_b32 v157, s62, v150
    v_mfma_f32_32x32x16_bf16 v[96:111], v[196:199], a[108:111], v[96:111]
    ds_read_b64_tr_b16 v[214:215], v2 offset:59904
    v_lshlrev_b32 v158, 16, v151
    v_and_b32 v159, s62, v151
    v_fma_f32 v152, v152, v248, v250
    v_fma_f32 v153, v153, v248, v250
    v_fma_f32 v154, v154, v248, v250
    s_waitcnt lgkmcnt(4)
    v_mfma_f32_32x32x16_bf16 v[80:95], v[200:203], a[112:115], v[80:95]
    ds_read_b64_tr_b16 v[192:193], v5 offset:0
    v_fma_f32 v155, v155, v248, v250
    v_fma_f32 v156, v156, v248, v250
    v_fma_f32 v157, v157, v248, v250
    v_fma_f32 v158, v158, v248, v250
    v_fma_f32 v159, v159, v248, v250
    v_cvt_pk_bf16_f32 v148, v152, v153
    v_mfma_f32_32x32x16_bf16 v[96:111], v[200:203], a[116:119], v[96:111]
    ds_read_b64_tr_b16 v[194:195], v5 offset:512
    v_cvt_pk_bf16_f32 v149, v154, v155
    v_cvt_pk_bf16_f32 v150, v156, v157
    v_cvt_pk_bf16_f32 v151, v158, v159
    buffer_store_dwordx4 v[148:151], v11, s[36:39], s56 offen offset:256 sc1
    v_fma_f32 v224, -v48, v48, -s52
    v_fma_f32 v225, -v49, v49, -s52
    v_mfma_f32_32x32x16_bf16 v[80:95], v[204:207], a[120:123], v[80:95]
    ds_read_b64_tr_b16 v[196:197], v5 offset:2048
    v_fma_f32 v226, -v50, v50, -s52
    v_fma_f32 v227, -v51, v51, -s52
    v_mul_f32 v224, v224, v48
    v_mul_f32 v225, v225, v49
    v_mul_f32 v226, v226, v50
    v_mul_f32 v227, v227, v51
    v_mfma_f32_32x32x16_bf16 v[96:111], v[204:207], a[124:127], v[96:111]
    ds_read_b64_tr_b16 v[198:199], v5 offset:2560
    v_exp_f32 v224, v224
    v_exp_f32 v225, v225
    s_waitcnt lgkmcnt(4)
    v_mfma_f32_32x32x16_bf16 v[80:95], v[208:211], a[128:131], v[80:95]
    ds_read_b64_tr_b16 v[200:201], v5 offset:4096
    v_exp_f32 v226, v226
    v_exp_f32 v227, v227
    v_add_f32 v224, 1.0, v224
    v_add_f32 v225, 1.0, v225
    v_add_f32 v226, 1.0, v226
    v_mfma_f32_32x32x16_bf16 v[96:111], v[208:211], a[132:135], v[96:111]
    ds_read_b64_tr_b16 v[202:203], v5 offset:4608
    v_add_f32 v227, 1.0, v227
    v_rcp_f32 v224, v224
    v_rcp_f32 v225, v225
    v_mfma_f32_32x32x16_bf16 v[80:95], v[212:215], a[136:139], v[80:95]
    ds_read_b64_tr_b16 v[204:205], v5 offset:6144
    v_rcp_f32 v226, v226
    v_rcp_f32 v227, v227
    v_mul_f32 v224, v224, v48
    v_mul_f32 v225, v225, v49
    v_mul_f32 v226, v226, v50
    v_mfma_f32_32x32x16_bf16 v[96:111], v[212:215], a[140:143], v[96:111]
    ds_read_b64_tr_b16 v[206:207], v5 offset:6656
    v_mul_f32 v227, v227, v51
    v_cvt_pk_bf16_f32 v236, v224, v225
    v_cvt_pk_bf16_f32 v237, v226, v227
    v_fma_f32 v228, -v52, v52, -s52
    v_fma_f32 v229, -v53, v53, -s52
    s_waitcnt lgkmcnt(4)
    v_mfma_f32_32x32x16_bf16 v[80:95], v[192:195], a[144:147], v[80:95]
    ds_read_b64_tr_b16 v[208:209], v5 offset:8192
    v_fma_f32 v230, -v54, v54, -s52
    v_fma_f32 v231, -v55, v55, -s52
    v_mul_f32 v228, v228, v52
    v_mul_f32 v229, v229, v53
    v_mul_f32 v230, v230, v54
    v_mul_f32 v231, v231, v55
    v_mfma_f32_32x32x16_bf16 v[96:111], v[192:195], a[148:151], v[96:111]
    ds_read_b64_tr_b16 v[210:211], v5 offset:8704
    v_exp_f32 v228, v228
    v_exp_f32 v229, v229
    v_exp_f32 v230, v230
    v_mfma_f32_32x32x16_bf16 v[80:95], v[196:199], a[152:155], v[80:95]
    ds_read_b64_tr_b16 v[212:213], v5 offset:10240
    v_exp_f32 v231, v231
    v_add_f32 v228, 1.0, v228
    v_add_f32 v229, 1.0, v229
    v_add_f32 v230, 1.0, v230
    v_add_f32 v231, 1.0, v231
    v_mfma_f32_32x32x16_bf16 v[96:111], v[196:199], a[156:159], v[96:111]
    ds_read_b64_tr_b16 v[214:215], v5 offset:10752
    v_rcp_f32 v228, v228
    v_rcp_f32 v229, v229
    s_waitcnt lgkmcnt(4)
    v_mfma_f32_32x32x16_bf16 v[80:95], v[200:203], a[160:163], v[80:95]
    ds_read_b64_tr_b16 v[192:193], v5 offset:12288
    v_rcp_f32 v230, v230
    v_rcp_f32 v231, v231
    v_mul_f32 v228, v228, v52
    v_mul_f32 v229, v229, v53
    v_mul_f32 v230, v230, v54
    v_mfma_f32_32x32x16_bf16 v[96:111], v[200:203], a[164:167], v[96:111]
    ds_read_b64_tr_b16 v[194:195], v5 offset:12800
    v_mul_f32 v231, v231, v55
    v_cvt_pk_bf16_f32 v238, v228, v229
    v_cvt_pk_bf16_f32 v239, v230, v231
    buffer_store_dwordx4 v[236:239], v11, s[16:19], s54 offen offset:0 sc1
    v_fma_f32 v224, -v56, v56, -s52
    v_fma_f32 v225, -v57, v57, -s52
    v_mfma_f32_32x32x16_bf16 v[80:95], v[204:207], a[168:171], v[80:95]
    ds_read_b64_tr_b16 v[196:197], v5 offset:14336
    v_fma_f32 v226, -v58, v58, -s52
    v_fma_f32 v227, -v59, v59, -s52
    v_mul_f32 v224, v224, v56
    v_mul_f32 v225, v225, v57
    v_mul_f32 v226, v226, v58
    v_mul_f32 v227, v227, v59
    v_mfma_f32_32x32x16_bf16 v[96:111], v[204:207], a[172:175], v[96:111]
    ds_read_b64_tr_b16 v[198:199], v5 offset:14848
    v_exp_f32 v224, v224
    v_exp_f32 v225, v225
    s_waitcnt lgkmcnt(4)
    v_mfma_f32_32x32x16_bf16 v[80:95], v[208:211], a[176:179], v[80:95]
    ds_read_b64_tr_b16 v[200:201], v5 offset:16384
    v_exp_f32 v226, v226
    v_exp_f32 v227, v227
    v_add_f32 v224, 1.0, v224
    v_add_f32 v225, 1.0, v225
    v_add_f32 v226, 1.0, v226
    v_mfma_f32_32x32x16_bf16 v[96:111], v[208:211], a[180:183], v[96:111]
    ds_read_b64_tr_b16 v[202:203], v5 offset:16896
    v_add_f32 v227, 1.0, v227
    v_rcp_f32 v224, v224
    v_rcp_f32 v225, v225
    v_mfma_f32_32x32x16_bf16 v[80:95], v[212:215], a[184:187], v[80:95]
    ds_read_b64_tr_b16 v[204:205], v5 offset:18432
    v_rcp_f32 v226, v226
    v_rcp_f32 v227, v227
    v_mul_f32 v224, v224, v56
    v_mul_f32 v225, v225, v57
    v_mul_f32 v226, v226, v58
    v_mfma_f32_32x32x16_bf16 v[96:111], v[212:215], a[188:191], v[96:111]
    ds_read_b64_tr_b16 v[206:207], v5 offset:18944
    v_mul_f32 v227, v227, v59
    v_cvt_pk_bf16_f32 v242, v224, v225
    v_cvt_pk_bf16_f32 v243, v226, v227
    v_fma_f32 v228, -v60, v60, -s52
    v_fma_f32 v229, -v61, v61, -s52
    s_waitcnt lgkmcnt(4)
    v_mfma_f32_32x32x16_bf16 v[80:95], v[192:195], a[192:195], v[80:95]
    ds_read_b64_tr_b16 v[208:209], v5 offset:20480
    v_fma_f32 v230, -v62, v62, -s52
    v_fma_f32 v231, -v63, v63, -s52
    v_mul_f32 v228, v228, v60
    v_mul_f32 v229, v229, v61
    v_mul_f32 v230, v230, v62
    v_mul_f32 v231, v231, v63
    v_mfma_f32_32x32x16_bf16 v[96:111], v[192:195], a[196:199], v[96:111]
    ds_read_b64_tr_b16 v[210:211], v5 offset:20992
    v_exp_f32 v228, v228
    v_exp_f32 v229, v229
    v_exp_f32 v230, v230
    v_mfma_f32_32x32x16_bf16 v[80:95], v[196:199], a[200:203], v[80:95]
    ds_read_b64_tr_b16 v[212:213], v5 offset:22528
    v_exp_f32 v231, v231
    v_add_f32 v228, 1.0, v228
    v_add_f32 v229, 1.0, v229
    v_add_f32 v230, 1.0, v230
    v_add_f32 v231, 1.0, v231
    v_mfma_f32_32x32x16_bf16 v[96:111], v[196:199], a[204:207], v[96:111]
    ds_read_b64_tr_b16 v[214:215], v5 offset:23040
    v_rcp_f32 v228, v228
    v_rcp_f32 v229, v229
    s_waitcnt lgkmcnt(4)
    v_mfma_f32_32x32x16_bf16 v[80:95], v[200:203], a[208:211], v[80:95]
    ds_read_b64_tr_b16 v[192:193], v5 offset:24576
    v_rcp_f32 v230, v230
    v_rcp_f32 v231, v231
    v_mul_f32 v228, v228, v60
    v_mul_f32 v229, v229, v61
    v_mul_f32 v230, v230, v62
    v_mfma_f32_32x32x16_bf16 v[96:111], v[200:203], a[212:215], v[96:111]
    ds_read_b64_tr_b16 v[194:195], v5 offset:25088
    v_mul_f32 v231, v231, v63
    v_cvt_pk_bf16_f32 v240, v228, v229
    v_cvt_pk_bf16_f32 v241, v230, v231
    buffer_store_dwordx4 v[240:243], v11, s[16:19], s54 offen offset:256 sc1
    v_mfma_f32_32x32x16_bf16 v[80:95], v[204:207], a[216:219], v[80:95]
    ds_read_b64_tr_b16 v[196:197], v5 offset:26624
    s_waitcnt vmcnt(2)
    s_barrier
    v_mov_b32 v222, 1
    buffer_atomic_add v222, v6, s[28:31], 0 offen
    v_fma_f32 v224, -v64, v64, -s52
    v_fma_f32 v225, -v65, v65, -s52
    v_fma_f32 v226, -v66, v66, -s52
    v_mfma_f32_32x32x16_bf16 v[96:111], v[204:207], a[220:223], v[96:111]
    ds_read_b64_tr_b16 v[198:199], v5 offset:27136
    v_fma_f32 v227, -v67, v67, -s52
    v_mul_f32 v224, v224, v64
    v_mul_f32 v225, v225, v65
    v_mul_f32 v226, v226, v66
    v_mul_f32 v227, v227, v67
    s_waitcnt lgkmcnt(4)
    v_mfma_f32_32x32x16_bf16 v[80:95], v[208:211], a[224:227], v[80:95]
    ds_read_b64_tr_b16 v[200:201], v5 offset:28672
    v_exp_f32 v224, v224
    v_exp_f32 v225, v225
    v_exp_f32 v226, v226
    v_mfma_f32_32x32x16_bf16 v[96:111], v[208:211], a[228:231], v[96:111]
    ds_read_b64_tr_b16 v[202:203], v5 offset:29184
    v_exp_f32 v227, v227
    v_add_f32 v224, 1.0, v224
    v_add_f32 v225, 1.0, v225
    v_add_f32 v226, 1.0, v226
    v_add_f32 v227, 1.0, v227
    v_mfma_f32_32x32x16_bf16 v[80:95], v[212:215], a[232:235], v[80:95]
    ds_read_b64_tr_b16 v[204:205], v5 offset:30720
    v_rcp_f32 v224, v224
    v_rcp_f32 v225, v225
    v_rcp_f32 v226, v226
    v_mfma_f32_32x32x16_bf16 v[96:111], v[212:215], a[236:239], v[96:111]
    ds_read_b64_tr_b16 v[206:207], v5 offset:31232
    v_rcp_f32 v227, v227
    v_mul_f32 v224, v224, v64
    v_mul_f32 v225, v225, v65
    v_mul_f32 v226, v226, v66
    s_waitcnt lgkmcnt(4)
    v_mfma_f32_32x32x16_bf16 v[80:95], v[192:195], a[240:243], v[80:95]
    ds_read_b64_tr_b16 v[208:209], v5 offset:32768
    v_mul_f32 v227, v227, v67
    v_cvt_pk_bf16_f32 v232, v224, v225
    v_cvt_pk_bf16_f32 v233, v226, v227
    v_fma_f32 v228, -v68, v68, -s52
    v_fma_f32 v229, -v69, v69, -s52
    v_fma_f32 v230, -v70, v70, -s52
    v_mfma_f32_32x32x16_bf16 v[96:111], v[192:195], a[244:247], v[96:111]
    ds_read_b64_tr_b16 v[210:211], v5 offset:33280
    v_fma_f32 v231, -v71, v71, -s52
    v_mul_f32 v228, v228, v68
    v_mul_f32 v229, v229, v69
    v_mul_f32 v230, v230, v70
    v_mul_f32 v231, v231, v71
    v_mfma_f32_32x32x16_bf16 v[80:95], v[196:199], a[248:251], v[80:95]
    ds_read_b64_tr_b16 v[212:213], v5 offset:34816
    v_exp_f32 v228, v228
    v_exp_f32 v229, v229
    v_exp_f32 v230, v230
    v_mfma_f32_32x32x16_bf16 v[96:111], v[196:199], a[252:255], v[96:111]
    ds_read_b64_tr_b16 v[214:215], v5 offset:35328
    v_exp_f32 v231, v231
    v_add_f32 v228, 1.0, v228
    v_add_f32 v229, 1.0, v229
    v_add_f32 v230, 1.0, v230
    v_add_f32 v231, 1.0, v231
    s_waitcnt lgkmcnt(4)
    v_mfma_f32_32x32x16_bf16 v[80:95], v[200:203], v[160:163], v[80:95]
    v_rcp_f32 v228, v228
    v_rcp_f32 v229, v229
    v_rcp_f32 v230, v230
    v_mfma_f32_32x32x16_bf16 v[96:111], v[200:203], v[164:167], v[96:111]
    v_rcp_f32 v231, v231
    v_mul_f32 v228, v228, v68
    v_mul_f32 v229, v229, v69
    v_mul_f32 v230, v230, v70
    v_mul_f32 v231, v231, v71
    v_cvt_pk_bf16_f32 v234, v228, v229
    v_cvt_pk_bf16_f32 v235, v230, v231
    v_mfma_f32_32x32x16_bf16 v[80:95], v[204:207], v[168:171], v[80:95]
    buffer_store_dwordx4 v[232:235], v11, s[16:19], s55 offen offset:0 sc1
    v_fma_f32 v224, -v72, v72, -s52
    v_fma_f32 v225, -v73, v73, -s52
    v_fma_f32 v226, -v74, v74, -s52
    v_fma_f32 v227, -v75, v75, -s52
    v_mul_f32 v224, v224, v72
    v_mul_f32 v225, v225, v73
    v_mfma_f32_32x32x16_bf16 v[96:111], v[204:207], v[172:175], v[96:111]
    v_mul_f32 v226, v226, v74
    v_mul_f32 v227, v227, v75
    v_exp_f32 v224, v224
    v_exp_f32 v225, v225
    s_waitcnt lgkmcnt(0)
    v_mfma_f32_32x32x16_bf16 v[80:95], v[208:211], v[176:179], v[80:95]
    v_exp_f32 v226, v226
    v_exp_f32 v227, v227
    v_add_f32 v224, 1.0, v224
    v_add_f32 v225, 1.0, v225
    v_add_f32 v226, 1.0, v226
    v_mfma_f32_32x32x16_bf16 v[96:111], v[208:211], v[180:183], v[96:111]
    v_add_f32 v227, 1.0, v227
    v_rcp_f32 v224, v224
    v_rcp_f32 v225, v225
    v_rcp_f32 v226, v226
    v_mfma_f32_32x32x16_bf16 v[80:95], v[212:215], v[184:187], v[80:95]
    v_rcp_f32 v227, v227
    v_mul_f32 v224, v224, v72
    v_mul_f32 v225, v225, v73
    v_mul_f32 v226, v226, v74
    v_mul_f32 v227, v227, v75
    v_cvt_pk_bf16_f32 v238, v224, v225
    v_mfma_f32_32x32x16_bf16 v[96:111], v[212:215], v[188:191], v[96:111]
    v_cvt_pk_bf16_f32 v239, v226, v227
    v_fma_f32 v228, -v76, v76, -s52
    v_fma_f32 v229, -v77, v77, -s52
    v_fma_f32 v230, -v78, v78, -s52
    v_fma_f32 v231, -v79, v79, -s52
    v_mul_f32 v228, v228, v76
    v_mul_f32 v229, v229, v77
    v_mul_f32 v230, v230, v78
    v_mul_f32 v231, v231, v79
    v_exp_f32 v228, v228
    v_exp_f32 v229, v229
    v_exp_f32 v230, v230
    v_exp_f32 v231, v231
    v_add_f32 v228, 1.0, v228
    v_add_f32 v229, 1.0, v229
    v_add_f32 v230, 1.0, v230
    v_add_f32 v231, 1.0, v231
    v_rcp_f32 v228, v228
    v_rcp_f32 v229, v229
    v_rcp_f32 v230, v230
    v_rcp_f32 v231, v231
    v_mul_f32 v228, v228, v76
    v_mul_f32 v229, v229, v77
    v_mul_f32 v230, v230, v78
    v_mul_f32 v231, v231, v79
    v_cvt_pk_bf16_f32 v236, v228, v229
    v_cvt_pk_bf16_f32 v237, v230, v231
    buffer_store_dwordx4 v[236:239], v11, s[16:19], s55 offen offset:256 sc1
k1_fin:
    s_lshr_b32 s58, s42, 3
    s_lshl_b32 s58, s58, 7
    s_add_u32 s58, s58, 57344
    v_mov_b32 v250, v11
    s_mov_b32 s94, s52
    s_mov_b32 s95, s54
    s_mov_b32 s65, s55
    s_mov_b32 s20, s16
    s_mov_b32 s21, s17
    s_mov_b32 s22, s18
    s_mov_b32 s23, 0x20000
    s_load_dwordx4 s[96:99], s[0:1], 40
    s_load_dwordx2 s[84:85], s[0:1], 80
    s_load_dwordx2 s[86:87], s[0:1], 0
    s_load_dwordx2 s[88:89], s[0:1], 64
    v_lshrrev_b32 v2, 6, v0
    v_and_b32 v1, 63, v0
    v_readfirstlane_b32 s40, v2
    s_and_b32 s45, s2, 7
    s_lshr_b32 s46, s2, 3
    s_cmp_ge_u32 s46, 24
    s_cbranch_scc1 kb_a
    s_and_b32 s41, s45, 1
    s_lshl_b32 s41, s41, 3
    s_and_b32 s47, s46, 7
    s_add_u32 s41, s41, s47
    s_lshr_b32 s42, s45, 1
    s_mul_i32 s42, s42, 3
    s_lshr_b32 s47, s46, 3
    s_add_u32 s42, s42, s47
    s_and_b32 s43, s45, 3
    s_lshl_b32 s43, s43, 3
    s_and_b32 s47, s46, 7
    s_add_u32 s43, s43, s47
    s_lshr_b32 s44, s45, 2
    s_mul_i32 s44, s44, 3
    s_lshr_b32 s47, s46, 3
    s_add_u32 s44, s44, s47
    v_lshrrev_b32 v16, 3, v1
    s_lshl_b32 s45, s40, 5
    v_add_u32 v16, s45, v16
    v_lshlrev_b32 v16, 12, v16
    v_and_b32 v15, 7, v1
    v_lshrrev_b32 v17, 4, v1
    v_xor_b32 v15, v15, v17
    v_lshl_add_u32 v216, v15, 4, v16
    v_xor_b32 v15, 4, v15
    v_lshl_add_u32 v217, v15, 4, v16
    v_add_u32 v217, 31744, v217
    v_add_u32 v218, 63488, v216
    v_add_u32 v219, 63488, v217
    s_lshl_b32 s61, s41, 19
    s_lshl_b32 s63, s40, 12
    v_mov_b32 v15, 2147483632
    v_cmp_eq_u32 vcc, 0, v1
    v_lshlrev_b32 v19, 7, v1
    s_nop 0
    v_cndmask_b32 v222, v15, v1, vcc
    v_cmp_gt_u32 vcc, 8, v1
    s_nop 1
    v_cndmask_b32 v19, v15, v19, vcc
    s_waitcnt lgkmcnt(0)
    s_add_u32 s4, s84, 34603008
    s_addc_u32 s5, s85, 0
    s_mov_b32 s6, 81920
    s_mov_b32 s7, 0x20000
    s_mov_b32 s12, s96
    s_mov_b32 s13, s97
    s_mov_b32 s14, 8388608
    s_mov_b32 s15, 0x20000
    s_barrier
    s_lshl_b32 s48, s42, 7
    s_add_u32 s48, s48, 49152
    s_cmp_lt_u32 s42, 11
    s_cselect_b32 s3, 48, 96
    s_cmp_lt_u32 s42, 10
    s_cselect_b32 s3, 24, s3
    s_cmp_eq_u32 s40, 0
    s_cselect_b32 s3, s3, 0
    s_cselect_b32 s6, s6, 0
    v_mov_b32 v223, 0
    buffer_atomic_add v223, v222, s[4:7], s48 offen sc0
    v_lshrrev_b32 v15, 5, v1
    v_lshlrev_b32 v15, 2, v15
    v_xor_b32 v15, v15, v1
    v_lshlrev_b32 v220, 4, v15
    s_mul_i32 s62, s40, 73728
    s_mul_i32 s45, s42, 6144
    s_add_u32 s62, s62, s45
    s_add_u32 m0, s63, 0
    s_nop 0
    buffer_load_dwordx4 v216, s[12:15], s61 offen offset:0 lds
    s_mul_i32 s64, s40, 6144
    s_add_u32 s64, s64, 16384
    s_and_b32 s50, s40, 1
    s_lshr_b32 s51, s40, 1
    v_and_b32 v16, 15, v1
    v_lshrrev_b32 v15, 4, v1
    v_bfe_u32 v17, v1, 1, 3
    buffer_load_dwordx4 v217, s[12:15], s61 offen offset:1024 lds
    v_xor_b32 v15, v15, v17
    v_lshlrev_b32 v15, 4, v15
    v_lshl_add_u32 v15, v16, 7, v15
    s_lshl_b32 s45, s50, 13
    v_add_u32 v2, s45, v15
    v_xor_b32 v3, 64, v2
    v_lshrrev_b32 v15, 5, v1
    buffer_load_dwordx4 v218, s[12:15], s61 offen offset:2048 lds
    v_mul_u32_u24 v15, 6144, v15
    v_and_b32 v17, 3, v1
    v_lshl_add_u32 v15, v17, 8, v15
    v_bfe_u32 v17, v1, 4, 1
    v_lshlrev_b32 v17, 3, v17
    v_bfe_u32 v18, v1, 2, 2
    v_add_u32 v17, v17, v18
    buffer_load_dwordx4 v219, s[12:15], s61 offen offset:3072 lds
    v_bfe_u32 v18, v1, 1, 1
    v_lshlrev_b32 v18, 2, v18
    v_xor_b32 v17, v17, v18
    v_lshl_add_u32 v15, v17, 4, v15
    v_and_b32 v17, 1, v1
    v_lshl_add_u32 v15, v17, 3, v15
    s_mul_i32 s45, s51, 3072
    s_add_u32 s61, s61, 128
    s_add_u32 m0, s63, 40960
    s_nop 0
    buffer_load_dwordx4 v216, s[12:15], s61 offen offset:0 lds
    s_add_u32 s45, s45, 16384
    v_add_u32 v4, s45, v15
    v_xor_b32 v5, 8, v4
    v_xor_b32 v6, 64, v4
    v_xor_b32 v7, 72, v4
    v_add_u32 v8, 81920, v2
    v_add_u32 v9, 81920, v3
    buffer_load_dwordx4 v217, s[12:15], s61 offen offset:1024 lds
    v_add_u32 v10, 81920, v4
    v_add_u32 v11, 81920, v5
    v_add_u32 v12, 81920, v6
    v_add_u32 v13, 81920, v7
    s_lshl_b32 s55, s41, 1
    s_add_u32 s55, s55, s50
    s_lshl_b32 s55, s55, 7
    buffer_load_dwordx4 v218, s[12:15], s61 offen offset:2048 lds
    s_add_u32 s55, s55, 24576
    v_lshlrev_b32 v14, 4, v1
    s_mov_b32 s47, 0
    s_lshl_b32 s45, s41, 8
    s_lshl_b32 s46, s50, 7
    s_add_u32 s49, s45, s46
    v_lshlrev_b32 v15, 1, v16
    buffer_load_dwordx4 v219, s[12:15], s61 offen offset:3072 lds
    s_add_u32 s61, s61, 128
    s_add_u32 s16, s84, 14680064
    s_addc_u32 s17, s85, 0
    s_mov_b32 s18, 9437184
    s_mov_b32 s19, 0x20000
    s_mov_b32 s28, s98
    s_mov_b32 s29, s99
    s_mov_b32 s30, 4096
    s_mov_b32 s31, 0x20000
    buffer_load_ushort v152, v15, s[28:31], s49 offen offset:0
    buffer_load_ushort v153, v15, s[28:31], s49 offen offset:32
    buffer_load_ushort v154, v15, s[28:31], s49 offen offset:64
    buffer_load_ushort v155, v15, s[28:31], s49 offen offset:96
    s_waitcnt vmcnt(12)
    s_mov_b32 s60, 0
k1_kernel_pl9:
    v_bfe_u32 v223, v223, 0, 8
    v_cmp_gt_u32 vcc, s3, v223
    s_add_u32 s60, s60, 1
    s_and_b32 vcc_lo, vcc_lo, 1
    s_cbranch_scc0 k1_kernel_pd10
    s_cmp_ge_u32 s60, 200000
    s_cbranch_scc1 k1_kernel_pd10
    s_sleep 2
    v_mov_b32 v223, 0
    buffer_atomic_add v223, v222, s[4:7], s48 offen sc0
    s_waitcnt vmcnt(0)
    s_branch k1_kernel_pl9
k1_kernel_pd10:
    s_barrier
    s_add_u32 m0, s64, 0
    s_nop 0
    buffer_load_dwordx4 v220, s[16:19], s62 offen offset:0 sc1 lds
    buffer_load_dwordx4 v220, s[16:19], s62 offen offset:1024 sc1 lds
    buffer_load_dwordx4 v220, s[16:19], s62 offen offset:2048 sc1 lds
    buffer_load_dwordx4 v220, s[16:19], s62 offen offset:3072 sc1 lds
    s_add_u32 m0, s64, 4096
    s_add_u32 s62, s62, 4096
    buffer_load_dwordx4 v220, s[16:19], s62 offen offset:0 sc1 lds
    buffer_load_dwordx4 v220, s[16:19], s62 offen offset:1024 sc1 lds
    s_add_u32 s62, s62, 290816
    v_pk_fma_f32 v[224:225], v[80:81], v[80:81], s[94:95] op_sel_hi:[1,1,0] neg_lo:[1,0,1] neg_hi:[1,0,1]
    v_pk_fma_f32 v[226:227], v[82:83], v[82:83], s[94:95] op_sel_hi:[1,1,0] neg_lo:[1,0,1] neg_hi:[1,0,1]
    v_pk_mul_f32 v[224:225], v[224:225], v[80:81]
    v_pk_mul_f32 v[226:227], v[226:227], v[82:83]
    v_exp_f32 v224, v224
    v_exp_f32 v225, v225
    v_exp_f32 v226, v226
    v_exp_f32 v227, v227
    v_pk_add_f32 v[224:225], v[224:225], 1.0 op_sel_hi:[1,0]
    v_pk_add_f32 v[226:227], v[226:227], 1.0 op_sel_hi:[1,0]
    v_rcp_f32 v224, v224
    v_rcp_f32 v225, v225
    v_rcp_f32 v226, v226
    v_rcp_f32 v227, v227
    v_pk_mul_f32 v[224:225], v[224:225], v[80:81]
    v_pk_mul_f32 v[226:227], v[226:227], v[82:83]
    v_cvt_pk_bf16_f32 v232, v224, v225
    v_cvt_pk_bf16_f32 v233, v226, v227
    v_pk_fma_f32 v[228:229], v[84:85], v[84:85], s[94:95] op_sel_hi:[1,1,0] neg_lo:[1,0,1] neg_hi:[1,0,1]
    v_pk_fma_f32 v[230:231], v[86:87], v[86:87], s[94:95] op_sel_hi:[1,1,0] neg_lo:[1,0,1] neg_hi:[1,0,1]
    v_pk_mul_f32 v[228:229], v[228:229], v[84:85]
    v_pk_mul_f32 v[230:231], v[230:231], v[86:87]
    v_exp_f32 v228, v228
    v_exp_f32 v229, v229
    s_add_u32 m0, s64, 40960
    s_nop 0
    buffer_load_dwordx4 v220, s[16:19], s62 offen offset:0 sc1 lds
    v_exp_f32 v230, v230
    v_exp_f32 v231, v231
    v_pk_add_f32 v[228:229], v[228:229], 1.0 op_sel_hi:[1,0]
    v_pk_add_f32 v[230:231], v[230:231], 1.0 op_sel_hi:[1,0]
    v_rcp_f32 v228, v228
    v_rcp_f32 v229, v229
    v_rcp_f32 v230, v230
    v_rcp_f32 v231, v231
    v_pk_mul_f32 v[228:229], v[228:229], v[84:85]
    v_pk_mul_f32 v[230:231], v[230:231], v[86:87]
    v_cvt_pk_bf16_f32 v234, v228, v229
    v_cvt_pk_bf16_f32 v235, v230, v231
    buffer_store_dwordx4 v[232:235], v250, s[20:23], s95 offen offset:1024 sc1
    v_pk_fma_f32 v[224:225], v[88:89], v[88:89], s[94:95] op_sel_hi:[1,1,0] neg_lo:[1,0,1] neg_hi:[1,0,1]
    v_pk_fma_f32 v[226:227], v[90:91], v[90:91], s[94:95] op_sel_hi:[1,1,0] neg_lo:[1,0,1] neg_hi:[1,0,1]
    v_pk_mul_f32 v[224:225], v[224:225], v[88:89]
    v_pk_mul_f32 v[226:227], v[226:227], v[90:91]
    v_exp_f32 v224, v224
    v_exp_f32 v225, v225
    v_exp_f32 v226, v226
    v_exp_f32 v227, v227
    v_pk_add_f32 v[224:225], v[224:225], 1.0 op_sel_hi:[1,0]
    v_pk_add_f32 v[226:227], v[226:227], 1.0 op_sel_hi:[1,0]
    v_rcp_f32 v224, v224
    buffer_load_dwordx4 v220, s[16:19], s62 offen offset:1024 sc1 lds
    v_rcp_f32 v225, v225
    v_rcp_f32 v226, v226
    v_rcp_f32 v227, v227
    v_pk_mul_f32 v[224:225], v[224:225], v[88:89]
    v_pk_mul_f32 v[226:227], v[226:227], v[90:91]
    v_cvt_pk_bf16_f32 v238, v224, v225
    v_cvt_pk_bf16_f32 v239, v226, v227
    v_pk_fma_f32 v[228:229], v[92:93], v[92:93], s[94:95] op_sel_hi:[1,1,0] neg_lo:[1,0,1] neg_hi:[1,0,1]
    v_pk_fma_f32 v[230:231], v[94:95], v[94:95], s[94:95] op_sel_hi:[1,1,0] neg_lo:[1,0,1] neg_hi:[1,0,1]
    v_pk_mul_f32 v[228:229], v[228:229], v[92:93]
    v_pk_mul_f32 v[230:231], v[230:231], v[94:95]
    v_exp_f32 v228, v228
    v_exp_f32 v229, v229
    v_exp_f32 v230, v230
    v_exp_f32 v231, v231
    v_pk_add_f32 v[228:229], v[228:229], 1.0 op_sel_hi:[1,0]
    v_pk_add_f32 v[230:231], v[230:231], 1.0 op_sel_hi:[1,0]
    v_rcp_f32 v228, v228
    v_rcp_f32 v229, v229
    v_rcp_f32 v230, v230
    v_rcp_f32 v231, v231
    v_pk_mul_f32 v[228:229], v[228:229], v[92:93]
    v_pk_mul_f32 v[230:231], v[230:231], v[94:95]
    v_cvt_pk_bf16_f32 v236, v228, v229
    buffer_load_dwordx4 v220, s[16:19], s62 offen offset:2048 sc1 lds
    v_cvt_pk_bf16_f32 v237, v230, v231
    buffer_store_dwordx4 v[236:239], v250, s[20:23], s95 offen offset:1280 sc1
    v_pk_fma_f32 v[224:225], v[96:97], v[96:97], s[94:95] op_sel_hi:[1,1,0] neg_lo:[1,0,1] neg_hi:[1,0,1]
    v_pk_fma_f32 v[226:227], v[98:99], v[98:99], s[94:95] op_sel_hi:[1,1,0] neg_lo:[1,0,1] neg_hi:[1,0,1]
    v_pk_mul_f32 v[224:225], v[224:225], v[96:97]
    v_pk_mul_f32 v[226:227], v[226:227], v[98:99]
    v_exp_f32 v224, v224
    v_exp_f32 v225, v225
    v_exp_f32 v226, v226
    v_exp_f32 v227, v227
    v_pk_add_f32 v[224:225], v[224:225], 1.0 op_sel_hi:[1,0]
    v_pk_add_f32 v[226:227], v[226:227], 1.0 op_sel_hi:[1,0]
    v_rcp_f32 v224, v224
    v_rcp_f32 v225, v225
    v_rcp_f32 v226, v226
    v_rcp_f32 v227, v227
    v_pk_mul_f32 v[224:225], v[224:225], v[96:97]
    v_pk_mul_f32 v[226:227], v[226:227], v[98:99]
    v_cvt_pk_bf16_f32 v240, v224, v225
    v_cvt_pk_bf16_f32 v241, v226, v227
    v_pk_fma_f32 v[228:229], v[100:101], v[100:101], s[94:95] op_sel_hi:[1,1,0] neg_lo:[1,0,1] neg_hi:[1,0,1]
    v_pk_fma_f32 v[230:231], v[102:103], v[102:103], s[94:95] op_sel_hi:[1,1,0] neg_lo:[1,0,1] neg_hi:[1,0,1]
    v_pk_mul_f32 v[228:229], v[228:229], v[100:101]
    v_pk_mul_f32 v[230:231], v[230:231], v[102:103]
    buffer_load_dwordx4 v220, s[16:19], s62 offen offset:3072 sc1 lds
    v_exp_f32 v228, v228
    v_exp_f32 v229, v229
    v_exp_f32 v230, v230
    v_exp_f32 v231, v231
    v_pk_add_f32 v[228:229], v[228:229], 1.0 op_sel_hi:[1,0]
    v_pk_add_f32 v[230:231], v[230:231], 1.0 op_sel_hi:[1,0]
    v_rcp_f32 v228, v228
    v_rcp_f32 v229, v229
    v_rcp_f32 v230, v230
    v_rcp_f32 v231, v231
    v_pk_mul_f32 v[228:229], v[228:229], v[100:101]
    v_pk_mul_f32 v[230:231], v[230:231], v[102:103]
    v_cvt_pk_bf16_f32 v242, v228, v229
    v_cvt_pk_bf16_f32 v243, v230, v231
    buffer_store_dwordx4 v[240:243], v250, s[20:23], s65 offen offset:1024 sc1
    v_pk_fma_f32 v[224:225], v[104:105], v[104:105], s[94:95] op_sel_hi:[1,1,0] neg_lo:[1,0,1] neg_hi:[1,0,1]
    v_pk_fma_f32 v[226:227], v[106:107], v[106:107], s[94:95] op_sel_hi:[1,1,0] neg_lo:[1,0,1] neg_hi:[1,0,1]
    v_pk_mul_f32 v[224:225], v[224:225], v[104:105]
    v_pk_mul_f32 v[226:227], v[226:227], v[106:107]
    v_exp_f32 v224, v224
    v_exp_f32 v225, v225
    v_exp_f32 v226, v226
    v_exp_f32 v227, v227
    v_pk_add_f32 v[224:225], v[224:225], 1.0 op_sel_hi:[1,0]
    s_add_u32 m0, s64, 45056
    s_add_u32 s62, s62, 4096
    buffer_load_dwordx4 v220, s[16:19], s62 offen offset:0 sc1 lds
    v_pk_add_f32 v[226:227], v[226:227], 1.0 op_sel_hi:[1,0]
    v_rcp_f32 v224, v224
    v_rcp_f32 v225, v225
    v_rcp_f32 v226, v226
    v_rcp_f32 v227, v227
    v_pk_mul_f32 v[224:225], v[224:225], v[104:105]
    v_pk_mul_f32 v[226:227], v[226:227], v[106:107]
    v_cvt_pk_bf16_f32 v234, v224, v225
    v_cvt_pk_bf16_f32 v235, v226, v227
    v_pk_fma_f32 v[228:229], v[108:109], v[108:109], s[94:95] op_sel_hi:[1,1,0] neg_lo:[1,0,1] neg_hi:[1,0,1]
    v_pk_fma_f32 v[230:231], v[110:111], v[110:111], s[94:95] op_sel_hi:[1,1,0] neg_lo:[1,0,1] neg_hi:[1,0,1]
    v_pk_mul_f32 v[228:229], v[228:229], v[108:109]
    v_pk_mul_f32 v[230:231], v[230:231], v[110:111]
    v_exp_f32 v228, v228
    v_exp_f32 v229, v229
    v_exp_f32 v230, v230
    v_exp_f32 v231, v231
    v_pk_add_f32 v[228:229], v[228:229], 1.0 op_sel_hi:[1,0]
    v_pk_add_f32 v[230:231], v[230:231], 1.0 op_sel_hi:[1,0]
    v_rcp_f32 v228, v228
    v_rcp_f32 v229, v229
    v_rcp_f32 v230, v230
    v_rcp_f32 v231, v231
    v_pk_mul_f32 v[228:229], v[228:229], v[108:109]
    v_pk_mul_f32 v[230:231], v[230:231], v[110:111]
    v_cvt_pk_bf16_f32 v232, v228, v229
    v_cvt_pk_bf16_f32 v233, v230, v231
    buffer_store_dwordx4 v[232:235], v250, s[20:23], s65 offen offset:1280 sc1
    s_waitcnt vmcnt(15)
    v_lshlrev_b32 v152, 16, v152
    v_mul_f32 v152, 0x40088e99, v152
    v_lshlrev_b32 v153, 16, v153
    v_mul_f32 v153, 0x40088e99, v153
    buffer_load_dwordx4 v220, s[16:19], s62 offen offset:1024 sc1 lds
    v_lshlrev_b32 v154, 16, v154
    v_mul_f32 v154, 0x40088e99, v154
    v_lshlrev_b32 v155, 16, v155
    v_mul_f32 v155, 0x40088e99, v155
    s_add_u32 s62, s62, 290816
    s_add_u32 m0, s63, 81920
    s_nop 0
    buffer_load_dwordx4 v216, s[12:15], s61 offen offset:0 lds
    v_pk_mov_b32 v[16:17], v[152:153], v[152:153] op_sel:[0,0]
    v_pk_mov_b32 v[18:19], v[152:153], v[152:153] op_sel:[0,0]
    v_pk_mov_b32 v[20:21], v[152:153], v[152:153] op_sel:[1,1]
    v_pk_mov_b32 v[22:23], v[152:153], v[152:153] op_sel:[1,1]
    buffer_load_dwordx4 v217, s[12:15], s61 offen offset:1024 lds
    v_pk_mov_b32 v[24:25], v[154:155], v[154:155] op_sel:[0,0]
    v_pk_mov_b32 v[26:27], v[154:155], v[154:155] op_sel:[0,0]
    v_pk_mov_b32 v[28:29], v[154:155], v[154:155] op_sel:[1,1]
    v_pk_mov_b32 v[30:31], v[154:155], v[154:155] op_sel:[1,1]
    buffer_load_dwordx4 v218, s[12:15], s61 offen offset:2048 lds
    v_pk_mov_b32 v[32:33], v[152:153], v[152:153] op_sel:[0,0]
    v_pk_mov_b32 v[34:35], v[152:153], v[152:153] op_sel:[0,0]
    v_pk_mov_b32 v[36:37], v[152:153], v[152:153] op_sel:[1,1]
    v_pk_mov_b32 v[38:39], v[152:153], v[152:153] op_sel:[1,1]
    buffer_load_dwordx4 v219, s[12:15], s61 offen offset:3072 lds
    v_pk_mov_b32 v[40:41], v[154:155], v[154:155] op_sel:[0,0]
    v_pk_mov_b32 v[42:43], v[154:155], v[154:155] op_sel:[0,0]
    v_pk_mov_b32 v[44:45], v[154:155], v[154:155] op_sel:[1,1]
    v_pk_mov_b32 v[46:47], v[154:155], v[154:155] op_sel:[1,1]
    s_add_u32 s61, s61, 128
    s_add_u32 m0, s64, 81920
    s_nop 0
    buffer_load_dwordx4 v220, s[16:19], s62 offen offset:0 sc1 lds
    v_pk_mov_b32 v[48:49], v[152:153], v[152:153] op_sel:[0,0]
    v_pk_mov_b32 v[50:51], v[152:153], v[152:153] op_sel:[0,0]
    v_pk_mov_b32 v[52:53], v[152:153], v[152:153] op_sel:[1,1]
    v_pk_mov_b32 v[54:55], v[152:153], v[152:153] op_sel:[1,1]
    buffer_load_dwordx4 v220, s[16:19], s62 offen offset:1024 sc1 lds
    v_pk_mov_b32 v[56:57], v[154:155], v[154:155] op_sel:[0,0]
    v_pk_mov_b32 v[58:59], v[154:155], v[154:155] op_sel:[0,0]
    v_pk_mov_b32 v[60:61], v[154:155], v[154:155] op_sel:[1,1]
    v_pk_mov_b32 v[62:63], v[154:155], v[154:155] op_sel:[1,1]
    buffer_load_dwordx4 v220, s[16:19], s62 offen offset:2048 sc1 lds
    v_pk_mov_b32 v[64:65], v[152:153], v[152:153] op_sel:[0,0]
    v_pk_mov_b32 v[66:67], v[152:153], v[152:153] op_sel:[0,0]
    v_pk_mov_b32 v[68:69], v[152:153], v[152:153] op_sel:[1,1]
    v_pk_mov_b32 v[70:71], v[152:153], v[152:153] op_sel:[1,1]
    buffer_load_dwordx4 v220, s[16:19], s62 offen offset:3072 sc1 lds
    v_pk_mov_b32 v[72:73], v[154:155], v[154:155] op_sel:[0,0]
    v_pk_mov_b32 v[74:75], v[154:155], v[154:155] op_sel:[0,0]
    v_pk_mov_b32 v[76:77], v[154:155], v[154:155] op_sel:[1,1]
    v_pk_mov_b32 v[78:79], v[154:155], v[154:155] op_sel:[1,1]
    s_add_u32 m0, s64, 86016
    s_add_u32 s62, s62, 4096
    buffer_load_dwordx4 v220, s[16:19], s62 offen offset:0 sc1 lds
    v_pk_mov_b32 v[80:81], v[152:153], v[152:153] op_sel:[0,0]
    v_pk_mov_b32 v[82:83], v[152:153], v[152:153] op_sel:[0,0]
    v_pk_mov_b32 v[84:85], v[152:153], v[152:153] op_sel:[1,1]
    v_pk_mov_b32 v[86:87], v[152:153], v[152:153] op_sel:[1,1]
    buffer_load_dwordx4 v220, s[16:19], s62 offen offset:1024 sc1 lds
    v_pk_mov_b32 v[88:89], v[154:155], v[154:155] op_sel:[0,0]
    v_pk_mov_b32 v[90:91], v[154:155], v[154:155] op_sel:[0,0]
    v_pk_mov_b32 v[92:93], v[154:155], v[154:155] op_sel:[1,1]
    v_pk_mov_b32 v[94:95], v[154:155], v[154:155] op_sel:[1,1]
    s_add_u32 s62, s62, 290816
    v_pk_mov_b32 v[96:97], v[152:153], v[152:153] op_sel:[0,0]
    v_pk_mov_b32 v[98:99], v[152:153], v[152:153] op_sel:[0,0]
    v_pk_mov_b32 v[100:101], v[152:153], v[152:153] op_sel:[1,1]
    v_pk_mov_b32 v[102:103], v[152:153], v[152:153] op_sel:[1,1]
    v_pk_mov_b32 v[104:105], v[154:155], v[154:155] op_sel:[0,0]
    v_pk_mov_b32 v[106:107], v[154:155], v[154:155] op_sel:[0,0]
    v_pk_mov_b32 v[108:109], v[154:155], v[154:155] op_sel:[1,1]
    v_pk_mov_b32 v[110:111], v[154:155], v[154:155] op_sel:[1,1]
    s_getpc_b64 s[36:37]
k1_kernel_pc11:
    s_add_u32 s36, s36, kb_peel-k1_kernel_pc11
    s_addc_u32 s37, s37, 0
    s_mov_b32 s38, kb_a-kb_peel
    s_mov_b32 s39, 0x20000
    s_bfe_u32 s45, s2, 131075
    s_lshl_b32 s45, s45, 13
    v_lshlrev_b32 v15, 5, v0
    v_add_u32 v15, s45, v15
    s_waitcnt vmcnt(20)
    s_barrier
    v_mov_b32 v221, 1
    ds_read_b128 v[136:139], v2 offset:0
    ds_read_b64_tr_b16 v[112:113], v4 offset:0
    ds_read_b64_tr_b16 v[114:115], v6 offset:0
    ds_read_b128 v[140:143], v2 offset:2048
    ds_read_b128 v[144:147], v2 offset:4096
    ds_read_b128 v[148:151], v2 offset:6144
    ds_read_b64_tr_b16 v[116:117], v5 offset:0
    ds_read_b64_tr_b16 v[118:119], v7 offset:0
    ds_read_b64_tr_b16 v[120:121], v4 offset:1024
    ds_read_b64_tr_b16 v[122:123], v6 offset:1024
    ds_read_b64_tr_b16 v[124:125], v5 offset:1024
    ds_read_b64_tr_b16 v[126:127], v7 offset:1024
    ds_read_b64_tr_b16 v[128:129], v4 offset:2048
    ds_read_b64_tr_b16 v[130:131], v6 offset:2048
    ds_read_b64_tr_b16 v[132:133], v5 offset:2048
    ds_read_b64_tr_b16 v[134:135], v7 offset:2048
    s_add_u32 m0, s63, 122880
    s_nop 0
    buffer_load_dwordx4 v216, s[12:15], s61 offen offset:0 lds
    buffer_load_dwordx4 v217, s[12:15], s61 offen offset:1024 lds
    buffer_load_dwordx4 v218, s[12:15], s61 offen offset:2048 lds
    buffer_load_dwordx4 v219, s[12:15], s61 offen offset:3072 lds
    s_add_u32 s61, s61, 128
    s_add_u32 m0, s64, 122880
    s_nop 0
    buffer_load_dwordx4 v220, s[16:19], s62 offen offset:0 sc1 lds
kb_ml:
    s_waitcnt lgkmcnt(0)
    v_mfma_f32_16x16x32_bf16 v[16:19], v[112:115], v[136:139], v[16:19]
    ds_read_b128 v[176:179], v3 offset:0
    v_mfma_f32_16x16x32_bf16 v[20:23], v[112:115], v[140:143], v[20:23]
    ds_read_b64_tr_b16 v[152:153], v4 offset:12288
    v_mfma_f32_16x16x32_bf16 v[24:27], v[112:115], v[144:147], v[24:27]
    ds_read_b64_tr_b16 v[154:155], v6 offset:12288
    buffer_load_dwordx4 v220, s[16:19], s62 offen offset:1024 sc1 lds
    v_mfma_f32_16x16x32_bf16 v[28:31], v[112:115], v[148:151], v[28:31]
    ds_read_b128 v[180:183], v3 offset:2048
    v_mfma_f32_16x16x32_bf16 v[44:47], v[116:119], v[148:151], v[44:47]
    ds_read_b128 v[184:187], v3 offset:4096
    v_mfma_f32_16x16x32_bf16 v[40:43], v[116:119], v[144:147], v[40:43]
    ds_read_b128 v[188:191], v3 offset:6144
    v_mfma_f32_16x16x32_bf16 v[36:39], v[116:119], v[140:143], v[36:39]
    ds_read_b64_tr_b16 v[156:157], v5 offset:12288
    v_mfma_f32_16x16x32_bf16 v[32:35], v[116:119], v[136:139], v[32:35]
    ds_read_b64_tr_b16 v[158:159], v7 offset:12288
    buffer_load_dwordx4 v220, s[16:19], s62 offen offset:2048 sc1 lds
    v_mfma_f32_16x16x32_bf16 v[48:51], v[120:123], v[136:139], v[48:51]
    ds_read_b64_tr_b16 v[160:161], v4 offset:13312
    v_mfma_f32_16x16x32_bf16 v[52:55], v[120:123], v[140:143], v[52:55]
    ds_read_b64_tr_b16 v[162:163], v6 offset:13312
    v_mfma_f32_16x16x32_bf16 v[56:59], v[120:123], v[144:147], v[56:59]
    ds_read_b64_tr_b16 v[164:165], v5 offset:13312
    v_mfma_f32_16x16x32_bf16 v[60:63], v[120:123], v[148:151], v[60:63]
    ds_read_b64_tr_b16 v[166:167], v7 offset:13312
    v_mfma_f32_16x16x32_bf16 v[76:79], v[124:127], v[148:151], v[76:79]
    ds_read_b64_tr_b16 v[168:169], v4 offset:14336
    buffer_load_dwordx4 v220, s[16:19], s62 offen offset:3072 sc1 lds
    v_mfma_f32_16x16x32_bf16 v[72:75], v[124:127], v[144:147], v[72:75]
    ds_read_b64_tr_b16 v[170:171], v6 offset:14336
    s_add_u32 m0, s64, 126976
    v_mfma_f32_16x16x32_bf16 v[68:71], v[124:127], v[140:143], v[68:71]
    ds_read_b64_tr_b16 v[172:173], v5 offset:14336
    s_add_u32 s62, s62, 4096
    v_mfma_f32_16x16x32_bf16 v[64:67], v[124:127], v[136:139], v[64:67]
    ds_read_b64_tr_b16 v[174:175], v7 offset:14336
    v_mfma_f32_16x16x32_bf16 v[80:83], v[128:131], v[136:139], v[80:83]
    buffer_load_dwordx4 v220, s[16:19], s62 offen offset:0 sc1 lds
    v_mfma_f32_16x16x32_bf16 v[84:87], v[128:131], v[140:143], v[84:87]
    v_mfma_f32_16x16x32_bf16 v[88:91], v[128:131], v[144:147], v[88:91]
    v_mfma_f32_16x16x32_bf16 v[92:95], v[128:131], v[148:151], v[92:95]
    v_mfma_f32_16x16x32_bf16 v[108:111], v[132:135], v[148:151], v[108:111]
    v_mfma_f32_16x16x32_bf16 v[104:107], v[132:135], v[144:147], v[104:107]
    buffer_load_dwordx4 v220, s[16:19], s62 offen offset:1024 sc1 lds
    v_mfma_f32_16x16x32_bf16 v[100:103], v[132:135], v[140:143], v[100:103]
    s_add_u32 s62, s62, 290816
    v_mfma_f32_16x16x32_bf16 v[96:99], v[132:135], v[136:139], v[96:99]
    s_waitcnt vmcnt(20) lgkmcnt(0)
    s_barrier
    v_mfma_f32_16x16x32_bf16 v[16:19], v[152:155], v[176:179], v[16:19]
    ds_read_b128 v[136:139], v2 offset:40960
    s_add_u32 m0, s63, 0
    v_mfma_f32_16x16x32_bf16 v[20:23], v[152:155], v[180:183], v[20:23]
    ds_read_b64_tr_b16 v[112:113], v4 offset:40960
    v_mfma_f32_16x16x32_bf16 v[24:27], v[152:155], v[184:187], v[24:27]
    ds_read_b64_tr_b16 v[114:115], v6 offset:40960
    buffer_load_dwordx4 v216, s[12:15], s61 offen offset:0 lds
    v_mfma_f32_16x16x32_bf16 v[28:31], v[152:155], v[188:191], v[28:31]
    ds_read_b128 v[140:143], v2 offset:43008
    v_mfma_f32_16x16x32_bf16 v[44:47], v[156:159], v[188:191], v[44:47]
    ds_read_b128 v[144:147], v2 offset:45056
    v_mfma_f32_16x16x32_bf16 v[40:43], v[156:159], v[184:187], v[40:43]
    ds_read_b128 v[148:151], v2 offset:47104
    v_mfma_f32_16x16x32_bf16 v[36:39], v[156:159], v[180:183], v[36:39]
    ds_read_b64_tr_b16 v[116:117], v5 offset:40960
    v_mfma_f32_16x16x32_bf16 v[32:35], v[156:159], v[176:179], v[32:35]
    ds_read_b64_tr_b16 v[118:119], v7 offset:40960
    buffer_load_dwordx4 v217, s[12:15], s61 offen offset:1024 lds
    v_mfma_f32_16x16x32_bf16 v[48:51], v[160:163], v[176:179], v[48:51]
    ds_read_b64_tr_b16 v[120:121], v4 offset:41984
    v_mfma_f32_16x16x32_bf16 v[52:55], v[160:163], v[180:183], v[52:55]
    ds_read_b64_tr_b16 v[122:123], v6 offset:41984
    v_mfma_f32_16x16x32_bf16 v[56:59], v[160:163], v[184:187], v[56:59]
    ds_read_b64_tr_b16 v[124:125], v5 offset:41984
    v_mfma_f32_16x16x32_bf16 v[60:63], v[160:163], v[188:191], v[60:63]
    ds_read_b64_tr_b16 v[126:127], v7 offset:41984
    v_mfma_f32_16x16x32_bf16 v[76:79], v[164:167], v[188:191], v[76:79]
    ds_read_b64_tr_b16 v[128:129], v4 offset:43008
    buffer_load_dwordx4 v218, s[12:15], s61 offen offset:2048 lds
    v_mfma_f32_16x16x32_bf16 v[72:75], v[164:167], v[184:187], v[72:75]
    ds_read_b64_tr_b16 v[130:131], v6 offset:43008
    v_mfma_f32_16x16x32_bf16 v[68:71], v[164:167], v[180:183], v[68:71]
    ds_read_b64_tr_b16 v[132:133], v5 offset:43008
    v_mfma_f32_16x16x32_bf16 v[64:67], v[164:167], v[176:179], v[64:67]
    ds_read_b64_tr_b16 v[134:135], v7 offset:43008
    v_mfma_f32_16x16x32_bf16 v[80:83], v[168:171], v[176:179], v[80:83]
    buffer_load_dwordx4 v219, s[12:15], s61 offen offset:3072 lds
    v_mfma_f32_16x16x32_bf16 v[84:87], v[168:171], v[180:183], v[84:87]
    s_add_u32 s61, s61, 128
    v_mfma_f32_16x16x32_bf16 v[88:91], v[168:171], v[184:187], v[88:91]
    s_add_u32 m0, s64, 0
    v_mfma_f32_16x16x32_bf16 v[92:95], v[168:171], v[188:191], v[92:95]
    v_mfma_f32_16x16x32_bf16 v[108:111], v[172:175], v[188:191], v[108:111]
    v_mfma_f32_16x16x32_bf16 v[104:107], v[172:175], v[184:187], v[104:107]
    buffer_load_dwordx4 v220, s[16:19], s62 offen offset:0 sc1 lds
    v_mfma_f32_16x16x32_bf16 v[100:103], v[172:175], v[180:183], v[100:103]
    v_mfma_f32_16x16x32_bf16 v[96:99], v[172:175], v[176:179], v[96:99]
    s_waitcnt lgkmcnt(0)
    v_mfma_f32_16x16x32_bf16 v[16:19], v[112:115], v[136:139], v[16:19]
    ds_read_b128 v[176:179], v3 offset:40960
    v_mfma_f32_16x16x32_bf16 v[20:23], v[112:115], v[140:143], v[20:23]
    ds_read_b64_tr_b16 v[152:153], v4 offset:53248
    v_mfma_f32_16x16x32_bf16 v[24:27], v[112:115], v[144:147], v[24:27]
    ds_read_b64_tr_b16 v[154:155], v6 offset:53248
    buffer_load_dwordx4 v220, s[16:19], s62 offen offset:1024 sc1 lds
    v_mfma_f32_16x16x32_bf16 v[28:31], v[112:115], v[148:151], v[28:31]
    ds_read_b128 v[180:183], v3 offset:43008
    v_mfma_f32_16x16x32_bf16 v[44:47], v[116:119], v[148:151], v[44:47]
    ds_read_b128 v[184:187], v3 offset:45056
    v_mfma_f32_16x16x32_bf16 v[40:43], v[116:119], v[144:147], v[40:43]
    ds_read_b128 v[188:191], v3 offset:47104
    v_mfma_f32_16x16x32_bf16 v[36:39], v[116:119], v[140:143], v[36:39]
    ds_read_b64_tr_b16 v[156:157], v5 offset:53248
    v_mfma_f32_16x16x32_bf16 v[32:35], v[116:119], v[136:139], v[32:35]
    ds_read_b64_tr_b16 v[158:159], v7 offset:53248
    buffer_load_dwordx4 v220, s[16:19], s62 offen offset:2048 sc1 lds
    v_mfma_f32_16x16x32_bf16 v[48:51], v[120:123], v[136:139], v[48:51]
    ds_read_b64_tr_b16 v[160:161], v4 offset:54272
    v_mfma_f32_16x16x32_bf16 v[52:55], v[120:123], v[140:143], v[52:55]
    ds_read_b64_tr_b16 v[162:163], v6 offset:54272
    v_mfma_f32_16x16x32_bf16 v[56:59], v[120:123], v[144:147], v[56:59]
    ds_read_b64_tr_b16 v[164:165], v5 offset:54272
    v_mfma_f32_16x16x32_bf16 v[60:63], v[120:123], v[148:151], v[60:63]
    ds_read_b64_tr_b16 v[166:167], v7 offset:54272
    v_mfma_f32_16x16x32_bf16 v[76:79], v[124:127], v[148:151], v[76:79]
    ds_read_b64_tr_b16 v[168:169], v4 offset:55296
    buffer_load_dwordx4 v220, s[16:19], s62 offen offset:3072 sc1 lds
    v_mfma_f32_16x16x32_bf16 v[72:75], v[124:127], v[144:147], v[72:75]
    ds_read_b64_tr_b16 v[170:171], v6 offset:55296
    s_add_u32 m0, s64, 4096
    v_mfma_f32_16x16x32_bf16 v[68:71], v[124:127], v[140:143], v[68:71]
    ds_read_b64_tr_b16 v[172:173], v5 offset:55296
    s_add_u32 s62, s62, 4096
    v_mfma_f32_16x16x32_bf16 v[64:67], v[124:127], v[136:139], v[64:67]
    ds_read_b64_tr_b16 v[174:175], v7 offset:55296
    v_mfma_f32_16x16x32_bf16 v[80:83], v[128:131], v[136:139], v[80:83]
    buffer_load_dwordx4 v220, s[16:19], s62 offen offset:0 sc1 lds
    v_mfma_f32_16x16x32_bf16 v[84:87], v[128:131], v[140:143], v[84:87]
    v_mfma_f32_16x16x32_bf16 v[88:91], v[128:131], v[144:147], v[88:91]
    v_mfma_f32_16x16x32_bf16 v[92:95], v[128:131], v[148:151], v[92:95]
    v_mfma_f32_16x16x32_bf16 v[108:111], v[132:135], v[148:151], v[108:111]
    v_mfma_f32_16x16x32_bf16 v[104:107], v[132:135], v[144:147], v[104:107]
    buffer_load_dwordx4 v220, s[16:19], s62 offen offset:1024 sc1 lds
    v_mfma_f32_16x16x32_bf16 v[100:103], v[132:135], v[140:143], v[100:103]
    s_add_u32 s62, s62, 290816
    v_mfma_f32_16x16x32_bf16 v[96:99], v[132:135], v[136:139], v[96:99]
    s_waitcnt vmcnt(20) lgkmcnt(0)
    s_barrier
    v_mfma_f32_16x16x32_bf16 v[16:19], v[152:155], v[176:179], v[16:19]
    ds_read_b128 v[136:139], v8 offset:0
    s_add_u32 m0, s63, 40960
    v_mfma_f32_16x16x32_bf16 v[20:23], v[152:155], v[180:183], v[20:23]
    ds_read_b64_tr_b16 v[112:113], v10 offset:0
    buffer_load_dword v223, v15, s[36:39], 0 offen
    v_mfma_f32_16x16x32_bf16 v[24:27], v[152:155], v[184:187], v[24:27]
    ds_read_b64_tr_b16 v[114:115], v12 offset:0
    buffer_load_dwordx4 v216, s[12:15], s61 offen offset:0 lds
    v_mfma_f32_16x16x32_bf16 v[28:31], v[152:155], v[188:191], v[28:31]
    ds_read_b128 v[140:143], v8 offset:2048
    v_mfma_f32_16x16x32_bf16 v[44:47], v[156:159], v[188:191], v[44:47]
    ds_read_b128 v[144:147], v8 offset:4096
    v_mfma_f32_16x16x32_bf16 v[40:43], v[156:159], v[184:187], v[40:43]
    ds_read_b128 v[148:151], v8 offset:6144
    v_mfma_f32_16x16x32_bf16 v[36:39], v[156:159], v[180:183], v[36:39]
    ds_read_b64_tr_b16 v[116:117], v11 offset:0
    v_mfma_f32_16x16x32_bf16 v[32:35], v[156:159], v[176:179], v[32:35]
    ds_read_b64_tr_b16 v[118:119], v13 offset:0
    buffer_load_dwordx4 v217, s[12:15], s61 offen offset:1024 lds
    v_mfma_f32_16x16x32_bf16 v[48:51], v[160:163], v[176:179], v[48:51]
    ds_read_b64_tr_b16 v[120:121], v10 offset:1024
    v_mfma_f32_16x16x32_bf16 v[52:55], v[160:163], v[180:183], v[52:55]
    ds_read_b64_tr_b16 v[122:123], v12 offset:1024
    v_mfma_f32_16x16x32_bf16 v[56:59], v[160:163], v[184:187], v[56:59]
    ds_read_b64_tr_b16 v[124:125], v11 offset:1024
    v_mfma_f32_16x16x32_bf16 v[60:63], v[160:163], v[188:191], v[60:63]
    ds_read_b64_tr_b16 v[126:127], v13 offset:1024
    v_mfma_f32_16x16x32_bf16 v[76:79], v[164:167], v[188:191], v[76:79]
    ds_read_b64_tr_b16 v[128:129], v10 offset:2048
    buffer_load_dwordx4 v218, s[12:15], s61 offen offset:2048 lds
    v_mfma_f32_16x16x32_bf16 v[72:75], v[164:167], v[184:187], v[72:75]
    ds_read_b64_tr_b16 v[130:131], v12 offset:2048
    v_mfma_f32_16x16x32_bf16 v[68:71], v[164:167], v[180:183], v[68:71]
    ds_read_b64_tr_b16 v[132:133], v11 offset:2048
    v_mfma_f32_16x16x32_bf16 v[64:67], v[164:167], v[176:179], v[64:67]
    ds_read_b64_tr_b16 v[134:135], v13 offset:2048
    v_mfma_f32_16x16x32_bf16 v[80:83], v[168:171], v[176:179], v[80:83]
    buffer_load_dwordx4 v219, s[12:15], s61 offen offset:3072 lds
    v_mfma_f32_16x16x32_bf16 v[84:87], v[168:171], v[180:183], v[84:87]
    s_add_u32 s61, s61, 128
    v_mfma_f32_16x16x32_bf16 v[88:91], v[168:171], v[184:187], v[88:91]
    s_add_u32 m0, s64, 40960
    v_mfma_f32_16x16x32_bf16 v[92:95], v[168:171], v[188:191], v[92:95]
    v_mfma_f32_16x16x32_bf16 v[108:111], v[172:175], v[188:191], v[108:111]
    v_mfma_f32_16x16x32_bf16 v[104:107], v[172:175], v[184:187], v[104:107]
    buffer_load_dwordx4 v220, s[16:19], s62 offen offset:0 sc1 lds
    v_mfma_f32_16x16x32_bf16 v[100:103], v[172:175], v[180:183], v[100:103]
    v_mfma_f32_16x16x32_bf16 v[96:99], v[172:175], v[176:179], v[96:99]
    s_waitcnt lgkmcnt(0)
    v_mfma_f32_16x16x32_bf16 v[16:19], v[112:115], v[136:139], v[16:19]
    ds_read_b128 v[176:179], v9 offset:0
    v_mfma_f32_16x16x32_bf16 v[20:23], v[112:115], v[140:143], v[20:23]
    ds_read_b64_tr_b16 v[152:153], v10 offset:12288
    v_mfma_f32_16x16x32_bf16 v[24:27], v[112:115], v[144:147], v[24:27]
    ds_read_b64_tr_b16 v[154:155], v12 offset:12288
    buffer_load_dwordx4 v220, s[16:19], s62 offen offset:1024 sc1 lds
    v_mfma_f32_16x16x32_bf16 v[28:31], v[112:115], v[148:151], v[28:31]
    ds_read_b128 v[180:183], v9 offset:2048
    v_mfma_f32_16x16x32_bf16 v[44:47], v[116:119], v[148:151], v[44:47]
    ds_read_b128 v[184:187], v9 offset:4096
    v_mfma_f32_16x16x32_bf16 v[40:43], v[116:119], v[144:147], v[40:43]
    ds_read_b128 v[188:191], v9 offset:6144
    v_mfma_f32_16x16x32_bf16 v[36:39], v[116:119], v[140:143], v[36:39]
    ds_read_b64_tr_b16 v[156:157], v11 offset:12288
    v_mfma_f32_16x16x32_bf16 v[32:35], v[116:119], v[136:139], v[32:35]
    ds_read_b64_tr_b16 v[158:159], v13 offset:12288
    buffer_load_dwordx4 v220, s[16:19], s62 offen offset:2048 sc1 lds
    v_mfma_f32_16x16x32_bf16 v[48:51], v[120:123], v[136:139], v[48:51]
    ds_read_b64_tr_b16 v[160:161], v10 offset:13312
    v_mfma_f32_16x16x32_bf16 v[52:55], v[120:123], v[140:143], v[52:55]
    ds_read_b64_tr_b16 v[162:163], v12 offset:13312
    v_mfma_f32_16x16x32_bf16 v[56:59], v[120:123], v[144:147], v[56:59]
    ds_read_b64_tr_b16 v[164:165], v11 offset:13312
    v_mfma_f32_16x16x32_bf16 v[60:63], v[120:123], v[148:151], v[60:63]
    ds_read_b64_tr_b16 v[166:167], v13 offset:13312
    v_mfma_f32_16x16x32_bf16 v[76:79], v[124:127], v[148:151], v[76:79]
    ds_read_b64_tr_b16 v[168:169], v10 offset:14336
    buffer_load_dwordx4 v220, s[16:19], s62 offen offset:3072 sc1 lds
    v_mfma_f32_16x16x32_bf16 v[72:75], v[124:127], v[144:147], v[72:75]
    ds_read_b64_tr_b16 v[170:171], v12 offset:14336
    s_add_u32 m0, s64, 45056
    v_mfma_f32_16x16x32_bf16 v[68:71], v[124:127], v[140:143], v[68:71]
    ds_read_b64_tr_b16 v[172:173], v11 offset:14336
    s_add_u32 s62, s62, 4096
    v_mfma_f32_16x16x32_bf16 v[64:67], v[124:127], v[136:139], v[64:67]
    ds_read_b64_tr_b16 v[174:175], v13 offset:14336
    v_mfma_f32_16x16x32_bf16 v[80:83], v[128:131], v[136:139], v[80:83]
    buffer_load_dwordx4 v220, s[16:19], s62 offen offset:0 sc1 lds
    v_mfma_f32_16x16x32_bf16 v[84:87], v[128:131], v[140:143], v[84:87]
    v_mfma_f32_16x16x32_bf16 v[88:91], v[128:131], v[144:147], v[88:91]
    v_mfma_f32_16x16x32_bf16 v[92:95], v[128:131], v[148:151], v[92:95]
    v_mfma_f32_16x16x32_bf16 v[108:111], v[132:135], v[148:151], v[108:111]
    v_mfma_f32_16x16x32_bf16 v[104:107], v[132:135], v[144:147], v[104:107]
    buffer_load_dwordx4 v220, s[16:19], s62 offen offset:1024 sc1 lds
    v_mfma_f32_16x16x32_bf16 v[100:103], v[132:135], v[140:143], v[100:103]
    s_add_u32 s62, s62, 290816
    v_mfma_f32_16x16x32_bf16 v[96:99], v[132:135], v[136:139], v[96:99]
    s_waitcnt vmcnt(20) lgkmcnt(0)
    s_barrier
    v_mfma_f32_16x16x32_bf16 v[16:19], v[152:155], v[176:179], v[16:19]
    ds_read_b128 v[136:139], v8 offset:40960
    s_add_u32 m0, s63, 81920
    v_mfma_f32_16x16x32_bf16 v[20:23], v[152:155], v[180:183], v[20:23]
    ds_read_b64_tr_b16 v[112:113], v10 offset:40960
    s_cmp_eq_u32 s47, 0
    s_cbranch_scc0 kb_ns
    buffer_atomic_add v221, v222, s[4:7], s58 offen
kb_ns:
    v_mfma_f32_16x16x32_bf16 v[24:27], v[152:155], v[184:187], v[24:27]
    ds_read_b64_tr_b16 v[114:115], v12 offset:40960
    buffer_load_dwordx4 v216, s[12:15], s61 offen offset:0 lds
    v_mfma_f32_16x16x32_bf16 v[28:31], v[152:155], v[188:191], v[28:31]
    ds_read_b128 v[140:143], v8 offset:43008
    v_mfma_f32_16x16x32_bf16 v[44:47], v[156:159], v[188:191], v[44:47]
    ds_read_b128 v[144:147], v8 offset:45056
    v_mfma_f32_16x16x32_bf16 v[40:43], v[156:159], v[184:187], v[40:43]
    ds_read_b128 v[148:151], v8 offset:47104
    v_mfma_f32_16x16x32_bf16 v[36:39], v[156:159], v[180:183], v[36:39]
    ds_read_b64_tr_b16 v[116:117], v11 offset:40960
    v_mfma_f32_16x16x32_bf16 v[32:35], v[156:159], v[176:179], v[32:35]
    ds_read_b64_tr_b16 v[118:119], v13 offset:40960
    buffer_load_dwordx4 v217, s[12:15], s61 offen offset:1024 lds
    v_mfma_f32_16x16x32_bf16 v[48:51], v[160:163], v[176:179], v[48:51]
    ds_read_b64_tr_b16 v[120:121], v10 offset:41984
    v_mfma_f32_16x16x32_bf16 v[52:55], v[160:163], v[180:183], v[52:55]
    ds_read_b64_tr_b16 v[122:123], v12 offset:41984
    v_mfma_f32_16x16x32_bf16 v[56:59], v[160:163], v[184:187], v[56:59]
    ds_read_b64_tr_b16 v[124:125], v11 offset:41984
    v_mfma_f32_16x16x32_bf16 v[60:63], v[160:163], v[188:191], v[60:63]
    ds_read_b64_tr_b16 v[126:127], v13 offset:41984
    v_mfma_f32_16x16x32_bf16 v[76:79], v[164:167], v[188:191], v[76:79]
    ds_read_b64_tr_b16 v[128:129], v10 offset:43008
    buffer_load_dwordx4 v218, s[12:15], s61 offen offset:2048 lds
    v_mfma_f32_16x16x32_bf16 v[72:75], v[164:167], v[184:187], v[72:75]
    ds_read_b64_tr_b16 v[130:131], v12 offset:43008
    v_mfma_f32_16x16x32_bf16 v[68:71], v[164:167], v[180:183], v[68:71]
    ds_read_b64_tr_b16 v[132:133], v11 offset:43008
    v_mfma_f32_16x16x32_bf16 v[64:67], v[164:167], v[176:179], v[64:67]
    ds_read_b64_tr_b16 v[134:135], v13 offset:43008
    v_mfma_f32_16x16x32_bf16 v[80:83], v[168:171], v[176:179], v[80:83]
    buffer_load_dwordx4 v219, s[12:15], s61 offen offset:3072 lds
    v_mfma_f32_16x16x32_bf16 v[84:87], v[168:171], v[180:183], v[84:87]
    s_add_u32 s61, s61, 128
    v_mfma_f32_16x16x32_bf16 v[88:91], v[168:171], v[184:187], v[88:91]
    s_add_u32 m0, s64, 81920
    v_mfma_f32_16x16x32_bf16 v[92:95], v[168:171], v[188:191], v[92:95]
    v_mfma_f32_16x16x32_bf16 v[108:111], v[172:175], v[188:191], v[108:111]
    v_mfma_f32_16x16x32_bf16 v[104:107], v[172:175], v[184:187], v[104:107]
    buffer_load_dwordx4 v220, s[16:19], s62 offen offset:0 sc1 lds
    v_mfma_f32_16x16x32_bf16 v[100:103], v[172:175], v[180:183], v[100:103]
    v_mfma_f32_16x16x32_bf16 v[96:99], v[172:175], v[176:179], v[96:99]
    s_waitcnt lgkmcnt(0)
    v_mfma_f32_16x16x32_bf16 v[16:19], v[112:115], v[136:139], v[16:19]
    ds_read_b128 v[176:179], v9 offset:40960
    v_mfma_f32_16x16x32_bf16 v[20:23], v[112:115], v[140:143], v[20:23]
    ds_read_b64_tr_b16 v[152:153], v10 offset:53248
    v_mfma_f32_16x16x32_bf16 v[24:27], v[112:115], v[144:147], v[24:27]
    ds_read_b64_tr_b16 v[154:155], v12 offset:53248
    buffer_load_dwordx4 v220, s[16:19], s62 offen offset:1024 sc1 lds
    v_mfma_f32_16x16x32_bf16 v[28:31], v[112:115], v[148:151], v[28:31]
    ds_read_b128 v[180:183], v9 offset:43008
    v_mfma_f32_16x16x32_bf16 v[44:47], v[116:119], v[148:151], v[44:47]
    ds_read_b128 v[184:187], v9 offset:45056
    v_mfma_f32_16x16x32_bf16 v[40:43], v[116:119], v[144:147], v[40:43]
    ds_read_b128 v[188:191], v9 offset:47104
    v_mfma_f32_16x16x32_bf16 v[36:39], v[116:119], v[140:143], v[36:39]
    ds_read_b64_tr_b16 v[156:157], v11 offset:53248
    v_mfma_f32_16x16x32_bf16 v[32:35], v[116:119], v[136:139], v[32:35]
    ds_read_b64_tr_b16 v[158:159], v13 offset:53248
    buffer_load_dwordx4 v220, s[16:19], s62 offen offset:2048 sc1 lds
    v_mfma_f32_16x16x32_bf16 v[48:51], v[120:123], v[136:139], v[48:51]
    ds_read_b64_tr_b16 v[160:161], v10 offset:54272
    v_mfma_f32_16x16x32_bf16 v[52:55], v[120:123], v[140:143], v[52:55]
    ds_read_b64_tr_b16 v[162:163], v12 offset:54272
    v_mfma_f32_16x16x32_bf16 v[56:59], v[120:123], v[144:147], v[56:59]
    ds_read_b64_tr_b16 v[164:165], v11 offset:54272
    v_mfma_f32_16x16x32_bf16 v[60:63], v[120:123], v[148:151], v[60:63]
    ds_read_b64_tr_b16 v[166:167], v13 offset:54272
    v_mfma_f32_16x16x32_bf16 v[76:79], v[124:127], v[148:151], v[76:79]
    ds_read_b64_tr_b16 v[168:169], v10 offset:55296
    buffer_load_dwordx4 v220, s[16:19], s62 offen offset:3072 sc1 lds
    v_mfma_f32_16x16x32_bf16 v[72:75], v[124:127], v[144:147], v[72:75]
    ds_read_b64_tr_b16 v[170:171], v12 offset:55296
    s_add_u32 m0, s64, 86016
    v_mfma_f32_16x16x32_bf16 v[68:71], v[124:127], v[140:143], v[68:71]
    ds_read_b64_tr_b16 v[172:173], v11 offset:55296
    s_add_u32 s62, s62, 4096
    v_mfma_f32_16x16x32_bf16 v[64:67], v[124:127], v[136:139], v[64:67]
    ds_read_b64_tr_b16 v[174:175], v13 offset:55296
    v_mfma_f32_16x16x32_bf16 v[80:83], v[128:131], v[136:139], v[80:83]
    buffer_load_dwordx4 v220, s[16:19], s62 offen offset:0 sc1 lds
    v_mfma_f32_16x16x32_bf16 v[84:87], v[128:131], v[140:143], v[84:87]
    v_mfma_f32_16x16x32_bf16 v[88:91], v[128:131], v[144:147], v[88:91]
    v_mfma_f32_16x16x32_bf16 v[92:95], v[128:131], v[148:151], v[92:95]
    v_mfma_f32_16x16x32_bf16 v[108:111], v[132:135], v[148:151], v[108:111]
    v_mfma_f32_16x16x32_bf16 v[104:107], v[132:135], v[144:147], v[104:107]
    buffer_load_dwordx4 v220, s[16:19], s62 offen offset:1024 sc1 lds
    v_mfma_f32_16x16x32_bf16 v[100:103], v[132:135], v[140:143], v[100:103]
    s_add_u32 s62, s62, 290816
    v_mfma_f32_16x16x32_bf16 v[96:99], v[132:135], v[136:139], v[96:99]
    s_waitcnt vmcnt(20) lgkmcnt(0)
    s_barrier
    v_mfma_f32_16x16x32_bf16 v[16:19], v[152:155], v[176:179], v[16:19]
    ds_read_b128 v[136:139], v2 offset:0
    s_add_u32 m0, s63, 122880
    v_mfma_f32_16x16x32_bf16 v[20:23], v[152:155], v[180:183], v[20:23]
    ds_read_b64_tr_b16 v[112:113], v4 offset:0
    s_add_u32 s47, s47, 4
    v_mfma_f32_16x16x32_bf16 v[24:27], v[152:155], v[184:187], v[24:27]
    ds_read_b64_tr_b16 v[114:115], v6 offset:0
    buffer_load_dwordx4 v216, s[12:15], s61 offen offset:0 lds
    v_mfma_f32_16x16x32_bf16 v[28:31], v[152:155], v[188:191], v[28:31]
    ds_read_b128 v[140:143], v2 offset:2048
    v_mfma_f32_16x16x32_bf16 v[44:47], v[156:159], v[188:191], v[44:47]
    ds_read_b128 v[144:147], v2 offset:4096
    v_mfma_f32_16x16x32_bf16 v[40:43], v[156:159], v[184:187], v[40:43]
    ds_read_b128 v[148:151], v2 offset:6144
    v_mfma_f32_16x16x32_bf16 v[36:39], v[156:159], v[180:183], v[36:39]
    ds_read_b64_tr_b16 v[116:117], v5 offset:0
    v_mfma_f32_16x16x32_bf16 v[32:35], v[156:159], v[176:179], v[32:35]
    ds_read_b64_tr_b16 v[118:119], v7 offset:0
    buffer_load_dwordx4 v217, s[12:15], s61 offen offset:1024 lds
    v_mfma_f32_16x16x32_bf16 v[48:51], v[160:163], v[176:179], v[48:51]
    ds_read_b64_tr_b16 v[120:121], v4 offset:1024
    v_mfma_f32_16x16x32_bf16 v[52:55], v[160:163], v[180:183], v[52:55]
    ds_read_b64_tr_b16 v[122:123], v6 offset:1024
    v_mfma_f32_16x16x32_bf16 v[56:59], v[160:163], v[184:187], v[56:59]
    ds_read_b64_tr_b16 v[124:125], v5 offset:1024
    v_mfma_f32_16x16x32_bf16 v[60:63], v[160:163], v[188:191], v[60:63]
    ds_read_b64_tr_b16 v[126:127], v7 offset:1024
    v_mfma_f32_16x16x32_bf16 v[76:79], v[164:167], v[188:191], v[76:79]
    ds_read_b64_tr_b16 v[128:129], v4 offset:2048
    buffer_load_dwordx4 v218, s[12:15], s61 offen offset:2048 lds
    v_mfma_f32_16x16x32_bf16 v[72:75], v[164:167], v[184:187], v[72:75]
    ds_read_b64_tr_b16 v[130:131], v6 offset:2048
    v_mfma_f32_16x16x32_bf16 v[68:71], v[164:167], v[180:183], v[68:71]
    ds_read_b64_tr_b16 v[132:133], v5 offset:2048
    v_mfma_f32_16x16x32_bf16 v[64:67], v[164:167], v[176:179], v[64:67]
    ds_read_b64_tr_b16 v[134:135], v7 offset:2048
    v_mfma_f32_16x16x32_bf16 v[80:83], v[168:171], v[176:179], v[80:83]
    buffer_load_dwordx4 v219, s[12:15], s61 offen offset:3072 lds
    v_mfma_f32_16x16x32_bf16 v[84:87], v[168:171], v[180:183], v[84:87]
    s_add_u32 s61, s61, 128
    v_mfma_f32_16x16x32_bf16 v[88:91], v[168:171], v[184:187], v[88:91]
    s_add_u32 m0, s64, 122880
    v_mfma_f32_16x16x32_bf16 v[92:95], v[168:171], v[188:191], v[92:95]
    v_mfma_f32_16x16x32_bf16 v[108:111], v[172:175], v[188:191], v[108:111]
    v_mfma_f32_16x16x32_bf16 v[104:107], v[172:175], v[184:187], v[104:107]
    buffer_load_dwordx4 v220, s[16:19], s62 offen offset:0 sc1 lds
    v_mfma_f32_16x16x32_bf16 v[100:103], v[172:175], v[180:183], v[100:103]
    v_mfma_f32_16x16x32_bf16 v[96:99], v[172:175], v[176:179], v[96:99]
    s_cmp_lt_u32 s47, 24
    s_cbranch_scc1 kb_ml
kb_peel:
    s_waitcnt lgkmcnt(0)
    v_mfma_f32_16x16x32_bf16 v[16:19], v[112:115], v[136:139], v[16:19]
    ds_read_b128 v[176:179], v3 offset:0
    s_add_u32 s8, s84, 35651584
    s_addc_u32 s9, s85, 0
    v_mfma_f32_16x16x32_bf16 v[20:23], v[112:115], v[140:143], v[20:23]
    ds_read_b64_tr_b16 v[152:153], v4 offset:12288
    s_mov_b32 s10, 9437184
    v_mfma_f32_16x16x32_bf16 v[24:27], v[112:115], v[144:147], v[24:27]
    ds_read_b64_tr_b16 v[154:155], v6 offset:12288
    buffer_load_dwordx4 v220, s[16:19], s62 offen offset:1024 sc1 lds
    v_mfma_f32_16x16x32_bf16 v[28:31], v[112:115], v[148:151], v[28:31]
    ds_read_b128 v[180:183], v3 offset:2048
    s_mov_b32 s11, 0x20000
    v_mfma_f32_16x16x32_bf16 v[44:47], v[116:119], v[148:151], v[44:47]
    ds_read_b128 v[184:187], v3 offset:4096
    s_add_u32 s24, s84, 50331648
    s_addc_u32 s25, s85, 0
    v_mfma_f32_16x16x32_bf16 v[40:43], v[116:119], v[144:147], v[40:43]
    ds_read_b128 v[188:191], v3 offset:6144
    s_mov_b32 s26, 3317760
    v_mfma_f32_16x16x32_bf16 v[36:39], v[116:119], v[140:143], v[36:39]
    ds_read_b64_tr_b16 v[156:157], v5 offset:12288
    s_mov_b32 s27, 0x20000
    v_mfma_f32_16x16x32_bf16 v[32:35], v[116:119], v[136:139], v[32:35]
    ds_read_b64_tr_b16 v[158:159], v7 offset:12288
    buffer_load_dwordx4 v220, s[16:19], s62 offen offset:2048 sc1 lds
    v_mfma_f32_16x16x32_bf16 v[48:51], v[120:123], v[136:139], v[48:51]
    ds_read_b64_tr_b16 v[160:161], v4 offset:13312
    s_add_u32 s20, s84, 4194304
    s_addc_u32 s21, s85, 0
    v_mfma_f32_16x16x32_bf16 v[52:55], v[120:123], v[140:143], v[52:55]
    ds_read_b64_tr_b16 v[162:163], v6 offset:13312
    s_mov_b32 s22, 9437184
    v_mfma_f32_16x16x32_bf16 v[56:59], v[120:123], v[144:147], v[56:59]
    ds_read_b64_tr_b16 v[164:165], v5 offset:13312
    s_mov_b32 s23, 0x20000
    v_mfma_f32_16x16x32_bf16 v[60:63], v[120:123], v[148:151], v[60:63]
    ds_read_b64_tr_b16 v[166:167], v7 offset:13312
    s_add_u32 s36, s84, 54525952
    s_addc_u32 s37, s85, 0
    v_mfma_f32_16x16x32_bf16 v[76:79], v[124:127], v[148:151], v[76:79]
    ds_read_b64_tr_b16 v[168:169], v4 offset:14336
    buffer_load_dwordx4 v220, s[16:19], s62 offen offset:3072 sc1 lds
    v_mfma_f32_16x16x32_bf16 v[72:75], v[124:127], v[144:147], v[72:75]
    ds_read_b64_tr_b16 v[170:171], v6 offset:14336
    s_add_u32 m0, s64, 126976
    v_mfma_f32_16x16x32_bf16 v[68:71], v[124:127], v[140:143], v[68:71]
    ds_read_b64_tr_b16 v[172:173], v5 offset:14336
    s_add_u32 s62, s62, 4096
    v_mfma_f32_16x16x32_bf16 v[64:67], v[124:127], v[136:139], v[64:67]
    ds_read_b64_tr_b16 v[174:175], v7 offset:14336
    s_mov_b32 s38, 2359296
    v_mfma_f32_16x16x32_bf16 v[80:83], v[128:131], v[136:139], v[80:83]
    buffer_load_dwordx4 v220, s[16:19], s62 offen offset:0 sc1 lds
    s_mov_b32 s39, 0x20000
    v_mfma_f32_16x16x32_bf16 v[84:87], v[128:131], v[140:143], v[84:87]
    s_mov_b32 s28, s86
    s_mov_b32 s29, s87
    s_mov_b32 s30, 2359296
    v_mfma_f32_16x16x32_bf16 v[88:91], v[128:131], v[144:147], v[88:91]
    s_mov_b32 s31, 0x20000
    s_mov_b32 s32, s88
    s_mov_b32 s33, s89
    v_mfma_f32_16x16x32_bf16 v[92:95], v[128:131], v[148:151], v[92:95]
    s_mov_b32 s34, 2359296
    s_mov_b32 s35, 0x20000
    v_mfma_f32_16x16x32_bf16 v[108:111], v[132:135], v[148:151], v[108:111]
    s_mov_b32 s6, 81920
    s_mul_i32 s45, s40, 18
    v_mfma_f32_16x16x32_bf16 v[104:107], v[132:135], v[144:147], v[104:107]
    buffer_load_dwordx4 v220, s[16:19], s62 offen offset:1024 sc1 lds
    s_mul_i32 s53, s45, 36864
    v_mfma_f32_16x16x32_bf16 v[100:103], v[132:135], v[140:143], v[100:103]
    s_add_u32 s62, s62, 290816
    s_mul_i32 s46, s44, 6144
    v_mfma_f32_16x16x32_bf16 v[96:99], v[132:135], v[136:139], v[96:99]
    s_add_u32 s53, s53, s46
    s_lshl_b32 s52, s45, 10
    s_waitcnt vmcnt(20)
    s_waitcnt lgkmcnt(0)
    s_barrier
    v_mfma_f32_16x16x32_bf16 v[16:19], v[152:155], v[176:179], v[16:19]
    ds_read_b128 v[136:139], v2 offset:40960
    s_add_u32 m0, s63, 0
    v_mfma_f32_16x16x32_bf16 v[20:23], v[152:155], v[180:183], v[20:23]
    ds_read_b64_tr_b16 v[112:113], v4 offset:40960
    s_mul_i32 s46, s43, 294912
    v_mfma_f32_16x16x32_bf16 v[24:27], v[152:155], v[184:187], v[24:27]
    ds_read_b64_tr_b16 v[114:115], v6 offset:40960
    buffer_load_dwordx4 v216, s[12:15], s61 offen offset:0 lds
    v_mfma_f32_16x16x32_bf16 v[28:31], v[152:155], v[188:191], v[28:31]
    ds_read_b128 v[140:143], v2 offset:43008
    s_add_u32 s52, s52, s46
    v_mfma_f32_16x16x32_bf16 v[44:47], v[156:159], v[188:191], v[44:47]
    ds_read_b128 v[144:147], v2 offset:45056
    s_lshl_b32 s54, s43, 7
    v_mfma_f32_16x16x32_bf16 v[40:43], v[156:159], v[184:187], v[40:43]
    ds_read_b128 v[148:151], v2 offset:47104
    s_add_u32 s54, s54, 24576
    v_mfma_f32_16x16x32_bf16 v[36:39], v[156:159], v[180:183], v[36:39]
    ds_read_b64_tr_b16 v[116:117], v5 offset:40960
    s_mov_b32 s57, 32768
    v_mfma_f32_16x16x32_bf16 v[32:35], v[156:159], v[176:179], v[32:35]
    ds_read_b64_tr_b16 v[118:119], v7 offset:40960
    buffer_load_dwordx4 v217, s[12:15], s61 offen offset:1024 lds
    v_mfma_f32_16x16x32_bf16 v[48:51], v[160:163], v[176:179], v[48:51]
    ds_read_b64_tr_b16 v[120:121], v4 offset:41984
    s_lshr_b32 s48, s41, 1
    v_mfma_f32_16x16x32_bf16 v[52:55], v[160:163], v[180:183], v[52:55]
    ds_read_b64_tr_b16 v[122:123], v6 offset:41984
    s_lshl_b32 s48, s48, 7
    v_mfma_f32_16x16x32_bf16 v[56:59], v[160:163], v[184:187], v[56:59]
    ds_read_b64_tr_b16 v[124:125], v5 offset:41984
    s_add_u32 s48, s48, 57344
    v_mfma_f32_16x16x32_bf16 v[60:63], v[160:163], v[188:191], v[60:63]
    ds_read_b64_tr_b16 v[126:127], v7 offset:41984
    s_xor_b32 s45, s40, 0
    v_mfma_f32_16x16x32_bf16 v[76:79], v[164:167], v[188:191], v[76:79]
    ds_read_b64_tr_b16 v[128:129], v4 offset:43008
    buffer_load_dwordx4 v218, s[12:15], s61 offen offset:2048 lds
    v_mfma_f32_16x16x32_bf16 v[72:75], v[164:167], v[184:187], v[72:75]
    ds_read_b64_tr_b16 v[130:131], v6 offset:43008
    s_mul_i32 s45, s45, 73728
    v_mfma_f32_16x16x32_bf16 v[68:71], v[164:167], v[180:183], v[68:71]
    ds_read_b64_tr_b16 v[132:133], v5 offset:43008
    v_add_u32 v244, s45, v14
    v_mfma_f32_16x16x32_bf16 v[64:67], v[164:167], v[176:179], v[64:67]
    ds_read_b64_tr_b16 v[134:135], v7 offset:43008
    s_xor_b32 s45, s40, 1
    v_mfma_f32_16x16x32_bf16 v[80:83], v[168:171], v[176:179], v[80:83]
    buffer_load_dwordx4 v219, s[12:15], s61 offen offset:3072 lds
    s_mul_i32 s45, s45, 73728
    v_mfma_f32_16x16x32_bf16 v[84:87], v[168:171], v[180:183], v[84:87]
    s_add_u32 s61, s61, 128
    v_add_u32 v245, s45, v14
    v_mfma_f32_16x16x32_bf16 v[88:91], v[168:171], v[184:187], v[88:91]
    s_add_u32 m0, s64, 0
    s_xor_b32 s45, s40, 2
    v_mfma_f32_16x16x32_bf16 v[92:95], v[168:171], v[188:191], v[92:95]
    s_mul_i32 s45, s45, 73728
    v_add_u32 v246, s45, v14
    v_mfma_f32_16x16x32_bf16 v[108:111], v[172:175], v[188:191], v[108:111]
    s_xor_b32 s45, s40, 3
    s_mul_i32 s45, s45, 73728
    v_mfma_f32_16x16x32_bf16 v[104:107], v[172:175], v[184:187], v[104:107]
    buffer_load_dwordx4 v220, s[16:19], s62 offen offset:0 sc1 lds
    v_add_u32 v247, s45, v14
    v_mfma_f32_16x16x32_bf16 v[100:103], v[172:175], v[180:183], v[100:103]
    v_mfma_f32_16x16x32_bf16 v[96:99], v[172:175], v[176:179], v[96:99]
    s_waitcnt lgkmcnt(0)
    buffer_load_dword v223, v222, s[4:7], s57 offen sc1
    v_mfma_f32_16x16x32_bf16 v[16:19], v[112:115], v[136:139], v[16:19]
    ds_read_b128 v[176:179], v3 offset:40960
    v_mfma_f32_16x16x32_bf16 v[20:23], v[112:115], v[140:143], v[20:23]
    ds_read_b64_tr_b16 v[152:153], v4 offset:53248
    v_mfma_f32_16x16x32_bf16 v[24:27], v[112:115], v[144:147], v[24:27]
    ds_read_b64_tr_b16 v[154:155], v6 offset:53248
    buffer_load_dwordx4 v220, s[16:19], s62 offen offset:1024 sc1 lds
    v_mfma_f32_16x16x32_bf16 v[28:31], v[112:115], v[148:151], v[28:31]
    ds_read_b128 v[180:183], v3 offset:43008
    v_mfma_f32_16x16x32_bf16 v[44:47], v[116:119], v[148:151], v[44:47]
    ds_read_b128 v[184:187], v3 offset:45056
    v_mfma_f32_16x16x32_bf16 v[40:43], v[116:119], v[144:147], v[40:43]
    ds_read_b128 v[188:191], v3 offset:47104
    v_mfma_f32_16x16x32_bf16 v[36:39], v[116:119], v[140:143], v[36:39]
    ds_read_b64_tr_b16 v[156:157], v5 offset:53248
    v_mfma_f32_16x16x32_bf16 v[32:35], v[116:119], v[136:139], v[32:35]
    ds_read_b64_tr_b16 v[158:159], v7 offset:53248
    buffer_load_dwordx4 v220, s[16:19], s62 offen offset:2048 sc1 lds
    v_mfma_f32_16x16x32_bf16 v[48:51], v[120:123], v[136:139], v[48:51]
    ds_read_b64_tr_b16 v[160:161], v4 offset:54272
    v_mfma_f32_16x16x32_bf16 v[52:55], v[120:123], v[140:143], v[52:55]
    ds_read_b64_tr_b16 v[162:163], v6 offset:54272
    v_mfma_f32_16x16x32_bf16 v[56:59], v[120:123], v[144:147], v[56:59]
    ds_read_b64_tr_b16 v[164:165], v5 offset:54272
    v_mfma_f32_16x16x32_bf16 v[60:63], v[120:123], v[148:151], v[60:63]
    ds_read_b64_tr_b16 v[166:167], v7 offset:54272
    v_mfma_f32_16x16x32_bf16 v[76:79], v[124:127], v[148:151], v[76:79]
    ds_read_b64_tr_b16 v[168:169], v4 offset:55296
    buffer_load_dwordx4 v220, s[16:19], s62 offen offset:3072 sc1 lds
    v_mfma_f32_16x16x32_bf16 v[72:75], v[124:127], v[144:147], v[72:75]
    ds_read_b64_tr_b16 v[170:171], v6 offset:55296
    s_add_u32 m0, s64, 4096
    v_mfma_f32_16x16x32_bf16 v[68:71], v[124:127], v[140:143], v[68:71]
    ds_read_b64_tr_b16 v[172:173], v5 offset:55296
    s_add_u32 s62, s62, 4096
    v_mfma_f32_16x16x32_bf16 v[64:67], v[124:127], v[136:139], v[64:67]
    ds_read_b64_tr_b16 v[174:175], v7 offset:55296
    v_mfma_f32_16x16x32_bf16 v[80:83], v[128:131], v[136:139], v[80:83]
    buffer_load_dwordx4 v220, s[16:19], s62 offen offset:0 sc1 lds
    v_mfma_f32_16x16x32_bf16 v[84:87], v[128:131], v[140:143], v[84:87]
    v_mfma_f32_16x16x32_bf16 v[88:91], v[128:131], v[144:147], v[88:91]
    v_mfma_f32_16x16x32_bf16 v[92:95], v[128:131], v[148:151], v[92:95]
    v_mfma_f32_16x16x32_bf16 v[108:111], v[132:135], v[148:151], v[108:111]
    v_mfma_f32_16x16x32_bf16 v[104:107], v[132:135], v[144:147], v[104:107]
    buffer_load_dwordx4 v220, s[16:19], s62 offen offset:1024 sc1 lds
    v_mfma_f32_16x16x32_bf16 v[100:103], v[132:135], v[140:143], v[100:103]
    s_add_u32 s62, s62, 290816
    v_mfma_f32_16x16x32_bf16 v[96:99], v[132:135], v[136:139], v[96:99]
    s_waitcnt vmcnt(21)
    s_waitcnt lgkmcnt(0)
    s_barrier
    v_mfma_f32_16x16x32_bf16 v[16:19], v[152:155], v[176:179], v[16:19]
    ds_read_b128 v[136:139], v8 offset:0
    s_add_u32 m0, s63, 40960
    v_mfma_f32_16x16x32_bf16 v[20:23], v[152:155], v[180:183], v[20:23]
    ds_read_b64_tr_b16 v[112:113], v10 offset:0
    v_mfma_f32_16x16x32_bf16 v[24:27], v[152:155], v[184:187], v[24:27]
    ds_read_b64_tr_b16 v[114:115], v12 offset:0
    buffer_load_dwordx4 v216, s[12:15], s61 offen offset:0 lds
    v_mfma_f32_16x16x32_bf16 v[28:31], v[152:155], v[188:191], v[28:31]
    ds_read_b128 v[140:143], v8 offset:2048
    v_mfma_f32_16x16x32_bf16 v[44:47], v[156:159], v[188:191], v[44:47]
    ds_read_b128 v[144:147], v8 offset:4096
    v_mfma_f32_16x16x32_bf16 v[40:43], v[156:159], v[184:187], v[40:43]
    ds_read_b128 v[148:151], v8 offset:6144
    v_mfma_f32_16x16x32_bf16 v[36:39], v[156:159], v[180:183], v[36:39]
    ds_read_b64_tr_b16 v[116:117], v11 offset:0
    v_mfma_f32_16x16x32_bf16 v[32:35], v[156:159], v[176:179], v[32:35]
    ds_read_b64_tr_b16 v[118:119], v13 offset:0
    buffer_load_dwordx4 v217, s[12:15], s61 offen offset:1024 lds
    v_mfma_f32_16x16x32_bf16 v[48:51], v[160:163], v[176:179], v[48:51]
    ds_read_b64_tr_b16 v[120:121], v10 offset:1024
    v_mfma_f32_16x16x32_bf16 v[52:55], v[160:163], v[180:183], v[52:55]
    ds_read_b64_tr_b16 v[122:123], v12 offset:1024
    v_mfma_f32_16x16x32_bf16 v[56:59], v[160:163], v[184:187], v[56:59]
    ds_read_b64_tr_b16 v[124:125], v11 offset:1024
    v_mfma_f32_16x16x32_bf16 v[60:63], v[160:163], v[188:191], v[60:63]
    ds_read_b64_tr_b16 v[126:127], v13 offset:1024
    v_mfma_f32_16x16x32_bf16 v[76:79], v[164:167], v[188:191], v[76:79]
    ds_read_b64_tr_b16 v[128:129], v10 offset:2048
    buffer_load_dwordx4 v218, s[12:15], s61 offen offset:2048 lds
    v_mfma_f32_16x16x32_bf16 v[72:75], v[164:167], v[184:187], v[72:75]
    ds_read_b64_tr_b16 v[130:131], v12 offset:2048
    v_mfma_f32_16x16x32_bf16 v[68:71], v[164:167], v[180:183], v[68:71]
    ds_read_b64_tr_b16 v[132:133], v11 offset:2048
    v_mfma_f32_16x16x32_bf16 v[64:67], v[164:167], v[176:179], v[64:67]
    ds_read_b64_tr_b16 v[134:135], v13 offset:2048
    v_mfma_f32_16x16x32_bf16 v[80:83], v[168:171], v[176:179], v[80:83]
    buffer_load_dwordx4 v219, s[12:15], s61 offen offset:3072 lds
    v_mfma_f32_16x16x32_bf16 v[84:87], v[168:171], v[180:183], v[84:87]
    s_add_u32 s61, s61, 128
    v_mfma_f32_16x16x32_bf16 v[88:91], v[168:171], v[184:187], v[88:91]
    s_add_u32 m0, s64, 40960
    v_mfma_f32_16x16x32_bf16 v[92:95], v[168:171], v[188:191], v[92:95]
    v_mfma_f32_16x16x32_bf16 v[108:111], v[172:175], v[188:191], v[108:111]
    v_mfma_f32_16x16x32_bf16 v[104:107], v[172:175], v[184:187], v[104:107]
    buffer_load_dwordx4 v220, s[16:19], s62 offen offset:0 sc1 lds
    v_mfma_f32_16x16x32_bf16 v[100:103], v[172:175], v[180:183], v[100:103]
    v_mfma_f32_16x16x32_bf16 v[96:99], v[172:175], v[176:179], v[96:99]
    s_waitcnt lgkmcnt(0)
    v_mfma_f32_16x16x32_bf16 v[16:19], v[112:115], v[136:139], v[16:19]
    ds_read_b128 v[176:179], v9 offset:0
    v_mfma_f32_16x16x32_bf16 v[20:23], v[112:115], v[140:143], v[20:23]
    ds_read_b64_tr_b16 v[152:153], v10 offset:12288
    v_mfma_f32_16x16x32_bf16 v[24:27], v[112:115], v[144:147], v[24:27]
    ds_read_b64_tr_b16 v[154:155], v12 offset:12288
    buffer_load_dwordx4 v220, s[16:19], s62 offen offset:1024 sc1 lds
    v_mfma_f32_16x16x32_bf16 v[28:31], v[112:115], v[148:151], v[28:31]
    ds_read_b128 v[180:183], v9 offset:2048
    v_mfma_f32_16x16x32_bf16 v[44:47], v[116:119], v[148:151], v[44:47]
    ds_read_b128 v[184:187], v9 offset:4096
    v_mfma_f32_16x16x32_bf16 v[40:43], v[116:119], v[144:147], v[40:43]
    ds_read_b128 v[188:191], v9 offset:6144
    v_mfma_f32_16x16x32_bf16 v[36:39], v[116:119], v[140:143], v[36:39]
    ds_read_b64_tr_b16 v[156:157], v11 offset:12288
    v_mfma_f32_16x16x32_bf16 v[32:35], v[116:119], v[136:139], v[32:35]
    ds_read_b64_tr_b16 v[158:159], v13 offset:12288
    buffer_load_dwordx4 v220, s[16:19], s62 offen offset:2048 sc1 lds
    v_mfma_f32_16x16x32_bf16 v[48:51], v[120:123], v[136:139], v[48:51]
    ds_read_b64_tr_b16 v[160:161], v10 offset:13312
    v_mfma_f32_16x16x32_bf16 v[52:55], v[120:123], v[140:143], v[52:55]
    ds_read_b64_tr_b16 v[162:163], v12 offset:13312
    v_mfma_f32_16x16x32_bf16 v[56:59], v[120:123], v[144:147], v[56:59]
    ds_read_b64_tr_b16 v[164:165], v11 offset:13312
    v_mfma_f32_16x16x32_bf16 v[60:63], v[120:123], v[148:151], v[60:63]
    ds_read_b64_tr_b16 v[166:167], v13 offset:13312
    v_mfma_f32_16x16x32_bf16 v[76:79], v[124:127], v[148:151], v[76:79]
    ds_read_b64_tr_b16 v[168:169], v10 offset:14336
    buffer_load_dwordx4 v220, s[16:19], s62 offen offset:3072 sc1 lds
    v_mfma_f32_16x16x32_bf16 v[72:75], v[124:127], v[144:147], v[72:75]
    ds_read_b64_tr_b16 v[170:171], v12 offset:14336
    s_add_u32 m0, s64, 45056
    v_mfma_f32_16x16x32_bf16 v[68:71], v[124:127], v[140:143], v[68:71]
    ds_read_b64_tr_b16 v[172:173], v11 offset:14336
    s_add_u32 s62, s62, 4096
    v_mfma_f32_16x16x32_bf16 v[64:67], v[124:127], v[136:139], v[64:67]
    ds_read_b64_tr_b16 v[174:175], v13 offset:14336
    v_mfma_f32_16x16x32_bf16 v[80:83], v[128:131], v[136:139], v[80:83]
    buffer_load_dwordx4 v220, s[16:19], s62 offen offset:0 sc1 lds
    v_mfma_f32_16x16x32_bf16 v[84:87], v[128:131], v[140:143], v[84:87]
    v_mfma_f32_16x16x32_bf16 v[88:91], v[128:131], v[144:147], v[88:91]
    v_mfma_f32_16x16x32_bf16 v[92:95], v[128:131], v[148:151], v[92:95]
    v_mfma_f32_16x16x32_bf16 v[108:111], v[132:135], v[148:151], v[108:111]
    v_mfma_f32_16x16x32_bf16 v[104:107], v[132:135], v[144:147], v[104:107]
    buffer_load_dwordx4 v220, s[16:19], s62 offen offset:1024 sc1 lds
    v_mfma_f32_16x16x32_bf16 v[100:103], v[132:135], v[140:143], v[100:103]
    s_add_u32 s62, s62, 290816
    v_mfma_f32_16x16x32_bf16 v[96:99], v[132:135], v[136:139], v[96:99]
    s_waitcnt vmcnt(21)
    s_waitcnt lgkmcnt(0)
    s_barrier
    v_mfma_f32_16x16x32_bf16 v[16:19], v[152:155], v[176:179], v[16:19]
    ds_read_b128 v[136:139], v8 offset:40960
    s_add_u32 m0, s63, 81920
    v_mfma_f32_16x16x32_bf16 v[20:23], v[152:155], v[180:183], v[20:23]
    ds_read_b64_tr_b16 v[112:113], v10 offset:40960
    v_mfma_f32_16x16x32_bf16 v[24:27], v[152:155], v[184:187], v[24:27]
    ds_read_b64_tr_b16 v[114:115], v12 offset:40960
    buffer_load_dwordx4 v216, s[12:15], s61 offen offset:0 lds
    v_mfma_f32_16x16x32_bf16 v[28:31], v[152:155], v[188:191], v[28:31]
    ds_read_b128 v[140:143], v8 offset:43008
    v_mfma_f32_16x16x32_bf16 v[44:47], v[156:159], v[188:191], v[44:47]
    ds_read_b128 v[144:147], v8 offset:45056
    v_mfma_f32_16x16x32_bf16 v[40:43], v[156:159], v[184:187], v[40:43]
    ds_read_b128 v[148:151], v8 offset:47104
    v_mfma_f32_16x16x32_bf16 v[36:39], v[156:159], v[180:183], v[36:39]
    ds_read_b64_tr_b16 v[116:117], v11 offset:40960
    v_mfma_f32_16x16x32_bf16 v[32:35], v[156:159], v[176:179], v[32:35]
    ds_read_b64_tr_b16 v[118:119], v13 offset:40960
    buffer_load_dwordx4 v217, s[12:15], s61 offen offset:1024 lds
    v_mfma_f32_16x16x32_bf16 v[48:51], v[160:163], v[176:179], v[48:51]
    ds_read_b64_tr_b16 v[120:121], v10 offset:41984
    v_mfma_f32_16x16x32_bf16 v[52:55], v[160:163], v[180:183], v[52:55]
    ds_read_b64_tr_b16 v[122:123], v12 offset:41984
    v_mfma_f32_16x16x32_bf16 v[56:59], v[160:163], v[184:187], v[56:59]
    ds_read_b64_tr_b16 v[124:125], v11 offset:41984
    v_mfma_f32_16x16x32_bf16 v[60:63], v[160:163], v[188:191], v[60:63]
    ds_read_b64_tr_b16 v[126:127], v13 offset:41984
    v_mfma_f32_16x16x32_bf16 v[76:79], v[164:167], v[188:191], v[76:79]
    ds_read_b64_tr_b16 v[128:129], v10 offset:43008
    buffer_load_dwordx4 v218, s[12:15], s61 offen offset:2048 lds
    v_mfma_f32_16x16x32_bf16 v[72:75], v[164:167], v[184:187], v[72:75]
    ds_read_b64_tr_b16 v[130:131], v12 offset:43008
    v_mfma_f32_16x16x32_bf16 v[68:71], v[164:167], v[180:183], v[68:71]
    ds_read_b64_tr_b16 v[132:133], v11 offset:43008
    v_mfma_f32_16x16x32_bf16 v[64:67], v[164:167], v[176:179], v[64:67]
    ds_read_b64_tr_b16 v[134:135], v13 offset:43008
    v_mfma_f32_16x16x32_bf16 v[80:83], v[168:171], v[176:179], v[80:83]
    buffer_load_dwordx4 v219, s[12:15], s61 offen offset:3072 lds
    v_mfma_f32_16x16x32_bf16 v[84:87], v[168:171], v[180:183], v[84:87]
    s_add_u32 s61, s61, 128
    v_mfma_f32_16x16x32_bf16 v[88:91], v[168:171], v[184:187], v[88:91]
    s_add_u32 m0, s64, 81920
    v_mfma_f32_16x16x32_bf16 v[92:95], v[168:171], v[188:191], v[92:95]
    v_mfma_f32_16x16x32_bf16 v[108:111], v[172:175], v[188:191], v[108:111]
    v_mfma_f32_16x16x32_bf16 v[104:107], v[172:175], v[184:187], v[104:107]
    buffer_load_dwordx4 v220, s[16:19], s62 offen offset:0 sc1 lds
    v_mfma_f32_16x16x32_bf16 v[100:103], v[172:175], v[180:183], v[100:103]
    v_mfma_f32_16x16x32_bf16 v[96:99], v[172:175], v[176:179], v[96:99]
    s_waitcnt lgkmcnt(0)
    buffer_load_dword v221, v222, s[4:7], s48 offen sc1
    v_mfma_f32_16x16x32_bf16 v[16:19], v[112:115], v[136:139], v[16:19]
    ds_read_b128 v[176:179], v9 offset:40960
    v_mfma_f32_16x16x32_bf16 v[20:23], v[112:115], v[140:143], v[20:23]
    ds_read_b64_tr_b16 v[152:153], v10 offset:53248
    v_mfma_f32_16x16x32_bf16 v[24:27], v[112:115], v[144:147], v[24:27]
    ds_read_b64_tr_b16 v[154:155], v12 offset:53248
    buffer_load_dwordx4 v220, s[16:19], s62 offen offset:1024 sc1 lds
    v_mfma_f32_16x16x32_bf16 v[28:31], v[112:115], v[148:151], v[28:31]
    ds_read_b128 v[180:183], v9 offset:43008
    v_mfma_f32_16x16x32_bf16 v[44:47], v[116:119], v[148:151], v[44:47]
    ds_read_b128 v[184:187], v9 offset:45056
    v_mfma_f32_16x16x32_bf16 v[40:43], v[116:119], v[144:147], v[40:43]
    ds_read_b128 v[188:191], v9 offset:47104
    v_mfma_f32_16x16x32_bf16 v[36:39], v[116:119], v[140:143], v[36:39]
    ds_read_b64_tr_b16 v[156:157], v11 offset:53248
    v_mfma_f32_16x16x32_bf16 v[32:35], v[116:119], v[136:139], v[32:35]
    ds_read_b64_tr_b16 v[158:159], v13 offset:53248
    buffer_load_dwordx4 v220, s[16:19], s62 offen offset:2048 sc1 lds
    v_mfma_f32_16x16x32_bf16 v[48:51], v[120:123], v[136:139], v[48:51]
    ds_read_b64_tr_b16 v[160:161], v10 offset:54272
    v_mfma_f32_16x16x32_bf16 v[52:55], v[120:123], v[140:143], v[52:55]
    ds_read_b64_tr_b16 v[162:163], v12 offset:54272
    v_mfma_f32_16x16x32_bf16 v[56:59], v[120:123], v[144:147], v[56:59]
    ds_read_b64_tr_b16 v[164:165], v11 offset:54272
    v_mfma_f32_16x16x32_bf16 v[60:63], v[120:123], v[148:151], v[60:63]
    ds_read_b64_tr_b16 v[166:167], v13 offset:54272
    v_mfma_f32_16x16x32_bf16 v[76:79], v[124:127], v[148:151], v[76:79]
    ds_read_b64_tr_b16 v[168:169], v10 offset:55296
    buffer_load_dwordx4 v220, s[16:19], s62 offen offset:3072 sc1 lds
    v_mfma_f32_16x16x32_bf16 v[72:75], v[124:127], v[144:147], v[72:75]
    ds_read_b64_tr_b16 v[170:171], v12 offset:55296
    s_add_u32 m0, s64, 86016
    v_mfma_f32_16x16x32_bf16 v[68:71], v[124:127], v[140:143], v[68:71]
    ds_read_b64_tr_b16 v[172:173], v11 offset:55296
    s_add_u32 s62, s62, 4096
    v_mfma_f32_16x16x32_bf16 v[64:67], v[124:127], v[136:139], v[64:67]
    ds_read_b64_tr_b16 v[174:175], v13 offset:55296
    v_mfma_f32_16x16x32_bf16 v[80:83], v[128:131], v[136:139], v[80:83]
    buffer_load_dwordx4 v220, s[16:19], s62 offen offset:0 sc1 lds
    v_mfma_f32_16x16x32_bf16 v[84:87], v[128:131], v[140:143], v[84:87]
    v_mfma_f32_16x16x32_bf16 v[88:91], v[128:131], v[144:147], v[88:91]
    v_mfma_f32_16x16x32_bf16 v[92:95], v[128:131], v[148:151], v[92:95]
    v_mfma_f32_16x16x32_bf16 v[108:111], v[132:135], v[148:151], v[108:111]
    v_mfma_f32_16x16x32_bf16 v[104:107], v[132:135], v[144:147], v[104:107]
    buffer_load_dwordx4 v220, s[16:19], s62 offen offset:1024 sc1 lds
    v_mfma_f32_16x16x32_bf16 v[100:103], v[132:135], v[140:143], v[100:103]
    s_add_u32 s62, s62, 290816
    v_mfma_f32_16x16x32_bf16 v[96:99], v[132:135], v[136:139], v[96:99]
    s_waitcnt vmcnt(21)
    s_waitcnt lgkmcnt(0)
    s_barrier
    v_mfma_f32_16x16x32_bf16 v[16:19], v[152:155], v[176:179], v[16:19]
    ds_read_b128 v[136:139], v2 offset:0
    s_add_u32 m0, s63, 122880
    v_mfma_f32_16x16x32_bf16 v[20:23], v[152:155], v[180:183], v[20:23]
    ds_read_b64_tr_b16 v[112:113], v4 offset:0
    v_mfma_f32_16x16x32_bf16 v[24:27], v[152:155], v[184:187], v[24:27]
    ds_read_b64_tr_b16 v[114:115], v6 offset:0
    buffer_load_dwordx4 v216, s[12:15], s61 offen offset:0 lds
    v_mfma_f32_16x16x32_bf16 v[28:31], v[152:155], v[188:191], v[28:31]
    ds_read_b128 v[140:143], v2 offset:2048
    v_mfma_f32_16x16x32_bf16 v[44:47], v[156:159], v[188:191], v[44:47]
    ds_read_b128 v[144:147], v2 offset:4096
    v_mfma_f32_16x16x32_bf16 v[40:43], v[156:159], v[184:187], v[40:43]
    ds_read_b128 v[148:151], v2 offset:6144
    v_mfma_f32_16x16x32_bf16 v[36:39], v[156:159], v[180:183], v[36:39]
    ds_read_b64_tr_b16 v[116:117], v5 offset:0
    v_mfma_f32_16x16x32_bf16 v[32:35], v[156:159], v[176:179], v[32:35]
    ds_read_b64_tr_b16 v[118:119], v7 offset:0
    buffer_load_dwordx4 v217, s[12:15], s61 offen offset:1024 lds
    v_mfma_f32_16x16x32_bf16 v[48:51], v[160:163], v[176:179], v[48:51]
    ds_read_b64_tr_b16 v[120:121], v4 offset:1024
    v_mfma_f32_16x16x32_bf16 v[52:55], v[160:163], v[180:183], v[52:55]
    ds_read_b64_tr_b16 v[122:123], v6 offset:1024
    v_mfma_f32_16x16x32_bf16 v[56:59], v[160:163], v[184:187], v[56:59]
    ds_read_b64_tr_b16 v[124:125], v5 offset:1024
    v_mfma_f32_16x16x32_bf16 v[60:63], v[160:163], v[188:191], v[60:63]
    ds_read_b64_tr_b16 v[126:127], v7 offset:1024
    v_mfma_f32_16x16x32_bf16 v[76:79], v[164:167], v[188:191], v[76:79]
    ds_read_b64_tr_b16 v[128:129], v4 offset:2048
    buffer_load_dwordx4 v218, s[12:15], s61 offen offset:2048 lds
    v_mfma_f32_16x16x32_bf16 v[72:75], v[164:167], v[184:187], v[72:75]
    ds_read_b64_tr_b16 v[130:131], v6 offset:2048
    v_mfma_f32_16x16x32_bf16 v[68:71], v[164:167], v[180:183], v[68:71]
    ds_read_b64_tr_b16 v[132:133], v5 offset:2048
    v_mfma_f32_16x16x32_bf16 v[64:67], v[164:167], v[176:179], v[64:67]
    ds_read_b64_tr_b16 v[134:135], v7 offset:2048
    v_mfma_f32_16x16x32_bf16 v[80:83], v[168:171], v[176:179], v[80:83]
    buffer_load_dwordx4 v219, s[12:15], s61 offen offset:3072 lds
    v_mfma_f32_16x16x32_bf16 v[84:87], v[168:171], v[180:183], v[84:87]
    s_add_u32 s61, s61, 128
    v_mfma_f32_16x16x32_bf16 v[88:91], v[168:171], v[184:187], v[88:91]
    s_add_u32 m0, s64, 122880
    v_mfma_f32_16x16x32_bf16 v[92:95], v[168:171], v[188:191], v[92:95]
    v_mfma_f32_16x16x32_bf16 v[108:111], v[172:175], v[188:191], v[108:111]
    v_mfma_f32_16x16x32_bf16 v[104:107], v[172:175], v[184:187], v[104:107]
    buffer_load_dwordx4 v220, s[16:19], s62 offen offset:0 sc1 lds
    v_mfma_f32_16x16x32_bf16 v[100:103], v[172:175], v[180:183], v[100:103]
    v_mfma_f32_16x16x32_bf16 v[96:99], v[172:175], v[176:179], v[96:99]
    s_waitcnt lgkmcnt(0)
    v_mfma_f32_16x16x32_bf16 v[16:19], v[112:115], v[136:139], v[16:19]
    ds_read_b128 v[176:179], v3 offset:0
    v_mfma_f32_16x16x32_bf16 v[20:23], v[112:115], v[140:143], v[20:23]
    ds_read_b64_tr_b16 v[152:153], v4 offset:12288
    v_mfma_f32_16x16x32_bf16 v[24:27], v[112:115], v[144:147], v[24:27]
    ds_read_b64_tr_b16 v[154:155], v6 offset:12288
    buffer_load_dwordx4 v220, s[16:19], s62 offen offset:1024 sc1 lds
    v_mfma_f32_16x16x32_bf16 v[28:31], v[112:115], v[148:151], v[28:31]
    ds_read_b128 v[180:183], v3 offset:2048
    v_mfma_f32_16x16x32_bf16 v[44:47], v[116:119], v[148:151], v[44:47]
    ds_read_b128 v[184:187], v3 offset:4096
    v_mfma_f32_16x16x32_bf16 v[40:43], v[116:119], v[144:147], v[40:43]
    ds_read_b128 v[188:191], v3 offset:6144
    v_mfma_f32_16x16x32_bf16 v[36:39], v[116:119], v[140:143], v[36:39]
    ds_read_b64_tr_b16 v[156:157], v5 offset:12288
    v_mfma_f32_16x16x32_bf16 v[32:35], v[116:119], v[136:139], v[32:35]
    ds_read_b64_tr_b16 v[158:159], v7 offset:12288
    buffer_load_dwordx4 v220, s[16:19], s62 offen offset:2048 sc1 lds
    v_mfma_f32_16x16x32_bf16 v[48:51], v[120:123], v[136:139], v[48:51]
    ds_read_b64_tr_b16 v[160:161], v4 offset:13312
    v_mfma_f32_16x16x32_bf16 v[52:55], v[120:123], v[140:143], v[52:55]
    ds_read_b64_tr_b16 v[162:163], v6 offset:13312
    v_mfma_f32_16x16x32_bf16 v[56:59], v[120:123], v[144:147], v[56:59]
    ds_read_b64_tr_b16 v[164:165], v5 offset:13312
    v_mfma_f32_16x16x32_bf16 v[60:63], v[120:123], v[148:151], v[60:63]
    ds_read_b64_tr_b16 v[166:167], v7 offset:13312
    v_mfma_f32_16x16x32_bf16 v[76:79], v[124:127], v[148:151], v[76:79]
    ds_read_b64_tr_b16 v[168:169], v4 offset:14336
    buffer_load_dwordx4 v220, s[16:19], s62 offen offset:3072 sc1 lds
    v_mfma_f32_16x16x32_bf16 v[72:75], v[124:127], v[144:147], v[72:75]
    ds_read_b64_tr_b16 v[170:171], v6 offset:14336
    s_add_u32 m0, s64, 126976
    v_mfma_f32_16x16x32_bf16 v[68:71], v[124:127], v[140:143], v[68:71]
    ds_read_b64_tr_b16 v[172:173], v5 offset:14336
    s_add_u32 s62, s62, 4096
    v_mfma_f32_16x16x32_bf16 v[64:67], v[124:127], v[136:139], v[64:67]
    ds_read_b64_tr_b16 v[174:175], v7 offset:14336
    v_mfma_f32_16x16x32_bf16 v[80:83], v[128:131], v[136:139], v[80:83]
    buffer_load_dwordx4 v220, s[16:19], s62 offen offset:0 sc1 lds
    v_mfma_f32_16x16x32_bf16 v[84:87], v[128:131], v[140:143], v[84:87]
    v_mfma_f32_16x16x32_bf16 v[88:91], v[128:131], v[144:147], v[88:91]
    v_mfma_f32_16x16x32_bf16 v[92:95], v[128:131], v[148:151], v[92:95]
    v_mfma_f32_16x16x32_bf16 v[108:111], v[132:135], v[148:151], v[108:111]
    v_mfma_f32_16x16x32_bf16 v[104:107], v[132:135], v[144:147], v[104:107]
    buffer_load_dwordx4 v220, s[16:19], s62 offen offset:1024 sc1 lds
    v_mfma_f32_16x16x32_bf16 v[100:103], v[132:135], v[140:143], v[100:103]
    s_add_u32 s62, s62, 290816
    v_mfma_f32_16x16x32_bf16 v[96:99], v[132:135], v[136:139], v[96:99]
    s_waitcnt vmcnt(21)
    s_waitcnt lgkmcnt(0)
    s_barrier
    v_mfma_f32_16x16x32_bf16 v[16:19], v[152:155], v[176:179], v[16:19]
    ds_read_b128 v[136:139], v2 offset:40960
    v_mfma_f32_16x16x32_bf16 v[20:23], v[152:155], v[180:183], v[20:23]
    ds_read_b64_tr_b16 v[112:113], v4 offset:40960
    v_mfma_f32_16x16x32_bf16 v[24:27], v[152:155], v[184:187], v[24:27]
    ds_read_b64_tr_b16 v[114:115], v6 offset:40960
    s_waitcnt vmcnt(15)
    s_mov_b32 s60, 0
k1_kernel_pl12:
    v_bfe_u32 v221, v221, 0, 8
    v_cmp_gt_u32 vcc, 32, v221
    s_add_u32 s60, s60, 1
    s_and_b32 vcc_lo, vcc_lo, 1
    s_cbranch_scc0 k1_kernel_pd13
    s_cmp_ge_u32 s60, 200000
    s_cbranch_scc1 k1_kernel_pd13
    s_sleep 4
    v_mov_b32 v221, 0
    buffer_atomic_add v221, v222, s[4:7], s48 offen sc0
    s_waitcnt vmcnt(0)
    s_branch k1_kernel_pl12
k1_kernel_pd13:
    s_lshl_b32 s50, s41, 3
    s_lshl_b32 s51, s40, 1
    s_add_u32 s50, s50, s51
    s_mul_i32 s50, s50, 73728
    s_mul_i32 s51, s42, 6144
    s_add_u32 s50, s50, s51
    s_mul_i32 s51, s40, 6144
    s_add_u32 m0, s51, 0
    s_nop 0
    buffer_load_dwordx4 v14, s[20:23], s50 offen offset:0 sc1 lds
    v_mfma_f32_16x16x32_bf16 v[28:31], v[152:155], v[188:191], v[28:31]
    ds_read_b128 v[140:143], v2 offset:43008
    v_mfma_f32_16x16x32_bf16 v[44:47], v[156:159], v[188:191], v[44:47]
    ds_read_b128 v[144:147], v2 offset:45056
    v_mfma_f32_16x16x32_bf16 v[40:43], v[156:159], v[184:187], v[40:43]
    ds_read_b128 v[148:151], v2 offset:47104
    v_mfma_f32_16x16x32_bf16 v[36:39], v[156:159], v[180:183], v[36:39]
    ds_read_b64_tr_b16 v[116:117], v5 offset:40960
    buffer_load_dwordx4 v14, s[20:23], s50 offen offset:1024 sc1 lds
    v_mfma_f32_16x16x32_bf16 v[32:35], v[156:159], v[176:179], v[32:35]
    ds_read_b64_tr_b16 v[118:119], v7 offset:40960
    v_mfma_f32_16x16x32_bf16 v[48:51], v[160:163], v[176:179], v[48:51]
    ds_read_b64_tr_b16 v[120:121], v4 offset:41984
    v_mfma_f32_16x16x32_bf16 v[52:55], v[160:163], v[180:183], v[52:55]
    ds_read_b64_tr_b16 v[122:123], v6 offset:41984
    v_mfma_f32_16x16x32_bf16 v[56:59], v[160:163], v[184:187], v[56:59]
    ds_read_b64_tr_b16 v[124:125], v5 offset:41984
    buffer_load_dwordx4 v14, s[20:23], s50 offen offset:2048 sc1 lds
    v_mfma_f32_16x16x32_bf16 v[60:63], v[160:163], v[188:191], v[60:63]
    ds_read_b64_tr_b16 v[126:127], v7 offset:41984
    v_mfma_f32_16x16x32_bf16 v[76:79], v[164:167], v[188:191], v[76:79]
    ds_read_b64_tr_b16 v[128:129], v4 offset:43008
    v_mfma_f32_16x16x32_bf16 v[72:75], v[164:167], v[184:187], v[72:75]
    ds_read_b64_tr_b16 v[130:131], v6 offset:43008
    v_mfma_f32_16x16x32_bf16 v[68:71], v[164:167], v[180:183], v[68:71]
    ds_read_b64_tr_b16 v[132:133], v5 offset:43008
    buffer_load_dwordx4 v14, s[20:23], s50 offen offset:3072 sc1 lds
    v_mfma_f32_16x16x32_bf16 v[64:67], v[164:167], v[176:179], v[64:67]
    ds_read_b64_tr_b16 v[134:135], v7 offset:43008
    s_add_u32 m0, s51, 4096
    v_mfma_f32_16x16x32_bf16 v[80:83], v[168:171], v[176:179], v[80:83]
    s_add_u32 s50, s50, 4096
    v_mfma_f32_16x16x32_bf16 v[84:87], v[168:171], v[180:183], v[84:87]
    v_mfma_f32_16x16x32_bf16 v[88:91], v[168:171], v[184:187], v[88:91]
    buffer_load_dwordx4 v14, s[20:23], s50 offen offset:0 sc1 lds
    v_mfma_f32_16x16x32_bf16 v[92:95], v[168:171], v[188:191], v[92:95]
    v_mfma_f32_16x16x32_bf16 v[108:111], v[172:175], v[188:191], v[108:111]
    v_mfma_f32_16x16x32_bf16 v[104:107], v[172:175], v[184:187], v[104:107]
    v_mfma_f32_16x16x32_bf16 v[100:103], v[172:175], v[180:183], v[100:103]
    buffer_load_dwordx4 v14, s[20:23], s50 offen offset:1024 sc1 lds
    v_mfma_f32_16x16x32_bf16 v[96:99], v[172:175], v[176:179], v[96:99]
    s_add_u32 s50, s50, 69632
    s_waitcnt lgkmcnt(0)
    v_mfma_f32_16x16x32_bf16 v[16:19], v[112:115], v[136:139], v[16:19]
    ds_read_b128 v[176:179], v3 offset:40960
    v_mfma_f32_16x16x32_bf16 v[20:23], v[112:115], v[140:143], v[20:23]
    ds_read_b64_tr_b16 v[152:153], v4 offset:53248
    v_mfma_f32_16x16x32_bf16 v[24:27], v[112:115], v[144:147], v[24:27]
    ds_read_b64_tr_b16 v[154:155], v6 offset:53248
    s_mov_b32 s60, 0
k1_kernel_pl14:
    v_bfe_u32 v223, v223, 0, 8
    v_cmp_gt_u32 vcc, 64, v223
    s_add_u32 s60, s60, 1
    s_and_b32 vcc_lo, vcc_lo, 1
    s_cbranch_scc0 k1_kernel_pd15
    s_cmp_ge_u32 s60, 200000
    s_cbranch_scc1 k1_kernel_pd15
    s_sleep 4
    v_mov_b32 v223, 0
    buffer_atomic_add v223, v222, s[4:7], s57 offen sc0
    s_waitcnt vmcnt(0)
    s_branch k1_kernel_pl14
k1_kernel_pd15:
    buffer_load_dwordx4 a[0:3], v14, s[24:27], s53 offen offset:0 sc1
    v_mfma_f32_16x16x32_bf16 v[28:31], v[112:115], v[148:151], v[28:31]
    ds_read_b128 v[180:183], v3 offset:43008
    v_mfma_f32_16x16x32_bf16 v[44:47], v[116:119], v[148:151], v[44:47]
    ds_read_b128 v[184:187], v3 offset:45056
    v_mfma_f32_16x16x32_bf16 v[40:43], v[116:119], v[144:147], v[40:43]
    ds_read_b128 v[188:191], v3 offset:47104
    v_mfma_f32_16x16x32_bf16 v[36:39], v[116:119], v[140:143], v[36:39]
    ds_read_b64_tr_b16 v[156:157], v5 offset:53248
    buffer_load_dwordx4 a[4:7], v14, s[24:27], s53 offen offset:1024 sc1
    v_mfma_f32_16x16x32_bf16 v[32:35], v[116:119], v[136:139], v[32:35]
    ds_read_b64_tr_b16 v[158:159], v7 offset:53248
    v_mfma_f32_16x16x32_bf16 v[48:51], v[120:123], v[136:139], v[48:51]
    ds_read_b64_tr_b16 v[160:161], v4 offset:54272
    v_mfma_f32_16x16x32_bf16 v[52:55], v[120:123], v[140:143], v[52:55]
    ds_read_b64_tr_b16 v[162:163], v6 offset:54272
    v_mfma_f32_16x16x32_bf16 v[56:59], v[120:123], v[144:147], v[56:59]
    ds_read_b64_tr_b16 v[164:165], v5 offset:54272
    buffer_load_dwordx4 a[8:11], v14, s[24:27], s53 offen offset:2048 sc1
    v_mfma_f32_16x16x32_bf16 v[60:63], v[120:123], v[148:151], v[60:63]
    ds_read_b64_tr_b16 v[166:167], v7 offset:54272
    v_mfma_f32_16x16x32_bf16 v[76:79], v[124:127], v[148:151], v[76:79]
    ds_read_b64_tr_b16 v[168:169], v4 offset:55296
    v_mfma_f32_16x16x32_bf16 v[72:75], v[124:127], v[144:147], v[72:75]
    ds_read_b64_tr_b16 v[170:171], v6 offset:55296
    v_mfma_f32_16x16x32_bf16 v[68:71], v[124:127], v[140:143], v[68:71]
    ds_read_b64_tr_b16 v[172:173], v5 offset:55296
    buffer_load_dwordx4 a[12:15], v14, s[24:27], s53 offen offset:3072 sc1
    v_mfma_f32_16x16x32_bf16 v[64:67], v[124:127], v[136:139], v[64:67]
    ds_read_b64_tr_b16 v[174:175], v7 offset:55296
    s_add_u32 s53, s53, 4096
    v_mfma_f32_16x16x32_bf16 v[80:83], v[128:131], v[136:139], v[80:83]
    v_mfma_f32_16x16x32_bf16 v[84:87], v[128:131], v[140:143], v[84:87]
    v_mfma_f32_16x16x32_bf16 v[88:91], v[128:131], v[144:147], v[88:91]
    buffer_load_dwordx4 a[16:19], v14, s[24:27], s53 offen offset:0 sc1
    v_mfma_f32_16x16x32_bf16 v[92:95], v[128:131], v[148:151], v[92:95]
    v_mfma_f32_16x16x32_bf16 v[108:111], v[132:135], v[148:151], v[108:111]
    v_mfma_f32_16x16x32_bf16 v[104:107], v[132:135], v[144:147], v[104:107]
    v_mfma_f32_16x16x32_bf16 v[100:103], v[132:135], v[140:143], v[100:103]
    buffer_load_dwordx4 a[20:23], v14, s[24:27], s53 offen offset:1024 sc1
    v_mfma_f32_16x16x32_bf16 v[96:99], v[132:135], v[136:139], v[96:99]
    s_waitcnt vmcnt(22)
    s_waitcnt lgkmcnt(0)
    s_barrier
    v_mfma_f32_16x16x32_bf16 v[16:19], v[152:155], v[176:179], v[16:19]
    ds_read_b128 v[136:139], v8 offset:0
    s_add_u32 m0, s51, 40960
    v_mfma_f32_16x16x32_bf16 v[20:23], v[152:155], v[180:183], v[20:23]
    ds_read_b64_tr_b16 v[112:113], v10 offset:0
    v_mfma_f32_16x16x32_bf16 v[24:27], v[152:155], v[184:187], v[24:27]
    ds_read_b64_tr_b16 v[114:115], v12 offset:0
    buffer_load_dwordx4 v14, s[20:23], s50 offen offset:0 sc1 lds
    v_mfma_f32_16x16x32_bf16 v[28:31], v[152:155], v[188:191], v[28:31]
    ds_read_b128 v[140:143], v8 offset:2048
    v_mfma_f32_16x16x32_bf16 v[44:47], v[156:159], v[188:191], v[44:47]
    ds_read_b128 v[144:147], v8 offset:4096
    v_mfma_f32_16x16x32_bf16 v[40:43], v[156:159], v[184:187], v[40:43]
    ds_read_b128 v[148:151], v8 offset:6144
    v_mfma_f32_16x16x32_bf16 v[36:39], v[156:159], v[180:183], v[36:39]
    ds_read_b64_tr_b16 v[116:117], v11 offset:0
    buffer_load_dwordx4 v14, s[20:23], s50 offen offset:1024 sc1 lds
    v_mfma_f32_16x16x32_bf16 v[32:35], v[156:159], v[176:179], v[32:35]
    ds_read_b64_tr_b16 v[118:119], v13 offset:0
    v_mfma_f32_16x16x32_bf16 v[48:51], v[160:163], v[176:179], v[48:51]
    ds_read_b64_tr_b16 v[120:121], v10 offset:1024
    v_mfma_f32_16x16x32_bf16 v[52:55], v[160:163], v[180:183], v[52:55]
    ds_read_b64_tr_b16 v[122:123], v12 offset:1024
    v_mfma_f32_16x16x32_bf16 v[56:59], v[160:163], v[184:187], v[56:59]
    ds_read_b64_tr_b16 v[124:125], v11 offset:1024
    buffer_load_dwordx4 v14, s[20:23], s50 offen offset:2048 sc1 lds
    v_mfma_f32_16x16x32_bf16 v[60:63], v[160:163], v[188:191], v[60:63]
    ds_read_b64_tr_b16 v[126:127], v13 offset:1024
    v_mfma_f32_16x16x32_bf16 v[76:79], v[164:167], v[188:191], v[76:79]
    ds_read_b64_tr_b16 v[128:129], v10 offset:2048
    v_mfma_f32_16x16x32_bf16 v[72:75], v[164:167], v[184:187], v[72:75]
    ds_read_b64_tr_b16 v[130:131], v12 offset:2048
    v_mfma_f32_16x16x32_bf16 v[68:71], v[164:167], v[180:183], v[68:71]
    ds_read_b64_tr_b16 v[132:133], v11 offset:2048
    buffer_load_dwordx4 v14, s[20:23], s50 offen offset:3072 sc1 lds
    v_mfma_f32_16x16x32_bf16 v[64:67], v[164:167], v[176:179], v[64:67]
    ds_read_b64_tr_b16 v[134:135], v13 offset:2048
    s_add_u32 m0, s51, 45056
    v_mfma_f32_16x16x32_bf16 v[80:83], v[168:171], v[176:179], v[80:83]
    s_add_u32 s50, s50, 4096
    v_mfma_f32_16x16x32_bf16 v[84:87], v[168:171], v[180:183], v[84:87]
    v_mfma_f32_16x16x32_bf16 v[88:91], v[168:171], v[184:187], v[88:91]
    buffer_load_dwordx4 v14, s[20:23], s50 offen offset:0 sc1 lds
    v_mfma_f32_16x16x32_bf16 v[92:95], v[168:171], v[188:191], v[92:95]
    v_mfma_f32_16x16x32_bf16 v[108:111], v[172:175], v[188:191], v[108:111]
    v_mfma_f32_16x16x32_bf16 v[104:107], v[172:175], v[184:187], v[104:107]
    v_mfma_f32_16x16x32_bf16 v[100:103], v[172:175], v[180:183], v[100:103]
    buffer_load_dwordx4 v14, s[20:23], s50 offen offset:1024 sc1 lds
    v_mfma_f32_16x16x32_bf16 v[96:99], v[172:175], v[176:179], v[96:99]
    s_add_u32 s50, s50, 69632
    s_waitcnt lgkmcnt(0)
    v_mfma_f32_16x16x32_bf16 v[16:19], v[112:115], v[136:139], v[16:19]
    ds_read_b128 v[176:179], v9 offset:0
    s_add_u32 s53, s53, 32768
    v_mfma_f32_16x16x32_bf16 v[20:23], v[112:115], v[140:143], v[20:23]
    ds_read_b64_tr_b16 v[152:153], v10 offset:12288
    v_mfma_f32_16x16x32_bf16 v[24:27], v[112:115], v[144:147], v[24:27]
    ds_read_b64_tr_b16 v[154:155], v12 offset:12288
    buffer_load_dwordx4 a[24:27], v14, s[24:27], s53 offen offset:0 sc1
    v_mfma_f32_16x16x32_bf16 v[28:31], v[112:115], v[148:151], v[28:31]
    ds_read_b128 v[180:183], v9 offset:2048
    v_mfma_f32_16x16x32_bf16 v[44:47], v[116:119], v[148:151], v[44:47]
    ds_read_b128 v[184:187], v9 offset:4096
    v_mfma_f32_16x16x32_bf16 v[40:43], v[116:119], v[144:147], v[40:43]
    ds_read_b128 v[188:191], v9 offset:6144
    v_mfma_f32_16x16x32_bf16 v[36:39], v[116:119], v[140:143], v[36:39]
    ds_read_b64_tr_b16 v[156:157], v11 offset:12288
    buffer_load_dwordx4 a[28:31], v14, s[24:27], s53 offen offset:1024 sc1
    v_mfma_f32_16x16x32_bf16 v[32:35], v[116:119], v[136:139], v[32:35]
    ds_read_b64_tr_b16 v[158:159], v13 offset:12288
    v_mfma_f32_16x16x32_bf16 v[48:51], v[120:123], v[136:139], v[48:51]
    ds_read_b64_tr_b16 v[160:161], v10 offset:13312
    v_mfma_f32_16x16x32_bf16 v[52:55], v[120:123], v[140:143], v[52:55]
    ds_read_b64_tr_b16 v[162:163], v12 offset:13312
    v_mfma_f32_16x16x32_bf16 v[56:59], v[120:123], v[144:147], v[56:59]
    ds_read_b64_tr_b16 v[164:165], v11 offset:13312
    buffer_load_dwordx4 a[32:35], v14, s[24:27], s53 offen offset:2048 sc1
    v_mfma_f32_16x16x32_bf16 v[60:63], v[120:123], v[148:151], v[60:63]
    ds_read_b64_tr_b16 v[166:167], v13 offset:13312
    v_mfma_f32_16x16x32_bf16 v[76:79], v[124:127], v[148:151], v[76:79]
    ds_read_b64_tr_b16 v[168:169], v10 offset:14336
    v_mfma_f32_16x16x32_bf16 v[72:75], v[124:127], v[144:147], v[72:75]
    ds_read_b64_tr_b16 v[170:171], v12 offset:14336
    v_mfma_f32_16x16x32_bf16 v[68:71], v[124:127], v[140:143], v[68:71]
    ds_read_b64_tr_b16 v[172:173], v11 offset:14336
    buffer_load_dwordx4 a[36:39], v14, s[24:27], s53 offen offset:3072 sc1
    v_mfma_f32_16x16x32_bf16 v[64:67], v[124:127], v[136:139], v[64:67]
    ds_read_b64_tr_b16 v[174:175], v13 offset:14336
    s_add_u32 s53, s53, 4096
    v_mfma_f32_16x16x32_bf16 v[80:83], v[128:131], v[136:139], v[80:83]
    v_mfma_f32_16x16x32_bf16 v[84:87], v[128:131], v[140:143], v[84:87]
    v_mfma_f32_16x16x32_bf16 v[88:91], v[128:131], v[144:147], v[88:91]
    buffer_load_dwordx4 a[40:43], v14, s[24:27], s53 offen offset:0 sc1
    v_mfma_f32_16x16x32_bf16 v[92:95], v[128:131], v[148:151], v[92:95]
    v_mfma_f32_16x16x32_bf16 v[108:111], v[132:135], v[148:151], v[108:111]
    v_mfma_f32_16x16x32_bf16 v[104:107], v[132:135], v[144:147], v[104:107]
    v_mfma_f32_16x16x32_bf16 v[100:103], v[132:135], v[140:143], v[100:103]
    buffer_load_dwordx4 a[44:47], v14, s[24:27], s53 offen offset:1024 sc1
    v_mfma_f32_16x16x32_bf16 v[96:99], v[132:135], v[136:139], v[96:99]
    s_waitcnt vmcnt(24)
    s_waitcnt lgkmcnt(0)
    s_barrier
    v_mfma_f32_16x16x32_bf16 v[16:19], v[152:155], v[176:179], v[16:19]
    ds_read_b128 v[136:139], v8 offset:40960
    s_add_u32 s53, s53, 32768
    v_mfma_f32_16x16x32_bf16 v[20:23], v[152:155], v[180:183], v[20:23]
    ds_read_b64_tr_b16 v[112:113], v10 offset:40960
    v_mfma_f32_16x16x32_bf16 v[24:27], v[152:155], v[184:187], v[24:27]
    ds_read_b64_tr_b16 v[114:115], v12 offset:40960
    buffer_load_dwordx4 a[48:51], v14, s[24:27], s53 offen offset:0 sc1
    v_mfma_f32_16x16x32_bf16 v[28:31], v[152:155], v[188:191], v[28:31]
    ds_read_b128 v[140:143], v8 offset:43008
    v_mfma_f32_16x16x32_bf16 v[44:47], v[156:159], v[188:191], v[44:47]
    ds_read_b128 v[144:147], v8 offset:45056
    v_mfma_f32_16x16x32_bf16 v[40:43], v[156:159], v[184:187], v[40:43]
    ds_read_b128 v[148:151], v8 offset:47104
    v_mfma_f32_16x16x32_bf16 v[36:39], v[156:159], v[180:183], v[36:39]
    ds_read_b64_tr_b16 v[116:117], v11 offset:40960
    buffer_load_dwordx4 a[52:55], v14, s[24:27], s53 offen offset:1024 sc1
    v_mfma_f32_16x16x32_bf16 v[32:35], v[156:159], v[176:179], v[32:35]
    ds_read_b64_tr_b16 v[118:119], v13 offset:40960
    v_mfma_f32_16x16x32_bf16 v[48:51], v[160:163], v[176:179], v[48:51]
    ds_read_b64_tr_b16 v[120:121], v10 offset:41984
    v_mfma_f32_16x16x32_bf16 v[52:55], v[160:163], v[180:183], v[52:55]
    ds_read_b64_tr_b16 v[122:123], v12 offset:41984
    v_mfma_f32_16x16x32_bf16 v[56:59], v[160:163], v[184:187], v[56:59]
    ds_read_b64_tr_b16 v[124:125], v11 offset:41984
    buffer_load_dwordx4 a[56:59], v14, s[24:27], s53 offen offset:2048 sc1
    v_mfma_f32_16x16x32_bf16 v[60:63], v[160:163], v[188:191], v[60:63]
    ds_read_b64_tr_b16 v[126:127], v13 offset:41984
    v_mfma_f32_16x16x32_bf16 v[76:79], v[164:167], v[188:191], v[76:79]
    ds_read_b64_tr_b16 v[128:129], v10 offset:43008
    v_mfma_f32_16x16x32_bf16 v[72:75], v[164:167], v[184:187], v[72:75]
    ds_read_b64_tr_b16 v[130:131], v12 offset:43008
    v_mfma_f32_16x16x32_bf16 v[68:71], v[164:167], v[180:183], v[68:71]
    ds_read_b64_tr_b16 v[132:133], v11 offset:43008
    buffer_load_dwordx4 a[60:63], v14, s[24:27], s53 offen offset:3072 sc1
    v_mfma_f32_16x16x32_bf16 v[64:67], v[164:167], v[176:179], v[64:67]
    ds_read_b64_tr_b16 v[134:135], v13 offset:43008
    s_add_u32 s53, s53, 4096
    v_mfma_f32_16x16x32_bf16 v[80:83], v[168:171], v[176:179], v[80:83]
    v_mfma_f32_16x16x32_bf16 v[84:87], v[168:171], v[180:183], v[84:87]
    v_mfma_f32_16x16x32_bf16 v[88:91], v[168:171], v[184:187], v[88:91]
    buffer_load_dwordx4 a[64:67], v14, s[24:27], s53 offen offset:0 sc1
    v_mfma_f32_16x16x32_bf16 v[92:95], v[168:171], v[188:191], v[92:95]
    v_mfma_f32_16x16x32_bf16 v[108:111], v[172:175], v[188:191], v[108:111]
    v_mfma_f32_16x16x32_bf16 v[104:107], v[172:175], v[184:187], v[104:107]
    v_mfma_f32_16x16x32_bf16 v[100:103], v[172:175], v[180:183], v[100:103]
    buffer_load_dwordx4 a[68:71], v14, s[24:27], s53 offen offset:1024 sc1
    v_mfma_f32_16x16x32_bf16 v[96:99], v[172:175], v[176:179], v[96:99]
    s_waitcnt lgkmcnt(0)
    v_mfma_f32_16x16x32_bf16 v[16:19], v[112:115], v[136:139], v[16:19]
    ds_read_b128 v[176:179], v9 offset:40960
    s_add_u32 s53, s53, 32768
    v_mfma_f32_16x16x32_bf16 v[20:23], v[112:115], v[140:143], v[20:23]
    ds_read_b64_tr_b16 v[152:153], v10 offset:53248
    v_mfma_f32_16x16x32_bf16 v[24:27], v[112:115], v[144:147], v[24:27]
    ds_read_b64_tr_b16 v[154:155], v12 offset:53248
    buffer_load_dwordx4 a[72:75], v14, s[24:27], s53 offen offset:0 sc1
    v_mfma_f32_16x16x32_bf16 v[28:31], v[112:115], v[148:151], v[28:31]
    ds_read_b128 v[180:183], v9 offset:43008
    v_mfma_f32_16x16x32_bf16 v[44:47], v[116:119], v[148:151], v[44:47]
    ds_read_b128 v[184:187], v9 offset:45056
    v_mfma_f32_16x16x32_bf16 v[40:43], v[116:119], v[144:147], v[40:43]
    ds_read_b128 v[188:191], v9 offset:47104
    v_mfma_f32_16x16x32_bf16 v[36:39], v[116:119], v[140:143], v[36:39]
    ds_read_b64_tr_b16 v[156:157], v11 offset:53248
    buffer_load_dwordx4 a[76:79], v14, s[24:27], s53 offen offset:1024 sc1
    v_mfma_f32_16x16x32_bf16 v[32:35], v[116:119], v[136:139], v[32:35]
    ds_read_b64_tr_b16 v[158:159], v13 offset:53248
    v_mfma_f32_16x16x32_bf16 v[48:51], v[120:123], v[136:139], v[48:51]
    ds_read_b64_tr_b16 v[160:161], v10 offset:54272
    v_mfma_f32_16x16x32_bf16 v[52:55], v[120:123], v[140:143], v[52:55]
    ds_read_b64_tr_b16 v[162:163], v12 offset:54272
    v_mfma_f32_16x16x32_bf16 v[56:59], v[120:123], v[144:147], v[56:59]
    ds_read_b64_tr_b16 v[164:165], v11 offset:54272
    buffer_load_dwordx4 a[80:83], v14, s[24:27], s53 offen offset:2048 sc1
    v_mfma_f32_16x16x32_bf16 v[60:63], v[120:123], v[148:151], v[60:63]
    ds_read_b64_tr_b16 v[166:167], v13 offset:54272
    v_mfma_f32_16x16x32_bf16 v[76:79], v[124:127], v[148:151], v[76:79]
    ds_read_b64_tr_b16 v[168:169], v10 offset:55296
    v_mfma_f32_16x16x32_bf16 v[72:75], v[124:127], v[144:147], v[72:75]
    ds_read_b64_tr_b16 v[170:171], v12 offset:55296
    v_mfma_f32_16x16x32_bf16 v[68:71], v[124:127], v[140:143], v[68:71]
    ds_read_b64_tr_b16 v[172:173], v11 offset:55296
    buffer_load_dwordx4 a[84:87], v14, s[24:27], s53 offen offset:3072 sc1
    v_mfma_f32_16x16x32_bf16 v[64:67], v[124:127], v[136:139], v[64:67]
    ds_read_b64_tr_b16 v[174:175], v13 offset:55296
    s_add_u32 s53, s53, 4096
    v_mfma_f32_16x16x32_bf16 v[80:83], v[128:131], v[136:139], v[80:83]
    v_mfma_f32_16x16x32_bf16 v[84:87], v[128:131], v[140:143], v[84:87]
    v_mfma_f32_16x16x32_bf16 v[88:91], v[128:131], v[144:147], v[88:91]
    buffer_load_dwordx4 a[88:91], v14, s[24:27], s53 offen offset:0 sc1
    v_mfma_f32_16x16x32_bf16 v[92:95], v[128:131], v[148:151], v[92:95]
    v_mfma_f32_16x16x32_bf16 v[108:111], v[132:135], v[148:151], v[108:111]
    v_mfma_f32_16x16x32_bf16 v[104:107], v[132:135], v[144:147], v[104:107]
    v_mfma_f32_16x16x32_bf16 v[100:103], v[132:135], v[140:143], v[100:103]
    buffer_load_dwordx4 a[92:95], v14, s[24:27], s53 offen offset:1024 sc1
    v_mfma_f32_16x16x32_bf16 v[96:99], v[132:135], v[136:139], v[96:99]
    s_waitcnt vmcnt(18)
    s_waitcnt lgkmcnt(0)
    s_barrier
    s_and_b32 s50, s40, 1
    s_lshr_b32 s51, s40, 1
    s_mul_i32 s45, s50, 12288
    s_mul_i32 s46, s51, 3072
    s_add_u32 s45, s45, s46
    v_add_u32 v15, s45, v14
    v_mfma_f32_16x16x32_bf16 v[16:19], v[152:155], v[176:179], v[16:19]
    ds_read_b128 v[112:115], v15 offset:0
    s_add_u32 s53, s53, 32768
    v_mfma_f32_16x16x32_bf16 v[20:23], v[152:155], v[180:183], v[20:23]
    ds_read_b128 v[116:119], v15 offset:1024
    v_mfma_f32_16x16x32_bf16 v[24:27], v[152:155], v[184:187], v[24:27]
    ds_read_b128 v[120:123], v15 offset:2048
    buffer_load_dwordx4 a[96:99], v14, s[24:27], s53 offen offset:0 sc1
    v_mfma_f32_16x16x32_bf16 v[28:31], v[152:155], v[188:191], v[28:31]
    ds_read_b128 v[124:127], v15 offset:40960
    v_mfma_f32_16x16x32_bf16 v[44:47], v[156:159], v[188:191], v[44:47]
    ds_read_b128 v[128:131], v15 offset:41984
    v_mfma_f32_16x16x32_bf16 v[40:43], v[156:159], v[184:187], v[40:43]
    ds_read_b128 v[132:135], v15 offset:43008
    v_mfma_f32_16x16x32_bf16 v[36:39], v[156:159], v[180:183], v[36:39]
    ds_read_b128 v[136:139], v15 offset:6144
    buffer_load_dwordx4 a[100:103], v14, s[24:27], s53 offen offset:1024 sc1
    v_mfma_f32_16x16x32_bf16 v[32:35], v[156:159], v[176:179], v[32:35]
    ds_read_b128 v[140:143], v15 offset:7168
    v_mfma_f32_16x16x32_bf16 v[48:51], v[160:163], v[176:179], v[48:51]
    ds_read_b128 v[144:147], v15 offset:8192
    v_mfma_f32_16x16x32_bf16 v[52:55], v[160:163], v[180:183], v[52:55]
    ds_read_b128 v[148:151], v15 offset:47104
    v_mfma_f32_16x16x32_bf16 v[56:59], v[160:163], v[184:187], v[56:59]
    buffer_load_dwordx4 a[104:107], v14, s[24:27], s53 offen offset:2048 sc1
    v_mfma_f32_16x16x32_bf16 v[60:63], v[160:163], v[188:191], v[60:63]
    v_mfma_f32_16x16x32_bf16 v[76:79], v[164:167], v[188:191], v[76:79]
    v_mfma_f32_16x16x32_bf16 v[72:75], v[164:167], v[184:187], v[72:75]
    v_mfma_f32_16x16x32_bf16 v[68:71], v[164:167], v[180:183], v[68:71]
    buffer_load_dwordx4 a[108:111], v14, s[24:27], s53 offen offset:3072 sc1
    v_mfma_f32_16x16x32_bf16 v[64:67], v[164:167], v[176:179], v[64:67]
    s_add_u32 s53, s53, 4096
    v_mfma_f32_16x16x32_bf16 v[80:83], v[168:171], v[176:179], v[80:83]
    v_mfma_f32_16x16x32_bf16 v[84:87], v[168:171], v[180:183], v[84:87]
    v_mfma_f32_16x16x32_bf16 v[88:91], v[168:171], v[184:187], v[88:91]
    buffer_load_dwordx4 a[112:115], v14, s[24:27], s53 offen offset:0 sc1
    v_mfma_f32_16x16x32_bf16 v[92:95], v[168:171], v[188:191], v[92:95]
    v_mfma_f32_16x16x32_bf16 v[108:111], v[172:175], v[188:191], v[108:111]
    v_mfma_f32_16x16x32_bf16 v[104:107], v[172:175], v[184:187], v[104:107]
    v_mfma_f32_16x16x32_bf16 v[100:103], v[172:175], v[180:183], v[100:103]
    buffer_load_dwordx4 a[116:119], v14, s[24:27], s53 offen offset:1024 sc1
    v_mfma_f32_16x16x32_bf16 v[96:99], v[172:175], v[176:179], v[96:99]
    ds_read_b128 v[152:155], v15 offset:48128
    ds_read_b128 v[156:159], v15 offset:49152
    s_lshl_b32 s45, s41, 3
    s_lshl_b32 s46, s50, 2
    s_add_u32 s45, s45, s46
    s_mul_i32 s45, s45, 73728
    s_mul_i32 s46, s42, 6144
    s_add_u32 s45, s45, s46
    s_mul_i32 s46, s51, 3072
    s_add_u32 s45, s45, s46
    s_mov_b32 s47, 0xffff0000
    s_mul_i32 s63, s40, 36864
    s_waitcnt lgkmcnt(0)
    s_barrier
    v_lshlrev_b32 v160, 16, v112
    v_and_b32 v161, s47, v112
    v_lshlrev_b32 v162, 16, v113
    v_and_b32 v163, s47, v113
    v_lshlrev_b32 v164, 16, v114
    v_and_b32 v165, s47, v114
    v_lshlrev_b32 v166, 16, v115
    v_and_b32 v167, s47, v115
    v_pk_mul_f32 v[160:161], v[160:161], v[16:17]
    v_pk_mul_f32 v[162:163], v[162:163], v[18:19]
    v_pk_mul_f32 v[164:165], v[164:165], v[32:33]
    v_pk_mul_f32 v[166:167], v[166:167], v[34:35]
    v_cvt_pk_bf16_f32 v112, v160, v161
    v_cvt_pk_bf16_f32 v113, v162, v163
    v_cvt_pk_bf16_f32 v114, v164, v165
    v_cvt_pk_bf16_f32 v115, v166, v167
    buffer_store_dwordx4 v[112:115], v14, s[8:11], s45 offen offset:0 sc1
    v_lshlrev_b32 v168, 16, v116
    v_and_b32 v169, s47, v116
    v_lshlrev_b32 v170, 16, v117
    v_and_b32 v171, s47, v117
    v_lshlrev_b32 v172, 16, v118
    v_and_b32 v173, s47, v118
    v_lshlrev_b32 v174, 16, v119
    v_and_b32 v175, s47, v119
    v_pk_mul_f32 v[168:169], v[168:169], v[48:49]
    v_pk_mul_f32 v[170:171], v[170:171], v[50:51]
    v_pk_mul_f32 v[172:173], v[172:173], v[64:65]
    v_pk_mul_f32 v[174:175], v[174:175], v[66:67]
    v_cvt_pk_bf16_f32 v116, v168, v169
    v_cvt_pk_bf16_f32 v117, v170, v171
    v_cvt_pk_bf16_f32 v118, v172, v173
    v_cvt_pk_bf16_f32 v119, v174, v175
    buffer_store_dwordx4 v[116:119], v14, s[8:11], s45 offen offset:1024 sc1
    v_lshlrev_b32 v160, 16, v120
    v_and_b32 v161, s47, v120
    v_lshlrev_b32 v162, 16, v121
    v_and_b32 v163, s47, v121
    v_lshlrev_b32 v164, 16, v122
    v_and_b32 v165, s47, v122
    v_lshlrev_b32 v166, 16, v123
    v_and_b32 v167, s47, v123
    v_pk_mul_f32 v[160:161], v[160:161], v[80:81]
    v_pk_mul_f32 v[162:163], v[162:163], v[82:83]
    v_pk_mul_f32 v[164:165], v[164:165], v[96:97]
    v_pk_mul_f32 v[166:167], v[166:167], v[98:99]
    v_cvt_pk_bf16_f32 v120, v160, v161
    v_cvt_pk_bf16_f32 v121, v162, v163
    v_cvt_pk_bf16_f32 v122, v164, v165
    v_cvt_pk_bf16_f32 v123, v166, v167
    buffer_store_dwordx4 v[120:123], v14, s[8:11], s45 offen offset:2048 sc1
    s_add_u32 s45, s45, 73728
    v_lshlrev_b32 v168, 16, v124
    v_and_b32 v169, s47, v124
    v_lshlrev_b32 v170, 16, v125
    v_and_b32 v171, s47, v125
    v_lshlrev_b32 v172, 16, v126
    v_and_b32 v173, s47, v126
    v_lshlrev_b32 v174, 16, v127
    v_and_b32 v175, s47, v127
    v_pk_mul_f32 v[168:169], v[168:169], v[20:21]
    v_pk_mul_f32 v[170:171], v[170:171], v[22:23]
    v_pk_mul_f32 v[172:173], v[172:173], v[36:37]
    v_pk_mul_f32 v[174:175], v[174:175], v[38:39]
    v_cvt_pk_bf16_f32 v124, v168, v169
    v_cvt_pk_bf16_f32 v125, v170, v171
    v_cvt_pk_bf16_f32 v126, v172, v173
    v_cvt_pk_bf16_f32 v127, v174, v175
    buffer_store_dwordx4 v[124:127], v14, s[8:11], s45 offen offset:0 sc1
    v_lshlrev_b32 v160, 16, v128
    v_and_b32 v161, s47, v128
    v_lshlrev_b32 v162, 16, v129
    v_and_b32 v163, s47, v129
    v_lshlrev_b32 v164, 16, v130
    v_and_b32 v165, s47, v130
    v_lshlrev_b32 v166, 16, v131
    v_and_b32 v167, s47, v131
    v_pk_mul_f32 v[160:161], v[160:161], v[52:53]
    v_pk_mul_f32 v[162:163], v[162:163], v[54:55]
    v_pk_mul_f32 v[164:165], v[164:165], v[68:69]
    v_pk_mul_f32 v[166:167], v[166:167], v[70:71]
    v_cvt_pk_bf16_f32 v128, v160, v161
    v_cvt_pk_bf16_f32 v129, v162, v163
    v_cvt_pk_bf16_f32 v130, v164, v165
    v_cvt_pk_bf16_f32 v131, v166, v167
    buffer_store_dwordx4 v[128:131], v14, s[8:11], s45 offen offset:1024 sc1
    v_lshlrev_b32 v168, 16, v132
    v_and_b32 v169, s47, v132
    v_lshlrev_b32 v170, 16, v133
    v_and_b32 v171, s47, v133
    v_lshlrev_b32 v172, 16, v134
    v_and_b32 v173, s47, v134
    v_lshlrev_b32 v174, 16, v135
    v_and_b32 v175, s47, v135
    v_pk_mul_f32 v[168:169], v[168:169], v[84:85]
    v_pk_mul_f32 v[170:171], v[170:171], v[86:87]
    v_pk_mul_f32 v[172:173], v[172:173], v[100:101]
    v_pk_mul_f32 v[174:175], v[174:175], v[102:103]
    v_cvt_pk_bf16_f32 v132, v168, v169
    v_cvt_pk_bf16_f32 v133, v170, v171
    v_cvt_pk_bf16_f32 v134, v172, v173
    v_cvt_pk_bf16_f32 v135, v174, v175
    buffer_store_dwordx4 v[132:135], v14, s[8:11], s45 offen offset:2048 sc1
    s_add_u32 s45, s45, 73728
    v_lshlrev_b32 v160, 16, v136
    v_and_b32 v161, s47, v136
    v_lshlrev_b32 v162, 16, v137
    v_and_b32 v163, s47, v137
    v_lshlrev_b32 v164, 16, v138
    v_and_b32 v165, s47, v138
    v_lshlrev_b32 v166, 16, v139
    v_and_b32 v167, s47, v139
    v_pk_mul_f32 v[160:161], v[160:161], v[24:25]
    v_pk_mul_f32 v[162:163], v[162:163], v[26:27]
    v_pk_mul_f32 v[164:165], v[164:165], v[40:41]
    v_pk_mul_f32 v[166:167], v[166:167], v[42:43]
    v_cvt_pk_bf16_f32 v136, v160, v161
    v_cvt_pk_bf16_f32 v137, v162, v163
    v_cvt_pk_bf16_f32 v138, v164, v165
    v_cvt_pk_bf16_f32 v139, v166, v167
    buffer_store_dwordx4 v[136:139], v14, s[8:11], s45 offen offset:0 sc1
    v_lshlrev_b32 v168, 16, v140
    v_and_b32 v169, s47, v140
    v_lshlrev_b32 v170, 16, v141
    v_and_b32 v171, s47, v141
    v_lshlrev_b32 v172, 16, v142
    v_and_b32 v173, s47, v142
    v_lshlrev_b32 v174, 16, v143
    v_and_b32 v175, s47, v143
    v_pk_mul_f32 v[168:169], v[168:169], v[56:57]
    v_pk_mul_f32 v[170:171], v[170:171], v[58:59]
    v_pk_mul_f32 v[172:173], v[172:173], v[72:73]
    v_pk_mul_f32 v[174:175], v[174:175], v[74:75]
    v_cvt_pk_bf16_f32 v140, v168, v169
    v_cvt_pk_bf16_f32 v141, v170, v171
    v_cvt_pk_bf16_f32 v142, v172, v173
    v_cvt_pk_bf16_f32 v143, v174, v175
    buffer_store_dwordx4 v[140:143], v14, s[8:11], s45 offen offset:1024 sc1
    v_lshlrev_b32 v160, 16, v144
    v_and_b32 v161, s47, v144
    v_lshlrev_b32 v162, 16, v145
    v_and_b32 v163, s47, v145
    v_lshlrev_b32 v164, 16, v146
    v_and_b32 v165, s47, v146
    v_lshlrev_b32 v166, 16, v147
    v_and_b32 v167, s47, v147
    v_pk_mul_f32 v[160:161], v[160:161], v[88:89]
    v_pk_mul_f32 v[162:163], v[162:163], v[90:91]
    v_pk_mul_f32 v[164:165], v[164:165], v[104:105]
    v_pk_mul_f32 v[166:167], v[166:167], v[106:107]
    v_cvt_pk_bf16_f32 v144, v160, v161
    v_cvt_pk_bf16_f32 v145, v162, v163
    v_cvt_pk_bf16_f32 v146, v164, v165
    v_cvt_pk_bf16_f32 v147, v166, v167
    buffer_store_dwordx4 v[144:147], v14, s[8:11], s45 offen offset:2048 sc1
    s_add_u32 s45, s45, 73728
    v_lshlrev_b32 v168, 16, v148
    v_and_b32 v169, s47, v148
    v_lshlrev_b32 v170, 16, v149
    v_and_b32 v171, s47, v149
    v_lshlrev_b32 v172, 16, v150
    v_and_b32 v173, s47, v150
    v_lshlrev_b32 v174, 16, v151
    v_and_b32 v175, s47, v151
    v_pk_mul_f32 v[168:169], v[168:169], v[28:29]
    v_pk_mul_f32 v[170:171], v[170:171], v[30:31]
    v_pk_mul_f32 v[172:173], v[172:173], v[44:45]
    v_pk_mul_f32 v[174:175], v[174:175], v[46:47]
    v_cvt_pk_bf16_f32 v148, v168, v169
    v_cvt_pk_bf16_f32 v149, v170, v171
    v_cvt_pk_bf16_f32 v150, v172, v173
    v_cvt_pk_bf16_f32 v151, v174, v175
    buffer_store_dwordx4 v[148:151], v14, s[8:11], s45 offen offset:0 sc1
    v_lshlrev_b32 v160, 16, v152
    v_and_b32 v161, s47, v152
    v_lshlrev_b32 v162, 16, v153
    v_and_b32 v163, s47, v153
    v_lshlrev_b32 v164, 16, v154
    v_and_b32 v165, s47, v154
    v_lshlrev_b32 v166, 16, v155
    v_and_b32 v167, s47, v155
    v_pk_mul_f32 v[160:161], v[160:161], v[60:61]
    v_pk_mul_f32 v[162:163], v[162:163], v[62:63]
    v_pk_mul_f32 v[164:165], v[164:165], v[76:77]
    v_pk_mul_f32 v[166:167], v[166:167], v[78:79]
    v_cvt_pk_bf16_f32 v152, v160, v161
    v_cvt_pk_bf16_f32 v153, v162, v163
    v_cvt_pk_bf16_f32 v154, v164, v165
    v_cvt_pk_bf16_f32 v155, v166, v167
    buffer_store_dwordx4 v[152:155], v14, s[8:11], s45 offen offset:1024 sc1
    v_lshlrev_b32 v168, 16, v156
    v_and_b32 v169, s47, v156
    v_lshlrev_b32 v170, 16, v157
    v_and_b32 v171, s47, v157
    v_lshlrev_b32 v172, 16, v158
    v_and_b32 v173, s47, v158
    v_lshlrev_b32 v174, 16, v159
    v_and_b32 v175, s47, v159
    v_pk_mul_f32 v[168:169], v[168:169], v[92:93]
    v_pk_mul_f32 v[170:171], v[170:171], v[94:95]
    v_pk_mul_f32 v[172:173], v[172:173], v[108:109]
    v_pk_mul_f32 v[174:175], v[174:175], v[110:111]
    v_cvt_pk_bf16_f32 v156, v168, v169
    v_cvt_pk_bf16_f32 v157, v170, v171
    v_cvt_pk_bf16_f32 v158, v172, v173
    v_cvt_pk_bf16_f32 v159, v174, v175
    buffer_store_dwordx4 v[156:159], v14, s[8:11], s45 offen offset:2048 sc1
    s_add_u32 s53, s53, 32768
    buffer_load_dwordx4 a[120:123], v14, s[24:27], s53 offen offset:0 sc1
    buffer_load_dwordx4 a[124:127], v14, s[24:27], s53 offen offset:1024 sc1
    buffer_load_dwordx4 a[128:131], v14, s[24:27], s53 offen offset:2048 sc1
    buffer_load_dwordx4 a[132:135], v14, s[24:27], s53 offen offset:3072 sc1
    s_add_u32 s53, s53, 4096
    buffer_load_dwordx4 a[136:139], v14, s[24:27], s53 offen offset:0 sc1
    buffer_load_dwordx4 a[140:143], v14, s[24:27], s53 offen offset:1024 sc1
    s_add_u32 s53, s53, 32768
    buffer_load_dwordx4 a[144:147], v14, s[24:27], s53 offen offset:0 sc1
    buffer_load_dwordx4 a[148:151], v14, s[24:27], s53 offen offset:1024 sc1
    s_waitcnt vmcnt(8)
    v_mov_b32 v221, 1
    buffer_atomic_add v221, v222, s[4:7], s55 offen
    v_and_b32 v15, 15, v1
    v_mul_u32_u24 v2, 1152, v15
    buffer_load_dwordx4 a[152:155], v14, s[24:27], s53 offen offset:2048 sc1
    v_lshrrev_b32 v15, 4, v1
    v_lshl_add_u32 v2, v15, 4, v2
    buffer_load_dwordx4 a[156:159], v14, s[24:27], s53 offen offset:3072 sc1
    s_lshl_b32 s45, s43, 2
    s_add_u32 s45, s45, s40
    s_add_u32 s53, s53, 4096
    buffer_load_dwordx4 a[160:163], v14, s[24:27], s53 offen offset:0 sc1
    s_mul_i32 s45, s45, 18432
    s_mul_i32 s46, s44, 192
    buffer_load_dwordx4 a[164:167], v14, s[24:27], s53 offen offset:1024 sc1
    s_add_u32 s50, s45, s46
    s_mul_i32 s46, s44, 3072
    s_add_u32 s53, s53, 32768
    buffer_load_dwordx4 a[168:171], v14, s[24:27], s53 offen offset:0 sc1
    s_add_u32 s51, s45, s46
    s_mul_i32 s45, s40, 18432
    buffer_load_dwordx4 a[172:175], v14, s[24:27], s53 offen offset:1024 sc1
    v_add_u32 v4, s45, v14
    s_xor_b32 s45, s40, 1
    buffer_load_dwordx4 a[176:179], v14, s[24:27], s53 offen offset:2048 sc1
    s_mul_i32 s45, s45, 18432
    s_add_u32 s45, s45, 0
    buffer_load_dwordx4 a[180:183], v14, s[24:27], s53 offen offset:3072 sc1
    v_add_u32 v5, s45, v14
    s_xor_b32 s45, s40, 2
    s_add_u32 s53, s53, 4096
    buffer_load_dwordx4 a[184:187], v14, s[24:27], s53 offen offset:0 sc1
    s_mul_i32 s45, s45, 18432
    s_add_u32 s45, s45, 6144
    buffer_load_dwordx4 a[188:191], v14, s[24:27], s53 offen offset:1024 sc1
    v_add_u32 v6, s45, v14
    s_xor_b32 s45, s40, 3
    s_add_u32 s53, s53, 32768
    buffer_load_dwordx4 a[192:195], v14, s[24:27], s53 offen offset:0 sc1
    s_mul_i32 s45, s45, 18432
    s_add_u32 s45, s45, 12288
    buffer_load_dwordx4 a[196:199], v14, s[24:27], s53 offen offset:1024 sc1
    v_add_u32 v7, s45, v14
    v_add_u32 v8, s63, v14
    buffer_load_dwordx4 a[200:203], v14, s[24:27], s53 offen offset:2048 sc1
    buffer_load_dwordx4 a[204:207], v14, s[24:27], s53 offen offset:3072 sc1
    s_add_u32 s53, s53, 4096
    buffer_load_dwordx4 a[208:211], v14, s[24:27], s53 offen offset:0 sc1
    buffer_load_dwordx4 a[212:215], v14, s[24:27], s53 offen offset:1024 sc1
    s_add_u32 s53, s53, 32768
    buffer_load_dwordx4 a[216:219], v14, s[24:27], s53 offen offset:0 sc1
    buffer_load_dwordx4 a[220:223], v14, s[24:27], s53 offen offset:1024 sc1
    buffer_load_dwordx4 a[224:227], v14, s[24:27], s53 offen offset:2048 sc1
    buffer_load_dwordx4 a[228:231], v14, s[24:27], s53 offen offset:3072 sc1
    s_add_u32 s53, s53, 4096
    buffer_load_dwordx4 a[232:235], v14, s[24:27], s53 offen offset:0 sc1
    buffer_load_dwordx4 a[236:239], v14, s[24:27], s53 offen offset:1024 sc1
    s_add_u32 s53, s53, 32768
    buffer_load_dwordx4 a[240:243], v14, s[24:27], s53 offen offset:0 sc1
    buffer_load_dwordx4 a[244:247], v14, s[24:27], s53 offen offset:1024 sc1
    buffer_load_dwordx4 a[248:251], v14, s[24:27], s53 offen offset:2048 sc1
    buffer_load_dwordx4 a[252:255], v14, s[24:27], s53 offen offset:3072 sc1
    s_add_u32 s53, s53, 4096
    buffer_load_dwordx4 v[192:195], v14, s[24:27], s53 offen offset:0 sc1
    buffer_load_dwordx4 v[196:199], v14, s[24:27], s53 offen offset:1024 sc1
    s_add_u32 s53, s53, 32768
    buffer_load_dwordx4 v[200:203], v14, s[24:27], s53 offen offset:0 sc1
    buffer_load_dwordx4 v[204:207], v14, s[24:27], s53 offen offset:1024 sc1
    buffer_load_dwordx4 v[208:211], v14, s[24:27], s53 offen offset:2048 sc1
    buffer_load_dwordx4 v[212:215], v14, s[24:27], s53 offen offset:3072 sc1
    s_add_u32 s53, s53, 4096
    buffer_load_dwordx4 v[224:227], v14, s[24:27], s53 offen offset:0 sc1
    buffer_load_dwordx4 v[228:231], v14, s[24:27], s53 offen offset:1024 sc1
    s_add_u32 s53, s53, 32768
    s_add_u32 m0, s63, 0
    s_nop 0
    buffer_load_dwordx4 v14, s[24:27], s53 offen offset:0 sc1 lds
    buffer_load_dwordx4 v14, s[24:27], s53 offen offset:1024 sc1 lds
    s_cmp_eq_u32 s40, 0
    s_cselect_b32 s3, 24, 0
    s_cselect_b32 s49, 8, 0
    s_cselect_b32 s6, s6, 0
    v_mov_b32 v223, 0
    buffer_atomic_add v223, v222, s[4:7], s54 offen sc0
    buffer_load_dwordx4 v14, s[24:27], s53 offen offset:2048 sc1 lds
    buffer_load_dwordx4 v14, s[24:27], s53 offen offset:3072 sc1 lds
    s_add_u32 s53, s53, 4096
    s_add_u32 m0, s63, 4096
    s_nop 0
    buffer_load_dwordx4 v14, s[24:27], s53 offen offset:0 sc1 lds
    buffer_load_dwordx4 v14, s[24:27], s53 offen offset:1024 sc1 lds
    s_add_u32 s53, s53, 32768
    s_add_u32 m0, s63, 6144
    s_nop 0
    buffer_load_dwordx4 v14, s[24:27], s53 offen offset:0 sc1 lds
    buffer_load_dwordx4 v14, s[24:27], s53 offen offset:1024 sc1 lds
    buffer_load_dwordx4 v14, s[24:27], s53 offen offset:2048 sc1 lds
    buffer_load_dwordx4 v14, s[24:27], s53 offen offset:3072 sc1 lds
    s_add_u32 s53, s53, 4096
    s_add_u32 m0, s63, 10240
    s_nop 0
    buffer_load_dwordx4 v14, s[24:27], s53 offen offset:0 sc1 lds
    buffer_load_dwordx4 v14, s[24:27], s53 offen offset:1024 sc1 lds
    s_add_u32 s53, s53, 32768
    s_add_u32 m0, s63, 12288
    s_nop 0
    buffer_load_dwordx4 v14, s[24:27], s53 offen offset:0 sc1 lds
    buffer_load_dwordx4 v14, s[24:27], s53 offen offset:1024 sc1 lds
    buffer_load_dwordx4 v14, s[24:27], s53 offen offset:2048 sc1 lds
    buffer_load_dwordx4 v14, s[24:27], s53 offen offset:3072 sc1 lds
    s_add_u32 s53, s53, 4096
    s_add_u32 m0, s63, 16384
    s_nop 0
    buffer_load_dwordx4 v14, s[24:27], s53 offen offset:0 sc1 lds
    buffer_load_dwordx4 v14, s[24:27], s53 offen offset:1024 sc1 lds
    s_add_u32 s53, s53, 32768
    s_waitcnt vmcnt(16)
    s_mov_b32 s60, 0
k1_kernel_pl16:
    v_bfe_u32 v223, v223, 0, 8
    v_cmp_gt_u32 vcc, s3, v223
    s_add_u32 s60, s60, 1
    s_and_b32 vcc_lo, vcc_lo, 1
    s_cbranch_scc0 k1_kernel_pd17
    s_cmp_ge_u32 s60, 200000
    s_cbranch_scc1 k1_kernel_pd17
    s_sleep 2
    v_mov_b32 v223, 0
    buffer_atomic_add v223, v222, s[4:7], s54 offen sc0
    s_waitcnt vmcnt(0)
    s_branch k1_kernel_pl16
k1_kernel_pd17:
    s_barrier
    buffer_load_dwordx4 v[232:235], v244, s[8:11], s52 offen offset:0 sc1
    buffer_load_dwordx4 v[236:239], v245, s[8:11], s52 offen offset:0 sc1
    buffer_load_dwordx4 v[240:243], v246, s[8:11], s52 offen offset:0 sc1
    buffer_load_dwordx4 v[248:251], v247, s[8:11], s52 offen offset:0 sc1
    buffer_load_dwordx4 v[252:255], v244, s[8:11], s52 offen offset:1024 sc1
    buffer_load_dwordx4 v[112:115], v245, s[8:11], s52 offen offset:1024 sc1
    buffer_load_dwordx4 v[116:119], v246, s[8:11], s52 offen offset:1024 sc1
    buffer_load_dwordx4 v[120:123], v247, s[8:11], s52 offen offset:1024 sc1
    buffer_load_dwordx4 v[124:127], v244, s[8:11], s52 offen offset:2048 sc1
    buffer_load_dwordx4 v[128:131], v245, s[8:11], s52 offen offset:2048 sc1
    buffer_load_dwordx4 v[132:135], v246, s[8:11], s52 offen offset:2048 sc1
    buffer_load_dwordx4 v[136:139], v247, s[8:11], s52 offen offset:2048 sc1
    buffer_load_dwordx4 v[140:143], v244, s[8:11], s52 offen offset:3072 sc1
    buffer_load_dwordx4 v[144:147], v245, s[8:11], s52 offen offset:3072 sc1
    buffer_load_dwordx4 v[148:151], v246, s[8:11], s52 offen offset:3072 sc1
    buffer_load_dwordx4 v[152:155], v247, s[8:11], s52 offen offset:3072 sc1
    s_add_u32 s52, s52, 4096
    buffer_load_dwordx4 v[156:159], v244, s[8:11], s52 offen offset:0 sc1
    buffer_load_dwordx4 v[160:163], v245, s[8:11], s52 offen offset:0 sc1
    buffer_load_dwordx4 v[164:167], v246, s[8:11], s52 offen offset:0 sc1
    buffer_load_dwordx4 v[168:171], v247, s[8:11], s52 offen offset:0 sc1
    s_waitcnt vmcnt(16)
    v_mfma_f32_16x16x32_bf16 v[16:19], a[0:3], v[232:235], 0
    buffer_load_dwordx4 v[172:175], v244, s[8:11], s52 offen offset:1024 sc1
    v_mfma_f32_16x16x32_bf16 v[20:23], a[0:3], v[236:239], 0
    v_mfma_f32_16x16x32_bf16 v[24:27], a[0:3], v[240:243], 0
    v_mfma_f32_16x16x32_bf16 v[28:31], a[0:3], v[248:251], 0
    v_mfma_f32_16x16x32_bf16 v[32:35], a[4:7], v[232:235], 0
    buffer_load_dwordx4 v[176:179], v245, s[8:11], s52 offen offset:1024 sc1
    v_mfma_f32_16x16x32_bf16 v[36:39], a[4:7], v[236:239], 0
    v_mfma_f32_16x16x32_bf16 v[40:43], a[4:7], v[240:243], 0
    v_mfma_f32_16x16x32_bf16 v[44:47], a[4:7], v[248:251], 0
    v_mfma_f32_16x16x32_bf16 v[48:51], a[8:11], v[232:235], 0
    buffer_load_dwordx4 v[180:183], v246, s[8:11], s52 offen offset:1024 sc1
    v_mfma_f32_16x16x32_bf16 v[52:55], a[8:11], v[236:239], 0
    v_mfma_f32_16x16x32_bf16 v[56:59], a[8:11], v[240:243], 0
    v_mfma_f32_16x16x32_bf16 v[60:63], a[8:11], v[248:251], 0
    v_mfma_f32_16x16x32_bf16 v[64:67], a[12:15], v[232:235], 0
    buffer_load_dwordx4 v[184:187], v247, s[8:11], s52 offen offset:1024 sc1
    v_mfma_f32_16x16x32_bf16 v[68:71], a[12:15], v[236:239], 0
    v_mfma_f32_16x16x32_bf16 v[72:75], a[12:15], v[240:243], 0
    v_mfma_f32_16x16x32_bf16 v[76:79], a[12:15], v[248:251], 0
    v_mfma_f32_16x16x32_bf16 v[80:83], a[16:19], v[232:235], 0
    s_add_u32 m0, s63, 18432
    s_nop 0
    buffer_load_dwordx4 v14, s[24:27], s53 offen offset:0 sc1 lds
    v_mfma_f32_16x16x32_bf16 v[84:87], a[16:19], v[236:239], 0
    v_mfma_f32_16x16x32_bf16 v[88:91], a[16:19], v[240:243], 0
    v_mfma_f32_16x16x32_bf16 v[92:95], a[16:19], v[248:251], 0
    v_mfma_f32_16x16x32_bf16 v[96:99], a[20:23], v[232:235], 0
    buffer_load_dwordx4 v14, s[24:27], s53 offen offset:1024 sc1 lds
    v_mfma_f32_16x16x32_bf16 v[100:103], a[20:23], v[236:239], 0
    v_mfma_f32_16x16x32_bf16 v[104:107], a[20:23], v[240:243], 0
    v_mfma_f32_16x16x32_bf16 v[108:111], a[20:23], v[248:251], 0
    s_waitcnt vmcnt(18)
    v_mfma_f32_16x16x32_bf16 v[16:19], a[24:27], v[252:255], v[16:19]
    buffer_load_dwordx4 v[188:191], v244, s[8:11], s52 offen offset:2048 sc1
    v_mfma_f32_16x16x32_bf16 v[20:23], a[24:27], v[112:115], v[20:23]
    v_mfma_f32_16x16x32_bf16 v[24:27], a[24:27], v[116:119], v[24:27]
    v_mfma_f32_16x16x32_bf16 v[28:31], a[24:27], v[120:123], v[28:31]
    v_mfma_f32_16x16x32_bf16 v[32:35], a[28:31], v[252:255], v[32:35]
    buffer_load_dwordx4 a[0:3], v245, s[8:11], s52 offen offset:2048 sc1
    v_mfma_f32_16x16x32_bf16 v[36:39], a[28:31], v[112:115], v[36:39]
    v_mfma_f32_16x16x32_bf16 v[40:43], a[28:31], v[116:119], v[40:43]
    v_mfma_f32_16x16x32_bf16 v[44:47], a[28:31], v[120:123], v[44:47]
    v_mfma_f32_16x16x32_bf16 v[48:51], a[32:35], v[252:255], v[48:51]
    buffer_load_dwordx4 a[4:7], v246, s[8:11], s52 offen offset:2048 sc1
    v_mfma_f32_16x16x32_bf16 v[52:55], a[32:35], v[112:115], v[52:55]
    v_mfma_f32_16x16x32_bf16 v[56:59], a[32:35], v[116:119], v[56:59]
    v_mfma_f32_16x16x32_bf16 v[60:63], a[32:35], v[120:123], v[60:63]
    v_mfma_f32_16x16x32_bf16 v[64:67], a[36:39], v[252:255], v[64:67]
    buffer_load_dwordx4 a[8:11], v247, s[8:11], s52 offen offset:2048 sc1
    v_mfma_f32_16x16x32_bf16 v[68:71], a[36:39], v[112:115], v[68:71]
    v_mfma_f32_16x16x32_bf16 v[72:75], a[36:39], v[116:119], v[72:75]
    v_mfma_f32_16x16x32_bf16 v[76:79], a[36:39], v[120:123], v[76:79]
    v_mfma_f32_16x16x32_bf16 v[80:83], a[40:43], v[252:255], v[80:83]
    buffer_load_dwordx4 v14, s[24:27], s53 offen offset:2048 sc1 lds
    v_mfma_f32_16x16x32_bf16 v[84:87], a[40:43], v[112:115], v[84:87]
    v_mfma_f32_16x16x32_bf16 v[88:91], a[40:43], v[116:119], v[88:91]
    v_mfma_f32_16x16x32_bf16 v[92:95], a[40:43], v[120:123], v[92:95]
    v_mfma_f32_16x16x32_bf16 v[96:99], a[44:47], v[252:255], v[96:99]
    buffer_load_dwordx4 v14, s[24:27], s53 offen offset:3072 sc1 lds
    v_mfma_f32_16x16x32_bf16 v[100:103], a[44:47], v[112:115], v[100:103]
    v_mfma_f32_16x16x32_bf16 v[104:107], a[44:47], v[116:119], v[104:107]
    v_mfma_f32_16x16x32_bf16 v[108:111], a[44:47], v[120:123], v[108:111]
    s_waitcnt vmcnt(20)
    v_mfma_f32_16x16x32_bf16 v[16:19], a[48:51], v[124:127], v[16:19]
    buffer_load_dwordx4 a[12:15], v244, s[8:11], s52 offen offset:3072 sc1
    v_mfma_f32_16x16x32_bf16 v[20:23], a[48:51], v[128:131], v[20:23]
    v_mfma_f32_16x16x32_bf16 v[24:27], a[48:51], v[132:135], v[24:27]
    v_mfma_f32_16x16x32_bf16 v[28:31], a[48:51], v[136:139], v[28:31]
    v_mfma_f32_16x16x32_bf16 v[32:35], a[52:55], v[124:127], v[32:35]
    buffer_load_dwordx4 a[16:19], v245, s[8:11], s52 offen offset:3072 sc1
    v_mfma_f32_16x16x32_bf16 v[36:39], a[52:55], v[128:131], v[36:39]
    v_mfma_f32_16x16x32_bf16 v[40:43], a[52:55], v[132:135], v[40:43]
    v_mfma_f32_16x16x32_bf16 v[44:47], a[52:55], v[136:139], v[44:47]
    v_mfma_f32_16x16x32_bf16 v[48:51], a[56:59], v[124:127], v[48:51]
    buffer_load_dwordx4 a[20:23], v246, s[8:11], s52 offen offset:3072 sc1
    v_mfma_f32_16x16x32_bf16 v[52:55], a[56:59], v[128:131], v[52:55]
    v_mfma_f32_16x16x32_bf16 v[56:59], a[56:59], v[132:135], v[56:59]
    v_mfma_f32_16x16x32_bf16 v[60:63], a[56:59], v[136:139], v[60:63]
    v_mfma_f32_16x16x32_bf16 v[64:67], a[60:63], v[124:127], v[64:67]
    buffer_load_dwordx4 v[232:235], v247, s[8:11], s52 offen offset:3072 sc1
    v_mfma_f32_16x16x32_bf16 v[68:71], a[60:63], v[128:131], v[68:71]
    v_mfma_f32_16x16x32_bf16 v[72:75], a[60:63], v[132:135], v[72:75]
    v_mfma_f32_16x16x32_bf16 v[76:79], a[60:63], v[136:139], v[76:79]
    v_mfma_f32_16x16x32_bf16 v[80:83], a[64:67], v[124:127], v[80:83]
    s_add_u32 s52, s52, 4096
    s_add_u32 s53, s53, 4096
    s_add_u32 m0, s63, 22528
    s_nop 0
    buffer_load_dwordx4 v14, s[24:27], s53 offen offset:0 sc1 lds
    v_mfma_f32_16x16x32_bf16 v[84:87], a[64:67], v[128:131], v[84:87]
    v_mfma_f32_16x16x32_bf16 v[88:91], a[64:67], v[132:135], v[88:91]
    v_mfma_f32_16x16x32_bf16 v[92:95], a[64:67], v[136:139], v[92:95]
    v_mfma_f32_16x16x32_bf16 v[96:99], a[68:71], v[124:127], v[96:99]
    buffer_load_dwordx4 v14, s[24:27], s53 offen offset:1024 sc1 lds
    v_mfma_f32_16x16x32_bf16 v[100:103], a[68:71], v[128:131], v[100:103]
    v_mfma_f32_16x16x32_bf16 v[104:107], a[68:71], v[132:135], v[104:107]
    v_mfma_f32_16x16x32_bf16 v[108:111], a[68:71], v[136:139], v[108:111]
    s_waitcnt vmcnt(22)
    v_mfma_f32_16x16x32_bf16 v[16:19], a[72:75], v[140:143], v[16:19]
    buffer_load_dwordx4 v[236:239], v244, s[8:11], s52 offen offset:0 sc1
    v_mfma_f32_16x16x32_bf16 v[20:23], a[72:75], v[144:147], v[20:23]
    v_mfma_f32_16x16x32_bf16 v[24:27], a[72:75], v[148:151], v[24:27]
    v_mfma_f32_16x16x32_bf16 v[28:31], a[72:75], v[152:155], v[28:31]
    v_mfma_f32_16x16x32_bf16 v[32:35], a[76:79], v[140:143], v[32:35]
    buffer_load_dwordx4 v[240:243], v245, s[8:11], s52 offen offset:0 sc1
    v_mfma_f32_16x16x32_bf16 v[36:39], a[76:79], v[144:147], v[36:39]
    v_mfma_f32_16x16x32_bf16 v[40:43], a[76:79], v[148:151], v[40:43]
    v_mfma_f32_16x16x32_bf16 v[44:47], a[76:79], v[152:155], v[44:47]
    v_mfma_f32_16x16x32_bf16 v[48:51], a[80:83], v[140:143], v[48:51]
    buffer_load_dwordx4 v[248:251], v246, s[8:11], s52 offen offset:0 sc1
    v_mfma_f32_16x16x32_bf16 v[52:55], a[80:83], v[144:147], v[52:55]
    v_mfma_f32_16x16x32_bf16 v[56:59], a[80:83], v[148:151], v[56:59]
    v_mfma_f32_16x16x32_bf16 v[60:63], a[80:83], v[152:155], v[60:63]
    v_mfma_f32_16x16x32_bf16 v[64:67], a[84:87], v[140:143], v[64:67]
    buffer_load_dwordx4 a[24:27], v247, s[8:11], s52 offen offset:0 sc1
    v_mfma_f32_16x16x32_bf16 v[68:71], a[84:87], v[144:147], v[68:71]
    v_mfma_f32_16x16x32_bf16 v[72:75], a[84:87], v[148:151], v[72:75]
    v_mfma_f32_16x16x32_bf16 v[76:79], a[84:87], v[152:155], v[76:79]
    v_mfma_f32_16x16x32_bf16 v[80:83], a[88:91], v[140:143], v[80:83]
    s_add_u32 s53, s53, 32768
    s_add_u32 m0, s63, 24576
    s_nop 0
    buffer_load_dwordx4 v14, s[24:27], s53 offen offset:0 sc1 lds
    v_mfma_f32_16x16x32_bf16 v[84:87], a[88:91], v[144:147], v[84:87]
    v_mfma_f32_16x16x32_bf16 v[88:91], a[88:91], v[148:151], v[88:91]
    v_mfma_f32_16x16x32_bf16 v[92:95], a[88:91], v[152:155], v[92:95]
    v_mfma_f32_16x16x32_bf16 v[96:99], a[92:95], v[140:143], v[96:99]
    buffer_load_dwordx4 v14, s[24:27], s53 offen offset:1024 sc1 lds
    v_mfma_f32_16x16x32_bf16 v[100:103], a[92:95], v[144:147], v[100:103]
    v_mfma_f32_16x16x32_bf16 v[104:107], a[92:95], v[148:151], v[104:107]
    v_mfma_f32_16x16x32_bf16 v[108:111], a[92:95], v[152:155], v[108:111]
    s_waitcnt vmcnt(24)
    v_mfma_f32_16x16x32_bf16 v[16:19], a[96:99], v[156:159], v[16:19]
    buffer_load_dwordx4 a[28:31], v244, s[8:11], s52 offen offset:1024 sc1
    v_mfma_f32_16x16x32_bf16 v[20:23], a[96:99], v[160:163], v[20:23]
    v_mfma_f32_16x16x32_bf16 v[24:27], a[96:99], v[164:167], v[24:27]
    v_mfma_f32_16x16x32_bf16 v[28:31], a[96:99], v[168:171], v[28:31]
    v_mfma_f32_16x16x32_bf16 v[32:35], a[100:103], v[156:159], v[32:35]
    buffer_load_dwordx4 a[32:35], v245, s[8:11], s52 offen offset:1024 sc1
    v_mfma_f32_16x16x32_bf16 v[36:39], a[100:103], v[160:163], v[36:39]
    v_mfma_f32_16x16x32_bf16 v[40:43], a[100:103], v[164:167], v[40:43]
    v_mfma_f32_16x16x32_bf16 v[44:47], a[100:103], v[168:171], v[44:47]
    v_mfma_f32_16x16x32_bf16 v[48:51], a[104:107], v[156:159], v[48:51]
    buffer_load_dwordx4 a[36:39], v246, s[8:11], s52 offen offset:1024 sc1
    v_mfma_f32_16x16x32_bf16 v[52:55], a[104:107], v[160:163], v[52:55]
    v_mfma_f32_16x16x32_bf16 v[56:59], a[104:107], v[164:167], v[56:59]
    v_mfma_f32_16x16x32_bf16 v[60:63], a[104:107], v[168:171], v[60:63]
    v_mfma_f32_16x16x32_bf16 v[64:67], a[108:111], v[156:159], v[64:67]
    buffer_load_dwordx4 a[40:43], v247, s[8:11], s52 offen offset:1024 sc1
    v_mfma_f32_16x16x32_bf16 v[68:71], a[108:111], v[160:163], v[68:71]
    v_mfma_f32_16x16x32_bf16 v[72:75], a[108:111], v[164:167], v[72:75]
    v_mfma_f32_16x16x32_bf16 v[76:79], a[108:111], v[168:171], v[76:79]
    v_mfma_f32_16x16x32_bf16 v[80:83], a[112:115], v[156:159], v[80:83]
    buffer_load_dwordx4 v14, s[24:27], s53 offen offset:2048 sc1 lds
    v_mfma_f32_16x16x32_bf16 v[84:87], a[112:115], v[160:163], v[84:87]
    v_mfma_f32_16x16x32_bf16 v[88:91], a[112:115], v[164:167], v[88:91]
    v_mfma_f32_16x16x32_bf16 v[92:95], a[112:115], v[168:171], v[92:95]
    v_mfma_f32_16x16x32_bf16 v[96:99], a[116:119], v[156:159], v[96:99]
    buffer_load_dwordx4 v14, s[24:27], s53 offen offset:3072 sc1 lds
    v_mfma_f32_16x16x32_bf16 v[100:103], a[116:119], v[160:163], v[100:103]
    v_mfma_f32_16x16x32_bf16 v[104:107], a[116:119], v[164:167], v[104:107]
    v_mfma_f32_16x16x32_bf16 v[108:111], a[116:119], v[168:171], v[108:111]
    s_waitcnt vmcnt(26)
    v_mfma_f32_16x16x32_bf16 v[16:19], a[120:123], v[172:175], v[16:19]
    buffer_load_dwordx4 a[44:47], v244, s[8:11], s52 offen offset:2048 sc1
    v_mfma_f32_16x16x32_bf16 v[20:23], a[120:123], v[176:179], v[20:23]
    v_mfma_f32_16x16x32_bf16 v[24:27], a[120:123], v[180:183], v[24:27]
    v_mfma_f32_16x16x32_bf16 v[28:31], a[120:123], v[184:187], v[28:31]
    v_mfma_f32_16x16x32_bf16 v[32:35], a[124:127], v[172:175], v[32:35]
    buffer_load_dwordx4 v[252:255], v245, s[8:11], s52 offen offset:2048 sc1
    v_mfma_f32_16x16x32_bf16 v[36:39], a[124:127], v[176:179], v[36:39]
    v_mfma_f32_16x16x32_bf16 v[40:43], a[124:127], v[180:183], v[40:43]
    v_mfma_f32_16x16x32_bf16 v[44:47], a[124:127], v[184:187], v[44:47]
    v_mfma_f32_16x16x32_bf16 v[48:51], a[128:131], v[172:175], v[48:51]
    buffer_load_dwordx4 v[112:115], v246, s[8:11], s52 offen offset:2048 sc1
    v_mfma_f32_16x16x32_bf16 v[52:55], a[128:131], v[176:179], v[52:55]
    v_mfma_f32_16x16x32_bf16 v[56:59], a[128:131], v[180:183], v[56:59]
    v_mfma_f32_16x16x32_bf16 v[60:63], a[128:131], v[184:187], v[60:63]
    v_mfma_f32_16x16x32_bf16 v[64:67], a[132:135], v[172:175], v[64:67]
    buffer_load_dwordx4 v[116:119], v247, s[8:11], s52 offen offset:2048 sc1
    v_mfma_f32_16x16x32_bf16 v[68:71], a[132:135], v[176:179], v[68:71]
    v_mfma_f32_16x16x32_bf16 v[72:75], a[132:135], v[180:183], v[72:75]
    v_mfma_f32_16x16x32_bf16 v[76:79], a[132:135], v[184:187], v[76:79]
    v_mfma_f32_16x16x32_bf16 v[80:83], a[136:139], v[172:175], v[80:83]
    s_add_u32 s53, s53, 4096
    s_add_u32 m0, s63, 28672
    s_nop 0
    buffer_load_dwordx4 v14, s[24:27], s53 offen offset:0 sc1 lds
    v_mfma_f32_16x16x32_bf16 v[84:87], a[136:139], v[176:179], v[84:87]
    v_mfma_f32_16x16x32_bf16 v[88:91], a[136:139], v[180:183], v[88:91]
    v_mfma_f32_16x16x32_bf16 v[92:95], a[136:139], v[184:187], v[92:95]
    v_mfma_f32_16x16x32_bf16 v[96:99], a[140:143], v[172:175], v[96:99]
    buffer_load_dwordx4 v14, s[24:27], s53 offen offset:1024 sc1 lds
    v_mfma_f32_16x16x32_bf16 v[100:103], a[140:143], v[176:179], v[100:103]
    v_mfma_f32_16x16x32_bf16 v[104:107], a[140:143], v[180:183], v[104:107]
    v_mfma_f32_16x16x32_bf16 v[108:111], a[140:143], v[184:187], v[108:111]
    s_waitcnt vmcnt(26)
    v_mfma_f32_16x16x32_bf16 v[16:19], a[144:147], v[188:191], v[16:19]
    buffer_load_dwordx4 v[120:123], v244, s[8:11], s52 offen offset:3072 sc1
    v_mfma_f32_16x16x32_bf16 v[20:23], a[144:147], a[0:3], v[20:23]
    v_mfma_f32_16x16x32_bf16 v[24:27], a[144:147], a[4:7], v[24:27]
    v_mfma_f32_16x16x32_bf16 v[28:31], a[144:147], a[8:11], v[28:31]
    v_mfma_f32_16x16x32_bf16 v[32:35], a[148:151], v[188:191], v[32:35]
    buffer_load_dwordx4 a[48:51], v245, s[8:11], s52 offen offset:3072 sc1
    v_mfma_f32_16x16x32_bf16 v[36:39], a[148:151], a[0:3], v[36:39]
    v_mfma_f32_16x16x32_bf16 v[40:43], a[148:151], a[4:7], v[40:43]
    v_mfma_f32_16x16x32_bf16 v[44:47], a[148:151], a[8:11], v[44:47]
    v_mfma_f32_16x16x32_bf16 v[48:51], a[152:155], v[188:191], v[48:51]
    buffer_load_dwordx4 a[52:55], v246, s[8:11], s52 offen offset:3072 sc1
    v_mfma_f32_16x16x32_bf16 v[52:55], a[152:155], a[0:3], v[52:55]
    v_mfma_f32_16x16x32_bf16 v[56:59], a[152:155], a[4:7], v[56:59]
    v_mfma_f32_16x16x32_bf16 v[60:63], a[152:155], a[8:11], v[60:63]
    v_mfma_f32_16x16x32_bf16 v[64:67], a[156:159], v[188:191], v[64:67]
    buffer_load_dwordx4 a[56:59], v247, s[8:11], s52 offen offset:3072 sc1
    v_mfma_f32_16x16x32_bf16 v[68:71], a[156:159], a[0:3], v[68:71]
    v_mfma_f32_16x16x32_bf16 v[72:75], a[156:159], a[4:7], v[72:75]
    v_mfma_f32_16x16x32_bf16 v[76:79], a[156:159], a[8:11], v[76:79]
    v_mfma_f32_16x16x32_bf16 v[80:83], a[160:163], v[188:191], v[80:83]
    s_add_u32 s52, s52, 4096
    s_add_u32 s53, s53, 32768
    s_add_u32 m0, s63, 30720
    s_nop 0
    buffer_load_dwordx4 v14, s[24:27], s53 offen offset:0 sc1 lds
    v_mfma_f32_16x16x32_bf16 v[84:87], a[160:163], a[0:3], v[84:87]
    v_mfma_f32_16x16x32_bf16 v[88:91], a[160:163], a[4:7], v[88:91]
    v_mfma_f32_16x16x32_bf16 v[92:95], a[160:163], a[8:11], v[92:95]
    v_mfma_f32_16x16x32_bf16 v[96:99], a[164:167], v[188:191], v[96:99]
    buffer_load_dwordx4 v14, s[24:27], s53 offen offset:1024 sc1 lds
    v_mfma_f32_16x16x32_bf16 v[100:103], a[164:167], a[0:3], v[100:103]
    v_mfma_f32_16x16x32_bf16 v[104:107], a[164:167], a[4:7], v[104:107]
    v_mfma_f32_16x16x32_bf16 v[108:111], a[164:167], a[8:11], v[108:111]
    s_waitcnt vmcnt(26)
    v_mfma_f32_16x16x32_bf16 v[16:19], a[168:171], a[12:15], v[16:19]
    buffer_load_dwordx4 a[60:63], v244, s[8:11], s52 offen offset:0 sc1
    v_mfma_f32_16x16x32_bf16 v[20:23], a[168:171], a[16:19], v[20:23]
    v_mfma_f32_16x16x32_bf16 v[24:27], a[168:171], a[20:23], v[24:27]
    v_mfma_f32_16x16x32_bf16 v[28:31], a[168:171], v[232:235], v[28:31]
    v_mfma_f32_16x16x32_bf16 v[32:35], a[172:175], a[12:15], v[32:35]
    buffer_load_dwordx4 a[64:67], v245, s[8:11], s52 offen offset:0 sc1
    v_mfma_f32_16x16x32_bf16 v[36:39], a[172:175], a[16:19], v[36:39]
    v_mfma_f32_16x16x32_bf16 v[40:43], a[172:175], a[20:23], v[40:43]
    v_mfma_f32_16x16x32_bf16 v[44:47], a[172:175], v[232:235], v[44:47]
    v_mfma_f32_16x16x32_bf16 v[48:51], a[176:179], a[12:15], v[48:51]
    buffer_load_dwordx4 a[68:71], v246, s[8:11], s52 offen offset:0 sc1
    v_mfma_f32_16x16x32_bf16 v[52:55], a[176:179], a[16:19], v[52:55]
    v_mfma_f32_16x16x32_bf16 v[56:59], a[176:179], a[20:23], v[56:59]
    v_mfma_f32_16x16x32_bf16 v[60:63], a[176:179], v[232:235], v[60:63]
    v_mfma_f32_16x16x32_bf16 v[64:67], a[180:183], a[12:15], v[64:67]
    buffer_load_dwordx4 v[124:127], v247, s[8:11], s52 offen offset:0 sc1
    v_mfma_f32_16x16x32_bf16 v[68:71], a[180:183], a[16:19], v[68:71]
    v_mfma_f32_16x16x32_bf16 v[72:75], a[180:183], a[20:23], v[72:75]
    v_mfma_f32_16x16x32_bf16 v[76:79], a[180:183], v[232:235], v[76:79]
    v_mfma_f32_16x16x32_bf16 v[80:83], a[184:187], a[12:15], v[80:83]
    buffer_load_dwordx4 v14, s[24:27], s53 offen offset:2048 sc1 lds
    v_mfma_f32_16x16x32_bf16 v[84:87], a[184:187], a[16:19], v[84:87]
    v_mfma_f32_16x16x32_bf16 v[88:91], a[184:187], a[20:23], v[88:91]
    v_mfma_f32_16x16x32_bf16 v[92:95], a[184:187], v[232:235], v[92:95]
    v_mfma_f32_16x16x32_bf16 v[96:99], a[188:191], a[12:15], v[96:99]
    buffer_load_dwordx4 v14, s[24:27], s53 offen offset:3072 sc1 lds
    v_mfma_f32_16x16x32_bf16 v[100:103], a[188:191], a[16:19], v[100:103]
    v_mfma_f32_16x16x32_bf16 v[104:107], a[188:191], a[20:23], v[104:107]
    v_mfma_f32_16x16x32_bf16 v[108:111], a[188:191], v[232:235], v[108:111]
    s_waitcnt vmcnt(26)
    v_mfma_f32_16x16x32_bf16 v[16:19], a[192:195], v[236:239], v[16:19]
    buffer_load_dwordx4 v[128:131], v244, s[8:11], s52 offen offset:1024 sc1
    v_mfma_f32_16x16x32_bf16 v[20:23], a[192:195], v[240:243], v[20:23]
    v_mfma_f32_16x16x32_bf16 v[24:27], a[192:195], v[248:251], v[24:27]
    v_mfma_f32_16x16x32_bf16 v[28:31], a[192:195], a[24:27], v[28:31]
    v_mfma_f32_16x16x32_bf16 v[32:35], a[196:199], v[236:239], v[32:35]
    buffer_load_dwordx4 v[132:135], v245, s[8:11], s52 offen offset:1024 sc1
    v_mfma_f32_16x16x32_bf16 v[36:39], a[196:199], v[240:243], v[36:39]
    v_mfma_f32_16x16x32_bf16 v[40:43], a[196:199], v[248:251], v[40:43]
    v_mfma_f32_16x16x32_bf16 v[44:47], a[196:199], a[24:27], v[44:47]
    v_mfma_f32_16x16x32_bf16 v[48:51], a[200:203], v[236:239], v[48:51]
    buffer_load_dwordx4 v[136:139], v246, s[8:11], s52 offen offset:1024 sc1
    v_mfma_f32_16x16x32_bf16 v[52:55], a[200:203], v[240:243], v[52:55]
    v_mfma_f32_16x16x32_bf16 v[56:59], a[200:203], v[248:251], v[56:59]
    v_mfma_f32_16x16x32_bf16 v[60:63], a[200:203], a[24:27], v[60:63]
    v_mfma_f32_16x16x32_bf16 v[64:67], a[204:207], v[236:239], v[64:67]
    buffer_load_dwordx4 a[72:75], v247, s[8:11], s52 offen offset:1024 sc1
    v_mfma_f32_16x16x32_bf16 v[68:71], a[204:207], v[240:243], v[68:71]
    v_mfma_f32_16x16x32_bf16 v[72:75], a[204:207], v[248:251], v[72:75]
    v_mfma_f32_16x16x32_bf16 v[76:79], a[204:207], a[24:27], v[76:79]
    v_mfma_f32_16x16x32_bf16 v[80:83], a[208:211], v[236:239], v[80:83]
    s_add_u32 s53, s53, 4096
    s_add_u32 m0, s63, 34816
    s_nop 0
    buffer_load_dwordx4 v14, s[24:27], s53 offen offset:0 sc1 lds
    v_mfma_f32_16x16x32_bf16 v[84:87], a[208:211], v[240:243], v[84:87]
    v_mfma_f32_16x16x32_bf16 v[88:91], a[208:211], v[248:251], v[88:91]
    v_mfma_f32_16x16x32_bf16 v[92:95], a[208:211], a[24:27], v[92:95]
    v_mfma_f32_16x16x32_bf16 v[96:99], a[212:215], v[236:239], v[96:99]
    buffer_load_dwordx4 v14, s[24:27], s53 offen offset:1024 sc1 lds
    v_mfma_f32_16x16x32_bf16 v[100:103], a[212:215], v[240:243], v[100:103]
    v_mfma_f32_16x16x32_bf16 v[104:107], a[212:215], v[248:251], v[104:107]
    v_mfma_f32_16x16x32_bf16 v[108:111], a[212:215], a[24:27], v[108:111]
    s_waitcnt vmcnt(26)
    v_mfma_f32_16x16x32_bf16 v[16:19], a[216:219], a[28:31], v[16:19]
    buffer_load_dwordx4 v[144:147], v244, s[8:11], s52 offen offset:2048 sc1
    v_mfma_f32_16x16x32_bf16 v[20:23], a[216:219], a[32:35], v[20:23]
    v_mfma_f32_16x16x32_bf16 v[24:27], a[216:219], a[36:39], v[24:27]
    ds_read_b128 a[76:79], v8 offset:0
    v_mfma_f32_16x16x32_bf16 v[28:31], a[216:219], a[40:43], v[28:31]
    v_mfma_f32_16x16x32_bf16 v[32:35], a[220:223], a[28:31], v[32:35]
    buffer_load_dwordx4 v[148:151], v245, s[8:11], s52 offen offset:2048 sc1
    v_mfma_f32_16x16x32_bf16 v[36:39], a[220:223], a[32:35], v[36:39]
    ds_read_b128 a[80:83], v8 offset:1024
    v_mfma_f32_16x16x32_bf16 v[40:43], a[220:223], a[36:39], v[40:43]
    v_mfma_f32_16x16x32_bf16 v[44:47], a[220:223], a[40:43], v[44:47]
    v_mfma_f32_16x16x32_bf16 v[48:51], a[224:227], a[28:31], v[48:51]
    buffer_load_dwordx4 v[152:155], v246, s[8:11], s52 offen offset:2048 sc1
    v_mfma_f32_16x16x32_bf16 v[52:55], a[224:227], a[32:35], v[52:55]
    v_mfma_f32_16x16x32_bf16 v[56:59], a[224:227], a[36:39], v[56:59]
    v_mfma_f32_16x16x32_bf16 v[60:63], a[224:227], a[40:43], v[60:63]
    ds_read_b128 a[84:87], v8 offset:2048
    v_mfma_f32_16x16x32_bf16 v[64:67], a[228:231], a[28:31], v[64:67]
    buffer_load_dwordx4 a[96:99], v247, s[8:11], s52 offen offset:2048 sc1
    v_mfma_f32_16x16x32_bf16 v[68:71], a[228:231], a[32:35], v[68:71]
    v_mfma_f32_16x16x32_bf16 v[72:75], a[228:231], a[36:39], v[72:75]
    ds_read_b128 a[88:91], v8 offset:3072
    v_mfma_f32_16x16x32_bf16 v[76:79], a[228:231], a[40:43], v[76:79]
    v_mfma_f32_16x16x32_bf16 v[80:83], a[232:235], a[28:31], v[80:83]
    s_add_u32 s53, s53, 32768
    v_mfma_f32_16x16x32_bf16 v[84:87], a[232:235], a[32:35], v[84:87]
    ds_read_b128 a[92:95], v8 offset:4096
    v_mfma_f32_16x16x32_bf16 v[88:91], a[232:235], a[36:39], v[88:91]
    v_mfma_f32_16x16x32_bf16 v[92:95], a[232:235], a[40:43], v[92:95]
    v_mfma_f32_16x16x32_bf16 v[96:99], a[236:239], a[28:31], v[96:99]
    ds_read_b128 v[140:143], v8 offset:5120
    v_mfma_f32_16x16x32_bf16 v[100:103], a[236:239], a[32:35], v[100:103]
    v_mfma_f32_16x16x32_bf16 v[104:107], a[236:239], a[36:39], v[104:107]
    v_mfma_f32_16x16x32_bf16 v[108:111], a[236:239], a[40:43], v[108:111]
    s_waitcnt vmcnt(24)
    v_mfma_f32_16x16x32_bf16 v[16:19], a[240:243], a[44:47], v[16:19]
    buffer_load_dwordx4 v[160:163], v244, s[8:11], s52 offen offset:3072 sc1
    v_mfma_f32_16x16x32_bf16 v[20:23], a[240:243], v[252:255], v[20:23]
    v_mfma_f32_16x16x32_bf16 v[24:27], a[240:243], v[112:115], v[24:27]
    ds_read_b128 a[100:103], v8 offset:6144
    v_mfma_f32_16x16x32_bf16 v[28:31], a[240:243], v[116:119], v[28:31]
    v_mfma_f32_16x16x32_bf16 v[32:35], a[244:247], a[44:47], v[32:35]
    buffer_load_dwordx4 v[164:167], v245, s[8:11], s52 offen offset:3072 sc1
    v_mfma_f32_16x16x32_bf16 v[36:39], a[244:247], v[252:255], v[36:39]
    ds_read_b128 a[104:107], v8 offset:7168
    v_mfma_f32_16x16x32_bf16 v[40:43], a[244:247], v[112:115], v[40:43]
    v_mfma_f32_16x16x32_bf16 v[44:47], a[244:247], v[116:119], v[44:47]
    v_mfma_f32_16x16x32_bf16 v[48:51], a[248:251], a[44:47], v[48:51]
    buffer_load_dwordx4 v[168:171], v246, s[8:11], s52 offen offset:3072 sc1
    v_mfma_f32_16x16x32_bf16 v[52:55], a[248:251], v[252:255], v[52:55]
    v_mfma_f32_16x16x32_bf16 v[56:59], a[248:251], v[112:115], v[56:59]
    v_mfma_f32_16x16x32_bf16 v[60:63], a[248:251], v[116:119], v[60:63]
    ds_read_b128 a[108:111], v8 offset:8192
    v_mfma_f32_16x16x32_bf16 v[64:67], a[252:255], a[44:47], v[64:67]
    buffer_load_dwordx4 a[120:123], v247, s[8:11], s52 offen offset:3072 sc1
    v_mfma_f32_16x16x32_bf16 v[68:71], a[252:255], v[252:255], v[68:71]
    v_mfma_f32_16x16x32_bf16 v[72:75], a[252:255], v[112:115], v[72:75]
    ds_read_b128 a[112:115], v8 offset:9216
    v_mfma_f32_16x16x32_bf16 v[76:79], a[252:255], v[116:119], v[76:79]
    v_mfma_f32_16x16x32_bf16 v[80:83], v[192:195], a[44:47], v[80:83]
    s_add_u32 s52, s52, 4096
    v_mfma_f32_16x16x32_bf16 v[84:87], v[192:195], v[252:255], v[84:87]
    ds_read_b128 a[116:119], v8 offset:10240
    v_mfma_f32_16x16x32_bf16 v[88:91], v[192:195], v[112:115], v[88:91]
    v_mfma_f32_16x16x32_bf16 v[92:95], v[192:195], v[116:119], v[92:95]
    v_mfma_f32_16x16x32_bf16 v[96:99], v[196:199], a[44:47], v[96:99]
    ds_read_b128 v[156:159], v8 offset:11264
    v_mfma_f32_16x16x32_bf16 v[100:103], v[196:199], v[252:255], v[100:103]
    v_mfma_f32_16x16x32_bf16 v[104:107], v[196:199], v[112:115], v[104:107]
    v_mfma_f32_16x16x32_bf16 v[108:111], v[196:199], v[116:119], v[108:111]
    s_waitcnt vmcnt(22)
    v_mfma_f32_16x16x32_bf16 v[16:19], v[200:203], v[120:123], v[16:19]
    buffer_load_dwordx4 v[176:179], v244, s[8:11], s52 offen offset:0 sc1
    v_mfma_f32_16x16x32_bf16 v[20:23], v[200:203], a[48:51], v[20:23]
    v_mfma_f32_16x16x32_bf16 v[24:27], v[200:203], a[52:55], v[24:27]
    ds_read_b128 a[124:127], v8 offset:12288
    v_mfma_f32_16x16x32_bf16 v[28:31], v[200:203], a[56:59], v[28:31]
    v_mfma_f32_16x16x32_bf16 v[32:35], v[204:207], v[120:123], v[32:35]
    buffer_load_dwordx4 v[180:183], v245, s[8:11], s52 offen offset:0 sc1
    v_mfma_f32_16x16x32_bf16 v[36:39], v[204:207], a[48:51], v[36:39]
    ds_read_b128 a[128:131], v8 offset:13312
    v_mfma_f32_16x16x32_bf16 v[40:43], v[204:207], a[52:55], v[40:43]
    v_mfma_f32_16x16x32_bf16 v[44:47], v[204:207], a[56:59], v[44:47]
    v_mfma_f32_16x16x32_bf16 v[48:51], v[208:211], v[120:123], v[48:51]
    buffer_load_dwordx4 v[184:187], v246, s[8:11], s52 offen offset:0 sc1
    v_mfma_f32_16x16x32_bf16 v[52:55], v[208:211], a[48:51], v[52:55]
    v_mfma_f32_16x16x32_bf16 v[56:59], v[208:211], a[52:55], v[56:59]
    v_mfma_f32_16x16x32_bf16 v[60:63], v[208:211], a[56:59], v[60:63]
    ds_read_b128 a[132:135], v8 offset:14336
    v_mfma_f32_16x16x32_bf16 v[64:67], v[212:215], v[120:123], v[64:67]
    buffer_load_dwordx4 a[144:147], v247, s[8:11], s52 offen offset:0 sc1
    v_mfma_f32_16x16x32_bf16 v[68:71], v[212:215], a[48:51], v[68:71]
    v_mfma_f32_16x16x32_bf16 v[72:75], v[212:215], a[52:55], v[72:75]
    ds_read_b128 a[136:139], v8 offset:15360
    v_mfma_f32_16x16x32_bf16 v[76:79], v[212:215], a[56:59], v[76:79]
    v_mfma_f32_16x16x32_bf16 v[80:83], v[224:227], v[120:123], v[80:83]
    v_mfma_f32_16x16x32_bf16 v[84:87], v[224:227], a[48:51], v[84:87]
    ds_read_b128 a[140:143], v8 offset:16384
    v_mfma_f32_16x16x32_bf16 v[88:91], v[224:227], a[52:55], v[88:91]
    v_mfma_f32_16x16x32_bf16 v[92:95], v[224:227], a[56:59], v[92:95]
    v_mfma_f32_16x16x32_bf16 v[96:99], v[228:231], v[120:123], v[96:99]
    ds_read_b128 v[172:175], v8 offset:17408
    v_mfma_f32_16x16x32_bf16 v[100:103], v[228:231], a[48:51], v[100:103]
    v_mfma_f32_16x16x32_bf16 v[104:107], v[228:231], a[52:55], v[104:107]
    v_mfma_f32_16x16x32_bf16 v[108:111], v[228:231], a[56:59], v[108:111]
    s_waitcnt vmcnt(20) lgkmcnt(12)
    v_mfma_f32_16x16x32_bf16 v[16:19], a[76:79], a[60:63], v[16:19]
    buffer_load_dwordx4 a[0:3], v244, s[8:11], s52 offen offset:1024 sc1
    v_mfma_f32_16x16x32_bf16 v[20:23], a[76:79], a[64:67], v[20:23]
    v_mfma_f32_16x16x32_bf16 v[24:27], a[76:79], a[68:71], v[24:27]
    ds_read_b128 a[148:151], v8 offset:18432
    v_mfma_f32_16x16x32_bf16 v[28:31], a[76:79], v[124:127], v[28:31]
    v_mfma_f32_16x16x32_bf16 v[32:35], a[80:83], a[60:63], v[32:35]
    buffer_load_dwordx4 a[4:7], v245, s[8:11], s52 offen offset:1024 sc1
    v_mfma_f32_16x16x32_bf16 v[36:39], a[80:83], a[64:67], v[36:39]
    ds_read_b128 a[152:155], v8 offset:19456
    v_mfma_f32_16x16x32_bf16 v[40:43], a[80:83], a[68:71], v[40:43]
    v_mfma_f32_16x16x32_bf16 v[44:47], a[80:83], v[124:127], v[44:47]
    v_mfma_f32_16x16x32_bf16 v[48:51], a[84:87], a[60:63], v[48:51]
    buffer_load_dwordx4 a[8:11], v246, s[8:11], s52 offen offset:1024 sc1
    v_mfma_f32_16x16x32_bf16 v[52:55], a[84:87], a[64:67], v[52:55]
    v_mfma_f32_16x16x32_bf16 v[56:59], a[84:87], a[68:71], v[56:59]
    v_mfma_f32_16x16x32_bf16 v[60:63], a[84:87], v[124:127], v[60:63]
    ds_read_b128 a[156:159], v8 offset:20480
    v_mfma_f32_16x16x32_bf16 v[64:67], a[88:91], a[60:63], v[64:67]
    buffer_load_dwordx4 a[168:171], v247, s[8:11], s52 offen offset:1024 sc1
    v_mfma_f32_16x16x32_bf16 v[68:71], a[88:91], a[64:67], v[68:71]
    v_mfma_f32_16x16x32_bf16 v[72:75], a[88:91], a[68:71], v[72:75]
    ds_read_b128 a[160:163], v8 offset:21504
    v_mfma_f32_16x16x32_bf16 v[76:79], a[88:91], v[124:127], v[76:79]
    v_mfma_f32_16x16x32_bf16 v[80:83], a[92:95], a[60:63], v[80:83]
    v_mfma_f32_16x16x32_bf16 v[84:87], a[92:95], a[64:67], v[84:87]
    ds_read_b128 a[164:167], v8 offset:22528
    v_mfma_f32_16x16x32_bf16 v[88:91], a[92:95], a[68:71], v[88:91]
    v_mfma_f32_16x16x32_bf16 v[92:95], a[92:95], v[124:127], v[92:95]
    v_mfma_f32_16x16x32_bf16 v[96:99], v[140:143], a[60:63], v[96:99]
    ds_read_b128 v[188:191], v8 offset:23552
    v_mfma_f32_16x16x32_bf16 v[100:103], v[140:143], a[64:67], v[100:103]
    v_mfma_f32_16x16x32_bf16 v[104:107], v[140:143], a[68:71], v[104:107]
    v_mfma_f32_16x16x32_bf16 v[108:111], v[140:143], v[124:127], v[108:111]
    s_waitcnt vmcnt(18) lgkmcnt(12)
    v_mfma_f32_16x16x32_bf16 v[16:19], a[100:103], v[128:131], v[16:19]
    v_mov_b32 v223, 0
    buffer_atomic_add v223, v222, s[4:7], s54 offen sc0
    buffer_load_dwordx4 v[232:235], v2, s[28:31], s50 offen offset:0
    v_mfma_f32_16x16x32_bf16 v[20:23], a[100:103], v[132:135], v[20:23]
    v_mfma_f32_16x16x32_bf16 v[24:27], a[100:103], v[136:139], v[24:27]
    ds_read_b128 a[172:175], v8 offset:24576
    v_mfma_f32_16x16x32_bf16 v[28:31], a[100:103], a[72:75], v[28:31]
    v_mfma_f32_16x16x32_bf16 v[32:35], a[104:107], v[128:131], v[32:35]
    buffer_load_dwordx4 v[236:239], v2, s[28:31], s50 offen offset:64
    v_mfma_f32_16x16x32_bf16 v[36:39], a[104:107], v[132:135], v[36:39]
    ds_read_b128 a[176:179], v8 offset:25600
    v_mfma_f32_16x16x32_bf16 v[40:43], a[104:107], v[136:139], v[40:43]
    v_mfma_f32_16x16x32_bf16 v[44:47], a[104:107], a[72:75], v[44:47]
    v_mfma_f32_16x16x32_bf16 v[48:51], a[108:111], v[128:131], v[48:51]
    buffer_load_dwordx4 v[240:243], v2, s[28:31], s50 offen offset:128
    v_mfma_f32_16x16x32_bf16 v[52:55], a[108:111], v[132:135], v[52:55]
    v_mfma_f32_16x16x32_bf16 v[56:59], a[108:111], v[136:139], v[56:59]
    v_mfma_f32_16x16x32_bf16 v[60:63], a[108:111], a[72:75], v[60:63]
    ds_read_b128 a[180:183], v8 offset:26624
    v_mfma_f32_16x16x32_bf16 v[64:67], a[112:115], v[128:131], v[64:67]
    v_mfma_f32_16x16x32_bf16 v[68:71], a[112:115], v[132:135], v[68:71]
    v_mfma_f32_16x16x32_bf16 v[72:75], a[112:115], v[136:139], v[72:75]
    ds_read_b128 a[184:187], v8 offset:27648
    v_mfma_f32_16x16x32_bf16 v[76:79], a[112:115], a[72:75], v[76:79]
    v_mfma_f32_16x16x32_bf16 v[80:83], a[116:119], v[128:131], v[80:83]
    v_mfma_f32_16x16x32_bf16 v[84:87], a[116:119], v[132:135], v[84:87]
    ds_read_b128 a[188:191], v8 offset:28672
    v_mfma_f32_16x16x32_bf16 v[88:91], a[116:119], v[136:139], v[88:91]
    v_mfma_f32_16x16x32_bf16 v[92:95], a[116:119], a[72:75], v[92:95]
    v_mfma_f32_16x16x32_bf16 v[96:99], v[156:159], v[128:131], v[96:99]
    ds_read_b128 a[12:15], v8 offset:29696
    v_mfma_f32_16x16x32_bf16 v[100:103], v[156:159], v[132:135], v[100:103]
    v_mfma_f32_16x16x32_bf16 v[104:107], v[156:159], v[136:139], v[104:107]
    v_mfma_f32_16x16x32_bf16 v[108:111], v[156:159], a[72:75], v[108:111]
    s_waitcnt vmcnt(20)
    s_waitcnt vmcnt(16) lgkmcnt(12)
    v_mfma_f32_16x16x32_bf16 v[16:19], a[124:127], v[144:147], v[16:19]
    v_mfma_f32_16x16x32_bf16 v[20:23], a[124:127], v[148:151], v[20:23]
    v_mfma_f32_16x16x32_bf16 v[24:27], a[124:127], v[152:155], v[24:27]
    ds_read_b128 a[16:19], v8 offset:30720
    v_mfma_f32_16x16x32_bf16 v[28:31], a[124:127], a[96:99], v[28:31]
    v_mfma_f32_16x16x32_bf16 v[32:35], a[128:131], v[144:147], v[32:35]
    v_mfma_f32_16x16x32_bf16 v[36:39], a[128:131], v[148:151], v[36:39]
    ds_read_b128 a[20:23], v8 offset:31744
    v_mfma_f32_16x16x32_bf16 v[40:43], a[128:131], v[152:155], v[40:43]
    v_mfma_f32_16x16x32_bf16 v[44:47], a[128:131], a[96:99], v[44:47]
    v_mfma_f32_16x16x32_bf16 v[48:51], a[132:135], v[144:147], v[48:51]
    ds_read_b128 a[192:195], v8 offset:32768
    v_mfma_f32_16x16x32_bf16 v[52:55], a[132:135], v[148:151], v[52:55]
    v_mfma_f32_16x16x32_bf16 v[56:59], a[132:135], v[152:155], v[56:59]
    v_mfma_f32_16x16x32_bf16 v[60:63], a[132:135], a[96:99], v[60:63]
    ds_read_b128 a[196:199], v8 offset:33792
    v_mfma_f32_16x16x32_bf16 v[64:67], a[136:139], v[144:147], v[64:67]
    v_mfma_f32_16x16x32_bf16 v[68:71], a[136:139], v[148:151], v[68:71]
    v_mfma_f32_16x16x32_bf16 v[72:75], a[136:139], v[152:155], v[72:75]
    ds_read_b128 a[200:203], v8 offset:34816
    v_mfma_f32_16x16x32_bf16 v[76:79], a[136:139], a[96:99], v[76:79]
    v_mfma_f32_16x16x32_bf16 v[80:83], a[140:143], v[144:147], v[80:83]
    v_mfma_f32_16x16x32_bf16 v[84:87], a[140:143], v[148:151], v[84:87]
    ds_read_b128 a[204:207], v8 offset:35840
    v_mfma_f32_16x16x32_bf16 v[88:91], a[140:143], v[152:155], v[88:91]
    v_mfma_f32_16x16x32_bf16 v[92:95], a[140:143], a[96:99], v[92:95]
    v_mfma_f32_16x16x32_bf16 v[96:99], v[172:175], v[144:147], v[96:99]
    v_mfma_f32_16x16x32_bf16 v[100:103], v[172:175], v[148:151], v[100:103]
    v_mfma_f32_16x16x32_bf16 v[104:107], v[172:175], v[152:155], v[104:107]
    v_mfma_f32_16x16x32_bf16 v[108:111], v[172:175], a[96:99], v[108:111]
    s_waitcnt vmcnt(12) lgkmcnt(12)
    v_mfma_f32_16x16x32_bf16 v[16:19], a[148:151], v[160:163], v[16:19]
    v_mfma_f32_16x16x32_bf16 v[20:23], a[148:151], v[164:167], v[20:23]
    v_mfma_f32_16x16x32_bf16 v[24:27], a[148:151], v[168:171], v[24:27]
    v_mfma_f32_16x16x32_bf16 v[28:31], a[148:151], a[120:123], v[28:31]
    v_mfma_f32_16x16x32_bf16 v[32:35], a[152:155], v[160:163], v[32:35]
    v_mfma_f32_16x16x32_bf16 v[36:39], a[152:155], v[164:167], v[36:39]
    v_mfma_f32_16x16x32_bf16 v[40:43], a[152:155], v[168:171], v[40:43]
    v_mfma_f32_16x16x32_bf16 v[44:47], a[152:155], a[120:123], v[44:47]
    v_mfma_f32_16x16x32_bf16 v[48:51], a[156:159], v[160:163], v[48:51]
    v_mfma_f32_16x16x32_bf16 v[52:55], a[156:159], v[164:167], v[52:55]
    v_mfma_f32_16x16x32_bf16 v[56:59], a[156:159], v[168:171], v[56:59]
    v_mfma_f32_16x16x32_bf16 v[60:63], a[156:159], a[120:123], v[60:63]
    v_mfma_f32_16x16x32_bf16 v[64:67], a[160:163], v[160:163], v[64:67]
    v_mfma_f32_16x16x32_bf16 v[68:71], a[160:163], v[164:167], v[68:71]
    v_mfma_f32_16x16x32_bf16 v[72:75], a[160:163], v[168:171], v[72:75]
    v_mfma_f32_16x16x32_bf16 v[76:79], a[160:163], a[120:123], v[76:79]
    v_mfma_f32_16x16x32_bf16 v[80:83], a[164:167], v[160:163], v[80:83]
    v_mfma_f32_16x16x32_bf16 v[84:87], a[164:167], v[164:167], v[84:87]
    v_mfma_f32_16x16x32_bf16 v[88:91], a[164:167], v[168:171], v[88:91]
    v_mfma_f32_16x16x32_bf16 v[92:95], a[164:167], a[120:123], v[92:95]
    v_mfma_f32_16x16x32_bf16 v[96:99], v[188:191], v[160:163], v[96:99]
    v_mfma_f32_16x16x32_bf16 v[100:103], v[188:191], v[164:167], v[100:103]
    v_mfma_f32_16x16x32_bf16 v[104:107], v[188:191], v[168:171], v[104:107]
    v_mfma_f32_16x16x32_bf16 v[108:111], v[188:191], a[120:123], v[108:111]
    s_waitcnt vmcnt(8) lgkmcnt(6)
    s_waitcnt vmcnt(4) lgkmcnt(0)
    s_waitcnt vmcnt(3)
    s_mov_b32 s60, 0
k1_kernel_pl18:
    v_bfe_u32 v223, v223, 8, 8
    v_cmp_gt_u32 vcc, s49, v223
    s_add_u32 s60, s60, 1
    s_and_b32 vcc_lo, vcc_lo, 1
    s_cbranch_scc0 k1_kernel_pd19
    s_cmp_ge_u32 s60, 200000
    s_cbranch_scc1 k1_kernel_pd19
    s_sleep 4
    v_mov_b32 v223, 0
    buffer_atomic_add v223, v222, s[4:7], s54 offen sc0
    s_waitcnt vmcnt(0)
    s_branch k1_kernel_pl18
k1_kernel_pd19:
    s_barrier
    v_mfma_f32_16x16x32_bf16 v[20:23], a[172:175], v[180:183], v[20:23]
    buffer_load_dwordx4 v[248:251], v14, s[36:39], s51 offen offset:0 sc1
    v_mfma_f32_16x16x32_bf16 v[36:39], a[176:179], v[180:183], v[36:39]
    v_mfma_f32_16x16x32_bf16 v[52:55], a[180:183], v[180:183], v[52:55]
    buffer_load_dwordx4 v[192:195], v14, s[36:39], s51 offen offset:1024 sc1
    v_mfma_f32_16x16x32_bf16 v[68:71], a[184:187], v[180:183], v[68:71]
    v_mfma_f32_16x16x32_bf16 v[84:87], a[188:191], v[180:183], v[84:87]
    buffer_load_dwordx4 v[196:199], v14, s[36:39], s51 offen offset:2048 sc1
    v_mfma_f32_16x16x32_bf16 v[100:103], a[12:15], v[180:183], v[100:103]
    v_mfma_f32_16x16x32_bf16 v[20:23], a[16:19], a[4:7], v[20:23]
    v_mfma_f32_16x16x32_bf16 v[36:39], a[20:23], a[4:7], v[36:39]
    v_mfma_f32_16x16x32_bf16 v[52:55], a[192:195], a[4:7], v[52:55]
    v_mfma_f32_16x16x32_bf16 v[68:71], a[196:199], a[4:7], v[68:71]
    v_mfma_f32_16x16x32_bf16 v[84:87], a[200:203], a[4:7], v[84:87]
    s_nop 3
    ds_write_b128 v5, v[20:23] offset:0
    v_mfma_f32_16x16x32_bf16 v[100:103], a[204:207], a[4:7], v[100:103]
    v_mfma_f32_16x16x32_bf16 v[24:27], a[172:175], v[184:187], v[24:27]
    ds_write_b128 v5, v[36:39] offset:1024
    v_mfma_f32_16x16x32_bf16 v[40:43], a[176:179], v[184:187], v[40:43]
    v_mfma_f32_16x16x32_bf16 v[56:59], a[180:183], v[184:187], v[56:59]
    ds_write_b128 v5, v[52:55] offset:2048
    v_mfma_f32_16x16x32_bf16 v[72:75], a[184:187], v[184:187], v[72:75]
    v_mfma_f32_16x16x32_bf16 v[88:91], a[188:191], v[184:187], v[88:91]
    ds_write_b128 v5, v[68:71] offset:3072
    v_mfma_f32_16x16x32_bf16 v[104:107], a[12:15], v[184:187], v[104:107]
    v_mfma_f32_16x16x32_bf16 v[24:27], a[16:19], a[8:11], v[24:27]
    ds_write_b128 v5, v[84:87] offset:4096
    v_mfma_f32_16x16x32_bf16 v[40:43], a[20:23], a[8:11], v[40:43]
    v_mfma_f32_16x16x32_bf16 v[56:59], a[192:195], a[8:11], v[56:59]
    ds_write_b128 v5, v[100:103] offset:5120
    v_mfma_f32_16x16x32_bf16 v[72:75], a[196:199], a[8:11], v[72:75]
    v_mfma_f32_16x16x32_bf16 v[88:91], a[200:203], a[8:11], v[88:91]
    s_nop 1
    ds_write_b128 v6, v[24:27] offset:0
    v_mfma_f32_16x16x32_bf16 v[104:107], a[204:207], a[8:11], v[104:107]
    v_mfma_f32_16x16x32_bf16 v[28:31], a[172:175], a[144:147], v[28:31]
    ds_write_b128 v6, v[40:43] offset:1024
    v_mfma_f32_16x16x32_bf16 v[44:47], a[176:179], a[144:147], v[44:47]
    v_mfma_f32_16x16x32_bf16 v[60:63], a[180:183], a[144:147], v[60:63]
    ds_write_b128 v6, v[56:59] offset:2048
    v_mfma_f32_16x16x32_bf16 v[76:79], a[184:187], a[144:147], v[76:79]
    v_mfma_f32_16x16x32_bf16 v[92:95], a[188:191], a[144:147], v[92:95]
    ds_write_b128 v6, v[72:75] offset:3072
    v_mfma_f32_16x16x32_bf16 v[108:111], a[12:15], a[144:147], v[108:111]
    v_mfma_f32_16x16x32_bf16 v[28:31], a[16:19], a[168:171], v[28:31]
    ds_write_b128 v6, v[88:91] offset:4096
    v_mfma_f32_16x16x32_bf16 v[44:47], a[20:23], a[168:171], v[44:47]
    v_mfma_f32_16x16x32_bf16 v[60:63], a[192:195], a[168:171], v[60:63]
    ds_write_b128 v6, v[104:107] offset:5120
    v_mfma_f32_16x16x32_bf16 v[76:79], a[196:199], a[168:171], v[76:79]
    v_mfma_f32_16x16x32_bf16 v[92:95], a[200:203], a[168:171], v[92:95]
    s_nop 1
    ds_write_b128 v7, v[28:31] offset:0
    v_mfma_f32_16x16x32_bf16 v[108:111], a[204:207], a[168:171], v[108:111]
    v_mfma_f32_16x16x32_bf16 v[16:19], a[172:175], v[176:179], v[16:19]
    ds_write_b128 v7, v[44:47] offset:1024
    v_mfma_f32_16x16x32_bf16 v[32:35], a[176:179], v[176:179], v[32:35]
    v_mfma_f32_16x16x32_bf16 v[48:51], a[180:183], v[176:179], v[48:51]
    ds_write_b128 v7, v[60:63] offset:2048
    v_mfma_f32_16x16x32_bf16 v[64:67], a[184:187], v[176:179], v[64:67]
    v_mfma_f32_16x16x32_bf16 v[80:83], a[188:191], v[176:179], v[80:83]
    ds_write_b128 v7, v[76:79] offset:3072
    v_mfma_f32_16x16x32_bf16 v[96:99], a[12:15], v[176:179], v[96:99]
    v_mfma_f32_16x16x32_bf16 v[16:19], a[16:19], a[0:3], v[16:19]
    ds_write_b128 v7, v[92:95] offset:4096
    v_mfma_f32_16x16x32_bf16 v[32:35], a[20:23], a[0:3], v[32:35]
    v_mfma_f32_16x16x32_bf16 v[48:51], a[192:195], a[0:3], v[48:51]
    ds_write_b128 v7, v[108:111] offset:5120
    v_mfma_f32_16x16x32_bf16 v[64:67], a[196:199], a[0:3], v[64:67]
    v_mfma_f32_16x16x32_bf16 v[80:83], a[200:203], a[0:3], v[80:83]
    v_mfma_f32_16x16x32_bf16 v[96:99], a[204:207], a[0:3], v[96:99]
    s_waitcnt lgkmcnt(0)
    s_barrier
    ds_read_b128 v[20:23], v4 offset:0
    ds_read_b128 v[24:27], v4 offset:6144
    ds_read_b128 v[28:31], v4 offset:12288
    ds_read_b128 v[36:39], v4 offset:1024
    ds_read_b128 v[40:43], v4 offset:7168
    ds_read_b128 v[44:47], v4 offset:13312
    ds_read_b128 v[52:55], v4 offset:2048
    ds_read_b128 v[56:59], v4 offset:8192
    ds_read_b128 v[60:63], v4 offset:14336
    ds_read_b128 v[68:71], v4 offset:3072
    ds_read_b128 v[72:75], v4 offset:9216
    ds_read_b128 v[76:79], v4 offset:15360
    ds_read_b128 v[84:87], v4 offset:4096
    ds_read_b128 v[88:91], v4 offset:10240
    ds_read_b128 v[92:95], v4 offset:16384
    ds_read_b128 v[100:103], v4 offset:5120
    ds_read_b128 v[104:107], v4 offset:11264
    ds_read_b128 v[108:111], v4 offset:17408
    s_mov_b32 s48, 0xbfb8aa3b
    s_waitcnt lgkmcnt(12)
    v_pk_add_f32 v[16:17], v[16:17], v[20:21]
    v_pk_add_f32 v[24:25], v[24:25], v[28:29]
    v_pk_add_f32 v[18:19], v[18:19], v[22:23]
    v_pk_add_f32 v[26:27], v[26:27], v[30:31]
    v_pk_add_f32 v[32:33], v[32:33], v[36:37]
    v_pk_add_f32 v[40:41], v[40:41], v[44:45]
    v_pk_add_f32 v[34:35], v[34:35], v[38:39]
    v_pk_add_f32 v[42:43], v[42:43], v[46:47]
    v_pk_add_f32 v[16:17], v[16:17], v[24:25]
    v_pk_add_f32 v[18:19], v[18:19], v[26:27]
    v_pk_add_f32 v[32:33], v[32:33], v[40:41]
    v_pk_add_f32 v[34:35], v[34:35], v[42:43]
    v_pk_mul_f32 v[20:21], v[16:17], s[48:49] op_sel_hi:[1,0]
    v_pk_mul_f32 v[22:23], v[18:19], s[48:49] op_sel_hi:[1,0]
    v_pk_mul_f32 v[36:37], v[32:33], s[48:49] op_sel_hi:[1,0]
    v_pk_mul_f32 v[38:39], v[34:35], s[48:49] op_sel_hi:[1,0]
    v_exp_f32 v20, v20
    v_exp_f32 v21, v21
    v_exp_f32 v22, v22
    v_exp_f32 v23, v23
    v_exp_f32 v36, v36
    v_exp_f32 v37, v37
    v_exp_f32 v38, v38
    v_exp_f32 v39, v39
    s_waitcnt vmcnt(0)
    v_lshlrev_b32 v28, 16, v248
    v_and_b32 v29, s47, v248
    v_lshlrev_b32 v30, 16, v249
    v_and_b32 v31, s47, v249
    v_lshlrev_b32 v44, 16, v250
    v_and_b32 v45, s47, v250
    v_lshlrev_b32 v46, 16, v251
    v_and_b32 v47, s47, v251
    v_pk_add_f32 v[20:21], v[20:21], 1.0 op_sel_hi:[1,0]
    v_pk_add_f32 v[22:23], v[22:23], 1.0 op_sel_hi:[1,0]
    v_pk_add_f32 v[36:37], v[36:37], 1.0 op_sel_hi:[1,0]
    v_pk_add_f32 v[38:39], v[38:39], 1.0 op_sel_hi:[1,0]
    v_rcp_f32 v20, v20
    v_rcp_f32 v21, v21
    v_rcp_f32 v22, v22
    v_rcp_f32 v23, v23
    v_rcp_f32 v36, v36
    v_rcp_f32 v37, v37
    v_rcp_f32 v38, v38
    v_rcp_f32 v39, v39
    v_lshlrev_b32 v24, 16, v232
    v_and_b32 v25, s47, v232
    v_lshlrev_b32 v26, 16, v233
    v_and_b32 v27, s47, v233
    v_lshlrev_b32 v40, 16, v234
    v_and_b32 v41, s47, v234
    v_lshlrev_b32 v42, 16, v235
    v_and_b32 v43, s47, v235
    v_pk_mul_f32 v[28:29], v[28:29], v[16:17]
    v_pk_mul_f32 v[30:31], v[30:31], v[18:19]
    v_pk_mul_f32 v[44:45], v[44:45], v[32:33]
    v_pk_mul_f32 v[46:47], v[46:47], v[34:35]
    v_pk_fma_f32 v[20:21], v[20:21], v[28:29], v[24:25]
    v_pk_fma_f32 v[22:23], v[22:23], v[30:31], v[26:27]
    v_pk_fma_f32 v[36:37], v[36:37], v[44:45], v[40:41]
    v_pk_fma_f32 v[38:39], v[38:39], v[46:47], v[42:43]
    v_cvt_pk_bf16_f32 v232, v20, v21
    v_cvt_pk_bf16_f32 v233, v22, v23
    v_cvt_pk_bf16_f32 v234, v36, v37
    v_cvt_pk_bf16_f32 v235, v38, v39
    buffer_store_dwordx4 v[232:235], v2, s[32:35], s50 offen offset:0
    s_waitcnt lgkmcnt(6)
    v_pk_add_f32 v[48:49], v[48:49], v[52:53]
    v_pk_add_f32 v[56:57], v[56:57], v[60:61]
    v_pk_add_f32 v[50:51], v[50:51], v[54:55]
    v_pk_add_f32 v[58:59], v[58:59], v[62:63]
    v_pk_add_f32 v[64:65], v[64:65], v[68:69]
    v_pk_add_f32 v[72:73], v[72:73], v[76:77]
    v_pk_add_f32 v[66:67], v[66:67], v[70:71]
    v_pk_add_f32 v[74:75], v[74:75], v[78:79]
    v_pk_add_f32 v[48:49], v[48:49], v[56:57]
    v_pk_add_f32 v[50:51], v[50:51], v[58:59]
    v_pk_add_f32 v[64:65], v[64:65], v[72:73]
    v_pk_add_f32 v[66:67], v[66:67], v[74:75]
    v_pk_mul_f32 v[52:53], v[48:49], s[48:49] op_sel_hi:[1,0]
    v_pk_mul_f32 v[54:55], v[50:51], s[48:49] op_sel_hi:[1,0]
    v_pk_mul_f32 v[68:69], v[64:65], s[48:49] op_sel_hi:[1,0]
    v_pk_mul_f32 v[70:71], v[66:67], s[48:49] op_sel_hi:[1,0]
    v_exp_f32 v52, v52
    v_exp_f32 v53, v53
    v_exp_f32 v54, v54
    v_exp_f32 v55, v55
    v_exp_f32 v68, v68
    v_exp_f32 v69, v69
    v_exp_f32 v70, v70
    v_exp_f32 v71, v71
    v_lshlrev_b32 v60, 16, v192
    v_and_b32 v61, s47, v192
    v_lshlrev_b32 v62, 16, v193
    v_and_b32 v63, s47, v193
    v_lshlrev_b32 v76, 16, v194
    v_and_b32 v77, s47, v194
    v_lshlrev_b32 v78, 16, v195
    v_and_b32 v79, s47, v195
    v_pk_add_f32 v[52:53], v[52:53], 1.0 op_sel_hi:[1,0]
    v_pk_add_f32 v[54:55], v[54:55], 1.0 op_sel_hi:[1,0]
    v_pk_add_f32 v[68:69], v[68:69], 1.0 op_sel_hi:[1,0]
    v_pk_add_f32 v[70:71], v[70:71], 1.0 op_sel_hi:[1,0]
    v_rcp_f32 v52, v52
    v_rcp_f32 v53, v53
    v_rcp_f32 v54, v54
    v_rcp_f32 v55, v55
    v_rcp_f32 v68, v68
    v_rcp_f32 v69, v69
    v_rcp_f32 v70, v70
    v_rcp_f32 v71, v71
    v_lshlrev_b32 v56, 16, v236
    v_and_b32 v57, s47, v236
    v_lshlrev_b32 v58, 16, v237
    v_and_b32 v59, s47, v237
    v_lshlrev_b32 v72, 16, v238
    v_and_b32 v73, s47, v238
    v_lshlrev_b32 v74, 16, v239
    v_and_b32 v75, s47, v239
    v_pk_mul_f32 v[60:61], v[60:61], v[48:49]
    v_pk_mul_f32 v[62:63], v[62:63], v[50:51]
    v_pk_mul_f32 v[76:77], v[76:77], v[64:65]
    v_pk_mul_f32 v[78:79], v[78:79], v[66:67]
    v_pk_fma_f32 v[52:53], v[52:53], v[60:61], v[56:57]
    v_pk_fma_f32 v[54:55], v[54:55], v[62:63], v[58:59]
    v_pk_fma_f32 v[68:69], v[68:69], v[76:77], v[72:73]
    v_pk_fma_f32 v[70:71], v[70:71], v[78:79], v[74:75]
    v_cvt_pk_bf16_f32 v236, v52, v53
    v_cvt_pk_bf16_f32 v237, v54, v55
    v_cvt_pk_bf16_f32 v238, v68, v69
    v_cvt_pk_bf16_f32 v239, v70, v71
    buffer_store_dwordx4 v[236:239], v2, s[32:35], s50 offen offset:64
    s_waitcnt lgkmcnt(0)
    v_pk_add_f32 v[80:81], v[80:81], v[84:85]
    v_pk_add_f32 v[88:89], v[88:89], v[92:93]
    v_pk_add_f32 v[82:83], v[82:83], v[86:87]
    v_pk_add_f32 v[90:91], v[90:91], v[94:95]
    v_pk_add_f32 v[96:97], v[96:97], v[100:101]
    v_pk_add_f32 v[104:105], v[104:105], v[108:109]
    v_pk_add_f32 v[98:99], v[98:99], v[102:103]
    v_pk_add_f32 v[106:107], v[106:107], v[110:111]
    v_pk_add_f32 v[80:81], v[80:81], v[88:89]
    v_pk_add_f32 v[82:83], v[82:83], v[90:91]
    v_pk_add_f32 v[96:97], v[96:97], v[104:105]
    v_pk_add_f32 v[98:99], v[98:99], v[106:107]
    v_pk_mul_f32 v[84:85], v[80:81], s[48:49] op_sel_hi:[1,0]
    v_pk_mul_f32 v[86:87], v[82:83], s[48:49] op_sel_hi:[1,0]
    v_pk_mul_f32 v[100:101], v[96:97], s[48:49] op_sel_hi:[1,0]
    v_pk_mul_f32 v[102:103], v[98:99], s[48:49] op_sel_hi:[1,0]
    v_exp_f32 v84, v84
    v_exp_f32 v85, v85
    v_exp_f32 v86, v86
    v_exp_f32 v87, v87
    v_exp_f32 v100, v100
    v_exp_f32 v101, v101
    v_exp_f32 v102, v102
    v_exp_f32 v103, v103
    v_lshlrev_b32 v92, 16, v196
    v_and_b32 v93, s47, v196
    v_lshlrev_b32 v94, 16, v197
    v_and_b32 v95, s47, v197
    v_lshlrev_b32 v108, 16, v198
    v_and_b32 v109, s47, v198
    v_lshlrev_b32 v110, 16, v199
    v_and_b32 v111, s47, v199
    v_pk_add_f32 v[84:85], v[84:85], 1.0 op_sel_hi:[1,0]
    v_pk_add_f32 v[86:87], v[86:87], 1.0 op_sel_hi:[1,0]
    v_pk_add_f32 v[100:101], v[100:101], 1.0 op_sel_hi:[1,0]
    v_pk_add_f32 v[102:103], v[102:103], 1.0 op_sel_hi:[1,0]
    v_rcp_f32 v84, v84
    v_rcp_f32 v85, v85
    v_rcp_f32 v86, v86
    v_rcp_f32 v87, v87
    v_rcp_f32 v100, v100
    v_rcp_f32 v101, v101
    v_rcp_f32 v102, v102
    v_rcp_f32 v103, v103
    v_lshlrev_b32 v88, 16, v240
    v_and_b32 v89, s47, v240
    v_lshlrev_b32 v90, 16, v241
    v_and_b32 v91, s47, v241
    v_lshlrev_b32 v104, 16, v242
    v_and_b32 v105, s47, v242
    v_lshlrev_b32 v106, 16, v243
    v_and_b32 v107, s47, v243
    v_pk_mul_f32 v[92:93], v[92:93], v[80:81]
    v_pk_mul_f32 v[94:95], v[94:95], v[82:83]
    v_pk_mul_f32 v[108:109], v[108:109], v[96:97]
    v_pk_mul_f32 v[110:111], v[110:111], v[98:99]
    v_pk_fma_f32 v[84:85], v[84:85], v[92:93], v[88:89]
    v_pk_fma_f32 v[86:87], v[86:87], v[94:95], v[90:91]
    v_pk_fma_f32 v[100:101], v[100:101], v[108:109], v[104:105]
    v_pk_fma_f32 v[102:103], v[102:103], v[110:111], v[106:107]
    v_cvt_pk_bf16_f32 v240, v84, v85
    v_cvt_pk_bf16_f32 v241, v86, v87
    v_cvt_pk_bf16_f32 v242, v100, v101
    v_cvt_pk_bf16_f32 v243, v102, v103
    buffer_store_dwordx4 v[240:243], v2, s[32:35], s50 offen offset:128
    s_branch kb_fin
kb_a:
    s_sub_u32 s46, s46, 24
    s_lshr_b32 s41, s46, 1
    s_lshl_b32 s47, s45, 2
    s_add_u32 s41, s41, s47
    s_and_b32 s42, s46, 1
    s_lshl_b32 s42, s42, 5
    s_lshl_b32 s47, s40, 3
    s_add_u32 s42, s42, s47
    s_lshl_b32 s43, s45, 1
    s_lshr_b32 s47, s46, 2
    s_add_u32 s43, s43, s47
    s_and_b32 s44, s46, 3
    s_mul_i32 s56, s46, 6
    s_add_u32 s56, s56, 40
    s_lshl_b32 s47, s46, 1
    s_add_u32 s47, s47, 26
    s_cmp_ge_u32 s45, 6
    s_cselect_b32 s56, s47, s56
    s_add_u32 s56, s56, s45
    s_sub_u32 s47, s2, 224
    s_cmp_ge_u32 s46, 4
    s_cselect_b32 s56, s47, s56
    s_lshl_b32 s56, s56, 2
    s_add_u32 s56, s56, s40
    v_mov_b32 v15, 2147483632
    v_cmp_eq_u32 vcc, 0, v1
    v_lshlrev_b32 v251, 7, v1
    s_nop 0
    v_cndmask_b32 v252, v15, v1, vcc
    v_cmp_gt_u32 vcc, 8, v1
    s_nop 1
    v_cndmask_b32 v251, v15, v251, vcc
    v_lshlrev_b32 v255, 4, v1
    s_waitcnt lgkmcnt(0)
    s_add_u32 s4, s84, 34603008
    s_addc_u32 s5, s85, 0
    s_mov_b32 s6, 81920
    s_mov_b32 s7, 0x20000
    s_load_dwordx2 s[100:101], s[0:1], 16
    s_load_dwordx2 s[86:87], s[0:1], 56
    s_waitcnt lgkmcnt(0)
    s_barrier
    s_mul_hi_u32 s50, s56, 477218589
    s_mul_i32 s51, s50, 9
    s_sub_u32 s51, s56, s51
    s_mov_b32 s28, s100
    s_mov_b32 s29, s101
    s_mov_b32 s30, 663552
    s_mov_b32 s31, 0x20000
    s_cmp_lt_u32 s56, 162
    s_cselect_b32 s30, s30, 0
    v_lshrrev_b32 v20, 3, v1
    v_and_b32 v21, 7, v1
    v_lshlrev_b32 v21, 4, v21
    v_and_b32 v22, 3, v20
    v_lshrrev_b32 v23, 2, v20
    v_lshl_add_u32 v22, v23, 3, v22
    v_lshrrev_b32 v23, 1, v20
    v_mul_u32_u24 v23, 18, v23
    v_and_b32 v24, 1, v20
    v_add_u32 v23, v23, v24
    s_mul_i32 s45, s50, 36
    s_sub_u32 s46, s50, 16
    s_mul_i32 s46, s46, 288
    s_add_u32 s46, s46, 16
    s_cmp_lt_u32 s50, 16
    s_cselect_b32 s45, s45, s46
    s_cselect_b64 vcc, -1, 0
    v_cndmask_b32 v22, v23, v22, vcc
    v_mul_u32_u24 v22, 1152, v22
    v_add_u32 v22, v22, v21
    s_mul_i32 s45, s45, 1152
    s_lshl_b32 s46, s51, 7
    s_add_u32 s45, s45, s46
    s_lshl_b32 s46, s40, 12
    s_add_u32 m0, s46, 0
    s_cmp_lt_u32 s50, 16
    s_cselect_b32 s46, 0, 0
    s_mul_i32 s46, s46, 1152
    s_add_u32 s46, s46, s45
    buffer_load_dwordx4 v22, s[28:31], s46 offen lds
    s_lshl_b32 s46, s40, 12
    s_add_u32 m0, s46, 1024
    s_cmp_lt_u32 s50, 16
    s_cselect_b32 s46, 4, 72
    s_mul_i32 s46, s46, 1152
    s_add_u32 s46, s46, s45
    buffer_load_dwordx4 v22, s[28:31], s46 offen lds
    s_lshl_b32 s46, s40, 12
    s_add_u32 m0, s46, 2048
    s_cmp_lt_u32 s50, 16
    s_cselect_b32 s46, 18, 144
    s_mul_i32 s46, s46, 1152
    s_add_u32 s46, s46, s45
    buffer_load_dwordx4 v22, s[28:31], s46 offen lds
    s_lshl_b32 s46, s40, 12
    s_add_u32 m0, s46, 3072
    s_cmp_lt_u32 s50, 16
    s_cselect_b32 s46, 22, 216
    s_mul_i32 s46, s46, 1152
    s_add_u32 s46, s46, s45
    buffer_load_dwordx4 v22, s[28:31], s46 offen lds
    s_mov_b32 s52, s56
    s_add_u32 s53, s52, 0
    s_mul_hi_u32 s50, s53, 477218589
    s_mul_i32 s51, s50, 9
    s_sub_u32 s51, s53, s51
    s_mov_b32 s28, s86
    s_mov_b32 s29, s87
    s_mov_b32 s30, 2654208
    s_mov_b32 s31, 0x20000
    s_cmp_lt_u32 s53, 648
    s_cselect_b32 s30, s30, 0
    v_lshrrev_b32 v20, 3, v1
    v_and_b32 v21, 7, v1
    v_lshlrev_b32 v21, 4, v21
    v_xor_b32 v22, 4, v20
    v_mul_u32_u24 v23, 1152, v22
    v_add_u32 v23, v23, v21
    v_mul_u32_u24 v22, 1152, v20
    v_add_u32 v22, v22, v21
    s_mul_i32 s45, s50, 36864
    s_lshl_b32 s46, s51, 7
    s_add_u32 s45, s45, s46
    s_lshl_b32 s46, s40, 12
    s_add_u32 m0, s46, 16384
    s_add_u32 s46, s45, 0
    buffer_load_dwordx4 v22, s[28:31], s46 offen lds
    s_lshl_b32 s46, s40, 12
    s_add_u32 m0, s46, 17408
    s_add_u32 s46, s45, 9216
    buffer_load_dwordx4 v23, s[28:31], s46 offen lds
    s_lshl_b32 s46, s40, 12
    s_add_u32 m0, s46, 18432
    s_add_u32 s46, s45, 18432
    buffer_load_dwordx4 v22, s[28:31], s46 offen lds
    s_lshl_b32 s46, s40, 12
    s_add_u32 m0, s46, 19456
    s_add_u32 s46, s45, 27648
    buffer_load_dwordx4 v23, s[28:31], s46 offen lds
    s_add_u32 s54, s52, 256
    s_mul_hi_u32 s50, s54, 477218589
    s_mul_i32 s51, s50, 9
    s_sub_u32 s51, s54, s51
    s_mov_b32 s28, s86
    s_mov_b32 s29, s87
    s_mov_b32 s30, 2654208
    s_mov_b32 s31, 0x20000
    s_cmp_lt_u32 s54, 648
    s_cselect_b32 s30, s30, 0
    v_lshrrev_b32 v20, 3, v1
    v_and_b32 v21, 7, v1
    v_lshlrev_b32 v21, 4, v21
    v_xor_b32 v22, 4, v20
    v_mul_u32_u24 v23, 1152, v22
    v_add_u32 v23, v23, v21
    v_mul_u32_u24 v22, 1152, v20
    v_add_u32 v22, v22, v21
    s_mul_i32 s45, s50, 36864
    s_lshl_b32 s46, s51, 7
    s_add_u32 s45, s45, s46
    s_lshl_b32 s46, s40, 12
    s_add_u32 m0, s46, 32768
    s_add_u32 s46, s45, 0
    buffer_load_dwordx4 v22, s[28:31], s46 offen lds
    s_lshl_b32 s46, s40, 12
    s_add_u32 m0, s46, 33792
    s_add_u32 s46, s45, 9216
    buffer_load_dwordx4 v23, s[28:31], s46 offen lds
    s_lshl_b32 s46, s40, 12
    s_add_u32 m0, s46, 34816
    s_add_u32 s46, s45, 18432
    buffer_load_dwordx4 v22, s[28:31], s46 offen lds
    s_lshl_b32 s46, s40, 12
    s_add_u32 m0, s46, 35840
    s_add_u32 s46, s45, 27648
    buffer_load_dwordx4 v23, s[28:31], s46 offen lds
    s_add_u32 s55, s52, 512
    s_mul_hi_u32 s50, s55, 477218589
    s_mul_i32 s51, s50, 9
    s_sub_u32 s51, s55, s51
    s_mov_b32 s28, s86
    s_mov_b32 s29, s87
    s_mov_b32 s30, 2654208
    s_mov_b32 s31, 0x20000
    s_cmp_lt_u32 s55, 648
    s_cselect_b32 s30, s30, 0
    v_lshrrev_b32 v20, 3, v1
    v_and_b32 v21, 7, v1
    v_lshlrev_b32 v21, 4, v21
    v_xor_b32 v22, 4, v20
    v_mul_u32_u24 v23, 1152, v22
    v_add_u32 v23, v23, v21
    v_mul_u32_u24 v22, 1152, v20
    v_add_u32 v22, v22, v21
    s_mul_i32 s45, s50, 36864
    s_lshl_b32 s46, s51, 7
    s_add_u32 s45, s45, s46
    s_lshl_b32 s46, s40, 12
    s_add_u32 m0, s46, 49152
    s_add_u32 s46, s45, 0
    buffer_load_dwordx4 v22, s[28:31], s46 offen lds
    s_lshl_b32 s46, s40, 12
    s_add_u32 m0, s46, 50176
    s_add_u32 s46, s45, 9216
    buffer_load_dwordx4 v23, s[28:31], s46 offen lds
    s_lshl_b32 s46, s40, 12
    s_add_u32 m0, s46, 51200
    s_add_u32 s46, s45, 18432
    buffer_load_dwordx4 v22, s[28:31], s46 offen lds
    s_lshl_b32 s46, s40, 12
    s_add_u32 m0, s46, 52224
    s_add_u32 s46, s45, 27648
    buffer_load_dwordx4 v23, s[28:31], s46 offen lds
    s_cmp_eq_u32 s40, 0
    s_cselect_b32 s6, s6, 0
    s_cselect_b32 s57, 32, 0
    s_mov_b32 s88, s58
    s_mov_b32 s3, 65536
    v_mov_b32 v253, 0
    buffer_atomic_add v253, v251, s[4:7], s3 offen sc0
    v_pk_fma_f32 v[224:225], v[80:81], v[80:81], s[94:95] op_sel_hi:[1,1,0] neg_lo:[1,0,1] neg_hi:[1,0,1]
    v_pk_fma_f32 v[226:227], v[82:83], v[82:83], s[94:95] op_sel_hi:[1,1,0] neg_lo:[1,0,1] neg_hi:[1,0,1]
    v_pk_mul_f32 v[224:225], v[224:225], v[80:81]
    v_pk_mul_f32 v[226:227], v[226:227], v[82:83]
    v_exp_f32 v224, v224
    v_exp_f32 v225, v225
    v_exp_f32 v226, v226
    v_exp_f32 v227, v227
    v_pk_add_f32 v[224:225], v[224:225], 1.0 op_sel_hi:[1,0]
    v_pk_add_f32 v[226:227], v[226:227], 1.0 op_sel_hi:[1,0]
    v_rcp_f32 v224, v224
    v_rcp_f32 v225, v225
    v_rcp_f32 v226, v226
    v_rcp_f32 v227, v227
    v_pk_mul_f32 v[224:225], v[224:225], v[80:81]
    v_pk_mul_f32 v[226:227], v[226:227], v[82:83]
    v_cvt_pk_bf16_f32 v232, v224, v225
    v_cvt_pk_bf16_f32 v233, v226, v227
    v_pk_fma_f32 v[228:229], v[84:85], v[84:85], s[94:95] op_sel_hi:[1,1,0] neg_lo:[1,0,1] neg_hi:[1,0,1]
    v_pk_fma_f32 v[230:231], v[86:87], v[86:87], s[94:95] op_sel_hi:[1,1,0] neg_lo:[1,0,1] neg_hi:[1,0,1]
    v_pk_mul_f32 v[228:229], v[228:229], v[84:85]
    v_pk_mul_f32 v[230:231], v[230:231], v[86:87]
    v_exp_f32 v228, v228
    v_exp_f32 v229, v229
    v_exp_f32 v230, v230
    v_exp_f32 v231, v231
    v_pk_add_f32 v[228:229], v[228:229], 1.0 op_sel_hi:[1,0]
    v_pk_add_f32 v[230:231], v[230:231], 1.0 op_sel_hi:[1,0]
    v_rcp_f32 v228, v228
    v_rcp_f32 v229, v229
    v_rcp_f32 v230, v230
    v_rcp_f32 v231, v231
    v_pk_mul_f32 v[228:229], v[228:229], v[84:85]
    v_pk_mul_f32 v[230:231], v[230:231], v[86:87]
    v_cvt_pk_bf16_f32 v234, v228, v229
    v_cvt_pk_bf16_f32 v235, v230, v231
    buffer_store_dwordx4 v[232:235], v250, s[20:23], s95 offen offset:1024 sc1
    v_pk_fma_f32 v[224:225], v[88:89], v[88:89], s[94:95] op_sel_hi:[1,1,0] neg_lo:[1,0,1] neg_hi:[1,0,1]
    v_pk_fma_f32 v[226:227], v[90:91], v[90:91], s[94:95] op_sel_hi:[1,1,0] neg_lo:[1,0,1] neg_hi:[1,0,1]
    v_pk_mul_f32 v[224:225], v[224:225], v[88:89]
    v_pk_mul_f32 v[226:227], v[226:227], v[90:91]
    v_exp_f32 v224, v224
    v_exp_f32 v225, v225
    v_exp_f32 v226, v226
    v_exp_f32 v227, v227
    v_pk_add_f32 v[224:225], v[224:225], 1.0 op_sel_hi:[1,0]
    v_pk_add_f32 v[226:227], v[226:227], 1.0 op_sel_hi:[1,0]
    v_rcp_f32 v224, v224
    v_rcp_f32 v225, v225
    v_rcp_f32 v226, v226
    v_rcp_f32 v227, v227
    v_pk_mul_f32 v[224:225], v[224:225], v[88:89]
    v_pk_mul_f32 v[226:227], v[226:227], v[90:91]
    v_cvt_pk_bf16_f32 v238, v224, v225
    v_cvt_pk_bf16_f32 v239, v226, v227
    v_pk_fma_f32 v[228:229], v[92:93], v[92:93], s[94:95] op_sel_hi:[1,1,0] neg_lo:[1,0,1] neg_hi:[1,0,1]
    v_pk_fma_f32 v[230:231], v[94:95], v[94:95], s[94:95] op_sel_hi:[1,1,0] neg_lo:[1,0,1] neg_hi:[1,0,1]
    v_pk_mul_f32 v[228:229], v[228:229], v[92:93]
    v_pk_mul_f32 v[230:231], v[230:231], v[94:95]
    v_exp_f32 v228, v228
    v_exp_f32 v229, v229
    v_exp_f32 v230, v230
    v_exp_f32 v231, v231
    v_pk_add_f32 v[228:229], v[228:229], 1.0 op_sel_hi:[1,0]
    v_pk_add_f32 v[230:231], v[230:231], 1.0 op_sel_hi:[1,0]
    v_rcp_f32 v228, v228
    v_rcp_f32 v229, v229
    v_rcp_f32 v230, v230
    v_rcp_f32 v231, v231
    v_pk_mul_f32 v[228:229], v[228:229], v[92:93]
    v_pk_mul_f32 v[230:231], v[230:231], v[94:95]
    v_cvt_pk_bf16_f32 v236, v228, v229
    v_cvt_pk_bf16_f32 v237, v230, v231
    buffer_store_dwordx4 v[236:239], v250, s[20:23], s95 offen offset:1280 sc1
    v_pk_fma_f32 v[224:225], v[96:97], v[96:97], s[94:95] op_sel_hi:[1,1,0] neg_lo:[1,0,1] neg_hi:[1,0,1]
    v_pk_fma_f32 v[226:227], v[98:99], v[98:99], s[94:95] op_sel_hi:[1,1,0] neg_lo:[1,0,1] neg_hi:[1,0,1]
    v_pk_mul_f32 v[224:225], v[224:225], v[96:97]
    v_pk_mul_f32 v[226:227], v[226:227], v[98:99]
    v_exp_f32 v224, v224
    v_exp_f32 v225, v225
    v_exp_f32 v226, v226
    v_exp_f32 v227, v227
    v_pk_add_f32 v[224:225], v[224:225], 1.0 op_sel_hi:[1,0]
    v_pk_add_f32 v[226:227], v[226:227], 1.0 op_sel_hi:[1,0]
    v_rcp_f32 v224, v224
    v_rcp_f32 v225, v225
    v_rcp_f32 v226, v226
    v_rcp_f32 v227, v227
    v_pk_mul_f32 v[224:225], v[224:225], v[96:97]
    v_pk_mul_f32 v[226:227], v[226:227], v[98:99]
    v_cvt_pk_bf16_f32 v240, v224, v225
    v_cvt_pk_bf16_f32 v241, v226, v227
    v_pk_fma_f32 v[228:229], v[100:101], v[100:101], s[94:95] op_sel_hi:[1,1,0] neg_lo:[1,0,1] neg_hi:[1,0,1]
    v_pk_fma_f32 v[230:231], v[102:103], v[102:103], s[94:95] op_sel_hi:[1,1,0] neg_lo:[1,0,1] neg_hi:[1,0,1]
    v_pk_mul_f32 v[228:229], v[228:229], v[100:101]
    v_pk_mul_f32 v[230:231], v[230:231], v[102:103]
    v_exp_f32 v228, v228
    v_exp_f32 v229, v229
    v_exp_f32 v230, v230
    v_exp_f32 v231, v231
    v_pk_add_f32 v[228:229], v[228:229], 1.0 op_sel_hi:[1,0]
    v_pk_add_f32 v[230:231], v[230:231], 1.0 op_sel_hi:[1,0]
    v_rcp_f32 v228, v228
    v_rcp_f32 v229, v229
    v_rcp_f32 v230, v230
    v_rcp_f32 v231, v231
    v_pk_mul_f32 v[228:229], v[228:229], v[100:101]
    v_pk_mul_f32 v[230:231], v[230:231], v[102:103]
    v_cvt_pk_bf16_f32 v242, v228, v229
    v_cvt_pk_bf16_f32 v243, v230, v231
    buffer_store_dwordx4 v[240:243], v250, s[20:23], s65 offen offset:1024 sc1
    v_pk_fma_f32 v[224:225], v[104:105], v[104:105], s[94:95] op_sel_hi:[1,1,0] neg_lo:[1,0,1] neg_hi:[1,0,1]
    v_pk_fma_f32 v[226:227], v[106:107], v[106:107], s[94:95] op_sel_hi:[1,1,0] neg_lo:[1,0,1] neg_hi:[1,0,1]
    v_pk_mul_f32 v[224:225], v[224:225], v[104:105]
    v_pk_mul_f32 v[226:227], v[226:227], v[106:107]
    v_exp_f32 v224, v224
    v_exp_f32 v225, v225
    v_exp_f32 v226, v226
    v_exp_f32 v227, v227
    v_pk_add_f32 v[224:225], v[224:225], 1.0 op_sel_hi:[1,0]
    v_pk_add_f32 v[226:227], v[226:227], 1.0 op_sel_hi:[1,0]
    v_rcp_f32 v224, v224
    v_rcp_f32 v225, v225
    v_rcp_f32 v226, v226
    v_rcp_f32 v227, v227
    v_pk_mul_f32 v[224:225], v[224:225], v[104:105]
    v_pk_mul_f32 v[226:227], v[226:227], v[106:107]
    v_cvt_pk_bf16_f32 v234, v224, v225
    v_cvt_pk_bf16_f32 v235, v226, v227
    v_pk_fma_f32 v[228:229], v[108:109], v[108:109], s[94:95] op_sel_hi:[1,1,0] neg_lo:[1,0,1] neg_hi:[1,0,1]
    v_pk_fma_f32 v[230:231], v[110:111], v[110:111], s[94:95] op_sel_hi:[1,1,0] neg_lo:[1,0,1] neg_hi:[1,0,1]
    v_pk_mul_f32 v[228:229], v[228:229], v[108:109]
    v_pk_mul_f32 v[230:231], v[230:231], v[110:111]
    v_exp_f32 v228, v228
    v_exp_f32 v229, v229
    v_exp_f32 v230, v230
    v_exp_f32 v231, v231
    v_pk_add_f32 v[228:229], v[228:229], 1.0 op_sel_hi:[1,0]
    v_pk_add_f32 v[230:231], v[230:231], 1.0 op_sel_hi:[1,0]
    v_rcp_f32 v228, v228
    v_rcp_f32 v229, v229
    v_rcp_f32 v230, v230
    v_rcp_f32 v231, v231
    v_pk_mul_f32 v[228:229], v[228:229], v[108:109]
    v_pk_mul_f32 v[230:231], v[230:231], v[110:111]
    v_cvt_pk_bf16_f32 v232, v228, v229
    v_cvt_pk_bf16_f32 v233, v230, v231
    buffer_store_dwordx4 v[232:235], v250, s[20:23], s65 offen offset:1280 sc1
    s_mul_hi_u32 s50, s56, 477218589
    s_mul_i32 s51, s50, 9
    s_sub_u32 s51, s56, s51
    s_add_u32 s50, s50, 72
    s_mul_i32 s47, s50, 36864
    s_lshl_b32 s46, s51, 12
    s_add_u32 s47, s47, s46
    s_cmp_lt_u32 s56, 162
    s_cselect_b32 s47, s47, 2147478512
    v_add_u32 v246, s47, v255
    s_mul_hi_u32 s50, s53, 477218589
    s_mul_i32 s51, s50, 9
    s_sub_u32 s51, s53, s51
    s_add_u32 s50, s50, 0
    s_mul_i32 s47, s50, 36864
    s_lshl_b32 s46, s51, 12
    s_add_u32 s47, s47, s46
    s_cmp_lt_u32 s53, 648
    s_cselect_b32 s47, s47, 2147478512
    v_add_u32 v247, s47, v255
    s_mul_hi_u32 s50, s54, 477218589
    s_mul_i32 s51, s50, 9
    s_sub_u32 s51, s54, s51
    s_add_u32 s50, s50, 0
    s_mul_i32 s47, s50, 36864
    s_lshl_b32 s46, s51, 12
    s_add_u32 s47, s47, s46
    s_cmp_lt_u32 s54, 648
    s_cselect_b32 s47, s47, 2147478512
    v_add_u32 v248, s47, v255
    s_mul_hi_u32 s50, s55, 477218589
    s_mul_i32 s51, s50, 9
    s_sub_u32 s51, s55, s51
    s_add_u32 s50, s50, 0
    s_mul_i32 s47, s50, 36864
    s_lshl_b32 s46, s51, 12
    s_add_u32 s47, s47, s46
    s_cmp_lt_u32 s55, 648
    s_cselect_b32 s47, s47, 2147478512
    v_add_u32 v249, s47, v255
    v_lshrrev_b32 v244, 4, v1
    v_lshlrev_b32 v244, 3, v244
    v_bfe_u32 v245, v1, 2, 2
    v_add_u32 v244, v244, v245
    v_lshlrev_b32 v244, 7, v244
    s_lshl_b32 s46, s40, 12
    v_add_u32 v244, s46, v244
    v_and_b32 v243, 3, v1
    v_lshl_add_u32 v245, v243, 4, v244
    v_lshl_add_u32 v244, v243, 3, v244
    s_waitcnt vmcnt(4)
    s_mov_b32 s45, 0
k1_kernel_pl20:
    v_bfe_u32 v253, v253, 0, 8
    v_cmp_gt_u32 vcc, s57, v253
    s_add_u32 s45, s45, 1
    s_and_b32 vcc_lo, vcc_lo, 255
    s_cbranch_scc0 k1_kernel_pd21
    s_cmp_ge_u32 s45, 200000
    s_cbranch_scc1 k1_kernel_pd21
    s_sleep 4
    v_mov_b32 v253, 0
    buffer_atomic_add v253, v251, s[4:7], s3 offen sc0
    s_waitcnt vmcnt(0)
    s_branch k1_kernel_pl20
k1_kernel_pd21:
    s_add_u32 s8, s84, 25165824
    s_addc_u32 s9, s85, 0
    s_mov_b32 s10, 4718592
    s_mov_b32 s11, 0x20000
    s_add_u32 s12, s84, 31457280
    s_addc_u32 s13, s85, 0
    s_mov_b32 s14, 2392064
    s_mov_b32 s15, 0x20000
    s_add_u32 s16, s84, 46137344
    s_addc_u32 s17, s85, 0
    s_mov_b32 s18, 2359296
    s_mov_b32 s19, 0x20000
    v_and_b32 v10, 31, v1
    v_lshrrev_b32 v11, 5, v1
    s_lshr_b32 s60, s41, 1
    s_mul_i32 s60, s60, 9
    s_and_b32 s61, s41, 1
    s_mul_i32 s62, s61, 5
    s_add_u32 s62, s62, s60
    s_lshl_b32 s62, s62, 8
    v_lshlrev_b32 v12, 3, v10
    v_lshl_add_u32 v2, v11, 9, v12
    v_add_u32 v2, s62, v2
    s_add_u32 s60, s60, 4
    s_lshl_b32 s60, s60, 8
    v_add_u32 v3, s60, v12
    v_cmp_eq_u32 vcc, 0, v11
    v_mov_b32 v13, 2147483632
    s_nop 0
    v_cndmask_b32 v3, v13, v3, vcc
    s_cmp_eq_u32 s61, 0
    s_cselect_b32 s58, -1, 0
    s_cselect_b32 s59, 0, -1
    s_mul_i32 s62, s41, 18
    v_add_u32 v12, s62, v10
    v_mov_b32 v14, 576
    v_cmp_gt_u32 vcc, 18, v10
    s_nop 1
    v_cndmask_b32 v12, v14, v12, vcc
    v_lshlrev_b32 v12, 4, v12
    v_mul_u32_u24 v14, 9344, v11
    v_add_u32 v4, v12, v14
    v_add_u32 v5, 18688, v4
    v_bfe_u32 v12, v1, 4, 1
    v_mul_u32_u24 v12, 18432, v12
    v_and_b32 v14, 15, v1
    v_lshl_add_u32 v12, v14, 4, v12
    s_lshl_b32 s62, s41, 9
    v_lshl_add_u32 v6, v11, 8, v12
    v_add_u32 v6, s62, v6
    s_lshr_b32 s62, s41, 2
    s_add_u32 s62, s62, 64
    s_lshl_b32 s62, s62, 8
    s_and_b32 s61, s41, 3
    s_lshl_b32 s61, s61, 2
    s_add_u32 s62, s62, s61
    v_add_u32 v7, s62, v12
    v_cmp_eq_u32 vcc, 0, v11
    s_nop 1
    v_cndmask_b32 v7, v13, v7, vcc
    v_mul_u32_u24 v8, 0x3f80, v11
    v_mul_u32_u24 v9, 0xff00, v11
    v_lshlrev_b32 v12, 2, v11
    v_sub_u32 v12, v10, v12
    v_cmp_le_i32 s[20:21], 0, v12
    v_cmp_le_i32 s[22:23], 1, v12
    v_cmp_le_i32 s[24:25], 2, v12
    v_cmp_le_i32 s[26:27], 3, v12
    v_cmp_le_i32 s[28:29], 8, v12
    v_cmp_le_i32 s[30:31], 9, v12
    v_cmp_le_i32 s[32:33], 10, v12
    v_cmp_le_i32 s[34:35], 11, v12
    v_cmp_le_i32 s[36:37], 16, v12
    v_cmp_le_i32 s[38:39], 17, v12
    v_cmp_le_i32 s[46:47], 18, v12
    v_cmp_le_i32 s[48:49], 19, v12
    v_cmp_le_i32 s[50:51], 24, v12
    v_cmp_le_i32 s[52:53], 25, v12
    v_cmp_le_i32 s[54:55], 26, v12
    v_cmp_le_i32 s[56:57], 27, v12
    v_mov_b32 v14, 0xffff
    v_mov_b32 v15, 0xffff0000
    v_cndmask_b32 v234, 0, v14, s[20:21]
    v_cndmask_b32 v242, 0, v15, s[22:23]
    v_or_b32 v234, v234, v242
    v_cndmask_b32 v235, 0, v14, s[24:25]
    v_cndmask_b32 v242, 0, v15, s[26:27]
    v_or_b32 v235, v235, v242
    v_cndmask_b32 v236, 0, v14, s[28:29]
    v_cndmask_b32 v242, 0, v15, s[30:31]
    v_or_b32 v236, v236, v242
    v_cndmask_b32 v237, 0, v14, s[32:33]
    v_cndmask_b32 v242, 0, v15, s[34:35]
    v_or_b32 v237, v237, v242
    v_cndmask_b32 v238, 0, v14, s[36:37]
    v_cndmask_b32 v242, 0, v15, s[38:39]
    v_or_b32 v238, v238, v242
    v_cndmask_b32 v239, 0, v14, s[46:47]
    v_cndmask_b32 v242, 0, v15, s[48:49]
    v_or_b32 v239, v239, v242
    v_cndmask_b32 v240, 0, v14, s[50:51]
    v_cndmask_b32 v242, 0, v15, s[52:53]
    v_or_b32 v240, v240, v242
    v_cndmask_b32 v241, 0, v14, s[54:55]
    v_cndmask_b32 v242, 0, v15, s[56:57]
    v_or_b32 v241, v241, v242
    v_mov_b32 v84, 0
    v_mov_b32 v85, 0
    v_mov_b32 v92, 0
    v_mov_b32 v93, 0
    v_mov_b32 v100, 0
    v_mov_b32 v101, 0
    v_mov_b32 v12, v246
    v_mov_b32 v13, v247
    v_mov_b32 v14, v248
    v_mov_b32 v15, v249
    s_add_u32 s96, s84, 50331648
    s_addc_u32 s97, s85, 0
    s_mov_b32 s98, 3317760
    s_mov_b32 s99, 0x20000
    s_add_u32 s100, s40, 72
    s_mul_i32 s100, s100, 36864
    s_mul_i32 s101, s44, 9216
    s_add_u32 s100, s100, s101
    s_mul_i32 s101, s40, 9216
    s_barrier
    s_mov_b32 s3, 32768
    s_getpc_b64 s[86:87]
kb_apc:
    s_bfe_u32 s45, s2, 131075
    s_lshl_b32 s45, s45, 13
    v_lshlrev_b32 v10, 5, v0
    v_add_u32 v10, s45, v10
    v_min_u32 v10, kb_fin-kb_apc-4, v10
    global_load_dword v11, v10, s[86:87]
    s_bfe_u32 s89, s2, 0x30003
    s_lshl_b32 s89, s89, 2
    s_add_u32 s89, s89, s40
    s_mul_i32 s89, s89, 324
    s_bfe_u32 s94, s2, 0x10002
    s_mul_i32 s94, s94, 18432
    s_mul_i32 s61, s42, 73728
    s_add_u32 s61, s61, 0
    buffer_load_dwordx2 v[86:87], v2, s[8:11], s61 offen sc1
    buffer_load_dwordx2 v[88:89], v2, s[8:11], s61 offen offset:256 sc1
    buffer_load_dwordx2 v[82:83], v3, s[8:11], s61 offen sc1
    s_add_i32 s62, s42, -8
    s_max_i32 s62, s62, 0
    s_mul_i32 s62, s62, 73728
    s_add_u32 s62, s62, 36864
    buffer_load_dwordx2 v[18:19], v2, s[8:11], s62 offen sc1
    buffer_load_dwordx2 v[20:21], v2, s[8:11], s62 offen offset:256 sc1
    buffer_load_dwordx2 v[16:17], v3, s[8:11], s62 offen sc1
    s_mul_i32 s63, s42, 73728
    s_add_u32 s63, s63, 36864
    buffer_load_dwordx2 v[66:67], v2, s[8:11], s63 offen sc1
    buffer_load_dwordx2 v[68:69], v2, s[8:11], s63 offen offset:256 sc1
    buffer_load_dwordx2 v[64:65], v3, s[8:11], s63 offen sc1
    s_add_i32 s64, s42, -7
    s_max_i32 s64, s64, 0
    s_mul_i32 s64, s64, 73728
    s_add_u32 s64, s64, 36864
    buffer_load_dwordx2 v[24:25], v2, s[8:11], s64 offen sc1
    buffer_load_dwordx2 v[26:27], v2, s[8:11], s64 offen offset:256 sc1
    buffer_load_dwordx2 v[22:23], v3, s[8:11], s64 offen sc1
    s_add_i32 s65, s42, -6
    s_max_i32 s65, s65, 0
    s_mul_i32 s65, s65, 73728
    s_add_u32 s65, s65, 36864
    buffer_load_dwordx2 v[30:31], v2, s[8:11], s65 offen sc1
    buffer_load_dwordx2 v[32:33], v2, s[8:11], s65 offen offset:256 sc1
    buffer_load_dwordx2 v[28:29], v3, s[8:11], s65 offen sc1
    s_add_i32 s60, s42, -5
    s_max_i32 s60, s60, 0
    s_mul_i32 s60, s60, 73728
    s_add_u32 s60, s60, 36864
    buffer_load_dwordx2 v[36:37], v2, s[8:11], s60 offen sc1
    buffer_load_dwordx2 v[38:39], v2, s[8:11], s60 offen offset:256 sc1
    buffer_load_dwordx2 v[34:35], v3, s[8:11], s60 offen sc1
    s_add_i32 s61, s42, -4
    s_max_i32 s61, s61, 0
    s_mul_i32 s61, s61, 73728
    s_add_u32 s61, s61, 36864
    buffer_load_dwordx2 v[42:43], v2, s[8:11], s61 offen sc1
    buffer_load_dwordx2 v[44:45], v2, s[8:11], s61 offen offset:256 sc1
    buffer_load_dwordx2 v[40:41], v3, s[8:11], s61 offen sc1
    s_add_i32 s62, s42, -3
    s_max_i32 s62, s62, 0
    s_mul_i32 s62, s62, 73728
    s_add_u32 s62, s62, 36864
    buffer_load_dwordx2 v[48:49], v2, s[8:11], s62 offen sc1
    buffer_load_dwordx2 v[50:51], v2, s[8:11], s62 offen offset:256 sc1
    buffer_load_dwordx2 v[46:47], v3, s[8:11], s62 offen sc1
    s_add_i32 s63, s42, -2
    s_max_i32 s63, s63, 0
    s_mul_i32 s63, s63, 73728
    s_add_u32 s63, s63, 36864
    buffer_load_dwordx2 v[54:55], v2, s[8:11], s63 offen sc1
    buffer_load_dwordx2 v[56:57], v2, s[8:11], s63 offen offset:256 sc1
    buffer_load_dwordx2 v[52:53], v3, s[8:11], s63 offen sc1
    s_add_i32 s64, s42, -1
    s_max_i32 s64, s64, 0
    s_mul_i32 s64, s64, 73728
    s_add_u32 s64, s64, 36864
    buffer_load_dwordx2 v[60:61], v2, s[8:11], s64 offen sc1
    buffer_load_dwordx2 v[62:63], v2, s[8:11], s64 offen offset:256 sc1
    buffer_load_dwordx2 v[58:59], v3, s[8:11], s64 offen sc1
    s_waitcnt vmcnt(30)
    ds_read_b64_tr_b16 a[128:129], v244 offset:0
    ds_read_b64_tr_b16 a[130:131], v244 offset:512
    ds_read_b64_tr_b16 a[132:133], v244 offset:32
    ds_read_b64_tr_b16 a[134:135], v244 offset:544
    ds_read_b64_tr_b16 a[136:137], v244 offset:64
    ds_read_b64_tr_b16 a[138:139], v244 offset:576
    ds_read_b64_tr_b16 a[140:141], v244 offset:96
    ds_read_b64_tr_b16 a[142:143], v244 offset:608
    ds_read_b64_tr_b16 a[144:145], v245 offset:16384
    ds_read_b64_tr_b16 a[146:147], v245 offset:16896
    ds_read_b64_tr_b16 a[148:149], v245 offset:16392
    ds_read_b64_tr_b16 a[150:151], v245 offset:16904
    ds_read_b64_tr_b16 a[152:153], v245 offset:16448
    ds_read_b64_tr_b16 a[154:155], v245 offset:16960
    ds_read_b64_tr_b16 a[156:157], v245 offset:16456
    ds_read_b64_tr_b16 a[158:159], v245 offset:16968
    ds_read_b64_tr_b16 a[160:161], v245 offset:32768
    ds_read_b64_tr_b16 a[162:163], v245 offset:33280
    ds_read_b64_tr_b16 a[164:165], v245 offset:32776
    ds_read_b64_tr_b16 a[166:167], v245 offset:33288
    ds_read_b64_tr_b16 a[168:169], v245 offset:32832
    ds_read_b64_tr_b16 a[170:171], v245 offset:33344
    ds_read_b64_tr_b16 a[172:173], v245 offset:32840
    ds_read_b64_tr_b16 a[174:175], v245 offset:33352
    ds_read_b64_tr_b16 a[176:177], v245 offset:49152
    ds_read_b64_tr_b16 a[178:179], v245 offset:49664
    ds_read_b64_tr_b16 a[180:181], v245 offset:49160
    ds_read_b64_tr_b16 a[182:183], v245 offset:49672
    ds_read_b64_tr_b16 a[184:185], v245 offset:49216
    ds_read_b64_tr_b16 a[186:187], v245 offset:49728
    ds_read_b64_tr_b16 a[188:189], v245 offset:49224
    ds_read_b64_tr_b16 a[190:191], v245 offset:49736
    s_waitcnt lgkmcnt(0)
    s_waitcnt vmcnt(25)
    v_mfma_f32_32x32x16_bf16 v[154:169], v[18:21], v[86:89], 0
    s_mul_i32 s65, s42, 73728
    s_add_u32 s65, s65, 73728
    buffer_load_dwordx2 v[94:95], v2, s[8:11], s65 offen sc1
    s_mul_i32 s60, s42, 73728
    s_add_u32 s60, s60, 110592
    s_add_i32 s61, s42, -7
    s_waitcnt vmcnt(23)
    v_mfma_f32_32x32x16_bf16 v[186:201], v[66:69], v[86:89], 0
    s_max_i32 s61, s61, 0
    s_mul_i32 s61, s61, 37376
    v_and_or_b32 v82, v82, s58, v8
    buffer_store_dwordx4 a[128:131], v12, s[96:99], 0 offen offset:0 sc1
    v_and_b32 v83, s59, v83
    s_cmp_lt_i32 s42, 8
    s_cselect_b32 s62, -1, 0
    s_waitcnt vmcnt(23)
    v_mfma_f32_32x32x16_bf16 v[186:201], v[64:67], v[82:85], v[186:201]
    buffer_load_dwordx2 v[96:97], v2, s[8:11], s65 offen offset:256 sc1
    v_and_or_b32 v16, v9, s62, v16
    s_add_i32 s63, s42, -6
    s_max_i32 s63, s63, 0
    s_mul_i32 s63, s63, 37376
    s_cmp_lt_i32 s42, 7
    v_mfma_f32_32x32x16_bf16 v[154:169], v[16:19], v[82:85], v[154:169]
    buffer_store_dwordx4 a[132:135], v12, s[96:99], 0 offen offset:1024 sc1
    s_cselect_b32 s64, -1, 0
    s_waitcnt vmcnt(22)
    v_and_or_b32 v22, v9, s64, v22
    buffer_load_dwordx2 v[90:91], v3, s[8:11], s65 offen sc1
    s_add_i32 s65, s42, -5
    v_mfma_f32_32x32x16_bf16 v[170:185], v[24:27], v[86:89], 0
    s_max_i32 s65, s65, 0
    s_mul_i32 s65, s65, 37376
    s_cmp_lt_i32 s42, 6
    v_mfma_f32_32x32x16_bf16 v[170:185], v[22:25], v[82:85], v[170:185]
    buffer_load_dwordx2 v[72:73], v2, s[8:11], s60 offen sc1
    v_cndmask_b32 v154, v154, v186, s[20:21]
    buffer_store_dwordx4 a[136:139], v12, s[96:99], 0 offen offset:2048 sc1
    v_cndmask_b32 v155, v155, v187, s[22:23]
    v_cndmask_b32 v156, v156, v188, s[24:25]
    v_cndmask_b32 v157, v157, v189, s[26:27]
    v_cndmask_b32 v158, v158, v190, s[28:29]
    v_cndmask_b32 v159, v159, v191, s[30:31]
    v_cndmask_b32 v160, v160, v192, s[32:33]
    v_cndmask_b32 v161, v161, v193, s[34:35]
    v_cndmask_b32 v162, v162, v194, s[36:37]
    v_cndmask_b32 v163, v163, v195, s[38:39]
    v_cndmask_b32 v164, v164, v196, s[46:47]
    buffer_load_dwordx2 v[74:75], v2, s[8:11], s60 offen offset:256 sc1
    buffer_store_dwordx4 a[140:143], v12, s[96:99], 0 offen offset:3072 sc1
    v_cndmask_b32 v165, v165, v197, s[48:49]
    v_cndmask_b32 v166, v166, v198, s[50:51]
    v_cndmask_b32 v167, v167, v199, s[52:53]
    v_cndmask_b32 v168, v168, v200, s[54:55]
    v_cndmask_b32 v169, v169, v201, s[56:57]
    v_max3_f32 v242, v154, v155, v156
    v_max3_f32 v243, v157, v158, v159
    v_max3_f32 v242, v160, v161, v242
    v_max3_f32 v243, v162, v163, v243
    v_max3_f32 v242, v164, v165, v242
    v_max3_f32 v243, v166, v167, v243
    buffer_store_dwordx4 a[144:147], v13, s[96:99], 0 offen offset:0 sc1
    buffer_load_dwordx2 v[70:71], v3, s[8:11], s60 offen sc1
    v_max3_f32 v242, v168, v169, v242
    s_waitcnt vmcnt(27)
    v_mfma_f32_32x32x16_bf16 v[154:169], v[30:33], v[86:89], 0
    v_max3_f32 v242, v170, v171, v242
    v_max3_f32 v243, v172, v173, v243
    v_max3_f32 v242, v174, v175, v242
    v_max3_f32 v243, v176, v177, v243
    v_max3_f32 v242, v178, v179, v242
    v_max3_f32 v243, v180, v181, v243
    v_max3_f32 v242, v182, v183, v242
    v_max3_f32 v243, v184, v185, v243
    buffer_store_dwordx4 a[148:151], v13, s[96:99], 0 offen offset:1024 sc1
    s_waitcnt vmcnt(25)
    v_mfma_f32_32x32x16_bf16 v[170:185], v[36:39], v[86:89], 0
    buffer_load_dwordx4 a[8:11], v4, s[12:15], s61 offen sc1
    s_cselect_b32 s60, -1, 0
    v_and_or_b32 v28, v9, s60, v28
    s_nop 1
    v_mfma_f32_32x32x16_bf16 v[154:169], v[28:31], v[82:85], v[154:169]
    buffer_load_dwordx4 a[12:15], v5, s[12:15], s61 offen sc1
    s_add_i32 s61, s42, -4
    s_max_i32 s61, s61, 0
    s_mul_i32 s61, s61, 37376
    s_cmp_lt_i32 s42, 5
    s_cselect_b32 s62, -1, 0
    buffer_store_dwordx4 a[152:155], v13, s[96:99], 0 offen offset:2048 sc1
    s_waitcnt vmcnt(27)
    v_and_or_b32 v34, v9, s62, v34
    s_nop 1
    v_mfma_f32_32x32x16_bf16 v[170:185], v[34:37], v[82:85], v[170:185]
    buffer_load_dwordx4 a[16:19], v4, s[12:15], s63 offen sc1
    v_max3_f32 v242, v154, v155, v242
    v_max3_f32 v243, v156, v157, v243
    v_max3_f32 v242, v158, v159, v242
    v_max3_f32 v243, v160, v161, v243
    v_max3_f32 v242, v162, v163, v242
    v_max3_f32 v243, v164, v165, v243
    v_max3_f32 v242, v166, v167, v242
    v_max3_f32 v243, v168, v169, v243
    buffer_store_dwordx4 a[156:159], v13, s[96:99], 0 offen offset:3072 sc1
    s_waitcnt vmcnt(27)
    v_mfma_f32_32x32x16_bf16 v[154:169], v[42:45], v[86:89], 0
    buffer_load_dwordx4 a[20:23], v5, s[12:15], s63 offen sc1
    s_add_i32 s63, s42, -3
    s_max_i32 s63, s63, 0
    s_mul_i32 s63, s63, 37376
    v_max3_f32 v242, v170, v171, v242
    v_max3_f32 v243, v172, v173, v243
    v_max3_f32 v242, v174, v175, v242
    v_max3_f32 v243, v176, v177, v243
    v_max3_f32 v242, v178, v179, v242
    v_max3_f32 v243, v180, v181, v243
    buffer_store_dwordx4 a[160:163], v14, s[96:99], 0 offen offset:0 sc1
    v_max3_f32 v242, v182, v183, v242
    v_max3_f32 v243, v184, v185, v243
    s_waitcnt vmcnt(26)
    v_mfma_f32_32x32x16_bf16 v[170:185], v[48:51], v[86:89], 0
    buffer_load_dwordx4 a[24:27], v4, s[12:15], s65 offen sc1
    s_cmp_lt_i32 s42, 4
    s_cselect_b32 s64, -1, 0
    v_and_or_b32 v40, v9, s64, v40
    s_nop 1
    v_mfma_f32_32x32x16_bf16 v[154:169], v[40:43], v[82:85], v[154:169]
    buffer_load_dwordx4 a[28:31], v5, s[12:15], s65 offen sc1
    s_add_i32 s65, s42, -2
    s_max_i32 s65, s65, 0
    buffer_store_dwordx4 a[164:167], v14, s[96:99], 0 offen offset:1024 sc1
    s_mul_i32 s65, s65, 37376
    s_cmp_lt_i32 s42, 3
    s_cselect_b32 s60, -1, 0
    s_waitcnt vmcnt(28)
    v_and_or_b32 v46, v9, s60, v46
    s_nop 1
    v_mfma_f32_32x32x16_bf16 v[170:185], v[46:49], v[82:85], v[170:185]
    buffer_load_dwordx4 a[32:35], v4, s[12:15], s61 offen sc1
    v_max3_f32 v242, v154, v155, v242
    v_max3_f32 v243, v156, v157, v243
    v_max3_f32 v242, v158, v159, v242
    v_max3_f32 v243, v160, v161, v243
    v_max3_f32 v242, v162, v163, v242
    buffer_store_dwordx4 a[168:171], v14, s[96:99], 0 offen offset:2048 sc1
    v_max3_f32 v243, v164, v165, v243
    v_max3_f32 v242, v166, v167, v242
    v_max3_f32 v243, v168, v169, v243
    s_waitcnt vmcnt(28)
    v_mfma_f32_32x32x16_bf16 v[154:169], v[54:57], v[86:89], 0
    buffer_load_dwordx4 a[36:39], v5, s[12:15], s61 offen sc1
    s_add_i32 s61, s42, -1
    s_max_i32 s61, s61, 0
    s_mul_i32 s61, s61, 37376
    v_max3_f32 v242, v170, v171, v242
    v_max3_f32 v243, v172, v173, v243
    v_max3_f32 v242, v174, v175, v242
    buffer_store_dwordx4 a[172:175], v14, s[96:99], 0 offen offset:3072 sc1
    v_max3_f32 v243, v176, v177, v243
    v_max3_f32 v242, v178, v179, v242
    v_max3_f32 v243, v180, v181, v243
    v_max3_f32 v242, v182, v183, v242
    v_max3_f32 v243, v184, v185, v243
    s_waitcnt vmcnt(27)
    v_mfma_f32_32x32x16_bf16 v[170:185], v[60:63], v[86:89], 0
    buffer_load_dwordx4 a[40:43], v4, s[12:15], s63 offen sc1
    s_cmp_lt_i32 s42, 2
    s_cselect_b32 s62, -1, 0
    v_and_or_b32 v52, v9, s62, v52
    buffer_store_dwordx4 a[176:179], v15, s[96:99], 0 offen offset:0 sc1
    s_mul_i32 s60, s42, 73728
    s_mul_i32 s62, s42, 37376
    v_mfma_f32_32x32x16_bf16 v[154:169], v[52:55], v[82:85], v[154:169]
    buffer_load_dwordx4 a[44:47], v5, s[12:15], s63 offen sc1
    s_add_i32 s63, s42, -8
    s_max_i32 s63, s63, 0
    s_mul_i32 s63, s63, 37376
    s_cmp_lt_i32 s42, 1
    s_cselect_b32 s64, -1, 0
    s_waitcnt vmcnt(29)
    v_and_or_b32 v58, v9, s64, v58
    s_nop 1
    v_mfma_f32_32x32x16_bf16 v[170:185], v[58:61], v[82:85], v[170:185]
    buffer_store_dwordx4 a[180:183], v15, s[96:99], 0 offen offset:1024 sc1
    buffer_load_dwordx4 a[48:51], v4, s[12:15], s65 offen sc1
    v_max3_f32 v242, v154, v155, v242
    v_max3_f32 v243, v156, v157, v243
    v_max3_f32 v242, v158, v159, v242
    v_max3_f32 v243, v160, v161, v243
    v_max3_f32 v242, v162, v163, v242
    v_max3_f32 v243, v164, v165, v243
    v_max3_f32 v242, v166, v167, v242
    v_max3_f32 v243, v168, v169, v243
    buffer_load_dwordx4 a[52:55], v5, s[12:15], s65 offen sc1
    s_mul_i32 s65, s42, 37376
    buffer_store_dwordx4 a[184:187], v15, s[96:99], 0 offen offset:2048 sc1
    s_waitcnt vmcnt(30)
    v_mfma_f32_32x32x16_bf16 v[154:169], v[24:27], v[94:97], 0
    v_max3_f32 v242, v170, v171, v242
    v_max3_f32 v243, v172, v173, v243
    v_max3_f32 v242, v174, v175, v242
    v_max3_f32 v243, v176, v177, v243
    v_max3_f32 v242, v178, v179, v242
    v_max3_f32 v243, v180, v181, v243
    v_max3_f32 v242, v182, v183, v242
    v_max3_f32 v243, v184, v185, v243
    buffer_load_dwordx4 a[56:59], v4, s[12:15], s61 offen sc1
    v_max_f32 v242, v242, v243
    buffer_store_dwordx4 a[188:191], v15, s[96:99], 0 offen offset:3072 sc1
    s_add_u32 s65, s65, 0
    v_mov_b32 v243, v242
    s_add_u32 s60, s60, 147456
    s_waitcnt vmcnt(30)
    v_and_or_b32 v90, v90, s58, v8
    v_permlane32_swap_b32 v242, v243
    global_load_dword v11, v10, s[86:87]
    v_and_b32 v91, s59, v91
    v_max_f32 v242, v242, v243
    v_mul_f32 v186, -1.0, v242
    v_mfma_f32_32x32x16_bf16 v[154:169], v[22:25], v[90:93], v[154:169]
    buffer_load_dwordx4 a[60:63], v5, s[12:15], s61 offen sc1
    v_mul_f32 v187, -1.0, v242
    v_mul_f32 v188, -1.0, v242
    v_mul_f32 v189, -1.0, v242
    v_mul_f32 v190, -1.0, v242
    v_mul_f32 v191, -1.0, v242
    v_mul_f32 v192, -1.0, v242
    v_mul_f32 v193, -1.0, v242
    v_mul_f32 v194, -1.0, v242
    v_mul_f32 v195, -1.0, v242
    v_mul_f32 v196, -1.0, v242
    v_mul_f32 v197, -1.0, v242
    buffer_load_dwordx4 a[0:3], v4, s[12:15], s63 offen sc1
    s_waitcnt vmcnt(29)
    v_mfma_f32_32x32x16_bf16 v[202:217], v[72:75], v[94:97], 0
    v_mul_f32 v198, -1.0, v242
    v_mul_f32 v199, -1.0, v242
    v_mul_f32 v200, -1.0, v242
    v_mul_f32 v201, -1.0, v242
    s_mul_i32 s61, s42, 73728
    s_add_u32 s61, s61, 184320
    v_mfma_f32_32x32x16_bf16 v[122:137], v[24:27], v[86:89], v[186:201]
    s_add_u32 s62, s62, 37376
    buffer_load_dwordx4 a[4:7], v5, s[12:15], s63 offen sc1
    s_waitcnt vmcnt(27)
    v_mfma_f32_32x32x16_bf16 v[202:217], v[70:73], v[90:93], v[202:217]
    buffer_load_dwordx4 a[64:67], v4, s[12:15], s65 offen sc1
    v_mfma_f32_32x32x16_bf16 v[122:137], v[22:25], v[82:85], v[122:137]
    v_mfma_f32_32x32x16_bf16 v[170:185], v[30:33], v[94:97], 0
    buffer_load_dwordx4 a[68:71], v5, s[12:15], s65 offen sc1
    s_nop 7
    v_cndmask_b32 v154, v154, v202, s[20:21]
    v_cndmask_b32 v155, v155, v203, s[22:23]
    v_cndmask_b32 v156, v156, v204, s[24:25]
    v_cndmask_b32 v157, v157, v205, s[26:27]
    v_mfma_f32_32x32x16_bf16 v[170:185], v[28:31], v[90:93], v[170:185]
    v_cndmask_b32 v158, v158, v206, s[28:29]
    v_cndmask_b32 v159, v159, v207, s[30:31]
    v_cndmask_b32 v160, v160, v208, s[32:33]
    v_cndmask_b32 v161, v161, v209, s[34:35]
    v_cndmask_b32 v162, v162, v210, s[36:37]
    buffer_load_dwordx2 v[102:103], v2, s[8:11], s60 offen sc1
    v_mfma_f32_32x32x16_bf16 v[138:153], v[30:33], v[86:89], v[186:201]
    v_cndmask_b32 v163, v163, v211, s[38:39]
    v_cndmask_b32 v164, v164, v212, s[46:47]
    v_cndmask_b32 v165, v165, v213, s[48:49]
    v_cndmask_b32 v166, v166, v214, s[50:51]
    v_cndmask_b32 v167, v167, v215, s[52:53]
    v_cndmask_b32 v168, v168, v216, s[54:55]
    v_mfma_f32_32x32x16_bf16 v[138:153], v[28:31], v[82:85], v[138:153]
    v_cndmask_b32 v169, v169, v217, s[56:57]
    buffer_load_dwordx2 v[104:105], v2, s[8:11], s60 offen offset:256 sc1
    v_max3_f32 v242, v154, v155, v156
    v_max3_f32 v243, v157, v158, v159
    v_max3_f32 v242, v160, v161, v242
    v_max3_f32 v243, v162, v163, v243
    v_max3_f32 v242, v164, v165, v242
    v_max3_f32 v243, v166, v167, v243
    v_max3_f32 v242, v168, v169, v242
    v_mfma_f32_32x32x16_bf16 v[154:169], v[36:39], v[94:97], 0
    v_exp_f32 v122, v122
    buffer_load_dwordx2 v[98:99], v3, s[8:11], s60 offen sc1
    v_exp_f32 v123, v123
    v_exp_f32 v124, v124
    v_mfma_f32_32x32x16_bf16 v[154:169], v[34:37], v[90:93], v[154:169]
    v_exp_f32 v125, v125
    v_exp_f32 v126, v126
    v_exp_f32 v127, v127
    buffer_load_dwordx2 v[78:79], v2, s[8:11], s61 offen sc1
    v_exp_f32 v128, v128
    v_exp_f32 v129, v129
    v_exp_f32 v130, v130
    v_exp_f32 v131, v131
    v_exp_f32 v132, v132
    v_exp_f32 v133, v133
    buffer_load_dwordx2 v[80:81], v2, s[8:11], s61 offen offset:256 sc1
    v_exp_f32 v134, v134
    v_exp_f32 v135, v135
    v_exp_f32 v136, v136
    v_exp_f32 v137, v137
    v_cvt_pk_bf16_f32 v122, v122, v123
    v_cvt_pk_bf16_f32 v123, v124, v125
    v_cvt_pk_bf16_f32 v124, v126, v127
    buffer_load_dwordx2 v[76:77], v3, s[8:11], s61 offen sc1
    v_mfma_f32_32x32x16_bf16 v[106:121], v[36:39], v[86:89], v[186:201]
    v_cvt_pk_bf16_f32 v125, v128, v129
    v_cvt_pk_bf16_f32 v126, v130, v131
    v_cvt_pk_bf16_f32 v127, v132, v133
    v_cvt_pk_bf16_f32 v128, v134, v135
    v_cvt_pk_bf16_f32 v129, v136, v137
    v_max3_f32 v242, v170, v171, v242
    s_waitcnt vmcnt(33)
    v_mfma_f32_32x32x16_bf16 v[218:233], a[8:11], v[122:125], 0
    v_max3_f32 v243, v172, v173, v243
    buffer_load_dwordx4 a[72:75], v4, s[12:15], s62 offen sc1
    v_max3_f32 v242, v174, v175, v242
    v_max3_f32 v243, v176, v177, v243
    v_max3_f32 v242, v178, v179, v242
    v_max3_f32 v243, v180, v181, v243
    s_waitcnt vmcnt(33)
    v_mfma_f32_32x32x16_bf16 v[218:233], a[12:15], v[126:129], v[218:233]
    v_max3_f32 v242, v182, v183, v242
    v_max3_f32 v243, v184, v185, v243
    v_exp_f32 v138, v138
    v_exp_f32 v139, v139
    v_mfma_f32_32x32x16_bf16 v[106:121], v[34:37], v[82:85], v[106:121]
    buffer_load_dwordx4 a[76:79], v5, s[12:15], s62 offen sc1
    v_exp_f32 v140, v140
    v_exp_f32 v141, v141
    v_exp_f32 v142, v142
    v_mfma_f32_32x32x16_bf16 v[170:185], v[42:45], v[94:97], 0
    v_exp_f32 v143, v143
    v_exp_f32 v144, v144
    v_exp_f32 v145, v145
    v_mfma_f32_32x32x16_bf16 v[170:185], v[40:43], v[90:93], v[170:185]
    v_exp_f32 v146, v146
    v_exp_f32 v147, v147
    v_exp_f32 v148, v148
    v_mfma_f32_32x32x16_bf16 v[122:137], v[42:45], v[86:89], v[186:201]
    v_exp_f32 v149, v149
    v_exp_f32 v150, v150
    v_exp_f32 v151, v151
    v_mfma_f32_32x32x16_bf16 v[122:137], v[40:43], v[82:85], v[122:137]
    v_exp_f32 v152, v152
    v_exp_f32 v153, v153
    v_cvt_pk_bf16_f32 v138, v138, v139
    v_cvt_pk_bf16_f32 v139, v140, v141
    v_cvt_pk_bf16_f32 v140, v142, v143
    v_cvt_pk_bf16_f32 v141, v144, v145
    v_cvt_pk_bf16_f32 v142, v146, v147
    v_cvt_pk_bf16_f32 v143, v148, v149
    s_waitcnt vmcnt(32)
    v_mfma_f32_32x32x16_bf16 v[218:233], a[16:19], v[138:141], v[218:233]
    v_cvt_pk_bf16_f32 v144, v150, v151
    v_cvt_pk_bf16_f32 v145, v152, v153
    v_max3_f32 v242, v154, v155, v242
    v_max3_f32 v243, v156, v157, v243
    v_max3_f32 v242, v158, v159, v242
    v_max3_f32 v243, v160, v161, v243
    s_waitcnt vmcnt(30)
    v_mfma_f32_32x32x16_bf16 v[218:233], a[20:23], v[142:145], v[218:233]
    v_max3_f32 v242, v162, v163, v242
    v_max3_f32 v243, v164, v165, v243
    v_max3_f32 v242, v166, v167, v242
    v_max3_f32 v243, v168, v169, v243
    v_exp_f32 v106, v106
    v_mfma_f32_32x32x16_bf16 v[154:169], v[48:51], v[94:97], 0
    v_exp_f32 v107, v107
    v_exp_f32 v108, v108
    v_exp_f32 v109, v109
    v_mfma_f32_32x32x16_bf16 v[154:169], v[46:49], v[90:93], v[154:169]
    v_exp_f32 v110, v110
    v_exp_f32 v111, v111
    v_exp_f32 v112, v112
    v_mfma_f32_32x32x16_bf16 v[138:153], v[48:51], v[86:89], v[186:201]
    v_exp_f32 v113, v113
    v_exp_f32 v114, v114
    v_exp_f32 v115, v115
    v_mfma_f32_32x32x16_bf16 v[138:153], v[46:49], v[82:85], v[138:153]
    v_exp_f32 v116, v116
    v_exp_f32 v117, v117
    v_exp_f32 v118, v118
    v_exp_f32 v119, v119
    v_exp_f32 v120, v120
    v_exp_f32 v121, v121
    v_cvt_pk_bf16_f32 v106, v106, v107
    v_cvt_pk_bf16_f32 v107, v108, v109
    v_cvt_pk_bf16_f32 v108, v110, v111
    v_cvt_pk_bf16_f32 v109, v112, v113
    v_cvt_pk_bf16_f32 v110, v114, v115
    v_cvt_pk_bf16_f32 v111, v116, v117
    s_waitcnt vmcnt(28)
    v_mfma_f32_32x32x16_bf16 v[218:233], a[24:27], v[106:109], v[218:233]
    v_cvt_pk_bf16_f32 v112, v118, v119
    v_cvt_pk_bf16_f32 v113, v120, v121
    v_max3_f32 v242, v170, v171, v242
    v_max3_f32 v243, v172, v173, v243
    v_max3_f32 v242, v174, v175, v242
    v_max3_f32 v243, v176, v177, v243
    s_waitcnt vmcnt(27)
    v_mfma_f32_32x32x16_bf16 v[218:233], a[28:31], v[110:113], v[218:233]
    v_max3_f32 v242, v178, v179, v242
    v_max3_f32 v243, v180, v181, v243
    v_max3_f32 v242, v182, v183, v242
    v_max3_f32 v243, v184, v185, v243
    v_exp_f32 v122, v122
    v_mfma_f32_32x32x16_bf16 v[170:185], v[54:57], v[94:97], 0
    v_exp_f32 v123, v123
    v_exp_f32 v124, v124
    v_exp_f32 v125, v125
    v_mfma_f32_32x32x16_bf16 v[170:185], v[52:55], v[90:93], v[170:185]
    v_exp_f32 v126, v126
    v_exp_f32 v127, v127
    v_exp_f32 v128, v128
    v_mfma_f32_32x32x16_bf16 v[106:121], v[54:57], v[86:89], v[186:201]
    v_exp_f32 v129, v129
    v_exp_f32 v130, v130
    v_exp_f32 v131, v131
    v_mfma_f32_32x32x16_bf16 v[106:121], v[52:55], v[82:85], v[106:121]
    v_exp_f32 v132, v132
    v_exp_f32 v133, v133
    v_exp_f32 v134, v134
    v_exp_f32 v135, v135
    v_exp_f32 v136, v136
    v_exp_f32 v137, v137
    v_cvt_pk_bf16_f32 v122, v122, v123
    v_cvt_pk_bf16_f32 v123, v124, v125
    v_cvt_pk_bf16_f32 v124, v126, v127
    v_cvt_pk_bf16_f32 v125, v128, v129
    v_cvt_pk_bf16_f32 v126, v130, v131
    v_cvt_pk_bf16_f32 v127, v132, v133
    s_waitcnt vmcnt(25)
    v_mfma_f32_32x32x16_bf16 v[218:233], a[32:35], v[122:125], v[218:233]
    v_cvt_pk_bf16_f32 v128, v134, v135
    v_cvt_pk_bf16_f32 v129, v136, v137
    v_max3_f32 v242, v154, v155, v242
    v_max3_f32 v243, v156, v157, v243
    v_max3_f32 v242, v158, v159, v242
    v_max3_f32 v243, v160, v161, v243
    s_waitcnt vmcnt(23)
    v_mfma_f32_32x32x16_bf16 v[218:233], a[36:39], v[126:129], v[218:233]
    v_max3_f32 v242, v162, v163, v242
    v_max3_f32 v243, v164, v165, v243
    v_max3_f32 v242, v166, v167, v242
    v_max3_f32 v243, v168, v169, v243
    v_exp_f32 v138, v138
    v_mfma_f32_32x32x16_bf16 v[154:169], v[60:63], v[94:97], 0
    v_exp_f32 v139, v139
    v_exp_f32 v140, v140
    v_exp_f32 v141, v141
    v_mfma_f32_32x32x16_bf16 v[154:169], v[58:61], v[90:93], v[154:169]
    v_exp_f32 v142, v142
    v_exp_f32 v143, v143
    v_exp_f32 v144, v144
    v_mfma_f32_32x32x16_bf16 v[122:137], v[60:63], v[86:89], v[186:201]
    v_exp_f32 v145, v145
    v_exp_f32 v146, v146
    v_exp_f32 v147, v147
    v_mfma_f32_32x32x16_bf16 v[122:137], v[58:61], v[82:85], v[122:137]
    v_exp_f32 v148, v148
    v_exp_f32 v149, v149
    v_exp_f32 v150, v150
    v_exp_f32 v151, v151
    v_exp_f32 v152, v152
    v_exp_f32 v153, v153
    v_cvt_pk_bf16_f32 v138, v138, v139
    v_cvt_pk_bf16_f32 v139, v140, v141
    v_cvt_pk_bf16_f32 v140, v142, v143
    v_cvt_pk_bf16_f32 v141, v144, v145
    v_cvt_pk_bf16_f32 v142, v146, v147
    v_cvt_pk_bf16_f32 v143, v148, v149
    s_waitcnt vmcnt(21)
    v_mfma_f32_32x32x16_bf16 v[218:233], a[40:43], v[138:141], v[218:233]
    v_cvt_pk_bf16_f32 v144, v150, v151
    v_cvt_pk_bf16_f32 v145, v152, v153
    v_max3_f32 v242, v170, v171, v242
    v_max3_f32 v243, v172, v173, v243
    v_max3_f32 v242, v174, v175, v242
    v_max3_f32 v243, v176, v177, v243
    s_waitcnt vmcnt(19)
    v_mfma_f32_32x32x16_bf16 v[218:233], a[44:47], v[142:145], v[218:233]
    v_max3_f32 v242, v178, v179, v242
    v_max3_f32 v243, v180, v181, v243
    v_max3_f32 v242, v182, v183, v242
    v_max3_f32 v243, v184, v185, v243
    v_exp_f32 v106, v106
    v_mfma_f32_32x32x16_bf16 v[170:185], v[66:69], v[94:97], 0
    v_exp_f32 v107, v107
    v_exp_f32 v108, v108
    v_exp_f32 v109, v109
    v_mfma_f32_32x32x16_bf16 v[170:185], v[64:67], v[90:93], v[170:185]
    v_exp_f32 v110, v110
    v_exp_f32 v111, v111
    v_exp_f32 v112, v112
    v_mfma_f32_32x32x16_bf16 v[138:153], v[18:21], v[86:89], v[186:201]
    v_exp_f32 v113, v113
    v_exp_f32 v114, v114
    v_exp_f32 v115, v115
    v_mfma_f32_32x32x16_bf16 v[138:153], v[16:19], v[82:85], v[138:153]
    v_exp_f32 v116, v116
    v_exp_f32 v117, v117
    v_exp_f32 v118, v118
    v_exp_f32 v119, v119
    v_exp_f32 v120, v120
    v_exp_f32 v121, v121
    v_cvt_pk_bf16_f32 v106, v106, v107
    v_cvt_pk_bf16_f32 v107, v108, v109
    v_cvt_pk_bf16_f32 v108, v110, v111
    v_cvt_pk_bf16_f32 v109, v112, v113
    v_cvt_pk_bf16_f32 v110, v114, v115
    v_cvt_pk_bf16_f32 v111, v116, v117
    s_waitcnt vmcnt(17)
    v_mfma_f32_32x32x16_bf16 v[218:233], a[48:51], v[106:109], v[218:233]
    v_cvt_pk_bf16_f32 v112, v118, v119
    v_cvt_pk_bf16_f32 v113, v120, v121
    v_max3_f32 v242, v154, v155, v242
    v_max3_f32 v243, v156, v157, v243
    v_max3_f32 v242, v158, v159, v242
    v_max3_f32 v243, v160, v161, v243
    s_waitcnt vmcnt(16)
    v_mfma_f32_32x32x16_bf16 v[218:233], a[52:55], v[110:113], v[218:233]
    v_max3_f32 v242, v162, v163, v242
    v_max3_f32 v243, v164, v165, v243
    v_max3_f32 v242, v166, v167, v242
    v_max3_f32 v243, v168, v169, v243
    v_exp_f32 v122, v122
    v_mfma_f32_32x32x16_bf16 v[106:121], v[66:69], v[86:89], v[186:201]
    v_exp_f32 v123, v123
    v_exp_f32 v124, v124
    v_exp_f32 v125, v125
    v_mfma_f32_32x32x16_bf16 v[106:121], v[64:67], v[82:85], v[106:121]
    v_exp_f32 v126, v126
    v_exp_f32 v127, v127
    v_exp_f32 v128, v128
    v_exp_f32 v129, v129
    v_exp_f32 v130, v130
    v_exp_f32 v131, v131
    v_exp_f32 v132, v132
    v_exp_f32 v133, v133
    v_exp_f32 v134, v134
    v_exp_f32 v135, v135
    v_exp_f32 v136, v136
    v_exp_f32 v137, v137
    v_cvt_pk_bf16_f32 v122, v122, v123
    v_cvt_pk_bf16_f32 v123, v124, v125
    v_cvt_pk_bf16_f32 v124, v126, v127
    v_cvt_pk_bf16_f32 v125, v128, v129
    v_cvt_pk_bf16_f32 v126, v130, v131
    v_cvt_pk_bf16_f32 v127, v132, v133
    s_waitcnt vmcnt(14)
    v_mfma_f32_32x32x16_bf16 v[218:233], a[56:59], v[122:125], v[218:233]
    v_cvt_pk_bf16_f32 v128, v134, v135
    v_cvt_pk_bf16_f32 v129, v136, v137
    v_max3_f32 v242, v170, v171, v242
    v_max3_f32 v243, v172, v173, v243
    v_max3_f32 v242, v174, v175, v242
    v_max3_f32 v243, v176, v177, v243
    s_waitcnt vmcnt(12)
    v_mfma_f32_32x32x16_bf16 v[218:233], a[60:63], v[126:129], v[218:233]
    s_barrier
    v_mov_b32 v254, 1
    buffer_atomic_add v254, v252, s[4:7], s3 offen
    buffer_atomic_add v254, v252, s[4:7], s88 offen
    s_mov_b32 s6, 81920
    v_max3_f32 v242, v178, v179, v242
    v_max3_f32 v243, v180, v181, v243
    v_max3_f32 v242, v182, v183, v242
    v_max3_f32 v243, v184, v185, v243
    v_cndmask_b32 v138, v138, v106, s[20:21]
    v_max_f32 v242, v242, v243
    v_cndmask_b32 v139, v139, v107, s[22:23]
    v_mov_b32 v243, v242
    v_cndmask_b32 v140, v140, v108, s[24:25]
    v_cndmask_b32 v141, v141, v109, s[26:27]
    v_permlane32_swap_b32 v242, v243
    global_load_dword v11, v10, s[86:87]
    v_cndmask_b32 v142, v142, v110, s[28:29]
    v_max_f32 v242, v242, v243
    v_cndmask_b32 v143, v143, v111, s[30:31]
    v_mul_f32 v202, -1.0, v242
    v_mul_f32 v203, -1.0, v242
    v_mul_f32 v204, -1.0, v242
    v_mul_f32 v205, -1.0, v242
    v_mul_f32 v206, -1.0, v242
    v_mul_f32 v207, -1.0, v242
    v_mul_f32 v208, -1.0, v242
    v_mul_f32 v209, -1.0, v242
    s_waitcnt vmcnt(6)
    v_mfma_f32_32x32x16_bf16 v[154:169], v[30:33], v[102:105], 0
    v_mul_f32 v210, -1.0, v242
    v_mul_f32 v211, -1.0, v242
    v_mul_f32 v212, -1.0, v242
    v_mul_f32 v213, -1.0, v242
    v_mul_f32 v214, -1.0, v242
    v_mul_f32 v215, -1.0, v242
    s_waitcnt vmcnt(3)
    v_mfma_f32_32x32x16_bf16 v[186:201], v[78:81], v[102:105], 0
    v_mul_f32 v216, -1.0, v242
    v_mul_f32 v217, -1.0, v242
    v_cndmask_b32 v144, v144, v112, s[32:33]
    v_cndmask_b32 v145, v145, v113, s[34:35]
    v_cndmask_b32 v146, v146, v114, s[36:37]
    v_cndmask_b32 v147, v147, v115, s[38:39]
    v_cndmask_b32 v148, v148, v116, s[46:47]
    v_cndmask_b32 v149, v149, v117, s[48:49]
    v_cndmask_b32 v150, v150, v118, s[50:51]
    v_cndmask_b32 v151, v151, v119, s[52:53]
    v_cndmask_b32 v152, v152, v120, s[54:55]
    v_mfma_f32_32x32x16_bf16 v[122:137], v[30:33], v[94:97], v[202:217]
    v_cndmask_b32 v153, v153, v121, s[56:57]
    v_exp_f32 v138, v138
    v_exp_f32 v139, v139
    v_exp_f32 v140, v140
    v_mfma_f32_32x32x16_bf16 v[122:137], v[28:31], v[90:93], v[122:137]
    v_exp_f32 v141, v141
    v_exp_f32 v142, v142
    v_exp_f32 v143, v143
    v_exp_f32 v144, v144
    v_exp_f32 v145, v145
    v_exp_f32 v146, v146
    v_exp_f32 v147, v147
    v_exp_f32 v148, v148
    v_exp_f32 v149, v149
    v_exp_f32 v150, v150
    v_exp_f32 v151, v151
    v_exp_f32 v152, v152
    v_exp_f32 v153, v153
    v_cvt_pk_bf16_f32 v138, v138, v139
    v_cvt_pk_bf16_f32 v139, v140, v141
    v_cvt_pk_bf16_f32 v140, v142, v143
    v_cvt_pk_bf16_f32 v141, v144, v145
    v_cvt_pk_bf16_f32 v142, v146, v147
    v_cvt_pk_bf16_f32 v143, v148, v149
    v_cvt_pk_bf16_f32 v144, v150, v151
    v_cvt_pk_bf16_f32 v145, v152, v153
    v_bfi_b32 v106, v234, 0, v138
    v_and_b32 v114, v234, v138
    v_bfi_b32 v107, v235, 0, v139
    v_mfma_f32_32x32x16_bf16 v[170:185], v[36:39], v[102:105], 0
    v_and_b32 v115, v235, v139
    v_bfi_b32 v108, v236, 0, v140
    v_and_b32 v116, v236, v140
    v_bfi_b32 v109, v237, 0, v141
    v_and_b32 v117, v237, v141
    v_bfi_b32 v110, v238, 0, v142
    v_mfma_f32_32x32x16_bf16 v[218:233], a[0:3], v[106:109], v[218:233]
    v_and_b32 v118, v238, v142
    v_bfi_b32 v111, v239, 0, v143
    v_and_b32 v119, v239, v143
    v_bfi_b32 v112, v240, 0, v144
    v_and_b32 v120, v240, v144
    v_bfi_b32 v113, v241, 0, v145
    v_and_b32 v121, v241, v145
    s_mul_i32 s63, s42, 36864
    v_mfma_f32_32x32x16_bf16 v[218:233], a[4:7], v[110:113], v[218:233]
    s_add_u32 s63, s63, 0
    s_mul_i32 s64, s42, 73728
    s_add_u32 s64, s64, 221184
    s_mul_i32 s65, s42, 73728
    s_add_u32 s65, s65, 258048
    s_mul_i32 s60, s42, 37376
    v_mfma_f32_32x32x16_bf16 v[218:233], a[64:67], v[114:117], v[218:233]
    s_add_u32 s60, s60, 74752
    v_and_or_b32 v98, v98, s58, v8
    v_and_b32 v99, s59, v99
    v_exp_f32 v122, v122
    v_exp_f32 v123, v123
    v_mfma_f32_32x32x16_bf16 v[218:233], a[68:71], v[118:121], v[218:233]
    v_exp_f32 v124, v124
    v_exp_f32 v125, v125
    v_exp_f32 v126, v126
    v_mfma_f32_32x32x16_bf16 v[154:169], v[28:31], v[98:101], v[154:169]
    v_exp_f32 v127, v127
    v_exp_f32 v128, v128
    v_exp_f32 v129, v129
    s_waitcnt vmcnt(2)
    v_mfma_f32_32x32x16_bf16 v[186:201], v[76:79], v[98:101], v[186:201]
    v_exp_f32 v130, v130
    s_nop 1
    v_rcp_f32 v244, v228
    v_exp_f32 v131, v131
    v_mfma_f32_32x32x16_bf16 v[170:185], v[34:37], v[98:101], v[170:185]
    v_mul_f32 v244, 0x40088e99, v244
    v_exp_f32 v132, v132
    v_mul_f32 v138, v218, v244
    v_mul_f32 v139, v219, v244
    v_mul_f32 v140, v220, v244
    v_mul_f32 v141, v221, v244
    v_mul_f32 v142, v222, v244
    v_mul_f32 v143, v223, v244
    v_mul_f32 v144, v224, v244
    v_mul_f32 v145, v225, v244
    v_mul_f32 v146, v226, v244
    v_mul_f32 v147, v227, v244
    v_cvt_pk_bf16_f32 v246, v138, v139
    v_cvt_pk_bf16_f32 v247, v140, v141
    v_cvt_pk_bf16_f32 v248, v142, v143
    v_cvt_pk_bf16_f32 v249, v144, v145
    v_cvt_pk_bf16_f32 v250, v146, v147
    v_mfma_f32_32x32x16_bf16 v[138:153], v[36:39], v[94:97], v[202:217]
    buffer_store_dwordx4 v[246:249], v6, s[16:19], s63 offen sc1
    v_cndmask_b32 v154, v154, v186, s[20:21]
    v_cndmask_b32 v155, v155, v187, s[22:23]
    v_cndmask_b32 v156, v156, v188, s[24:25]
    v_cndmask_b32 v157, v157, v189, s[26:27]
    v_cndmask_b32 v158, v158, v190, s[28:29]
    v_mfma_f32_32x32x16_bf16 v[138:153], v[34:37], v[90:93], v[138:153]
    v_cndmask_b32 v159, v159, v191, s[30:31]
    v_cndmask_b32 v160, v160, v192, s[32:33]
    v_cndmask_b32 v161, v161, v193, s[34:35]
    v_cndmask_b32 v162, v162, v194, s[36:37]
    buffer_store_dword v250, v7, s[16:19], s63 offen sc1
    v_cndmask_b32 v163, v163, v195, s[38:39]
    v_cndmask_b32 v164, v164, v196, s[46:47]
    v_cndmask_b32 v165, v165, v197, s[48:49]
    v_cndmask_b32 v166, v166, v198, s[50:51]
    v_cndmask_b32 v167, v167, v199, s[52:53]
    v_cndmask_b32 v168, v168, v200, s[54:55]
    v_cndmask_b32 v169, v169, v201, s[56:57]
    v_max3_f32 v242, v154, v155, v156
    v_max3_f32 v243, v157, v158, v159
    v_max3_f32 v242, v160, v161, v242
    v_max3_f32 v243, v162, v163, v243
    buffer_load_dwordx2 v[86:87], v2, s[8:11], s64 offen sc1
    v_max3_f32 v242, v164, v165, v242
    v_max3_f32 v243, v166, v167, v243
    v_max3_f32 v242, v168, v169, v242
    v_mfma_f32_32x32x16_bf16 v[154:169], v[42:45], v[102:105], 0
    v_exp_f32 v133, v133
    v_exp_f32 v134, v134
    v_exp_f32 v135, v135
    v_mfma_f32_32x32x16_bf16 v[154:169], v[40:43], v[98:101], v[154:169]
    buffer_load_dwordx2 v[88:89], v2, s[8:11], s64 offen offset:256 sc1
    v_exp_f32 v136, v136
    v_exp_f32 v137, v137
    v_cvt_pk_bf16_f32 v122, v122, v123
    v_cvt_pk_bf16_f32 v123, v124, v125
    v_cvt_pk_bf16_f32 v124, v126, v127
    v_cvt_pk_bf16_f32 v125, v128, v129
    v_cvt_pk_bf16_f32 v126, v130, v131
    v_cvt_pk_bf16_f32 v127, v132, v133
    v_mfma_f32_32x32x16_bf16 v[218:233], a[16:19], v[122:125], 0
    buffer_load_dwordx2 v[82:83], v3, s[8:11], s64 offen sc1
    v_cvt_pk_bf16_f32 v128, v134, v135
    v_cvt_pk_bf16_f32 v129, v136, v137
    v_max3_f32 v242, v170, v171, v242
    v_max3_f32 v243, v172, v173, v243
    v_max3_f32 v242, v174, v175, v242
    v_mfma_f32_32x32x16_bf16 v[218:233], a[20:23], v[126:129], v[218:233]
    v_max3_f32 v243, v176, v177, v243
    v_max3_f32 v242, v178, v179, v242
    v_max3_f32 v243, v180, v181, v243
    v_max3_f32 v242, v182, v183, v242
    buffer_load_dwordx2 v[18:19], v2, s[8:11], s65 offen sc1
    v_max3_f32 v243, v184, v185, v243
    v_exp_f32 v138, v138
    v_exp_f32 v139, v139
    v_exp_f32 v140, v140
    v_exp_f32 v141, v141
    v_exp_f32 v142, v142
    buffer_load_dwordx2 v[20:21], v2, s[8:11], s65 offen offset:256 sc1
    v_exp_f32 v143, v143
    v_exp_f32 v144, v144
    v_exp_f32 v145, v145
    v_exp_f32 v146, v146
    v_exp_f32 v147, v147
    v_exp_f32 v148, v148
    buffer_load_dwordx2 v[16:17], v3, s[8:11], s65 offen sc1
    v_mfma_f32_32x32x16_bf16 v[106:121], v[42:45], v[94:97], v[202:217]
    v_exp_f32 v149, v149
    v_exp_f32 v150, v150
    v_exp_f32 v151, v151
    v_mfma_f32_32x32x16_bf16 v[106:121], v[40:43], v[90:93], v[106:121]
    v_exp_f32 v152, v152
    buffer_load_dwordx4 a[80:83], v4, s[12:15], s60 offen sc1
    v_exp_f32 v153, v153
    v_cvt_pk_bf16_f32 v138, v138, v139
    v_cvt_pk_bf16_f32 v139, v140, v141
    v_cvt_pk_bf16_f32 v140, v142, v143
    v_cvt_pk_bf16_f32 v141, v144, v145
    v_cvt_pk_bf16_f32 v142, v146, v147
    v_cvt_pk_bf16_f32 v143, v148, v149
    v_mfma_f32_32x32x16_bf16 v[218:233], a[24:27], v[138:141], v[218:233]
    v_cvt_pk_bf16_f32 v144, v150, v151
    buffer_load_dwordx4 a[84:87], v5, s[12:15], s60 offen sc1
    v_cvt_pk_bf16_f32 v145, v152, v153
    v_max3_f32 v242, v154, v155, v242
    v_max3_f32 v243, v156, v157, v243
    v_max3_f32 v242, v158, v159, v242
    v_mfma_f32_32x32x16_bf16 v[218:233], a[28:31], v[142:145], v[218:233]
    v_max3_f32 v243, v160, v161, v243
    v_max3_f32 v242, v162, v163, v242
    v_max3_f32 v243, v164, v165, v243
    v_max3_f32 v242, v166, v167, v242
    v_max3_f32 v243, v168, v169, v243
    v_exp_f32 v106, v106
    v_mfma_f32_32x32x16_bf16 v[170:185], v[48:51], v[102:105], 0
    v_exp_f32 v107, v107
    v_exp_f32 v108, v108
    v_exp_f32 v109, v109
    v_mfma_f32_32x32x16_bf16 v[170:185], v[46:49], v[98:101], v[170:185]
    v_exp_f32 v110, v110
    v_exp_f32 v111, v111
    v_exp_f32 v112, v112
    v_mfma_f32_32x32x16_bf16 v[122:137], v[48:51], v[94:97], v[202:217]
    v_exp_f32 v113, v113
    v_exp_f32 v114, v114
    v_exp_f32 v115, v115
    v_mfma_f32_32x32x16_bf16 v[122:137], v[46:49], v[90:93], v[122:137]
    v_exp_f32 v116, v116
    v_exp_f32 v117, v117
    v_exp_f32 v118, v118
    v_mfma_f32_32x32x16_bf16 v[154:169], v[54:57], v[102:105], 0
    v_exp_f32 v119, v119
    v_exp_f32 v120, v120
    v_exp_f32 v121, v121
    v_mfma_f32_32x32x16_bf16 v[154:169], v[52:55], v[98:101], v[154:169]
    v_cvt_pk_bf16_f32 v106, v106, v107
    v_cvt_pk_bf16_f32 v107, v108, v109
    v_cvt_pk_bf16_f32 v108, v110, v111
    v_cvt_pk_bf16_f32 v109, v112, v113
    v_cvt_pk_bf16_f32 v110, v114, v115
    v_cvt_pk_bf16_f32 v111, v116, v117
    v_mfma_f32_32x32x16_bf16 v[218:233], a[32:35], v[106:109], v[218:233]
    v_cvt_pk_bf16_f32 v112, v118, v119
    v_cvt_pk_bf16_f32 v113, v120, v121
    v_max3_f32 v242, v170, v171, v242
    v_max3_f32 v243, v172, v173, v243
    v_max3_f32 v242, v174, v175, v242
    v_max3_f32 v243, v176, v177, v243
    v_mfma_f32_32x32x16_bf16 v[218:233], a[36:39], v[110:113], v[218:233]
    v_max3_f32 v242, v178, v179, v242
    v_max3_f32 v243, v180, v181, v243
    v_max3_f32 v242, v182, v183, v242
    v_max3_f32 v243, v184, v185, v243
    v_exp_f32 v122, v122
    v_mfma_f32_32x32x16_bf16 v[138:153], v[54:57], v[94:97], v[202:217]
    v_exp_f32 v123, v123
    v_exp_f32 v124, v124
    v_exp_f32 v125, v125
    v_mfma_f32_32x32x16_bf16 v[138:153], v[52:55], v[90:93], v[138:153]
    v_exp_f32 v126, v126
    v_exp_f32 v127, v127
    v_exp_f32 v128, v128
    v_mfma_f32_32x32x16_bf16 v[170:185], v[60:63], v[102:105], 0
    v_exp_f32 v129, v129
    v_exp_f32 v130, v130
    v_exp_f32 v131, v131
    v_mfma_f32_32x32x16_bf16 v[170:185], v[58:61], v[98:101], v[170:185]
    v_exp_f32 v132, v132
    v_exp_f32 v133, v133
    v_exp_f32 v134, v134
    v_mfma_f32_32x32x16_bf16 v[106:121], v[60:63], v[94:97], v[202:217]
    v_exp_f32 v135, v135
    v_exp_f32 v136, v136
    v_exp_f32 v137, v137
    v_mfma_f32_32x32x16_bf16 v[106:121], v[58:61], v[90:93], v[106:121]
    v_cvt_pk_bf16_f32 v122, v122, v123
    v_cvt_pk_bf16_f32 v123, v124, v125
    v_cvt_pk_bf16_f32 v124, v126, v127
    v_cvt_pk_bf16_f32 v125, v128, v129
    v_cvt_pk_bf16_f32 v126, v130, v131
    v_cvt_pk_bf16_f32 v127, v132, v133
    v_mfma_f32_32x32x16_bf16 v[218:233], a[40:43], v[122:125], v[218:233]
    v_cvt_pk_bf16_f32 v128, v134, v135
    v_cvt_pk_bf16_f32 v129, v136, v137
    v_max3_f32 v242, v154, v155, v242
    v_max3_f32 v243, v156, v157, v243
    v_max3_f32 v242, v158, v159, v242
    v_max3_f32 v243, v160, v161, v243
    v_mfma_f32_32x32x16_bf16 v[218:233], a[44:47], v[126:129], v[218:233]
    v_max3_f32 v242, v162, v163, v242
    v_max3_f32 v243, v164, v165, v243
    v_max3_f32 v242, v166, v167, v242
    v_max3_f32 v243, v168, v169, v243
    v_exp_f32 v138, v138
    v_mfma_f32_32x32x16_bf16 v[154:169], v[66:69], v[102:105], 0
    v_exp_f32 v139, v139
    v_exp_f32 v140, v140
    v_exp_f32 v141, v141
    v_mfma_f32_32x32x16_bf16 v[154:169], v[64:67], v[98:101], v[154:169]
    v_exp_f32 v142, v142
    v_exp_f32 v143, v143
    v_exp_f32 v144, v144
    v_mfma_f32_32x32x16_bf16 v[122:137], v[66:69], v[94:97], v[202:217]
    v_exp_f32 v145, v145
    v_exp_f32 v146, v146
    v_exp_f32 v147, v147
    v_mfma_f32_32x32x16_bf16 v[122:137], v[64:67], v[90:93], v[122:137]
    v_exp_f32 v148, v148
    v_exp_f32 v149, v149
    v_exp_f32 v150, v150
    v_exp_f32 v151, v151
    v_exp_f32 v152, v152
    v_exp_f32 v153, v153
    v_cvt_pk_bf16_f32 v138, v138, v139
    v_cvt_pk_bf16_f32 v139, v140, v141
    v_cvt_pk_bf16_f32 v140, v142, v143
    v_cvt_pk_bf16_f32 v141, v144, v145
    v_cvt_pk_bf16_f32 v142, v146, v147
    v_cvt_pk_bf16_f32 v143, v148, v149
    v_mfma_f32_32x32x16_bf16 v[218:233], a[48:51], v[138:141], v[218:233]
    v_cvt_pk_bf16_f32 v144, v150, v151
    v_cvt_pk_bf16_f32 v145, v152, v153
    v_max3_f32 v242, v170, v171, v242
    v_max3_f32 v243, v172, v173, v243
    v_max3_f32 v242, v174, v175, v242
    v_max3_f32 v243, v176, v177, v243
    v_mfma_f32_32x32x16_bf16 v[218:233], a[52:55], v[142:145], v[218:233]
    v_max3_f32 v242, v178, v179, v242
    v_max3_f32 v243, v180, v181, v243
    v_max3_f32 v242, v182, v183, v242
    v_max3_f32 v243, v184, v185, v243
    v_exp_f32 v106, v106
    v_mfma_f32_32x32x16_bf16 v[170:185], v[72:75], v[102:105], 0
    v_exp_f32 v107, v107
    v_exp_f32 v108, v108
    v_exp_f32 v109, v109
    v_mfma_f32_32x32x16_bf16 v[170:185], v[70:73], v[98:101], v[170:185]
    v_exp_f32 v110, v110
    v_exp_f32 v111, v111
    v_exp_f32 v112, v112
    v_mfma_f32_32x32x16_bf16 v[138:153], v[24:27], v[94:97], v[202:217]
    v_exp_f32 v113, v113
    v_exp_f32 v114, v114
    v_exp_f32 v115, v115
    v_mfma_f32_32x32x16_bf16 v[138:153], v[22:25], v[90:93], v[138:153]
    v_exp_f32 v116, v116
    v_exp_f32 v117, v117
    v_exp_f32 v118, v118
    v_exp_f32 v119, v119
    v_exp_f32 v120, v120
    v_exp_f32 v121, v121
    v_cvt_pk_bf16_f32 v106, v106, v107
    v_cvt_pk_bf16_f32 v107, v108, v109
    v_cvt_pk_bf16_f32 v108, v110, v111
    v_cvt_pk_bf16_f32 v109, v112, v113
    v_cvt_pk_bf16_f32 v110, v114, v115
    v_cvt_pk_bf16_f32 v111, v116, v117
    v_mfma_f32_32x32x16_bf16 v[218:233], a[56:59], v[106:109], v[218:233]
    v_cvt_pk_bf16_f32 v112, v118, v119
    v_cvt_pk_bf16_f32 v113, v120, v121
    v_max3_f32 v242, v154, v155, v242
    v_max3_f32 v243, v156, v157, v243
    v_max3_f32 v242, v158, v159, v242
    v_max3_f32 v243, v160, v161, v243
    v_mfma_f32_32x32x16_bf16 v[218:233], a[60:63], v[110:113], v[218:233]
    v_max3_f32 v242, v162, v163, v242
    v_max3_f32 v243, v164, v165, v243
    v_max3_f32 v242, v166, v167, v242
    v_max3_f32 v243, v168, v169, v243
    v_exp_f32 v122, v122
    v_mfma_f32_32x32x16_bf16 v[106:121], v[72:75], v[94:97], v[202:217]
    v_exp_f32 v123, v123
    v_exp_f32 v124, v124
    v_exp_f32 v125, v125
    v_mfma_f32_32x32x16_bf16 v[106:121], v[70:73], v[90:93], v[106:121]
    v_exp_f32 v126, v126
    v_exp_f32 v127, v127
    v_exp_f32 v128, v128
    v_exp_f32 v129, v129
    v_exp_f32 v130, v130
    v_exp_f32 v131, v131
    v_exp_f32 v132, v132
    v_exp_f32 v133, v133
    v_exp_f32 v134, v134
    v_exp_f32 v135, v135
    v_exp_f32 v136, v136
    v_exp_f32 v137, v137
    v_cvt_pk_bf16_f32 v122, v122, v123
    v_cvt_pk_bf16_f32 v123, v124, v125
    v_cvt_pk_bf16_f32 v124, v126, v127
    v_cvt_pk_bf16_f32 v125, v128, v129
    v_cvt_pk_bf16_f32 v126, v130, v131
    v_cvt_pk_bf16_f32 v127, v132, v133
    v_mfma_f32_32x32x16_bf16 v[218:233], a[64:67], v[122:125], v[218:233]
    v_cvt_pk_bf16_f32 v128, v134, v135
    v_cvt_pk_bf16_f32 v129, v136, v137
    v_max3_f32 v242, v170, v171, v242
    v_max3_f32 v243, v172, v173, v243
    v_max3_f32 v242, v174, v175, v242
    v_max3_f32 v243, v176, v177, v243
    v_mfma_f32_32x32x16_bf16 v[218:233], a[68:71], v[126:129], v[218:233]
    v_max3_f32 v242, v178, v179, v242
    v_max3_f32 v243, v180, v181, v243
    v_max3_f32 v242, v182, v183, v242
    v_max3_f32 v243, v184, v185, v243
    v_cndmask_b32 v138, v138, v106, s[20:21]
    v_max_f32 v242, v242, v243
    v_cndmask_b32 v139, v139, v107, s[22:23]
    v_mov_b32 v243, v242
    v_cndmask_b32 v140, v140, v108, s[24:25]
    v_cndmask_b32 v141, v141, v109, s[26:27]
    v_permlane32_swap_b32 v242, v243
    global_load_dword v11, v10, s[86:87]
    v_cndmask_b32 v142, v142, v110, s[28:29]
    v_max_f32 v242, v242, v243
    v_cndmask_b32 v143, v143, v111, s[30:31]
    v_mul_f32 v186, -1.0, v242
    v_mul_f32 v187, -1.0, v242
    v_mul_f32 v188, -1.0, v242
    v_mul_f32 v189, -1.0, v242
    v_mul_f32 v190, -1.0, v242
    v_mul_f32 v191, -1.0, v242
    v_mul_f32 v192, -1.0, v242
    v_mul_f32 v193, -1.0, v242
    s_waitcnt vmcnt(6)
    v_mfma_f32_32x32x16_bf16 v[154:169], v[36:39], v[86:89], 0
    v_mul_f32 v194, -1.0, v242
    v_mul_f32 v195, -1.0, v242
    v_mul_f32 v196, -1.0, v242
    v_mul_f32 v197, -1.0, v242
    v_mul_f32 v198, -1.0, v242
    v_mul_f32 v199, -1.0, v242
    s_waitcnt vmcnt(3)
    v_mfma_f32_32x32x16_bf16 v[202:217], v[18:21], v[86:89], 0
    v_mul_f32 v200, -1.0, v242
    v_mul_f32 v201, -1.0, v242
    v_cndmask_b32 v144, v144, v112, s[32:33]
    v_cndmask_b32 v145, v145, v113, s[34:35]
    v_cndmask_b32 v146, v146, v114, s[36:37]
    v_cndmask_b32 v147, v147, v115, s[38:39]
    v_cndmask_b32 v148, v148, v116, s[46:47]
    v_cndmask_b32 v149, v149, v117, s[48:49]
    v_cndmask_b32 v150, v150, v118, s[50:51]
    v_cndmask_b32 v151, v151, v119, s[52:53]
    v_cndmask_b32 v152, v152, v120, s[54:55]
    v_mfma_f32_32x32x16_bf16 v[122:137], v[36:39], v[102:105], v[186:201]
    v_cndmask_b32 v153, v153, v121, s[56:57]
    v_exp_f32 v138, v138
    buffer_load_dword v253, v252, s[4:7], s3 offen sc1
    v_exp_f32 v139, v139
    v_exp_f32 v140, v140
    v_mfma_f32_32x32x16_bf16 v[122:137], v[34:37], v[98:101], v[122:137]
    v_exp_f32 v141, v141
    v_exp_f32 v142, v142
    v_exp_f32 v143, v143
    v_exp_f32 v144, v144
    v_exp_f32 v145, v145
    v_exp_f32 v146, v146
    v_exp_f32 v147, v147
    v_exp_f32 v148, v148
    v_exp_f32 v149, v149
    v_exp_f32 v150, v150
    v_exp_f32 v151, v151
    v_exp_f32 v152, v152
    v_exp_f32 v153, v153
    v_cvt_pk_bf16_f32 v138, v138, v139
    v_cvt_pk_bf16_f32 v139, v140, v141
    v_cvt_pk_bf16_f32 v140, v142, v143
    v_cvt_pk_bf16_f32 v141, v144, v145
    v_cvt_pk_bf16_f32 v142, v146, v147
    v_cvt_pk_bf16_f32 v143, v148, v149
    v_cvt_pk_bf16_f32 v144, v150, v151
    v_cvt_pk_bf16_f32 v145, v152, v153
    v_bfi_b32 v106, v234, 0, v138
    v_and_b32 v114, v234, v138
    v_bfi_b32 v107, v235, 0, v139
    v_mfma_f32_32x32x16_bf16 v[170:185], v[42:45], v[86:89], 0
    v_and_b32 v115, v235, v139
    v_bfi_b32 v108, v236, 0, v140
    v_and_b32 v116, v236, v140
    v_bfi_b32 v109, v237, 0, v141
    v_and_b32 v117, v237, v141
    v_bfi_b32 v110, v238, 0, v142
    v_mfma_f32_32x32x16_bf16 v[218:233], a[8:11], v[106:109], v[218:233]
    v_and_b32 v118, v238, v142
    v_bfi_b32 v111, v239, 0, v143
    v_and_b32 v119, v239, v143
    v_bfi_b32 v112, v240, 0, v144
    v_and_b32 v120, v240, v144
    v_bfi_b32 v113, v241, 0, v145
    v_and_b32 v121, v241, v145
    s_mul_i32 s61, s42, 36864
    v_mfma_f32_32x32x16_bf16 v[218:233], a[12:15], v[110:113], v[218:233]
    s_add_u32 s61, s61, 36864
    s_mul_i32 s62, s42, 73728
    s_add_u32 s62, s62, 294912
    s_mul_i32 s63, s42, 73728
    s_add_u32 s63, s63, 331776
    s_mul_i32 s64, s42, 37376
    v_mfma_f32_32x32x16_bf16 v[218:233], a[72:75], v[114:117], v[218:233]
    s_add_u32 s64, s64, 112128
    v_and_or_b32 v82, v82, s58, v8
    v_and_b32 v83, s59, v83
    v_exp_f32 v122, v122
    v_exp_f32 v123, v123
    v_mfma_f32_32x32x16_bf16 v[218:233], a[76:79], v[118:121], v[218:233]
    v_exp_f32 v124, v124
    v_exp_f32 v125, v125
    v_exp_f32 v126, v126
    v_mfma_f32_32x32x16_bf16 v[154:169], v[34:37], v[82:85], v[154:169]
    v_exp_f32 v127, v127
    v_exp_f32 v128, v128
    v_exp_f32 v129, v129
    s_waitcnt vmcnt(3)
    v_mfma_f32_32x32x16_bf16 v[202:217], v[16:19], v[82:85], v[202:217]
    v_exp_f32 v130, v130
    s_nop 1
    v_rcp_f32 v244, v228
    v_exp_f32 v131, v131
    v_mfma_f32_32x32x16_bf16 v[170:185], v[40:43], v[82:85], v[170:185]
    v_mul_f32 v244, 0x40088e99, v244
    v_exp_f32 v132, v132
    v_mul_f32 v138, v218, v244
    v_mul_f32 v139, v219, v244
    v_mul_f32 v140, v220, v244
    v_mul_f32 v141, v221, v244
    v_mul_f32 v142, v222, v244
    v_mul_f32 v143, v223, v244
    v_mul_f32 v144, v224, v244
    v_mul_f32 v145, v225, v244
    v_mul_f32 v146, v226, v244
    v_mul_f32 v147, v227, v244
    v_cvt_pk_bf16_f32 v246, v138, v139
    v_cvt_pk_bf16_f32 v247, v140, v141
    v_cvt_pk_bf16_f32 v248, v142, v143
    v_cvt_pk_bf16_f32 v249, v144, v145
    v_cvt_pk_bf16_f32 v250, v146, v147
    v_mfma_f32_32x32x16_bf16 v[138:153], v[42:45], v[102:105], v[186:201]
    buffer_store_dwordx4 v[246:249], v6, s[16:19], s61 offen sc1
    v_cndmask_b32 v154, v154, v202, s[20:21]
    v_cndmask_b32 v155, v155, v203, s[22:23]
    v_cndmask_b32 v156, v156, v204, s[24:25]
    v_cndmask_b32 v157, v157, v205, s[26:27]
    v_cndmask_b32 v158, v158, v206, s[28:29]
    v_mfma_f32_32x32x16_bf16 v[138:153], v[40:43], v[98:101], v[138:153]
    v_cndmask_b32 v159, v159, v207, s[30:31]
    v_cndmask_b32 v160, v160, v208, s[32:33]
    v_cndmask_b32 v161, v161, v209, s[34:35]
    v_cndmask_b32 v162, v162, v210, s[36:37]
    buffer_store_dword v250, v7, s[16:19], s61 offen sc1
    v_cndmask_b32 v163, v163, v211, s[38:39]
    v_cndmask_b32 v164, v164, v212, s[46:47]
    v_cndmask_b32 v165, v165, v213, s[48:49]
    v_cndmask_b32 v166, v166, v214, s[50:51]
    v_cndmask_b32 v167, v167, v215, s[52:53]
    v_cndmask_b32 v168, v168, v216, s[54:55]
    v_cndmask_b32 v169, v169, v217, s[56:57]
    v_max3_f32 v242, v154, v155, v156
    v_max3_f32 v243, v157, v158, v159
    v_max3_f32 v242, v160, v161, v242
    v_max3_f32 v243, v162, v163, v243
    buffer_load_dwordx2 v[94:95], v2, s[8:11], s62 offen sc1
    v_max3_f32 v242, v164, v165, v242
    v_max3_f32 v243, v166, v167, v243
    v_max3_f32 v242, v168, v169, v242
    v_mfma_f32_32x32x16_bf16 v[154:169], v[48:51], v[86:89], 0
    v_exp_f32 v133, v133
    v_exp_f32 v134, v134
    v_exp_f32 v135, v135
    v_mfma_f32_32x32x16_bf16 v[154:169], v[46:49], v[82:85], v[154:169]
    buffer_load_dwordx2 v[96:97], v2, s[8:11], s62 offen offset:256 sc1
    v_exp_f32 v136, v136
    v_exp_f32 v137, v137
    v_cvt_pk_bf16_f32 v122, v122, v123
    v_cvt_pk_bf16_f32 v123, v124, v125
    v_cvt_pk_bf16_f32 v124, v126, v127
    v_cvt_pk_bf16_f32 v125, v128, v129
    v_cvt_pk_bf16_f32 v126, v130, v131
    v_cvt_pk_bf16_f32 v127, v132, v133
    v_mfma_f32_32x32x16_bf16 v[218:233], a[24:27], v[122:125], 0
    buffer_load_dwordx2 v[90:91], v3, s[8:11], s62 offen sc1
    v_cvt_pk_bf16_f32 v128, v134, v135
    v_cvt_pk_bf16_f32 v129, v136, v137
    v_max3_f32 v242, v170, v171, v242
    v_max3_f32 v243, v172, v173, v243
    v_max3_f32 v242, v174, v175, v242
    v_mfma_f32_32x32x16_bf16 v[218:233], a[28:31], v[126:129], v[218:233]
    v_max3_f32 v243, v176, v177, v243
    v_max3_f32 v242, v178, v179, v242
    v_max3_f32 v243, v180, v181, v243
    v_max3_f32 v242, v182, v183, v242
    buffer_load_dwordx2 v[24:25], v2, s[8:11], s63 offen sc1
    v_max3_f32 v243, v184, v185, v243
    v_exp_f32 v138, v138
    v_exp_f32 v139, v139
    v_exp_f32 v140, v140
    v_exp_f32 v141, v141
    v_exp_f32 v142, v142
    buffer_load_dwordx2 v[26:27], v2, s[8:11], s63 offen offset:256 sc1
    v_exp_f32 v143, v143
    v_exp_f32 v144, v144
    v_exp_f32 v145, v145
    v_exp_f32 v146, v146
    v_exp_f32 v147, v147
    v_exp_f32 v148, v148
    buffer_load_dwordx2 v[22:23], v3, s[8:11], s63 offen sc1
    v_mfma_f32_32x32x16_bf16 v[106:121], v[48:51], v[102:105], v[186:201]
    v_exp_f32 v149, v149
    v_exp_f32 v150, v150
    v_exp_f32 v151, v151
    v_mfma_f32_32x32x16_bf16 v[106:121], v[46:49], v[98:101], v[106:121]
    v_exp_f32 v152, v152
    buffer_load_dwordx4 a[88:91], v4, s[12:15], s64 offen sc1
    v_exp_f32 v153, v153
    v_cvt_pk_bf16_f32 v138, v138, v139
    v_cvt_pk_bf16_f32 v139, v140, v141
    v_cvt_pk_bf16_f32 v140, v142, v143
    v_cvt_pk_bf16_f32 v141, v144, v145
    v_cvt_pk_bf16_f32 v142, v146, v147
    v_cvt_pk_bf16_f32 v143, v148, v149
    v_mfma_f32_32x32x16_bf16 v[218:233], a[32:35], v[138:141], v[218:233]
    v_cvt_pk_bf16_f32 v144, v150, v151
    buffer_load_dwordx4 a[92:95], v5, s[12:15], s64 offen sc1
    v_cvt_pk_bf16_f32 v145, v152, v153
    v_max3_f32 v242, v154, v155, v242
    v_max3_f32 v243, v156, v157, v243
    v_max3_f32 v242, v158, v159, v242
    v_mfma_f32_32x32x16_bf16 v[218:233], a[36:39], v[142:145], v[218:233]
    v_max3_f32 v243, v160, v161, v243
    v_max3_f32 v242, v162, v163, v242
    v_max3_f32 v243, v164, v165, v243
    v_max3_f32 v242, v166, v167, v242
    v_max3_f32 v243, v168, v169, v243
    v_exp_f32 v106, v106
    v_mfma_f32_32x32x16_bf16 v[170:185], v[54:57], v[86:89], 0
    v_exp_f32 v107, v107
    v_exp_f32 v108, v108
    v_exp_f32 v109, v109
    v_mfma_f32_32x32x16_bf16 v[170:185], v[52:55], v[82:85], v[170:185]
    v_exp_f32 v110, v110
    v_exp_f32 v111, v111
    v_exp_f32 v112, v112
    v_mfma_f32_32x32x16_bf16 v[122:137], v[54:57], v[102:105], v[186:201]
    v_exp_f32 v113, v113
    v_exp_f32 v114, v114
    v_exp_f32 v115, v115
    v_mfma_f32_32x32x16_bf16 v[122:137], v[52:55], v[98:101], v[122:137]
    v_exp_f32 v116, v116
    v_exp_f32 v117, v117
    v_exp_f32 v118, v118
    v_mfma_f32_32x32x16_bf16 v[154:169], v[60:63], v[86:89], 0
    v_exp_f32 v119, v119
    v_exp_f32 v120, v120
    v_exp_f32 v121, v121
    v_mfma_f32_32x32x16_bf16 v[154:169], v[58:61], v[82:85], v[154:169]
    v_cvt_pk_bf16_f32 v106, v106, v107
    v_cvt_pk_bf16_f32 v107, v108, v109
    s_waitcnt vmcnt(10)
    s_mov_b32 s45, 0
k1_kernel_pl22:
    v_bfe_u32 v253, v253, 0, 8
    v_cmp_gt_u32 vcc, 64, v253
    s_add_u32 s45, s45, 1
    s_and_b32 vcc_lo, vcc_lo, 1
    s_cbranch_scc0 k1_kernel_pd23
    s_cmp_ge_u32 s45, 200000
    s_cbranch_scc1 k1_kernel_pd23
    s_sleep 4
    v_mov_b32 v253, 0
    buffer_atomic_add v253, v252, s[4:7], s3 offen sc0
    s_waitcnt vmcnt(0)
    s_branch k1_kernel_pl22
k1_kernel_pd23:
    v_cvt_pk_bf16_f32 v108, v110, v111
    v_cvt_pk_bf16_f32 v109, v112, v113
    v_cvt_pk_bf16_f32 v110, v114, v115
    v_cvt_pk_bf16_f32 v111, v116, v117
    v_mfma_f32_32x32x16_bf16 v[218:233], a[40:43], v[106:109], v[218:233]
    v_cvt_pk_bf16_f32 v112, v118, v119
    v_cvt_pk_bf16_f32 v113, v120, v121
    v_max3_f32 v242, v170, v171, v242
    v_max3_f32 v243, v172, v173, v243
    v_max3_f32 v242, v174, v175, v242
    v_max3_f32 v243, v176, v177, v243
    v_mfma_f32_32x32x16_bf16 v[218:233], a[44:47], v[110:113], v[218:233]
    v_max3_f32 v242, v178, v179, v242
    v_max3_f32 v243, v180, v181, v243
    v_max3_f32 v242, v182, v183, v242
    v_max3_f32 v243, v184, v185, v243
    v_exp_f32 v122, v122
    v_mfma_f32_32x32x16_bf16 v[138:153], v[60:63], v[102:105], v[186:201]
    v_exp_f32 v123, v123
    v_exp_f32 v124, v124
    v_exp_f32 v125, v125
    v_mfma_f32_32x32x16_bf16 v[138:153], v[58:61], v[98:101], v[138:153]
    v_exp_f32 v126, v126
    v_exp_f32 v127, v127
    v_exp_f32 v128, v128
    v_mfma_f32_32x32x16_bf16 v[170:185], v[66:69], v[86:89], 0
    v_exp_f32 v129, v129
    v_exp_f32 v130, v130
    v_exp_f32 v131, v131
    v_mfma_f32_32x32x16_bf16 v[170:185], v[64:67], v[82:85], v[170:185]
    v_exp_f32 v132, v132
    v_exp_f32 v133, v133
    v_exp_f32 v134, v134
    v_mfma_f32_32x32x16_bf16 v[106:121], v[66:69], v[102:105], v[186:201]
    v_exp_f32 v135, v135
    v_exp_f32 v136, v136
    v_exp_f32 v137, v137
    v_mfma_f32_32x32x16_bf16 v[106:121], v[64:67], v[98:101], v[106:121]
    v_cvt_pk_bf16_f32 v122, v122, v123
    v_cvt_pk_bf16_f32 v123, v124, v125
    v_cvt_pk_bf16_f32 v124, v126, v127
    v_cvt_pk_bf16_f32 v125, v128, v129
    v_cvt_pk_bf16_f32 v126, v130, v131
    v_cvt_pk_bf16_f32 v127, v132, v133
    v_mfma_f32_32x32x16_bf16 v[218:233], a[48:51], v[122:125], v[218:233]
    v_cvt_pk_bf16_f32 v128, v134, v135
    v_cvt_pk_bf16_f32 v129, v136, v137
    v_max3_f32 v242, v154, v155, v242
    v_max3_f32 v243, v156, v157, v243
    v_max3_f32 v242, v158, v159, v242
    v_max3_f32 v243, v160, v161, v243
    v_mfma_f32_32x32x16_bf16 v[218:233], a[52:55], v[126:129], v[218:233]
    s_add_u32 m0, s101, 0
    s_nop 0
    buffer_load_dwordx4 v255, s[96:99], s100 offen offset:0 sc1 lds
    v_max3_f32 v242, v162, v163, v242
    v_max3_f32 v243, v164, v165, v243
    v_max3_f32 v242, v166, v167, v242
    v_max3_f32 v243, v168, v169, v243
    v_exp_f32 v138, v138
    v_mfma_f32_32x32x16_bf16 v[154:169], v[72:75], v[86:89], 0
    v_exp_f32 v139, v139
    v_exp_f32 v140, v140
    v_exp_f32 v141, v141
    v_mfma_f32_32x32x16_bf16 v[154:169], v[70:73], v[82:85], v[154:169]
    v_exp_f32 v142, v142
    v_exp_f32 v143, v143
    v_exp_f32 v144, v144
    v_mfma_f32_32x32x16_bf16 v[122:137], v[72:75], v[102:105], v[186:201]
    v_exp_f32 v145, v145
    v_exp_f32 v146, v146
    v_exp_f32 v147, v147
    v_mfma_f32_32x32x16_bf16 v[122:137], v[70:73], v[98:101], v[122:137]
    v_exp_f32 v148, v148
    v_exp_f32 v149, v149
    v_exp_f32 v150, v150
    v_exp_f32 v151, v151
    v_exp_f32 v152, v152
    v_exp_f32 v153, v153
    v_cvt_pk_bf16_f32 v138, v138, v139
    v_cvt_pk_bf16_f32 v139, v140, v141
    v_cvt_pk_bf16_f32 v140, v142, v143
    v_cvt_pk_bf16_f32 v141, v144, v145
    v_cvt_pk_bf16_f32 v142, v146, v147
    v_cvt_pk_bf16_f32 v143, v148, v149
    v_mfma_f32_32x32x16_bf16 v[218:233], a[56:59], v[138:141], v[218:233]
    v_cvt_pk_bf16_f32 v144, v150, v151
    v_cvt_pk_bf16_f32 v145, v152, v153
    v_max3_f32 v242, v170, v171, v242
    v_max3_f32 v243, v172, v173, v243
    v_max3_f32 v242, v174, v175, v242
    v_max3_f32 v243, v176, v177, v243
    v_mfma_f32_32x32x16_bf16 v[218:233], a[60:63], v[142:145], v[218:233]
    v_max3_f32 v242, v178, v179, v242
    v_max3_f32 v243, v180, v181, v243
    v_max3_f32 v242, v182, v183, v242
    v_max3_f32 v243, v184, v185, v243
    v_exp_f32 v106, v106
    v_mfma_f32_32x32x16_bf16 v[170:185], v[78:81], v[86:89], 0
    v_exp_f32 v107, v107
    v_exp_f32 v108, v108
    v_exp_f32 v109, v109
    v_mfma_f32_32x32x16_bf16 v[170:185], v[76:79], v[82:85], v[170:185]
    v_exp_f32 v110, v110
    v_exp_f32 v111, v111
    v_exp_f32 v112, v112
    buffer_load_dwordx4 v255, s[96:99], s100 offen offset:1024 sc1 lds
    v_mfma_f32_32x32x16_bf16 v[138:153], v[30:33], v[102:105], v[186:201]
    v_exp_f32 v113, v113
    v_exp_f32 v114, v114
    v_exp_f32 v115, v115
    v_mfma_f32_32x32x16_bf16 v[138:153], v[28:31], v[98:101], v[138:153]
    v_exp_f32 v116, v116
    v_exp_f32 v117, v117
    v_exp_f32 v118, v118
    v_exp_f32 v119, v119
    v_exp_f32 v120, v120
    v_exp_f32 v121, v121
    v_cvt_pk_bf16_f32 v106, v106, v107
    v_cvt_pk_bf16_f32 v107, v108, v109
    v_cvt_pk_bf16_f32 v108, v110, v111
    v_cvt_pk_bf16_f32 v109, v112, v113
    v_cvt_pk_bf16_f32 v110, v114, v115
    v_cvt_pk_bf16_f32 v111, v116, v117
    v_mfma_f32_32x32x16_bf16 v[218:233], a[64:67], v[106:109], v[218:233]
    v_cvt_pk_bf16_f32 v112, v118, v119
    v_cvt_pk_bf16_f32 v113, v120, v121
    v_max3_f32 v242, v154, v155, v242
    v_max3_f32 v243, v156, v157, v243
    v_max3_f32 v242, v158, v159, v242
    v_max3_f32 v243, v160, v161, v243
    v_mfma_f32_32x32x16_bf16 v[218:233], a[68:71], v[110:113], v[218:233]
    v_max3_f32 v242, v162, v163, v242
    v_max3_f32 v243, v164, v165, v243
    v_max3_f32 v242, v166, v167, v242
    v_max3_f32 v243, v168, v169, v243
    v_exp_f32 v122, v122
    v_mfma_f32_32x32x16_bf16 v[106:121], v[78:81], v[102:105], v[186:201]
    v_exp_f32 v123, v123
    v_exp_f32 v124, v124
    v_exp_f32 v125, v125
    v_mfma_f32_32x32x16_bf16 v[106:121], v[76:79], v[98:101], v[106:121]
    v_exp_f32 v126, v126
    v_exp_f32 v127, v127
    v_exp_f32 v128, v128
    v_exp_f32 v129, v129
    v_exp_f32 v130, v130
    v_exp_f32 v131, v131
    v_exp_f32 v132, v132
    v_exp_f32 v133, v133
    v_exp_f32 v134, v134
    v_exp_f32 v135, v135
    v_exp_f32 v136, v136
    v_exp_f32 v137, v137
    v_cvt_pk_bf16_f32 v122, v122, v123
    v_cvt_pk_bf16_f32 v123, v124, v125
    v_cvt_pk_bf16_f32 v124, v126, v127
    v_cvt_pk_bf16_f32 v125, v128, v129
    v_cvt_pk_bf16_f32 v126, v130, v131
    buffer_load_dwordx4 v255, s[96:99], s100 offen offset:2048 sc1 lds
    s_add_u32 s100, s100, 3072
    v_cvt_pk_bf16_f32 v127, v132, v133
    v_mfma_f32_32x32x16_bf16 v[218:233], a[72:75], v[122:125], v[218:233]
    v_cvt_pk_bf16_f32 v128, v134, v135
    v_cvt_pk_bf16_f32 v129, v136, v137
    v_max3_f32 v242, v170, v171, v242
    v_max3_f32 v243, v172, v173, v243
    v_max3_f32 v242, v174, v175, v242
    v_max3_f32 v243, v176, v177, v243
    v_mfma_f32_32x32x16_bf16 v[218:233], a[76:79], v[126:129], v[218:233]
    v_max3_f32 v242, v178, v179, v242
    v_max3_f32 v243, v180, v181, v243
    v_max3_f32 v242, v182, v183, v242
    v_max3_f32 v243, v184, v185, v243
    v_cndmask_b32 v138, v138, v106, s[20:21]
    v_max_f32 v242, v242, v243
    v_cndmask_b32 v139, v139, v107, s[22:23]
    v_mov_b32 v243, v242
    v_cndmask_b32 v140, v140, v108, s[24:25]
    v_cndmask_b32 v141, v141, v109, s[26:27]
    v_permlane32_swap_b32 v242, v243
    global_load_dword v11, v10, s[86:87]
    v_cndmask_b32 v142, v142, v110, s[28:29]
    v_max_f32 v242, v242, v243
    v_cndmask_b32 v143, v143, v111, s[30:31]
    v_mul_f32 v202, -1.0, v242
    v_mul_f32 v203, -1.0, v242
    v_mul_f32 v204, -1.0, v242
    v_mul_f32 v205, -1.0, v242
    v_mul_f32 v206, -1.0, v242
    v_mul_f32 v207, -1.0, v242
    v_mul_f32 v208, -1.0, v242
    v_mul_f32 v209, -1.0, v242
    s_waitcnt vmcnt(9)
    v_mfma_f32_32x32x16_bf16 v[154:169], v[42:45], v[94:97], 0
    v_mul_f32 v210, -1.0, v242
    v_mul_f32 v211, -1.0, v242
    v_mul_f32 v212, -1.0, v242
    v_mul_f32 v213, -1.0, v242
    v_mul_f32 v214, -1.0, v242
    v_mul_f32 v215, -1.0, v242
    s_waitcnt vmcnt(6)
    v_mfma_f32_32x32x16_bf16 v[186:201], v[24:27], v[94:97], 0
    v_mul_f32 v216, -1.0, v242
    v_mul_f32 v217, -1.0, v242
    v_cndmask_b32 v144, v144, v112, s[32:33]
    v_cndmask_b32 v145, v145, v113, s[34:35]
    v_cndmask_b32 v146, v146, v114, s[36:37]
    v_cndmask_b32 v147, v147, v115, s[38:39]
    v_cndmask_b32 v148, v148, v116, s[46:47]
    v_cndmask_b32 v149, v149, v117, s[48:49]
    v_cndmask_b32 v150, v150, v118, s[50:51]
    v_cndmask_b32 v151, v151, v119, s[52:53]
    v_cndmask_b32 v152, v152, v120, s[54:55]
    v_mfma_f32_32x32x16_bf16 v[122:137], v[42:45], v[86:89], v[202:217]
    s_add_u32 m0, s101, 3072
    s_nop 0
    buffer_load_dwordx4 v255, s[96:99], s100 offen offset:0 sc1 lds
    v_cndmask_b32 v153, v153, v121, s[56:57]
    v_exp_f32 v138, v138
    v_exp_f32 v139, v139
    v_exp_f32 v140, v140
    v_mfma_f32_32x32x16_bf16 v[122:137], v[40:43], v[82:85], v[122:137]
    v_exp_f32 v141, v141
    v_exp_f32 v142, v142
    v_exp_f32 v143, v143
    v_exp_f32 v144, v144
    v_exp_f32 v145, v145
    v_exp_f32 v146, v146
    v_exp_f32 v147, v147
    v_exp_f32 v148, v148
    v_exp_f32 v149, v149
    v_exp_f32 v150, v150
    v_exp_f32 v151, v151
    v_exp_f32 v152, v152
    v_exp_f32 v153, v153
    v_cvt_pk_bf16_f32 v138, v138, v139
    v_cvt_pk_bf16_f32 v139, v140, v141
    v_cvt_pk_bf16_f32 v140, v142, v143
    v_cvt_pk_bf16_f32 v141, v144, v145
    v_cvt_pk_bf16_f32 v142, v146, v147
    v_cvt_pk_bf16_f32 v143, v148, v149
    v_cvt_pk_bf16_f32 v144, v150, v151
    v_cvt_pk_bf16_f32 v145, v152, v153
    v_bfi_b32 v106, v234, 0, v138
    v_and_b32 v114, v234, v138
    v_bfi_b32 v107, v235, 0, v139
    v_mfma_f32_32x32x16_bf16 v[170:185], v[48:51], v[94:97], 0
    v_and_b32 v115, v235, v139
    v_bfi_b32 v108, v236, 0, v140
    v_and_b32 v116, v236, v140
    v_bfi_b32 v109, v237, 0, v141
    v_and_b32 v117, v237, v141
    v_bfi_b32 v110, v238, 0, v142
    v_mfma_f32_32x32x16_bf16 v[218:233], a[16:19], v[106:109], v[218:233]
    v_and_b32 v118, v238, v142
    v_bfi_b32 v111, v239, 0, v143
    v_and_b32 v119, v239, v143
    v_bfi_b32 v112, v240, 0, v144
    v_and_b32 v120, v240, v144
    v_bfi_b32 v113, v241, 0, v145
    v_and_b32 v121, v241, v145
    s_mul_i32 s65, s42, 36864
    v_mfma_f32_32x32x16_bf16 v[218:233], a[20:23], v[110:113], v[218:233]
    s_add_u32 s65, s65, 73728
    s_mul_i32 s60, s42, 73728
    s_add_u32 s60, s60, 368640
    s_mul_i32 s61, s42, 73728
    s_add_u32 s61, s61, 405504
    s_mul_i32 s62, s42, 37376
    buffer_load_dwordx4 v255, s[96:99], s100 offen offset:1024 sc1 lds
    v_mfma_f32_32x32x16_bf16 v[218:233], a[80:83], v[114:117], v[218:233]
    s_add_u32 s62, s62, 149504
    v_and_or_b32 v90, v90, s58, v8
    v_and_b32 v91, s59, v91
    v_exp_f32 v122, v122
    v_exp_f32 v123, v123
    v_mfma_f32_32x32x16_bf16 v[218:233], a[84:87], v[118:121], v[218:233]
    v_exp_f32 v124, v124
    v_exp_f32 v125, v125
    v_exp_f32 v126, v126
    v_mfma_f32_32x32x16_bf16 v[154:169], v[40:43], v[90:93], v[154:169]
    v_exp_f32 v127, v127
    v_exp_f32 v128, v128
    v_exp_f32 v129, v129
    s_waitcnt vmcnt(7)
    v_mfma_f32_32x32x16_bf16 v[186:201], v[22:25], v[90:93], v[186:201]
    v_exp_f32 v130, v130
    s_nop 1
    v_rcp_f32 v244, v228
    v_exp_f32 v131, v131
    v_mfma_f32_32x32x16_bf16 v[170:185], v[46:49], v[90:93], v[170:185]
    v_mul_f32 v244, 0x40088e99, v244
    v_exp_f32 v132, v132
    v_mul_f32 v138, v218, v244
    v_mul_f32 v139, v219, v244
    v_mul_f32 v140, v220, v244
    v_mul_f32 v141, v221, v244
    v_mul_f32 v142, v222, v244
    v_mul_f32 v143, v223, v244
    v_mul_f32 v144, v224, v244
    v_mul_f32 v145, v225, v244
    v_mul_f32 v146, v226, v244
    v_mul_f32 v147, v227, v244
    v_cvt_pk_bf16_f32 v246, v138, v139
    v_cvt_pk_bf16_f32 v247, v140, v141
    v_cvt_pk_bf16_f32 v248, v142, v143
    v_cvt_pk_bf16_f32 v249, v144, v145
    v_cvt_pk_bf16_f32 v250, v146, v147
    v_mfma_f32_32x32x16_bf16 v[138:153], v[48:51], v[86:89], v[202:217]
    buffer_store_dwordx4 v[246:249], v6, s[16:19], s65 offen sc1
    v_cndmask_b32 v154, v154, v186, s[20:21]
    v_cndmask_b32 v155, v155, v187, s[22:23]
    v_cndmask_b32 v156, v156, v188, s[24:25]
    v_cndmask_b32 v157, v157, v189, s[26:27]
    v_cndmask_b32 v158, v158, v190, s[28:29]
    v_mfma_f32_32x32x16_bf16 v[138:153], v[46:49], v[82:85], v[138:153]
    v_cndmask_b32 v159, v159, v191, s[30:31]
    v_cndmask_b32 v160, v160, v192, s[32:33]
    v_cndmask_b32 v161, v161, v193, s[34:35]
    v_cndmask_b32 v162, v162, v194, s[36:37]
    buffer_store_dword v250, v7, s[16:19], s65 offen sc1
    v_cndmask_b32 v163, v163, v195, s[38:39]
    v_cndmask_b32 v164, v164, v196, s[46:47]
    buffer_load_dwordx4 v255, s[96:99], s100 offen offset:2048 sc1 lds
    s_add_u32 s100, s100, 3072
    v_cndmask_b32 v165, v165, v197, s[48:49]
    v_cndmask_b32 v166, v166, v198, s[50:51]
    v_cndmask_b32 v167, v167, v199, s[52:53]
    v_cndmask_b32 v168, v168, v200, s[54:55]
    v_cndmask_b32 v169, v169, v201, s[56:57]
    v_max3_f32 v242, v154, v155, v156
    v_max3_f32 v243, v157, v158, v159
    v_max3_f32 v242, v160, v161, v242
    v_max3_f32 v243, v162, v163, v243
    buffer_load_dwordx2 v[102:103], v2, s[8:11], s60 offen sc1
    v_max3_f32 v242, v164, v165, v242
    v_max3_f32 v243, v166, v167, v243
    v_max3_f32 v242, v168, v169, v242
    v_mfma_f32_32x32x16_bf16 v[154:169], v[54:57], v[94:97], 0
    v_exp_f32 v133, v133
    v_exp_f32 v134, v134
    v_exp_f32 v135, v135
    v_mfma_f32_32x32x16_bf16 v[154:169], v[52:55], v[90:93], v[154:169]
    buffer_load_dwordx2 v[104:105], v2, s[8:11], s60 offen offset:256 sc1
    v_exp_f32 v136, v136
    v_exp_f32 v137, v137
    v_cvt_pk_bf16_f32 v122, v122, v123
    v_cvt_pk_bf16_f32 v123, v124, v125
    v_cvt_pk_bf16_f32 v124, v126, v127
    v_cvt_pk_bf16_f32 v125, v128, v129
    v_cvt_pk_bf16_f32 v126, v130, v131
    v_cvt_pk_bf16_f32 v127, v132, v133
    v_mfma_f32_32x32x16_bf16 v[218:233], a[32:35], v[122:125], 0
    buffer_load_dwordx2 v[98:99], v3, s[8:11], s60 offen sc1
    v_cvt_pk_bf16_f32 v128, v134, v135
    v_cvt_pk_bf16_f32 v129, v136, v137
    v_max3_f32 v242, v170, v171, v242
    v_max3_f32 v243, v172, v173, v243
    v_max3_f32 v242, v174, v175, v242
    v_mfma_f32_32x32x16_bf16 v[218:233], a[36:39], v[126:129], v[218:233]
    v_max3_f32 v243, v176, v177, v243
    v_max3_f32 v242, v178, v179, v242
    v_max3_f32 v243, v180, v181, v243
    v_max3_f32 v242, v182, v183, v242
    buffer_load_dwordx2 v[30:31], v2, s[8:11], s61 offen sc1
    v_max3_f32 v243, v184, v185, v243
    v_exp_f32 v138, v138
    v_exp_f32 v139, v139
    v_exp_f32 v140, v140
    v_exp_f32 v141, v141
    v_exp_f32 v142, v142
    buffer_load_dwordx2 v[32:33], v2, s[8:11], s61 offen offset:256 sc1
    v_exp_f32 v143, v143
    v_exp_f32 v144, v144
    v_exp_f32 v145, v145
    v_exp_f32 v146, v146
    v_exp_f32 v147, v147
    s_add_u32 m0, s101, 6144
    s_nop 0
    buffer_load_dwordx4 v255, s[96:99], s100 offen offset:0 sc1 lds
    v_exp_f32 v148, v148
    buffer_load_dwordx2 v[28:29], v3, s[8:11], s61 offen sc1
    v_mfma_f32_32x32x16_bf16 v[106:121], v[54:57], v[86:89], v[202:217]
    v_exp_f32 v149, v149
    v_exp_f32 v150, v150
    v_exp_f32 v151, v151
    v_mfma_f32_32x32x16_bf16 v[106:121], v[52:55], v[82:85], v[106:121]
    v_exp_f32 v152, v152
    buffer_load_dwordx4 a[96:99], v4, s[12:15], s62 offen sc1
    v_exp_f32 v153, v153
    v_cvt_pk_bf16_f32 v138, v138, v139
    v_cvt_pk_bf16_f32 v139, v140, v141
    v_cvt_pk_bf16_f32 v140, v142, v143
    v_cvt_pk_bf16_f32 v141, v144, v145
    v_cvt_pk_bf16_f32 v142, v146, v147
    v_cvt_pk_bf16_f32 v143, v148, v149
    v_mfma_f32_32x32x16_bf16 v[218:233], a[40:43], v[138:141], v[218:233]
    v_cvt_pk_bf16_f32 v144, v150, v151
    buffer_load_dwordx4 a[100:103], v5, s[12:15], s62 offen sc1
    v_cvt_pk_bf16_f32 v145, v152, v153
    v_max3_f32 v242, v154, v155, v242
    v_max3_f32 v243, v156, v157, v243
    v_max3_f32 v242, v158, v159, v242
    v_mfma_f32_32x32x16_bf16 v[218:233], a[44:47], v[142:145], v[218:233]
    v_max3_f32 v243, v160, v161, v243
    v_max3_f32 v242, v162, v163, v242
    v_max3_f32 v243, v164, v165, v243
    v_max3_f32 v242, v166, v167, v242
    v_max3_f32 v243, v168, v169, v243
    v_exp_f32 v106, v106
    v_mfma_f32_32x32x16_bf16 v[170:185], v[60:63], v[94:97], 0
    v_exp_f32 v107, v107
    v_exp_f32 v108, v108
    v_exp_f32 v109, v109
    v_mfma_f32_32x32x16_bf16 v[170:185], v[58:61], v[90:93], v[170:185]
    v_exp_f32 v110, v110
    v_exp_f32 v111, v111
    v_exp_f32 v112, v112
    v_mfma_f32_32x32x16_bf16 v[122:137], v[60:63], v[86:89], v[202:217]
    v_exp_f32 v113, v113
    v_exp_f32 v114, v114
    v_exp_f32 v115, v115
    v_mfma_f32_32x32x16_bf16 v[122:137], v[58:61], v[82:85], v[122:137]
    v_exp_f32 v116, v116
    v_exp_f32 v117, v117
    v_exp_f32 v118, v118
    v_mfma_f32_32x32x16_bf16 v[154:169], v[66:69], v[94:97], 0
    v_exp_f32 v119, v119
    v_exp_f32 v120, v120
    v_exp_f32 v121, v121
    v_mfma_f32_32x32x16_bf16 v[154:169], v[64:67], v[90:93], v[154:169]
    buffer_load_dwordx4 v255, s[96:99], s100 offen offset:1024 sc1 lds
    v_cvt_pk_bf16_f32 v106, v106, v107
    v_cvt_pk_bf16_f32 v107, v108, v109
    v_cvt_pk_bf16_f32 v108, v110, v111
    v_cvt_pk_bf16_f32 v109, v112, v113
    v_cvt_pk_bf16_f32 v110, v114, v115
    v_cvt_pk_bf16_f32 v111, v116, v117
    v_mfma_f32_32x32x16_bf16 v[218:233], a[48:51], v[106:109], v[218:233]
    v_cvt_pk_bf16_f32 v112, v118, v119
    v_cvt_pk_bf16_f32 v113, v120, v121
    v_max3_f32 v242, v170, v171, v242
    v_max3_f32 v243, v172, v173, v243
    v_max3_f32 v242, v174, v175, v242
    v_max3_f32 v243, v176, v177, v243
    v_mfma_f32_32x32x16_bf16 v[218:233], a[52:55], v[110:113], v[218:233]
    v_max3_f32 v242, v178, v179, v242
    v_max3_f32 v243, v180, v181, v243
    v_max3_f32 v242, v182, v183, v242
    v_max3_f32 v243, v184, v185, v243
    v_exp_f32 v122, v122
    v_mfma_f32_32x32x16_bf16 v[138:153], v[66:69], v[86:89], v[202:217]
    v_exp_f32 v123, v123
    v_exp_f32 v124, v124
    v_exp_f32 v125, v125
    v_mfma_f32_32x32x16_bf16 v[138:153], v[64:67], v[82:85], v[138:153]
    v_exp_f32 v126, v126
    v_exp_f32 v127, v127
    v_exp_f32 v128, v128
    v_mfma_f32_32x32x16_bf16 v[170:185], v[72:75], v[94:97], 0
    v_exp_f32 v129, v129
    v_exp_f32 v130, v130
    v_exp_f32 v131, v131
    v_mfma_f32_32x32x16_bf16 v[170:185], v[70:73], v[90:93], v[170:185]
    v_exp_f32 v132, v132
    v_exp_f32 v133, v133
    v_exp_f32 v134, v134
    v_mfma_f32_32x32x16_bf16 v[106:121], v[72:75], v[86:89], v[202:217]
    v_exp_f32 v135, v135
    v_exp_f32 v136, v136
    v_exp_f32 v137, v137
    v_mfma_f32_32x32x16_bf16 v[106:121], v[70:73], v[82:85], v[106:121]
    v_cvt_pk_bf16_f32 v122, v122, v123
    v_cvt_pk_bf16_f32 v123, v124, v125
    v_cvt_pk_bf16_f32 v124, v126, v127
    v_cvt_pk_bf16_f32 v125, v128, v129
    v_cvt_pk_bf16_f32 v126, v130, v131
    v_cvt_pk_bf16_f32 v127, v132, v133
    v_mfma_f32_32x32x16_bf16 v[218:233], a[56:59], v[122:125], v[218:233]
    v_cvt_pk_bf16_f32 v128, v134, v135
    v_cvt_pk_bf16_f32 v129, v136, v137
    v_max3_f32 v242, v154, v155, v242
    v_max3_f32 v243, v156, v157, v243
    v_max3_f32 v242, v158, v159, v242
    buffer_load_dwordx4 v255, s[96:99], s100 offen offset:2048 sc1 lds
    s_add_u32 s100, s100, 141312
    v_max3_f32 v243, v160, v161, v243
    v_mfma_f32_32x32x16_bf16 v[218:233], a[60:63], v[126:129], v[218:233]
    v_max3_f32 v242, v162, v163, v242
    v_max3_f32 v243, v164, v165, v243
    v_max3_f32 v242, v166, v167, v242
    v_max3_f32 v243, v168, v169, v243
    v_exp_f32 v138, v138
    v_mfma_f32_32x32x16_bf16 v[154:169], v[78:81], v[94:97], 0
    v_exp_f32 v139, v139
    v_exp_f32 v140, v140
    v_exp_f32 v141, v141
    v_mfma_f32_32x32x16_bf16 v[154:169], v[76:79], v[90:93], v[154:169]
    v_exp_f32 v142, v142
    v_exp_f32 v143, v143
    v_exp_f32 v144, v144
    v_mfma_f32_32x32x16_bf16 v[122:137], v[78:81], v[86:89], v[202:217]
    v_exp_f32 v145, v145
    v_exp_f32 v146, v146
    v_exp_f32 v147, v147
    v_mfma_f32_32x32x16_bf16 v[122:137], v[76:79], v[82:85], v[122:137]
    v_exp_f32 v148, v148
    v_exp_f32 v149, v149
    v_exp_f32 v150, v150
    v_exp_f32 v151, v151
    v_exp_f32 v152, v152
    v_exp_f32 v153, v153
    v_cvt_pk_bf16_f32 v138, v138, v139
    v_cvt_pk_bf16_f32 v139, v140, v141
    v_cvt_pk_bf16_f32 v140, v142, v143
    v_cvt_pk_bf16_f32 v141, v144, v145
    v_cvt_pk_bf16_f32 v142, v146, v147
    v_cvt_pk_bf16_f32 v143, v148, v149
    v_mfma_f32_32x32x16_bf16 v[218:233], a[64:67], v[138:141], v[218:233]
    v_cvt_pk_bf16_f32 v144, v150, v151
    v_cvt_pk_bf16_f32 v145, v152, v153
    v_max3_f32 v242, v170, v171, v242
    v_max3_f32 v243, v172, v173, v243
    v_max3_f32 v242, v174, v175, v242
    v_max3_f32 v243, v176, v177, v243
    v_mfma_f32_32x32x16_bf16 v[218:233], a[68:71], v[142:145], v[218:233]
    v_max3_f32 v242, v178, v179, v242
    v_max3_f32 v243, v180, v181, v243
    v_max3_f32 v242, v182, v183, v242
    v_max3_f32 v243, v184, v185, v243
    v_exp_f32 v106, v106
    v_mfma_f32_32x32x16_bf16 v[170:185], v[18:21], v[94:97], 0
    v_exp_f32 v107, v107
    v_exp_f32 v108, v108
    v_exp_f32 v109, v109
    v_mfma_f32_32x32x16_bf16 v[170:185], v[16:19], v[90:93], v[170:185]
    v_exp_f32 v110, v110
    s_add_u32 m0, s101, 36864
    s_nop 0
    buffer_load_dwordx4 v255, s[96:99], s100 offen offset:0 sc1 lds
    v_exp_f32 v111, v111
    v_exp_f32 v112, v112
    v_mfma_f32_32x32x16_bf16 v[138:153], v[36:39], v[86:89], v[202:217]
    v_exp_f32 v113, v113
    v_exp_f32 v114, v114
    v_exp_f32 v115, v115
    v_mfma_f32_32x32x16_bf16 v[138:153], v[34:37], v[82:85], v[138:153]
    v_exp_f32 v116, v116
    v_exp_f32 v117, v117
    v_exp_f32 v118, v118
    v_exp_f32 v119, v119
    v_exp_f32 v120, v120
    v_exp_f32 v121, v121
    v_cvt_pk_bf16_f32 v106, v106, v107
    v_cvt_pk_bf16_f32 v107, v108, v109
    v_cvt_pk_bf16_f32 v108, v110, v111
    v_cvt_pk_bf16_f32 v109, v112, v113
    v_cvt_pk_bf16_f32 v110, v114, v115
    v_cvt_pk_bf16_f32 v111, v116, v117
    v_mfma_f32_32x32x16_bf16 v[218:233], a[72:75], v[106:109], v[218:233]
    v_cvt_pk_bf16_f32 v112, v118, v119
    v_cvt_pk_bf16_f32 v113, v120, v121
    v_max3_f32 v242, v154, v155, v242
    v_max3_f32 v243, v156, v157, v243
    v_max3_f32 v242, v158, v159, v242
    v_max3_f32 v243, v160, v161, v243
    v_mfma_f32_32x32x16_bf16 v[218:233], a[76:79], v[110:113], v[218:233]
    v_max3_f32 v242, v162, v163, v242
    v_max3_f32 v243, v164, v165, v243
    v_max3_f32 v242, v166, v167, v242
    v_max3_f32 v243, v168, v169, v243
    v_exp_f32 v122, v122
    v_mfma_f32_32x32x16_bf16 v[106:121], v[18:21], v[86:89], v[202:217]
    v_exp_f32 v123, v123
    v_exp_f32 v124, v124
    v_exp_f32 v125, v125
    v_mfma_f32_32x32x16_bf16 v[106:121], v[16:19], v[82:85], v[106:121]
    v_exp_f32 v126, v126
    v_exp_f32 v127, v127
    v_exp_f32 v128, v128
    v_exp_f32 v129, v129
    v_exp_f32 v130, v130
    v_exp_f32 v131, v131
    v_exp_f32 v132, v132
    v_exp_f32 v133, v133
    v_exp_f32 v134, v134
    v_exp_f32 v135, v135
    v_exp_f32 v136, v136
    v_exp_f32 v137, v137
    v_cvt_pk_bf16_f32 v122, v122, v123
    v_cvt_pk_bf16_f32 v123, v124, v125
    v_cvt_pk_bf16_f32 v124, v126, v127
    buffer_load_dwordx4 v255, s[96:99], s100 offen offset:1024 sc1 lds
    v_cvt_pk_bf16_f32 v125, v128, v129
    v_cvt_pk_bf16_f32 v126, v130, v131
    v_cvt_pk_bf16_f32 v127, v132, v133
    v_mfma_f32_32x32x16_bf16 v[218:233], a[80:83], v[122:125], v[218:233]
    v_cvt_pk_bf16_f32 v128, v134, v135
    v_cvt_pk_bf16_f32 v129, v136, v137
    v_max3_f32 v242, v170, v171, v242
    v_max3_f32 v243, v172, v173, v243
    v_max3_f32 v242, v174, v175, v242
    v_max3_f32 v243, v176, v177, v243
    v_mfma_f32_32x32x16_bf16 v[218:233], a[84:87], v[126:129], v[218:233]
    v_max3_f32 v242, v178, v179, v242
    v_max3_f32 v243, v180, v181, v243
    v_max3_f32 v242, v182, v183, v242
    v_max3_f32 v243, v184, v185, v243
    v_cndmask_b32 v138, v138, v106, s[20:21]
    v_max_f32 v242, v242, v243
    v_cndmask_b32 v139, v139, v107, s[22:23]
    v_mov_b32 v243, v242
    v_cndmask_b32 v140, v140, v108, s[24:25]
    v_cndmask_b32 v141, v141, v109, s[26:27]
    v_permlane32_swap_b32 v242, v243
    global_load_dword v11, v10, s[86:87]
    v_cndmask_b32 v142, v142, v110, s[28:29]
    v_max_f32 v242, v242, v243
    v_cndmask_b32 v143, v143, v111, s[30:31]
    v_mul_f32 v186, -1.0, v242
    v_mul_f32 v187, -1.0, v242
    v_mul_f32 v188, -1.0, v242
    v_mul_f32 v189, -1.0, v242
    v_mul_f32 v190, -1.0, v242
    v_mul_f32 v191, -1.0, v242
    v_mul_f32 v192, -1.0, v242
    v_mul_f32 v193, -1.0, v242
    s_waitcnt vmcnt(11)
    v_mfma_f32_32x32x16_bf16 v[154:169], v[48:51], v[102:105], 0
    v_mul_f32 v194, -1.0, v242
    v_mul_f32 v195, -1.0, v242
    v_mul_f32 v196, -1.0, v242
    v_mul_f32 v197, -1.0, v242
    v_mul_f32 v198, -1.0, v242
    v_mul_f32 v199, -1.0, v242
    s_waitcnt vmcnt(8)
    v_mfma_f32_32x32x16_bf16 v[202:217], v[30:33], v[102:105], 0
    v_mul_f32 v200, -1.0, v242
    v_mul_f32 v201, -1.0, v242
    v_cndmask_b32 v144, v144, v112, s[32:33]
    v_cndmask_b32 v145, v145, v113, s[34:35]
    v_cndmask_b32 v146, v146, v114, s[36:37]
    v_cndmask_b32 v147, v147, v115, s[38:39]
    v_cndmask_b32 v148, v148, v116, s[46:47]
    v_cndmask_b32 v149, v149, v117, s[48:49]
    v_cndmask_b32 v150, v150, v118, s[50:51]
    v_cndmask_b32 v151, v151, v119, s[52:53]
    buffer_load_dwordx4 v255, s[96:99], s100 offen offset:2048 sc1 lds
    s_add_u32 s100, s100, 3072
    v_cndmask_b32 v152, v152, v120, s[54:55]
    v_mfma_f32_32x32x16_bf16 v[122:137], v[48:51], v[94:97], v[186:201]
    v_cndmask_b32 v153, v153, v121, s[56:57]
    v_exp_f32 v138, v138
    v_exp_f32 v139, v139
    v_exp_f32 v140, v140
    v_mfma_f32_32x32x16_bf16 v[122:137], v[46:49], v[90:93], v[122:137]
    v_exp_f32 v141, v141
    v_exp_f32 v142, v142
    v_exp_f32 v143, v143
    v_exp_f32 v144, v144
    v_exp_f32 v145, v145
    v_exp_f32 v146, v146
    v_exp_f32 v147, v147
    v_exp_f32 v148, v148
    v_exp_f32 v149, v149
    v_exp_f32 v150, v150
    v_exp_f32 v151, v151
    v_exp_f32 v152, v152
    v_exp_f32 v153, v153
    v_cvt_pk_bf16_f32 v138, v138, v139
    v_cvt_pk_bf16_f32 v139, v140, v141
    v_cvt_pk_bf16_f32 v140, v142, v143
    v_cvt_pk_bf16_f32 v141, v144, v145
    v_cvt_pk_bf16_f32 v142, v146, v147
    v_cvt_pk_bf16_f32 v143, v148, v149
    v_cvt_pk_bf16_f32 v144, v150, v151
    v_cvt_pk_bf16_f32 v145, v152, v153
    v_bfi_b32 v106, v234, 0, v138
    v_and_b32 v114, v234, v138
    v_bfi_b32 v107, v235, 0, v139
    v_mfma_f32_32x32x16_bf16 v[170:185], v[54:57], v[102:105], 0
    v_and_b32 v115, v235, v139
    v_bfi_b32 v108, v236, 0, v140
    v_and_b32 v116, v236, v140
    v_bfi_b32 v109, v237, 0, v141
    v_and_b32 v117, v237, v141
    v_bfi_b32 v110, v238, 0, v142
    v_mfma_f32_32x32x16_bf16 v[218:233], a[24:27], v[106:109], v[218:233]
    v_and_b32 v118, v238, v142
    v_bfi_b32 v111, v239, 0, v143
    v_and_b32 v119, v239, v143
    v_bfi_b32 v112, v240, 0, v144
    v_and_b32 v120, v240, v144
    v_bfi_b32 v113, v241, 0, v145
    v_and_b32 v121, v241, v145
    s_mul_i32 s63, s42, 36864
    v_mfma_f32_32x32x16_bf16 v[218:233], a[28:31], v[110:113], v[218:233]
    s_add_u32 s63, s63, 110592
    s_mul_i32 s64, s42, 73728
    s_add_u32 s64, s64, 442368
    s_mul_i32 s65, s42, 73728
    s_add_u32 m0, s101, 39936
    s_nop 0
    buffer_load_dwordx4 v255, s[96:99], s100 offen offset:0 sc1 lds
    s_add_u32 s65, s65, 479232
    s_mul_i32 s60, s42, 37376
    v_mfma_f32_32x32x16_bf16 v[218:233], a[88:91], v[114:117], v[218:233]
    s_add_u32 s60, s60, 186880
    v_and_or_b32 v98, v98, s58, v8
    v_and_b32 v99, s59, v99
    v_exp_f32 v122, v122
    v_exp_f32 v123, v123
    v_mfma_f32_32x32x16_bf16 v[218:233], a[92:95], v[118:121], v[218:233]
    v_exp_f32 v124, v124
    v_exp_f32 v125, v125
    v_exp_f32 v126, v126
    v_mfma_f32_32x32x16_bf16 v[154:169], v[46:49], v[98:101], v[154:169]
    v_exp_f32 v127, v127
    v_exp_f32 v128, v128
    v_exp_f32 v129, v129
    s_waitcnt vmcnt(8)
    v_mfma_f32_32x32x16_bf16 v[202:217], v[28:31], v[98:101], v[202:217]
    v_exp_f32 v130, v130
    s_nop 1
    v_rcp_f32 v244, v228
    v_exp_f32 v131, v131
    v_mfma_f32_32x32x16_bf16 v[170:185], v[52:55], v[98:101], v[170:185]
    v_mul_f32 v244, 0x40088e99, v244
    v_exp_f32 v132, v132
    v_mul_f32 v138, v218, v244
    v_mul_f32 v139, v219, v244
    v_mul_f32 v140, v220, v244
    v_mul_f32 v141, v221, v244
    v_mul_f32 v142, v222, v244
    v_mul_f32 v143, v223, v244
    v_mul_f32 v144, v224, v244
    v_mul_f32 v145, v225, v244
    v_mul_f32 v146, v226, v244
    v_mul_f32 v147, v227, v244
    v_cvt_pk_bf16_f32 v246, v138, v139
    v_cvt_pk_bf16_f32 v247, v140, v141
    v_cvt_pk_bf16_f32 v248, v142, v143
    v_cvt_pk_bf16_f32 v249, v144, v145
    v_cvt_pk_bf16_f32 v250, v146, v147
    v_mfma_f32_32x32x16_bf16 v[138:153], v[54:57], v[94:97], v[186:201]
    buffer_store_dwordx4 v[246:249], v6, s[16:19], s63 offen sc1
    v_cndmask_b32 v154, v154, v202, s[20:21]
    v_cndmask_b32 v155, v155, v203, s[22:23]
    v_cndmask_b32 v156, v156, v204, s[24:25]
    v_cndmask_b32 v157, v157, v205, s[26:27]
    v_cndmask_b32 v158, v158, v206, s[28:29]
    v_mfma_f32_32x32x16_bf16 v[138:153], v[52:55], v[90:93], v[138:153]
    v_cndmask_b32 v159, v159, v207, s[30:31]
    v_cndmask_b32 v160, v160, v208, s[32:33]
    v_cndmask_b32 v161, v161, v209, s[34:35]
    v_cndmask_b32 v162, v162, v210, s[36:37]
    buffer_store_dword v250, v7, s[16:19], s63 offen sc1
    buffer_load_dwordx4 v255, s[96:99], s100 offen offset:1024 sc1 lds
    v_cndmask_b32 v163, v163, v211, s[38:39]
    v_cndmask_b32 v164, v164, v212, s[46:47]
    v_cndmask_b32 v165, v165, v213, s[48:49]
    v_cndmask_b32 v166, v166, v214, s[50:51]
    v_cndmask_b32 v167, v167, v215, s[52:53]
    v_cndmask_b32 v168, v168, v216, s[54:55]
    v_add_u32 v12, s89, v1
    v_mul_u32_u24 v13, 58255, v12
    v_lshrrev_b32 v13, 23, v13
    v_mul_u32_u24 v13, 144, v13
    v_add_u32 v13, v13, v12
    v_lshlrev_b32 v13, 7, v13
    buffer_load_dword v14, v13, s[96:99], s94 offen
    v_cndmask_b32 v169, v169, v217, s[56:57]
    v_max3_f32 v242, v154, v155, v156
    v_max3_f32 v243, v157, v158, v159
    v_max3_f32 v242, v160, v161, v242
    v_max3_f32 v243, v162, v163, v243
    buffer_load_dwordx2 v[86:87], v2, s[8:11], s64 offen sc1
    v_max3_f32 v242, v164, v165, v242
    v_max3_f32 v243, v166, v167, v243
    v_max3_f32 v242, v168, v169, v242
    v_mfma_f32_32x32x16_bf16 v[154:169], v[60:63], v[102:105], 0
    v_exp_f32 v133, v133
    v_exp_f32 v134, v134
    v_exp_f32 v135, v135
    v_mfma_f32_32x32x16_bf16 v[154:169], v[58:61], v[98:101], v[154:169]
    buffer_load_dwordx2 v[88:89], v2, s[8:11], s64 offen offset:256 sc1
    v_exp_f32 v136, v136
    v_exp_f32 v137, v137
    v_cvt_pk_bf16_f32 v122, v122, v123
    v_cvt_pk_bf16_f32 v123, v124, v125
    v_cvt_pk_bf16_f32 v124, v126, v127
    v_cvt_pk_bf16_f32 v125, v128, v129
    v_cvt_pk_bf16_f32 v126, v130, v131
    v_cvt_pk_bf16_f32 v127, v132, v133
    v_mfma_f32_32x32x16_bf16 v[218:233], a[40:43], v[122:125], 0
    buffer_load_dwordx2 v[82:83], v3, s[8:11], s64 offen sc1
    v_cvt_pk_bf16_f32 v128, v134, v135
    v_cvt_pk_bf16_f32 v129, v136, v137
    v_max3_f32 v242, v170, v171, v242
    v_max3_f32 v243, v172, v173, v243
    v_max3_f32 v242, v174, v175, v242
    v_mfma_f32_32x32x16_bf16 v[218:233], a[44:47], v[126:129], v[218:233]
    v_max3_f32 v243, v176, v177, v243
    v_max3_f32 v242, v178, v179, v242
    v_max3_f32 v243, v180, v181, v243
    v_max3_f32 v242, v182, v183, v242
    buffer_load_dwordx2 v[36:37], v2, s[8:11], s65 offen sc1
    v_max3_f32 v243, v184, v185, v243
    v_exp_f32 v138, v138
    v_exp_f32 v139, v139
    v_exp_f32 v140, v140
    v_exp_f32 v141, v141
    v_exp_f32 v142, v142
    buffer_load_dwordx2 v[38:39], v2, s[8:11], s65 offen offset:256 sc1
    v_exp_f32 v143, v143
    v_exp_f32 v144, v144
    v_exp_f32 v145, v145
    buffer_load_dwordx4 v255, s[96:99], s100 offen offset:2048 sc1 lds
    s_add_u32 s100, s100, 3072
    v_exp_f32 v146, v146
    v_exp_f32 v147, v147
    v_exp_f32 v148, v148
    buffer_load_dwordx2 v[34:35], v3, s[8:11], s65 offen sc1
    v_mfma_f32_32x32x16_bf16 v[106:121], v[60:63], v[94:97], v[186:201]
    v_exp_f32 v149, v149
    v_exp_f32 v150, v150
    v_exp_f32 v151, v151
    v_mfma_f32_32x32x16_bf16 v[106:121], v[58:61], v[90:93], v[106:121]
    v_exp_f32 v152, v152
    buffer_load_dwordx4 a[104:107], v4, s[12:15], s60 offen sc1
    v_exp_f32 v153, v153
    v_cvt_pk_bf16_f32 v138, v138, v139
    v_cvt_pk_bf16_f32 v139, v140, v141
    v_cvt_pk_bf16_f32 v140, v142, v143
    v_cvt_pk_bf16_f32 v141, v144, v145
    v_cvt_pk_bf16_f32 v142, v146, v147
    v_cvt_pk_bf16_f32 v143, v148, v149
    v_mfma_f32_32x32x16_bf16 v[218:233], a[48:51], v[138:141], v[218:233]
    v_cvt_pk_bf16_f32 v144, v150, v151
    buffer_load_dwordx4 a[108:111], v5, s[12:15], s60 offen sc1
    v_cvt_pk_bf16_f32 v145, v152, v153
    v_max3_f32 v242, v154, v155, v242
    v_max3_f32 v243, v156, v157, v243
    v_max3_f32 v242, v158, v159, v242
    v_mfma_f32_32x32x16_bf16 v[218:233], a[52:55], v[142:145], v[218:233]
    v_max3_f32 v243, v160, v161, v243
    v_max3_f32 v242, v162, v163, v242
    v_max3_f32 v243, v164, v165, v243
    v_max3_f32 v242, v166, v167, v242
    v_max3_f32 v243, v168, v169, v243
    v_exp_f32 v106, v106
    v_mfma_f32_32x32x16_bf16 v[170:185], v[66:69], v[102:105], 0
    v_exp_f32 v107, v107
    v_exp_f32 v108, v108
    v_exp_f32 v109, v109
    v_mfma_f32_32x32x16_bf16 v[170:185], v[64:67], v[98:101], v[170:185]
    v_exp_f32 v110, v110
    v_exp_f32 v111, v111
    v_exp_f32 v112, v112
    v_mfma_f32_32x32x16_bf16 v[122:137], v[66:69], v[94:97], v[186:201]
    v_exp_f32 v113, v113
    v_exp_f32 v114, v114
    v_exp_f32 v115, v115
    v_mfma_f32_32x32x16_bf16 v[122:137], v[64:67], v[90:93], v[122:137]
    v_exp_f32 v116, v116
    v_exp_f32 v117, v117
    v_exp_f32 v118, v118
    v_mfma_f32_32x32x16_bf16 v[154:169], v[72:75], v[102:105], 0
    v_exp_f32 v119, v119
    v_exp_f32 v120, v120
    s_add_u32 m0, s101, 43008
    s_nop 0
    buffer_load_dwordx4 v255, s[96:99], s100 offen offset:0 sc1 lds
    v_exp_f32 v121, v121
    v_mfma_f32_32x32x16_bf16 v[154:169], v[70:73], v[98:101], v[154:169]
    v_cvt_pk_bf16_f32 v106, v106, v107
    v_cvt_pk_bf16_f32 v107, v108, v109
    v_cvt_pk_bf16_f32 v108, v110, v111
    v_cvt_pk_bf16_f32 v109, v112, v113
    v_cvt_pk_bf16_f32 v110, v114, v115
    v_cvt_pk_bf16_f32 v111, v116, v117
    v_mfma_f32_32x32x16_bf16 v[218:233], a[56:59], v[106:109], v[218:233]
    v_cvt_pk_bf16_f32 v112, v118, v119
    v_cvt_pk_bf16_f32 v113, v120, v121
    v_max3_f32 v242, v170, v171, v242
    v_max3_f32 v243, v172, v173, v243
    v_max3_f32 v242, v174, v175, v242
    v_max3_f32 v243, v176, v177, v243
    v_mfma_f32_32x32x16_bf16 v[218:233], a[60:63], v[110:113], v[218:233]
    v_max3_f32 v242, v178, v179, v242
    v_max3_f32 v243, v180, v181, v243
    v_max3_f32 v242, v182, v183, v242
    v_max3_f32 v243, v184, v185, v243
    v_exp_f32 v122, v122
    v_mfma_f32_32x32x16_bf16 v[138:153], v[72:75], v[94:97], v[186:201]
    v_exp_f32 v123, v123
    v_exp_f32 v124, v124
    v_exp_f32 v125, v125
    v_mfma_f32_32x32x16_bf16 v[138:153], v[70:73], v[90:93], v[138:153]
    v_exp_f32 v126, v126
    v_exp_f32 v127, v127
    v_exp_f32 v128, v128
    v_mfma_f32_32x32x16_bf16 v[170:185], v[78:81], v[102:105], 0
    v_exp_f32 v129, v129
    v_exp_f32 v130, v130
    v_exp_f32 v131, v131
    v_mfma_f32_32x32x16_bf16 v[170:185], v[76:79], v[98:101], v[170:185]
    v_exp_f32 v132, v132
    v_exp_f32 v133, v133
    v_exp_f32 v134, v134
    v_mfma_f32_32x32x16_bf16 v[106:121], v[78:81], v[94:97], v[186:201]
    v_exp_f32 v135, v135
    v_exp_f32 v136, v136
    v_exp_f32 v137, v137
    v_mfma_f32_32x32x16_bf16 v[106:121], v[76:79], v[90:93], v[106:121]
    v_cvt_pk_bf16_f32 v122, v122, v123
    v_cvt_pk_bf16_f32 v123, v124, v125
    v_cvt_pk_bf16_f32 v124, v126, v127
    v_cvt_pk_bf16_f32 v125, v128, v129
    v_cvt_pk_bf16_f32 v126, v130, v131
    v_cvt_pk_bf16_f32 v127, v132, v133
    v_mfma_f32_32x32x16_bf16 v[218:233], a[64:67], v[122:125], v[218:233]
    v_cvt_pk_bf16_f32 v128, v134, v135
    v_cvt_pk_bf16_f32 v129, v136, v137
    v_max3_f32 v242, v154, v155, v242
    buffer_load_dwordx4 v255, s[96:99], s100 offen offset:1024 sc1 lds
    v_max3_f32 v243, v156, v157, v243
    v_max3_f32 v242, v158, v159, v242
    v_max3_f32 v243, v160, v161, v243
    v_mfma_f32_32x32x16_bf16 v[218:233], a[68:71], v[126:129], v[218:233]
    v_max3_f32 v242, v162, v163, v242
    v_max3_f32 v243, v164, v165, v243
    v_max3_f32 v242, v166, v167, v242
    v_max3_f32 v243, v168, v169, v243
    v_exp_f32 v138, v138
    v_mfma_f32_32x32x16_bf16 v[154:169], v[18:21], v[102:105], 0
    v_exp_f32 v139, v139
    v_exp_f32 v140, v140
    v_exp_f32 v141, v141
    v_mfma_f32_32x32x16_bf16 v[154:169], v[16:19], v[98:101], v[154:169]
    v_exp_f32 v142, v142
    v_exp_f32 v143, v143
    v_exp_f32 v144, v144
    v_mfma_f32_32x32x16_bf16 v[122:137], v[18:21], v[94:97], v[186:201]
    v_exp_f32 v145, v145
    v_exp_f32 v146, v146
    v_exp_f32 v147, v147
    v_mfma_f32_32x32x16_bf16 v[122:137], v[16:19], v[90:93], v[122:137]
    v_exp_f32 v148, v148
    v_exp_f32 v149, v149
    v_exp_f32 v150, v150
    v_exp_f32 v151, v151
    v_exp_f32 v152, v152
    v_exp_f32 v153, v153
    v_cvt_pk_bf16_f32 v138, v138, v139
    v_cvt_pk_bf16_f32 v139, v140, v141
    v_cvt_pk_bf16_f32 v140, v142, v143
    v_cvt_pk_bf16_f32 v141, v144, v145
    v_cvt_pk_bf16_f32 v142, v146, v147
    v_cvt_pk_bf16_f32 v143, v148, v149
    v_mfma_f32_32x32x16_bf16 v[218:233], a[72:75], v[138:141], v[218:233]
    v_cvt_pk_bf16_f32 v144, v150, v151
    v_cvt_pk_bf16_f32 v145, v152, v153
    v_max3_f32 v242, v170, v171, v242
    v_max3_f32 v243, v172, v173, v243
    v_max3_f32 v242, v174, v175, v242
    v_max3_f32 v243, v176, v177, v243
    v_mfma_f32_32x32x16_bf16 v[218:233], a[76:79], v[142:145], v[218:233]
    v_max3_f32 v242, v178, v179, v242
    v_max3_f32 v243, v180, v181, v243
    v_max3_f32 v242, v182, v183, v242
    v_max3_f32 v243, v184, v185, v243
    v_exp_f32 v106, v106
    v_mfma_f32_32x32x16_bf16 v[170:185], v[24:27], v[102:105], 0
    v_exp_f32 v107, v107
    v_exp_f32 v108, v108
    v_exp_f32 v109, v109
    buffer_load_dwordx4 v255, s[96:99], s100 offen offset:2048 sc1 lds
    s_add_u32 s100, s100, 141312
    v_mfma_f32_32x32x16_bf16 v[170:185], v[22:25], v[98:101], v[170:185]
    v_exp_f32 v110, v110
    v_exp_f32 v111, v111
    v_add_u32 v12, 64, v12
    v_mul_u32_u24 v13, 58255, v12
    v_lshrrev_b32 v13, 23, v13
    v_mul_u32_u24 v13, 144, v13
    v_add_u32 v13, v13, v12
    v_lshlrev_b32 v13, 7, v13
    buffer_load_dword v14, v13, s[96:99], s94 offen
    v_exp_f32 v112, v112
    v_mfma_f32_32x32x16_bf16 v[138:153], v[42:45], v[94:97], v[186:201]
    v_exp_f32 v113, v113
    v_exp_f32 v114, v114
    v_exp_f32 v115, v115
    v_mfma_f32_32x32x16_bf16 v[138:153], v[40:43], v[90:93], v[138:153]
    v_exp_f32 v116, v116
    v_exp_f32 v117, v117
    v_exp_f32 v118, v118
    v_exp_f32 v119, v119
    v_exp_f32 v120, v120
    v_exp_f32 v121, v121
    v_cvt_pk_bf16_f32 v106, v106, v107
    v_cvt_pk_bf16_f32 v107, v108, v109
    v_cvt_pk_bf16_f32 v108, v110, v111
    v_cvt_pk_bf16_f32 v109, v112, v113
    v_cvt_pk_bf16_f32 v110, v114, v115
    v_cvt_pk_bf16_f32 v111, v116, v117
    v_mfma_f32_32x32x16_bf16 v[218:233], a[80:83], v[106:109], v[218:233]
    v_cvt_pk_bf16_f32 v112, v118, v119
    v_cvt_pk_bf16_f32 v113, v120, v121
    v_max3_f32 v242, v154, v155, v242
    v_max3_f32 v243, v156, v157, v243
    v_max3_f32 v242, v158, v159, v242
    v_max3_f32 v243, v160, v161, v243
    v_mfma_f32_32x32x16_bf16 v[218:233], a[84:87], v[110:113], v[218:233]
    v_max3_f32 v242, v162, v163, v242
    v_max3_f32 v243, v164, v165, v243
    v_max3_f32 v242, v166, v167, v242
    v_max3_f32 v243, v168, v169, v243
    v_exp_f32 v122, v122
    v_mfma_f32_32x32x16_bf16 v[106:121], v[24:27], v[94:97], v[186:201]
    v_exp_f32 v123, v123
    v_exp_f32 v124, v124
    v_exp_f32 v125, v125
    v_mfma_f32_32x32x16_bf16 v[106:121], v[22:25], v[90:93], v[106:121]
    v_exp_f32 v126, v126
    v_exp_f32 v127, v127
    v_exp_f32 v128, v128
    v_exp_f32 v129, v129
    v_exp_f32 v130, v130
    v_exp_f32 v131, v131
    v_exp_f32 v132, v132
    v_exp_f32 v133, v133
    v_exp_f32 v134, v134
    v_exp_f32 v135, v135
    v_exp_f32 v136, v136
    v_exp_f32 v137, v137
    v_cvt_pk_bf16_f32 v122, v122, v123
    s_add_u32 m0, s101, 73728
    s_nop 0
    buffer_load_dwordx4 v255, s[96:99], s100 offen offset:0 sc1 lds
    v_cvt_pk_bf16_f32 v123, v124, v125
    v_cvt_pk_bf16_f32 v124, v126, v127
    v_cvt_pk_bf16_f32 v125, v128, v129
    v_cvt_pk_bf16_f32 v126, v130, v131
    v_cvt_pk_bf16_f32 v127, v132, v133
    v_mfma_f32_32x32x16_bf16 v[218:233], a[88:91], v[122:125], v[218:233]
    v_cvt_pk_bf16_f32 v128, v134, v135
    v_cvt_pk_bf16_f32 v129, v136, v137
    v_max3_f32 v242, v170, v171, v242
    v_max3_f32 v243, v172, v173, v243
    v_max3_f32 v242, v174, v175, v242
    v_max3_f32 v243, v176, v177, v243
    v_mfma_f32_32x32x16_bf16 v[218:233], a[92:95], v[126:129], v[218:233]
    v_max3_f32 v242, v178, v179, v242
    v_max3_f32 v243, v180, v181, v243
    v_max3_f32 v242, v182, v183, v242
    v_max3_f32 v243, v184, v185, v243
    v_cndmask_b32 v138, v138, v106, s[20:21]
    v_max_f32 v242, v242, v243
    v_cndmask_b32 v139, v139, v107, s[22:23]
    v_mov_b32 v243, v242
    v_cndmask_b32 v140, v140, v108, s[24:25]
    v_cndmask_b32 v141, v141, v109, s[26:27]
    v_permlane32_swap_b32 v242, v243
    global_load_dword v11, v10, s[86:87]
    v_cndmask_b32 v142, v142, v110, s[28:29]
    v_max_f32 v242, v242, v243
    v_cndmask_b32 v143, v143, v111, s[30:31]
    v_mul_f32 v202, -1.0, v242
    v_mul_f32 v203, -1.0, v242
    v_mul_f32 v204, -1.0, v242
    v_mul_f32 v205, -1.0, v242
    v_mul_f32 v206, -1.0, v242
    v_mul_f32 v207, -1.0, v242
    v_mul_f32 v208, -1.0, v242
    v_mul_f32 v209, -1.0, v242
    s_waitcnt vmcnt(12)
    v_mfma_f32_32x32x16_bf16 v[154:169], v[54:57], v[86:89], 0
    v_mul_f32 v210, -1.0, v242
    v_mul_f32 v211, -1.0, v242
    v_mul_f32 v212, -1.0, v242
    v_mul_f32 v213, -1.0, v242
    v_mul_f32 v214, -1.0, v242
    v_mul_f32 v215, -1.0, v242
    s_waitcnt vmcnt(9)
    v_mfma_f32_32x32x16_bf16 v[186:201], v[36:39], v[86:89], 0
    v_mul_f32 v216, -1.0, v242
    v_mul_f32 v217, -1.0, v242
    v_cndmask_b32 v144, v144, v112, s[32:33]
    v_cndmask_b32 v145, v145, v113, s[34:35]
    v_cndmask_b32 v146, v146, v114, s[36:37]
    v_cndmask_b32 v147, v147, v115, s[38:39]
    v_cndmask_b32 v148, v148, v116, s[46:47]
    v_cndmask_b32 v149, v149, v117, s[48:49]
    buffer_load_dwordx4 v255, s[96:99], s100 offen offset:1024 sc1 lds
    v_cndmask_b32 v150, v150, v118, s[50:51]
    v_cndmask_b32 v151, v151, v119, s[52:53]
    v_cndmask_b32 v152, v152, v120, s[54:55]
    v_mfma_f32_32x32x16_bf16 v[122:137], v[54:57], v[102:105], v[202:217]
    v_cndmask_b32 v153, v153, v121, s[56:57]
    v_exp_f32 v138, v138
    v_exp_f32 v139, v139
    v_exp_f32 v140, v140
    v_mfma_f32_32x32x16_bf16 v[122:137], v[52:55], v[98:101], v[122:137]
    v_exp_f32 v141, v141
    v_exp_f32 v142, v142
    v_exp_f32 v143, v143
    v_exp_f32 v144, v144
    v_exp_f32 v145, v145
    v_exp_f32 v146, v146
    v_exp_f32 v147, v147
    v_exp_f32 v148, v148
    v_exp_f32 v149, v149
    v_exp_f32 v150, v150
    v_exp_f32 v151, v151
    v_exp_f32 v152, v152
    v_exp_f32 v153, v153
    v_cvt_pk_bf16_f32 v138, v138, v139
    v_cvt_pk_bf16_f32 v139, v140, v141
    v_cvt_pk_bf16_f32 v140, v142, v143
    v_cvt_pk_bf16_f32 v141, v144, v145
    v_cvt_pk_bf16_f32 v142, v146, v147
    v_cvt_pk_bf16_f32 v143, v148, v149
    v_cvt_pk_bf16_f32 v144, v150, v151
    v_cvt_pk_bf16_f32 v145, v152, v153
    v_bfi_b32 v106, v234, 0, v138
    v_and_b32 v114, v234, v138
    v_bfi_b32 v107, v235, 0, v139
    v_mfma_f32_32x32x16_bf16 v[170:185], v[60:63], v[86:89], 0
    v_and_b32 v115, v235, v139
    v_bfi_b32 v108, v236, 0, v140
    v_and_b32 v116, v236, v140
    v_bfi_b32 v109, v237, 0, v141
    v_and_b32 v117, v237, v141
    v_bfi_b32 v110, v238, 0, v142
    v_mfma_f32_32x32x16_bf16 v[218:233], a[32:35], v[106:109], v[218:233]
    v_and_b32 v118, v238, v142
    v_bfi_b32 v111, v239, 0, v143
    v_and_b32 v119, v239, v143
    v_bfi_b32 v112, v240, 0, v144
    v_and_b32 v120, v240, v144
    v_bfi_b32 v113, v241, 0, v145
    v_and_b32 v121, v241, v145
    s_mul_i32 s61, s42, 36864
    v_mfma_f32_32x32x16_bf16 v[218:233], a[36:39], v[110:113], v[218:233]
    s_add_u32 s61, s61, 147456
    s_mul_i32 s62, s42, 73728
    buffer_load_dwordx4 v255, s[96:99], s100 offen offset:2048 sc1 lds
    s_add_u32 s100, s100, 3072
    s_add_u32 s62, s62, 516096
    s_mul_i32 s63, s42, 73728
    s_add_u32 s63, s63, 552960
    s_mul_i32 s64, s42, 37376
    v_mfma_f32_32x32x16_bf16 v[218:233], a[96:99], v[114:117], v[218:233]
    s_add_u32 s64, s64, 224256
    v_and_or_b32 v82, v82, s58, v8
    v_and_b32 v83, s59, v83
    v_exp_f32 v122, v122
    v_exp_f32 v123, v123
    v_mfma_f32_32x32x16_bf16 v[218:233], a[100:103], v[118:121], v[218:233]
    v_exp_f32 v124, v124
    v_exp_f32 v125, v125
    v_exp_f32 v126, v126
    v_mfma_f32_32x32x16_bf16 v[154:169], v[52:55], v[82:85], v[154:169]
    v_exp_f32 v127, v127
    v_exp_f32 v128, v128
    v_exp_f32 v129, v129
    s_waitcnt vmcnt(9)
    v_mfma_f32_32x32x16_bf16 v[186:201], v[34:37], v[82:85], v[186:201]
    v_exp_f32 v130, v130
    s_nop 1
    v_rcp_f32 v244, v228
    v_exp_f32 v131, v131
    v_mfma_f32_32x32x16_bf16 v[170:185], v[58:61], v[82:85], v[170:185]
    v_mul_f32 v244, 0x40088e99, v244
    v_exp_f32 v132, v132
    v_mul_f32 v138, v218, v244
    v_mul_f32 v139, v219, v244
    v_mul_f32 v140, v220, v244
    v_mul_f32 v141, v221, v244
    v_mul_f32 v142, v222, v244
    v_mul_f32 v143, v223, v244
    v_mul_f32 v144, v224, v244
    v_mul_f32 v145, v225, v244
    v_mul_f32 v146, v226, v244
    v_mul_f32 v147, v227, v244
    v_cvt_pk_bf16_f32 v246, v138, v139
    v_cvt_pk_bf16_f32 v247, v140, v141
    v_cvt_pk_bf16_f32 v248, v142, v143
    v_cvt_pk_bf16_f32 v249, v144, v145
    v_cvt_pk_bf16_f32 v250, v146, v147
    v_mfma_f32_32x32x16_bf16 v[138:153], v[60:63], v[102:105], v[202:217]
    buffer_store_dwordx4 v[246:249], v6, s[16:19], s61 offen sc1
    v_cndmask_b32 v154, v154, v186, s[20:21]
    v_cndmask_b32 v155, v155, v187, s[22:23]
    v_cndmask_b32 v156, v156, v188, s[24:25]
    v_cndmask_b32 v157, v157, v189, s[26:27]
    v_cndmask_b32 v158, v158, v190, s[28:29]
    v_mfma_f32_32x32x16_bf16 v[138:153], v[58:61], v[98:101], v[138:153]
    v_cndmask_b32 v159, v159, v191, s[30:31]
    v_cndmask_b32 v160, v160, v192, s[32:33]
    v_cndmask_b32 v161, v161, v193, s[34:35]
    s_add_u32 m0, s101, 76800
    v_add_u32 v12, 64, v12
    v_mul_u32_u24 v13, 58255, v12
    v_lshrrev_b32 v13, 23, v13
    v_mul_u32_u24 v13, 144, v13
    v_add_u32 v13, v13, v12
    v_lshlrev_b32 v13, 7, v13
    buffer_load_dword v14, v13, s[96:99], s94 offen
    buffer_load_dwordx4 v255, s[96:99], s100 offen offset:0 sc1 lds
    v_cndmask_b32 v162, v162, v194, s[36:37]
    buffer_store_dword v250, v7, s[16:19], s61 offen sc1
    v_cndmask_b32 v163, v163, v195, s[38:39]
    v_cndmask_b32 v164, v164, v196, s[46:47]
    v_cndmask_b32 v165, v165, v197, s[48:49]
    v_cndmask_b32 v166, v166, v198, s[50:51]
    v_cndmask_b32 v167, v167, v199, s[52:53]
    v_cndmask_b32 v168, v168, v200, s[54:55]
    v_cndmask_b32 v169, v169, v201, s[56:57]
    v_max3_f32 v242, v154, v155, v156
    v_max3_f32 v243, v157, v158, v159
    v_max3_f32 v242, v160, v161, v242
    v_max3_f32 v243, v162, v163, v243
    buffer_load_dwordx2 v[94:95], v2, s[8:11], s62 offen sc1
    v_max3_f32 v242, v164, v165, v242
    v_max3_f32 v243, v166, v167, v243
    v_max3_f32 v242, v168, v169, v242
    v_mfma_f32_32x32x16_bf16 v[154:169], v[66:69], v[86:89], 0
    v_exp_f32 v133, v133
    v_exp_f32 v134, v134
    v_exp_f32 v135, v135
    v_mfma_f32_32x32x16_bf16 v[154:169], v[64:67], v[82:85], v[154:169]
    buffer_load_dwordx2 v[96:97], v2, s[8:11], s62 offen offset:256 sc1
    v_exp_f32 v136, v136
    v_exp_f32 v137, v137
    v_cvt_pk_bf16_f32 v122, v122, v123
    v_cvt_pk_bf16_f32 v123, v124, v125
    v_cvt_pk_bf16_f32 v124, v126, v127
    v_cvt_pk_bf16_f32 v125, v128, v129
    v_cvt_pk_bf16_f32 v126, v130, v131
    v_cvt_pk_bf16_f32 v127, v132, v133
    v_mfma_f32_32x32x16_bf16 v[218:233], a[48:51], v[122:125], 0
    buffer_load_dwordx2 v[90:91], v3, s[8:11], s62 offen sc1
    v_cvt_pk_bf16_f32 v128, v134, v135
    v_cvt_pk_bf16_f32 v129, v136, v137
    v_max3_f32 v242, v170, v171, v242
    v_max3_f32 v243, v172, v173, v243
    v_max3_f32 v242, v174, v175, v242
    v_mfma_f32_32x32x16_bf16 v[218:233], a[52:55], v[126:129], v[218:233]
    v_max3_f32 v243, v176, v177, v243
    v_max3_f32 v242, v178, v179, v242
    v_max3_f32 v243, v180, v181, v243
    v_max3_f32 v242, v182, v183, v242
    buffer_load_dwordx2 v[42:43], v2, s[8:11], s63 offen sc1
    v_max3_f32 v243, v184, v185, v243
    v_exp_f32 v138, v138
    v_exp_f32 v139, v139
    v_exp_f32 v140, v140
    v_exp_f32 v141, v141
    v_exp_f32 v142, v142
    buffer_load_dwordx2 v[44:45], v2, s[8:11], s63 offen offset:256 sc1
    v_exp_f32 v143, v143
    buffer_load_dwordx4 v255, s[96:99], s100 offen offset:1024 sc1 lds
    v_exp_f32 v144, v144
    v_exp_f32 v145, v145
    v_exp_f32 v146, v146
    v_exp_f32 v147, v147
    v_exp_f32 v148, v148
    buffer_load_dwordx2 v[40:41], v3, s[8:11], s63 offen sc1
    v_mfma_f32_32x32x16_bf16 v[106:121], v[66:69], v[102:105], v[202:217]
    v_exp_f32 v149, v149
    v_exp_f32 v150, v150
    v_exp_f32 v151, v151
    v_mfma_f32_32x32x16_bf16 v[106:121], v[64:67], v[98:101], v[106:121]
    v_exp_f32 v152, v152
    buffer_load_dwordx4 a[112:115], v4, s[12:15], s64 offen sc1
    v_exp_f32 v153, v153
    v_cvt_pk_bf16_f32 v138, v138, v139
    v_cvt_pk_bf16_f32 v139, v140, v141
    v_cvt_pk_bf16_f32 v140, v142, v143
    v_cvt_pk_bf16_f32 v141, v144, v145
    v_cvt_pk_bf16_f32 v142, v146, v147
    v_cvt_pk_bf16_f32 v143, v148, v149
    v_mfma_f32_32x32x16_bf16 v[218:233], a[56:59], v[138:141], v[218:233]
    v_cvt_pk_bf16_f32 v144, v150, v151
    buffer_load_dwordx4 a[116:119], v5, s[12:15], s64 offen sc1
    v_cvt_pk_bf16_f32 v145, v152, v153
    v_max3_f32 v242, v154, v155, v242
    v_max3_f32 v243, v156, v157, v243
    v_max3_f32 v242, v158, v159, v242
    v_mfma_f32_32x32x16_bf16 v[218:233], a[60:63], v[142:145], v[218:233]
    v_max3_f32 v243, v160, v161, v243
    v_max3_f32 v242, v162, v163, v242
    v_max3_f32 v243, v164, v165, v243
    v_max3_f32 v242, v166, v167, v242
    v_max3_f32 v243, v168, v169, v243
    v_exp_f32 v106, v106
    v_mfma_f32_32x32x16_bf16 v[170:185], v[72:75], v[86:89], 0
    v_exp_f32 v107, v107
    v_exp_f32 v108, v108
    v_exp_f32 v109, v109
    v_mfma_f32_32x32x16_bf16 v[170:185], v[70:73], v[82:85], v[170:185]
    v_exp_f32 v110, v110
    v_exp_f32 v111, v111
    v_exp_f32 v112, v112
    v_mfma_f32_32x32x16_bf16 v[122:137], v[72:75], v[102:105], v[202:217]
    v_exp_f32 v113, v113
    v_exp_f32 v114, v114
    v_exp_f32 v115, v115
    v_mfma_f32_32x32x16_bf16 v[122:137], v[70:73], v[98:101], v[122:137]
    v_exp_f32 v116, v116
    v_exp_f32 v117, v117
    v_exp_f32 v118, v118
    v_mfma_f32_32x32x16_bf16 v[154:169], v[78:81], v[86:89], 0
    buffer_load_dwordx4 v255, s[96:99], s100 offen offset:2048 sc1 lds
    s_add_u32 s100, s100, 3072
    v_exp_f32 v119, v119
    v_exp_f32 v120, v120
    v_exp_f32 v121, v121
    v_mfma_f32_32x32x16_bf16 v[154:169], v[76:79], v[82:85], v[154:169]
    v_cvt_pk_bf16_f32 v106, v106, v107
    v_cvt_pk_bf16_f32 v107, v108, v109
    v_cvt_pk_bf16_f32 v108, v110, v111
    v_cvt_pk_bf16_f32 v109, v112, v113
    v_cvt_pk_bf16_f32 v110, v114, v115
    v_cvt_pk_bf16_f32 v111, v116, v117
    v_mfma_f32_32x32x16_bf16 v[218:233], a[64:67], v[106:109], v[218:233]
    v_cvt_pk_bf16_f32 v112, v118, v119
    v_cvt_pk_bf16_f32 v113, v120, v121
    v_max3_f32 v242, v170, v171, v242
    v_max3_f32 v243, v172, v173, v243
    v_max3_f32 v242, v174, v175, v242
    v_max3_f32 v243, v176, v177, v243
    v_mfma_f32_32x32x16_bf16 v[218:233], a[68:71], v[110:113], v[218:233]
    v_max3_f32 v242, v178, v179, v242
    v_max3_f32 v243, v180, v181, v243
    v_max3_f32 v242, v182, v183, v242
    v_max3_f32 v243, v184, v185, v243
    v_exp_f32 v122, v122
    v_mfma_f32_32x32x16_bf16 v[138:153], v[78:81], v[102:105], v[202:217]
    v_exp_f32 v123, v123
    v_exp_f32 v124, v124
    v_exp_f32 v125, v125
    v_mfma_f32_32x32x16_bf16 v[138:153], v[76:79], v[98:101], v[138:153]
    v_exp_f32 v126, v126
    v_exp_f32 v127, v127
    v_exp_f32 v128, v128
    v_mfma_f32_32x32x16_bf16 v[170:185], v[18:21], v[86:89], 0
    v_exp_f32 v129, v129
    v_exp_f32 v130, v130
    v_exp_f32 v131, v131
    v_mfma_f32_32x32x16_bf16 v[170:185], v[16:19], v[82:85], v[170:185]
    v_exp_f32 v132, v132
    v_exp_f32 v133, v133
    v_exp_f32 v134, v134
    v_mfma_f32_32x32x16_bf16 v[106:121], v[18:21], v[102:105], v[202:217]
    v_exp_f32 v135, v135
    v_exp_f32 v136, v136
    v_exp_f32 v137, v137
    v_mfma_f32_32x32x16_bf16 v[106:121], v[16:19], v[98:101], v[106:121]
    v_cvt_pk_bf16_f32 v122, v122, v123
    v_cvt_pk_bf16_f32 v123, v124, v125
    v_cvt_pk_bf16_f32 v124, v126, v127
    v_cvt_pk_bf16_f32 v125, v128, v129
    v_cvt_pk_bf16_f32 v126, v130, v131
    v_cvt_pk_bf16_f32 v127, v132, v133
    v_mfma_f32_32x32x16_bf16 v[218:233], a[72:75], v[122:125], v[218:233]
    v_cvt_pk_bf16_f32 v128, v134, v135
    s_add_u32 m0, s101, 79872
    s_nop 0
    buffer_load_dwordx4 v255, s[96:99], s100 offen offset:0 sc1 lds
    v_cvt_pk_bf16_f32 v129, v136, v137
    v_max3_f32 v242, v154, v155, v242
    v_max3_f32 v243, v156, v157, v243
    v_max3_f32 v242, v158, v159, v242
    v_max3_f32 v243, v160, v161, v243
    v_mfma_f32_32x32x16_bf16 v[218:233], a[76:79], v[126:129], v[218:233]
    v_max3_f32 v242, v162, v163, v242
    v_max3_f32 v243, v164, v165, v243
    v_max3_f32 v242, v166, v167, v242
    v_max3_f32 v243, v168, v169, v243
    v_exp_f32 v138, v138
    v_mfma_f32_32x32x16_bf16 v[154:169], v[24:27], v[86:89], 0
    v_exp_f32 v139, v139
    v_exp_f32 v140, v140
    v_exp_f32 v141, v141
    v_mfma_f32_32x32x16_bf16 v[154:169], v[22:25], v[82:85], v[154:169]
    v_exp_f32 v142, v142
    v_exp_f32 v143, v143
    v_exp_f32 v144, v144
    v_mfma_f32_32x32x16_bf16 v[122:137], v[24:27], v[102:105], v[202:217]
    v_exp_f32 v145, v145
    v_exp_f32 v146, v146
    v_exp_f32 v147, v147
    v_mfma_f32_32x32x16_bf16 v[122:137], v[22:25], v[98:101], v[122:137]
    v_exp_f32 v148, v148
    v_exp_f32 v149, v149
    v_exp_f32 v150, v150
    v_exp_f32 v151, v151
    v_exp_f32 v152, v152
    v_exp_f32 v153, v153
    v_cvt_pk_bf16_f32 v138, v138, v139
    v_cvt_pk_bf16_f32 v139, v140, v141
    v_cvt_pk_bf16_f32 v140, v142, v143
    v_cvt_pk_bf16_f32 v141, v144, v145
    v_cvt_pk_bf16_f32 v142, v146, v147
    v_cvt_pk_bf16_f32 v143, v148, v149
    v_mfma_f32_32x32x16_bf16 v[218:233], a[80:83], v[138:141], v[218:233]
    v_cvt_pk_bf16_f32 v144, v150, v151
    v_cvt_pk_bf16_f32 v145, v152, v153
    v_max3_f32 v242, v170, v171, v242
    v_max3_f32 v243, v172, v173, v243
    v_max3_f32 v242, v174, v175, v242
    v_max3_f32 v243, v176, v177, v243
    v_mfma_f32_32x32x16_bf16 v[218:233], a[84:87], v[142:145], v[218:233]
    v_max3_f32 v242, v178, v179, v242
    v_max3_f32 v243, v180, v181, v243
    v_max3_f32 v242, v182, v183, v242
    v_max3_f32 v243, v184, v185, v243
    v_exp_f32 v106, v106
    v_add_u32 v12, 64, v12
    v_mul_u32_u24 v13, 58255, v12
    v_lshrrev_b32 v13, 23, v13
    v_mul_u32_u24 v13, 144, v13
    v_add_u32 v13, v13, v12
    v_lshlrev_b32 v13, 7, v13
    buffer_load_dword v14, v13, s[96:99], s94 offen
    v_mfma_f32_32x32x16_bf16 v[170:185], v[30:33], v[86:89], 0
    v_exp_f32 v107, v107
    buffer_load_dwordx4 v255, s[96:99], s100 offen offset:1024 sc1 lds
    v_exp_f32 v108, v108
    v_exp_f32 v109, v109
    v_mfma_f32_32x32x16_bf16 v[170:185], v[28:31], v[82:85], v[170:185]
    v_exp_f32 v110, v110
    v_exp_f32 v111, v111
    v_exp_f32 v112, v112
    v_mfma_f32_32x32x16_bf16 v[138:153], v[48:51], v[102:105], v[202:217]
    v_exp_f32 v113, v113
    v_exp_f32 v114, v114
    v_exp_f32 v115, v115
    v_mfma_f32_32x32x16_bf16 v[138:153], v[46:49], v[98:101], v[138:153]
    v_exp_f32 v116, v116
    v_exp_f32 v117, v117
    v_exp_f32 v118, v118
    v_exp_f32 v119, v119
    v_exp_f32 v120, v120
    v_exp_f32 v121, v121
    v_cvt_pk_bf16_f32 v106, v106, v107
    v_cvt_pk_bf16_f32 v107, v108, v109
    v_cvt_pk_bf16_f32 v108, v110, v111
    v_cvt_pk_bf16_f32 v109, v112, v113
    v_cvt_pk_bf16_f32 v110, v114, v115
    v_cvt_pk_bf16_f32 v111, v116, v117
    v_mfma_f32_32x32x16_bf16 v[218:233], a[88:91], v[106:109], v[218:233]
    v_cvt_pk_bf16_f32 v112, v118, v119
    v_cvt_pk_bf16_f32 v113, v120, v121
    v_max3_f32 v242, v154, v155, v242
    v_max3_f32 v243, v156, v157, v243
    v_max3_f32 v242, v158, v159, v242
    v_max3_f32 v243, v160, v161, v243
    v_mfma_f32_32x32x16_bf16 v[218:233], a[92:95], v[110:113], v[218:233]
    v_max3_f32 v242, v162, v163, v242
    v_max3_f32 v243, v164, v165, v243
    v_max3_f32 v242, v166, v167, v242
    v_max3_f32 v243, v168, v169, v243
    v_exp_f32 v122, v122
    v_mfma_f32_32x32x16_bf16 v[106:121], v[30:33], v[102:105], v[202:217]
    v_exp_f32 v123, v123
    v_exp_f32 v124, v124
    v_exp_f32 v125, v125
    v_mfma_f32_32x32x16_bf16 v[106:121], v[28:31], v[98:101], v[106:121]
    v_exp_f32 v126, v126
    v_exp_f32 v127, v127
    v_exp_f32 v128, v128
    v_exp_f32 v129, v129
    v_exp_f32 v130, v130
    v_exp_f32 v131, v131
    v_exp_f32 v132, v132
    v_exp_f32 v133, v133
    v_exp_f32 v134, v134
    v_exp_f32 v135, v135
    v_exp_f32 v136, v136
    buffer_load_dwordx4 v255, s[96:99], s100 offen offset:2048 sc1 lds
    s_add_u32 s100, s100, 141312
    v_exp_f32 v137, v137
    v_cvt_pk_bf16_f32 v122, v122, v123
    v_cvt_pk_bf16_f32 v123, v124, v125
    v_cvt_pk_bf16_f32 v124, v126, v127
    v_cvt_pk_bf16_f32 v125, v128, v129
    v_cvt_pk_bf16_f32 v126, v130, v131
    v_cvt_pk_bf16_f32 v127, v132, v133
    v_mfma_f32_32x32x16_bf16 v[218:233], a[96:99], v[122:125], v[218:233]
    v_cvt_pk_bf16_f32 v128, v134, v135
    v_cvt_pk_bf16_f32 v129, v136, v137
    v_max3_f32 v242, v170, v171, v242
    v_max3_f32 v243, v172, v173, v243
    v_max3_f32 v242, v174, v175, v242
    v_max3_f32 v243, v176, v177, v243
    v_mfma_f32_32x32x16_bf16 v[218:233], a[100:103], v[126:129], v[218:233]
    v_max3_f32 v242, v178, v179, v242
    v_max3_f32 v243, v180, v181, v243
    v_max3_f32 v242, v182, v183, v242
    v_max3_f32 v243, v184, v185, v243
    v_cndmask_b32 v138, v138, v106, s[20:21]
    v_max_f32 v242, v242, v243
    v_cndmask_b32 v139, v139, v107, s[22:23]
    v_mov_b32 v243, v242
    s_waitcnt vmcnt(12)
    v_mfma_f32_32x32x16_bf16 v[154:169], v[60:63], v[94:97], 0
    v_permlane32_swap_b32 v242, v243
    global_load_dword v11, v10, s[86:87]
    v_cndmask_b32 v140, v140, v108, s[24:25]
    v_max_f32 v242, v242, v243
    v_cndmask_b32 v141, v141, v109, s[26:27]
    v_mul_f32 v186, -1.0, v242
    v_mul_f32 v187, -1.0, v242
    s_waitcnt vmcnt(9)
    v_mfma_f32_32x32x16_bf16 v[202:217], v[42:45], v[94:97], 0
    v_mul_f32 v188, -1.0, v242
    v_mul_f32 v189, -1.0, v242
    v_mul_f32 v190, -1.0, v242
    v_mul_f32 v191, -1.0, v242
    v_mul_f32 v192, -1.0, v242
    v_mul_f32 v193, -1.0, v242
    v_mul_f32 v194, -1.0, v242
    v_mul_f32 v195, -1.0, v242
    v_mul_f32 v196, -1.0, v242
    v_mul_f32 v197, -1.0, v242
    v_mul_f32 v198, -1.0, v242
    v_mul_f32 v199, -1.0, v242
    v_mul_f32 v200, -1.0, v242
    v_mul_f32 v201, -1.0, v242
    v_cndmask_b32 v142, v142, v110, s[28:29]
    v_cndmask_b32 v143, v143, v111, s[30:31]
    v_mfma_f32_32x32x16_bf16 v[122:137], v[60:63], v[86:89], v[186:201]
    v_cndmask_b32 v144, v144, v112, s[32:33]
    v_cndmask_b32 v145, v145, v113, s[34:35]
    v_cndmask_b32 v146, v146, v114, s[36:37]
    s_add_u32 m0, s101, 110592
    s_nop 0
    buffer_load_dwordx4 v255, s[96:99], s100 offen offset:0 sc1 lds
    v_cndmask_b32 v147, v147, v115, s[38:39]
    v_cndmask_b32 v148, v148, v116, s[46:47]
    v_cndmask_b32 v149, v149, v117, s[48:49]
    v_mfma_f32_32x32x16_bf16 v[122:137], v[58:61], v[82:85], v[122:137]
    v_cndmask_b32 v150, v150, v118, s[50:51]
    v_cndmask_b32 v151, v151, v119, s[52:53]
    v_cndmask_b32 v152, v152, v120, s[54:55]
    v_cndmask_b32 v153, v153, v121, s[56:57]
    v_exp_f32 v138, v138
    v_exp_f32 v139, v139
    v_exp_f32 v140, v140
    v_exp_f32 v141, v141
    v_exp_f32 v142, v142
    v_exp_f32 v143, v143
    v_exp_f32 v144, v144
    v_exp_f32 v145, v145
    v_exp_f32 v146, v146
    v_exp_f32 v147, v147
    v_exp_f32 v148, v148
    v_exp_f32 v149, v149
    v_exp_f32 v150, v150
    v_exp_f32 v151, v151
    v_exp_f32 v152, v152
    v_exp_f32 v153, v153
    v_cvt_pk_bf16_f32 v138, v138, v139
    v_mfma_f32_32x32x16_bf16 v[170:185], v[66:69], v[94:97], 0
    v_cvt_pk_bf16_f32 v139, v140, v141
    v_cvt_pk_bf16_f32 v140, v142, v143
    v_cvt_pk_bf16_f32 v141, v144, v145
    v_cvt_pk_bf16_f32 v142, v146, v147
    v_cvt_pk_bf16_f32 v143, v148, v149
    v_cvt_pk_bf16_f32 v144, v150, v151
    v_cvt_pk_bf16_f32 v145, v152, v153
    v_bfi_b32 v106, v234, 0, v138
    v_and_b32 v114, v234, v138
    v_bfi_b32 v107, v235, 0, v139
    v_and_b32 v115, v235, v139
    v_bfi_b32 v108, v236, 0, v140
    v_and_b32 v116, v236, v140
    v_bfi_b32 v109, v237, 0, v141
    v_and_b32 v117, v237, v141
    v_bfi_b32 v110, v238, 0, v142
    v_mfma_f32_32x32x16_bf16 v[218:233], a[40:43], v[106:109], v[218:233]
    v_and_b32 v118, v238, v142
    v_bfi_b32 v111, v239, 0, v143
    v_and_b32 v119, v239, v143
    v_bfi_b32 v112, v240, 0, v144
    v_and_b32 v120, v240, v144
    v_bfi_b32 v113, v241, 0, v145
    v_and_b32 v121, v241, v145
    s_mul_i32 s65, s42, 36864
    v_mfma_f32_32x32x16_bf16 v[218:233], a[44:47], v[110:113], v[218:233]
    buffer_load_dwordx4 v255, s[96:99], s100 offen offset:1024 sc1 lds
    s_add_u32 s65, s65, 184320
    s_mul_i32 s60, s42, 37376
    s_add_u32 s60, s60, 261632
    v_and_or_b32 v90, v90, s58, v8
    v_and_b32 v91, s59, v91
    v_exp_f32 v122, v122
    v_mfma_f32_32x32x16_bf16 v[218:233], a[104:107], v[114:117], v[218:233]
    v_exp_f32 v123, v123
    v_exp_f32 v124, v124
    v_exp_f32 v125, v125
    v_mfma_f32_32x32x16_bf16 v[218:233], a[108:111], v[118:121], v[218:233]
    v_exp_f32 v126, v126
    v_exp_f32 v127, v127
    v_exp_f32 v128, v128
    v_mfma_f32_32x32x16_bf16 v[154:169], v[58:61], v[90:93], v[154:169]
    v_exp_f32 v129, v129
    v_exp_f32 v130, v130
    v_exp_f32 v131, v131
    s_waitcnt vmcnt(9)
    v_mfma_f32_32x32x16_bf16 v[202:217], v[40:43], v[90:93], v[202:217]
    v_exp_f32 v132, v132
    s_nop 1
    v_rcp_f32 v244, v228
    v_exp_f32 v133, v133
    v_mfma_f32_32x32x16_bf16 v[170:185], v[64:67], v[90:93], v[170:185]
    v_mul_f32 v244, 0x40088e99, v244
    v_exp_f32 v134, v134
    v_mul_f32 v138, v218, v244
    v_mul_f32 v139, v219, v244
    v_mul_f32 v140, v220, v244
    v_mul_f32 v141, v221, v244
    v_mul_f32 v142, v222, v244
    v_mul_f32 v143, v223, v244
    v_mul_f32 v144, v224, v244
    v_mul_f32 v145, v225, v244
    v_mul_f32 v146, v226, v244
    v_mul_f32 v147, v227, v244
    v_cvt_pk_bf16_f32 v246, v138, v139
    v_cvt_pk_bf16_f32 v247, v140, v141
    v_cvt_pk_bf16_f32 v248, v142, v143
    v_cvt_pk_bf16_f32 v249, v144, v145
    v_cvt_pk_bf16_f32 v250, v146, v147
    v_mfma_f32_32x32x16_bf16 v[138:153], v[66:69], v[86:89], v[186:201]
    buffer_store_dwordx4 v[246:249], v6, s[16:19], s65 offen sc1
    v_cndmask_b32 v154, v154, v202, s[20:21]
    v_cndmask_b32 v155, v155, v203, s[22:23]
    v_cndmask_b32 v156, v156, v204, s[24:25]
    v_cndmask_b32 v157, v157, v205, s[26:27]
    v_cndmask_b32 v158, v158, v206, s[28:29]
    v_add_u32 v12, 64, v12
    v_mul_u32_u24 v13, 58255, v12
    v_lshrrev_b32 v13, 23, v13
    v_mul_u32_u24 v13, 144, v13
    v_add_u32 v13, v13, v12
    v_lshlrev_b32 v13, 7, v13
    buffer_load_dword v14, v13, s[96:99], s94 offen
    v_mfma_f32_32x32x16_bf16 v[138:153], v[64:67], v[82:85], v[138:153]
    v_cndmask_b32 v159, v159, v207, s[30:31]
    v_cndmask_b32 v160, v160, v208, s[32:33]
    v_cndmask_b32 v161, v161, v209, s[34:35]
    buffer_load_dwordx4 v255, s[96:99], s100 offen offset:2048 sc1 lds
    s_add_u32 s100, s100, 3072
    v_cndmask_b32 v162, v162, v210, s[36:37]
    buffer_store_dword v250, v7, s[16:19], s65 offen sc1
    v_cndmask_b32 v163, v163, v211, s[38:39]
    v_mfma_f32_32x32x16_bf16 v[106:121], v[72:75], v[86:89], v[186:201]
    v_cndmask_b32 v164, v164, v212, s[46:47]
    v_cndmask_b32 v165, v165, v213, s[48:49]
    v_cndmask_b32 v166, v166, v214, s[50:51]
    v_cndmask_b32 v167, v167, v215, s[52:53]
    v_cndmask_b32 v168, v168, v216, s[54:55]
    v_cndmask_b32 v169, v169, v217, s[56:57]
    v_mfma_f32_32x32x16_bf16 v[106:121], v[70:73], v[82:85], v[106:121]
    buffer_load_dwordx4 a[120:123], v4, s[12:15], s60 offen sc1
    v_max3_f32 v242, v154, v155, v156
    v_max3_f32 v243, v157, v158, v159
    v_max3_f32 v242, v160, v161, v242
    v_max3_f32 v243, v162, v163, v243
    v_max3_f32 v242, v164, v165, v242
    v_max3_f32 v243, v166, v167, v243
    v_max3_f32 v242, v168, v169, v242
    v_mfma_f32_32x32x16_bf16 v[154:169], v[72:75], v[94:97], 0
    v_exp_f32 v135, v135
    buffer_load_dwordx4 a[124:127], v5, s[12:15], s60 offen sc1
    v_exp_f32 v136, v136
    v_exp_f32 v137, v137
    v_mfma_f32_32x32x16_bf16 v[154:169], v[70:73], v[90:93], v[154:169]
    v_cvt_pk_bf16_f32 v122, v122, v123
    v_cvt_pk_bf16_f32 v123, v124, v125
    v_cvt_pk_bf16_f32 v124, v126, v127
    v_cvt_pk_bf16_f32 v125, v128, v129
    v_cvt_pk_bf16_f32 v126, v130, v131
    v_cvt_pk_bf16_f32 v127, v132, v133
    v_mfma_f32_32x32x16_bf16 v[218:233], a[56:59], v[122:125], 0
    v_cvt_pk_bf16_f32 v128, v134, v135
    v_cvt_pk_bf16_f32 v129, v136, v137
    v_max3_f32 v242, v170, v171, v242
    v_max3_f32 v243, v172, v173, v243
    v_max3_f32 v242, v174, v175, v242
    v_max3_f32 v243, v176, v177, v243
    v_mfma_f32_32x32x16_bf16 v[218:233], a[60:63], v[126:129], v[218:233]
    v_max3_f32 v242, v178, v179, v242
    v_max3_f32 v243, v180, v181, v243
    v_max3_f32 v242, v182, v183, v242
    v_max3_f32 v243, v184, v185, v243
    v_exp_f32 v138, v138
    v_mfma_f32_32x32x16_bf16 v[170:185], v[78:81], v[94:97], 0
    v_exp_f32 v139, v139
    v_exp_f32 v140, v140
    v_exp_f32 v141, v141
    v_mfma_f32_32x32x16_bf16 v[170:185], v[76:79], v[90:93], v[170:185]
    v_exp_f32 v142, v142
    v_exp_f32 v143, v143
    v_exp_f32 v144, v144
    s_add_u32 m0, s101, 113664
    s_nop 0
    buffer_load_dwordx4 v255, s[96:99], s100 offen offset:0 sc1 lds
    v_mfma_f32_32x32x16_bf16 v[122:137], v[78:81], v[86:89], v[186:201]
    v_exp_f32 v145, v145
    v_exp_f32 v146, v146
    v_exp_f32 v147, v147
    v_mfma_f32_32x32x16_bf16 v[122:137], v[76:79], v[82:85], v[122:137]
    v_exp_f32 v148, v148
    v_exp_f32 v149, v149
    v_exp_f32 v150, v150
    v_exp_f32 v151, v151
    v_exp_f32 v152, v152
    v_exp_f32 v153, v153
    v_cvt_pk_bf16_f32 v138, v138, v139
    v_cvt_pk_bf16_f32 v139, v140, v141
    v_cvt_pk_bf16_f32 v140, v142, v143
    v_cvt_pk_bf16_f32 v141, v144, v145
    v_cvt_pk_bf16_f32 v142, v146, v147
    v_cvt_pk_bf16_f32 v143, v148, v149
    v_mfma_f32_32x32x16_bf16 v[218:233], a[64:67], v[138:141], v[218:233]
    v_cvt_pk_bf16_f32 v144, v150, v151
    v_cvt_pk_bf16_f32 v145, v152, v153
    v_max3_f32 v242, v154, v155, v242
    v_max3_f32 v243, v156, v157, v243
    v_max3_f32 v242, v158, v159, v242
    v_max3_f32 v243, v160, v161, v243
    v_mfma_f32_32x32x16_bf16 v[218:233], a[68:71], v[142:145], v[218:233]
    v_max3_f32 v242, v162, v163, v242
    v_max3_f32 v243, v164, v165, v243
    v_max3_f32 v242, v166, v167, v242
    v_max3_f32 v243, v168, v169, v243
    v_exp_f32 v106, v106
    v_mfma_f32_32x32x16_bf16 v[154:169], v[18:21], v[94:97], 0
    v_exp_f32 v107, v107
    v_exp_f32 v108, v108
    v_exp_f32 v109, v109
    v_mfma_f32_32x32x16_bf16 v[154:169], v[16:19], v[90:93], v[154:169]
    v_exp_f32 v110, v110
    v_exp_f32 v111, v111
    v_exp_f32 v112, v112
    v_mfma_f32_32x32x16_bf16 v[138:153], v[18:21], v[86:89], v[186:201]
    v_exp_f32 v113, v113
    v_exp_f32 v114, v114
    v_exp_f32 v115, v115
    v_mfma_f32_32x32x16_bf16 v[138:153], v[16:19], v[82:85], v[138:153]
    v_exp_f32 v116, v116
    v_exp_f32 v117, v117
    v_exp_f32 v118, v118
    v_exp_f32 v119, v119
    v_exp_f32 v120, v120
    v_exp_f32 v121, v121
    v_cvt_pk_bf16_f32 v106, v106, v107
    v_cvt_pk_bf16_f32 v107, v108, v109
    buffer_load_dwordx4 v255, s[96:99], s100 offen offset:1024 sc1 lds
    v_cvt_pk_bf16_f32 v108, v110, v111
    v_cvt_pk_bf16_f32 v109, v112, v113
    v_cvt_pk_bf16_f32 v110, v114, v115
    v_cvt_pk_bf16_f32 v111, v116, v117
    v_mfma_f32_32x32x16_bf16 v[218:233], a[72:75], v[106:109], v[218:233]
    v_cvt_pk_bf16_f32 v112, v118, v119
    v_cvt_pk_bf16_f32 v113, v120, v121
    v_max3_f32 v242, v170, v171, v242
    v_max3_f32 v243, v172, v173, v243
    v_max3_f32 v242, v174, v175, v242
    v_max3_f32 v243, v176, v177, v243
    v_mfma_f32_32x32x16_bf16 v[218:233], a[76:79], v[110:113], v[218:233]
    v_max3_f32 v242, v178, v179, v242
    v_max3_f32 v243, v180, v181, v243
    v_max3_f32 v242, v182, v183, v242
    v_max3_f32 v243, v184, v185, v243
    v_exp_f32 v122, v122
    v_mfma_f32_32x32x16_bf16 v[170:185], v[24:27], v[94:97], 0
    v_exp_f32 v123, v123
    v_exp_f32 v124, v124
    v_exp_f32 v125, v125
    v_mfma_f32_32x32x16_bf16 v[170:185], v[22:25], v[90:93], v[170:185]
    v_exp_f32 v126, v126
    v_exp_f32 v127, v127
    v_exp_f32 v128, v128
    v_mfma_f32_32x32x16_bf16 v[106:121], v[24:27], v[86:89], v[186:201]
    v_exp_f32 v129, v129
    v_exp_f32 v130, v130
    v_exp_f32 v131, v131
    v_mfma_f32_32x32x16_bf16 v[106:121], v[22:25], v[82:85], v[106:121]
    v_exp_f32 v132, v132
    v_exp_f32 v133, v133
    v_exp_f32 v134, v134
    v_exp_f32 v135, v135
    v_exp_f32 v136, v136
    v_exp_f32 v137, v137
    v_cvt_pk_bf16_f32 v122, v122, v123
    v_cvt_pk_bf16_f32 v123, v124, v125
    v_cvt_pk_bf16_f32 v124, v126, v127
    v_cvt_pk_bf16_f32 v125, v128, v129
    v_cvt_pk_bf16_f32 v126, v130, v131
    v_cvt_pk_bf16_f32 v127, v132, v133
    v_mfma_f32_32x32x16_bf16 v[218:233], a[80:83], v[122:125], v[218:233]
    v_cvt_pk_bf16_f32 v128, v134, v135
    v_cvt_pk_bf16_f32 v129, v136, v137
    v_max3_f32 v242, v154, v155, v242
    v_max3_f32 v243, v156, v157, v243
    v_max3_f32 v242, v158, v159, v242
    v_max3_f32 v243, v160, v161, v243
    v_mfma_f32_32x32x16_bf16 v[218:233], a[84:87], v[126:129], v[218:233]
    v_max3_f32 v242, v162, v163, v242
    v_max3_f32 v243, v164, v165, v243
    buffer_load_dwordx4 v255, s[96:99], s100 offen offset:2048 sc1 lds
    s_add_u32 s100, s100, 3072
    v_max3_f32 v242, v166, v167, v242
    v_max3_f32 v243, v168, v169, v243
    v_exp_f32 v138, v138
    v_mfma_f32_32x32x16_bf16 v[154:169], v[30:33], v[94:97], 0
    v_exp_f32 v139, v139
    v_exp_f32 v140, v140
    v_exp_f32 v141, v141
    v_mfma_f32_32x32x16_bf16 v[154:169], v[28:31], v[90:93], v[154:169]
    v_exp_f32 v142, v142
    v_exp_f32 v143, v143
    v_exp_f32 v144, v144
    v_mfma_f32_32x32x16_bf16 v[122:137], v[30:33], v[86:89], v[186:201]
    v_exp_f32 v145, v145
    v_exp_f32 v146, v146
    v_exp_f32 v147, v147
    v_mfma_f32_32x32x16_bf16 v[122:137], v[28:31], v[82:85], v[122:137]
    v_exp_f32 v148, v148
    v_exp_f32 v149, v149
    v_exp_f32 v150, v150
    v_exp_f32 v151, v151
    v_exp_f32 v152, v152
    v_exp_f32 v153, v153
    v_cvt_pk_bf16_f32 v138, v138, v139
    v_cvt_pk_bf16_f32 v139, v140, v141
    v_cvt_pk_bf16_f32 v140, v142, v143
    v_cvt_pk_bf16_f32 v141, v144, v145
    v_cvt_pk_bf16_f32 v142, v146, v147
    v_cvt_pk_bf16_f32 v143, v148, v149
    v_mfma_f32_32x32x16_bf16 v[218:233], a[88:91], v[138:141], v[218:233]
    v_cvt_pk_bf16_f32 v144, v150, v151
    v_cvt_pk_bf16_f32 v145, v152, v153
    v_max3_f32 v242, v170, v171, v242
    v_max3_f32 v243, v172, v173, v243
    v_max3_f32 v242, v174, v175, v242
    v_max3_f32 v243, v176, v177, v243
    v_mfma_f32_32x32x16_bf16 v[218:233], a[92:95], v[142:145], v[218:233]
    v_max3_f32 v242, v178, v179, v242
    v_max3_f32 v243, v180, v181, v243
    v_max3_f32 v242, v182, v183, v242
    v_max3_f32 v243, v184, v185, v243
    v_exp_f32 v106, v106
    v_mfma_f32_32x32x16_bf16 v[170:185], v[36:39], v[94:97], 0
    v_exp_f32 v107, v107
    v_add_u32 v12, 4, v12
    v_mul_u32_u24 v13, 58255, v12
    v_lshrrev_b32 v13, 23, v13
    v_mul_u32_u24 v13, 144, v13
    v_add_u32 v13, v13, v12
    v_lshlrev_b32 v13, 7, v13
    buffer_load_dword v14, v13, s[96:99], s94 offen
    v_exp_f32 v108, v108
    v_exp_f32 v109, v109
    v_mfma_f32_32x32x16_bf16 v[170:185], v[34:37], v[90:93], v[170:185]
    v_exp_f32 v110, v110
    v_exp_f32 v111, v111
    v_exp_f32 v112, v112
    v_mfma_f32_32x32x16_bf16 v[138:153], v[54:57], v[86:89], v[186:201]
    v_exp_f32 v113, v113
    s_add_u32 m0, s101, 116736
    s_nop 0
    buffer_load_dwordx4 v255, s[96:99], s100 offen offset:0 sc1 lds
    v_exp_f32 v114, v114
    v_exp_f32 v115, v115
    v_mfma_f32_32x32x16_bf16 v[138:153], v[52:55], v[82:85], v[138:153]
    v_exp_f32 v116, v116
    v_exp_f32 v117, v117
    v_exp_f32 v118, v118
    v_exp_f32 v119, v119
    v_exp_f32 v120, v120
    v_exp_f32 v121, v121
    v_cvt_pk_bf16_f32 v106, v106, v107
    v_cvt_pk_bf16_f32 v107, v108, v109
    v_cvt_pk_bf16_f32 v108, v110, v111
    v_cvt_pk_bf16_f32 v109, v112, v113
    v_cvt_pk_bf16_f32 v110, v114, v115
    v_cvt_pk_bf16_f32 v111, v116, v117
    v_mfma_f32_32x32x16_bf16 v[218:233], a[96:99], v[106:109], v[218:233]
    v_cvt_pk_bf16_f32 v112, v118, v119
    v_cvt_pk_bf16_f32 v113, v120, v121
    v_max3_f32 v242, v154, v155, v242
    v_max3_f32 v243, v156, v157, v243
    v_max3_f32 v242, v158, v159, v242
    v_max3_f32 v243, v160, v161, v243
    v_mfma_f32_32x32x16_bf16 v[218:233], a[100:103], v[110:113], v[218:233]
    v_max3_f32 v242, v162, v163, v242
    v_max3_f32 v243, v164, v165, v243
    v_max3_f32 v242, v166, v167, v242
    v_max3_f32 v243, v168, v169, v243
    v_exp_f32 v122, v122
    v_mfma_f32_32x32x16_bf16 v[106:121], v[36:39], v[86:89], v[186:201]
    v_exp_f32 v123, v123
    v_exp_f32 v124, v124
    v_exp_f32 v125, v125
    v_mfma_f32_32x32x16_bf16 v[106:121], v[34:37], v[82:85], v[106:121]
    v_exp_f32 v126, v126
    v_exp_f32 v127, v127
    v_exp_f32 v128, v128
    v_exp_f32 v129, v129
    v_exp_f32 v130, v130
    v_exp_f32 v131, v131
    v_exp_f32 v132, v132
    v_exp_f32 v133, v133
    v_exp_f32 v134, v134
    v_exp_f32 v135, v135
    v_exp_f32 v136, v136
    v_exp_f32 v137, v137
    v_cvt_pk_bf16_f32 v122, v122, v123
    v_cvt_pk_bf16_f32 v123, v124, v125
    v_cvt_pk_bf16_f32 v124, v126, v127
    v_cvt_pk_bf16_f32 v125, v128, v129
    v_cvt_pk_bf16_f32 v126, v130, v131
    v_cvt_pk_bf16_f32 v127, v132, v133
    v_mfma_f32_32x32x16_bf16 v[218:233], a[104:107], v[122:125], v[218:233]
    buffer_load_dwordx4 v255, s[96:99], s100 offen offset:1024 sc1 lds
    v_cvt_pk_bf16_f32 v128, v134, v135
    v_cvt_pk_bf16_f32 v129, v136, v137
    v_max3_f32 v242, v170, v171, v242
    v_max3_f32 v243, v172, v173, v243
    v_max3_f32 v242, v174, v175, v242
    v_max3_f32 v243, v176, v177, v243
    v_mfma_f32_32x32x16_bf16 v[218:233], a[108:111], v[126:129], v[218:233]
    v_max3_f32 v242, v178, v179, v242
    v_max3_f32 v243, v180, v181, v243
    v_max3_f32 v242, v182, v183, v242
    v_max3_f32 v243, v184, v185, v243
    v_cndmask_b32 v138, v138, v106, s[20:21]
    v_max_f32 v242, v242, v243
    v_cndmask_b32 v139, v139, v107, s[22:23]
    v_mov_b32 v243, v242
    v_cndmask_b32 v140, v140, v108, s[24:25]
    v_cndmask_b32 v141, v141, v109, s[26:27]
    v_permlane32_swap_b32 v242, v243
    global_load_dword v11, v10, s[86:87]
    v_cndmask_b32 v142, v142, v110, s[28:29]
    v_max_f32 v242, v242, v243
    v_cndmask_b32 v143, v143, v111, s[30:31]
    v_mul_f32 v202, -1.0, v242
    v_mul_f32 v203, -1.0, v242
    v_mul_f32 v204, -1.0, v242
    v_mul_f32 v205, -1.0, v242
    v_mul_f32 v206, -1.0, v242
    v_mul_f32 v207, -1.0, v242
    v_mul_f32 v208, -1.0, v242
    v_mul_f32 v209, -1.0, v242
    v_mul_f32 v210, -1.0, v242
    v_mul_f32 v211, -1.0, v242
    v_mul_f32 v212, -1.0, v242
    v_mul_f32 v213, -1.0, v242
    v_mul_f32 v214, -1.0, v242
    v_mul_f32 v215, -1.0, v242
    v_mul_f32 v216, -1.0, v242
    v_mul_f32 v217, -1.0, v242
    v_cndmask_b32 v144, v144, v112, s[32:33]
    v_cndmask_b32 v145, v145, v113, s[34:35]
    v_mfma_f32_32x32x16_bf16 v[122:137], v[66:69], v[94:97], v[202:217]
    v_cndmask_b32 v146, v146, v114, s[36:37]
    v_cndmask_b32 v147, v147, v115, s[38:39]
    v_cndmask_b32 v148, v148, v116, s[46:47]
    v_cndmask_b32 v149, v149, v117, s[48:49]
    v_cndmask_b32 v150, v150, v118, s[50:51]
    v_cndmask_b32 v151, v151, v119, s[52:53]
    v_mfma_f32_32x32x16_bf16 v[122:137], v[64:67], v[90:93], v[122:137]
    v_cndmask_b32 v152, v152, v120, s[54:55]
    v_cndmask_b32 v153, v153, v121, s[56:57]
    v_exp_f32 v138, v138
    v_exp_f32 v139, v139
    buffer_load_dwordx4 v255, s[96:99], s100 offen offset:2048 sc1 lds
    s_add_u32 s100, s100, 141312
    v_exp_f32 v140, v140
    v_exp_f32 v141, v141
    v_exp_f32 v142, v142
    v_exp_f32 v143, v143
    v_exp_f32 v144, v144
    v_exp_f32 v145, v145
    v_exp_f32 v146, v146
    v_exp_f32 v147, v147
    v_exp_f32 v148, v148
    v_exp_f32 v149, v149
    v_exp_f32 v150, v150
    v_exp_f32 v151, v151
    v_exp_f32 v152, v152
    v_exp_f32 v153, v153
    v_cvt_pk_bf16_f32 v138, v138, v139
    v_cvt_pk_bf16_f32 v139, v140, v141
    v_cvt_pk_bf16_f32 v140, v142, v143
    v_cvt_pk_bf16_f32 v141, v144, v145
    v_cvt_pk_bf16_f32 v142, v146, v147
    v_cvt_pk_bf16_f32 v143, v148, v149
    v_cvt_pk_bf16_f32 v144, v150, v151
    v_cvt_pk_bf16_f32 v145, v152, v153
    v_bfi_b32 v106, v234, 0, v138
    v_and_b32 v114, v234, v138
    v_bfi_b32 v107, v235, 0, v139
    v_and_b32 v115, v235, v139
    v_bfi_b32 v108, v236, 0, v140
    v_and_b32 v116, v236, v140
    v_bfi_b32 v109, v237, 0, v141
    v_and_b32 v117, v237, v141
    v_bfi_b32 v110, v238, 0, v142
    v_mfma_f32_32x32x16_bf16 v[218:233], a[48:51], v[106:109], v[218:233]
    v_and_b32 v118, v238, v142
    v_bfi_b32 v111, v239, 0, v143
    v_and_b32 v119, v239, v143
    v_bfi_b32 v112, v240, 0, v144
    v_and_b32 v120, v240, v144
    v_bfi_b32 v113, v241, 0, v145
    v_and_b32 v121, v241, v145
    s_mul_i32 s61, s42, 36864
    v_mfma_f32_32x32x16_bf16 v[218:233], a[52:55], v[110:113], v[218:233]
    s_add_u32 s61, s61, 221184
    v_exp_f32 v122, v122
    v_exp_f32 v123, v123
    v_exp_f32 v124, v124
    s_waitcnt vmcnt(21)
    v_mfma_f32_32x32x16_bf16 v[218:233], a[112:115], v[114:117], v[218:233]
    v_exp_f32 v125, v125
    v_exp_f32 v126, v126
    v_exp_f32 v127, v127
    s_waitcnt vmcnt(20)
    v_mfma_f32_32x32x16_bf16 v[218:233], a[116:119], v[118:121], v[218:233]
    v_exp_f32 v128, v128
    v_exp_f32 v129, v129
    v_exp_f32 v130, v130
    v_mfma_f32_32x32x16_bf16 v[106:121], v[78:81], v[94:97], v[202:217]
    v_exp_f32 v131, v131
    v_exp_f32 v132, v132
    v_exp_f32 v133, v133
    v_mfma_f32_32x32x16_bf16 v[106:121], v[76:79], v[90:93], v[106:121]
    v_exp_f32 v134, v134
    s_nop 2
    v_rcp_f32 v244, v228
    v_exp_f32 v135, v135
    v_mul_f32 v244, 0x40088e99, v244
    v_exp_f32 v136, v136
    v_mul_f32 v138, v218, v244
    v_mul_f32 v139, v219, v244
    v_mul_f32 v140, v220, v244
    v_mul_f32 v141, v221, v244
    v_mul_f32 v142, v222, v244
    v_mul_f32 v143, v223, v244
    v_mul_f32 v144, v224, v244
    v_mul_f32 v145, v225, v244
    v_mul_f32 v146, v226, v244
    v_mul_f32 v147, v227, v244
    v_cvt_pk_bf16_f32 v246, v138, v139
    v_cvt_pk_bf16_f32 v247, v140, v141
    v_cvt_pk_bf16_f32 v248, v142, v143
    v_cvt_pk_bf16_f32 v249, v144, v145
    v_cvt_pk_bf16_f32 v250, v146, v147
    v_mfma_f32_32x32x16_bf16 v[138:153], v[72:75], v[94:97], v[202:217]
    buffer_store_dwordx4 v[246:249], v6, s[16:19], s61 offen sc1
    v_exp_f32 v137, v137
    v_cvt_pk_bf16_f32 v122, v122, v123
    v_cvt_pk_bf16_f32 v123, v124, v125
    v_cvt_pk_bf16_f32 v124, v126, v127
    v_mfma_f32_32x32x16_bf16 v[138:153], v[70:73], v[90:93], v[138:153]
    v_cvt_pk_bf16_f32 v125, v128, v129
    v_cvt_pk_bf16_f32 v126, v130, v131
    v_cvt_pk_bf16_f32 v127, v132, v133
    v_cvt_pk_bf16_f32 v128, v134, v135
    buffer_store_dword v250, v7, s[16:19], s61 offen sc1
    v_cvt_pk_bf16_f32 v129, v136, v137
    v_mfma_f32_32x32x16_bf16 v[218:233], a[64:67], v[122:125], 0
    v_exp_f32 v106, v106
    v_exp_f32 v107, v107
    v_exp_f32 v108, v108
    v_mfma_f32_32x32x16_bf16 v[218:233], a[68:71], v[126:129], v[218:233]
    v_exp_f32 v109, v109
    v_exp_f32 v138, v138
    v_exp_f32 v139, v139
    v_mfma_f32_32x32x16_bf16 v[122:137], v[18:21], v[94:97], v[202:217]
    v_exp_f32 v140, v140
    v_exp_f32 v141, v141
    v_exp_f32 v142, v142
    v_mfma_f32_32x32x16_bf16 v[122:137], v[16:19], v[90:93], v[122:137]
    v_exp_f32 v143, v143
    v_exp_f32 v144, v144
    v_exp_f32 v145, v145
    v_exp_f32 v146, v146
    v_exp_f32 v147, v147
    v_exp_f32 v148, v148
    v_exp_f32 v149, v149
    v_exp_f32 v150, v150
    v_exp_f32 v151, v151
    v_exp_f32 v152, v152
    v_exp_f32 v153, v153
    v_cvt_pk_bf16_f32 v138, v138, v139
    v_cvt_pk_bf16_f32 v139, v140, v141
    v_cvt_pk_bf16_f32 v140, v142, v143
    v_cvt_pk_bf16_f32 v141, v144, v145
    v_cvt_pk_bf16_f32 v142, v146, v147
    v_cvt_pk_bf16_f32 v143, v148, v149
    v_mfma_f32_32x32x16_bf16 v[218:233], a[72:75], v[138:141], v[218:233]
    v_cvt_pk_bf16_f32 v144, v150, v151
    v_cvt_pk_bf16_f32 v145, v152, v153
    v_exp_f32 v110, v110
    v_exp_f32 v111, v111
    v_mfma_f32_32x32x16_bf16 v[218:233], a[76:79], v[142:145], v[218:233]
    v_exp_f32 v112, v112
    v_exp_f32 v113, v113
    v_exp_f32 v114, v114
    v_mfma_f32_32x32x16_bf16 v[138:153], v[24:27], v[94:97], v[202:217]
    v_exp_f32 v115, v115
    v_exp_f32 v116, v116
    v_exp_f32 v117, v117
    v_mfma_f32_32x32x16_bf16 v[138:153], v[22:25], v[90:93], v[138:153]
    v_exp_f32 v118, v118
    v_exp_f32 v119, v119
    v_exp_f32 v120, v120
    v_exp_f32 v121, v121
    v_cvt_pk_bf16_f32 v106, v106, v107
    v_cvt_pk_bf16_f32 v107, v108, v109
    v_cvt_pk_bf16_f32 v108, v110, v111
    v_cvt_pk_bf16_f32 v109, v112, v113
    v_cvt_pk_bf16_f32 v110, v114, v115
    v_cvt_pk_bf16_f32 v111, v116, v117
    v_mfma_f32_32x32x16_bf16 v[218:233], a[80:83], v[106:109], v[218:233]
    v_cvt_pk_bf16_f32 v112, v118, v119
    v_cvt_pk_bf16_f32 v113, v120, v121
    v_exp_f32 v122, v122
    v_exp_f32 v123, v123
    v_mfma_f32_32x32x16_bf16 v[218:233], a[84:87], v[110:113], v[218:233]
    v_exp_f32 v124, v124
    v_exp_f32 v125, v125
    v_exp_f32 v126, v126
    v_mfma_f32_32x32x16_bf16 v[106:121], v[30:33], v[94:97], v[202:217]
    v_exp_f32 v127, v127
    v_exp_f32 v128, v128
    v_exp_f32 v129, v129
    v_mfma_f32_32x32x16_bf16 v[106:121], v[28:31], v[90:93], v[106:121]
    v_exp_f32 v130, v130
    v_exp_f32 v131, v131
    v_exp_f32 v132, v132
    v_exp_f32 v133, v133
    v_exp_f32 v134, v134
    v_exp_f32 v135, v135
    v_exp_f32 v136, v136
    v_exp_f32 v137, v137
    v_cvt_pk_bf16_f32 v122, v122, v123
    v_cvt_pk_bf16_f32 v123, v124, v125
    v_cvt_pk_bf16_f32 v124, v126, v127
    v_cvt_pk_bf16_f32 v125, v128, v129
    v_cvt_pk_bf16_f32 v126, v130, v131
    v_cvt_pk_bf16_f32 v127, v132, v133
    v_mfma_f32_32x32x16_bf16 v[218:233], a[88:91], v[122:125], v[218:233]
    v_cvt_pk_bf16_f32 v128, v134, v135
    v_cvt_pk_bf16_f32 v129, v136, v137
    v_exp_f32 v138, v138
    v_exp_f32 v139, v139
    v_mfma_f32_32x32x16_bf16 v[218:233], a[92:95], v[126:129], v[218:233]
    v_exp_f32 v140, v140
    v_exp_f32 v141, v141
    v_exp_f32 v142, v142
    v_mfma_f32_32x32x16_bf16 v[122:137], v[36:39], v[94:97], v[202:217]
    v_exp_f32 v143, v143
    v_exp_f32 v144, v144
    v_exp_f32 v145, v145
    v_mfma_f32_32x32x16_bf16 v[122:137], v[34:37], v[90:93], v[122:137]
    v_exp_f32 v146, v146
    v_exp_f32 v147, v147
    v_exp_f32 v148, v148
    v_exp_f32 v149, v149
    v_exp_f32 v150, v150
    v_exp_f32 v151, v151
    v_exp_f32 v152, v152
    v_exp_f32 v153, v153
    v_cvt_pk_bf16_f32 v138, v138, v139
    v_cvt_pk_bf16_f32 v139, v140, v141
    v_cvt_pk_bf16_f32 v140, v142, v143
    v_cvt_pk_bf16_f32 v141, v144, v145
    v_cvt_pk_bf16_f32 v142, v146, v147
    v_cvt_pk_bf16_f32 v143, v148, v149
    v_mfma_f32_32x32x16_bf16 v[218:233], a[96:99], v[138:141], v[218:233]
    v_cvt_pk_bf16_f32 v144, v150, v151
    v_cvt_pk_bf16_f32 v145, v152, v153
    v_exp_f32 v106, v106
    v_exp_f32 v107, v107
    v_mfma_f32_32x32x16_bf16 v[218:233], a[100:103], v[142:145], v[218:233]
    v_exp_f32 v108, v108
    v_exp_f32 v109, v109
    v_exp_f32 v110, v110
    v_mfma_f32_32x32x16_bf16 v[138:153], v[60:63], v[94:97], v[202:217]
    v_exp_f32 v111, v111
    v_exp_f32 v112, v112
    v_exp_f32 v113, v113
    v_mfma_f32_32x32x16_bf16 v[138:153], v[58:61], v[90:93], v[138:153]
    v_exp_f32 v114, v114
    v_exp_f32 v115, v115
    v_exp_f32 v116, v116
    v_exp_f32 v117, v117
    v_exp_f32 v118, v118
    v_exp_f32 v119, v119
    v_exp_f32 v120, v120
    v_exp_f32 v121, v121
    v_cvt_pk_bf16_f32 v106, v106, v107
    v_cvt_pk_bf16_f32 v107, v108, v109
    v_cvt_pk_bf16_f32 v108, v110, v111
    v_cvt_pk_bf16_f32 v109, v112, v113
    v_cvt_pk_bf16_f32 v110, v114, v115
    v_cvt_pk_bf16_f32 v111, v116, v117
    v_mfma_f32_32x32x16_bf16 v[218:233], a[104:107], v[106:109], v[218:233]
    v_cvt_pk_bf16_f32 v112, v118, v119
    v_cvt_pk_bf16_f32 v113, v120, v121
    v_exp_f32 v122, v122
    v_exp_f32 v123, v123
    v_mfma_f32_32x32x16_bf16 v[218:233], a[108:111], v[110:113], v[218:233]
    v_exp_f32 v124, v124
    v_exp_f32 v125, v125
    v_exp_f32 v126, v126
    v_mfma_f32_32x32x16_bf16 v[106:121], v[42:45], v[94:97], v[202:217]
    v_exp_f32 v127, v127
    v_exp_f32 v128, v128
    v_exp_f32 v129, v129
    v_mfma_f32_32x32x16_bf16 v[106:121], v[40:43], v[90:93], v[106:121]
    v_exp_f32 v130, v130
    v_exp_f32 v131, v131
    v_exp_f32 v132, v132
    v_exp_f32 v133, v133
    v_exp_f32 v134, v134
    v_exp_f32 v135, v135
    v_exp_f32 v136, v136
    v_exp_f32 v137, v137
    v_cvt_pk_bf16_f32 v122, v122, v123
    v_cvt_pk_bf16_f32 v123, v124, v125
    v_cvt_pk_bf16_f32 v124, v126, v127
    v_cvt_pk_bf16_f32 v125, v128, v129
    v_cvt_pk_bf16_f32 v126, v130, v131
    v_cvt_pk_bf16_f32 v127, v132, v133
    v_mfma_f32_32x32x16_bf16 v[218:233], a[112:115], v[122:125], v[218:233]
    v_cvt_pk_bf16_f32 v128, v134, v135
    v_cvt_pk_bf16_f32 v129, v136, v137
    v_cndmask_b32 v138, v138, v106, s[20:21]
    v_cndmask_b32 v139, v139, v107, s[22:23]
    v_cndmask_b32 v140, v140, v108, s[24:25]
    v_cndmask_b32 v141, v141, v109, s[26:27]
    v_mfma_f32_32x32x16_bf16 v[218:233], a[116:119], v[126:129], v[218:233]
    v_cndmask_b32 v142, v142, v110, s[28:29]
    v_cndmask_b32 v143, v143, v111, s[30:31]
    v_cndmask_b32 v144, v144, v112, s[32:33]
    v_cndmask_b32 v145, v145, v113, s[34:35]
    v_cndmask_b32 v146, v146, v114, s[36:37]
    v_cndmask_b32 v147, v147, v115, s[38:39]
    v_cndmask_b32 v148, v148, v116, s[46:47]
    v_cndmask_b32 v149, v149, v117, s[48:49]
    v_cndmask_b32 v150, v150, v118, s[50:51]
    v_cndmask_b32 v151, v151, v119, s[52:53]
    v_cndmask_b32 v152, v152, v120, s[54:55]
    v_cndmask_b32 v153, v153, v121, s[56:57]
    v_exp_f32 v138, v138
    v_exp_f32 v139, v139
    v_exp_f32 v140, v140
    v_exp_f32 v141, v141
    v_exp_f32 v142, v142
    v_exp_f32 v143, v143
    v_exp_f32 v144, v144
    v_exp_f32 v145, v145
    v_exp_f32 v146, v146
    v_exp_f32 v147, v147
    v_exp_f32 v148, v148
    v_exp_f32 v149, v149
    v_exp_f32 v150, v150
    v_exp_f32 v151, v151
    v_exp_f32 v152, v152
    v_exp_f32 v153, v153
    v_cvt_pk_bf16_f32 v138, v138, v139
    v_cvt_pk_bf16_f32 v139, v140, v141
    v_cvt_pk_bf16_f32 v140, v142, v143
    v_cvt_pk_bf16_f32 v141, v144, v145
    v_cvt_pk_bf16_f32 v142, v146, v147
    v_cvt_pk_bf16_f32 v143, v148, v149
    v_cvt_pk_bf16_f32 v144, v150, v151
    v_cvt_pk_bf16_f32 v145, v152, v153
    v_bfi_b32 v106, v234, 0, v138
    v_and_b32 v114, v234, v138
    v_bfi_b32 v107, v235, 0, v139
    v_and_b32 v115, v235, v139
    v_bfi_b32 v108, v236, 0, v140
    v_and_b32 v116, v236, v140
    v_bfi_b32 v109, v237, 0, v141
    v_and_b32 v117, v237, v141
    v_bfi_b32 v110, v238, 0, v142
    v_mfma_f32_32x32x16_bf16 v[218:233], a[56:59], v[106:109], v[218:233]
    v_and_b32 v118, v238, v142
    v_bfi_b32 v111, v239, 0, v143
    v_and_b32 v119, v239, v143
    v_bfi_b32 v112, v240, 0, v144
    v_and_b32 v120, v240, v144
    v_bfi_b32 v113, v241, 0, v145
    v_and_b32 v121, v241, v145
    s_mul_i32 s62, s42, 36864
    v_mfma_f32_32x32x16_bf16 v[218:233], a[60:63], v[110:113], v[218:233]
    s_add_u32 s62, s62, 258048
    s_waitcnt vmcnt(10)
    v_mfma_f32_32x32x16_bf16 v[218:233], a[120:123], v[114:117], v[218:233]
    s_waitcnt vmcnt(9)
    v_mfma_f32_32x32x16_bf16 v[218:233], a[124:127], v[118:121], v[218:233]
    s_nop 11
    v_rcp_f32 v244, v228
    s_nop 0
    v_mul_f32 v244, 0x40088e99, v244
    v_mul_f32 v138, v218, v244
    v_mul_f32 v139, v219, v244
    v_mul_f32 v140, v220, v244
    v_mul_f32 v141, v221, v244
    v_mul_f32 v142, v222, v244
    v_mul_f32 v143, v223, v244
    v_mul_f32 v144, v224, v244
    v_mul_f32 v145, v225, v244
    v_mul_f32 v146, v226, v244
    v_mul_f32 v147, v227, v244
    v_cvt_pk_bf16_f32 v246, v138, v139
    v_cvt_pk_bf16_f32 v247, v140, v141
    v_cvt_pk_bf16_f32 v248, v142, v143
    v_cvt_pk_bf16_f32 v249, v144, v145
    v_cvt_pk_bf16_f32 v250, v146, v147
    buffer_store_dwordx4 v[246:249], v6, s[16:19], s62 offen sc1
    buffer_store_dword v250, v7, s[16:19], s62 offen sc1
    s_lshl_b32 s45, s42, 5
    s_add_u32 s45, s45, 40960
    s_lshl_b32 s3, s43, 7
    s_add_u32 s3, s3, 40960
    s_lshl_b32 s46, s43, 3
    s_lshl_b32 s47, s40, 1
    s_add_u32 s46, s46, s47
    s_mul_i32 s46, s46, 18432
    s_mov_b32 s47, s46
    v_add_u32 v2, 18432, v255
    s_add_u32 s20, s84, 54525952
    s_addc_u32 s21, s85, 0
    s_mov_b32 s22, 2359296
    s_mov_b32 s23, 0x20000
    v_lshrrev_b32 v3, 5, v1
    v_lshlrev_b32 v3, 8, v3
    v_and_b32 v4, 15, v1
    v_lshl_add_u32 v3, v4, 4, v3
    v_bfe_u32 v4, v1, 4, 1
    v_lshl_add_u32 v3, v4, 3, v3
    v_add_u32 v4, 18432, v3
    s_mul_i32 s48, s44, 4608
    s_add_u32 s48, s48, s46
    s_add_u32 s49, s48, 4096
    s_lshl_b32 s50, s43, 1
    s_lshr_b32 s51, s40, 1
    s_add_u32 s50, s50, s51
    s_lshl_b32 s50, s50, 7
    s_add_u32 s50, s50, 24576
    v_add_u32 v5, 55296, v255
    v_add_u32 v6, 110592, v255
    s_mul_i32 s100, s44, 9216
    s_add_u32 s100, s100, 3244032
    buffer_load_dwordx4 a[128:131], v255, s[96:99], s100 offen offset:0 sc1
    buffer_load_dwordx4 a[132:135], v255, s[96:99], s100 offen offset:1024 sc1
    buffer_load_dwordx4 a[136:139], v255, s[96:99], s100 offen offset:2048 sc1
    s_add_u32 s100, s100, 3072
    buffer_load_dwordx4 a[140:143], v255, s[96:99], s100 offen offset:0 sc1
    buffer_load_dwordx4 a[144:147], v255, s[96:99], s100 offen offset:1024 sc1
    buffer_load_dwordx4 a[148:151], v255, s[96:99], s100 offen offset:2048 sc1
    s_add_u32 s100, s100, 3072
    buffer_load_dwordx4 a[152:155], v255, s[96:99], s100 offen offset:0 sc1
    buffer_load_dwordx4 a[156:159], v255, s[96:99], s100 offen offset:1024 sc1
    buffer_load_dwordx4 a[160:163], v255, s[96:99], s100 offen offset:2048 sc1
    s_add_u32 s100, s100, 30720
    buffer_load_dwordx4 a[164:167], v255, s[96:99], s100 offen offset:0 sc1
    s_waitcnt vmcnt(10)
    v_mov_b32 v254, 1
    s_mov_b64 exec, 3
    buffer_atomic_add v254, v251, s[4:7], s45 offen
    s_mov_b64 exec, -1
    buffer_load_dwordx4 a[168:171], v255, s[96:99], s100 offen offset:1024 sc1
    buffer_load_dwordx4 a[172:175], v255, s[96:99], s100 offen offset:2048 sc1
    s_add_u32 s100, s100, 3072
    buffer_load_dwordx4 a[176:179], v255, s[96:99], s100 offen offset:0 sc1
    buffer_load_dwordx4 a[180:183], v255, s[96:99], s100 offen offset:1024 sc1
    buffer_load_dwordx4 a[184:187], v255, s[96:99], s100 offen offset:2048 sc1
    s_add_u32 s100, s100, 3072
    buffer_load_dwordx4 a[188:191], v255, s[96:99], s100 offen offset:0 sc1
    buffer_load_dwordx4 a[192:195], v255, s[96:99], s100 offen offset:1024 sc1
    buffer_load_dwordx4 a[196:199], v255, s[96:99], s100 offen offset:2048 sc1
    s_add_u32 s100, s100, 30720
    s_barrier
    ds_read_b128 a[0:3], v255 offset:0
    ds_read_b128 a[4:7], v255 offset:1024
    ds_read_b128 a[8:11], v255 offset:2048
    ds_read_b128 a[12:15], v255 offset:3072
    ds_read_b128 a[16:19], v255 offset:4096
    ds_read_b128 a[20:23], v255 offset:5120
    ds_read_b128 a[24:27], v255 offset:6144
    ds_read_b128 a[28:31], v255 offset:7168
    ds_read_b128 a[32:35], v255 offset:8192
    s_cmp_lg_u32 s40, 0
    s_cbranch_scc1 kb_aw
    v_mov_b32 v253, 0
    buffer_atomic_add v253, v252, s[4:7], s3 offen sc0
    s_waitcnt vmcnt(0)
    s_mov_b32 s45, 0
k1_kernel_pl24:
    v_bfe_u32 v253, v253, 0, 8
    v_cmp_gt_u32 vcc, 32, v253
    s_add_u32 s45, s45, 1
    s_and_b32 vcc_lo, vcc_lo, 1
    s_cbranch_scc0 k1_kernel_pd25
    s_cmp_ge_u32 s45, 200000
    s_cbranch_scc1 k1_kernel_pd25
    s_sleep 4
    v_mov_b32 v253, 0
    buffer_atomic_add v253, v252, s[4:7], s3 offen sc0
    s_waitcnt vmcnt(0)
    s_branch k1_kernel_pl24
k1_kernel_pd25:
kb_aw:
    s_barrier
    buffer_load_dwordx4 v[16:19], v255, s[16:19], s47 offen offset:0 sc1
    buffer_load_dwordx4 v[20:23], v2, s[16:19], s47 offen offset:0 sc1
    buffer_load_dwordx4 v[24:27], v255, s[16:19], s47 offen offset:1024 sc1
    buffer_load_dwordx4 v[28:31], v2, s[16:19], s47 offen offset:1024 sc1
    buffer_load_dwordx4 v[32:35], v255, s[16:19], s47 offen offset:2048 sc1
    buffer_load_dwordx4 v[36:39], v2, s[16:19], s47 offen offset:2048 sc1
    buffer_load_dwordx4 v[40:43], v255, s[16:19], s47 offen offset:3072 sc1
    buffer_load_dwordx4 v[44:47], v2, s[16:19], s47 offen offset:3072 sc1
    s_add_u32 s47, s47, 4096
    buffer_load_dwordx4 v[48:51], v255, s[16:19], s47 offen offset:0 sc1
    buffer_load_dwordx4 v[52:55], v2, s[16:19], s47 offen offset:0 sc1
    buffer_load_dwordx4 v[56:59], v255, s[16:19], s47 offen offset:1024 sc1
    buffer_load_dwordx4 v[60:63], v2, s[16:19], s47 offen offset:1024 sc1
    s_waitcnt vmcnt(10) lgkmcnt(0)
    v_mfma_f32_16x16x32_bf16 v[160:163], a[0:3], v[16:19], 0
    ds_read_b128 a[36:39], v255 offset:9216
    v_mfma_f32_16x16x32_bf16 v[164:167], a[0:3], v[20:23], 0
    ds_read_b128 a[40:43], v255 offset:10240
    buffer_load_dwordx4 v[64:67], v255, s[16:19], s47 offen offset:2048 sc1
    v_mfma_f32_16x16x32_bf16 v[168:171], a[4:7], v[16:19], 0
    ds_read_b128 a[44:47], v255 offset:11264
    v_mfma_f32_16x16x32_bf16 v[172:175], a[4:7], v[20:23], 0
    ds_read_b128 a[48:51], v255 offset:12288
    v_mfma_f32_16x16x32_bf16 v[176:179], a[8:11], v[16:19], 0
    ds_read_b128 a[52:55], v255 offset:13312
    v_mfma_f32_16x16x32_bf16 v[180:183], a[8:11], v[20:23], 0
    ds_read_b128 a[56:59], v255 offset:14336
    v_mfma_f32_16x16x32_bf16 v[184:187], a[12:15], v[16:19], 0
    ds_read_b128 a[60:63], v255 offset:15360
    buffer_load_dwordx4 v[68:71], v2, s[16:19], s47 offen offset:2048 sc1
    v_mfma_f32_16x16x32_bf16 v[188:191], a[12:15], v[20:23], 0
    ds_read_b128 a[64:67], v255 offset:16384
    v_mfma_f32_16x16x32_bf16 v[192:195], a[16:19], v[16:19], 0
    ds_read_b128 a[68:71], v255 offset:17408
    v_mfma_f32_16x16x32_bf16 v[196:199], a[16:19], v[20:23], 0
    v_mfma_f32_16x16x32_bf16 v[200:203], a[20:23], v[16:19], 0
    v_mfma_f32_16x16x32_bf16 v[204:207], a[20:23], v[20:23], 0
    buffer_load_dwordx4 v[72:75], v255, s[16:19], s47 offen offset:3072 sc1
    v_mfma_f32_16x16x32_bf16 v[208:211], a[24:27], v[16:19], 0
    v_mfma_f32_16x16x32_bf16 v[212:215], a[24:27], v[20:23], 0
    v_mfma_f32_16x16x32_bf16 v[216:219], a[28:31], v[16:19], 0
    v_mfma_f32_16x16x32_bf16 v[220:223], a[28:31], v[20:23], 0
    v_mfma_f32_16x16x32_bf16 v[224:227], a[32:35], v[16:19], 0
    buffer_load_dwordx4 v[76:79], v2, s[16:19], s47 offen offset:3072 sc1
    v_mfma_f32_16x16x32_bf16 v[228:231], a[32:35], v[20:23], 0
    s_waitcnt vmcnt(12) lgkmcnt(0)
    v_mfma_f32_16x16x32_bf16 v[160:163], a[36:39], v[24:27], v[160:163]
    ds_read_b128 a[0:3], v255 offset:18432
    v_mfma_f32_16x16x32_bf16 v[164:167], a[36:39], v[28:31], v[164:167]
    ds_read_b128 a[4:7], v255 offset:19456
    s_add_u32 s47, s47, 4096
    buffer_load_dwordx4 v[80:83], v255, s[16:19], s47 offen offset:0 sc1
    v_mfma_f32_16x16x32_bf16 v[168:171], a[40:43], v[24:27], v[168:171]
    ds_read_b128 a[8:11], v255 offset:20480
    v_mfma_f32_16x16x32_bf16 v[172:175], a[40:43], v[28:31], v[172:175]
    ds_read_b128 a[12:15], v255 offset:21504
    v_mfma_f32_16x16x32_bf16 v[176:179], a[44:47], v[24:27], v[176:179]
    ds_read_b128 a[16:19], v255 offset:22528
    v_mfma_f32_16x16x32_bf16 v[180:183], a[44:47], v[28:31], v[180:183]
    ds_read_b128 a[20:23], v255 offset:23552
    v_mfma_f32_16x16x32_bf16 v[184:187], a[48:51], v[24:27], v[184:187]
    ds_read_b128 a[24:27], v255 offset:24576
    buffer_load_dwordx4 v[84:87], v2, s[16:19], s47 offen offset:0 sc1
    v_mfma_f32_16x16x32_bf16 v[188:191], a[48:51], v[28:31], v[188:191]
    ds_read_b128 a[28:31], v255 offset:25600
    v_mfma_f32_16x16x32_bf16 v[192:195], a[52:55], v[24:27], v[192:195]
    ds_read_b128 a[32:35], v255 offset:26624
    v_mfma_f32_16x16x32_bf16 v[196:199], a[52:55], v[28:31], v[196:199]
    v_mfma_f32_16x16x32_bf16 v[200:203], a[56:59], v[24:27], v[200:203]
    v_mfma_f32_16x16x32_bf16 v[204:207], a[56:59], v[28:31], v[204:207]
    buffer_load_dwordx4 v[88:91], v255, s[16:19], s47 offen offset:1024 sc1
    v_mfma_f32_16x16x32_bf16 v[208:211], a[60:63], v[24:27], v[208:211]
    v_mfma_f32_16x16x32_bf16 v[212:215], a[60:63], v[28:31], v[212:215]
    v_mfma_f32_16x16x32_bf16 v[216:219], a[64:67], v[24:27], v[216:219]
    v_mfma_f32_16x16x32_bf16 v[220:223], a[64:67], v[28:31], v[220:223]
    v_mfma_f32_16x16x32_bf16 v[224:227], a[68:71], v[24:27], v[224:227]
    buffer_load_dwordx4 v[92:95], v2, s[16:19], s47 offen offset:1024 sc1
    v_mfma_f32_16x16x32_bf16 v[228:231], a[68:71], v[28:31], v[228:231]
    s_waitcnt vmcnt(14) lgkmcnt(0)
    v_mfma_f32_16x16x32_bf16 v[160:163], a[0:3], v[32:35], v[160:163]
    ds_read_b128 a[36:39], v255 offset:27648
    v_mfma_f32_16x16x32_bf16 v[164:167], a[0:3], v[36:39], v[164:167]
    ds_read_b128 a[40:43], v255 offset:28672
    buffer_load_dwordx4 v[96:99], v255, s[16:19], s47 offen offset:2048 sc1
    v_mfma_f32_16x16x32_bf16 v[168:171], a[4:7], v[32:35], v[168:171]
    ds_read_b128 a[44:47], v255 offset:29696
    v_mfma_f32_16x16x32_bf16 v[172:175], a[4:7], v[36:39], v[172:175]
    ds_read_b128 a[48:51], v255 offset:30720
    v_mfma_f32_16x16x32_bf16 v[176:179], a[8:11], v[32:35], v[176:179]
    ds_read_b128 a[52:55], v255 offset:31744
    v_mfma_f32_16x16x32_bf16 v[180:183], a[8:11], v[36:39], v[180:183]
    ds_read_b128 a[56:59], v255 offset:32768
    v_mfma_f32_16x16x32_bf16 v[184:187], a[12:15], v[32:35], v[184:187]
    ds_read_b128 a[60:63], v255 offset:33792
    buffer_load_dwordx4 v[100:103], v2, s[16:19], s47 offen offset:2048 sc1
    v_mfma_f32_16x16x32_bf16 v[188:191], a[12:15], v[36:39], v[188:191]
    ds_read_b128 a[64:67], v255 offset:34816
    v_mfma_f32_16x16x32_bf16 v[192:195], a[16:19], v[32:35], v[192:195]
    ds_read_b128 a[68:71], v255 offset:35840
    v_mfma_f32_16x16x32_bf16 v[196:199], a[16:19], v[36:39], v[196:199]
    v_mfma_f32_16x16x32_bf16 v[200:203], a[20:23], v[32:35], v[200:203]
    v_mfma_f32_16x16x32_bf16 v[204:207], a[20:23], v[36:39], v[204:207]
    buffer_load_dwordx4 v[104:107], v255, s[16:19], s47 offen offset:3072 sc1
    v_mfma_f32_16x16x32_bf16 v[208:211], a[24:27], v[32:35], v[208:211]
    v_mfma_f32_16x16x32_bf16 v[212:215], a[24:27], v[36:39], v[212:215]
    v_mfma_f32_16x16x32_bf16 v[216:219], a[28:31], v[32:35], v[216:219]
    v_mfma_f32_16x16x32_bf16 v[220:223], a[28:31], v[36:39], v[220:223]
    v_mfma_f32_16x16x32_bf16 v[224:227], a[32:35], v[32:35], v[224:227]
    buffer_load_dwordx4 v[108:111], v2, s[16:19], s47 offen offset:3072 sc1
    v_mfma_f32_16x16x32_bf16 v[228:231], a[32:35], v[36:39], v[228:231]
    s_waitcnt vmcnt(16) lgkmcnt(0)
    v_mfma_f32_16x16x32_bf16 v[160:163], a[36:39], v[40:43], v[160:163]
    ds_read_b128 a[0:3], v255 offset:36864
    v_mfma_f32_16x16x32_bf16 v[164:167], a[36:39], v[44:47], v[164:167]
    ds_read_b128 a[4:7], v255 offset:37888
    s_add_u32 s47, s47, 4096
    buffer_load_dwordx4 v[112:115], v255, s[16:19], s47 offen offset:0 sc1
    v_mfma_f32_16x16x32_bf16 v[168:171], a[40:43], v[40:43], v[168:171]
    ds_read_b128 a[8:11], v255 offset:38912
    v_mfma_f32_16x16x32_bf16 v[172:175], a[40:43], v[44:47], v[172:175]
    ds_read_b128 a[12:15], v255 offset:39936
    v_mfma_f32_16x16x32_bf16 v[176:179], a[44:47], v[40:43], v[176:179]
    ds_read_b128 a[16:19], v255 offset:40960
    v_mfma_f32_16x16x32_bf16 v[180:183], a[44:47], v[44:47], v[180:183]
    ds_read_b128 a[20:23], v255 offset:41984
    v_mfma_f32_16x16x32_bf16 v[184:187], a[48:51], v[40:43], v[184:187]
    ds_read_b128 a[24:27], v255 offset:43008
    buffer_load_dwordx4 v[116:119], v2, s[16:19], s47 offen offset:0 sc1
    v_mfma_f32_16x16x32_bf16 v[188:191], a[48:51], v[44:47], v[188:191]
    ds_read_b128 a[28:31], v255 offset:44032
    v_mfma_f32_16x16x32_bf16 v[192:195], a[52:55], v[40:43], v[192:195]
    ds_read_b128 a[32:35], v255 offset:45056
    v_mfma_f32_16x16x32_bf16 v[196:199], a[52:55], v[44:47], v[196:199]
    v_mfma_f32_16x16x32_bf16 v[200:203], a[56:59], v[40:43], v[200:203]
    v_mfma_f32_16x16x32_bf16 v[204:207], a[56:59], v[44:47], v[204:207]
    buffer_load_dwordx4 v[120:123], v255, s[16:19], s47 offen offset:1024 sc1
    v_mfma_f32_16x16x32_bf16 v[208:211], a[60:63], v[40:43], v[208:211]
    v_mfma_f32_16x16x32_bf16 v[212:215], a[60:63], v[44:47], v[212:215]
    v_mfma_f32_16x16x32_bf16 v[216:219], a[64:67], v[40:43], v[216:219]
    v_mfma_f32_16x16x32_bf16 v[220:223], a[64:67], v[44:47], v[220:223]
    v_mfma_f32_16x16x32_bf16 v[224:227], a[68:71], v[40:43], v[224:227]
    buffer_load_dwordx4 v[124:127], v2, s[16:19], s47 offen offset:1024 sc1
    v_mfma_f32_16x16x32_bf16 v[228:231], a[68:71], v[44:47], v[228:231]
    s_waitcnt vmcnt(18) lgkmcnt(0)
    v_mfma_f32_16x16x32_bf16 v[160:163], a[0:3], v[48:51], v[160:163]
    ds_read_b128 a[36:39], v255 offset:46080
    v_mfma_f32_16x16x32_bf16 v[164:167], a[0:3], v[52:55], v[164:167]
    ds_read_b128 a[40:43], v255 offset:47104
    buffer_load_dwordx4 v[128:131], v255, s[16:19], s47 offen offset:2048 sc1
    v_mfma_f32_16x16x32_bf16 v[168:171], a[4:7], v[48:51], v[168:171]
    ds_read_b128 a[44:47], v255 offset:48128
    v_mfma_f32_16x16x32_bf16 v[172:175], a[4:7], v[52:55], v[172:175]
    ds_read_b128 a[48:51], v255 offset:49152
    v_mfma_f32_16x16x32_bf16 v[176:179], a[8:11], v[48:51], v[176:179]
    ds_read_b128 a[52:55], v255 offset:50176
    v_mfma_f32_16x16x32_bf16 v[180:183], a[8:11], v[52:55], v[180:183]
    ds_read_b128 a[56:59], v255 offset:51200
    v_mfma_f32_16x16x32_bf16 v[184:187], a[12:15], v[48:51], v[184:187]
    ds_read_b128 a[60:63], v255 offset:52224
    buffer_load_dwordx4 v[132:135], v2, s[16:19], s47 offen offset:2048 sc1
    v_mfma_f32_16x16x32_bf16 v[188:191], a[12:15], v[52:55], v[188:191]
    ds_read_b128 a[64:67], v255 offset:53248
    v_mfma_f32_16x16x32_bf16 v[192:195], a[16:19], v[48:51], v[192:195]
    ds_read_b128 a[68:71], v255 offset:54272
    v_mfma_f32_16x16x32_bf16 v[196:199], a[16:19], v[52:55], v[196:199]
    v_mfma_f32_16x16x32_bf16 v[200:203], a[20:23], v[48:51], v[200:203]
    v_mfma_f32_16x16x32_bf16 v[204:207], a[20:23], v[52:55], v[204:207]
    buffer_load_dwordx4 v[136:139], v255, s[16:19], s47 offen offset:3072 sc1
    v_mfma_f32_16x16x32_bf16 v[208:211], a[24:27], v[48:51], v[208:211]
    v_mfma_f32_16x16x32_bf16 v[212:215], a[24:27], v[52:55], v[212:215]
    v_mfma_f32_16x16x32_bf16 v[216:219], a[28:31], v[48:51], v[216:219]
    v_mfma_f32_16x16x32_bf16 v[220:223], a[28:31], v[52:55], v[220:223]
    v_mfma_f32_16x16x32_bf16 v[224:227], a[32:35], v[48:51], v[224:227]
    buffer_load_dwordx4 v[140:143], v2, s[16:19], s47 offen offset:3072 sc1
    v_mfma_f32_16x16x32_bf16 v[228:231], a[32:35], v[52:55], v[228:231]
    s_waitcnt vmcnt(20) lgkmcnt(0)
    v_mfma_f32_16x16x32_bf16 v[160:163], a[36:39], v[56:59], v[160:163]
    ds_read_b128 a[0:3], v5 offset:0
    v_mfma_f32_16x16x32_bf16 v[164:167], a[36:39], v[60:63], v[164:167]
    ds_read_b128 a[4:7], v5 offset:1024
    s_add_u32 s47, s47, 4096
    buffer_load_dwordx4 v[144:147], v255, s[16:19], s47 offen offset:0 sc1
    v_mfma_f32_16x16x32_bf16 v[168:171], a[40:43], v[56:59], v[168:171]
    ds_read_b128 a[8:11], v5 offset:2048
    v_mfma_f32_16x16x32_bf16 v[172:175], a[40:43], v[60:63], v[172:175]
    ds_read_b128 a[12:15], v5 offset:3072
    v_mfma_f32_16x16x32_bf16 v[176:179], a[44:47], v[56:59], v[176:179]
    ds_read_b128 a[16:19], v5 offset:4096
    v_mfma_f32_16x16x32_bf16 v[180:183], a[44:47], v[60:63], v[180:183]
    ds_read_b128 a[20:23], v5 offset:5120
    v_mfma_f32_16x16x32_bf16 v[184:187], a[48:51], v[56:59], v[184:187]
    ds_read_b128 a[24:27], v5 offset:6144
    buffer_load_dwordx4 v[148:151], v2, s[16:19], s47 offen offset:0 sc1
    v_mfma_f32_16x16x32_bf16 v[188:191], a[48:51], v[60:63], v[188:191]
    ds_read_b128 a[28:31], v5 offset:7168
    v_mfma_f32_16x16x32_bf16 v[192:195], a[52:55], v[56:59], v[192:195]
    ds_read_b128 a[32:35], v5 offset:8192
    v_mfma_f32_16x16x32_bf16 v[196:199], a[52:55], v[60:63], v[196:199]
    v_mfma_f32_16x16x32_bf16 v[200:203], a[56:59], v[56:59], v[200:203]
    v_mfma_f32_16x16x32_bf16 v[204:207], a[56:59], v[60:63], v[204:207]
    buffer_load_dwordx4 v[152:155], v255, s[16:19], s47 offen offset:1024 sc1
    v_mfma_f32_16x16x32_bf16 v[208:211], a[60:63], v[56:59], v[208:211]
    v_mfma_f32_16x16x32_bf16 v[212:215], a[60:63], v[60:63], v[212:215]
    v_mfma_f32_16x16x32_bf16 v[216:219], a[64:67], v[56:59], v[216:219]
    v_mfma_f32_16x16x32_bf16 v[220:223], a[64:67], v[60:63], v[220:223]
    v_mfma_f32_16x16x32_bf16 v[224:227], a[68:71], v[56:59], v[224:227]
    buffer_load_dwordx4 v[156:159], v2, s[16:19], s47 offen offset:1024 sc1
    v_mfma_f32_16x16x32_bf16 v[228:231], a[68:71], v[60:63], v[228:231]
    s_waitcnt vmcnt(22) lgkmcnt(0)
    v_mfma_f32_16x16x32_bf16 v[160:163], a[0:3], v[64:67], v[160:163]
    ds_read_b128 a[36:39], v5 offset:9216
    v_mfma_f32_16x16x32_bf16 v[164:167], a[0:3], v[68:71], v[164:167]
    ds_read_b128 a[40:43], v5 offset:10240
    v_mfma_f32_16x16x32_bf16 v[168:171], a[4:7], v[64:67], v[168:171]
    ds_read_b128 a[44:47], v5 offset:11264
    v_mfma_f32_16x16x32_bf16 v[172:175], a[4:7], v[68:71], v[172:175]
    ds_read_b128 a[48:51], v5 offset:12288
    v_mfma_f32_16x16x32_bf16 v[176:179], a[8:11], v[64:67], v[176:179]
    ds_read_b128 a[52:55], v5 offset:13312
    v_mfma_f32_16x16x32_bf16 v[180:183], a[8:11], v[68:71], v[180:183]
    ds_read_b128 a[56:59], v5 offset:14336
    v_mfma_f32_16x16x32_bf16 v[184:187], a[12:15], v[64:67], v[184:187]
    ds_read_b128 a[60:63], v5 offset:15360
    v_mfma_f32_16x16x32_bf16 v[188:191], a[12:15], v[68:71], v[188:191]
    ds_read_b128 a[64:67], v5 offset:16384
    v_mfma_f32_16x16x32_bf16 v[192:195], a[16:19], v[64:67], v[192:195]
    ds_read_b128 a[68:71], v5 offset:17408
    v_mfma_f32_16x16x32_bf16 v[196:199], a[16:19], v[68:71], v[196:199]
    v_mfma_f32_16x16x32_bf16 v[200:203], a[20:23], v[64:67], v[200:203]
    v_mfma_f32_16x16x32_bf16 v[204:207], a[20:23], v[68:71], v[204:207]
    v_mfma_f32_16x16x32_bf16 v[208:211], a[24:27], v[64:67], v[208:211]
    v_mfma_f32_16x16x32_bf16 v[212:215], a[24:27], v[68:71], v[212:215]
    v_mfma_f32_16x16x32_bf16 v[216:219], a[28:31], v[64:67], v[216:219]
    v_mfma_f32_16x16x32_bf16 v[220:223], a[28:31], v[68:71], v[220:223]
    v_mfma_f32_16x16x32_bf16 v[224:227], a[32:35], v[64:67], v[224:227]
    v_mfma_f32_16x16x32_bf16 v[228:231], a[32:35], v[68:71], v[228:231]
    s_waitcnt vmcnt(20) lgkmcnt(0)
    v_mfma_f32_16x16x32_bf16 v[160:163], a[36:39], v[72:75], v[160:163]
    ds_read_b128 a[0:3], v5 offset:18432
    v_mfma_f32_16x16x32_bf16 v[164:167], a[36:39], v[76:79], v[164:167]
    ds_read_b128 a[4:7], v5 offset:19456
    v_mfma_f32_16x16x32_bf16 v[168:171], a[40:43], v[72:75], v[168:171]
    ds_read_b128 a[8:11], v5 offset:20480
    v_mfma_f32_16x16x32_bf16 v[172:175], a[40:43], v[76:79], v[172:175]
    ds_read_b128 a[12:15], v5 offset:21504
    v_mfma_f32_16x16x32_bf16 v[176:179], a[44:47], v[72:75], v[176:179]
    ds_read_b128 a[16:19], v5 offset:22528
    v_mfma_f32_16x16x32_bf16 v[180:183], a[44:47], v[76:79], v[180:183]
    ds_read_b128 a[20:23], v5 offset:23552
    v_mfma_f32_16x16x32_bf16 v[184:187], a[48:51], v[72:75], v[184:187]
    ds_read_b128 a[24:27], v5 offset:24576
    v_mfma_f32_16x16x32_bf16 v[188:191], a[48:51], v[76:79], v[188:191]
    ds_read_b128 a[28:31], v5 offset:25600
    v_mfma_f32_16x16x32_bf16 v[192:195], a[52:55], v[72:75], v[192:195]
    ds_read_b128 a[32:35], v5 offset:26624
    v_mfma_f32_16x16x32_bf16 v[196:199], a[52:55], v[76:79], v[196:199]
    v_mfma_f32_16x16x32_bf16 v[200:203], a[56:59], v[72:75], v[200:203]
    v_mfma_f32_16x16x32_bf16 v[204:207], a[56:59], v[76:79], v[204:207]
    v_mfma_f32_16x16x32_bf16 v[208:211], a[60:63], v[72:75], v[208:211]
    v_mfma_f32_16x16x32_bf16 v[212:215], a[60:63], v[76:79], v[212:215]
    v_mfma_f32_16x16x32_bf16 v[216:219], a[64:67], v[72:75], v[216:219]
    v_mfma_f32_16x16x32_bf16 v[220:223], a[64:67], v[76:79], v[220:223]
    v_mfma_f32_16x16x32_bf16 v[224:227], a[68:71], v[72:75], v[224:227]
    v_mfma_f32_16x16x32_bf16 v[228:231], a[68:71], v[76:79], v[228:231]
    s_waitcnt vmcnt(18) lgkmcnt(0)
    v_mfma_f32_16x16x32_bf16 v[160:163], a[0:3], v[80:83], v[160:163]
    ds_read_b128 a[36:39], v5 offset:27648
    v_mfma_f32_16x16x32_bf16 v[164:167], a[0:3], v[84:87], v[164:167]
    ds_read_b128 a[40:43], v5 offset:28672
    v_mfma_f32_16x16x32_bf16 v[168:171], a[4:7], v[80:83], v[168:171]
    ds_read_b128 a[44:47], v5 offset:29696
    v_mfma_f32_16x16x32_bf16 v[172:175], a[4:7], v[84:87], v[172:175]
    ds_read_b128 a[48:51], v5 offset:30720
    v_mfma_f32_16x16x32_bf16 v[176:179], a[8:11], v[80:83], v[176:179]
    ds_read_b128 a[52:55], v5 offset:31744
    v_mfma_f32_16x16x32_bf16 v[180:183], a[8:11], v[84:87], v[180:183]
    ds_read_b128 a[56:59], v5 offset:32768
    v_mfma_f32_16x16x32_bf16 v[184:187], a[12:15], v[80:83], v[184:187]
    ds_read_b128 a[60:63], v5 offset:33792
    v_mfma_f32_16x16x32_bf16 v[188:191], a[12:15], v[84:87], v[188:191]
    ds_read_b128 a[64:67], v5 offset:34816
    v_mfma_f32_16x16x32_bf16 v[192:195], a[16:19], v[80:83], v[192:195]
    ds_read_b128 a[68:71], v5 offset:35840
    v_mfma_f32_16x16x32_bf16 v[196:199], a[16:19], v[84:87], v[196:199]
    v_mfma_f32_16x16x32_bf16 v[200:203], a[20:23], v[80:83], v[200:203]
    v_mfma_f32_16x16x32_bf16 v[204:207], a[20:23], v[84:87], v[204:207]
    v_mfma_f32_16x16x32_bf16 v[208:211], a[24:27], v[80:83], v[208:211]
    v_mfma_f32_16x16x32_bf16 v[212:215], a[24:27], v[84:87], v[212:215]
    v_mfma_f32_16x16x32_bf16 v[216:219], a[28:31], v[80:83], v[216:219]
    v_mfma_f32_16x16x32_bf16 v[220:223], a[28:31], v[84:87], v[220:223]
    v_mfma_f32_16x16x32_bf16 v[224:227], a[32:35], v[80:83], v[224:227]
    v_mfma_f32_16x16x32_bf16 v[228:231], a[32:35], v[84:87], v[228:231]
    s_waitcnt vmcnt(16) lgkmcnt(0)
    v_mfma_f32_16x16x32_bf16 v[160:163], a[36:39], v[88:91], v[160:163]
    ds_read_b128 a[0:3], v5 offset:36864
    v_mfma_f32_16x16x32_bf16 v[164:167], a[36:39], v[92:95], v[164:167]
    ds_read_b128 a[4:7], v5 offset:37888
    v_mfma_f32_16x16x32_bf16 v[168:171], a[40:43], v[88:91], v[168:171]
    ds_read_b128 a[8:11], v5 offset:38912
    v_mfma_f32_16x16x32_bf16 v[172:175], a[40:43], v[92:95], v[172:175]
    ds_read_b128 a[12:15], v5 offset:39936
    v_mfma_f32_16x16x32_bf16 v[176:179], a[44:47], v[88:91], v[176:179]
    ds_read_b128 a[16:19], v5 offset:40960
    v_mfma_f32_16x16x32_bf16 v[180:183], a[44:47], v[92:95], v[180:183]
    ds_read_b128 a[20:23], v5 offset:41984
    v_mfma_f32_16x16x32_bf16 v[184:187], a[48:51], v[88:91], v[184:187]
    ds_read_b128 a[24:27], v5 offset:43008
    v_mfma_f32_16x16x32_bf16 v[188:191], a[48:51], v[92:95], v[188:191]
    ds_read_b128 a[28:31], v5 offset:44032
    v_mfma_f32_16x16x32_bf16 v[192:195], a[52:55], v[88:91], v[192:195]
    ds_read_b128 a[32:35], v5 offset:45056
    v_mfma_f32_16x16x32_bf16 v[196:199], a[52:55], v[92:95], v[196:199]
    v_mfma_f32_16x16x32_bf16 v[200:203], a[56:59], v[88:91], v[200:203]
    v_mfma_f32_16x16x32_bf16 v[204:207], a[56:59], v[92:95], v[204:207]
    v_mfma_f32_16x16x32_bf16 v[208:211], a[60:63], v[88:91], v[208:211]
    v_mfma_f32_16x16x32_bf16 v[212:215], a[60:63], v[92:95], v[212:215]
    v_mfma_f32_16x16x32_bf16 v[216:219], a[64:67], v[88:91], v[216:219]
    v_mfma_f32_16x16x32_bf16 v[220:223], a[64:67], v[92:95], v[220:223]
    v_mfma_f32_16x16x32_bf16 v[224:227], a[68:71], v[88:91], v[224:227]
    v_mfma_f32_16x16x32_bf16 v[228:231], a[68:71], v[92:95], v[228:231]
    s_waitcnt vmcnt(14) lgkmcnt(0)
    v_mfma_f32_16x16x32_bf16 v[160:163], a[0:3], v[96:99], v[160:163]
    ds_read_b128 a[36:39], v5 offset:46080
    v_mfma_f32_16x16x32_bf16 v[164:167], a[0:3], v[100:103], v[164:167]
    ds_read_b128 a[40:43], v5 offset:47104
    v_mfma_f32_16x16x32_bf16 v[168:171], a[4:7], v[96:99], v[168:171]
    ds_read_b128 a[44:47], v5 offset:48128
    v_mfma_f32_16x16x32_bf16 v[172:175], a[4:7], v[100:103], v[172:175]
    ds_read_b128 a[48:51], v5 offset:49152
    v_mfma_f32_16x16x32_bf16 v[176:179], a[8:11], v[96:99], v[176:179]
    ds_read_b128 a[52:55], v5 offset:50176
    v_mfma_f32_16x16x32_bf16 v[180:183], a[8:11], v[100:103], v[180:183]
    ds_read_b128 a[56:59], v5 offset:51200
    v_mfma_f32_16x16x32_bf16 v[184:187], a[12:15], v[96:99], v[184:187]
    ds_read_b128 a[60:63], v5 offset:52224
    v_mfma_f32_16x16x32_bf16 v[188:191], a[12:15], v[100:103], v[188:191]
    ds_read_b128 a[64:67], v5 offset:53248
    v_mfma_f32_16x16x32_bf16 v[192:195], a[16:19], v[96:99], v[192:195]
    ds_read_b128 a[68:71], v5 offset:54272
    v_mfma_f32_16x16x32_bf16 v[196:199], a[16:19], v[100:103], v[196:199]
    v_mfma_f32_16x16x32_bf16 v[200:203], a[20:23], v[96:99], v[200:203]
    v_mfma_f32_16x16x32_bf16 v[204:207], a[20:23], v[100:103], v[204:207]
    v_mfma_f32_16x16x32_bf16 v[208:211], a[24:27], v[96:99], v[208:211]
    v_mfma_f32_16x16x32_bf16 v[212:215], a[24:27], v[100:103], v[212:215]
    v_mfma_f32_16x16x32_bf16 v[216:219], a[28:31], v[96:99], v[216:219]
    v_mfma_f32_16x16x32_bf16 v[220:223], a[28:31], v[100:103], v[220:223]
    v_mfma_f32_16x16x32_bf16 v[224:227], a[32:35], v[96:99], v[224:227]
    v_mfma_f32_16x16x32_bf16 v[228:231], a[32:35], v[100:103], v[228:231]
    s_waitcnt vmcnt(12) lgkmcnt(0)
    v_mfma_f32_16x16x32_bf16 v[160:163], a[36:39], v[104:107], v[160:163]
    ds_read_b128 a[0:3], v6 offset:0
    v_mfma_f32_16x16x32_bf16 v[164:167], a[36:39], v[108:111], v[164:167]
    ds_read_b128 a[4:7], v6 offset:1024
    v_mfma_f32_16x16x32_bf16 v[168:171], a[40:43], v[104:107], v[168:171]
    ds_read_b128 a[8:11], v6 offset:2048
    v_mfma_f32_16x16x32_bf16 v[172:175], a[40:43], v[108:111], v[172:175]
    ds_read_b128 a[12:15], v6 offset:3072
    v_mfma_f32_16x16x32_bf16 v[176:179], a[44:47], v[104:107], v[176:179]
    ds_read_b128 a[16:19], v6 offset:4096
    v_mfma_f32_16x16x32_bf16 v[180:183], a[44:47], v[108:111], v[180:183]
    ds_read_b128 a[20:23], v6 offset:5120
    v_mfma_f32_16x16x32_bf16 v[184:187], a[48:51], v[104:107], v[184:187]
    ds_read_b128 a[24:27], v6 offset:6144
    v_mfma_f32_16x16x32_bf16 v[188:191], a[48:51], v[108:111], v[188:191]
    ds_read_b128 a[28:31], v6 offset:7168
    v_mfma_f32_16x16x32_bf16 v[192:195], a[52:55], v[104:107], v[192:195]
    ds_read_b128 a[32:35], v6 offset:8192
    v_mfma_f32_16x16x32_bf16 v[196:199], a[52:55], v[108:111], v[196:199]
    v_mfma_f32_16x16x32_bf16 v[200:203], a[56:59], v[104:107], v[200:203]
    v_mfma_f32_16x16x32_bf16 v[204:207], a[56:59], v[108:111], v[204:207]
    v_mfma_f32_16x16x32_bf16 v[208:211], a[60:63], v[104:107], v[208:211]
    v_mfma_f32_16x16x32_bf16 v[212:215], a[60:63], v[108:111], v[212:215]
    v_mfma_f32_16x16x32_bf16 v[216:219], a[64:67], v[104:107], v[216:219]
    v_mfma_f32_16x16x32_bf16 v[220:223], a[64:67], v[108:111], v[220:223]
    v_mfma_f32_16x16x32_bf16 v[224:227], a[68:71], v[104:107], v[224:227]
    v_mfma_f32_16x16x32_bf16 v[228:231], a[68:71], v[108:111], v[228:231]
    s_waitcnt vmcnt(10) lgkmcnt(0)
    v_mfma_f32_16x16x32_bf16 v[160:163], a[0:3], v[112:115], v[160:163]
    ds_read_b128 a[36:39], v6 offset:9216
    v_mfma_f32_16x16x32_bf16 v[164:167], a[0:3], v[116:119], v[164:167]
    ds_read_b128 a[40:43], v6 offset:10240
    v_mfma_f32_16x16x32_bf16 v[168:171], a[4:7], v[112:115], v[168:171]
    ds_read_b128 a[44:47], v6 offset:11264
    v_mfma_f32_16x16x32_bf16 v[172:175], a[4:7], v[116:119], v[172:175]
    ds_read_b128 a[48:51], v6 offset:12288
    v_mfma_f32_16x16x32_bf16 v[176:179], a[8:11], v[112:115], v[176:179]
    ds_read_b128 a[52:55], v6 offset:13312
    v_mfma_f32_16x16x32_bf16 v[180:183], a[8:11], v[116:119], v[180:183]
    ds_read_b128 a[56:59], v6 offset:14336
    v_mfma_f32_16x16x32_bf16 v[184:187], a[12:15], v[112:115], v[184:187]
    ds_read_b128 a[60:63], v6 offset:15360
    v_mfma_f32_16x16x32_bf16 v[188:191], a[12:15], v[116:119], v[188:191]
    ds_read_b128 a[64:67], v6 offset:16384
    v_mfma_f32_16x16x32_bf16 v[192:195], a[16:19], v[112:115], v[192:195]
    ds_read_b128 a[68:71], v6 offset:17408
    v_mfma_f32_16x16x32_bf16 v[196:199], a[16:19], v[116:119], v[196:199]
    v_mfma_f32_16x16x32_bf16 v[200:203], a[20:23], v[112:115], v[200:203]
    v_mfma_f32_16x16x32_bf16 v[204:207], a[20:23], v[116:119], v[204:207]
    v_mfma_f32_16x16x32_bf16 v[208:211], a[24:27], v[112:115], v[208:211]
    v_mfma_f32_16x16x32_bf16 v[212:215], a[24:27], v[116:119], v[212:215]
    v_mfma_f32_16x16x32_bf16 v[216:219], a[28:31], v[112:115], v[216:219]
    v_mfma_f32_16x16x32_bf16 v[220:223], a[28:31], v[116:119], v[220:223]
    v_mfma_f32_16x16x32_bf16 v[224:227], a[32:35], v[112:115], v[224:227]
    v_mfma_f32_16x16x32_bf16 v[228:231], a[32:35], v[116:119], v[228:231]
    s_waitcnt vmcnt(8) lgkmcnt(0)
    v_mfma_f32_16x16x32_bf16 v[160:163], a[36:39], v[120:123], v[160:163]
    ds_read_b128 a[0:3], v6 offset:18432
    v_mfma_f32_16x16x32_bf16 v[164:167], a[36:39], v[124:127], v[164:167]
    ds_read_b128 a[4:7], v6 offset:19456
    v_mfma_f32_16x16x32_bf16 v[168:171], a[40:43], v[120:123], v[168:171]
    ds_read_b128 a[8:11], v6 offset:20480
    v_mfma_f32_16x16x32_bf16 v[172:175], a[40:43], v[124:127], v[172:175]
    ds_read_b128 a[12:15], v6 offset:21504
    v_mfma_f32_16x16x32_bf16 v[176:179], a[44:47], v[120:123], v[176:179]
    ds_read_b128 a[16:19], v6 offset:22528
    v_mfma_f32_16x16x32_bf16 v[180:183], a[44:47], v[124:127], v[180:183]
    ds_read_b128 a[20:23], v6 offset:23552
    v_mfma_f32_16x16x32_bf16 v[184:187], a[48:51], v[120:123], v[184:187]
    ds_read_b128 a[24:27], v6 offset:24576
    v_mfma_f32_16x16x32_bf16 v[188:191], a[48:51], v[124:127], v[188:191]
    ds_read_b128 a[28:31], v6 offset:25600
    v_mfma_f32_16x16x32_bf16 v[192:195], a[52:55], v[120:123], v[192:195]
    ds_read_b128 a[32:35], v6 offset:26624
    v_mfma_f32_16x16x32_bf16 v[196:199], a[52:55], v[124:127], v[196:199]
    v_mfma_f32_16x16x32_bf16 v[200:203], a[56:59], v[120:123], v[200:203]
    v_mfma_f32_16x16x32_bf16 v[204:207], a[56:59], v[124:127], v[204:207]
    v_mfma_f32_16x16x32_bf16 v[208:211], a[60:63], v[120:123], v[208:211]
    v_mfma_f32_16x16x32_bf16 v[212:215], a[60:63], v[124:127], v[212:215]
    v_mfma_f32_16x16x32_bf16 v[216:219], a[64:67], v[120:123], v[216:219]
    v_mfma_f32_16x16x32_bf16 v[220:223], a[64:67], v[124:127], v[220:223]
    v_mfma_f32_16x16x32_bf16 v[224:227], a[68:71], v[120:123], v[224:227]
    v_mfma_f32_16x16x32_bf16 v[228:231], a[68:71], v[124:127], v[228:231]
    s_waitcnt vmcnt(6) lgkmcnt(0)
    v_mfma_f32_16x16x32_bf16 v[160:163], a[0:3], v[128:131], v[160:163]
    ds_read_b128 a[36:39], v6 offset:27648
    v_mfma_f32_16x16x32_bf16 v[164:167], a[0:3], v[132:135], v[164:167]
    ds_read_b128 a[40:43], v6 offset:28672
    v_mfma_f32_16x16x32_bf16 v[168:171], a[4:7], v[128:131], v[168:171]
    ds_read_b128 a[44:47], v6 offset:29696
    v_mfma_f32_16x16x32_bf16 v[172:175], a[4:7], v[132:135], v[172:175]
    ds_read_b128 a[48:51], v6 offset:30720
    v_mfma_f32_16x16x32_bf16 v[176:179], a[8:11], v[128:131], v[176:179]
    ds_read_b128 a[52:55], v6 offset:31744
    v_mfma_f32_16x16x32_bf16 v[180:183], a[8:11], v[132:135], v[180:183]
    ds_read_b128 a[56:59], v6 offset:32768
    v_mfma_f32_16x16x32_bf16 v[184:187], a[12:15], v[128:131], v[184:187]
    ds_read_b128 a[60:63], v6 offset:33792
    v_mfma_f32_16x16x32_bf16 v[188:191], a[12:15], v[132:135], v[188:191]
    ds_read_b128 a[64:67], v6 offset:34816
    v_mfma_f32_16x16x32_bf16 v[192:195], a[16:19], v[128:131], v[192:195]
    ds_read_b128 a[68:71], v6 offset:35840
    v_mfma_f32_16x16x32_bf16 v[196:199], a[16:19], v[132:135], v[196:199]
    v_mfma_f32_16x16x32_bf16 v[200:203], a[20:23], v[128:131], v[200:203]
    v_mfma_f32_16x16x32_bf16 v[204:207], a[20:23], v[132:135], v[204:207]
    v_mfma_f32_16x16x32_bf16 v[208:211], a[24:27], v[128:131], v[208:211]
    v_mfma_f32_16x16x32_bf16 v[212:215], a[24:27], v[132:135], v[212:215]
    v_mfma_f32_16x16x32_bf16 v[216:219], a[28:31], v[128:131], v[216:219]
    v_mfma_f32_16x16x32_bf16 v[220:223], a[28:31], v[132:135], v[220:223]
    v_mfma_f32_16x16x32_bf16 v[224:227], a[32:35], v[128:131], v[224:227]
    v_mfma_f32_16x16x32_bf16 v[228:231], a[32:35], v[132:135], v[228:231]
    s_waitcnt vmcnt(0) lgkmcnt(0)
    v_mfma_f32_16x16x32_bf16 v[160:163], a[36:39], v[136:139], v[160:163]
    v_mfma_f32_16x16x32_bf16 v[164:167], a[36:39], v[140:143], v[164:167]
    v_mfma_f32_16x16x32_bf16 v[160:163], a[128:131], v[144:147], v[160:163]
    v_mfma_f32_16x16x32_bf16 v[164:167], a[128:131], v[148:151], v[164:167]
    v_mfma_f32_16x16x32_bf16 v[160:163], a[164:167], v[152:155], v[160:163]
    v_mfma_f32_16x16x32_bf16 v[164:167], a[164:167], v[156:159], v[164:167]
    v_mfma_f32_16x16x32_bf16 v[168:171], a[40:43], v[136:139], v[168:171]
    v_mfma_f32_16x16x32_bf16 v[172:175], a[40:43], v[140:143], v[172:175]
    v_mfma_f32_16x16x32_bf16 v[168:171], a[132:135], v[144:147], v[168:171]
    v_mfma_f32_16x16x32_bf16 v[172:175], a[132:135], v[148:151], v[172:175]
    v_mfma_f32_16x16x32_bf16 v[168:171], a[168:171], v[152:155], v[168:171]
    v_mfma_f32_16x16x32_bf16 v[172:175], a[168:171], v[156:159], v[172:175]
    v_mfma_f32_16x16x32_bf16 v[176:179], a[44:47], v[136:139], v[176:179]
    v_cvt_pk_bf16_f32 v160, v160, v161
    v_cvt_pk_bf16_f32 v161, v162, v163
    v_mfma_f32_16x16x32_bf16 v[180:183], a[44:47], v[140:143], v[180:183]
    buffer_store_dwordx2 v[160:161], v3, s[20:23], s48 offen offset:0 sc1
    v_cvt_pk_bf16_f32 v164, v164, v165
    v_mfma_f32_16x16x32_bf16 v[176:179], a[136:139], v[144:147], v[176:179]
    v_cvt_pk_bf16_f32 v165, v166, v167
    buffer_store_dwordx2 v[164:165], v4, s[20:23], s48 offen offset:0 sc1
    v_mfma_f32_16x16x32_bf16 v[180:183], a[136:139], v[148:151], v[180:183]
    v_mfma_f32_16x16x32_bf16 v[176:179], a[172:175], v[152:155], v[176:179]
    v_mfma_f32_16x16x32_bf16 v[180:183], a[172:175], v[156:159], v[180:183]
    v_mfma_f32_16x16x32_bf16 v[184:187], a[48:51], v[136:139], v[184:187]
    v_cvt_pk_bf16_f32 v168, v168, v169
    v_cvt_pk_bf16_f32 v169, v170, v171
    v_mfma_f32_16x16x32_bf16 v[188:191], a[48:51], v[140:143], v[188:191]
    buffer_store_dwordx2 v[168:169], v3, s[20:23], s48 offen offset:512 sc1
    v_cvt_pk_bf16_f32 v172, v172, v173
    v_mfma_f32_16x16x32_bf16 v[184:187], a[140:143], v[144:147], v[184:187]
    v_cvt_pk_bf16_f32 v173, v174, v175
    buffer_store_dwordx2 v[172:173], v4, s[20:23], s48 offen offset:512 sc1
    v_mfma_f32_16x16x32_bf16 v[188:191], a[140:143], v[148:151], v[188:191]
    v_mfma_f32_16x16x32_bf16 v[184:187], a[176:179], v[152:155], v[184:187]
    v_mfma_f32_16x16x32_bf16 v[188:191], a[176:179], v[156:159], v[188:191]
    v_mfma_f32_16x16x32_bf16 v[192:195], a[52:55], v[136:139], v[192:195]
    v_cvt_pk_bf16_f32 v176, v176, v177
    v_cvt_pk_bf16_f32 v177, v178, v179
    v_mfma_f32_16x16x32_bf16 v[196:199], a[52:55], v[140:143], v[196:199]
    buffer_store_dwordx2 v[176:177], v3, s[20:23], s48 offen offset:1024 sc1
    v_cvt_pk_bf16_f32 v180, v180, v181
    v_mfma_f32_16x16x32_bf16 v[192:195], a[144:147], v[144:147], v[192:195]
    v_cvt_pk_bf16_f32 v181, v182, v183
    buffer_store_dwordx2 v[180:181], v4, s[20:23], s48 offen offset:1024 sc1
    v_mfma_f32_16x16x32_bf16 v[196:199], a[144:147], v[148:151], v[196:199]
    v_mfma_f32_16x16x32_bf16 v[192:195], a[180:183], v[152:155], v[192:195]
    v_mfma_f32_16x16x32_bf16 v[196:199], a[180:183], v[156:159], v[196:199]
    v_mfma_f32_16x16x32_bf16 v[200:203], a[56:59], v[136:139], v[200:203]
    v_cvt_pk_bf16_f32 v184, v184, v185
    v_cvt_pk_bf16_f32 v185, v186, v187
    v_mfma_f32_16x16x32_bf16 v[204:207], a[56:59], v[140:143], v[204:207]
    buffer_store_dwordx2 v[184:185], v3, s[20:23], s48 offen offset:1536 sc1
    v_cvt_pk_bf16_f32 v188, v188, v189
    v_mfma_f32_16x16x32_bf16 v[200:203], a[148:151], v[144:147], v[200:203]
    v_cvt_pk_bf16_f32 v189, v190, v191
    buffer_store_dwordx2 v[188:189], v4, s[20:23], s48 offen offset:1536 sc1
    v_mfma_f32_16x16x32_bf16 v[204:207], a[148:151], v[148:151], v[204:207]
    v_mfma_f32_16x16x32_bf16 v[200:203], a[184:187], v[152:155], v[200:203]
    v_mfma_f32_16x16x32_bf16 v[204:207], a[184:187], v[156:159], v[204:207]
    v_mfma_f32_16x16x32_bf16 v[208:211], a[60:63], v[136:139], v[208:211]
    v_cvt_pk_bf16_f32 v192, v192, v193
    v_cvt_pk_bf16_f32 v193, v194, v195
    v_mfma_f32_16x16x32_bf16 v[212:215], a[60:63], v[140:143], v[212:215]
    buffer_store_dwordx2 v[192:193], v3, s[20:23], s48 offen offset:2048 sc1
    v_cvt_pk_bf16_f32 v196, v196, v197
    v_mfma_f32_16x16x32_bf16 v[208:211], a[152:155], v[144:147], v[208:211]
    v_cvt_pk_bf16_f32 v197, v198, v199
    buffer_store_dwordx2 v[196:197], v4, s[20:23], s48 offen offset:2048 sc1
    v_mfma_f32_16x16x32_bf16 v[212:215], a[152:155], v[148:151], v[212:215]
    v_mfma_f32_16x16x32_bf16 v[208:211], a[188:191], v[152:155], v[208:211]
    v_mfma_f32_16x16x32_bf16 v[212:215], a[188:191], v[156:159], v[212:215]
    v_mfma_f32_16x16x32_bf16 v[216:219], a[64:67], v[136:139], v[216:219]
    v_cvt_pk_bf16_f32 v200, v200, v201
    v_cvt_pk_bf16_f32 v201, v202, v203
    v_mfma_f32_16x16x32_bf16 v[220:223], a[64:67], v[140:143], v[220:223]
    buffer_store_dwordx2 v[200:201], v3, s[20:23], s48 offen offset:2560 sc1
    v_cvt_pk_bf16_f32 v204, v204, v205
    v_mfma_f32_16x16x32_bf16 v[216:219], a[156:159], v[144:147], v[216:219]
    v_cvt_pk_bf16_f32 v205, v206, v207
    buffer_store_dwordx2 v[204:205], v4, s[20:23], s48 offen offset:2560 sc1
    v_mfma_f32_16x16x32_bf16 v[220:223], a[156:159], v[148:151], v[220:223]
    v_mfma_f32_16x16x32_bf16 v[216:219], a[192:195], v[152:155], v[216:219]
    v_mfma_f32_16x16x32_bf16 v[220:223], a[192:195], v[156:159], v[220:223]
    v_mfma_f32_16x16x32_bf16 v[224:227], a[68:71], v[136:139], v[224:227]
    v_cvt_pk_bf16_f32 v208, v208, v209
    v_cvt_pk_bf16_f32 v209, v210, v211
    v_mfma_f32_16x16x32_bf16 v[228:231], a[68:71], v[140:143], v[228:231]
    buffer_store_dwordx2 v[208:209], v3, s[20:23], s48 offen offset:3072 sc1
    v_cvt_pk_bf16_f32 v212, v212, v213
    v_mfma_f32_16x16x32_bf16 v[224:227], a[160:163], v[144:147], v[224:227]
    v_cvt_pk_bf16_f32 v213, v214, v215
    buffer_store_dwordx2 v[212:213], v4, s[20:23], s48 offen offset:3072 sc1
    v_mfma_f32_16x16x32_bf16 v[228:231], a[160:163], v[148:151], v[228:231]
    v_mfma_f32_16x16x32_bf16 v[224:227], a[196:199], v[152:155], v[224:227]
    v_mfma_f32_16x16x32_bf16 v[228:231], a[196:199], v[156:159], v[228:231]
    v_cvt_pk_bf16_f32 v216, v216, v217
    v_cvt_pk_bf16_f32 v217, v218, v219
    buffer_store_dwordx2 v[216:217], v3, s[20:23], s48 offen offset:3584 sc1
    v_cvt_pk_bf16_f32 v220, v220, v221
    v_cvt_pk_bf16_f32 v221, v222, v223
    buffer_store_dwordx2 v[220:221], v4, s[20:23], s48 offen offset:3584 sc1
    s_nop 0
    v_cvt_pk_bf16_f32 v224, v224, v225
    v_cvt_pk_bf16_f32 v225, v226, v227
    buffer_store_dwordx2 v[224:225], v3, s[20:23], s49 offen offset:0 sc1
    v_cvt_pk_bf16_f32 v228, v228, v229
    v_cvt_pk_bf16_f32 v229, v230, v231
    buffer_store_dwordx2 v[228:229], v4, s[20:23], s49 offen offset:0 sc1
    s_waitcnt vmcnt(0)
    v_mov_b32 v254, 256
    buffer_atomic_add v254, v252, s[4:7], s50 offen
kb_fin:
k1_end:
    s_endpgm
code_end:
.section .rodata,"a"
.p2align 6
.amdhsa_kernel k1_kernel
  .amdhsa_next_free_vgpr 512
  .amdhsa_next_free_sgpr 102
  .amdhsa_accum_offset 256
  .amdhsa_group_segment_fixed_size 0
  .amdhsa_kernarg_size 88
  .amdhsa_user_sgpr_count 2
  .amdhsa_user_sgpr_kernarg_segment_ptr 1
  .amdhsa_system_sgpr_workgroup_id_x 1
  .amdhsa_float_denorm_mode_32 3
  .amdhsa_float_denorm_mode_16_64 3
  .amdhsa_ieee_mode 0
  .amdhsa_dx10_clamp 0
.end_amdhsa_kernel
```
